```python
import torch

def _softmax(x, axis=-1):
    return torch.softmax(x, dim=axis)
def _gelu(x):
    return torch.nn.functional.gelu(x, approximate="tanh")
def _silu(x):
    return torch.nn.functional.silu(x)
def _sigmoid(x):
    return torch.sigmoid(x)
def _layernorm(x, axis=-1, eps=1e-5):
    m = x.mean(dim=axis, keepdim=True)
    v = x.var(dim=axis, keepdim=True, unbiased=False)
    return (x - m) / torch.sqrt(v + eps)
def _scatter_add(tgt, idx, src, axis=0):
    return tgt.clone().index_add_(axis, idx, src)
def _segment_sum(src, seg, n):
    out = torch.zeros((n,) + src.shape[1:], dtype=src.dtype)
    return out.index_add_(0, seg, src)
def _pad(x, pw):
    flat = tuple(v for pair in reversed(pw) for v in pair)
    return torch.nn.functional.pad(x, flat)

kernel_name = 'recurrent_scan__sliding_block_cached__geglu_ffn__prompt'

def setup_inputs():

    _w = (lambda a: (lambda t: t.to(torch.bfloat16) if t.is_floating_point() else t)(torch.as_tensor(a)))
    def _A_setup():
        B, Sq, D = 1, 2048, 576
        Hq, Hkv, Sk, Dh = 32, 16, 2048, 128
        assert Hq % Hkv == 0, (Hq, Hkv)
        return {
            "x": _w((lambda *s: torch.randn(*s, dtype=torch.bfloat16) * 0.05)(B, Sq, D)),
            "k_cache": _w((lambda *s: torch.randn(*s, dtype=torch.bfloat16) * 0.8)(B, Hkv, Sk, Dh)),
            "v_cache": _w((lambda *s: torch.randn(*s, dtype=torch.bfloat16) * 0.2)(B, Hkv, Sk, Dh)),
            "wq": _w((lambda *s: torch.randn(*s, dtype=torch.bfloat16) * 0.8)(D, Hq * Dh) * (D ** -0.5)),
            "wo": _w((lambda *s: torch.randn(*s, dtype=torch.bfloat16) * 0.2)(Hq * Dh, D) * ((Hq * Dh) ** -0.5)),
        }
    _A_in = _A_setup()

    def _B_setup():
        B, S, D, F = 1, 2048, 576, 4608
        return {
            "x": _w((lambda *s: torch.randn(*s, dtype=torch.bfloat16) * 0.05)(B, S, D)),
            "w_gate": _w((lambda *s: torch.randn(*s, dtype=torch.bfloat16) * 0.1)(D, F)),
            "w_up": _w((lambda *s: torch.randn(*s, dtype=torch.bfloat16) * 0.1)(D, F)),
            "w_down": _w((lambda *s: torch.randn(*s, dtype=torch.bfloat16) * 0.1)(F, D)),
        }
    _B_in = _B_setup()

    return {
        "A_x": _A_in["x"],
        "A_k_cache": _A_in["k_cache"],
        "A_v_cache": _A_in["v_cache"],
        "A_wq": _A_in["wq"],
        "A_wo": _A_in["wo"],
        "B_x": _B_in["x"],
        "B_w_gate": _B_in["w_gate"],
        "B_w_up": _B_in["w_up"],
        "B_w_down": _B_in["w_down"],
    }

def reference(A_x, A_k_cache, A_v_cache, A_wq, A_wo, B_x, B_w_gate, B_w_up, B_w_down):
    def _A_ref(x, k_cache, v_cache, wq, wo):
        B, Sq, D = x.shape
        Hq, Dh = 32, 128
        Hkv, Sk = k_cache.shape[1], k_cache.shape[2]
        W = min(4096, max(256, Sk // 4))
        rep = Hq // Hkv
        q = (lambda x, *d: x.permute(*d))((x @ wq).reshape(B, Sq, Hq, Dh), 0, 2, 1, 3)
        k = (lambda x, n, axis: torch.repeat_interleave(x, n, dim=axis))(k_cache[:, :, Sk - W:, :], rep, axis=1)
        v = (lambda x, n, axis: torch.repeat_interleave(x, n, dim=axis))(v_cache[:, :, Sk - W:, :], rep, axis=1)
        scores = torch.einsum("bhqd,bhkd->bhqk", q, k) * (Dh ** -0.5)
        p = _softmax(scores, axis=-1)
        o = torch.einsum("bhqk,bhkd->bhqd", p, v)
        return (lambda x, *d: x.permute(*d))(o, 0, 2, 1, 3).reshape(B, Sq, Hq * Dh) @ wo

    def _B_ref(x, w_gate, w_up, w_down):
        return (_gelu(x @ w_gate) * (x @ w_up)) @ w_down

    x = A_x
    xn = _layernorm(x, axis=-1)
    s = _A_ref(xn, A_k_cache, A_v_cache, A_wq, A_wo)
    g = _silu(_B_ref(xn, B_w_gate, B_w_up, B_w_down))
    return x + s * g
```

```asm
; @launch grid=(256,1,1) block=(256,1,1) lds=131072
.amdgcn_target "amdgcn-amd-amdhsa--gfx950"
.macro Mvvv d,a,b
v_mfma_f32_16x16x32_bf16 v[\d:\d+3], v[\a:\a+3], v[\b:\b+3], v[\d:\d+3]
.endm
.macro Zvvv d,a,b
v_mfma_f32_16x16x32_bf16 v[\d:\d+3], v[\a:\a+3], v[\b:\b+3], 0
.endm
.macro Mvva d,a,b
v_mfma_f32_16x16x32_bf16 v[\d:\d+3], v[\a:\a+3], a[\b:\b+3], v[\d:\d+3]
.endm
.macro Zvva d,a,b
v_mfma_f32_16x16x32_bf16 v[\d:\d+3], v[\a:\a+3], a[\b:\b+3], 0
.endm
.macro Mvav d,a,b
v_mfma_f32_16x16x32_bf16 v[\d:\d+3], a[\a:\a+3], v[\b:\b+3], v[\d:\d+3]
.endm
.macro Zvav d,a,b
v_mfma_f32_16x16x32_bf16 v[\d:\d+3], a[\a:\a+3], v[\b:\b+3], 0
.endm
.macro Mvaa d,a,b
v_mfma_f32_16x16x32_bf16 v[\d:\d+3], a[\a:\a+3], a[\b:\b+3], v[\d:\d+3]
.endm
.macro Zvaa d,a,b
v_mfma_f32_16x16x32_bf16 v[\d:\d+3], a[\a:\a+3], a[\b:\b+3], 0
.endm
.macro Mavv d,a,b
v_mfma_f32_16x16x32_bf16 a[\d:\d+3], v[\a:\a+3], v[\b:\b+3], a[\d:\d+3]
.endm
.macro Zavv d,a,b
v_mfma_f32_16x16x32_bf16 a[\d:\d+3], v[\a:\a+3], v[\b:\b+3], 0
.endm
.macro Mava d,a,b
v_mfma_f32_16x16x32_bf16 a[\d:\d+3], v[\a:\a+3], a[\b:\b+3], a[\d:\d+3]
.endm
.macro Zava d,a,b
v_mfma_f32_16x16x32_bf16 a[\d:\d+3], v[\a:\a+3], a[\b:\b+3], 0
.endm
.macro Maav d,a,b
v_mfma_f32_16x16x32_bf16 a[\d:\d+3], a[\a:\a+3], v[\b:\b+3], a[\d:\d+3]
.endm
.macro Zaav d,a,b
v_mfma_f32_16x16x32_bf16 a[\d:\d+3], a[\a:\a+3], v[\b:\b+3], 0
.endm
.macro Maaa d,a,b
v_mfma_f32_16x16x32_bf16 a[\d:\d+3], a[\a:\a+3], a[\b:\b+3], a[\d:\d+3]
.endm
.macro Zaaa d,a,b
v_mfma_f32_16x16x32_bf16 a[\d:\d+3], a[\a:\a+3], a[\b:\b+3], 0
.endm
.macro Tv d,r,o
ds_read_b64_tr_b16 v[\d:\d+1], v\r offset:\o
.endm
.macro Bv d,r,o
ds_read_b128 v[\d:\d+3], v\r offset:\o
.endm
.macro Ta d,r,o
ds_read_b64_tr_b16 a[\d:\d+1], v\r offset:\o
.endm
.macro Ba d,r,o
ds_read_b128 a[\d:\d+3], v\r offset:\o
.endm
.macro GDMA v,r,o
global_load_lds_dwordx4 v\v, s[\r:\r+1] offset:\o
.endm
.macro DMA v,r,s,o
buffer_load_dwordx4 v\v, s[\r:\r+3], s\s offen offset:\o lds
.endm
.text
.globl recurrent_scan__sliding_block_cached__geglu_ffn__prompt_kernel
.p2align 8
.type recurrent_scan__sliding_block_cached__geglu_ffn__prompt_kernel,@function
recurrent_scan__sliding_block_cached__geglu_ffn__prompt_kernel:
s_cmp_lt_u32 s2, 256
s_cbranch_scc1 L_go
s_endpgm
L_go:
s_load_dwordx4 s[56:59], s[0:1], 0
s_load_dwordx4 s[60:63], s[0:1], 16
s_load_dwordx2 s[64:65], s[0:1], 32
s_load_dwordx4 s[68:71], s[0:1], 48
s_load_dwordx2 s[72:73], s[0:1], 64
s_load_dwordx2 s[74:75], s[0:1], 88
s_load_dwordx4 s[88:91], s[0:1], 72
v_cmp_eq_u32_e64 s[92:93], 0, v0
v_and_b32 v1, 63, v0
v_lshrrev_b32 v6, 6, v0
s_nop 0
v_readfirstlane_b32 s3, v6
s_and_b32 s32, s2, 7
s_lshr_b32 s33, s2, 3
s_and_b32 s33, s33, 15
s_lshr_b32 s34, s2, 7
s_mov_b32 s86, s33
s_mov_b32 s87, s33
s_lshl_b32 s45, s33, 7
s_nop 1
s_lshl_b32 s79, s3, 5
s_add_u32 s45, s45, s79
v_and_b32 v6, 15, v1
v_add_u32 v6, s45, v6
v_mul_u32_u24 v6, 0x480, v6
v_lshrrev_b32 v7, 4, v1
v_lshl_add_u32 v6, v7, 4, v6
s_movk_i32 s43, 0x4800
s_mov_b32 s6, 0x240000
s_mov_b32 s7, 0x20000
s_lshl_b32 s35, s3, 12
s_waitcnt lgkmcnt(0)
s_mov_b32 s4, s56
s_mov_b32 s5, s57
buffer_load_dwordx4 v[16:19], v6, s[4:7], 0 offen offset:0
buffer_load_dwordx4 v[20:23], v6, s[4:7], s43 offen offset:0
buffer_load_dwordx4 v[24:27], v6, s[4:7], 0 offen offset:64
buffer_load_dwordx4 v[28:31], v6, s[4:7], s43 offen offset:64
buffer_load_dwordx4 v[32:35], v6, s[4:7], 0 offen offset:128
buffer_load_dwordx4 v[36:39], v6, s[4:7], s43 offen offset:128
buffer_load_dwordx4 v[40:43], v6, s[4:7], 0 offen offset:192
buffer_load_dwordx4 v[44:47], v6, s[4:7], s43 offen offset:192
buffer_load_dwordx4 v[48:51], v6, s[4:7], 0 offen offset:256
buffer_load_dwordx4 v[52:55], v6, s[4:7], s43 offen offset:256
buffer_load_dwordx4 v[56:59], v6, s[4:7], 0 offen offset:320
buffer_load_dwordx4 v[60:63], v6, s[4:7], s43 offen offset:320
buffer_load_dwordx4 v[64:67], v6, s[4:7], 0 offen offset:384
buffer_load_dwordx4 v[68:71], v6, s[4:7], s43 offen offset:384
buffer_load_dwordx4 v[72:75], v6, s[4:7], 0 offen offset:448
buffer_load_dwordx4 v[76:79], v6, s[4:7], s43 offen offset:448
buffer_load_dwordx4 v[80:83], v6, s[4:7], 0 offen offset:512
buffer_load_dwordx4 v[84:87], v6, s[4:7], s43 offen offset:512
buffer_load_dwordx4 v[88:91], v6, s[4:7], 0 offen offset:576
buffer_load_dwordx4 v[92:95], v6, s[4:7], s43 offen offset:576
buffer_load_dwordx4 v[96:99], v6, s[4:7], 0 offen offset:640
buffer_load_dwordx4 v[100:103], v6, s[4:7], s43 offen offset:640
buffer_load_dwordx4 v[104:107], v6, s[4:7], 0 offen offset:704
buffer_load_dwordx4 v[108:111], v6, s[4:7], s43 offen offset:704
buffer_load_dwordx4 v[112:115], v6, s[4:7], 0 offen offset:768
buffer_load_dwordx4 v[116:119], v6, s[4:7], s43 offen offset:768
buffer_load_dwordx4 v[120:123], v6, s[4:7], 0 offen offset:832
buffer_load_dwordx4 v[124:127], v6, s[4:7], s43 offen offset:832
buffer_load_dwordx4 v[128:131], v6, s[4:7], 0 offen offset:896
buffer_load_dwordx4 v[132:135], v6, s[4:7], s43 offen offset:896
buffer_load_dwordx4 v[136:139], v6, s[4:7], 0 offen offset:960
buffer_load_dwordx4 v[140:143], v6, s[4:7], s43 offen offset:960
buffer_load_dwordx4 v[144:147], v6, s[4:7], 0 offen offset:1024
buffer_load_dwordx4 v[148:151], v6, s[4:7], s43 offen offset:1024
buffer_load_dwordx4 v[152:155], v6, s[4:7], 0 offen offset:1088
buffer_load_dwordx4 v[156:159], v6, s[4:7], s43 offen offset:1088
s_mov_b32 s28, s74
s_mov_b32 s29, s75
s_mov_b32 s30, 0x10000000
s_mov_b32 s31, 0x20000
s_mov_b32 s46, 0xffff0000
s_mov_b32 s50, 0xaaaaaaaa
s_mov_b32 s51, 0xaaaaaaaa
s_mov_b32 s52, 0xcccccccc
s_mov_b32 s53, 0xcccccccc
s_lshl_b32 s47, s33, 4
s_lshl_b32 s45, s34, 3
s_add_u32 s47, s47, s45
s_add_u32 s47, s47, s32
s_lshl_b32 s47, s47, 2
s_add_u32 s47, s47, s3
s_mul_i32 s47, s47, 0x9000
s_cmp_lg_u32 s34, 0
s_cbranch_scc1 L_ffn
L_att:
s_mov_b32 s8, s62
s_mov_b32 s9, s63
s_mov_b32 s10, 0x480000
s_mov_b32 s11, 0x20000
s_mov_b32 s12, s64
s_mov_b32 s13, s65
s_mov_b32 s14, 0x480000
s_mov_b32 s15, 0x20000
s_mov_b32 s20, s58
s_mov_b32 s21, s59
s_mov_b32 s22, 0x800000
s_mov_b32 s23, 0x20000
s_mov_b32 s24, s60
s_mov_b32 s25, s61
s_mov_b32 s26, 0x800000
s_mov_b32 s27, 0x20000
s_cmp_lt_u32 s3, 2
s_cselect_b32 s16, s58, s60
s_cselect_b32 s17, s59, s61
s_mov_b32 s18, 0x800000
s_mov_b32 s19, 0x20000
s_cselect_b32 s76, 64, 0x80
s_cselect_b32 s77, 0x80, 0
s_xor_b32 s78, s76, s77
s_lshl_b32 s45, s32, 10
s_lshl_b32 s36, s3, 18
s_add_u32 s36, s36, s45
s_and_b32 s79, s3, 1
s_lshl_b32 s37, s79, 18
s_lshr_b32 s80, s3, 1
s_lshl_b32 s80, s80, 7
s_add_u32 s37, s37, s80
s_add_u32 s37, s37, s45
s_lshl_b32 s38, s32, 20
s_lshl_b32 s79, s79, 12
s_add_u32 s38, s38, s79
s_add_u32 s38, s38, 0x60000
s_lshl_b32 s84, s32, 20
s_add_u32 s84, s84, 0x60000
s_mul_i32 s39, s3, 0x9000
s_mul_i32 s45, s32, 0x90000
s_add_u32 s39, s39, s45
v_lshrrev_b32 v244, 3, v1
v_bfe_u32 v245, v1, 1, 2
v_bfe_u32 v13, v1, 4, 1
v_xor_b32 v245, v245, v13
v_lshlrev_b32 v245, 5, v245
v_and_b32 v13, 1, v1
v_lshl_or_b32 v245, v13, 4, v245
v_mul_u32_u24 v244, 0x2000, v244
v_add_u32 v12, v244, v245
v_xor_b32 v13, 64, v12
v_add_u32 v13, 0xfc00, v13
v_add_u32 v14, 0x1f800, v12
v_xor_b32 v15, 64, v12
v_add_u32 v15, 0x2f400, v15
v_lshrrev_b32 v244, 4, v1
v_lshlrev_b32 v244, 10, v244
v_bfe_u32 v245, v1, 2, 2
v_lshl_or_b32 v244, v245, 7, v244
v_bfe_u32 v245, v1, 3, 2
v_lshl_or_b32 v244, v245, 5, v244
v_and_b32 v245, 3, v1
v_lshl_or_b32 v2, v245, 3, v244
v_xor_b32 v3, 32, v2
v_xor_b32 v4, 64, v2
v_xor_b32 v5, 0x60, v2
s_lshl_b32 s42, s34, 3
s_add_u32 s42, s42, s32
s_lshl_b32 s45, s33, 7
s_lshl_b32 s79, s42, 2
s_add_u32 s45, s45, s79
s_add_u32 s45, s45, 0xc800000
v_mov_b32 v246, 0x7ffffff0
v_mov_b32 v247, s45
v_cndmask_b32 v246, v246, v247, s[92:93]
v_mov_b32 v247, 0
buffer_store_dword v247, v246, s[28:31], 0 offen offset:0 sc1
s_mov_b32 s60, s88
s_mov_b32 s61, s89
s_mov_b32 s62, 0x240000
s_mov_b32 s63, 0x20000
s_mov_b32 s68, s90
s_mov_b32 s69, s91
s_mov_b32 s70, 0x100
s_mov_b32 s71, 0x20000
s_mov_b32 m0, s35
s_mov_b32 s44, s37
s_add_u32 s98, s8, s44
s_addc_u32 s99, s9, 0
GDMA 12,98,0
GDMA 13,98,1024
GDMA 14,98,2048
GDMA 15,98,3072
s_getpc_b64 s[54:55]
L_pc_L_att:
s_lshl_b32 s45, s86, 2
s_add_u32 s45, s45, s3
s_lshl_b32 s45, s45, 11
v_lshlrev_b32 v7, 5, v1
v_add_u32 v7, s45, v7
v_min_u32 v7, L_att_end-L_pc_L_att-4, v7
global_load_dword v255, v7, s[54:55]
v_mov_b32 v240, 0x3f803f80
v_mov_b32 v241, 0x3f803f80
v_mov_b32 v242, 0x3f803f80
v_mov_b32 v243, 0x3f803f80
s_nop 1
s_waitcnt vmcnt(41)
Zvvv 224,240,16
Zvvv 228,16,16
s_waitcnt vmcnt(40)
Zvvv 232,240,20
Zvvv 236,20,20
s_waitcnt vmcnt(39)
Mvvv 224,240,24
Mvvv 228,24,24
s_waitcnt vmcnt(38)
Mvvv 232,240,28
Mvvv 236,28,28
s_waitcnt vmcnt(37)
Mvvv 224,240,32
Mvvv 228,32,32
s_waitcnt vmcnt(36)
Mvvv 232,240,36
Mvvv 236,36,36
s_waitcnt vmcnt(35)
Mvvv 224,240,40
Mvvv 228,40,40
s_waitcnt vmcnt(34)
Mvvv 232,240,44
Mvvv 236,44,44
s_waitcnt vmcnt(33)
Mvvv 224,240,48
Mvvv 228,48,48
s_waitcnt vmcnt(32)
Mvvv 232,240,52
Mvvv 236,52,52
s_waitcnt vmcnt(31)
Mvvv 224,240,56
Mvvv 228,56,56
s_waitcnt vmcnt(30)
Mvvv 232,240,60
Mvvv 236,60,60
s_waitcnt vmcnt(29)
Mvvv 224,240,64
Mvvv 228,64,64
s_waitcnt vmcnt(28)
Mvvv 232,240,68
Mvvv 236,68,68
s_waitcnt vmcnt(27)
Mvvv 224,240,72
Mvvv 228,72,72
s_waitcnt vmcnt(26)
Mvvv 232,240,76
Mvvv 236,76,76
s_waitcnt vmcnt(25)
Mvvv 224,240,80
Mvvv 228,80,80
s_waitcnt vmcnt(24)
Mvvv 232,240,84
Mvvv 236,84,84
s_waitcnt vmcnt(23)
Mvvv 224,240,88
Mvvv 228,88,88
s_waitcnt vmcnt(22)
Mvvv 232,240,92
Mvvv 236,92,92
s_waitcnt vmcnt(21)
Mvvv 224,240,96
Mvvv 228,96,96
s_waitcnt vmcnt(20)
Mvvv 232,240,100
Mvvv 236,100,100
s_waitcnt vmcnt(19)
Mvvv 224,240,104
Mvvv 228,104,104
s_waitcnt vmcnt(18)
Mvvv 232,240,108
Mvvv 236,108,108
s_waitcnt vmcnt(17)
Mvvv 224,240,112
Mvvv 228,112,112
s_waitcnt vmcnt(16)
Mvvv 232,240,116
Mvvv 236,116,116
s_waitcnt vmcnt(15)
Mvvv 224,240,120
Mvvv 228,120,120
s_waitcnt vmcnt(14)
Mvvv 232,240,124
Mvvv 236,124,124
s_add_u32 m0, s35, 0x4000
s_add_u32 s44, s37, 0x100
s_add_u32 s98, s8, s44
s_addc_u32 s99, s9, 0
GDMA 12,98,0
GDMA 13,98,1024
GDMA 14,98,2048
GDMA 15,98,3072
s_add_u32 m0, s35, 0x8000
s_add_u32 s44, s37, 0x200
s_add_u32 s98, s8, s44
s_addc_u32 s99, s9, 0
GDMA 12,98,0
GDMA 13,98,1024
GDMA 14,98,2048
GDMA 15,98,3072
s_waitcnt vmcnt(21)
Mvvv 224,240,128
Mvvv 228,128,128
s_waitcnt vmcnt(20)
Mvvv 232,240,132
Mvvv 236,132,132
s_waitcnt vmcnt(19)
Mvvv 224,240,136
Mvvv 228,136,136
s_waitcnt vmcnt(18)
Mvvv 232,240,140
Mvvv 236,140,140
s_waitcnt vmcnt(17)
Mvvv 224,240,144
Mvvv 228,144,144
s_waitcnt vmcnt(16)
Mvvv 232,240,148
Mvvv 236,148,148
s_waitcnt vmcnt(15)
Mvvv 224,240,152
Mvvv 228,152,152
s_waitcnt vmcnt(14)
Mvvv 232,240,156
Mvvv 236,156,156
v_and_b32 v244, 15, v1
v_lshrrev_b32 v245, 2, v244
v_lshl_add_u32 v244, v245, 4, v244
v_lshlrev_b32 v244, 2, v244
s_nop 0
v_cndmask_b32 v246, v228, v229, s[50:51]
v_cndmask_b32 v247, v230, v231, s[50:51]
v_cndmask_b32 v246, v246, v247, s[52:53]
ds_bpermute_b32 v248, v244, v246
v_cndmask_b32 v246, v236, v237, s[50:51]
v_cndmask_b32 v247, v238, v239, s[50:51]
v_cndmask_b32 v246, v246, v247, s[52:53]
ds_bpermute_b32 v249, v244, v246
v_mul_f32 v250, 0x3ae38e39, v224
s_waitcnt lgkmcnt(1)
v_mul_f32 v248, 0x3ae38e39, v248
v_fma_f32 v248, -v250, v250, v248
v_max_f32 v248, 0, v248
v_add_f32 v248, 0x3727c5ac, v248
v_rsq_f32 v248, v248
s_nop 0
v_mul_f32 v8, 0x3e0293ee, v248
v_mul_f32 v10, -v250, v8
v_mul_f32 v251, 0x3ae38e39, v232
s_waitcnt lgkmcnt(0)
v_mul_f32 v249, 0x3ae38e39, v249
v_fma_f32 v249, -v251, v251, v249
v_max_f32 v249, 0, v249
v_add_f32 v249, 0x3727c5ac, v249
v_rsq_f32 v249, v249
s_nop 0
v_mul_f32 v9, 0x3e0293ee, v249
v_mul_f32 v11, -v251, v9
s_waitcnt vmcnt(9)
s_barrier
Ta 224,2,0
Ta 226,2,512
Ta 228,3,0
Ta 230,3,512
Ta 232,4,0
Ta 234,4,512
Ta 236,5,0
Ta 238,5,512
Ta 240,2,4096
Ta 242,2,4608
Ta 244,3,4096
Ta 246,3,4608
v_lshlrev_b32 v6, 16, v16
v_and_b32 v7, s46, v16
v_pk_fma_f32 v[6:7], v[6:7], v[8:9], v[10:11] op_sel:[0,0,0] op_sel_hi:[1,0,0]
v_cvt_pk_bf16_f32 v16, v6, v7
v_lshlrev_b32 v246, 16, v17
v_and_b32 v247, s46, v17
v_pk_fma_f32 v[246:247], v[246:247], v[8:9], v[10:11] op_sel:[0,0,0] op_sel_hi:[1,0,0]
v_cvt_pk_bf16_f32 v17, v246, v247
v_lshlrev_b32 v6, 16, v18
v_and_b32 v7, s46, v18
v_pk_fma_f32 v[6:7], v[6:7], v[8:9], v[10:11] op_sel:[0,0,0] op_sel_hi:[1,0,0]
v_cvt_pk_bf16_f32 v18, v6, v7
v_lshlrev_b32 v246, 16, v19
v_and_b32 v247, s46, v19
v_pk_fma_f32 v[246:247], v[246:247], v[8:9], v[10:11] op_sel:[0,0,0] op_sel_hi:[1,0,0]
v_cvt_pk_bf16_f32 v19, v246, v247
v_lshlrev_b32 v6, 16, v20
v_and_b32 v7, s46, v20
v_pk_fma_f32 v[6:7], v[6:7], v[8:9], v[10:11] op_sel:[0,1,1] op_sel_hi:[1,1,1]
v_cvt_pk_bf16_f32 v20, v6, v7
v_lshlrev_b32 v246, 16, v21
v_and_b32 v247, s46, v21
v_pk_fma_f32 v[246:247], v[246:247], v[8:9], v[10:11] op_sel:[0,1,1] op_sel_hi:[1,1,1]
v_cvt_pk_bf16_f32 v21, v246, v247
v_lshlrev_b32 v6, 16, v22
v_and_b32 v7, s46, v22
v_pk_fma_f32 v[6:7], v[6:7], v[8:9], v[10:11] op_sel:[0,1,1] op_sel_hi:[1,1,1]
v_cvt_pk_bf16_f32 v22, v6, v7
v_lshlrev_b32 v246, 16, v23
v_and_b32 v247, s46, v23
v_pk_fma_f32 v[246:247], v[246:247], v[8:9], v[10:11] op_sel:[0,1,1] op_sel_hi:[1,1,1]
v_cvt_pk_bf16_f32 v23, v246, v247
v_lshlrev_b32 v6, 16, v24
v_and_b32 v7, s46, v24
v_pk_fma_f32 v[6:7], v[6:7], v[8:9], v[10:11] op_sel:[0,0,0] op_sel_hi:[1,0,0]
v_cvt_pk_bf16_f32 v24, v6, v7
v_lshlrev_b32 v246, 16, v25
v_and_b32 v247, s46, v25
v_pk_fma_f32 v[246:247], v[246:247], v[8:9], v[10:11] op_sel:[0,0,0] op_sel_hi:[1,0,0]
v_cvt_pk_bf16_f32 v25, v246, v247
v_lshlrev_b32 v6, 16, v26
v_and_b32 v7, s46, v26
v_pk_fma_f32 v[6:7], v[6:7], v[8:9], v[10:11] op_sel:[0,0,0] op_sel_hi:[1,0,0]
v_cvt_pk_bf16_f32 v26, v6, v7
v_lshlrev_b32 v246, 16, v27
v_and_b32 v247, s46, v27
v_pk_fma_f32 v[246:247], v[246:247], v[8:9], v[10:11] op_sel:[0,0,0] op_sel_hi:[1,0,0]
v_cvt_pk_bf16_f32 v27, v246, v247
v_lshlrev_b32 v6, 16, v28
v_and_b32 v7, s46, v28
v_pk_fma_f32 v[6:7], v[6:7], v[8:9], v[10:11] op_sel:[0,1,1] op_sel_hi:[1,1,1]
v_cvt_pk_bf16_f32 v28, v6, v7
v_lshlrev_b32 v246, 16, v29
v_and_b32 v247, s46, v29
v_pk_fma_f32 v[246:247], v[246:247], v[8:9], v[10:11] op_sel:[0,1,1] op_sel_hi:[1,1,1]
v_cvt_pk_bf16_f32 v29, v246, v247
v_lshlrev_b32 v6, 16, v30
v_and_b32 v7, s46, v30
v_pk_fma_f32 v[6:7], v[6:7], v[8:9], v[10:11] op_sel:[0,1,1] op_sel_hi:[1,1,1]
v_cvt_pk_bf16_f32 v30, v6, v7
v_lshlrev_b32 v246, 16, v31
v_and_b32 v247, s46, v31
v_pk_fma_f32 v[246:247], v[246:247], v[8:9], v[10:11] op_sel:[0,1,1] op_sel_hi:[1,1,1]
v_cvt_pk_bf16_f32 v31, v246, v247
s_waitcnt lgkmcnt(10)
Zvav 160,224,16
Ta 248,4,4096
s_add_u32 m0, s35, 0xc000
Zvav 164,224,20
Ta 250,4,4608
s_waitcnt lgkmcnt(4)
Zvav 172,228,20
Ta 252,5,4096
s_add_u32 s44, s37, 0x300
Zvav 168,228,16
Ta 254,5,4608
s_add_u32 s98, s8, s44
s_addc_u32 s99, s9, 0
Zvav 176,232,16
Ta 224,2,8192
GDMA 12,98,0
Zvav 180,232,20
Ta 226,2,8704
GDMA 13,98,1024
Zvav 188,236,20
Ta 228,3,8192
v_lshlrev_b32 v6, 16, v32
Zvav 184,236,16
Ta 230,3,8704
v_and_b32 v7, s46, v32
Mvav 160,240,24
Ta 232,4,8192
GDMA 14,98,2048
Mvav 164,240,28
Ta 234,4,8704
s_waitcnt lgkmcnt(4)
Mvav 172,244,28
Ta 236,5,8192
v_fma_f32 v6, v6, v8, v10
Mvav 168,244,24
Ta 238,5,8704
v_fma_f32 v7, v7, v8, v10
Mvav 176,248,24
Ta 240,2,12288
GDMA 15,98,3072
Mvav 180,248,28
Ta 242,2,12800
v_cvt_pk_bf16_f32 v32, v6, v7
Mvav 188,252,28
Ta 244,3,12288
v_lshlrev_b32 v6, 16, v33
Mvav 184,252,24
Ta 246,3,12800
v_and_b32 v7, s46, v33
Zvav 192,224,16
Ta 248,4,12288
s_add_u32 m0, s35, 0x10000
Zvav 196,224,20
Ta 250,4,12800
s_waitcnt lgkmcnt(4)
Zvav 204,228,20
Ta 252,5,12288
s_add_u32 s44, s36, 0x80000
Zvav 200,228,16
Ta 254,5,12800
s_waitcnt vmcnt(8)
s_barrier
Zvav 208,232,16
Ta 224,2,16384
s_add_u32 s98, s8, s44
s_addc_u32 s99, s9, 0
Zvav 212,232,20
Ta 226,2,16896
GDMA 12,98,0
Zvav 220,236,20
Ta 228,3,16384
GDMA 13,98,1024
Zvav 216,236,16
Ta 230,3,16896
v_fma_f32 v6, v6, v8, v10
Mvav 192,240,24
Ta 232,4,16384
GDMA 14,98,2048
Mvav 196,240,28
Ta 234,4,16896
s_waitcnt lgkmcnt(4)
Mvav 204,244,28
Ta 236,5,16384
v_fma_f32 v7, v7, v8, v10
Mvav 200,244,24
Ta 238,5,16896
v_cvt_pk_bf16_f32 v33, v6, v7
Mvav 208,248,24
Ta 240,2,20480
GDMA 15,98,3072
Mvav 212,248,28
Ta 242,2,20992
v_lshlrev_b32 v6, 16, v34
Mvav 220,252,28
Ta 244,3,20480
v_and_b32 v7, s46, v34
Mvav 216,252,24
Ta 246,3,20992
v_fma_f32 v6, v6, v8, v10
Zvav 224,224,16
Ta 248,4,20480
s_add_u32 m0, s35, 0x14000
Zvav 228,224,20
Ta 250,4,20992
s_waitcnt lgkmcnt(4)
Zvav 236,228,20
Ta 252,5,20480
s_add_u32 s44, s36, 0x80080
Zvav 232,228,16
Ta 254,5,20992
s_add_u32 s98, s8, s44
s_addc_u32 s99, s9, 0
Zvav 240,232,16
Ta 224,2,24576
GDMA 12,98,0
Zvav 244,232,20
Ta 226,2,25088
GDMA 13,98,1024
Zvav 252,236,20
Ta 228,3,24576
v_fma_f32 v7, v7, v8, v10
Zvav 248,236,16
Ta 230,3,25088
v_cvt_pk_bf16_f32 v34, v6, v7
Mvav 224,240,24
Ta 232,4,24576
GDMA 14,98,2048
Mvav 228,240,28
Ta 234,4,25088
s_waitcnt lgkmcnt(4)
Mvav 236,244,28
Ta 236,5,24576
v_lshlrev_b32 v6, 16, v35
Mvav 232,244,24
Ta 238,5,25088
v_and_b32 v7, s46, v35
Mvav 240,248,24
Ta 240,2,28672
GDMA 15,98,3072
Mvav 244,248,28
Ta 242,2,29184
v_fma_f32 v6, v6, v8, v10
Mvav 252,252,28
Ta 244,3,28672
v_fma_f32 v7, v7, v8, v10
Mvav 248,252,24
Ta 246,3,29184
v_cvt_pk_bf16_f32 v35, v6, v7
Zaav 128,224,16
Ta 248,4,28672
s_add_u32 m0, s35, 0x18000
Zaav 132,224,20
Ta 250,4,29184
s_waitcnt lgkmcnt(4)
Zaav 140,228,20
Ta 252,5,28672
s_add_u32 s44, s36, 0x80100
Zaav 136,228,16
Ta 254,5,29184
s_waitcnt vmcnt(12)
s_barrier
Zaav 144,232,16
Ta 224,2,32768
s_add_u32 s98, s8, s44
s_addc_u32 s99, s9, 0
Zaav 148,232,20
Ta 226,2,33280
GDMA 12,98,0
Zaav 156,236,20
Ta 228,3,32768
GDMA 13,98,1024
Zaav 152,236,16
Ta 230,3,33280
v_lshlrev_b32 v6, 16, v36
Maav 128,240,24
Ta 232,4,32768
GDMA 14,98,2048
Maav 132,240,28
Ta 234,4,33280
s_waitcnt lgkmcnt(4)
Maav 140,244,28
Ta 236,5,32768
v_and_b32 v7, s46, v36
Maav 136,244,24
Ta 238,5,33280
v_fma_f32 v6, v6, v9, v11
Maav 144,248,24
Ta 240,2,36864
GDMA 15,98,3072
Maav 148,248,28
Ta 242,2,37376
v_fma_f32 v7, v7, v9, v11
v_cvt_pk_bf16_f32 v36, v6, v7
Maav 156,252,28
Ta 244,3,36864
v_lshlrev_b32 v6, 16, v37
Maav 152,252,24
Ta 246,3,37376
v_and_b32 v7, s46, v37
v_fma_f32 v6, v6, v9, v11
Zaav 0,224,16
Ta 248,4,36864
s_add_u32 m0, s35, 0x1c000
v_fma_f32 v7, v7, v9, v11
Zaav 4,224,20
Ta 250,4,37376
v_cvt_pk_bf16_f32 v37, v6, v7
v_lshlrev_b32 v6, 16, v38
s_waitcnt lgkmcnt(4)
Zaav 12,228,20
Ta 252,5,36864
s_add_u32 s44, s36, 0x80180
v_and_b32 v7, s46, v38
Zaav 8,228,16
Ta 254,5,37376
s_add_u32 s98, s8, s44
s_addc_u32 s99, s9, 0
v_fma_f32 v6, v6, v9, v11
v_fma_f32 v7, v7, v9, v11
Zaav 16,232,16
Ta 224,2,40960
GDMA 12,98,0
v_cvt_pk_bf16_f32 v38, v6, v7
Zaav 20,232,20
Ta 226,2,41472
GDMA 13,98,1024
v_lshlrev_b32 v6, 16, v39
v_and_b32 v7, s46, v39
Zaav 28,236,20
Ta 228,3,40960
v_fma_f32 v6, v6, v9, v11
Zaav 24,236,16
Ta 230,3,41472
v_fma_f32 v7, v7, v9, v11
v_cvt_pk_bf16_f32 v39, v6, v7
Maav 0,240,24
Ta 232,4,40960
GDMA 14,98,2048
v_lshlrev_b32 v6, 16, v40
Maav 4,240,28
Ta 234,4,41472
v_and_b32 v7, s46, v40
v_fma_f32 v6, v6, v8, v10
s_waitcnt lgkmcnt(4)
Maav 12,244,28
Ta 236,5,40960
v_fma_f32 v7, v7, v8, v10
Maav 8,244,24
Ta 238,5,41472
v_cvt_pk_bf16_f32 v40, v6, v7
v_lshlrev_b32 v6, 16, v41
Maav 16,248,24
Ta 240,2,45056
GDMA 15,98,3072
v_and_b32 v7, s46, v41
Maav 20,248,28
Ta 242,2,45568
s_mov_b32 m0, s35
v_fma_f32 v6, v6, v8, v10
v_fma_f32 v7, v7, v8, v10
Maav 28,252,28
Ta 244,3,45056
s_add_u32 s44, s36, 0x80200
v_cvt_pk_bf16_f32 v41, v6, v7
Maav 24,252,24
Ta 246,3,45568
s_add_u32 s98, s8, s44
s_addc_u32 s99, s9, 0
v_lshlrev_b32 v6, 16, v42
v_and_b32 v7, s46, v42
Zaav 32,224,16
Ta 248,4,45056
GDMA 12,98,0
v_fma_f32 v6, v6, v8, v10
Zaav 36,224,20
Ta 250,4,45568
v_fma_f32 v7, v7, v8, v10
v_cvt_pk_bf16_f32 v42, v6, v7
s_waitcnt lgkmcnt(4)
Zaav 44,228,20
Ta 252,5,45056
GDMA 13,98,1024
v_lshlrev_b32 v6, 16, v43
Zaav 40,228,16
Ta 254,5,45568
v_and_b32 v7, s46, v43
v_fma_f32 v6, v6, v8, v10
s_waitcnt vmcnt(18)
s_barrier
Zaav 48,232,16
Ta 224,2,49152
GDMA 14,98,2048
v_fma_f32 v7, v7, v8, v10
Zaav 52,232,20
Ta 226,2,49664
GDMA 15,98,3072
v_cvt_pk_bf16_f32 v43, v6, v7
Zaav 60,236,20
Ta 228,3,49152
s_add_u32 m0, s35, 0x4000
v_lshlrev_b32 v6, 16, v44
v_and_b32 v7, s46, v44
Zaav 56,236,16
Ta 230,3,49664
s_add_u32 s44, s36, 0x80280
v_fma_f32 v6, v6, v9, v11
Maav 32,240,24
Ta 232,4,49152
s_add_u32 s98, s8, s44
s_addc_u32 s99, s9, 0
v_fma_f32 v7, v7, v9, v11
v_cvt_pk_bf16_f32 v44, v6, v7
Maav 36,240,28
Ta 234,4,49664
v_lshlrev_b32 v6, 16, v45
s_waitcnt lgkmcnt(4)
Maav 44,244,28
Ta 236,5,49152
GDMA 12,98,0
v_and_b32 v7, s46, v45
v_fma_f32 v6, v6, v9, v11
Maav 40,244,24
Ta 238,5,49664
GDMA 13,98,1024
v_fma_f32 v7, v7, v9, v11
Maav 48,248,24
Ta 240,2,53248
GDMA 14,98,2048
v_cvt_pk_bf16_f32 v45, v6, v7
v_lshlrev_b32 v6, 16, v46
Maav 52,248,28
Ta 242,2,53760
v_and_b32 v7, s46, v46
Maav 60,252,28
Ta 244,3,53248
v_fma_f32 v6, v6, v9, v11
v_fma_f32 v7, v7, v9, v11
Maav 56,252,24
Ta 246,3,53760
v_cvt_pk_bf16_f32 v46, v6, v7
Zaav 64,224,16
Ta 248,4,53248
GDMA 15,98,3072
v_lshlrev_b32 v6, 16, v47
v_and_b32 v7, s46, v47
Zaav 68,224,20
Ta 250,4,53760
v_fma_f32 v6, v6, v9, v11
s_waitcnt lgkmcnt(4)
Zaav 76,228,20
Ta 252,5,53248
v_fma_f32 v7, v7, v9, v11
v_cvt_pk_bf16_f32 v47, v6, v7
Zaav 72,228,16
Ta 254,5,53760
v_lshlrev_b32 v6, 16, v48
Zaav 80,232,16
Ta 224,2,57344
v_and_b32 v7, s46, v48
v_fma_f32 v6, v6, v8, v10
Zaav 84,232,20
Ta 226,2,57856
v_fma_f32 v7, v7, v8, v10
Zaav 92,236,20
Ta 228,3,57344
v_cvt_pk_bf16_f32 v48, v6, v7
v_lshlrev_b32 v6, 16, v49
Zaav 88,236,16
Ta 230,3,57856
v_and_b32 v7, s46, v49
Maav 64,240,24
Ta 232,4,57344
v_fma_f32 v6, v6, v8, v10
v_fma_f32 v7, v7, v8, v10
Maav 68,240,28
Ta 234,4,57856
v_cvt_pk_bf16_f32 v49, v6, v7
s_waitcnt lgkmcnt(4)
Maav 76,244,28
Ta 236,5,57344
v_lshlrev_b32 v6, 16, v50
v_and_b32 v7, s46, v50
Maav 72,244,24
Ta 238,5,57856
v_fma_f32 v6, v6, v8, v10
Maav 80,248,24
Ta 240,2,61440
v_fma_f32 v7, v7, v8, v10
v_cvt_pk_bf16_f32 v50, v6, v7
Maav 84,248,28
Ta 242,2,61952
v_xor_b32 v2, 0x10000, v2
v_lshlrev_b32 v6, 16, v51
Maav 92,252,28
Ta 244,3,61440
v_and_b32 v7, s46, v51
v_fma_f32 v6, v6, v8, v10
Maav 88,252,24
Ta 246,3,61952
v_xor_b32 v3, 0x10000, v3
v_fma_f32 v7, v7, v8, v10
Zaav 96,224,16
Ta 248,4,61440
v_cvt_pk_bf16_f32 v51, v6, v7
v_lshlrev_b32 v6, 16, v52
Zaav 100,224,20
Ta 250,4,61952
v_and_b32 v7, s46, v52
s_waitcnt lgkmcnt(4)
Zaav 108,228,20
Ta 252,5,61440
v_xor_b32 v4, 0x10000, v4
v_fma_f32 v6, v6, v9, v11
v_fma_f32 v7, v7, v9, v11
Zaav 104,228,16
Ta 254,5,61952
v_cvt_pk_bf16_f32 v52, v6, v7
s_waitcnt vmcnt(20)
s_barrier
Zaav 112,232,16
Ta 224,2,0
v_xor_b32 v5, 0x10000, v5
v_lshlrev_b32 v6, 16, v53
v_and_b32 v7, s46, v53
Zaav 116,232,20
Ta 226,2,512
s_add_u32 m0, s35, 0x8000
v_fma_f32 v6, v6, v9, v11
Zaav 124,236,20
Ta 228,3,0
s_add_u32 s44, s36, 0x80300
v_fma_f32 v7, v7, v9, v11
v_cvt_pk_bf16_f32 v53, v6, v7
Zaav 120,236,16
Ta 230,3,512
s_add_u32 s98, s8, s44
s_addc_u32 s99, s9, 0
v_lshlrev_b32 v6, 16, v54
Maav 96,240,24
Ta 232,4,0
GDMA 12,98,0
v_and_b32 v7, s46, v54
v_fma_f32 v6, v6, v9, v11
Maav 100,240,28
Ta 234,4,512
v_fma_f32 v7, v7, v9, v11
s_waitcnt lgkmcnt(4)
Maav 108,244,28
Ta 236,5,0
GDMA 13,98,1024
v_cvt_pk_bf16_f32 v54, v6, v7
v_lshlrev_b32 v6, 16, v55
Maav 104,244,24
Ta 238,5,512
v_and_b32 v7, s46, v55
Maav 112,248,24
Ta 240,2,4096
GDMA 14,98,2048
v_fma_f32 v6, v6, v9, v11
v_fma_f32 v7, v7, v9, v11
Maav 116,248,28
Ta 242,2,4608
v_cvt_pk_bf16_f32 v55, v6, v7
Maav 124,252,28
Ta 244,3,4096
v_lshlrev_b32 v6, 16, v56
v_and_b32 v7, s46, v56
Maav 120,252,24
Ta 246,3,4608
v_fma_f32 v6, v6, v8, v10
Mvav 160,224,32
Ta 248,4,4096
GDMA 15,98,3072
v_fma_f32 v7, v7, v8, v10
v_cvt_pk_bf16_f32 v56, v6, v7
Mvav 164,224,36
Ta 250,4,4608
v_lshlrev_b32 v6, 16, v57
s_waitcnt lgkmcnt(4)
Mvav 172,228,36
Ta 252,5,4096
v_and_b32 v7, s46, v57
v_fma_f32 v6, v6, v8, v10
Mvav 168,228,32
Ta 254,5,4608
v_fma_f32 v7, v7, v8, v10
Mvav 176,232,32
Ta 224,2,8192
v_cvt_pk_bf16_f32 v57, v6, v7
v_lshlrev_b32 v6, 16, v58
Mvav 180,232,36
Ta 226,2,8704
v_and_b32 v7, s46, v58
Mvav 188,236,36
Ta 228,3,8192
v_fma_f32 v6, v6, v8, v10
v_fma_f32 v7, v7, v8, v10
Mvav 184,236,32
Ta 230,3,8704
v_cvt_pk_bf16_f32 v58, v6, v7
Mvav 160,240,40
Ta 232,4,8192
v_lshlrev_b32 v6, 16, v59
v_and_b32 v7, s46, v59
Mvav 164,240,44
Ta 234,4,8704
v_fma_f32 v6, v6, v8, v10
s_waitcnt lgkmcnt(4)
Mvav 172,244,44
Ta 236,5,8192
v_fma_f32 v7, v7, v8, v10
v_cvt_pk_bf16_f32 v59, v6, v7
Mvav 168,244,40
Ta 238,5,8704
v_lshlrev_b32 v6, 16, v60
Mvav 176,248,40
Ta 240,2,12288
v_and_b32 v7, s46, v60
v_fma_f32 v6, v6, v9, v11
Mvav 180,248,44
Ta 242,2,12800
v_fma_f32 v7, v7, v9, v11
Mvav 188,252,44
Ta 244,3,12288
v_cvt_pk_bf16_f32 v60, v6, v7
v_lshlrev_b32 v6, 16, v61
Mvav 184,252,40
Ta 246,3,12800
v_and_b32 v7, s46, v61
Mvav 160,224,48
Ta 248,4,12288
v_fma_f32 v6, v6, v9, v11
v_fma_f32 v7, v7, v9, v11
Mvav 164,224,52
Ta 250,4,12800
v_cvt_pk_bf16_f32 v61, v6, v7
s_waitcnt lgkmcnt(4)
Mvav 172,228,52
Ta 252,5,12288
v_lshlrev_b32 v6, 16, v62
v_and_b32 v7, s46, v62
Mvav 168,228,48
Ta 254,5,12800
v_fma_f32 v6, v6, v9, v11
s_waitcnt vmcnt(20)
s_barrier
Mvav 176,232,48
Ta 224,2,16384
s_add_u32 m0, s35, 0xc000
v_fma_f32 v7, v7, v9, v11
v_cvt_pk_bf16_f32 v62, v6, v7
Mvav 180,232,52
Ta 226,2,16896
s_add_u32 s44, s36, 0x80380
v_lshlrev_b32 v6, 16, v63
Mvav 188,236,52
Ta 228,3,16384
s_add_u32 s98, s8, s44
s_addc_u32 s99, s9, 0
v_and_b32 v7, s46, v63
v_fma_f32 v6, v6, v9, v11
Mvav 184,236,48
Ta 230,3,16896
GDMA 12,98,0
v_fma_f32 v7, v7, v9, v11
v_cvt_pk_bf16_f32 v63, v6, v7
Mvav 160,240,56
Ta 232,4,16384
GDMA 13,98,1024
Mvav 164,240,60
Ta 234,4,16896
s_waitcnt lgkmcnt(4)
Mvav 172,244,60
Ta 236,5,16384
v_lshlrev_b32 v6, 16, v64
Mvav 168,244,56
Ta 238,5,16896
v_and_b32 v7, s46, v64
Mvav 176,248,56
Ta 240,2,20480
GDMA 14,98,2048
Mvav 180,248,60
Ta 242,2,20992
v_fma_f32 v6, v6, v8, v10
Mvav 188,252,60
Ta 244,3,20480
v_fma_f32 v7, v7, v8, v10
Mvav 184,252,56
Ta 246,3,20992
v_cvt_pk_bf16_f32 v64, v6, v7
Mvav 192,224,32
Ta 248,4,20480
GDMA 15,98,3072
Mvav 196,224,36
Ta 250,4,20992
s_waitcnt lgkmcnt(4)
Mvav 204,228,36
Ta 252,5,20480
v_lshlrev_b32 v6, 16, v65
Mvav 200,228,32
Ta 254,5,20992
v_and_b32 v7, s46, v65
Mvav 208,232,32
Ta 224,2,24576
v_fma_f32 v6, v6, v8, v10
Mvav 212,232,36
Ta 226,2,25088
v_fma_f32 v7, v7, v8, v10
Mvav 220,236,36
Ta 228,3,24576
v_cvt_pk_bf16_f32 v65, v6, v7
Mvav 216,236,32
Ta 230,3,25088
v_lshlrev_b32 v6, 16, v66
Mvav 192,240,40
Ta 232,4,24576
v_and_b32 v7, s46, v66
Mvav 196,240,44
Ta 234,4,25088
s_waitcnt lgkmcnt(4)
Mvav 204,244,44
Ta 236,5,24576
v_fma_f32 v6, v6, v8, v10
Mvav 200,244,40
Ta 238,5,25088
v_fma_f32 v7, v7, v8, v10
Mvav 208,248,40
Ta 240,2,28672
v_cvt_pk_bf16_f32 v66, v6, v7
Mvav 212,248,44
Ta 242,2,29184
v_lshlrev_b32 v6, 16, v67
Mvav 220,252,44
Ta 244,3,28672
v_and_b32 v7, s46, v67
Mvav 216,252,40
Ta 246,3,29184
v_fma_f32 v6, v6, v8, v10
Mvav 192,224,48
Ta 248,4,28672
v_fma_f32 v7, v7, v8, v10
Mvav 196,224,52
Ta 250,4,29184
s_waitcnt lgkmcnt(4)
Mvav 204,228,52
Ta 252,5,28672
v_cvt_pk_bf16_f32 v67, v6, v7
Mvav 200,228,48
Ta 254,5,29184
s_waitcnt vmcnt(20)
s_barrier
Mvav 208,232,48
Ta 224,2,32768
s_add_u32 m0, s35, 0x10000
Mvav 212,232,52
Ta 226,2,33280
s_add_u32 s44, s36, 0x180000
Mvav 220,236,52
Ta 228,3,32768
s_add_u32 s98, s8, s44
s_addc_u32 s99, s9, 0
Mvav 216,236,48
Ta 230,3,33280
GDMA 12,98,0
Mvav 192,240,56
Ta 232,4,32768
GDMA 13,98,1024
Mvav 196,240,60
Ta 234,4,33280
s_waitcnt lgkmcnt(4)
Mvav 204,244,60
Ta 236,5,32768
v_lshlrev_b32 v6, 16, v68
Mvav 200,244,56
Ta 238,5,33280
v_and_b32 v7, s46, v68
Mvav 208,248,56
Ta 240,2,36864
GDMA 14,98,2048
Mvav 212,248,60
Ta 242,2,37376
v_fma_f32 v6, v6, v9, v11
Mvav 220,252,60
Ta 244,3,36864
v_fma_f32 v7, v7, v9, v11
Mvav 216,252,56
Ta 246,3,37376
v_cvt_pk_bf16_f32 v68, v6, v7
Mvav 224,224,32
Ta 248,4,36864
GDMA 15,98,3072
Mvav 228,224,36
Ta 250,4,37376
s_waitcnt lgkmcnt(4)
Mvav 236,228,36
Ta 252,5,36864
v_lshlrev_b32 v6, 16, v69
Mvav 232,228,32
Ta 254,5,37376
v_and_b32 v7, s46, v69
Mvav 240,232,32
Ta 224,2,40960
v_fma_f32 v6, v6, v9, v11
Mvav 244,232,36
Ta 226,2,41472
v_fma_f32 v7, v7, v9, v11
Mvav 252,236,36
Ta 228,3,40960
v_cvt_pk_bf16_f32 v69, v6, v7
Mvav 248,236,32
Ta 230,3,41472
v_lshlrev_b32 v6, 16, v70
Mvav 224,240,40
Ta 232,4,40960
v_and_b32 v7, s46, v70
Mvav 228,240,44
Ta 234,4,41472
s_waitcnt lgkmcnt(4)
Mvav 236,244,44
Ta 236,5,40960
v_fma_f32 v6, v6, v9, v11
Mvav 232,244,40
Ta 238,5,41472
v_fma_f32 v7, v7, v9, v11
Mvav 240,248,40
Ta 240,2,45056
v_cvt_pk_bf16_f32 v70, v6, v7
Mvav 244,248,44
Ta 242,2,45568
v_lshlrev_b32 v6, 16, v71
Mvav 252,252,44
Ta 244,3,45056
v_and_b32 v7, s46, v71
Mvav 248,252,40
Ta 246,3,45568
v_fma_f32 v6, v6, v9, v11
Mvav 224,224,48
Ta 248,4,45056
v_fma_f32 v7, v7, v9, v11
Mvav 228,224,52
Ta 250,4,45568
s_waitcnt lgkmcnt(4)
Mvav 236,228,52
Ta 252,5,45056
v_cvt_pk_bf16_f32 v71, v6, v7
Mvav 232,228,48
Ta 254,5,45568
s_waitcnt vmcnt(20)
s_barrier
Mvav 240,232,48
Ta 224,2,49152
s_add_u32 m0, s35, 0x14000
Mvav 244,232,52
Ta 226,2,49664
s_add_u32 s44, s36, 0x180080
Mvav 252,236,52
Ta 228,3,49152
s_add_u32 s98, s8, s44
s_addc_u32 s99, s9, 0
Mvav 248,236,48
Ta 230,3,49664
GDMA 12,98,0
Mvav 224,240,56
Ta 232,4,49152
GDMA 13,98,1024
Mvav 228,240,60
Ta 234,4,49664
s_waitcnt lgkmcnt(4)
Mvav 236,244,60
Ta 236,5,49152
v_lshlrev_b32 v6, 16, v72
Mvav 232,244,56
Ta 238,5,49664
v_and_b32 v7, s46, v72
Mvav 240,248,56
Ta 240,2,53248
GDMA 14,98,2048
Mvav 244,248,60
Ta 242,2,53760
v_fma_f32 v6, v6, v8, v10
Mvav 252,252,60
Ta 244,3,53248
v_fma_f32 v7, v7, v8, v10
Mvav 248,252,56
Ta 246,3,53760
v_cvt_pk_bf16_f32 v72, v6, v7
Maav 128,224,32
Ta 248,4,53248
GDMA 15,98,3072
Maav 132,224,36
Ta 250,4,53760
s_waitcnt lgkmcnt(4)
Maav 140,228,36
Ta 252,5,53248
v_lshlrev_b32 v6, 16, v73
Maav 136,228,32
Ta 254,5,53760
v_and_b32 v7, s46, v73
Maav 144,232,32
Ta 224,2,57344
v_fma_f32 v6, v6, v8, v10
Maav 148,232,36
Ta 226,2,57856
v_fma_f32 v7, v7, v8, v10
Maav 156,236,36
Ta 228,3,57344
v_cvt_pk_bf16_f32 v73, v6, v7
Maav 152,236,32
Ta 230,3,57856
v_lshlrev_b32 v6, 16, v74
Maav 128,240,40
Ta 232,4,57344
v_and_b32 v7, s46, v74
Maav 132,240,44
Ta 234,4,57856
s_waitcnt lgkmcnt(4)
Maav 140,244,44
Ta 236,5,57344
v_fma_f32 v6, v6, v8, v10
Maav 136,244,40
Ta 238,5,57856
v_fma_f32 v7, v7, v8, v10
Maav 144,248,40
Ta 240,2,61440
v_cvt_pk_bf16_f32 v74, v6, v7
Maav 148,248,44
Ta 242,2,61952
v_xor_b32 v2, 0x10000, v2
Maav 156,252,44
Ta 244,3,61440
v_lshlrev_b32 v6, 16, v75
Maav 152,252,40
Ta 246,3,61952
v_xor_b32 v3, 0x10000, v3
Maav 128,224,48
Ta 248,4,61440
v_and_b32 v7, s46, v75
Maav 132,224,52
Ta 250,4,61952
s_waitcnt lgkmcnt(4)
Maav 140,228,52
Ta 252,5,61440
v_xor_b32 v4, 0x10000, v4
Maav 136,228,48
Ta 254,5,61952
s_waitcnt vmcnt(20)
s_barrier
Maav 144,232,48
Ta 224,2,0
v_xor_b32 v5, 0x10000, v5
Maav 148,232,52
Ta 226,2,512
s_add_u32 m0, s35, 0x18000
Maav 156,236,52
Ta 228,3,0
s_add_u32 s44, s36, 0x180100
Maav 152,236,48
Ta 230,3,512
s_add_u32 s98, s8, s44
s_addc_u32 s99, s9, 0
Maav 128,240,56
Ta 232,4,0
GDMA 12,98,0
Maav 132,240,60
Ta 234,4,512
s_waitcnt lgkmcnt(4)
Maav 140,244,60
Ta 236,5,0
GDMA 13,98,1024
Maav 136,244,56
Ta 238,5,512
v_fma_f32 v6, v6, v8, v10
Maav 144,248,56
Ta 240,2,4096
GDMA 14,98,2048
Maav 148,248,60
Ta 242,2,4608
v_fma_f32 v7, v7, v8, v10
Maav 156,252,60
Ta 244,3,4096
v_cvt_pk_bf16_f32 v75, v6, v7
Maav 152,252,56
Ta 246,3,4608
v_lshlrev_b32 v6, 16, v76
Maav 0,224,32
Ta 248,4,4096
GDMA 15,98,3072
Maav 4,224,36
Ta 250,4,4608
s_waitcnt lgkmcnt(4)
Maav 12,228,36
Ta 252,5,4096
v_and_b32 v7, s46, v76
Maav 8,228,32
Ta 254,5,4608
v_fma_f32 v6, v6, v9, v11
Maav 16,232,32
Ta 224,2,8192
v_fma_f32 v7, v7, v9, v11
Maav 20,232,36
Ta 226,2,8704
v_cvt_pk_bf16_f32 v76, v6, v7
Maav 28,236,36
Ta 228,3,8192
v_lshlrev_b32 v6, 16, v77
Maav 24,236,32
Ta 230,3,8704
v_and_b32 v7, s46, v77
Maav 0,240,40
Ta 232,4,8192
v_fma_f32 v6, v6, v9, v11
Maav 4,240,44
Ta 234,4,8704
s_waitcnt lgkmcnt(4)
Maav 12,244,44
Ta 236,5,8192
v_fma_f32 v7, v7, v9, v11
Maav 8,244,40
Ta 238,5,8704
v_cvt_pk_bf16_f32 v77, v6, v7
Maav 16,248,40
Ta 240,2,12288
v_lshlrev_b32 v6, 16, v78
Maav 20,248,44
Ta 242,2,12800
v_and_b32 v7, s46, v78
Maav 28,252,44
Ta 244,3,12288
v_fma_f32 v6, v6, v9, v11
Maav 24,252,40
Ta 246,3,12800
v_fma_f32 v7, v7, v9, v11
Maav 0,224,48
Ta 248,4,12288
v_cvt_pk_bf16_f32 v78, v6, v7
Maav 4,224,52
Ta 250,4,12800
s_waitcnt lgkmcnt(4)
Maav 12,228,52
Ta 252,5,12288
v_lshlrev_b32 v6, 16, v79
Maav 8,228,48
Ta 254,5,12800
s_waitcnt vmcnt(20)
s_barrier
Maav 16,232,48
Ta 224,2,16384
s_add_u32 m0, s35, 0x1c000
Maav 20,232,52
Ta 226,2,16896
s_add_u32 s44, s36, 0x180180
Maav 28,236,52
Ta 228,3,16384
s_add_u32 s98, s8, s44
s_addc_u32 s99, s9, 0
Maav 24,236,48
Ta 230,3,16896
GDMA 12,98,0
Maav 0,240,56
Ta 232,4,16384
GDMA 13,98,1024
Maav 4,240,60
Ta 234,4,16896
s_waitcnt lgkmcnt(4)
Maav 12,244,60
Ta 236,5,16384
v_and_b32 v7, s46, v79
Maav 8,244,56
Ta 238,5,16896
v_fma_f32 v6, v6, v9, v11
Maav 16,248,56
Ta 240,2,20480
GDMA 14,98,2048
Maav 20,248,60
Ta 242,2,20992
v_fma_f32 v7, v7, v9, v11
Maav 28,252,60
Ta 244,3,20480
v_cvt_pk_bf16_f32 v79, v6, v7
Maav 24,252,56
Ta 246,3,20992
v_lshlrev_b32 v6, 16, v80
Maav 32,224,32
Ta 248,4,20480
GDMA 15,98,3072
Maav 36,224,36
Ta 250,4,20992
s_waitcnt lgkmcnt(4)
Maav 44,228,36
Ta 252,5,20480
v_and_b32 v7, s46, v80
Maav 40,228,32
Ta 254,5,20992
v_fma_f32 v6, v6, v8, v10
Maav 48,232,32
Ta 224,2,24576
v_fma_f32 v7, v7, v8, v10
Maav 52,232,36
Ta 226,2,25088
v_cvt_pk_bf16_f32 v80, v6, v7
Maav 60,236,36
Ta 228,3,24576
v_lshlrev_b32 v6, 16, v81
Maav 56,236,32
Ta 230,3,25088
v_and_b32 v7, s46, v81
Maav 32,240,40
Ta 232,4,24576
v_fma_f32 v6, v6, v8, v10
Maav 36,240,44
Ta 234,4,25088
s_waitcnt lgkmcnt(4)
Maav 44,244,44
Ta 236,5,24576
v_fma_f32 v7, v7, v8, v10
Maav 40,244,40
Ta 238,5,25088
v_cvt_pk_bf16_f32 v81, v6, v7
Maav 48,248,40
Ta 240,2,28672
v_lshlrev_b32 v6, 16, v82
Maav 52,248,44
Ta 242,2,29184
v_and_b32 v7, s46, v82
Maav 60,252,44
Ta 244,3,28672
v_fma_f32 v6, v6, v8, v10
Maav 56,252,40
Ta 246,3,29184
v_fma_f32 v7, v7, v8, v10
Maav 32,224,48
Ta 248,4,28672
v_cvt_pk_bf16_f32 v82, v6, v7
Maav 36,224,52
Ta 250,4,29184
s_waitcnt lgkmcnt(4)
Maav 44,228,52
Ta 252,5,28672
v_lshlrev_b32 v6, 16, v83
Maav 40,228,48
Ta 254,5,29184
s_waitcnt vmcnt(20)
s_barrier
Maav 48,232,48
Ta 224,2,32768
s_mov_b32 m0, s35
Maav 52,232,52
Ta 226,2,33280
s_add_u32 s44, s36, 0x180200
Maav 60,236,52
Ta 228,3,32768
s_add_u32 s98, s8, s44
s_addc_u32 s99, s9, 0
Maav 56,236,48
Ta 230,3,33280
GDMA 12,98,0
Maav 32,240,56
Ta 232,4,32768
GDMA 13,98,1024
Maav 36,240,60
Ta 234,4,33280
s_waitcnt lgkmcnt(4)
Maav 44,244,60
Ta 236,5,32768
v_and_b32 v7, s46, v83
Maav 40,244,56
Ta 238,5,33280
v_fma_f32 v6, v6, v8, v10
Maav 48,248,56
Ta 240,2,36864
GDMA 14,98,2048
Maav 52,248,60
Ta 242,2,37376
v_fma_f32 v7, v7, v8, v10
Maav 60,252,60
Ta 244,3,36864
v_cvt_pk_bf16_f32 v83, v6, v7
Maav 56,252,56
Ta 246,3,37376
v_lshlrev_b32 v6, 16, v84
Maav 64,224,32
Ta 248,4,36864
GDMA 15,98,3072
Maav 68,224,36
Ta 250,4,37376
s_waitcnt lgkmcnt(4)
Maav 76,228,36
Ta 252,5,36864
v_and_b32 v7, s46, v84
Maav 72,228,32
Ta 254,5,37376
v_fma_f32 v6, v6, v9, v11
Maav 80,232,32
Ta 224,2,40960
v_fma_f32 v7, v7, v9, v11
Maav 84,232,36
Ta 226,2,41472
v_cvt_pk_bf16_f32 v84, v6, v7
Maav 92,236,36
Ta 228,3,40960
v_lshlrev_b32 v6, 16, v85
Maav 88,236,32
Ta 230,3,41472
v_and_b32 v7, s46, v85
Maav 64,240,40
Ta 232,4,40960
v_fma_f32 v6, v6, v9, v11
Maav 68,240,44
Ta 234,4,41472
s_waitcnt lgkmcnt(4)
Maav 76,244,44
Ta 236,5,40960
v_fma_f32 v7, v7, v9, v11
Maav 72,244,40
Ta 238,5,41472
v_cvt_pk_bf16_f32 v85, v6, v7
Maav 80,248,40
Ta 240,2,45056
v_lshlrev_b32 v6, 16, v86
Maav 84,248,44
Ta 242,2,45568
v_and_b32 v7, s46, v86
Maav 92,252,44
Ta 244,3,45056
v_fma_f32 v6, v6, v9, v11
Maav 88,252,40
Ta 246,3,45568
v_fma_f32 v7, v7, v9, v11
Maav 64,224,48
Ta 248,4,45056
v_cvt_pk_bf16_f32 v86, v6, v7
Maav 68,224,52
Ta 250,4,45568
s_waitcnt lgkmcnt(4)
Maav 76,228,52
Ta 252,5,45056
v_lshlrev_b32 v6, 16, v87
Maav 72,228,48
Ta 254,5,45568
s_waitcnt vmcnt(20)
s_barrier
Maav 80,232,48
Ta 224,2,49152
s_add_u32 m0, s35, 0x4000
Maav 84,232,52
Ta 226,2,49664
s_add_u32 s44, s36, 0x180280
Maav 92,236,52
Ta 228,3,49152
s_add_u32 s98, s8, s44
s_addc_u32 s99, s9, 0
Maav 88,236,48
Ta 230,3,49664
GDMA 12,98,0
Maav 64,240,56
Ta 232,4,49152
GDMA 13,98,1024
Maav 68,240,60
Ta 234,4,49664
s_waitcnt lgkmcnt(4)
Maav 76,244,60
Ta 236,5,49152
v_and_b32 v7, s46, v87
Maav 72,244,56
Ta 238,5,49664
v_fma_f32 v6, v6, v9, v11
Maav 80,248,56
Ta 240,2,53248
GDMA 14,98,2048
Maav 84,248,60
Ta 242,2,53760
v_fma_f32 v7, v7, v9, v11
Maav 92,252,60
Ta 244,3,53248
v_cvt_pk_bf16_f32 v87, v6, v7
Maav 88,252,56
Ta 246,3,53760
v_lshlrev_b32 v6, 16, v88
Maav 96,224,32
Ta 248,4,53248
GDMA 15,98,3072
Maav 100,224,36
Ta 250,4,53760
s_waitcnt lgkmcnt(4)
Maav 108,228,36
Ta 252,5,53248
v_and_b32 v7, s46, v88
Maav 104,228,32
Ta 254,5,53760
v_fma_f32 v6, v6, v8, v10
Maav 112,232,32
Ta 224,2,57344
v_fma_f32 v7, v7, v8, v10
Maav 116,232,36
Ta 226,2,57856
v_cvt_pk_bf16_f32 v88, v6, v7
Maav 124,236,36
Ta 228,3,57344
v_lshlrev_b32 v6, 16, v89
Maav 120,236,32
Ta 230,3,57856
v_and_b32 v7, s46, v89
Maav 96,240,40
Ta 232,4,57344
v_fma_f32 v6, v6, v8, v10
Maav 100,240,44
Ta 234,4,57856
s_waitcnt lgkmcnt(4)
Maav 108,244,44
Ta 236,5,57344
v_fma_f32 v7, v7, v8, v10
Maav 104,244,40
Ta 238,5,57856
v_cvt_pk_bf16_f32 v89, v6, v7
Maav 112,248,40
Ta 240,2,61440
v_lshlrev_b32 v6, 16, v90
Maav 116,248,44
Ta 242,2,61952
v_xor_b32 v2, 0x10000, v2
Maav 124,252,44
Ta 244,3,61440
v_and_b32 v7, s46, v90
Maav 120,252,40
Ta 246,3,61952
v_xor_b32 v3, 0x10000, v3
Maav 96,224,48
Ta 248,4,61440
v_fma_f32 v6, v6, v8, v10
Maav 100,224,52
Ta 250,4,61952
s_waitcnt lgkmcnt(4)
Maav 108,228,52
Ta 252,5,61440
v_xor_b32 v4, 0x10000, v4
Maav 104,228,48
Ta 254,5,61952
s_waitcnt vmcnt(20)
s_barrier
Maav 112,232,48
Ta 224,2,0
v_xor_b32 v5, 0x10000, v5
Maav 116,232,52
Ta 226,2,512
s_add_u32 m0, s35, 0x8000
Maav 124,236,52
Ta 228,3,0
s_add_u32 s44, s36, 0x180300
Maav 120,236,48
Ta 230,3,512
s_add_u32 s98, s8, s44
s_addc_u32 s99, s9, 0
Maav 96,240,56
Ta 232,4,0
GDMA 12,98,0
Maav 100,240,60
Ta 234,4,512
s_waitcnt lgkmcnt(4)
Maav 108,244,60
Ta 236,5,0
GDMA 13,98,1024
Maav 104,244,56
Ta 238,5,512
v_fma_f32 v7, v7, v8, v10
Maav 112,248,56
Ta 240,2,4096
GDMA 14,98,2048
Maav 116,248,60
Ta 242,2,4608
v_cvt_pk_bf16_f32 v90, v6, v7
Maav 124,252,60
Ta 244,3,4096
v_lshlrev_b32 v6, 16, v91
Maav 120,252,56
Ta 246,3,4608
v_and_b32 v7, s46, v91
Mvav 160,224,64
Ta 248,4,4096
GDMA 15,98,3072
Mvav 164,224,68
Ta 250,4,4608
s_waitcnt lgkmcnt(4)
Mvav 172,228,68
Ta 252,5,4096
v_fma_f32 v6, v6, v8, v10
Mvav 168,228,64
Ta 254,5,4608
v_fma_f32 v7, v7, v8, v10
Mvav 176,232,64
Ta 224,2,8192
v_cvt_pk_bf16_f32 v91, v6, v7
Mvav 180,232,68
Ta 226,2,8704
v_lshlrev_b32 v6, 16, v92
Mvav 188,236,68
Ta 228,3,8192
v_and_b32 v7, s46, v92
Mvav 184,236,64
Ta 230,3,8704
v_fma_f32 v6, v6, v9, v11
Mvav 160,240,72
Ta 232,4,8192
v_fma_f32 v7, v7, v9, v11
Mvav 164,240,76
Ta 234,4,8704
s_waitcnt lgkmcnt(4)
Mvav 172,244,76
Ta 236,5,8192
v_cvt_pk_bf16_f32 v92, v6, v7
Mvav 168,244,72
Ta 238,5,8704
v_lshlrev_b32 v6, 16, v93
Mvav 176,248,72
Ta 240,2,12288
v_and_b32 v7, s46, v93
Mvav 180,248,76
Ta 242,2,12800
v_fma_f32 v6, v6, v9, v11
Mvav 188,252,76
Ta 244,3,12288
v_fma_f32 v7, v7, v9, v11
Mvav 184,252,72
Ta 246,3,12800
v_cvt_pk_bf16_f32 v93, v6, v7
Mvav 160,224,80
Ta 248,4,12288
v_lshlrev_b32 v6, 16, v94
Mvav 164,224,84
Ta 250,4,12800
s_waitcnt lgkmcnt(4)
Mvav 172,228,84
Ta 252,5,12288
v_and_b32 v7, s46, v94
Mvav 168,228,80
Ta 254,5,12800
v_fma_f32 v6, v6, v9, v11
v_fma_f32 v7, v7, v9, v11
s_waitcnt vmcnt(20)
s_barrier
Mvav 176,232,80
Ta 224,2,16384
s_add_u32 m0, s35, 0xc000
v_cvt_pk_bf16_f32 v94, v6, v7
Mvav 180,232,84
Ta 226,2,16896
s_add_u32 s44, s36, 0x180380
v_lshlrev_b32 v6, 16, v95
v_and_b32 v7, s46, v95
Mvav 188,236,84
Ta 228,3,16384
s_add_u32 s98, s8, s44
s_addc_u32 s99, s9, 0
v_fma_f32 v6, v6, v9, v11
Mvav 184,236,80
Ta 230,3,16896
GDMA 12,98,0
v_fma_f32 v7, v7, v9, v11
v_cvt_pk_bf16_f32 v95, v6, v7
Mvav 160,240,88
Ta 232,4,16384
GDMA 13,98,1024
Mvav 164,240,92
Ta 234,4,16896
s_waitcnt lgkmcnt(4)
Mvav 172,244,92
Ta 236,5,16384
v_lshlrev_b32 v6, 16, v96
Mvav 168,244,88
Ta 238,5,16896
v_and_b32 v7, s46, v96
Mvav 176,248,88
Ta 240,2,20480
GDMA 14,98,2048
Mvav 180,248,92
Ta 242,2,20992
v_fma_f32 v6, v6, v8, v10
Mvav 188,252,92
Ta 244,3,20480
v_fma_f32 v7, v7, v8, v10
Mvav 184,252,88
Ta 246,3,20992
v_cvt_pk_bf16_f32 v96, v6, v7
Mvav 192,224,64
Ta 248,4,20480
GDMA 15,98,3072
Mvav 196,224,68
Ta 250,4,20992
s_waitcnt lgkmcnt(4)
Mvav 204,228,68
Ta 252,5,20480
v_lshlrev_b32 v6, 16, v97
Mvav 200,228,64
Ta 254,5,20992
v_and_b32 v7, s46, v97
Mvav 208,232,64
Ta 224,2,24576
v_fma_f32 v6, v6, v8, v10
Mvav 212,232,68
Ta 226,2,25088
v_fma_f32 v7, v7, v8, v10
Mvav 220,236,68
Ta 228,3,24576
v_cvt_pk_bf16_f32 v97, v6, v7
Mvav 216,236,64
Ta 230,3,25088
v_lshlrev_b32 v6, 16, v98
Mvav 192,240,72
Ta 232,4,24576
v_and_b32 v7, s46, v98
Mvav 196,240,76
Ta 234,4,25088
s_waitcnt lgkmcnt(4)
Mvav 204,244,76
Ta 236,5,24576
v_fma_f32 v6, v6, v8, v10
Mvav 200,244,72
Ta 238,5,25088
v_fma_f32 v7, v7, v8, v10
Mvav 208,248,72
Ta 240,2,28672
v_cvt_pk_bf16_f32 v98, v6, v7
Mvav 212,248,76
Ta 242,2,29184
v_lshlrev_b32 v6, 16, v99
Mvav 220,252,76
Ta 244,3,28672
v_and_b32 v7, s46, v99
Mvav 216,252,72
Ta 246,3,29184
v_fma_f32 v6, v6, v8, v10
Mvav 192,224,80
Ta 248,4,28672
v_fma_f32 v7, v7, v8, v10
Mvav 196,224,84
Ta 250,4,29184
s_waitcnt lgkmcnt(4)
Mvav 204,228,84
Ta 252,5,28672
v_cvt_pk_bf16_f32 v99, v6, v7
Mvav 200,228,80
Ta 254,5,29184
s_waitcnt vmcnt(20)
s_barrier
Mvav 208,232,80
Ta 224,2,32768
s_add_u32 m0, s35, 0x10000
Mvav 212,232,84
Ta 226,2,33280
s_add_u32 s44, s36, 0x280000
Mvav 220,236,84
Ta 228,3,32768
s_add_u32 s98, s8, s44
s_addc_u32 s99, s9, 0
Mvav 216,236,80
Ta 230,3,33280
GDMA 12,98,0
Mvav 192,240,88
Ta 232,4,32768
GDMA 13,98,1024
Mvav 196,240,92
Ta 234,4,33280
s_waitcnt lgkmcnt(4)
Mvav 204,244,92
Ta 236,5,32768
v_lshlrev_b32 v6, 16, v100
Mvav 200,244,88
Ta 238,5,33280
v_and_b32 v7, s46, v100
Mvav 208,248,88
Ta 240,2,36864
GDMA 14,98,2048
Mvav 212,248,92
Ta 242,2,37376
v_fma_f32 v6, v6, v9, v11
Mvav 220,252,92
Ta 244,3,36864
v_fma_f32 v7, v7, v9, v11
Mvav 216,252,88
Ta 246,3,37376
v_cvt_pk_bf16_f32 v100, v6, v7
Mvav 224,224,64
Ta 248,4,36864
GDMA 15,98,3072
Mvav 228,224,68
Ta 250,4,37376
s_waitcnt lgkmcnt(4)
Mvav 236,228,68
Ta 252,5,36864
v_lshlrev_b32 v6, 16, v101
Mvav 232,228,64
Ta 254,5,37376
v_and_b32 v7, s46, v101
Mvav 240,232,64
Ta 224,2,40960
v_fma_f32 v6, v6, v9, v11
Mvav 244,232,68
Ta 226,2,41472
v_fma_f32 v7, v7, v9, v11
Mvav 252,236,68
Ta 228,3,40960
v_cvt_pk_bf16_f32 v101, v6, v7
Mvav 248,236,64
Ta 230,3,41472
v_lshlrev_b32 v6, 16, v102
Mvav 224,240,72
Ta 232,4,40960
v_and_b32 v7, s46, v102
Mvav 228,240,76
Ta 234,4,41472
s_waitcnt lgkmcnt(4)
Mvav 236,244,76
Ta 236,5,40960
v_fma_f32 v6, v6, v9, v11
Mvav 232,244,72
Ta 238,5,41472
v_fma_f32 v7, v7, v9, v11
Mvav 240,248,72
Ta 240,2,45056
v_cvt_pk_bf16_f32 v102, v6, v7
Mvav 244,248,76
Ta 242,2,45568
v_lshlrev_b32 v6, 16, v103
Mvav 252,252,76
Ta 244,3,45056
v_and_b32 v7, s46, v103
Mvav 248,252,72
Ta 246,3,45568
v_fma_f32 v6, v6, v9, v11
Mvav 224,224,80
Ta 248,4,45056
v_fma_f32 v7, v7, v9, v11
Mvav 228,224,84
Ta 250,4,45568
s_waitcnt lgkmcnt(4)
Mvav 236,228,84
Ta 252,5,45056
v_cvt_pk_bf16_f32 v103, v6, v7
Mvav 232,228,80
Ta 254,5,45568
s_waitcnt vmcnt(20)
s_barrier
Mvav 240,232,80
Ta 224,2,49152
s_add_u32 m0, s35, 0x14000
Mvav 244,232,84
Ta 226,2,49664
s_add_u32 s44, s36, 0x280080
Mvav 252,236,84
Ta 228,3,49152
s_add_u32 s98, s8, s44
s_addc_u32 s99, s9, 0
Mvav 248,236,80
Ta 230,3,49664
GDMA 12,98,0
Mvav 224,240,88
Ta 232,4,49152
GDMA 13,98,1024
Mvav 228,240,92
Ta 234,4,49664
s_waitcnt lgkmcnt(4)
Mvav 236,244,92
Ta 236,5,49152
v_lshlrev_b32 v6, 16, v104
Mvav 232,244,88
Ta 238,5,49664
v_and_b32 v7, s46, v104
Mvav 240,248,88
Ta 240,2,53248
GDMA 14,98,2048
Mvav 244,248,92
Ta 242,2,53760
v_fma_f32 v6, v6, v8, v10
Mvav 252,252,92
Ta 244,3,53248
v_fma_f32 v7, v7, v8, v10
Mvav 248,252,88
Ta 246,3,53760
v_cvt_pk_bf16_f32 v104, v6, v7
Maav 128,224,64
Ta 248,4,53248
GDMA 15,98,3072
Maav 132,224,68
Ta 250,4,53760
s_waitcnt lgkmcnt(4)
Maav 140,228,68
Ta 252,5,53248
v_lshlrev_b32 v6, 16, v105
Maav 136,228,64
Ta 254,5,53760
v_and_b32 v7, s46, v105
Maav 144,232,64
Ta 224,2,57344
v_fma_f32 v6, v6, v8, v10
Maav 148,232,68
Ta 226,2,57856
v_fma_f32 v7, v7, v8, v10
Maav 156,236,68
Ta 228,3,57344
v_cvt_pk_bf16_f32 v105, v6, v7
Maav 152,236,64
Ta 230,3,57856
v_lshlrev_b32 v6, 16, v106
Maav 128,240,72
Ta 232,4,57344
v_and_b32 v7, s46, v106
Maav 132,240,76
Ta 234,4,57856
s_waitcnt lgkmcnt(4)
Maav 140,244,76
Ta 236,5,57344
v_fma_f32 v6, v6, v8, v10
Maav 136,244,72
Ta 238,5,57856
v_fma_f32 v7, v7, v8, v10
Maav 144,248,72
Ta 240,2,61440
v_cvt_pk_bf16_f32 v106, v6, v7
Maav 148,248,76
Ta 242,2,61952
v_xor_b32 v2, 0x10000, v2
Maav 156,252,76
Ta 244,3,61440
v_lshlrev_b32 v6, 16, v107
Maav 152,252,72
Ta 246,3,61952
v_xor_b32 v3, 0x10000, v3
Maav 128,224,80
Ta 248,4,61440
v_and_b32 v7, s46, v107
Maav 132,224,84
Ta 250,4,61952
s_waitcnt lgkmcnt(4)
Maav 140,228,84
Ta 252,5,61440
v_xor_b32 v4, 0x10000, v4
Maav 136,228,80
Ta 254,5,61952
s_waitcnt vmcnt(20)
s_barrier
Maav 144,232,80
Ta 224,2,0
v_xor_b32 v5, 0x10000, v5
Maav 148,232,84
Ta 226,2,512
s_add_u32 m0, s35, 0x18000
Maav 156,236,84
Ta 228,3,0
s_add_u32 s44, s36, 0x280100
Maav 152,236,80
Ta 230,3,512
s_add_u32 s98, s8, s44
s_addc_u32 s99, s9, 0
Maav 128,240,88
Ta 232,4,0
GDMA 12,98,0
Maav 132,240,92
Ta 234,4,512
s_waitcnt lgkmcnt(4)
Maav 140,244,92
Ta 236,5,0
GDMA 13,98,1024
Maav 136,244,88
Ta 238,5,512
v_fma_f32 v6, v6, v8, v10
Maav 144,248,88
Ta 240,2,4096
GDMA 14,98,2048
Maav 148,248,92
Ta 242,2,4608
v_fma_f32 v7, v7, v8, v10
Maav 156,252,92
Ta 244,3,4096
v_cvt_pk_bf16_f32 v107, v6, v7
Maav 152,252,88
Ta 246,3,4608
v_lshlrev_b32 v6, 16, v108
Maav 0,224,64
Ta 248,4,4096
GDMA 15,98,3072
Maav 4,224,68
Ta 250,4,4608
s_waitcnt lgkmcnt(4)
Maav 12,228,68
Ta 252,5,4096
v_and_b32 v7, s46, v108
Maav 8,228,64
Ta 254,5,4608
v_fma_f32 v6, v6, v9, v11
Maav 16,232,64
Ta 224,2,8192
v_fma_f32 v7, v7, v9, v11
Maav 20,232,68
Ta 226,2,8704
v_cvt_pk_bf16_f32 v108, v6, v7
Maav 28,236,68
Ta 228,3,8192
v_lshlrev_b32 v6, 16, v109
Maav 24,236,64
Ta 230,3,8704
v_and_b32 v7, s46, v109
Maav 0,240,72
Ta 232,4,8192
v_fma_f32 v6, v6, v9, v11
Maav 4,240,76
Ta 234,4,8704
s_waitcnt lgkmcnt(4)
Maav 12,244,76
Ta 236,5,8192
v_fma_f32 v7, v7, v9, v11
Maav 8,244,72
Ta 238,5,8704
v_cvt_pk_bf16_f32 v109, v6, v7
Maav 16,248,72
Ta 240,2,12288
v_lshlrev_b32 v6, 16, v110
Maav 20,248,76
Ta 242,2,12800
v_and_b32 v7, s46, v110
Maav 28,252,76
Ta 244,3,12288
v_fma_f32 v6, v6, v9, v11
Maav 24,252,72
Ta 246,3,12800
v_fma_f32 v7, v7, v9, v11
Maav 0,224,80
Ta 248,4,12288
v_cvt_pk_bf16_f32 v110, v6, v7
Maav 4,224,84
Ta 250,4,12800
s_waitcnt lgkmcnt(4)
Maav 12,228,84
Ta 252,5,12288
v_lshlrev_b32 v6, 16, v111
Maav 8,228,80
Ta 254,5,12800
s_waitcnt vmcnt(20)
s_barrier
Maav 16,232,80
Ta 224,2,16384
s_add_u32 m0, s35, 0x1c000
Maav 20,232,84
Ta 226,2,16896
s_add_u32 s44, s36, 0x280180
Maav 28,236,84
Ta 228,3,16384
s_add_u32 s98, s8, s44
s_addc_u32 s99, s9, 0
Maav 24,236,80
Ta 230,3,16896
GDMA 12,98,0
Maav 0,240,88
Ta 232,4,16384
GDMA 13,98,1024
Maav 4,240,92
Ta 234,4,16896
s_waitcnt lgkmcnt(4)
Maav 12,244,92
Ta 236,5,16384
v_and_b32 v7, s46, v111
Maav 8,244,88
Ta 238,5,16896
v_fma_f32 v6, v6, v9, v11
Maav 16,248,88
Ta 240,2,20480
GDMA 14,98,2048
Maav 20,248,92
Ta 242,2,20992
v_fma_f32 v7, v7, v9, v11
Maav 28,252,92
Ta 244,3,20480
v_cvt_pk_bf16_f32 v111, v6, v7
Maav 24,252,88
Ta 246,3,20992
v_lshlrev_b32 v6, 16, v112
Maav 32,224,64
Ta 248,4,20480
GDMA 15,98,3072
Maav 36,224,68
Ta 250,4,20992
s_waitcnt lgkmcnt(4)
Maav 44,228,68
Ta 252,5,20480
v_and_b32 v7, s46, v112
Maav 40,228,64
Ta 254,5,20992
v_fma_f32 v6, v6, v8, v10
Maav 48,232,64
Ta 224,2,24576
v_fma_f32 v7, v7, v8, v10
Maav 52,232,68
Ta 226,2,25088
v_cvt_pk_bf16_f32 v112, v6, v7
Maav 60,236,68
Ta 228,3,24576
v_lshlrev_b32 v6, 16, v113
Maav 56,236,64
Ta 230,3,25088
v_and_b32 v7, s46, v113
Maav 32,240,72
Ta 232,4,24576
v_fma_f32 v6, v6, v8, v10
Maav 36,240,76
Ta 234,4,25088
s_waitcnt lgkmcnt(4)
Maav 44,244,76
Ta 236,5,24576
v_fma_f32 v7, v7, v8, v10
Maav 40,244,72
Ta 238,5,25088
v_cvt_pk_bf16_f32 v113, v6, v7
Maav 48,248,72
Ta 240,2,28672
v_lshlrev_b32 v6, 16, v114
Maav 52,248,76
Ta 242,2,29184
v_and_b32 v7, s46, v114
Maav 60,252,76
Ta 244,3,28672
v_fma_f32 v6, v6, v8, v10
Maav 56,252,72
Ta 246,3,29184
v_fma_f32 v7, v7, v8, v10
Maav 32,224,80
Ta 248,4,28672
v_cvt_pk_bf16_f32 v114, v6, v7
Maav 36,224,84
Ta 250,4,29184
s_waitcnt lgkmcnt(4)
Maav 44,228,84
Ta 252,5,28672
v_lshlrev_b32 v6, 16, v115
Maav 40,228,80
Ta 254,5,29184
s_waitcnt vmcnt(20)
s_barrier
Maav 48,232,80
Ta 224,2,32768
s_mov_b32 m0, s35
Maav 52,232,84
Ta 226,2,33280
s_add_u32 s44, s36, 0x280200
Maav 60,236,84
Ta 228,3,32768
s_add_u32 s98, s8, s44
s_addc_u32 s99, s9, 0
Maav 56,236,80
Ta 230,3,33280
GDMA 12,98,0
Maav 32,240,88
Ta 232,4,32768
GDMA 13,98,1024
Maav 36,240,92
Ta 234,4,33280
s_waitcnt lgkmcnt(4)
Maav 44,244,92
Ta 236,5,32768
v_and_b32 v7, s46, v115
Maav 40,244,88
Ta 238,5,33280
v_fma_f32 v6, v6, v8, v10
Maav 48,248,88
Ta 240,2,36864
GDMA 14,98,2048
Maav 52,248,92
Ta 242,2,37376
v_fma_f32 v7, v7, v8, v10
Maav 60,252,92
Ta 244,3,36864
v_cvt_pk_bf16_f32 v115, v6, v7
Maav 56,252,88
Ta 246,3,37376
v_lshlrev_b32 v6, 16, v116
Maav 64,224,64
Ta 248,4,36864
GDMA 15,98,3072
Maav 68,224,68
Ta 250,4,37376
s_waitcnt lgkmcnt(4)
Maav 76,228,68
Ta 252,5,36864
v_and_b32 v7, s46, v116
Maav 72,228,64
Ta 254,5,37376
v_fma_f32 v6, v6, v9, v11
Maav 80,232,64
Ta 224,2,40960
v_fma_f32 v7, v7, v9, v11
Maav 84,232,68
Ta 226,2,41472
v_cvt_pk_bf16_f32 v116, v6, v7
Maav 92,236,68
Ta 228,3,40960
v_lshlrev_b32 v6, 16, v117
Maav 88,236,64
Ta 230,3,41472
v_and_b32 v7, s46, v117
Maav 64,240,72
Ta 232,4,40960
v_fma_f32 v6, v6, v9, v11
Maav 68,240,76
Ta 234,4,41472
s_waitcnt lgkmcnt(4)
Maav 76,244,76
Ta 236,5,40960
v_fma_f32 v7, v7, v9, v11
Maav 72,244,72
Ta 238,5,41472
v_cvt_pk_bf16_f32 v117, v6, v7
Maav 80,248,72
Ta 240,2,45056
v_lshlrev_b32 v6, 16, v118
Maav 84,248,76
Ta 242,2,45568
v_and_b32 v7, s46, v118
Maav 92,252,76
Ta 244,3,45056
v_fma_f32 v6, v6, v9, v11
Maav 88,252,72
Ta 246,3,45568
v_fma_f32 v7, v7, v9, v11
Maav 64,224,80
Ta 248,4,45056
v_cvt_pk_bf16_f32 v118, v6, v7
Maav 68,224,84
Ta 250,4,45568
s_waitcnt lgkmcnt(4)
Maav 76,228,84
Ta 252,5,45056
v_lshlrev_b32 v6, 16, v119
Maav 72,228,80
Ta 254,5,45568
s_waitcnt vmcnt(20)
s_barrier
Maav 80,232,80
Ta 224,2,49152
s_add_u32 m0, s35, 0x4000
Maav 84,232,84
Ta 226,2,49664
s_add_u32 s44, s36, 0x280280
Maav 92,236,84
Ta 228,3,49152
s_add_u32 s98, s8, s44
s_addc_u32 s99, s9, 0
Maav 88,236,80
Ta 230,3,49664
GDMA 12,98,0
Maav 64,240,88
Ta 232,4,49152
GDMA 13,98,1024
Maav 68,240,92
Ta 234,4,49664
s_waitcnt lgkmcnt(4)
Maav 76,244,92
Ta 236,5,49152
v_and_b32 v7, s46, v119
Maav 72,244,88
Ta 238,5,49664
v_fma_f32 v6, v6, v9, v11
Maav 80,248,88
Ta 240,2,53248
GDMA 14,98,2048
Maav 84,248,92
Ta 242,2,53760
v_fma_f32 v7, v7, v9, v11
Maav 92,252,92
Ta 244,3,53248
v_cvt_pk_bf16_f32 v119, v6, v7
Maav 88,252,88
Ta 246,3,53760
v_lshlrev_b32 v6, 16, v120
Maav 96,224,64
Ta 248,4,53248
GDMA 15,98,3072
Maav 100,224,68
Ta 250,4,53760
s_waitcnt lgkmcnt(4)
Maav 108,228,68
Ta 252,5,53248
v_and_b32 v7, s46, v120
Maav 104,228,64
Ta 254,5,53760
v_fma_f32 v6, v6, v8, v10
Maav 112,232,64
Ta 224,2,57344
v_fma_f32 v7, v7, v8, v10
Maav 116,232,68
Ta 226,2,57856
v_cvt_pk_bf16_f32 v120, v6, v7
Maav 124,236,68
Ta 228,3,57344
v_lshlrev_b32 v6, 16, v121
Maav 120,236,64
Ta 230,3,57856
v_and_b32 v7, s46, v121
Maav 96,240,72
Ta 232,4,57344
v_fma_f32 v6, v6, v8, v10
Maav 100,240,76
Ta 234,4,57856
s_waitcnt lgkmcnt(4)
Maav 108,244,76
Ta 236,5,57344
v_fma_f32 v7, v7, v8, v10
Maav 104,244,72
Ta 238,5,57856
v_cvt_pk_bf16_f32 v121, v6, v7
Maav 112,248,72
Ta 240,2,61440
v_lshlrev_b32 v6, 16, v122
Maav 116,248,76
Ta 242,2,61952
v_xor_b32 v2, 0x10000, v2
Maav 124,252,76
Ta 244,3,61440
v_and_b32 v7, s46, v122
Maav 120,252,72
Ta 246,3,61952
v_xor_b32 v3, 0x10000, v3
Maav 96,224,80
Ta 248,4,61440
v_fma_f32 v6, v6, v8, v10
Maav 100,224,84
Ta 250,4,61952
s_waitcnt lgkmcnt(4)
Maav 108,228,84
Ta 252,5,61440
v_xor_b32 v4, 0x10000, v4
Maav 104,228,80
Ta 254,5,61952
s_waitcnt vmcnt(20)
s_barrier
Maav 112,232,80
Ta 224,2,0
v_xor_b32 v5, 0x10000, v5
Maav 116,232,84
Ta 226,2,512
s_add_u32 m0, s35, 0x8000
Maav 124,236,84
Ta 228,3,0
s_add_u32 s44, s36, 0x280300
Maav 120,236,80
Ta 230,3,512
s_add_u32 s98, s8, s44
s_addc_u32 s99, s9, 0
Maav 96,240,88
Ta 232,4,0
GDMA 12,98,0
Maav 100,240,92
Ta 234,4,512
s_waitcnt lgkmcnt(4)
Maav 108,244,92
Ta 236,5,0
GDMA 13,98,1024
Maav 104,244,88
Ta 238,5,512
v_fma_f32 v7, v7, v8, v10
Maav 112,248,88
Ta 240,2,4096
GDMA 14,98,2048
Maav 116,248,92
Ta 242,2,4608
v_cvt_pk_bf16_f32 v122, v6, v7
Maav 124,252,92
Ta 244,3,4096
v_lshlrev_b32 v6, 16, v123
Maav 120,252,88
Ta 246,3,4608
v_and_b32 v7, s46, v123
Mvav 160,224,96
Ta 248,4,4096
GDMA 15,98,3072
Mvav 164,224,100
Ta 250,4,4608
s_waitcnt lgkmcnt(4)
Mvav 172,228,100
Ta 252,5,4096
v_fma_f32 v6, v6, v8, v10
Mvav 168,228,96
Ta 254,5,4608
v_fma_f32 v7, v7, v8, v10
Mvav 176,232,96
Ta 224,2,8192
v_cvt_pk_bf16_f32 v123, v6, v7
Mvav 180,232,100
Ta 226,2,8704
v_lshlrev_b32 v6, 16, v124
Mvav 188,236,100
Ta 228,3,8192
v_and_b32 v7, s46, v124
Mvav 184,236,96
Ta 230,3,8704
v_fma_f32 v6, v6, v9, v11
Mvav 160,240,104
Ta 232,4,8192
v_fma_f32 v7, v7, v9, v11
Mvav 164,240,108
Ta 234,4,8704
s_waitcnt lgkmcnt(4)
Mvav 172,244,108
Ta 236,5,8192
v_cvt_pk_bf16_f32 v124, v6, v7
Mvav 168,244,104
Ta 238,5,8704
v_lshlrev_b32 v6, 16, v125
Mvav 176,248,104
Ta 240,2,12288
v_and_b32 v7, s46, v125
Mvav 180,248,108
Ta 242,2,12800
v_fma_f32 v6, v6, v9, v11
Mvav 188,252,108
Ta 244,3,12288
v_fma_f32 v7, v7, v9, v11
Mvav 184,252,104
Ta 246,3,12800
v_cvt_pk_bf16_f32 v125, v6, v7
Mvav 160,224,112
Ta 248,4,12288
v_lshlrev_b32 v6, 16, v126
Mvav 164,224,116
Ta 250,4,12800
s_waitcnt lgkmcnt(4)
Mvav 172,228,116
Ta 252,5,12288
v_and_b32 v7, s46, v126
Mvav 168,228,112
Ta 254,5,12800
v_fma_f32 v6, v6, v9, v11
s_waitcnt vmcnt(20)
s_barrier
Mvav 176,232,112
Ta 224,2,16384
s_add_u32 m0, s35, 0xc000
v_fma_f32 v7, v7, v9, v11
v_cvt_pk_bf16_f32 v126, v6, v7
Mvav 180,232,116
Ta 226,2,16896
s_add_u32 s44, s36, 0x280380
v_lshlrev_b32 v6, 16, v127
Mvav 188,236,116
Ta 228,3,16384
s_add_u32 s98, s8, s44
s_addc_u32 s99, s9, 0
v_and_b32 v7, s46, v127
v_fma_f32 v6, v6, v9, v11
Mvav 184,236,112
Ta 230,3,16896
GDMA 12,98,0
v_fma_f32 v7, v7, v9, v11
v_cvt_pk_bf16_f32 v127, v6, v7
Mvav 160,240,120
Ta 232,4,16384
GDMA 13,98,1024
Mvav 164,240,124
Ta 234,4,16896
s_waitcnt lgkmcnt(4)
Mvav 172,244,124
Ta 236,5,16384
v_lshlrev_b32 v6, 16, v128
Mvav 168,244,120
Ta 238,5,16896
v_and_b32 v7, s46, v128
Mvav 176,248,120
Ta 240,2,20480
GDMA 14,98,2048
Mvav 180,248,124
Ta 242,2,20992
v_fma_f32 v6, v6, v8, v10
Mvav 188,252,124
Ta 244,3,20480
v_fma_f32 v7, v7, v8, v10
Mvav 184,252,120
Ta 246,3,20992
v_cvt_pk_bf16_f32 v128, v6, v7
Mvav 192,224,96
Ta 248,4,20480
GDMA 15,98,3072
Mvav 196,224,100
Ta 250,4,20992
s_waitcnt lgkmcnt(4)
Mvav 204,228,100
Ta 252,5,20480
v_lshlrev_b32 v6, 16, v129
Mvav 200,228,96
Ta 254,5,20992
v_and_b32 v7, s46, v129
Mvav 208,232,96
Ta 224,2,24576
v_fma_f32 v6, v6, v8, v10
Mvav 212,232,100
Ta 226,2,25088
v_fma_f32 v7, v7, v8, v10
Mvav 220,236,100
Ta 228,3,24576
v_cvt_pk_bf16_f32 v129, v6, v7
Mvav 216,236,96
Ta 230,3,25088
v_lshlrev_b32 v6, 16, v130
Mvav 192,240,104
Ta 232,4,24576
v_and_b32 v7, s46, v130
Mvav 196,240,108
Ta 234,4,25088
s_waitcnt lgkmcnt(4)
Mvav 204,244,108
Ta 236,5,24576
v_fma_f32 v6, v6, v8, v10
Mvav 200,244,104
Ta 238,5,25088
v_fma_f32 v7, v7, v8, v10
Mvav 208,248,104
Ta 240,2,28672
v_cvt_pk_bf16_f32 v130, v6, v7
Mvav 212,248,108
Ta 242,2,29184
v_lshlrev_b32 v6, 16, v131
Mvav 220,252,108
Ta 244,3,28672
v_and_b32 v7, s46, v131
Mvav 216,252,104
Ta 246,3,29184
v_fma_f32 v6, v6, v8, v10
Mvav 192,224,112
Ta 248,4,28672
v_fma_f32 v7, v7, v8, v10
Mvav 196,224,116
Ta 250,4,29184
s_waitcnt lgkmcnt(4)
Mvav 204,228,116
Ta 252,5,28672
v_cvt_pk_bf16_f32 v131, v6, v7
Mvav 200,228,112
Ta 254,5,29184
s_waitcnt vmcnt(20)
s_barrier
Mvav 208,232,112
Ta 224,2,32768
s_add_u32 m0, s35, 0x10000
Mvav 212,232,116
Ta 226,2,33280
s_add_u32 s44, s36, 0x380000
Mvav 220,236,116
Ta 228,3,32768
s_add_u32 s98, s8, s44
s_addc_u32 s99, s9, 0
Mvav 216,236,112
Ta 230,3,33280
GDMA 12,98,0
Mvav 192,240,120
Ta 232,4,32768
GDMA 13,98,1024
Mvav 196,240,124
Ta 234,4,33280
s_waitcnt lgkmcnt(4)
Mvav 204,244,124
Ta 236,5,32768
v_lshlrev_b32 v6, 16, v132
Mvav 200,244,120
Ta 238,5,33280
v_and_b32 v7, s46, v132
Mvav 208,248,120
Ta 240,2,36864
GDMA 14,98,2048
Mvav 212,248,124
Ta 242,2,37376
v_fma_f32 v6, v6, v9, v11
Mvav 220,252,124
Ta 244,3,36864
v_fma_f32 v7, v7, v9, v11
Mvav 216,252,120
Ta 246,3,37376
v_cvt_pk_bf16_f32 v132, v6, v7
Mvav 224,224,96
Ta 248,4,36864
GDMA 15,98,3072
Mvav 228,224,100
Ta 250,4,37376
s_waitcnt lgkmcnt(4)
Mvav 236,228,100
Ta 252,5,36864
v_lshlrev_b32 v6, 16, v133
Mvav 232,228,96
Ta 254,5,37376
v_and_b32 v7, s46, v133
Mvav 240,232,96
Ta 224,2,40960
v_fma_f32 v6, v6, v9, v11
Mvav 244,232,100
Ta 226,2,41472
v_fma_f32 v7, v7, v9, v11
Mvav 252,236,100
Ta 228,3,40960
v_cvt_pk_bf16_f32 v133, v6, v7
Mvav 248,236,96
Ta 230,3,41472
v_lshlrev_b32 v6, 16, v134
Mvav 224,240,104
Ta 232,4,40960
v_and_b32 v7, s46, v134
Mvav 228,240,108
Ta 234,4,41472
s_waitcnt lgkmcnt(4)
Mvav 236,244,108
Ta 236,5,40960
v_fma_f32 v6, v6, v9, v11
Mvav 232,244,104
Ta 238,5,41472
v_fma_f32 v7, v7, v9, v11
Mvav 240,248,104
Ta 240,2,45056
v_cvt_pk_bf16_f32 v134, v6, v7
Mvav 244,248,108
Ta 242,2,45568
v_lshlrev_b32 v6, 16, v135
Mvav 252,252,108
Ta 244,3,45056
v_and_b32 v7, s46, v135
Mvav 248,252,104
Ta 246,3,45568
v_fma_f32 v6, v6, v9, v11
Mvav 224,224,112
Ta 248,4,45056
v_fma_f32 v7, v7, v9, v11
Mvav 228,224,116
Ta 250,4,45568
s_waitcnt lgkmcnt(4)
Mvav 236,228,116
Ta 252,5,45056
v_cvt_pk_bf16_f32 v135, v6, v7
Mvav 232,228,112
Ta 254,5,45568
s_waitcnt vmcnt(20)
s_barrier
Mvav 240,232,112
Ta 224,2,49152
s_add_u32 m0, s35, 0x14000
Mvav 244,232,116
Ta 226,2,49664
s_add_u32 s44, s36, 0x380080
Mvav 252,236,116
Ta 228,3,49152
s_add_u32 s98, s8, s44
s_addc_u32 s99, s9, 0
Mvav 248,236,112
Ta 230,3,49664
GDMA 12,98,0
Mvav 224,240,120
Ta 232,4,49152
GDMA 13,98,1024
Mvav 228,240,124
Ta 234,4,49664
s_waitcnt lgkmcnt(4)
Mvav 236,244,124
Ta 236,5,49152
v_lshlrev_b32 v6, 16, v136
Mvav 232,244,120
Ta 238,5,49664
v_and_b32 v7, s46, v136
Mvav 240,248,120
Ta 240,2,53248
GDMA 14,98,2048
Mvav 244,248,124
Ta 242,2,53760
v_fma_f32 v6, v6, v8, v10
Mvav 252,252,124
Ta 244,3,53248
v_fma_f32 v7, v7, v8, v10
Mvav 248,252,120
Ta 246,3,53760
v_cvt_pk_bf16_f32 v136, v6, v7
Maav 128,224,96
Ta 248,4,53248
GDMA 15,98,3072
Maav 132,224,100
Ta 250,4,53760
s_waitcnt lgkmcnt(4)
Maav 140,228,100
Ta 252,5,53248
v_lshlrev_b32 v6, 16, v137
Maav 136,228,96
Ta 254,5,53760
v_and_b32 v7, s46, v137
Maav 144,232,96
Ta 224,2,57344
v_fma_f32 v6, v6, v8, v10
Maav 148,232,100
Ta 226,2,57856
v_fma_f32 v7, v7, v8, v10
Maav 156,236,100
Ta 228,3,57344
v_cvt_pk_bf16_f32 v137, v6, v7
Maav 152,236,96
Ta 230,3,57856
v_lshlrev_b32 v6, 16, v138
Maav 128,240,104
Ta 232,4,57344
v_and_b32 v7, s46, v138
Maav 132,240,108
Ta 234,4,57856
s_waitcnt lgkmcnt(4)
Maav 140,244,108
Ta 236,5,57344
v_fma_f32 v6, v6, v8, v10
Maav 136,244,104
Ta 238,5,57856
v_fma_f32 v7, v7, v8, v10
Maav 144,248,104
Ta 240,2,61440
v_cvt_pk_bf16_f32 v138, v6, v7
Maav 148,248,108
Ta 242,2,61952
v_xor_b32 v2, 0x10000, v2
Maav 156,252,108
Ta 244,3,61440
v_lshlrev_b32 v6, 16, v139
Maav 152,252,104
Ta 246,3,61952
v_xor_b32 v3, 0x10000, v3
Maav 128,224,112
Ta 248,4,61440
v_and_b32 v7, s46, v139
Maav 132,224,116
Ta 250,4,61952
s_waitcnt lgkmcnt(4)
Maav 140,228,116
Ta 252,5,61440
v_xor_b32 v4, 0x10000, v4
Maav 136,228,112
Ta 254,5,61952
s_waitcnt vmcnt(20)
s_barrier
Maav 144,232,112
Ta 224,2,0
v_xor_b32 v5, 0x10000, v5
Maav 148,232,116
Ta 226,2,512
s_add_u32 m0, s35, 0x18000
Maav 156,236,116
Ta 228,3,0
s_add_u32 s44, s36, 0x380100
Maav 152,236,112
Ta 230,3,512
s_add_u32 s98, s8, s44
s_addc_u32 s99, s9, 0
Maav 128,240,120
Ta 232,4,0
GDMA 12,98,0
Maav 132,240,124
Ta 234,4,512
s_waitcnt lgkmcnt(4)
Maav 140,244,124
Ta 236,5,0
GDMA 13,98,1024
Maav 136,244,120
Ta 238,5,512
v_fma_f32 v6, v6, v8, v10
Maav 144,248,120
Ta 240,2,4096
GDMA 14,98,2048
Maav 148,248,124
Ta 242,2,4608
v_fma_f32 v7, v7, v8, v10
Maav 156,252,124
Ta 244,3,4096
v_cvt_pk_bf16_f32 v139, v6, v7
Maav 152,252,120
Ta 246,3,4608
v_lshlrev_b32 v6, 16, v140
Maav 0,224,96
Ta 248,4,4096
GDMA 15,98,3072
Maav 4,224,100
Ta 250,4,4608
s_waitcnt lgkmcnt(4)
Maav 12,228,100
Ta 252,5,4096
v_and_b32 v7, s46, v140
Maav 8,228,96
Ta 254,5,4608
v_fma_f32 v6, v6, v9, v11
Maav 16,232,96
Ta 224,2,8192
v_fma_f32 v7, v7, v9, v11
Maav 20,232,100
Ta 226,2,8704
v_cvt_pk_bf16_f32 v140, v6, v7
Maav 28,236,100
Ta 228,3,8192
v_lshlrev_b32 v6, 16, v141
Maav 24,236,96
Ta 230,3,8704
v_and_b32 v7, s46, v141
Maav 0,240,104
Ta 232,4,8192
v_fma_f32 v6, v6, v9, v11
Maav 4,240,108
Ta 234,4,8704
s_waitcnt lgkmcnt(4)
Maav 12,244,108
Ta 236,5,8192
v_fma_f32 v7, v7, v9, v11
Maav 8,244,104
Ta 238,5,8704
v_cvt_pk_bf16_f32 v141, v6, v7
Maav 16,248,104
Ta 240,2,12288
v_lshlrev_b32 v6, 16, v142
Maav 20,248,108
Ta 242,2,12800
v_and_b32 v7, s46, v142
Maav 28,252,108
Ta 244,3,12288
v_fma_f32 v6, v6, v9, v11
Maav 24,252,104
Ta 246,3,12800
v_fma_f32 v7, v7, v9, v11
Maav 0,224,112
Ta 248,4,12288
v_cvt_pk_bf16_f32 v142, v6, v7
Maav 4,224,116
Ta 250,4,12800
s_waitcnt lgkmcnt(4)
Maav 12,228,116
Ta 252,5,12288
v_lshlrev_b32 v6, 16, v143
Maav 8,228,112
Ta 254,5,12800
s_waitcnt vmcnt(20)
s_barrier
Maav 16,232,112
Ta 224,2,16384
s_add_u32 m0, s35, 0x1c000
Maav 20,232,116
Ta 226,2,16896
s_add_u32 s44, s36, 0x380180
Maav 28,236,116
Ta 228,3,16384
s_add_u32 s98, s8, s44
s_addc_u32 s99, s9, 0
Maav 24,236,112
Ta 230,3,16896
GDMA 12,98,0
Maav 0,240,120
Ta 232,4,16384
GDMA 13,98,1024
Maav 4,240,124
Ta 234,4,16896
s_waitcnt lgkmcnt(4)
Maav 12,244,124
Ta 236,5,16384
v_and_b32 v7, s46, v143
Maav 8,244,120
Ta 238,5,16896
v_fma_f32 v6, v6, v9, v11
Maav 16,248,120
Ta 240,2,20480
GDMA 14,98,2048
Maav 20,248,124
Ta 242,2,20992
v_fma_f32 v7, v7, v9, v11
Maav 28,252,124
Ta 244,3,20480
v_cvt_pk_bf16_f32 v143, v6, v7
Maav 24,252,120
Ta 246,3,20992
v_lshlrev_b32 v6, 16, v144
Maav 32,224,96
Ta 248,4,20480
GDMA 15,98,3072
Maav 36,224,100
Ta 250,4,20992
s_waitcnt lgkmcnt(4)
Maav 44,228,100
Ta 252,5,20480
v_and_b32 v7, s46, v144
Maav 40,228,96
Ta 254,5,20992
v_fma_f32 v6, v6, v8, v10
Maav 48,232,96
Ta 224,2,24576
v_fma_f32 v7, v7, v8, v10
Maav 52,232,100
Ta 226,2,25088
v_cvt_pk_bf16_f32 v144, v6, v7
Maav 60,236,100
Ta 228,3,24576
v_lshlrev_b32 v6, 16, v145
Maav 56,236,96
Ta 230,3,25088
v_and_b32 v7, s46, v145
Maav 32,240,104
Ta 232,4,24576
v_fma_f32 v6, v6, v8, v10
Maav 36,240,108
Ta 234,4,25088
s_waitcnt lgkmcnt(4)
Maav 44,244,108
Ta 236,5,24576
v_fma_f32 v7, v7, v8, v10
Maav 40,244,104
Ta 238,5,25088
v_cvt_pk_bf16_f32 v145, v6, v7
Maav 48,248,104
Ta 240,2,28672
v_lshlrev_b32 v6, 16, v146
Maav 52,248,108
Ta 242,2,29184
v_and_b32 v7, s46, v146
Maav 60,252,108
Ta 244,3,28672
v_fma_f32 v6, v6, v8, v10
Maav 56,252,104
Ta 246,3,29184
v_fma_f32 v7, v7, v8, v10
Maav 32,224,112
Ta 248,4,28672
v_cvt_pk_bf16_f32 v146, v6, v7
Maav 36,224,116
Ta 250,4,29184
s_waitcnt lgkmcnt(4)
Maav 44,228,116
Ta 252,5,28672
v_lshlrev_b32 v6, 16, v147
Maav 40,228,112
Ta 254,5,29184
s_waitcnt vmcnt(20)
s_barrier
Maav 48,232,112
Ta 224,2,32768
s_mov_b32 m0, s35
Maav 52,232,116
Ta 226,2,33280
s_add_u32 s44, s36, 0x380200
Maav 60,236,116
Ta 228,3,32768
s_add_u32 s98, s8, s44
s_addc_u32 s99, s9, 0
Maav 56,236,112
Ta 230,3,33280
GDMA 12,98,0
Maav 32,240,120
Ta 232,4,32768
GDMA 13,98,1024
Maav 36,240,124
Ta 234,4,33280
s_waitcnt lgkmcnt(4)
Maav 44,244,124
Ta 236,5,32768
v_and_b32 v7, s46, v147
Maav 40,244,120
Ta 238,5,33280
v_fma_f32 v6, v6, v8, v10
Maav 48,248,120
Ta 240,2,36864
GDMA 14,98,2048
Maav 52,248,124
Ta 242,2,37376
v_fma_f32 v7, v7, v8, v10
Maav 60,252,124
Ta 244,3,36864
v_cvt_pk_bf16_f32 v147, v6, v7
Maav 56,252,120
Ta 246,3,37376
v_lshlrev_b32 v6, 16, v148
Maav 64,224,96
Ta 248,4,36864
GDMA 15,98,3072
Maav 68,224,100
Ta 250,4,37376
s_waitcnt lgkmcnt(4)
Maav 76,228,100
Ta 252,5,36864
v_and_b32 v7, s46, v148
Maav 72,228,96
Ta 254,5,37376
v_fma_f32 v6, v6, v9, v11
Maav 80,232,96
Ta 224,2,40960
v_fma_f32 v7, v7, v9, v11
Maav 84,232,100
Ta 226,2,41472
v_cvt_pk_bf16_f32 v148, v6, v7
Maav 92,236,100
Ta 228,3,40960
v_lshlrev_b32 v6, 16, v149
Maav 88,236,96
Ta 230,3,41472
v_and_b32 v7, s46, v149
Maav 64,240,104
Ta 232,4,40960
v_fma_f32 v6, v6, v9, v11
Maav 68,240,108
Ta 234,4,41472
s_waitcnt lgkmcnt(4)
Maav 76,244,108
Ta 236,5,40960
v_fma_f32 v7, v7, v9, v11
Maav 72,244,104
Ta 238,5,41472
v_cvt_pk_bf16_f32 v149, v6, v7
Maav 80,248,104
Ta 240,2,45056
v_lshlrev_b32 v6, 16, v150
Maav 84,248,108
Ta 242,2,45568
v_and_b32 v7, s46, v150
Maav 92,252,108
Ta 244,3,45056
v_fma_f32 v6, v6, v9, v11
Maav 88,252,104
Ta 246,3,45568
v_fma_f32 v7, v7, v9, v11
Maav 64,224,112
Ta 248,4,45056
v_cvt_pk_bf16_f32 v150, v6, v7
Maav 68,224,116
Ta 250,4,45568
s_waitcnt lgkmcnt(4)
Maav 76,228,116
Ta 252,5,45056
v_lshlrev_b32 v6, 16, v151
Maav 72,228,112
Ta 254,5,45568
s_waitcnt vmcnt(20)
s_barrier
Maav 80,232,112
Ta 224,2,49152
s_add_u32 m0, s35, 0x4000
Maav 84,232,116
Ta 226,2,49664
s_add_u32 s44, s36, 0x380280
Maav 92,236,116
Ta 228,3,49152
s_add_u32 s98, s8, s44
s_addc_u32 s99, s9, 0
Maav 88,236,112
Ta 230,3,49664
GDMA 12,98,0
Maav 64,240,120
Ta 232,4,49152
GDMA 13,98,1024
Maav 68,240,124
Ta 234,4,49664
s_waitcnt lgkmcnt(4)
Maav 76,244,124
Ta 236,5,49152
v_and_b32 v7, s46, v151
Maav 72,244,120
Ta 238,5,49664
v_fma_f32 v6, v6, v9, v11
Maav 80,248,120
Ta 240,2,53248
GDMA 14,98,2048
Maav 84,248,124
Ta 242,2,53760
v_fma_f32 v7, v7, v9, v11
Maav 92,252,124
Ta 244,3,53248
v_cvt_pk_bf16_f32 v151, v6, v7
Maav 88,252,120
Ta 246,3,53760
v_lshlrev_b32 v6, 16, v152
Maav 96,224,96
Ta 248,4,53248
GDMA 15,98,3072
Maav 100,224,100
Ta 250,4,53760
s_waitcnt lgkmcnt(4)
Maav 108,228,100
Ta 252,5,53248
v_and_b32 v7, s46, v152
Maav 104,228,96
Ta 254,5,53760
v_fma_f32 v6, v6, v8, v10
Maav 112,232,96
Ta 224,2,57344
v_fma_f32 v7, v7, v8, v10
Maav 116,232,100
Ta 226,2,57856
v_cvt_pk_bf16_f32 v152, v6, v7
Maav 124,236,100
Ta 228,3,57344
v_lshlrev_b32 v6, 16, v153
Maav 120,236,96
Ta 230,3,57856
v_and_b32 v7, s46, v153
Maav 96,240,104
Ta 232,4,57344
v_fma_f32 v6, v6, v8, v10
Maav 100,240,108
Ta 234,4,57856
s_waitcnt lgkmcnt(4)
Maav 108,244,108
Ta 236,5,57344
v_fma_f32 v7, v7, v8, v10
Maav 104,244,104
Ta 238,5,57856
v_cvt_pk_bf16_f32 v153, v6, v7
Maav 112,248,104
Ta 240,2,61440
v_lshlrev_b32 v6, 16, v154
Maav 116,248,108
Ta 242,2,61952
v_xor_b32 v2, 0x10000, v2
Maav 124,252,108
Ta 244,3,61440
v_and_b32 v7, s46, v154
Maav 120,252,104
Ta 246,3,61952
v_xor_b32 v3, 0x10000, v3
Maav 96,224,112
Ta 248,4,61440
v_fma_f32 v6, v6, v8, v10
Maav 100,224,116
Ta 250,4,61952
s_waitcnt lgkmcnt(4)
Maav 108,228,116
Ta 252,5,61440
v_xor_b32 v4, 0x10000, v4
Maav 104,228,112
Ta 254,5,61952
s_waitcnt vmcnt(20)
s_barrier
Maav 112,232,112
Ta 224,2,0
v_xor_b32 v5, 0x10000, v5
Maav 116,232,116
Ta 226,2,512
s_add_u32 m0, s35, 0x8000
Maav 124,236,116
Ta 228,3,0
s_add_u32 s44, s36, 0x380300
Maav 120,236,112
Ta 230,3,512
s_add_u32 s98, s8, s44
s_addc_u32 s99, s9, 0
Maav 96,240,120
Ta 232,4,0
GDMA 12,98,0
Maav 100,240,124
Ta 234,4,512
s_waitcnt lgkmcnt(4)
Maav 108,244,124
Ta 236,5,0
GDMA 13,98,1024
Maav 104,244,120
Ta 238,5,512
v_fma_f32 v7, v7, v8, v10
Maav 112,248,120
Ta 240,2,4096
GDMA 14,98,2048
Maav 116,248,124
Ta 242,2,4608
v_cvt_pk_bf16_f32 v154, v6, v7
Maav 124,252,124
Ta 244,3,4096
v_lshlrev_b32 v6, 16, v155
Maav 120,252,120
Ta 246,3,4608
v_and_b32 v7, s46, v155
Mvav 160,224,128
Ta 248,4,4096
GDMA 15,98,3072
Mvav 164,224,132
Ta 250,4,4608
s_waitcnt lgkmcnt(4)
Mvav 172,228,132
Ta 252,5,4096
v_fma_f32 v6, v6, v8, v10
Mvav 168,228,128
Ta 254,5,4608
v_fma_f32 v7, v7, v8, v10
Mvav 176,232,128
Ta 224,2,8192
v_cvt_pk_bf16_f32 v155, v6, v7
Mvav 180,232,132
Ta 226,2,8704
v_lshlrev_b32 v6, 16, v156
Mvav 188,236,132
Ta 228,3,8192
v_and_b32 v7, s46, v156
Mvav 184,236,128
Ta 230,3,8704
v_fma_f32 v6, v6, v9, v11
Mvav 160,240,136
Ta 232,4,8192
v_fma_f32 v7, v7, v9, v11
Mvav 164,240,140
Ta 234,4,8704
s_waitcnt lgkmcnt(4)
Mvav 172,244,140
Ta 236,5,8192
v_cvt_pk_bf16_f32 v156, v6, v7
Mvav 168,244,136
Ta 238,5,8704
v_lshlrev_b32 v6, 16, v157
Mvav 176,248,136
Ta 240,2,12288
v_and_b32 v7, s46, v157
Mvav 180,248,140
Ta 242,2,12800
v_fma_f32 v6, v6, v9, v11
Mvav 188,252,140
Ta 244,3,12288
v_fma_f32 v7, v7, v9, v11
Mvav 184,252,136
Ta 246,3,12800
v_cvt_pk_bf16_f32 v157, v6, v7
Mvav 160,224,144
Ta 248,4,12288
v_lshlrev_b32 v6, 16, v158
Mvav 164,224,148
Ta 250,4,12800
s_waitcnt lgkmcnt(4)
Mvav 172,228,148
Ta 252,5,12288
v_and_b32 v7, s46, v158
Mvav 168,228,144
Ta 254,5,12800
v_fma_f32 v6, v6, v9, v11
s_waitcnt vmcnt(20)
s_barrier
Mvav 176,232,144
Ta 224,2,16384
s_add_u32 m0, s35, 0xc000
v_fma_f32 v7, v7, v9, v11
v_cvt_pk_bf16_f32 v158, v6, v7
Mvav 180,232,148
Ta 226,2,16896
s_add_u32 s44, s36, 0x380380
v_lshlrev_b32 v6, 16, v159
Mvav 188,236,148
Ta 228,3,16384
s_add_u32 s98, s8, s44
s_addc_u32 s99, s9, 0
v_and_b32 v7, s46, v159
v_fma_f32 v6, v6, v9, v11
Mvav 184,236,144
Ta 230,3,16896
GDMA 12,98,0
v_fma_f32 v7, v7, v9, v11
v_cvt_pk_bf16_f32 v159, v6, v7
Mvav 160,240,152
Ta 232,4,16384
GDMA 13,98,1024
Mvav 164,240,156
Ta 234,4,16896
s_waitcnt lgkmcnt(4)
Mvav 172,244,156
Ta 236,5,16384
v_lshrrev_b32 v20, 4, v1
Mvav 168,244,152
Ta 238,5,16896
v_and_b32 v21, 15, v1
Mvav 176,248,152
Ta 240,2,20480
GDMA 14,98,2048
Mvav 180,248,156
Ta 242,2,20992
v_xor_b32 v22, v20, v21
Mvav 188,252,156
Ta 244,3,20480
v_lshlrev_b32 v22, 4, v22
Mvav 184,252,152
Ta 246,3,20992
v_lshl_or_b32 v28, v20, 8, v22
Mvav 192,224,128
Ta 248,4,20480
GDMA 15,98,3072
Mvav 196,224,132
Ta 250,4,20992
s_waitcnt lgkmcnt(4)
Mvav 204,228,132
Ta 252,5,20480
v_lshrrev_b32 v22, 1, v21
Mvav 200,228,128
Ta 254,5,20992
v_xor_b32 v22, v22, v20
Mvav 208,232,128
Ta 224,2,24576
v_lshlrev_b32 v22, 5, v22
Mvav 212,232,132
Ta 226,2,25088
v_and_b32 v21, 1, v21
Mvav 220,236,132
Ta 228,3,24576
v_lshl_or_b32 v22, v21, 4, v22
Mvav 216,236,128
Ta 230,3,25088
v_lshl_or_b32 v29, v20, 8, v22
Mvav 192,240,136
Ta 232,4,24576
v_cmp_gt_u32_e64 vcc, 2, s3
Mvav 196,240,140
Ta 234,4,25088
s_waitcnt lgkmcnt(4)
Mvav 204,244,140
Ta 236,5,24576
s_nop 1
Mvav 200,244,136
Ta 238,5,25088
v_cndmask_b32 v28, v29, v28, vcc
Mvav 208,248,136
Ta 240,2,28672
v_xor_b32 v29, s76, v28
Mvav 212,248,140
Ta 242,2,29184
v_xor_b32 v30, s77, v28
Mvav 220,252,140
Ta 244,3,28672
v_xor_b32 v31, s78, v28
Mvav 216,252,136
Ta 246,3,29184
v_cvt_pk_bf16_f32 v164, v164, v165
Mvav 192,224,144
Ta 248,4,28672
v_cvt_pk_bf16_f32 v165, v166, v167
Mvav 196,224,148
Ta 250,4,29184
s_waitcnt lgkmcnt(4)
Mvav 204,228,148
Ta 252,5,28672
v_cvt_pk_bf16_f32 v166, v172, v173
Mvav 200,228,144
Ta 254,5,29184
s_waitcnt vmcnt(20)
s_barrier
Mvav 208,232,144
Ta 224,2,32768
s_add_u32 m0, s35, 0x10000
Mvav 212,232,148
Ta 226,2,33280
s_mov_b32 s44, s38
Mvav 220,236,148
Ta 228,3,32768
s_add_u32 s98, s16, s44
s_addc_u32 s99, s17, 0
Mvav 216,236,144
Ta 230,3,33280
GDMA 28,98,0
Mvav 192,240,152
Ta 232,4,32768
GDMA 29,98,1024
Mvav 196,240,156
Ta 234,4,33280
s_waitcnt lgkmcnt(4)
Mvav 204,244,156
Ta 236,5,32768
v_cvt_pk_bf16_f32 v167, v174, v175
Mvav 200,244,152
Ta 238,5,33280
v_and_b32 v21, 15, v1
Mvav 208,248,152
Ta 240,2,36864
Ta 242,2,37376
Mvav 212,248,156
v_permlane32_swap_b32 v164, v166
Mvav 220,252,156
Ta 244,3,36864
Ta 246,3,37376
Mvav 216,252,152
v_permlane32_swap_b32 v165, v167
Mvav 224,224,128
Ta 248,4,36864
GDMA 30,98,2048
Mvav 228,224,132
Ta 250,4,37376
s_waitcnt lgkmcnt(4)
Mvav 236,228,132
Ta 252,5,36864
Ta 254,5,37376
Mvav 232,228,128
v_permlane16_swap_b32 v164, v166
Mvav 240,232,128
Ta 224,2,40960
Ta 226,2,41472
Mvav 244,232,132
v_permlane16_swap_b32 v165, v167
Mvav 252,236,132
Ta 228,3,40960
GDMA 31,98,3072
v_accvgpr_write_b32 a176, v164
Mvav 248,236,128
Ta 230,3,41472
v_accvgpr_write_b32 a177, v165
v_accvgpr_write_b32 a178, v166
Mvav 224,240,136
Ta 232,4,40960
v_accvgpr_write_b32 a179, v167
Mvav 228,240,140
Ta 234,4,41472
v_cvt_pk_bf16_f32 v160, v160, v161
v_cvt_pk_bf16_f32 v161, v162, v163
s_waitcnt lgkmcnt(4)
Mvav 236,244,140
Ta 236,5,40960
v_cvt_pk_bf16_f32 v162, v168, v169
Mvav 232,244,136
Ta 238,5,41472
v_cvt_pk_bf16_f32 v163, v170, v171
Mvav 240,248,136
Ta 240,2,45056
Ta 242,2,45568
v_permlane32_swap_b32 v160, v162
Mvav 244,248,140
v_permlane32_swap_b32 v161, v163
Mvav 252,252,140
Ta 244,3,45056
Ta 246,3,45568
Mvav 248,252,136
v_permlane16_swap_b32 v160, v162
Mvav 224,224,144
Ta 248,4,45056
v_permlane16_swap_b32 v161, v163
Mvav 228,224,148
Ta 250,4,45568
v_accvgpr_write_b32 a160, v160
v_accvgpr_write_b32 a161, v161
s_waitcnt lgkmcnt(4)
Mvav 236,228,148
Ta 252,5,45056
v_accvgpr_write_b32 a162, v162
Mvav 232,228,144
Ta 254,5,45568
v_accvgpr_write_b32 a163, v163
v_cvt_pk_bf16_f32 v180, v180, v181
s_waitcnt vmcnt(20)
s_barrier
Mvav 240,232,144
Ta 224,2,49152
s_add_u32 m0, s35, 0x14000
v_cvt_pk_bf16_f32 v181, v182, v183
Mvav 244,232,148
Ta 226,2,49664
s_add_u32 s44, s38, 0x2000
v_cvt_pk_bf16_f32 v182, v188, v189
v_cvt_pk_bf16_f32 v183, v190, v191
Mvav 252,236,148
Ta 228,3,49152
Ta 230,3,49664
Mvav 248,236,144
v_permlane32_swap_b32 v180, v182
Mvav 224,240,152
Ta 232,4,49152
s_add_u32 s98, s16, s44
s_addc_u32 s99, s17, 0
v_permlane32_swap_b32 v181, v183
Mvav 228,240,156
Ta 234,4,49664
v_permlane16_swap_b32 v180, v182
s_waitcnt lgkmcnt(4)
Mvav 236,244,156
Ta 236,5,49152
Ta 238,5,49664
Mvav 232,244,152
v_permlane16_swap_b32 v181, v183
v_accvgpr_write_b32 a180, v180
Mvav 240,248,152
Ta 240,2,53248
GDMA 28,98,0
v_accvgpr_write_b32 a181, v181
Mvav 244,248,156
Ta 242,2,53760
GDMA 29,98,1024
v_accvgpr_write_b32 a182, v182
v_accvgpr_write_b32 a183, v183
Mvav 252,252,156
Ta 244,3,53248
GDMA 30,98,2048
v_cvt_pk_bf16_f32 v176, v176, v177
Mvav 248,252,152
Ta 246,3,53760
v_cvt_pk_bf16_f32 v177, v178, v179
v_cvt_pk_bf16_f32 v178, v184, v185
Maav 128,224,128
Ta 248,4,53248
GDMA 31,98,3072
v_cvt_pk_bf16_f32 v179, v186, v187
Maav 132,224,132
Ta 250,4,53760
v_permlane32_swap_b32 v176, v178
s_waitcnt lgkmcnt(4)
Maav 140,228,132
Ta 252,5,53248
Ta 254,5,53760
Maav 136,228,128
v_permlane32_swap_b32 v177, v179
Maav 144,232,128
Ta 224,2,57344
Ta 226,2,57856
v_permlane16_swap_b32 v176, v178
Maav 148,232,132
v_permlane16_swap_b32 v177, v179
Maav 156,236,132
Ta 228,3,57344
v_accvgpr_write_b32 a164, v176
Maav 152,236,128
Ta 230,3,57856
v_accvgpr_write_b32 a165, v177
v_accvgpr_write_b32 a166, v178
Maav 128,240,136
Ta 232,4,57344
v_accvgpr_write_b32 a167, v179
Maav 132,240,140
Ta 234,4,57856
v_cvt_pk_bf16_f32 v196, v196, v197
v_cvt_pk_bf16_f32 v197, v198, v199
s_waitcnt lgkmcnt(4)
Maav 140,244,140
Ta 236,5,57344
v_cvt_pk_bf16_f32 v198, v204, v205
Maav 136,244,136
Ta 238,5,57856
v_cvt_pk_bf16_f32 v199, v206, v207
Maav 144,248,136
Ta 240,2,61440
Ta 242,2,61952
v_permlane32_swap_b32 v196, v198
Maav 148,248,140
v_permlane32_swap_b32 v197, v199
Maav 156,252,140
Ta 244,3,61440
Ta 246,3,61952
Maav 152,252,136
v_permlane16_swap_b32 v196, v198
Maav 128,224,144
Ta 248,4,61440
v_xor_b32 v2, 0x10000, v2
v_permlane16_swap_b32 v197, v199
Maav 132,224,148
Ta 250,4,61952
v_accvgpr_write_b32 a184, v196
v_accvgpr_write_b32 a185, v197
s_waitcnt lgkmcnt(4)
Maav 140,228,148
Ta 252,5,61440
v_xor_b32 v3, 0x10000, v3
v_accvgpr_write_b32 a186, v198
Maav 136,228,144
Ta 254,5,61952
v_accvgpr_write_b32 a187, v199
v_cvt_pk_bf16_f32 v192, v192, v193
s_waitcnt vmcnt(20)
s_barrier
Maav 144,232,144
Ta 224,2,0
v_xor_b32 v4, 0x10000, v4
v_cvt_pk_bf16_f32 v193, v194, v195
Maav 148,232,148
Ta 226,2,512
v_xor_b32 v5, 0x10000, v5
v_cvt_pk_bf16_f32 v194, v200, v201
v_cvt_pk_bf16_f32 v195, v202, v203
Maav 156,236,148
Ta 228,3,0
Ta 230,3,512
Maav 152,236,144
v_permlane32_swap_b32 v192, v194
Maav 128,240,152
Ta 232,4,0
s_add_u32 m0, s35, 0x18000
v_permlane32_swap_b32 v193, v195
Maav 132,240,156
Ta 234,4,512
v_permlane16_swap_b32 v192, v194
s_waitcnt lgkmcnt(4)
Maav 140,244,156
Ta 236,5,0
Ta 238,5,512
Maav 136,244,152
v_permlane16_swap_b32 v193, v195
v_accvgpr_write_b32 a168, v192
Maav 144,248,152
Ta 240,2,4096
s_add_u32 s44, s38, 0x4000
v_accvgpr_write_b32 a169, v193
Maav 148,248,156
Ta 242,2,4608
s_add_u32 s98, s16, s44
s_addc_u32 s99, s17, 0
v_accvgpr_write_b32 a170, v194
v_accvgpr_write_b32 a171, v195
Maav 156,252,156
Ta 244,3,4096
GDMA 28,98,0
v_cvt_pk_bf16_f32 v212, v212, v213
Maav 152,252,152
Ta 246,3,4608
GDMA 29,98,1024
v_cvt_pk_bf16_f32 v213, v214, v215
v_cvt_pk_bf16_f32 v214, v220, v221
Maav 0,224,128
Ta 248,4,4096
GDMA 30,98,2048
v_cvt_pk_bf16_f32 v215, v222, v223
Maav 4,224,132
Ta 250,4,4608
v_permlane32_swap_b32 v212, v214
s_waitcnt lgkmcnt(4)
Maav 12,228,132
Ta 252,5,4096
Ta 254,5,4608
Maav 8,228,128
v_permlane32_swap_b32 v213, v215
Maav 16,232,128
Ta 224,2,8192
Ta 226,2,8704
v_permlane16_swap_b32 v212, v214
Maav 20,232,132
v_permlane16_swap_b32 v213, v215
Maav 28,236,132
Ta 228,3,8192
GDMA 31,98,3072
v_accvgpr_write_b32 a188, v212
Maav 24,236,128
Ta 230,3,8704
v_accvgpr_write_b32 a189, v213
v_accvgpr_write_b32 a190, v214
Maav 0,240,136
Ta 232,4,8192
v_accvgpr_write_b32 a191, v215
Maav 4,240,140
Ta 234,4,8704
v_cvt_pk_bf16_f32 v208, v208, v209
v_cvt_pk_bf16_f32 v209, v210, v211
s_waitcnt lgkmcnt(4)
Maav 12,244,140
Ta 236,5,8192
v_cvt_pk_bf16_f32 v210, v216, v217
Maav 8,244,136
Ta 238,5,8704
v_cvt_pk_bf16_f32 v211, v218, v219
Maav 16,248,136
Ta 240,2,12288
Ta 242,2,12800
v_permlane32_swap_b32 v208, v210
Maav 20,248,140
v_permlane32_swap_b32 v209, v211
Maav 28,252,140
Ta 244,3,12288
Ta 246,3,12800
Maav 24,252,136
v_permlane16_swap_b32 v208, v210
Maav 0,224,144
Ta 248,4,12288
v_permlane16_swap_b32 v209, v211
Maav 4,224,148
Ta 250,4,12800
v_accvgpr_write_b32 a172, v208
v_accvgpr_write_b32 a173, v209
s_waitcnt lgkmcnt(4)
Maav 12,228,148
Ta 252,5,12288
v_accvgpr_write_b32 a174, v210
Maav 8,228,144
Ta 254,5,12800
v_accvgpr_write_b32 a175, v211
v_cvt_pk_bf16_f32 v228, v228, v229
s_waitcnt vmcnt(20)
s_barrier
Maav 16,232,144
Ta 224,2,16384
s_add_u32 m0, s35, 0x1c000
v_cvt_pk_bf16_f32 v229, v230, v231
Maav 20,232,148
Ta 226,2,16896
s_add_u32 s44, s38, 0x6000
v_cvt_pk_bf16_f32 v230, v236, v237
v_cvt_pk_bf16_f32 v231, v238, v239
Maav 28,236,148
Ta 228,3,16384
Ta 230,3,16896
Maav 24,236,144
v_permlane32_swap_b32 v228, v230
Maav 0,240,152
Ta 232,4,16384
s_add_u32 s98, s16, s44
s_addc_u32 s99, s17, 0
v_permlane32_swap_b32 v229, v231
Maav 4,240,156
Ta 234,4,16896
v_permlane16_swap_b32 v228, v230
s_waitcnt lgkmcnt(4)
Maav 12,244,156
Ta 236,5,16384
Ta 238,5,16896
Maav 8,244,152
v_permlane16_swap_b32 v229, v231
v_accvgpr_write_b32 a208, v228
Maav 16,248,152
Ta 240,2,20480
GDMA 28,98,0
v_accvgpr_write_b32 a209, v229
Maav 20,248,156
Ta 242,2,20992
GDMA 29,98,1024
v_accvgpr_write_b32 a210, v230
v_accvgpr_write_b32 a211, v231
Maav 28,252,156
Ta 244,3,20480
GDMA 30,98,2048
v_cvt_pk_bf16_f32 v224, v224, v225
Maav 24,252,152
Ta 246,3,20992
v_cvt_pk_bf16_f32 v225, v226, v227
v_cvt_pk_bf16_f32 v226, v232, v233
Maav 32,224,128
Ta 248,4,20480
GDMA 31,98,3072
v_cvt_pk_bf16_f32 v227, v234, v235
Maav 36,224,132
Ta 250,4,20992
v_permlane32_swap_b32 v224, v226
s_waitcnt lgkmcnt(4)
Maav 44,228,132
Ta 252,5,20480
Ta 254,5,20992
Maav 40,228,128
v_permlane32_swap_b32 v225, v227
Maav 48,232,128
Ta 224,2,24576
Ta 226,2,25088
v_permlane16_swap_b32 v224, v226
Maav 52,232,132
v_permlane16_swap_b32 v225, v227
Maav 60,236,132
Ta 228,3,24576
v_accvgpr_write_b32 a192, v224
Maav 56,236,128
Ta 230,3,25088
v_accvgpr_write_b32 a193, v225
v_accvgpr_write_b32 a194, v226
Maav 32,240,136
Ta 232,4,24576
v_accvgpr_write_b32 a195, v227
Maav 36,240,140
Ta 234,4,25088
v_cvt_pk_bf16_f32 v244, v244, v245
v_cvt_pk_bf16_f32 v245, v246, v247
s_waitcnt lgkmcnt(4)
Maav 44,244,140
Ta 236,5,24576
v_cvt_pk_bf16_f32 v246, v252, v253
Maav 40,244,136
Ta 238,5,25088
v_cvt_pk_bf16_f32 v247, v254, v255
Maav 48,248,136
Ta 240,2,28672
Ta 242,2,29184
v_permlane32_swap_b32 v244, v246
Maav 52,248,140
v_permlane32_swap_b32 v245, v247
Maav 60,252,140
Ta 244,3,28672
Ta 246,3,29184
Maav 56,252,136
v_permlane16_swap_b32 v244, v246
Maav 32,224,144
Ta 248,4,28672
v_permlane16_swap_b32 v245, v247
Maav 36,224,148
Ta 250,4,29184
v_accvgpr_write_b32 a212, v244
v_accvgpr_write_b32 a213, v245
s_waitcnt lgkmcnt(4)
Maav 44,228,148
Ta 252,5,28672
v_accvgpr_write_b32 a214, v246
Maav 40,228,144
Ta 254,5,29184
v_accvgpr_write_b32 a215, v247
v_cvt_pk_bf16_f32 v240, v240, v241
s_waitcnt vmcnt(20)
s_barrier
Maav 48,232,144
Ta 224,2,32768
s_mov_b32 m0, s35
v_cvt_pk_bf16_f32 v241, v242, v243
Maav 52,232,148
Ta 226,2,33280
s_add_u32 s44, s38, 0x8000
v_cvt_pk_bf16_f32 v242, v248, v249
v_cvt_pk_bf16_f32 v243, v250, v251
Maav 60,236,148
Ta 228,3,32768
Ta 230,3,33280
Maav 56,236,144
v_permlane32_swap_b32 v240, v242
Maav 32,240,152
Ta 232,4,32768
s_add_u32 s98, s16, s44
s_addc_u32 s99, s17, 0
v_permlane32_swap_b32 v241, v243
Maav 36,240,156
Ta 234,4,33280
v_permlane16_swap_b32 v240, v242
s_waitcnt lgkmcnt(4)
Maav 44,244,156
Ta 236,5,32768
Ta 238,5,33280
Maav 40,244,152
v_permlane16_swap_b32 v241, v243
v_accvgpr_write_b32 a196, v240
Maav 48,248,152
Ta 240,2,36864
GDMA 28,98,0
v_accvgpr_write_b32 a197, v241
Maav 52,248,156
Ta 242,2,37376
GDMA 29,98,1024
v_accvgpr_write_b32 a198, v242
v_accvgpr_write_b32 a199, v243
Maav 60,252,156
Ta 244,3,36864
GDMA 30,98,2048
v_accvgpr_read_b32 v40, a132
Maav 56,252,152
Ta 246,3,37376
v_accvgpr_read_b32 v41, a133
v_accvgpr_read_b32 v42, a134
Maav 64,224,128
Ta 248,4,36864
GDMA 31,98,3072
v_accvgpr_read_b32 v43, a135
Maav 68,224,132
Ta 250,4,37376
v_accvgpr_read_b32 v44, a140
v_accvgpr_read_b32 v45, a141
s_waitcnt lgkmcnt(4)
Maav 76,228,132
Ta 252,5,36864
v_accvgpr_read_b32 v46, a142
Maav 72,228,128
Ta 254,5,37376
v_accvgpr_read_b32 v47, a143
v_cvt_pk_bf16_f32 v40, v40, v41
Maav 80,232,128
Ta 224,2,40960
v_cvt_pk_bf16_f32 v41, v42, v43
Maav 84,232,132
Ta 226,2,41472
v_cvt_pk_bf16_f32 v42, v44, v45
v_cvt_pk_bf16_f32 v43, v46, v47
Maav 92,236,132
Ta 228,3,40960
Ta 230,3,41472
Maav 88,236,128
v_permlane32_swap_b32 v40, v42
Maav 64,240,136
Ta 232,4,40960
v_permlane32_swap_b32 v41, v43
Maav 68,240,140
Ta 234,4,41472
v_permlane16_swap_b32 v40, v42
s_waitcnt lgkmcnt(4)
Maav 76,244,140
Ta 236,5,40960
Ta 238,5,41472
Maav 72,244,136
v_permlane16_swap_b32 v41, v43
v_accvgpr_write_b32 a216, v40
Maav 80,248,136
Ta 240,2,45056
v_accvgpr_write_b32 a217, v41
Maav 84,248,140
Ta 242,2,45568
v_accvgpr_write_b32 a218, v42
v_accvgpr_write_b32 a219, v43
Maav 92,252,140
Ta 244,3,45056
v_accvgpr_read_b32 v32, a128
Maav 88,252,136
Ta 246,3,45568
v_accvgpr_read_b32 v33, a129
v_accvgpr_read_b32 v34, a130
Maav 64,224,144
Ta 248,4,45056
v_accvgpr_read_b32 v35, a131
Maav 68,224,148
Ta 250,4,45568
v_accvgpr_read_b32 v36, a136
v_accvgpr_read_b32 v37, a137
s_waitcnt lgkmcnt(4)
Maav 76,228,148
Ta 252,5,45056
v_accvgpr_read_b32 v38, a138
Maav 72,228,144
Ta 254,5,45568
v_accvgpr_read_b32 v39, a139
v_cvt_pk_bf16_f32 v32, v32, v33
s_waitcnt vmcnt(20)
s_barrier
Maav 80,232,144
Ta 224,2,49152
s_add_u32 m0, s35, 0x4000
v_cvt_pk_bf16_f32 v33, v34, v35
Maav 84,232,148
Ta 226,2,49664
s_add_u32 s44, s38, 0xa000
v_cvt_pk_bf16_f32 v34, v36, v37
v_cvt_pk_bf16_f32 v35, v38, v39
Maav 92,236,148
Ta 228,3,49152
Ta 230,3,49664
Maav 88,236,144
v_permlane32_swap_b32 v32, v34
Maav 64,240,152
Ta 232,4,49152
s_add_u32 s98, s16, s44
s_addc_u32 s99, s17, 0
v_permlane32_swap_b32 v33, v35
Maav 68,240,156
Ta 234,4,49664
v_permlane16_swap_b32 v32, v34
s_waitcnt lgkmcnt(4)
Maav 76,244,156
Ta 236,5,49152
Ta 238,5,49664
Maav 72,244,152
v_permlane16_swap_b32 v33, v35
v_accvgpr_write_b32 a200, v32
Maav 80,248,152
Ta 240,2,53248
GDMA 28,98,0
v_accvgpr_write_b32 a201, v33
Maav 84,248,156
Ta 242,2,53760
GDMA 29,98,1024
v_accvgpr_write_b32 a202, v34
v_accvgpr_write_b32 a203, v35
Maav 92,252,156
Ta 244,3,53248
GDMA 30,98,2048
v_accvgpr_read_b32 v40, a148
Maav 88,252,152
Ta 246,3,53760
v_accvgpr_read_b32 v41, a149
v_accvgpr_read_b32 v42, a150
Maav 96,224,128
Ta 248,4,53248
GDMA 31,98,3072
v_accvgpr_read_b32 v43, a151
Maav 100,224,132
Ta 250,4,53760
v_accvgpr_read_b32 v44, a156
v_accvgpr_read_b32 v45, a157
s_waitcnt lgkmcnt(4)
Maav 108,228,132
Ta 252,5,53248
v_accvgpr_read_b32 v46, a158
Maav 104,228,128
Ta 254,5,53760
v_accvgpr_read_b32 v47, a159
v_cvt_pk_bf16_f32 v40, v40, v41
Maav 112,232,128
Ta 224,2,57344
v_cvt_pk_bf16_f32 v41, v42, v43
v_lshrrev_b32 v20, 4, v1
Maav 116,232,132
Ta 226,2,57856
v_cvt_pk_bf16_f32 v42, v44, v45
v_xor_b32 v22, v20, v21
v_cvt_pk_bf16_f32 v43, v46, v47
Maav 124,236,132
Ta 228,3,57344
v_lshlrev_b32 v22, 4, v22
v_lshl_or_b32 v16, v21, 8, v22
Maav 120,236,128
Ta 230,3,57856
v_permlane32_swap_b32 v40, v42
v_add_u32 v16, 0x10000, v16
Maav 96,240,136
Ta 232,4,57344
v_xor_b32 v17, 64, v16
v_permlane32_swap_b32 v41, v43
v_xor_b32 v18, 0x80, v16
Maav 100,240,140
Ta 234,4,57856
v_xor_b32 v19, 0xc0, v16
v_permlane16_swap_b32 v40, v42
s_waitcnt lgkmcnt(4)
Maav 108,244,140
Ta 236,5,57344
v_lshrrev_b32 v20, 2, v1
v_and_b32 v21, 7, v20
Maav 104,244,136
Ta 238,5,57856
v_permlane16_swap_b32 v41, v43
v_lshlrev_b32 v21, 5, v21
v_accvgpr_write_b32 a220, v40
Maav 112,248,136
Ta 240,2,61440
v_lshl_or_b32 v21, v20, 8, v21
v_accvgpr_write_b32 a221, v41
v_and_b32 v20, 3, v1
Maav 116,248,140
Ta 242,2,61952
v_accvgpr_write_b32 a222, v42
v_lshl_or_b32 v20, v20, 3, v21
v_accvgpr_write_b32 a223, v43
Maav 124,252,140
Ta 244,3,61440
v_add_u32 v20, 0x10000, v20
v_accvgpr_read_b32 v32, a144
v_xor_b32 v27, 0xe0, v20
Maav 120,252,136
Ta 246,3,61952
v_accvgpr_read_b32 v33, a145
v_xor_b32 v26, 0xc0, v20
v_accvgpr_read_b32 v34, a146
Maav 96,224,144
Ta 248,4,61440
v_xor_b32 v25, 0xa0, v20
v_accvgpr_read_b32 v35, a147
v_xor_b32 v24, 0x80, v20
Maav 100,224,148
Ta 250,4,61952
v_accvgpr_read_b32 v36, a152
v_xor_b32 v23, 0x60, v20
v_accvgpr_read_b32 v37, a153
s_waitcnt lgkmcnt(4)
Maav 108,228,148
Ta 252,5,61440
v_xor_b32 v22, 64, v20
v_accvgpr_read_b32 v38, a154
v_xor_b32 v21, 32, v20
Maav 104,228,144
Ta 254,5,61952
v_accvgpr_read_b32 v39, a155
v_cvt_pk_bf16_f32 v32, v32, v33
s_waitcnt vmcnt(20)
s_barrier
Maav 112,232,144
Ba 224,16,0
s_add_u32 m0, s35, 0x8000
v_cvt_pk_bf16_f32 v33, v34, v35
Maav 116,232,148
s_add_u32 s44, s38, 0xc000
v_cvt_pk_bf16_f32 v34, v36, v37
v_cvt_pk_bf16_f32 v35, v38, v39
Maav 124,236,148
s_add_u32 s98, s16, s44
s_addc_u32 s99, s17, 0
Maav 120,236,144
GDMA 28,98,0
v_permlane32_swap_b32 v32, v34
Maav 96,240,152
Ba 228,17,0
GDMA 29,98,1024
v_permlane32_swap_b32 v33, v35
Maav 100,240,156
v_permlane16_swap_b32 v32, v34
s_waitcnt lgkmcnt(1)
Maav 108,244,156
v_permlane16_swap_b32 v33, v35
Maav 104,244,152
v_accvgpr_write_b32 a204, v32
v_accvgpr_write_b32 a205, v33
Maav 112,248,152
Ba 232,18,0
GDMA 30,98,2048
Maav 116,248,156
v_accvgpr_write_b32 a206, v34
v_accvgpr_write_b32 a207, v35
Maav 124,252,156
v_mov_b32 v32, 0x3f803f80
v_accvgpr_write_b32 a144, v32
Maav 120,252,152
v_accvgpr_write_b32 a145, v32
v_accvgpr_write_b32 a146, v32
Zvaa 160,224,160
Ba 236,19,0
GDMA 31,98,3072
Zvaa 168,224,176
v_accvgpr_write_b32 a147, v32
v_lshrrev_b32 v6, 3, v1
Zvaa 184,224,208
v_bfe_u32 v7, v1, 1, 2
v_bfe_u32 v13, v1, 4, 2
Zvaa 176,224,192
v_xor_b32 v7, v7, v13
s_waitcnt lgkmcnt(1)
Mvaa 160,228,164
Ba 240,16,4096
v_lshlrev_b32 v7, 5, v7
Mvaa 168,228,180
v_and_b32 v13, 1, v1
v_lshl_or_b32 v7, v13, 4, v7
Mvaa 184,228,212
v_mul_u32_u24 v6, 0x480, v6
v_add_u32 v12, v6, v7
Mvaa 176,228,196
v_add_u32 v13, 0x2000, v12
v_add_u32 v14, 0x4000, v12
Mvaa 160,232,168
Ba 244,17,4096
v_add_u32 v15, 0x6000, v12
Mvaa 168,232,184
v_lshrrev_b32 v6, 5, v1
v_lshlrev_b32 v6, 10, v6
Mvaa 184,232,216
v_bfe_u32 v7, v1, 2, 3
v_lshl_or_b32 v6, v7, 7, v6
Mvaa 176,232,200
v_bfe_u32 v7, v1, 3, 2
s_waitcnt lgkmcnt(1)
Mvaa 160,236,172
Ba 248,18,4096
v_lshl_or_b32 v6, v7, 5, v6
Mvaa 168,236,188
v_and_b32 v7, 3, v1
v_lshl_or_b32 v2, v7, 3, v6
Mvaa 184,236,220
v_add_u32 v2, 0x10000, v2
v_xor_b32 v3, 32, v2
Mvaa 176,236,204
v_xor_b32 v4, 64, v2
v_xor_b32 v5, 0x60, v2
Zvaa 164,240,160
Ba 252,19,4096
Zvaa 172,240,176
v_exp_f32 v160, v160
v_exp_f32 v161, v161
v_exp_f32 v162, v162
v_exp_f32 v163, v163
v_cvt_pk_bf16_f32 v192, v160, v161
v_cvt_pk_bf16_f32 v193, v162, v163
Zvaa 188,240,208
v_exp_f32 v168, v168
v_exp_f32 v169, v169
v_exp_f32 v170, v170
v_exp_f32 v171, v171
Zvaa 180,240,192
v_cvt_pk_bf16_f32 v196, v168, v169
v_cvt_pk_bf16_f32 v197, v170, v171
s_waitcnt lgkmcnt(1)
s_waitcnt vmcnt(20)
s_barrier
Mvaa 164,244,164
Ba 224,16,16384
s_add_u32 m0, s35, 0xc000
v_exp_f32 v176, v176
Mvaa 172,244,180
s_add_u32 s44, s38, 0xe000
v_exp_f32 v177, v177
Mvaa 188,244,212
s_add_u32 s98, s16, s44
s_addc_u32 s99, s17, 0
v_exp_f32 v178, v178
Mvaa 180,244,196
GDMA 28,98,0
v_exp_f32 v179, v179
Mvaa 164,248,168
Ba 228,17,16384
GDMA 29,98,1024
v_cvt_pk_bf16_f32 v200, v176, v177
v_cvt_pk_bf16_f32 v201, v178, v179
Mvaa 172,248,184
v_exp_f32 v184, v184
Mvaa 188,248,216
v_exp_f32 v185, v185
Mvaa 180,248,200
v_exp_f32 v186, v186
s_waitcnt lgkmcnt(1)
Mvaa 164,252,172
Ba 232,18,16384
GDMA 30,98,2048
v_exp_f32 v187, v187
Mvaa 172,252,188
v_cvt_pk_bf16_f32 v204, v184, v185
v_cvt_pk_bf16_f32 v205, v186, v187
Mvaa 188,252,220
Mvaa 180,252,204
Zvaa 160,224,160
Ba 236,19,16384
GDMA 31,98,3072
Zvaa 168,224,176
v_exp_f32 v164, v164
v_exp_f32 v165, v165
v_exp_f32 v166, v166
v_exp_f32 v167, v167
Zvaa 184,224,208
v_cvt_pk_bf16_f32 v194, v164, v165
v_cvt_pk_bf16_f32 v195, v166, v167
Zvaa 176,224,192
v_exp_f32 v172, v172
s_waitcnt lgkmcnt(1)
Mvaa 160,228,164
Ba 240,16,20480
v_exp_f32 v173, v173
Mvaa 168,228,180
v_exp_f32 v174, v174
Mvaa 184,228,212
v_exp_f32 v175, v175
Mvaa 176,228,196
v_cvt_pk_bf16_f32 v198, v172, v173
v_cvt_pk_bf16_f32 v199, v174, v175
Mvaa 160,232,168
Ba 244,17,20480
v_exp_f32 v180, v180
Mvaa 168,232,184
v_exp_f32 v181, v181
Mvaa 184,232,216
v_exp_f32 v182, v182
Mvaa 176,232,200
v_exp_f32 v183, v183
s_waitcnt lgkmcnt(1)
Mvaa 160,236,172
Ba 248,18,20480
v_cvt_pk_bf16_f32 v202, v180, v181
v_cvt_pk_bf16_f32 v203, v182, v183
Mvaa 168,236,188
v_exp_f32 v188, v188
Mvaa 184,236,220
v_exp_f32 v189, v189
Mvaa 176,236,204
v_exp_f32 v190, v190
Zvaa 164,240,160
Ba 252,19,20480
v_exp_f32 v191, v191
Zvaa 172,240,176
v_cvt_pk_bf16_f32 v206, v188, v189
v_cvt_pk_bf16_f32 v207, v190, v191
Zvaa 188,240,208
v_exp_f32 v160, v160
Zvaa 180,240,192
v_accvgpr_read_b32 v224, a4
s_waitcnt lgkmcnt(1)
Mvaa 164,244,164
v_exp_f32 v161, v161
Mvaa 172,244,180
v_exp_f32 v162, v162
Mvaa 188,244,212
v_exp_f32 v163, v163
Mvaa 180,244,196
v_cvt_pk_bf16_f32 v208, v160, v161
v_cvt_pk_bf16_f32 v209, v162, v163
Mvaa 164,248,168
Ta 224,20,8192
Ta 226,20,12288
Mvaa 172,248,184
v_exp_f32 v168, v168
Mvaa 188,248,216
v_exp_f32 v169, v169
Mvaa 180,248,200
v_accvgpr_read_b32 v225, a5
s_waitcnt lgkmcnt(0)
Mvaa 164,252,172
Ta 228,21,8192
Ta 230,21,12288
Mvaa 172,252,188
v_exp_f32 v170, v170
Mvaa 188,252,220
v_exp_f32 v171, v171
Mvaa 180,252,204
v_cvt_pk_bf16_f32 v212, v168, v169
v_cvt_pk_bf16_f32 v213, v170, v171
Zaav 128,144,192
Ta 232,22,8192
Ta 234,22,12288
Zaav 132,144,196
v_exp_f32 v176, v176
Zaav 136,144,200
v_exp_f32 v177, v177
Zaav 140,144,204
v_exp_f32 v178, v178
Zvav 96,224,200
Ta 236,23,8192
Ta 238,23,12288
Zvav 128,224,204
v_exp_f32 v179, v179
Zvav 64,224,196
v_cvt_pk_bf16_f32 v216, v176, v177
v_cvt_pk_bf16_f32 v217, v178, v179
Zvav 32,224,192
v_accvgpr_read_b32 v226, a6
s_waitcnt lgkmcnt(2)
Zvav 36,228,192
Ta 240,24,8192
Ta 242,24,12288
Zvav 68,228,196
v_exp_f32 v184, v184
Zvav 132,228,204
v_exp_f32 v185, v185
Zvav 100,228,200
v_exp_f32 v186, v186
Zvav 104,232,200
Ta 244,25,8192
Ta 246,25,12288
Zvav 136,232,204
v_exp_f32 v187, v187
Zvav 72,232,196
v_cvt_pk_bf16_f32 v220, v184, v185
v_cvt_pk_bf16_f32 v221, v186, v187
Zvav 40,232,192
v_accvgpr_read_b32 v227, a7
s_waitcnt lgkmcnt(2)
Zvav 44,236,192
Ta 248,26,8192
Ta 250,26,12288
Zvav 76,236,196
v_exp_f32 v164, v164
Zvav 140,236,204
v_exp_f32 v165, v165
Zvav 108,236,200
v_exp_f32 v166, v166
Zvav 112,240,200
Ta 252,27,8192
Ta 254,27,12288
Zvav 144,240,204
v_exp_f32 v167, v167
Zvav 80,240,196
v_cvt_pk_bf16_f32 v210, v164, v165
v_cvt_pk_bf16_f32 v211, v166, v167
Zvav 48,240,192
s_waitcnt lgkmcnt(2)
s_waitcnt vmcnt(20)
s_barrier
Zvav 52,244,192
Ba 224,16,32768
v_accvgpr_read_b32 v228, a12
Zvav 84,244,196
v_exp_f32 v172, v172
Zvav 148,244,204
v_exp_f32 v173, v173
Zvav 116,244,200
v_exp_f32 v174, v174
Zvav 120,248,200
Ba 228,17,32768
v_accvgpr_read_b32 v229, a13
Zvav 152,248,204
v_exp_f32 v175, v175
Zvav 88,248,196
v_cvt_pk_bf16_f32 v214, v172, v173
v_cvt_pk_bf16_f32 v215, v174, v175
Zvav 56,248,192
v_accvgpr_read_b32 v230, a14
s_waitcnt lgkmcnt(1)
Zvav 60,252,192
Ba 232,18,32768
v_accvgpr_read_b32 v231, a15
Zvav 92,252,196
v_exp_f32 v180, v180
Zvav 156,252,204
v_exp_f32 v181, v181
Zvav 124,252,200
v_exp_f32 v182, v182
Zvaa 160,224,160
Ba 236,19,32768
v_cvt_pk_bf16_f32 v224, v224, v225
Zvaa 168,224,176
v_exp_f32 v183, v183
Zvaa 184,224,208
v_cvt_pk_bf16_f32 v218, v180, v181
v_cvt_pk_bf16_f32 v219, v182, v183
Zvaa 176,224,192
v_cvt_pk_bf16_f32 v225, v226, v227
s_waitcnt lgkmcnt(1)
Mvaa 160,228,164
Ba 240,16,36864
v_cvt_pk_bf16_f32 v226, v228, v229
Mvaa 168,228,180
v_exp_f32 v188, v188
Mvaa 184,228,212
v_exp_f32 v189, v189
Mvaa 176,228,196
v_exp_f32 v190, v190
Mvaa 160,232,168
Ba 244,17,36864
v_cvt_pk_bf16_f32 v227, v230, v231
Mvaa 168,232,184
v_exp_f32 v191, v191
Mvaa 184,232,216
v_cvt_pk_bf16_f32 v222, v188, v189
v_cvt_pk_bf16_f32 v223, v190, v191
Mvaa 176,232,200
s_waitcnt lgkmcnt(1)
Mvaa 160,236,172
Ba 248,18,36864
Mvaa 168,236,188
v_permlane32_swap_b32 v224, v226
Mvaa 184,236,220
v_permlane32_swap_b32 v225, v227
Mvaa 176,236,204
v_permlane16_swap_b32 v224, v226
Zvaa 164,240,160
Ba 252,19,36864
Zvaa 172,240,176
v_exp_f32 v160, v160
Zvaa 188,240,208
v_exp_f32 v161, v161
Zvaa 180,240,192
s_waitcnt lgkmcnt(1)
Mvaa 164,244,164
v_exp_f32 v162, v162
Mvaa 172,244,180
v_exp_f32 v163, v163
Mvaa 188,244,212
v_cvt_pk_bf16_f32 v192, v160, v161
v_cvt_pk_bf16_f32 v193, v162, v163
Mvaa 180,244,196
v_exp_f32 v168, v168
Mvaa 164,248,168
Ta 224,20,24576
Ta 226,20,28672
Mvaa 172,248,184
v_exp_f32 v169, v169
Mvaa 188,248,216
v_exp_f32 v170, v170
Mvaa 180,248,200
s_waitcnt lgkmcnt(0)
Mvaa 164,252,172
Ta 228,21,24576
Ta 230,21,28672
Mvaa 172,252,188
v_exp_f32 v171, v171
Mvaa 188,252,220
v_cvt_pk_bf16_f32 v196, v168, v169
v_cvt_pk_bf16_f32 v197, v170, v171
Mvaa 180,252,204
v_exp_f32 v176, v176
Maav 128,144,208
Ta 232,22,24576
Ta 234,22,28672
Maav 132,144,212
v_exp_f32 v177, v177
Maav 136,144,216
v_exp_f32 v178, v178
Maav 140,144,220
v_exp_f32 v179, v179
Mvav 96,224,216
Ta 236,23,24576
Ta 238,23,28672
Mvav 128,224,220
v_permlane16_swap_b32 v225, v227
Mvav 64,224,212
v_cvt_pk_bf16_f32 v200, v176, v177
v_cvt_pk_bf16_f32 v201, v178, v179
Mvav 32,224,208
v_accvgpr_write_b32 a4, v224
s_waitcnt lgkmcnt(2)
Mvav 36,228,208
Ta 240,24,24576
Ta 242,24,28672
Mvav 68,228,212
v_exp_f32 v184, v184
Mvav 132,228,220
v_exp_f32 v185, v185
Mvav 100,228,216
v_exp_f32 v186, v186
Mvav 104,232,216
Ta 244,25,24576
Ta 246,25,28672
Mvav 136,232,220
v_exp_f32 v187, v187
Mvav 72,232,212
v_cvt_pk_bf16_f32 v204, v184, v185
v_cvt_pk_bf16_f32 v205, v186, v187
Mvav 40,232,208
v_accvgpr_write_b32 a5, v225
s_waitcnt lgkmcnt(2)
Mvav 44,236,208
Ta 248,26,24576
Ta 250,26,28672
Mvav 76,236,212
v_exp_f32 v164, v164
Mvav 140,236,220
v_exp_f32 v165, v165
Mvav 108,236,216
v_exp_f32 v166, v166
Mvav 112,240,216
Ta 252,27,24576
Ta 254,27,28672
Mvav 144,240,220
v_exp_f32 v167, v167
Mvav 80,240,212
v_cvt_pk_bf16_f32 v194, v164, v165
v_cvt_pk_bf16_f32 v195, v166, v167
Mvav 48,240,208
s_waitcnt lgkmcnt(2)
s_waitcnt vmcnt(16)
s_barrier
Mvav 52,244,208
Ba 224,16,49152
s_add_u32 m0, s35, 0x10000
Mvav 84,244,212
s_add_u32 s44, s38, 0x10000
v_accvgpr_write_b32 a6, v226
Mvav 148,244,220
s_add_u32 s98, s16, s44
s_addc_u32 s99, s17, 0
Mvav 116,244,216
GDMA 28,98,0
v_accvgpr_write_b32 a7, v227
Mvav 120,248,216
Ba 228,17,49152
GDMA 29,98,1024
Mvav 152,248,220
v_exp_f32 v172, v172
Mvav 88,248,212
v_exp_f32 v173, v173
Mvav 56,248,208
v_accvgpr_read_b32 v224, a0
s_waitcnt lgkmcnt(1)
Mvav 60,252,208
Ba 232,18,49152
GDMA 30,98,2048
Mvav 92,252,212
v_exp_f32 v174, v174
Mvav 156,252,220
v_exp_f32 v175, v175
Mvav 124,252,216
v_cvt_pk_bf16_f32 v198, v172, v173
v_cvt_pk_bf16_f32 v199, v174, v175
Zvaa 160,224,160
Ba 236,19,49152
GDMA 31,98,3072
Zvaa 168,224,176
v_exp_f32 v180, v180
Zvaa 184,224,208
v_exp_f32 v181, v181
Zvaa 176,224,192
v_accvgpr_read_b32 v225, a1
s_waitcnt lgkmcnt(1)
Mvaa 160,228,164
Ba 240,16,53248
v_xor_b32 v16, 0x10000, v16
Mvaa 168,228,180
v_exp_f32 v182, v182
Mvaa 184,228,212
v_exp_f32 v183, v183
Mvaa 176,228,196
v_cvt_pk_bf16_f32 v202, v180, v181
v_cvt_pk_bf16_f32 v203, v182, v183
Mvaa 160,232,168
Ba 244,17,53248
v_xor_b32 v17, 0x10000, v17
Mvaa 168,232,184
v_exp_f32 v188, v188
Mvaa 184,232,216
v_exp_f32 v189, v189
Mvaa 176,232,200
v_accvgpr_read_b32 v226, a2
s_waitcnt lgkmcnt(1)
Mvaa 160,236,172
Ba 248,18,53248
v_xor_b32 v18, 0x10000, v18
Mvaa 168,236,188
v_exp_f32 v190, v190
Mvaa 184,236,220
v_exp_f32 v191, v191
Mvaa 176,236,204
v_cvt_pk_bf16_f32 v206, v188, v189
v_cvt_pk_bf16_f32 v207, v190, v191
Zvaa 164,240,160
Ba 252,19,53248
v_xor_b32 v19, 0x10000, v19
Zvaa 172,240,176
v_exp_f32 v160, v160
Zvaa 188,240,208
v_exp_f32 v161, v161
Zvaa 180,240,192
v_accvgpr_read_b32 v227, a3
s_waitcnt lgkmcnt(1)
Mvaa 164,244,164
v_exp_f32 v162, v162
Mvaa 172,244,180
v_exp_f32 v163, v163
Mvaa 188,244,212
v_cvt_pk_bf16_f32 v208, v160, v161
v_cvt_pk_bf16_f32 v209, v162, v163
Mvaa 180,244,196
v_exp_f32 v168, v168
Mvaa 164,248,168
Ta 224,20,40960
Ta 226,20,45056
Mvaa 172,248,184
v_exp_f32 v169, v169
Mvaa 188,248,216
v_exp_f32 v170, v170
Mvaa 180,248,200
v_accvgpr_read_b32 v228, a8
s_waitcnt lgkmcnt(0)
Mvaa 164,252,172
Ta 228,21,40960
Ta 230,21,45056
Mvaa 172,252,188
v_exp_f32 v171, v171
Mvaa 188,252,220
v_cvt_pk_bf16_f32 v212, v168, v169
v_cvt_pk_bf16_f32 v213, v170, v171
Mvaa 180,252,204
v_exp_f32 v176, v176
Maav 128,144,192
Ta 232,22,40960
Ta 234,22,45056
Maav 132,144,196
v_exp_f32 v177, v177
Maav 136,144,200
v_exp_f32 v178, v178
Maav 140,144,204
v_exp_f32 v179, v179
Mvav 96,224,200
Ta 236,23,40960
v_cvt_pk_bf16_f32 v216, v176, v177
Mvav 128,224,204
Ta 238,23,45056
v_cvt_pk_bf16_f32 v217, v178, v179
Mvav 64,224,196
v_exp_f32 v184, v184
Mvav 32,224,192
v_accvgpr_read_b32 v229, a9
s_waitcnt lgkmcnt(2)
Mvav 36,228,192
Ta 240,24,40960
Ta 242,24,45056
Mvav 68,228,196
v_exp_f32 v185, v185
Mvav 132,228,204
v_exp_f32 v186, v186
Mvav 100,228,200
v_exp_f32 v187, v187
Mvav 104,232,200
Ta 244,25,40960
v_cvt_pk_bf16_f32 v220, v184, v185
Mvav 136,232,204
Ta 246,25,45056
v_cvt_pk_bf16_f32 v221, v186, v187
Mvav 72,232,196
v_exp_f32 v164, v164
Mvav 40,232,192
v_accvgpr_read_b32 v230, a10
s_waitcnt lgkmcnt(2)
Mvav 44,236,192
Ta 248,26,40960
Ta 250,26,45056
Mvav 76,236,196
v_exp_f32 v165, v165
Mvav 140,236,204
v_exp_f32 v166, v166
Mvav 108,236,200
v_exp_f32 v167, v167
Mvav 112,240,200
Ta 252,27,40960
v_cvt_pk_bf16_f32 v210, v164, v165
Mvav 144,240,204
Ta 254,27,45056
v_cvt_pk_bf16_f32 v211, v166, v167
Mvav 80,240,196
v_exp_f32 v172, v172
Mvav 48,240,192
s_waitcnt lgkmcnt(2)
s_waitcnt vmcnt(16)
s_barrier
Mvav 52,244,192
Ba 224,16,0
s_add_u32 m0, s35, 0x14000
Mvav 84,244,196
s_add_u32 s44, s38, 0x12000
v_accvgpr_read_b32 v231, a11
Mvav 148,244,204
s_add_u32 s98, s16, s44
s_addc_u32 s99, s17, 0
Mvav 116,244,200
GDMA 28,98,0
v_cvt_pk_bf16_f32 v224, v224, v225
Mvav 120,248,200
Ba 228,17,0
GDMA 29,98,1024
Mvav 152,248,204
v_exp_f32 v173, v173
Mvav 88,248,196
v_exp_f32 v174, v174
Mvav 56,248,192
v_cvt_pk_bf16_f32 v225, v226, v227
s_waitcnt lgkmcnt(1)
Mvav 60,252,192
Ba 232,18,0
GDMA 30,98,2048
Mvav 92,252,196
v_exp_f32 v175, v175
Mvav 156,252,204
v_cvt_pk_bf16_f32 v214, v172, v173
v_cvt_pk_bf16_f32 v215, v174, v175
Mvav 124,252,200
v_exp_f32 v180, v180
Zvaa 160,224,160
Ba 236,19,0
GDMA 31,98,3072
Zvaa 168,224,176
v_exp_f32 v181, v181
Zvaa 184,224,208
v_exp_f32 v182, v182
Zvaa 176,224,192
v_cvt_pk_bf16_f32 v226, v228, v229
s_waitcnt lgkmcnt(1)
Mvaa 160,228,164
Ba 240,16,4096
v_cvt_pk_bf16_f32 v227, v230, v231
Mvaa 168,228,180
v_exp_f32 v183, v183
Mvaa 184,228,212
v_cvt_pk_bf16_f32 v218, v180, v181
v_cvt_pk_bf16_f32 v219, v182, v183
Mvaa 176,228,196
v_exp_f32 v188, v188
Mvaa 160,232,168
Ba 244,17,4096
Mvaa 168,232,184
v_exp_f32 v189, v189
Mvaa 184,232,216
v_exp_f32 v190, v190
Mvaa 176,232,200
s_waitcnt lgkmcnt(1)
Mvaa 160,236,172
Ba 248,18,4096
Mvaa 168,236,188
v_exp_f32 v191, v191
Mvaa 184,236,220
v_cvt_pk_bf16_f32 v222, v188, v189
v_cvt_pk_bf16_f32 v223, v190, v191
Mvaa 176,236,204
v_permlane32_swap_b32 v224, v226
Zvaa 164,240,160
Ba 252,19,4096
Zvaa 172,240,176
v_exp_f32 v160, v160
Zvaa 188,240,208
v_exp_f32 v161, v161
Zvaa 180,240,192
s_waitcnt lgkmcnt(1)
Mvaa 164,244,164
v_exp_f32 v162, v162
Mvaa 172,244,180
v_exp_f32 v163, v163
Mvaa 188,244,212
v_cvt_pk_bf16_f32 v192, v160, v161
v_cvt_pk_bf16_f32 v193, v162, v163
Mvaa 180,244,196
v_exp_f32 v168, v168
Mvaa 164,248,168
Ta 224,20,57344
Ta 226,20,61440
Mvaa 172,248,184
v_exp_f32 v169, v169
Mvaa 188,248,216
v_xor_b32 v20, 0x10000, v20
Mvaa 180,248,200
s_waitcnt lgkmcnt(0)
Mvaa 164,252,172
Ta 228,21,57344
Ta 230,21,61440
Mvaa 172,252,188
v_exp_f32 v170, v170
Mvaa 188,252,220
v_xor_b32 v21, 0x10000, v21
Mvaa 180,252,204
v_exp_f32 v171, v171
Maav 128,144,208
Ta 232,22,57344
Ta 234,22,61440
Maav 132,144,212
v_permlane32_swap_b32 v225, v227
Maav 136,144,216
v_xor_b32 v22, 0x10000, v22
v_cvt_pk_bf16_f32 v196, v168, v169
Maav 140,144,220
v_cvt_pk_bf16_f32 v197, v170, v171
Mvav 96,224,216
Ta 236,23,57344
Ta 238,23,61440
Mvav 128,224,220
v_exp_f32 v176, v176
Mvav 64,224,212
v_xor_b32 v23, 0x10000, v23
Mvav 32,224,208
s_waitcnt lgkmcnt(2)
Mvav 36,228,208
Ta 240,24,57344
Ta 242,24,61440
Mvav 68,228,212
v_exp_f32 v177, v177
Mvav 132,228,220
v_xor_b32 v24, 0x10000, v24
Mvav 100,228,216
v_exp_f32 v178, v178
Mvav 104,232,216
Ta 244,25,57344
Ta 246,25,61440
Mvav 136,232,220
v_exp_f32 v179, v179
Mvav 72,232,212
v_xor_b32 v25, 0x10000, v25
v_cvt_pk_bf16_f32 v200, v176, v177
Mvav 40,232,208
v_cvt_pk_bf16_f32 v201, v178, v179
s_waitcnt lgkmcnt(2)
Mvav 44,236,208
Ta 248,26,57344
Ta 250,26,61440
Mvav 76,236,212
v_exp_f32 v184, v184
Mvav 140,236,220
v_xor_b32 v26, 0x10000, v26
Mvav 108,236,216
v_exp_f32 v185, v185
Mvav 112,240,216
Ta 252,27,57344
Ta 254,27,61440
Mvav 144,240,220
v_exp_f32 v186, v186
Mvav 80,240,212
v_xor_b32 v27, 0x10000, v27
Mvav 48,240,208
s_waitcnt lgkmcnt(2)
s_waitcnt vmcnt(16)
s_barrier
Mvav 52,244,208
Ba 224,16,16384
s_add_u32 m0, s35, 0x18000
Mvav 84,244,212
s_add_u32 s44, s38, 0x14000
Mvav 148,244,220
s_add_u32 s98, s16, s44
s_addc_u32 s99, s17, 0
Mvav 116,244,216
GDMA 28,98,0
Mvav 120,248,216
Ba 228,17,16384
GDMA 29,98,1024
Mvav 152,248,220
v_exp_f32 v187, v187
Mvav 88,248,212
v_cvt_pk_bf16_f32 v204, v184, v185
v_cvt_pk_bf16_f32 v205, v186, v187
Mvav 56,248,208
s_waitcnt lgkmcnt(1)
Mvav 60,252,208
Ba 232,18,16384
GDMA 30,98,2048
Mvav 92,252,212
v_exp_f32 v164, v164
Mvav 156,252,220
v_exp_f32 v165, v165
Mvav 124,252,216
v_exp_f32 v166, v166
Zvaa 160,224,160
Ba 236,19,16384
GDMA 31,98,3072
Zvaa 168,224,176
v_exp_f32 v167, v167
Zvaa 184,224,208
v_cvt_pk_bf16_f32 v194, v164, v165
v_cvt_pk_bf16_f32 v195, v166, v167
Zvaa 176,224,192
v_exp_f32 v172, v172
s_waitcnt lgkmcnt(1)
Mvaa 160,228,164
Ba 240,16,20480
v_exp_f32 v173, v173
Mvaa 168,228,180
v_exp_f32 v174, v174
Mvaa 184,228,212
v_exp_f32 v175, v175
Mvaa 176,228,196
v_cvt_pk_bf16_f32 v198, v172, v173
v_cvt_pk_bf16_f32 v199, v174, v175
Mvaa 160,232,168
Ba 244,17,20480
v_exp_f32 v180, v180
Mvaa 168,232,184
v_exp_f32 v181, v181
Mvaa 184,232,216
v_exp_f32 v182, v182
Mvaa 176,232,200
v_exp_f32 v183, v183
s_waitcnt lgkmcnt(1)
Mvaa 160,236,172
Ba 248,18,20480
v_cvt_pk_bf16_f32 v202, v180, v181
v_cvt_pk_bf16_f32 v203, v182, v183
Mvaa 168,236,188
v_exp_f32 v188, v188
Mvaa 184,236,220
v_exp_f32 v189, v189
Mvaa 176,236,204
v_exp_f32 v190, v190
Zvaa 164,240,160
Ba 252,19,20480
v_exp_f32 v191, v191
Zvaa 172,240,176
v_cvt_pk_bf16_f32 v206, v188, v189
v_cvt_pk_bf16_f32 v207, v190, v191
Zvaa 188,240,208
v_exp_f32 v160, v160
Zvaa 180,240,192
s_waitcnt lgkmcnt(1)
Mvaa 164,244,164
v_exp_f32 v161, v161
Mvaa 172,244,180
v_exp_f32 v162, v162
Mvaa 188,244,212
v_exp_f32 v163, v163
Mvaa 180,244,196
v_cvt_pk_bf16_f32 v208, v160, v161
v_cvt_pk_bf16_f32 v209, v162, v163
Mvaa 164,248,168
Ta 224,20,8192
Ta 226,20,12288
Mvaa 172,248,184
v_exp_f32 v168, v168
Mvaa 188,248,216
v_exp_f32 v169, v169
Mvaa 180,248,200
s_waitcnt lgkmcnt(0)
Mvaa 164,252,172
Ta 228,21,8192
Ta 230,21,12288
Mvaa 172,252,188
v_exp_f32 v170, v170
Mvaa 188,252,220
v_exp_f32 v171, v171
Mvaa 180,252,204
v_cvt_pk_bf16_f32 v212, v168, v169
v_cvt_pk_bf16_f32 v213, v170, v171
Maav 128,144,192
Ta 232,22,8192
Ta 234,22,12288
Maav 132,144,196
v_exp_f32 v176, v176
Maav 136,144,200
v_exp_f32 v177, v177
Maav 140,144,204
v_exp_f32 v178, v178
Mvav 96,224,200
Ta 236,23,8192
Ta 238,23,12288
Mvav 128,224,204
v_exp_f32 v179, v179
Mvav 64,224,196
v_cvt_pk_bf16_f32 v216, v176, v177
v_cvt_pk_bf16_f32 v217, v178, v179
Mvav 32,224,192
s_waitcnt lgkmcnt(2)
Mvav 36,228,192
Ta 240,24,8192
Ta 242,24,12288
Mvav 68,228,196
v_exp_f32 v184, v184
Mvav 132,228,204
v_exp_f32 v185, v185
Mvav 100,228,200
v_exp_f32 v186, v186
Mvav 104,232,200
Ta 244,25,8192
Ta 246,25,12288
Mvav 136,232,204
v_exp_f32 v187, v187
Mvav 72,232,196
v_cvt_pk_bf16_f32 v220, v184, v185
v_cvt_pk_bf16_f32 v221, v186, v187
Mvav 40,232,192
s_waitcnt lgkmcnt(2)
Mvav 44,236,192
Ta 248,26,8192
Ta 250,26,12288
Mvav 76,236,196
v_exp_f32 v164, v164
Mvav 140,236,204
v_exp_f32 v165, v165
Mvav 108,236,200
v_exp_f32 v166, v166
Mvav 112,240,200
Ta 252,27,8192
Ta 254,27,12288
Mvav 144,240,204
v_exp_f32 v167, v167
Mvav 80,240,196
v_cvt_pk_bf16_f32 v210, v164, v165
v_cvt_pk_bf16_f32 v211, v166, v167
Mvav 48,240,192
s_waitcnt lgkmcnt(2)
s_waitcnt vmcnt(16)
s_barrier
Mvav 52,244,192
Ba 224,16,32768
s_add_u32 m0, s35, 0x1c000
Mvav 84,244,196
s_add_u32 s44, s38, 0x16000
Mvav 148,244,204
s_add_u32 s98, s16, s44
s_addc_u32 s99, s17, 0
Mvav 116,244,200
GDMA 28,98,0
Mvav 120,248,200
Ba 228,17,32768
GDMA 29,98,1024
Mvav 152,248,204
v_exp_f32 v172, v172
Mvav 88,248,196
v_exp_f32 v173, v173
Mvav 56,248,192
s_waitcnt lgkmcnt(1)
Mvav 60,252,192
Ba 232,18,32768
GDMA 30,98,2048
Mvav 92,252,196
v_exp_f32 v174, v174
Mvav 156,252,204
v_exp_f32 v175, v175
Mvav 124,252,200
v_cvt_pk_bf16_f32 v214, v172, v173
v_cvt_pk_bf16_f32 v215, v174, v175
Zvaa 160,224,160
Ba 236,19,32768
GDMA 31,98,3072
Zvaa 168,224,176
v_exp_f32 v180, v180
Zvaa 184,224,208
v_exp_f32 v181, v181
Zvaa 176,224,192
v_mov_b32 v248, -1
s_waitcnt lgkmcnt(1)
Mvaa 160,228,164
Ba 240,16,36864
v_mov_b32 v249, -1
Mvaa 168,228,180
v_exp_f32 v182, v182
Mvaa 184,228,212
v_exp_f32 v183, v183
Mvaa 176,228,196
v_cvt_pk_bf16_f32 v218, v180, v181
v_cvt_pk_bf16_f32 v219, v182, v183
Mvaa 160,232,168
Ba 244,17,36864
v_mov_b32 v250, -1
Mvaa 168,232,184
v_exp_f32 v188, v188
Mvaa 184,232,216
v_exp_f32 v189, v189
Mvaa 176,232,200
v_mov_b32 v251, -1
s_waitcnt lgkmcnt(1)
Mvaa 160,236,172
Ba 248,18,36864
v_lshlrev_b32 v252, 4, v1
Mvaa 168,236,188
v_exp_f32 v190, v190
Mvaa 184,236,220
v_exp_f32 v191, v191
Mvaa 176,236,204
v_cvt_pk_bf16_f32 v222, v188, v189
v_cvt_pk_bf16_f32 v223, v190, v191
Zvaa 164,240,160
Ba 252,19,36864
s_add_u32 s48, s47, 0x7000
Zvaa 172,240,176
v_exp_f32 v160, v160
Zvaa 188,240,208
v_exp_f32 v161, v161
Zvaa 180,240,192
s_waitcnt lgkmcnt(1)
Mvaa 164,244,164
v_exp_f32 v162, v162
Mvaa 172,244,180
v_exp_f32 v163, v163
Mvaa 188,244,212
v_cvt_pk_bf16_f32 v192, v160, v161
v_cvt_pk_bf16_f32 v193, v162, v163
Mvaa 180,244,196
v_exp_f32 v168, v168
Mvaa 164,248,168
Ta 224,20,24576
Ta 226,20,28672
Mvaa 172,248,184
v_exp_f32 v169, v169
Mvaa 188,248,216
v_exp_f32 v170, v170
Mvaa 180,248,200
s_waitcnt lgkmcnt(0)
Mvaa 164,252,172
Ta 228,21,24576
Ta 230,21,28672
Mvaa 172,252,188
v_exp_f32 v171, v171
Mvaa 188,252,220
v_cvt_pk_bf16_f32 v196, v168, v169
v_cvt_pk_bf16_f32 v197, v170, v171
Mvaa 180,252,204
v_exp_f32 v176, v176
Maav 128,144,208
Ta 232,22,24576
Ta 234,22,28672
Maav 132,144,212
v_exp_f32 v177, v177
Maav 136,144,216
v_exp_f32 v178, v178
Maav 140,144,220
v_exp_f32 v179, v179
Mvav 96,224,216
Ta 236,23,24576
Ta 238,23,28672
Mvav 128,224,220
v_permlane16_swap_b32 v224, v226
Mvav 64,224,212
v_cvt_pk_bf16_f32 v200, v176, v177
v_cvt_pk_bf16_f32 v201, v178, v179
Mvav 32,224,208
s_waitcnt lgkmcnt(2)
Mvav 36,228,208
Ta 240,24,24576
Ta 242,24,28672
Mvav 68,228,212
v_exp_f32 v184, v184
Mvav 132,228,220
v_exp_f32 v185, v185
Mvav 100,228,216
v_exp_f32 v186, v186
Mvav 104,232,216
Ta 244,25,24576
Ta 246,25,28672
Mvav 136,232,220
v_exp_f32 v187, v187
Mvav 72,232,212
v_cvt_pk_bf16_f32 v204, v184, v185
v_cvt_pk_bf16_f32 v205, v186, v187
Mvav 40,232,208
s_waitcnt lgkmcnt(2)
Mvav 44,236,208
Ta 248,26,24576
Ta 250,26,28672
Mvav 76,236,212
v_exp_f32 v164, v164
Mvav 140,236,220
v_exp_f32 v165, v165
Mvav 108,236,216
v_exp_f32 v166, v166
Mvav 112,240,216
Ta 252,27,24576
Ta 254,27,28672
Mvav 144,240,220
v_exp_f32 v167, v167
Mvav 80,240,212
v_cvt_pk_bf16_f32 v194, v164, v165
v_cvt_pk_bf16_f32 v195, v166, v167
Mvav 48,240,208
s_waitcnt lgkmcnt(2)
s_waitcnt vmcnt(16)
s_barrier
Mvav 52,244,208
Ba 224,16,49152
s_mov_b32 m0, s35
Mvav 84,244,212
s_add_u32 s44, s38, 0x18000
Mvav 148,244,220
s_add_u32 s98, s16, s44
s_addc_u32 s99, s17, 0
Mvav 116,244,216
GDMA 28,98,0
Mvav 120,248,216
Ba 228,17,49152
GDMA 29,98,1024
Mvav 152,248,220
buffer_store_dwordx4 v[248:251], v252, s[28:31], s48 offen offset:0 sc1
Mvav 88,248,212
v_exp_f32 v172, v172
Mvav 56,248,208
s_waitcnt lgkmcnt(1)
Mvav 60,252,208
Ba 232,18,49152
GDMA 30,98,2048
Mvav 92,252,212
v_exp_f32 v173, v173
Mvav 156,252,220
v_exp_f32 v174, v174
Mvav 124,252,216
v_exp_f32 v175, v175
Zvaa 160,224,160
Ba 236,19,49152
GDMA 31,98,3072
Zvaa 168,224,176
v_cvt_pk_bf16_f32 v198, v172, v173
v_cvt_pk_bf16_f32 v199, v174, v175
Zvaa 184,224,208
v_exp_f32 v180, v180
Zvaa 176,224,192
s_waitcnt lgkmcnt(1)
Mvaa 160,228,164
Ba 240,16,53248
v_xor_b32 v16, 0x10000, v16
Mvaa 168,228,180
v_exp_f32 v181, v181
Mvaa 184,228,212
v_exp_f32 v182, v182
Mvaa 176,228,196
v_exp_f32 v183, v183
Mvaa 160,232,168
Ba 244,17,53248
v_xor_b32 v17, 0x10000, v17
Mvaa 168,232,184
v_cvt_pk_bf16_f32 v202, v180, v181
v_cvt_pk_bf16_f32 v203, v182, v183
Mvaa 184,232,216
v_exp_f32 v188, v188
Mvaa 176,232,200
s_waitcnt lgkmcnt(1)
Mvaa 160,236,172
Ba 248,18,53248
v_xor_b32 v18, 0x10000, v18
Mvaa 168,236,188
v_exp_f32 v189, v189
Mvaa 184,236,220
v_exp_f32 v190, v190
Mvaa 176,236,204
v_exp_f32 v191, v191
Zvaa 164,240,160
Ba 252,19,53248
v_xor_b32 v19, 0x10000, v19
Zvaa 172,240,176
v_cvt_pk_bf16_f32 v206, v188, v189
v_cvt_pk_bf16_f32 v207, v190, v191
Zvaa 188,240,208
v_exp_f32 v160, v160
Zvaa 180,240,192
s_waitcnt lgkmcnt(1)
Mvaa 164,244,164
v_exp_f32 v161, v161
Mvaa 172,244,180
v_exp_f32 v162, v162
Mvaa 188,244,212
v_exp_f32 v163, v163
Mvaa 180,244,196
v_cvt_pk_bf16_f32 v208, v160, v161
v_cvt_pk_bf16_f32 v209, v162, v163
Mvaa 164,248,168
Ta 224,20,40960
Ta 226,20,45056
Mvaa 172,248,184
v_exp_f32 v168, v168
Mvaa 188,248,216
v_exp_f32 v169, v169
Mvaa 180,248,200
s_waitcnt lgkmcnt(0)
Mvaa 164,252,172
Ta 228,21,40960
Ta 230,21,45056
Mvaa 172,252,188
v_exp_f32 v170, v170
Mvaa 188,252,220
v_exp_f32 v171, v171
Mvaa 180,252,204
v_cvt_pk_bf16_f32 v212, v168, v169
v_cvt_pk_bf16_f32 v213, v170, v171
Maav 128,144,192
Ta 232,22,40960
Ta 234,22,45056
Maav 132,144,196
v_exp_f32 v176, v176
Maav 136,144,200
v_exp_f32 v177, v177
Maav 140,144,204
v_exp_f32 v178, v178
Mvav 96,224,200
Ta 236,23,40960
Ta 238,23,45056
Mvav 128,224,204
v_exp_f32 v179, v179
Mvav 64,224,196
v_cvt_pk_bf16_f32 v216, v176, v177
v_cvt_pk_bf16_f32 v217, v178, v179
Mvav 32,224,192
s_waitcnt lgkmcnt(2)
Mvav 36,228,192
Ta 240,24,40960
Ta 242,24,45056
Mvav 68,228,196
v_exp_f32 v184, v184
Mvav 132,228,204
v_exp_f32 v185, v185
Mvav 100,228,200
v_exp_f32 v186, v186
Mvav 104,232,200
Ta 244,25,40960
Ta 246,25,45056
Mvav 136,232,204
v_exp_f32 v187, v187
Mvav 72,232,196
v_cvt_pk_bf16_f32 v220, v184, v185
v_cvt_pk_bf16_f32 v221, v186, v187
Mvav 40,232,192
s_waitcnt lgkmcnt(2)
Mvav 44,236,192
Ta 248,26,40960
Ta 250,26,45056
Mvav 76,236,196
v_exp_f32 v164, v164
Mvav 140,236,204
v_exp_f32 v165, v165
Mvav 108,236,200
v_exp_f32 v166, v166
Mvav 112,240,200
Ta 252,27,40960
Ta 254,27,45056
Mvav 144,240,204
v_exp_f32 v167, v167
Mvav 80,240,196
buffer_store_dwordx4 v[248:251], v252, s[28:31], s48 offen offset:1024 sc1
v_cvt_pk_bf16_f32 v210, v164, v165
Mvav 48,240,192
s_waitcnt lgkmcnt(2)
s_waitcnt vmcnt(18)
s_barrier
Mvav 52,244,192
Ba 224,16,0
s_add_u32 m0, s35, 0x4000
Mvav 84,244,196
s_add_u32 s44, s38, 0x1a000
v_cvt_pk_bf16_f32 v211, v166, v167
Mvav 148,244,204
s_add_u32 s98, s16, s44
s_addc_u32 s99, s17, 0
Mvav 116,244,200
GDMA 28,98,0
Mvav 120,248,200
Ba 228,17,0
GDMA 29,98,1024
Mvav 152,248,204
v_exp_f32 v172, v172
Mvav 88,248,196
v_exp_f32 v173, v173
Mvav 56,248,192
s_waitcnt lgkmcnt(1)
Mvav 60,252,192
Ba 232,18,0
GDMA 30,98,2048
Mvav 92,252,196
v_exp_f32 v174, v174
Mvav 156,252,204
v_exp_f32 v175, v175
Mvav 124,252,200
v_cvt_pk_bf16_f32 v214, v172, v173
v_cvt_pk_bf16_f32 v215, v174, v175
Zvaa 160,224,160
Ba 236,19,0
GDMA 31,98,3072
Zvaa 168,224,176
v_exp_f32 v180, v180
Zvaa 184,224,208
v_exp_f32 v181, v181
Zvaa 176,224,192
s_waitcnt lgkmcnt(1)
Mvaa 160,228,164
Ba 240,16,4096
Mvaa 168,228,180
v_exp_f32 v182, v182
Mvaa 184,228,212
v_exp_f32 v183, v183
Mvaa 176,228,196
v_cvt_pk_bf16_f32 v218, v180, v181
v_cvt_pk_bf16_f32 v219, v182, v183
Mvaa 160,232,168
Ba 244,17,4096
Mvaa 168,232,184
v_exp_f32 v188, v188
Mvaa 184,232,216
v_exp_f32 v189, v189
Mvaa 176,232,200
s_waitcnt lgkmcnt(1)
Mvaa 160,236,172
Ba 248,18,4096
Mvaa 168,236,188
v_exp_f32 v190, v190
Mvaa 184,236,220
v_exp_f32 v191, v191
Mvaa 176,236,204
v_cvt_pk_bf16_f32 v222, v188, v189
v_cvt_pk_bf16_f32 v223, v190, v191
Zvaa 164,240,160
Ba 252,19,4096
Zvaa 172,240,176
v_exp_f32 v160, v160
Zvaa 188,240,208
v_exp_f32 v161, v161
Zvaa 180,240,192
s_waitcnt lgkmcnt(1)
Mvaa 164,244,164
v_exp_f32 v162, v162
Mvaa 172,244,180
v_exp_f32 v163, v163
Mvaa 188,244,212
v_cvt_pk_bf16_f32 v192, v160, v161
v_cvt_pk_bf16_f32 v193, v162, v163
Mvaa 180,244,196
v_exp_f32 v168, v168
Mvaa 164,248,168
Ta 224,20,57344
Ta 226,20,61440
Mvaa 172,248,184
v_exp_f32 v169, v169
Mvaa 188,248,216
v_xor_b32 v20, 0x10000, v20
Mvaa 180,248,200
s_waitcnt lgkmcnt(0)
Mvaa 164,252,172
Ta 228,21,57344
Ta 230,21,61440
Mvaa 172,252,188
v_exp_f32 v170, v170
Mvaa 188,252,220
v_xor_b32 v21, 0x10000, v21
Mvaa 180,252,204
v_exp_f32 v171, v171
Maav 128,144,208
Ta 232,22,57344
Ta 234,22,61440
Maav 132,144,212
v_permlane16_swap_b32 v225, v227
Maav 136,144,216
v_xor_b32 v22, 0x10000, v22
v_cvt_pk_bf16_f32 v196, v168, v169
Maav 140,144,220
v_cvt_pk_bf16_f32 v197, v170, v171
v_accvgpr_write_b32 a0, v224
Mvav 96,224,216
Ta 236,23,57344
Ta 238,23,61440
Mvav 128,224,220
v_exp_f32 v176, v176
Mvav 64,224,212
v_xor_b32 v23, 0x10000, v23
v_accvgpr_write_b32 a1, v225
Mvav 32,224,208
v_accvgpr_write_b32 a2, v226
s_waitcnt lgkmcnt(2)
Mvav 36,228,208
Ta 240,24,57344
Ta 242,24,61440
Mvav 68,228,212
v_exp_f32 v177, v177
Mvav 132,228,220
v_xor_b32 v24, 0x10000, v24
v_accvgpr_write_b32 a3, v227
Mvav 100,228,216
v_exp_f32 v178, v178
Mvav 104,232,216
Ta 244,25,57344
Ta 246,25,61440
Mvav 136,232,220
v_exp_f32 v179, v179
Mvav 72,232,212
v_xor_b32 v25, 0x10000, v25
v_cvt_pk_bf16_f32 v200, v176, v177
Mvav 40,232,208
buffer_store_dwordx4 v[248:251], v252, s[28:31], s48 offen offset:2048 sc1
s_waitcnt lgkmcnt(2)
Mvav 44,236,208
Ta 248,26,57344
v_cvt_pk_bf16_f32 v201, v178, v179
Mvav 76,236,212
Ta 250,26,61440
v_xor_b32 v26, 0x10000, v26
Mvav 140,236,220
v_exp_f32 v184, v184
Mvav 108,236,216
v_exp_f32 v185, v185
Mvav 112,240,216
Ta 252,27,57344
Ta 254,27,61440
Mvav 144,240,220
v_exp_f32 v186, v186
Mvav 80,240,212
v_xor_b32 v27, 0x10000, v27
v_accvgpr_read_b32 v224, a20
Mvav 48,240,208
s_waitcnt lgkmcnt(2)
s_waitcnt vmcnt(19)
s_barrier
Mvav 52,244,208
Ba 224,16,16384
s_add_u32 m0, s35, 0x8000
Mvav 84,244,212
s_add_u32 s44, s38, 0x1c000
v_accvgpr_read_b32 v225, a21
Mvav 148,244,220
s_add_u32 s98, s16, s44
s_addc_u32 s99, s17, 0
Mvav 116,244,216
GDMA 28,98,0
v_accvgpr_read_b32 v226, a22
Mvav 120,248,216
Ba 228,17,16384
GDMA 29,98,1024
Mvav 152,248,220
v_exp_f32 v187, v187
Mvav 88,248,212
v_cvt_pk_bf16_f32 v204, v184, v185
v_cvt_pk_bf16_f32 v205, v186, v187
Mvav 56,248,208
v_accvgpr_read_b32 v227, a23
s_waitcnt lgkmcnt(1)
Mvav 60,252,208
Ba 232,18,16384
GDMA 30,98,2048
Mvav 92,252,212
v_exp_f32 v164, v164
Mvav 156,252,220
v_exp_f32 v165, v165
Mvav 124,252,216
v_exp_f32 v166, v166
Zvaa 160,224,160
Ba 236,19,16384
GDMA 31,98,3072
Zvaa 168,224,176
v_exp_f32 v167, v167
Zvaa 184,224,208
v_cvt_pk_bf16_f32 v194, v164, v165
v_cvt_pk_bf16_f32 v195, v166, v167
Zvaa 176,224,192
v_exp_f32 v172, v172
s_waitcnt lgkmcnt(1)
Mvaa 160,228,164
Ba 240,16,20480
v_exp_f32 v173, v173
Mvaa 168,228,180
v_exp_f32 v174, v174
Mvaa 184,228,212
v_exp_f32 v175, v175
Mvaa 176,228,196
v_cvt_pk_bf16_f32 v198, v172, v173
v_cvt_pk_bf16_f32 v199, v174, v175
Mvaa 160,232,168
Ba 244,17,20480
v_exp_f32 v180, v180
Mvaa 168,232,184
v_exp_f32 v181, v181
Mvaa 184,232,216
v_exp_f32 v182, v182
Mvaa 176,232,200
v_exp_f32 v183, v183
s_waitcnt lgkmcnt(1)
Mvaa 160,236,172
Ba 248,18,20480
v_cvt_pk_bf16_f32 v202, v180, v181
v_cvt_pk_bf16_f32 v203, v182, v183
Mvaa 168,236,188
v_exp_f32 v188, v188
Mvaa 184,236,220
v_exp_f32 v189, v189
Mvaa 176,236,204
v_exp_f32 v190, v190
Zvaa 164,240,160
Ba 252,19,20480
v_exp_f32 v191, v191
Zvaa 172,240,176
v_cvt_pk_bf16_f32 v206, v188, v189
v_cvt_pk_bf16_f32 v207, v190, v191
Zvaa 188,240,208
v_exp_f32 v160, v160
Zvaa 180,240,192
v_accvgpr_read_b32 v228, a28
s_waitcnt lgkmcnt(1)
Mvaa 164,244,164
v_exp_f32 v161, v161
Mvaa 172,244,180
v_exp_f32 v162, v162
Mvaa 188,244,212
v_exp_f32 v163, v163
Mvaa 180,244,196
v_cvt_pk_bf16_f32 v208, v160, v161
v_cvt_pk_bf16_f32 v209, v162, v163
Mvaa 164,248,168
Ta 224,20,8192
Ta 226,20,12288
Mvaa 172,248,184
v_exp_f32 v168, v168
Mvaa 188,248,216
v_exp_f32 v169, v169
Mvaa 180,248,200
v_accvgpr_read_b32 v229, a29
s_waitcnt lgkmcnt(0)
Mvaa 164,252,172
Ta 228,21,8192
Ta 230,21,12288
Mvaa 172,252,188
v_exp_f32 v170, v170
Mvaa 188,252,220
v_exp_f32 v171, v171
Mvaa 180,252,204
v_cvt_pk_bf16_f32 v212, v168, v169
v_cvt_pk_bf16_f32 v213, v170, v171
Maav 128,144,192
Ta 232,22,8192
Ta 234,22,12288
Maav 132,144,196
v_exp_f32 v176, v176
Maav 136,144,200
v_exp_f32 v177, v177
Maav 140,144,204
v_exp_f32 v178, v178
Mvav 96,224,200
Ta 236,23,8192
Ta 238,23,12288
Mvav 128,224,204
v_exp_f32 v179, v179
Mvav 64,224,196
buffer_store_dwordx4 v[248:251], v252, s[28:31], s48 offen offset:3072 sc1
v_cvt_pk_bf16_f32 v216, v176, v177
Mvav 32,224,192
v_cvt_pk_bf16_f32 v217, v178, v179
s_waitcnt lgkmcnt(2)
Mvav 36,228,192
Ta 240,24,8192
Ta 242,24,12288
Mvav 68,228,196
v_exp_f32 v184, v184
Mvav 132,228,204
v_exp_f32 v185, v185
Mvav 100,228,200
v_exp_f32 v186, v186
Mvav 104,232,200
Ta 244,25,8192
Ta 246,25,12288
Mvav 136,232,204
v_exp_f32 v187, v187
Mvav 72,232,196
v_cvt_pk_bf16_f32 v220, v184, v185
v_cvt_pk_bf16_f32 v221, v186, v187
Mvav 40,232,192
s_add_u32 s48, s47, 0x8000
s_waitcnt lgkmcnt(2)
Mvav 44,236,192
Ta 248,26,8192
Ta 250,26,12288
Mvav 76,236,196
v_exp_f32 v164, v164
Mvav 140,236,204
v_exp_f32 v165, v165
Mvav 108,236,200
v_exp_f32 v166, v166
Mvav 112,240,200
Ta 252,27,8192
Ta 254,27,12288
Mvav 144,240,204
v_exp_f32 v167, v167
Mvav 80,240,196
v_cvt_pk_bf16_f32 v210, v164, v165
v_cvt_pk_bf16_f32 v211, v166, v167
Mvav 48,240,192
s_waitcnt lgkmcnt(2)
s_waitcnt vmcnt(20)
s_barrier
Mvav 52,244,192
Ba 224,16,32768
s_add_u32 m0, s35, 0xc000
Mvav 84,244,196
s_add_u32 s44, s38, 0x1e000
v_accvgpr_read_b32 v230, a30
Mvav 148,244,204
s_add_u32 s98, s16, s44
s_addc_u32 s99, s17, 0
Mvav 116,244,200
GDMA 28,98,0
v_accvgpr_read_b32 v231, a31
Mvav 120,248,200
Ba 228,17,32768
GDMA 29,98,1024
Mvav 152,248,204
v_exp_f32 v172, v172
Mvav 88,248,196
v_exp_f32 v173, v173
Mvav 56,248,192
v_cvt_pk_bf16_f32 v224, v224, v225
s_waitcnt lgkmcnt(1)
Mvav 60,252,192
Ba 232,18,32768
GDMA 30,98,2048
Mvav 92,252,196
v_exp_f32 v174, v174
Mvav 156,252,204
v_exp_f32 v175, v175
Mvav 124,252,200
v_cvt_pk_bf16_f32 v214, v172, v173
v_cvt_pk_bf16_f32 v215, v174, v175
Zvaa 160,224,160
Ba 236,19,32768
GDMA 31,98,3072
Zvaa 168,224,176
v_exp_f32 v180, v180
Zvaa 184,224,208
v_exp_f32 v181, v181
Zvaa 176,224,192
v_cvt_pk_bf16_f32 v225, v226, v227
s_waitcnt lgkmcnt(1)
Mvaa 160,228,164
Ba 240,16,36864
v_cvt_pk_bf16_f32 v226, v228, v229
Mvaa 168,228,180
v_exp_f32 v182, v182
Mvaa 184,228,212
v_exp_f32 v183, v183
Mvaa 176,228,196
v_cvt_pk_bf16_f32 v218, v180, v181
v_cvt_pk_bf16_f32 v219, v182, v183
Mvaa 160,232,168
Ba 244,17,36864
v_cvt_pk_bf16_f32 v227, v230, v231
Mvaa 168,232,184
v_exp_f32 v188, v188
Mvaa 184,232,216
v_exp_f32 v189, v189
Mvaa 176,232,200
s_waitcnt lgkmcnt(1)
Mvaa 160,236,172
Ba 248,18,36864
Mvaa 168,236,188
v_exp_f32 v190, v190
Mvaa 184,236,220
v_exp_f32 v191, v191
Mvaa 176,236,204
v_cvt_pk_bf16_f32 v222, v188, v189
v_cvt_pk_bf16_f32 v223, v190, v191
Zvaa 164,240,160
Ba 252,19,36864
Zvaa 172,240,176
v_exp_f32 v160, v160
Zvaa 188,240,208
v_exp_f32 v161, v161
Zvaa 180,240,192
s_waitcnt lgkmcnt(1)
Mvaa 164,244,164
v_exp_f32 v162, v162
Mvaa 172,244,180
v_exp_f32 v163, v163
Mvaa 188,244,212
v_cvt_pk_bf16_f32 v192, v160, v161
v_cvt_pk_bf16_f32 v193, v162, v163
Mvaa 180,244,196
v_exp_f32 v168, v168
Mvaa 164,248,168
Ta 224,20,24576
Ta 226,20,28672
Mvaa 172,248,184
v_exp_f32 v169, v169
Mvaa 188,248,216
v_exp_f32 v170, v170
Mvaa 180,248,200
s_waitcnt lgkmcnt(0)
Mvaa 164,252,172
Ta 228,21,24576
Ta 230,21,28672
Mvaa 172,252,188
v_exp_f32 v171, v171
Mvaa 188,252,220
buffer_store_dwordx4 v[248:251], v252, s[28:31], s48 offen offset:0 sc1
v_cvt_pk_bf16_f32 v196, v168, v169
Mvaa 180,252,204
v_cvt_pk_bf16_f32 v197, v170, v171
Maav 128,144,208
Ta 232,22,24576
Ta 234,22,28672
Maav 132,144,212
v_exp_f32 v176, v176
Maav 136,144,216
v_exp_f32 v177, v177
Maav 140,144,220
v_exp_f32 v178, v178
Mvav 96,224,216
Ta 236,23,24576
Ta 238,23,28672
Mvav 128,224,220
v_exp_f32 v179, v179
Mvav 64,224,212
v_cvt_pk_bf16_f32 v200, v176, v177
v_cvt_pk_bf16_f32 v201, v178, v179
Mvav 32,224,208
s_waitcnt lgkmcnt(2)
Mvav 36,228,208
Ta 240,24,24576
Ta 242,24,28672
Mvav 68,228,212
v_exp_f32 v184, v184
Mvav 132,228,220
v_exp_f32 v185, v185
Mvav 100,228,216
v_exp_f32 v186, v186
Mvav 104,232,216
Ta 244,25,24576
Ta 246,25,28672
Mvav 136,232,220
v_exp_f32 v187, v187
Mvav 72,232,212
v_cvt_pk_bf16_f32 v204, v184, v185
v_cvt_pk_bf16_f32 v205, v186, v187
Mvav 40,232,208
s_waitcnt lgkmcnt(2)
Mvav 44,236,208
Ta 248,26,24576
Ta 250,26,28672
Mvav 76,236,212
v_exp_f32 v164, v164
Mvav 140,236,220
v_exp_f32 v165, v165
Mvav 108,236,216
v_exp_f32 v166, v166
Mvav 112,240,216
Ta 252,27,24576
Ta 254,27,28672
Mvav 144,240,220
v_exp_f32 v167, v167
Mvav 80,240,212
v_cvt_pk_bf16_f32 v194, v164, v165
v_cvt_pk_bf16_f32 v195, v166, v167
Mvav 48,240,208
s_waitcnt lgkmcnt(2)
s_waitcnt vmcnt(21)
s_barrier
Mvav 52,244,208
Ba 224,16,49152
s_add_u32 m0, s35, 0x10000
Mvav 84,244,212
s_add_u32 s44, s38, 0x80000
Mvav 148,244,220
s_add_u32 s98, s16, s44
s_addc_u32 s99, s17, 0
Mvav 116,244,216
GDMA 28,98,0
Mvav 120,248,216
Ba 228,17,49152
GDMA 29,98,1024
Mvav 152,248,220
v_exp_f32 v172, v172
Mvav 88,248,212
v_exp_f32 v173, v173
Mvav 56,248,208
s_waitcnt lgkmcnt(1)
Mvav 60,252,208
Ba 232,18,49152
GDMA 30,98,2048
Mvav 92,252,212
v_exp_f32 v174, v174
Mvav 156,252,220
v_exp_f32 v175, v175
Mvav 124,252,216
v_cvt_pk_bf16_f32 v198, v172, v173
v_cvt_pk_bf16_f32 v199, v174, v175
Zvaa 160,224,160
Ba 236,19,49152
GDMA 31,98,3072
Zvaa 168,224,176
v_exp_f32 v180, v180
Zvaa 184,224,208
v_exp_f32 v181, v181
Zvaa 176,224,192
s_waitcnt lgkmcnt(1)
Mvaa 160,228,164
Ba 240,16,53248
v_xor_b32 v16, 0x10000, v16
Mvaa 168,228,180
v_exp_f32 v182, v182
Mvaa 184,228,212
v_exp_f32 v183, v183
Mvaa 176,228,196
v_cvt_pk_bf16_f32 v202, v180, v181
v_cvt_pk_bf16_f32 v203, v182, v183
Mvaa 160,232,168
Ba 244,17,53248
v_xor_b32 v17, 0x10000, v17
Mvaa 168,232,184
v_exp_f32 v188, v188
Mvaa 184,232,216
v_exp_f32 v189, v189
Mvaa 176,232,200
s_waitcnt lgkmcnt(1)
Mvaa 160,236,172
Ba 248,18,53248
v_xor_b32 v18, 0x10000, v18
Mvaa 168,236,188
v_exp_f32 v190, v190
Mvaa 184,236,220
v_exp_f32 v191, v191
Mvaa 176,236,204
v_cvt_pk_bf16_f32 v206, v188, v189
v_cvt_pk_bf16_f32 v207, v190, v191
Zvaa 164,240,160
Ba 252,19,53248
v_xor_b32 v19, 0x10000, v19
Zvaa 172,240,176
v_exp_f32 v160, v160
Zvaa 188,240,208
v_exp_f32 v161, v161
Zvaa 180,240,192
s_waitcnt lgkmcnt(1)
Mvaa 164,244,164
buffer_store_dwordx4 v[248:251], v252, s[28:31], s48 offen offset:1024 sc1
Mvaa 172,244,180
v_exp_f32 v162, v162
Mvaa 188,244,212
v_exp_f32 v163, v163
Mvaa 180,244,196
v_cvt_pk_bf16_f32 v208, v160, v161
v_cvt_pk_bf16_f32 v209, v162, v163
Mvaa 164,248,168
Ta 224,20,40960
Ta 226,20,45056
Mvaa 172,248,184
v_exp_f32 v168, v168
Mvaa 188,248,216
v_exp_f32 v169, v169
Mvaa 180,248,200
s_waitcnt lgkmcnt(0)
Mvaa 164,252,172
Ta 228,21,40960
Ta 230,21,45056
Mvaa 172,252,188
v_exp_f32 v170, v170
Mvaa 188,252,220
v_exp_f32 v171, v171
Mvaa 180,252,204
v_cvt_pk_bf16_f32 v212, v168, v169
v_cvt_pk_bf16_f32 v213, v170, v171
Maav 128,144,192
Ta 232,22,40960
Ta 234,22,45056
Maav 132,144,196
v_exp_f32 v176, v176
Maav 136,144,200
v_exp_f32 v177, v177
Maav 140,144,204
v_exp_f32 v178, v178
Mvav 96,224,200
Ta 236,23,40960
Ta 238,23,45056
Mvav 128,224,204
v_exp_f32 v179, v179
Mvav 64,224,196
v_cvt_pk_bf16_f32 v216, v176, v177
v_cvt_pk_bf16_f32 v217, v178, v179
Mvav 32,224,192
s_waitcnt lgkmcnt(2)
Mvav 36,228,192
Ta 240,24,40960
Ta 242,24,45056
Mvav 68,228,196
v_exp_f32 v184, v184
Mvav 132,228,204
v_exp_f32 v185, v185
Mvav 100,228,200
v_exp_f32 v186, v186
Mvav 104,232,200
Ta 244,25,40960
Ta 246,25,45056
Mvav 136,232,204
v_exp_f32 v187, v187
Mvav 72,232,196
v_cvt_pk_bf16_f32 v220, v184, v185
v_cvt_pk_bf16_f32 v221, v186, v187
Mvav 40,232,192
s_waitcnt lgkmcnt(2)
Mvav 44,236,192
Ta 248,26,40960
Ta 250,26,45056
Mvav 76,236,196
v_exp_f32 v164, v164
Mvav 140,236,204
v_exp_f32 v165, v165
Mvav 108,236,200
v_exp_f32 v166, v166
Mvav 112,240,200
Ta 252,27,40960
Ta 254,27,45056
Mvav 144,240,204
v_exp_f32 v167, v167
Mvav 80,240,196
v_cvt_pk_bf16_f32 v210, v164, v165
v_cvt_pk_bf16_f32 v211, v166, v167
Mvav 48,240,192
s_waitcnt lgkmcnt(2)
s_waitcnt vmcnt(21)
s_barrier
Mvav 52,244,192
Ba 224,16,0
s_add_u32 m0, s35, 0x14000
Mvav 84,244,196
s_add_u32 s44, s38, 0x82000
Mvav 148,244,204
s_add_u32 s98, s16, s44
s_addc_u32 s99, s17, 0
Mvav 116,244,200
GDMA 28,98,0
Mvav 120,248,200
Ba 228,17,0
GDMA 29,98,1024
Mvav 152,248,204
v_exp_f32 v172, v172
Mvav 88,248,196
v_exp_f32 v173, v173
Mvav 56,248,192
s_waitcnt lgkmcnt(1)
Mvav 60,252,192
Ba 232,18,0
GDMA 30,98,2048
Mvav 92,252,196
v_exp_f32 v174, v174
Mvav 156,252,204
v_exp_f32 v175, v175
Mvav 124,252,200
v_cvt_pk_bf16_f32 v214, v172, v173
v_cvt_pk_bf16_f32 v215, v174, v175
Zvaa 160,224,160
Ba 236,19,0
GDMA 31,98,3072
Zvaa 168,224,176
v_exp_f32 v180, v180
Zvaa 184,224,208
v_exp_f32 v181, v181
Zvaa 176,224,192
s_waitcnt lgkmcnt(1)
Mvaa 160,228,164
Ba 240,16,4096
Mvaa 168,228,180
v_exp_f32 v182, v182
Mvaa 184,228,212
v_exp_f32 v183, v183
Mvaa 176,228,196
v_cvt_pk_bf16_f32 v218, v180, v181
v_cvt_pk_bf16_f32 v219, v182, v183
Mvaa 160,232,168
Ba 244,17,4096
Mvaa 168,232,184
v_exp_f32 v188, v188
Mvaa 184,232,216
v_exp_f32 v189, v189
Mvaa 176,232,200
s_waitcnt lgkmcnt(1)
Mvaa 160,236,172
Ba 248,18,4096
buffer_store_dwordx4 v[248:251], v252, s[28:31], s48 offen offset:2048 sc1
Mvaa 168,236,188
v_exp_f32 v190, v190
Mvaa 184,236,220
v_exp_f32 v191, v191
Mvaa 176,236,204
v_cvt_pk_bf16_f32 v222, v188, v189
v_cvt_pk_bf16_f32 v223, v190, v191
Zvaa 164,240,160
Ba 252,19,4096
Zvaa 172,240,176
v_exp_f32 v160, v160
Zvaa 188,240,208
v_exp_f32 v161, v161
Zvaa 180,240,192
s_waitcnt lgkmcnt(1)
Mvaa 164,244,164
v_exp_f32 v162, v162
Mvaa 172,244,180
v_exp_f32 v163, v163
Mvaa 188,244,212
v_cvt_pk_bf16_f32 v192, v160, v161
v_cvt_pk_bf16_f32 v193, v162, v163
Mvaa 180,244,196
v_exp_f32 v168, v168
Mvaa 164,248,168
Ta 224,20,57344
Ta 226,20,61440
Mvaa 172,248,184
v_exp_f32 v169, v169
Mvaa 188,248,216
v_xor_b32 v20, 0x10000, v20
Mvaa 180,248,200
s_waitcnt lgkmcnt(0)
Mvaa 164,252,172
Ta 228,21,57344
Ta 230,21,61440
Mvaa 172,252,188
v_exp_f32 v170, v170
Mvaa 188,252,220
v_xor_b32 v21, 0x10000, v21
Mvaa 180,252,204
v_exp_f32 v171, v171
Maav 128,144,208
Ta 232,22,57344
Ta 234,22,61440
Maav 132,144,212
v_permlane32_swap_b32 v224, v226
Maav 136,144,216
v_xor_b32 v22, 0x10000, v22
v_cvt_pk_bf16_f32 v196, v168, v169
Maav 140,144,220
v_cvt_pk_bf16_f32 v197, v170, v171
Mvav 96,224,216
Ta 236,23,57344
Ta 238,23,61440
Mvav 128,224,220
v_exp_f32 v176, v176
Mvav 64,224,212
v_xor_b32 v23, 0x10000, v23
Mvav 32,224,208
s_waitcnt lgkmcnt(2)
Mvav 36,228,208
Ta 240,24,57344
Ta 242,24,61440
Mvav 68,228,212
v_exp_f32 v177, v177
Mvav 132,228,220
v_xor_b32 v24, 0x10000, v24
Mvav 100,228,216
v_exp_f32 v178, v178
Mvav 104,232,216
Ta 244,25,57344
Ta 246,25,61440
Mvav 136,232,220
v_exp_f32 v179, v179
Mvav 72,232,212
v_xor_b32 v25, 0x10000, v25
v_cvt_pk_bf16_f32 v200, v176, v177
Mvav 40,232,208
v_cvt_pk_bf16_f32 v201, v178, v179
s_waitcnt lgkmcnt(2)
Mvav 44,236,208
Ta 248,26,57344
Ta 250,26,61440
Mvav 76,236,212
v_exp_f32 v184, v184
Mvav 140,236,220
v_xor_b32 v26, 0x10000, v26
Mvav 108,236,216
v_exp_f32 v185, v185
Mvav 112,240,216
Ta 252,27,57344
Ta 254,27,61440
Mvav 144,240,220
v_exp_f32 v186, v186
Mvav 80,240,212
v_xor_b32 v27, 0x10000, v27
Mvav 48,240,208
s_waitcnt lgkmcnt(2)
s_waitcnt vmcnt(21)
s_barrier
Mvav 52,244,208
Ba 224,16,16384
s_add_u32 m0, s35, 0x18000
Mvav 84,244,212
s_add_u32 s44, s38, 0x84000
Mvav 148,244,220
s_add_u32 s98, s16, s44
s_addc_u32 s99, s17, 0
Mvav 116,244,216
GDMA 28,98,0
Mvav 120,248,216
Ba 228,17,16384
GDMA 29,98,1024
Mvav 152,248,220
v_exp_f32 v187, v187
Mvav 88,248,212
v_cvt_pk_bf16_f32 v204, v184, v185
v_cvt_pk_bf16_f32 v205, v186, v187
Mvav 56,248,208
s_waitcnt lgkmcnt(1)
Mvav 60,252,208
Ba 232,18,16384
GDMA 30,98,2048
Mvav 92,252,212
v_exp_f32 v164, v164
Mvav 156,252,220
v_exp_f32 v165, v165
Mvav 124,252,216
v_exp_f32 v166, v166
Zvaa 160,224,160
Ba 236,19,16384
GDMA 31,98,3072
Zvaa 168,224,176
v_exp_f32 v167, v167
Zvaa 184,224,208
v_cvt_pk_bf16_f32 v194, v164, v165
v_cvt_pk_bf16_f32 v195, v166, v167
Zvaa 176,224,192
v_permlane32_swap_b32 v225, v227
v_exp_f32 v172, v172
s_waitcnt lgkmcnt(1)
Mvaa 160,228,164
Ba 240,16,20480
v_exp_f32 v173, v173
Mvaa 168,228,180
v_permlane16_swap_b32 v224, v226
v_exp_f32 v174, v174
Mvaa 184,228,212
v_permlane16_swap_b32 v225, v227
v_exp_f32 v175, v175
Mvaa 176,228,196
v_accvgpr_write_b32 a20, v224
v_cvt_pk_bf16_f32 v198, v172, v173
v_accvgpr_write_b32 a21, v225
v_cvt_pk_bf16_f32 v199, v174, v175
Mvaa 160,232,168
Ba 244,17,20480
v_accvgpr_write_b32 a22, v226
v_exp_f32 v180, v180
Mvaa 168,232,184
v_accvgpr_write_b32 a23, v227
v_accvgpr_read_b32 v224, a16
v_exp_f32 v181, v181
Mvaa 184,232,216
v_accvgpr_read_b32 v225, a17
v_exp_f32 v182, v182
Mvaa 176,232,200
v_accvgpr_read_b32 v226, a18
v_accvgpr_read_b32 v227, a19
v_exp_f32 v183, v183
s_waitcnt lgkmcnt(1)
Mvaa 160,236,172
Ba 248,18,20480
v_accvgpr_read_b32 v228, a24
v_cvt_pk_bf16_f32 v202, v180, v181
v_cvt_pk_bf16_f32 v203, v182, v183
Mvaa 168,236,188
v_accvgpr_read_b32 v229, a25
v_accvgpr_read_b32 v230, a26
v_exp_f32 v188, v188
Mvaa 184,236,220
v_accvgpr_read_b32 v231, a27
v_exp_f32 v189, v189
Mvaa 176,236,204
v_cvt_pk_bf16_f32 v224, v224, v225
v_cvt_pk_bf16_f32 v225, v226, v227
v_exp_f32 v190, v190
Zvaa 164,240,160
Ba 252,19,20480
v_cvt_pk_bf16_f32 v226, v228, v229
v_exp_f32 v191, v191
Zvaa 172,240,176
v_cvt_pk_bf16_f32 v227, v230, v231
v_cvt_pk_bf16_f32 v206, v188, v189
v_cvt_pk_bf16_f32 v207, v190, v191
Zvaa 188,240,208
v_permlane32_swap_b32 v224, v226
Zvaa 180,240,192
v_permlane32_swap_b32 v225, v227
s_waitcnt lgkmcnt(1)
Mvaa 164,244,164
buffer_store_dwordx4 v[248:251], v252, s[28:31], s48 offen offset:3072 sc1
Mvaa 172,244,180
v_permlane16_swap_b32 v224, v226
Mvaa 188,244,212
v_permlane16_swap_b32 v225, v227
Mvaa 180,244,196
v_accvgpr_write_b32 a16, v224
v_accvgpr_write_b32 a17, v225
Mvaa 164,248,168
Ta 224,20,8192
v_accvgpr_write_b32 a18, v226
Mvaa 172,248,184
Ta 226,20,12288
v_accvgpr_write_b32 a19, v227
v_accvgpr_read_b32 v224, a36
Mvaa 188,248,216
v_accvgpr_read_b32 v225, a37
v_accvgpr_read_b32 v226, a38
Mvaa 180,248,200
v_accvgpr_read_b32 v227, a39
s_waitcnt lgkmcnt(0)
Mvaa 164,252,172
Ta 228,21,8192
v_accvgpr_read_b32 v228, a44
Mvaa 172,252,188
Ta 230,21,12288
v_accvgpr_read_b32 v229, a45
v_accvgpr_read_b32 v230, a46
Mvaa 188,252,220
v_accvgpr_read_b32 v231, a47
v_cvt_pk_bf16_f32 v224, v224, v225
Mvaa 180,252,204
v_cvt_pk_bf16_f32 v225, v226, v227
v_cvt_pk_bf16_f32 v226, v228, v229
Maav 128,144,192
Ta 232,22,8192
Ta 234,22,12288
Maav 132,144,196
v_exp_f32 v160, v160
v_cvt_pk_bf16_f32 v227, v230, v231
Maav 136,144,200
v_permlane32_swap_b32 v224, v226
Maav 140,144,204
v_permlane32_swap_b32 v225, v227
Mvav 96,224,200
Ta 236,23,8192
Ta 238,23,12288
Mvav 128,224,204
v_permlane16_swap_b32 v224, v226
Mvav 64,224,196
v_permlane16_swap_b32 v225, v227
Mvav 32,224,192
v_accvgpr_write_b32 a36, v224
v_accvgpr_write_b32 a37, v225
s_waitcnt lgkmcnt(2)
Mvav 36,228,192
Ta 240,24,8192
v_accvgpr_write_b32 a38, v226
Mvav 68,228,196
Ta 242,24,12288
v_accvgpr_write_b32 a39, v227
v_accvgpr_read_b32 v224, a32
Mvav 132,228,204
v_accvgpr_read_b32 v225, a33
v_accvgpr_read_b32 v226, a34
Mvav 100,228,200
v_accvgpr_read_b32 v227, a35
v_accvgpr_read_b32 v228, a40
Mvav 104,232,200
Ta 244,25,8192
Ta 246,25,12288
Mvav 136,232,204
v_exp_f32 v161, v161
v_accvgpr_read_b32 v229, a41
v_accvgpr_read_b32 v230, a42
Mvav 72,232,196
v_accvgpr_read_b32 v231, a43
v_cvt_pk_bf16_f32 v224, v224, v225
Mvav 40,232,192
v_cvt_pk_bf16_f32 v225, v226, v227
s_waitcnt lgkmcnt(2)
Mvav 44,236,192
Ta 248,26,8192
v_cvt_pk_bf16_f32 v226, v228, v229
v_exp_f32 v162, v162
Mvav 76,236,196
Ta 250,26,12288
v_cvt_pk_bf16_f32 v227, v230, v231
v_exp_f32 v163, v163
Mvav 140,236,204
v_permlane32_swap_b32 v224, v226
v_cvt_pk_bf16_f32 v208, v160, v161
v_cvt_pk_bf16_f32 v209, v162, v163
Mvav 108,236,200
v_permlane32_swap_b32 v225, v227
v_exp_f32 v168, v168
Mvav 112,240,200
Ta 252,27,8192
Ta 254,27,12288
v_exp_f32 v169, v169
Mvav 144,240,204
v_permlane16_swap_b32 v224, v226
v_exp_f32 v170, v170
Mvav 80,240,196
v_permlane16_swap_b32 v225, v227
v_exp_f32 v171, v171
Mvav 48,240,192
v_accvgpr_write_b32 a32, v224
v_cvt_pk_bf16_f32 v212, v168, v169
v_accvgpr_write_b32 a33, v225
v_cvt_pk_bf16_f32 v213, v170, v171
s_waitcnt lgkmcnt(2)
s_waitcnt vmcnt(21)
s_barrier
Mvav 52,244,192
Ba 224,16,32768
s_add_u32 m0, s35, 0x1c000
v_accvgpr_write_b32 a34, v226
v_exp_f32 v176, v176
Mvav 84,244,196
s_add_u32 s44, s38, 0x86000
v_accvgpr_write_b32 a35, v227
v_accvgpr_read_b32 v224, a52
v_exp_f32 v177, v177
Mvav 148,244,204
s_add_u32 s98, s16, s44
s_addc_u32 s99, s17, 0
v_accvgpr_read_b32 v225, a53
v_exp_f32 v178, v178
Mvav 116,244,200
GDMA 28,98,0
v_accvgpr_read_b32 v226, a54
v_accvgpr_read_b32 v227, a55
v_exp_f32 v179, v179
Mvav 120,248,200
Ba 228,17,32768
GDMA 29,98,1024
v_accvgpr_read_b32 v228, a60
v_cvt_pk_bf16_f32 v216, v176, v177
v_cvt_pk_bf16_f32 v217, v178, v179
Mvav 152,248,204
v_accvgpr_read_b32 v229, a61
v_accvgpr_read_b32 v230, a62
v_exp_f32 v184, v184
Mvav 88,248,196
v_accvgpr_read_b32 v231, a63
v_exp_f32 v185, v185
Mvav 56,248,192
v_cvt_pk_bf16_f32 v224, v224, v225
v_cvt_pk_bf16_f32 v225, v226, v227
v_exp_f32 v186, v186
s_waitcnt lgkmcnt(1)
Mvav 60,252,192
Ba 232,18,32768
GDMA 30,98,2048
v_cvt_pk_bf16_f32 v226, v228, v229
v_exp_f32 v187, v187
Mvav 92,252,196
v_cvt_pk_bf16_f32 v227, v230, v231
v_cvt_pk_bf16_f32 v220, v184, v185
v_cvt_pk_bf16_f32 v221, v186, v187
Mvav 156,252,204
v_permlane32_swap_b32 v224, v226
v_exp_f32 v164, v164
Mvav 124,252,200
v_permlane32_swap_b32 v225, v227
v_exp_f32 v165, v165
Zvaa 160,224,160
Ba 236,19,32768
GDMA 31,98,3072
v_exp_f32 v166, v166
Zvaa 168,224,176
v_permlane16_swap_b32 v224, v226
v_exp_f32 v167, v167
Zvaa 184,224,208
v_permlane16_swap_b32 v225, v227
v_cvt_pk_bf16_f32 v210, v164, v165
v_cvt_pk_bf16_f32 v211, v166, v167
Zvaa 176,224,192
v_accvgpr_write_b32 a52, v224
v_accvgpr_write_b32 a53, v225
v_exp_f32 v172, v172
s_waitcnt lgkmcnt(1)
Mvaa 160,228,164
Ba 240,16,36864
v_accvgpr_write_b32 a54, v226
v_exp_f32 v173, v173
Mvaa 168,228,180
v_accvgpr_write_b32 a55, v227
v_accvgpr_read_b32 v224, a48
v_exp_f32 v174, v174
Mvaa 184,228,212
v_accvgpr_read_b32 v225, a49
v_exp_f32 v175, v175
Mvaa 176,228,196
v_accvgpr_read_b32 v226, a50
v_cvt_pk_bf16_f32 v214, v172, v173
v_accvgpr_read_b32 v227, a51
v_cvt_pk_bf16_f32 v215, v174, v175
Mvaa 160,232,168
Ba 244,17,36864
v_accvgpr_read_b32 v228, a56
v_exp_f32 v180, v180
Mvaa 168,232,184
v_accvgpr_read_b32 v229, a57
v_accvgpr_read_b32 v230, a58
v_exp_f32 v181, v181
Mvaa 184,232,216
v_accvgpr_read_b32 v231, a59
v_exp_f32 v182, v182
Mvaa 176,232,200
v_cvt_pk_bf16_f32 v224, v224, v225
v_cvt_pk_bf16_f32 v225, v226, v227
v_exp_f32 v183, v183
s_waitcnt lgkmcnt(1)
Mvaa 160,236,172
Ba 248,18,36864
v_cvt_pk_bf16_f32 v226, v228, v229
v_cvt_pk_bf16_f32 v218, v180, v181
v_cvt_pk_bf16_f32 v219, v182, v183
Mvaa 168,236,188
v_cvt_pk_bf16_f32 v227, v230, v231
v_exp_f32 v188, v188
Mvaa 184,236,220
v_permlane32_swap_b32 v224, v226
v_exp_f32 v189, v189
Mvaa 176,236,204
v_permlane32_swap_b32 v225, v227
v_exp_f32 v190, v190
Zvaa 164,240,160
Ba 252,19,36864
v_exp_f32 v191, v191
Zvaa 172,240,176
v_permlane16_swap_b32 v224, v226
v_cvt_pk_bf16_f32 v222, v188, v189
v_cvt_pk_bf16_f32 v223, v190, v191
Zvaa 188,240,208
v_permlane16_swap_b32 v225, v227
Zvaa 180,240,192
v_accvgpr_write_b32 a48, v224
v_accvgpr_write_b32 a49, v225
s_waitcnt lgkmcnt(1)
Mvaa 164,244,164
v_accvgpr_write_b32 a50, v226
v_accvgpr_write_b32 a51, v227
Mvaa 172,244,180
v_accvgpr_read_b32 v224, a68
v_accvgpr_read_b32 v225, a69
Mvaa 188,244,212
v_accvgpr_read_b32 v226, a70
v_accvgpr_read_b32 v227, a71
Mvaa 180,244,196
v_accvgpr_read_b32 v228, a76
v_accvgpr_read_b32 v229, a77
Mvaa 164,248,168
Ta 224,20,24576
Ta 226,20,28672
Mvaa 172,248,184
v_exp_f32 v160, v160
v_accvgpr_read_b32 v230, a78
Mvaa 188,248,216
v_accvgpr_read_b32 v231, a79
v_cvt_pk_bf16_f32 v224, v224, v225
Mvaa 180,248,200
v_cvt_pk_bf16_f32 v225, v226, v227
s_waitcnt lgkmcnt(0)
Mvaa 164,252,172
Ta 228,21,24576
v_cvt_pk_bf16_f32 v226, v228, v229
Mvaa 172,252,188
Ta 230,21,28672
v_cvt_pk_bf16_f32 v227, v230, v231
Mvaa 188,252,220
v_permlane32_swap_b32 v224, v226
Mvaa 180,252,204
v_permlane32_swap_b32 v225, v227
Maav 128,144,208
Ta 232,22,24576
Ta 234,22,28672
Maav 132,144,212
v_permlane16_swap_b32 v224, v226
Maav 136,144,216
v_permlane16_swap_b32 v225, v227
Maav 140,144,220
v_accvgpr_write_b32 a68, v224
v_accvgpr_write_b32 a69, v225
Mvav 96,224,216
Ta 236,23,24576
v_accvgpr_write_b32 a70, v226
Mvav 128,224,220
Ta 238,23,28672
v_accvgpr_write_b32 a71, v227
v_accvgpr_read_b32 v224, a64
Mvav 64,224,212
v_accvgpr_read_b32 v225, a65
v_accvgpr_read_b32 v226, a66
Mvav 32,224,208
v_accvgpr_read_b32 v227, a67
s_waitcnt lgkmcnt(2)
Mvav 36,228,208
Ta 240,24,24576
v_accvgpr_read_b32 v228, a72
Mvav 68,228,212
Ta 242,24,28672
v_accvgpr_read_b32 v229, a73
v_accvgpr_read_b32 v230, a74
Mvav 132,228,220
v_accvgpr_read_b32 v231, a75
v_cvt_pk_bf16_f32 v224, v224, v225
Mvav 100,228,216
v_cvt_pk_bf16_f32 v225, v226, v227
v_cvt_pk_bf16_f32 v226, v228, v229
Mvav 104,232,216
Ta 244,25,24576
Ta 246,25,28672
Mvav 136,232,220
v_exp_f32 v161, v161
v_cvt_pk_bf16_f32 v227, v230, v231
Mvav 72,232,212
v_permlane32_swap_b32 v224, v226
Mvav 40,232,208
v_permlane32_swap_b32 v225, v227
s_waitcnt lgkmcnt(2)
Mvav 44,236,208
Ta 248,26,24576
Ta 250,26,28672
v_exp_f32 v162, v162
Mvav 76,236,212
v_permlane16_swap_b32 v224, v226
v_exp_f32 v163, v163
Mvav 140,236,220
v_permlane16_swap_b32 v225, v227
v_cvt_pk_bf16_f32 v192, v160, v161
v_cvt_pk_bf16_f32 v193, v162, v163
Mvav 108,236,216
v_accvgpr_write_b32 a64, v224
v_accvgpr_write_b32 a65, v225
v_exp_f32 v168, v168
Mvav 112,240,216
Ta 252,27,24576
v_accvgpr_write_b32 a66, v226
v_exp_f32 v169, v169
Mvav 144,240,220
Ta 254,27,28672
v_accvgpr_write_b32 a67, v227
v_accvgpr_read_b32 v224, a84
v_exp_f32 v170, v170
Mvav 80,240,212
v_accvgpr_read_b32 v225, a85
v_exp_f32 v171, v171
Mvav 48,240,208
v_accvgpr_read_b32 v226, a86
v_cvt_pk_bf16_f32 v196, v168, v169
v_accvgpr_read_b32 v227, a87
v_cvt_pk_bf16_f32 v197, v170, v171
s_waitcnt lgkmcnt(2)
s_waitcnt vmcnt(20)
s_barrier
Mvav 52,244,208
Ba 224,16,49152
s_mov_b32 m0, s35
v_accvgpr_read_b32 v228, a92
v_exp_f32 v176, v176
Mvav 84,244,212
s_add_u32 s44, s38, 0x88000
v_accvgpr_read_b32 v229, a93
v_accvgpr_read_b32 v230, a94
v_exp_f32 v177, v177
Mvav 148,244,220
s_add_u32 s98, s16, s44
s_addc_u32 s99, s17, 0
v_accvgpr_read_b32 v231, a95
v_exp_f32 v178, v178
Mvav 116,244,216
GDMA 28,98,0
v_cvt_pk_bf16_f32 v224, v224, v225
v_cvt_pk_bf16_f32 v225, v226, v227
v_exp_f32 v179, v179
Mvav 120,248,216
Ba 228,17,49152
GDMA 29,98,1024
v_cvt_pk_bf16_f32 v226, v228, v229
v_cvt_pk_bf16_f32 v200, v176, v177
v_cvt_pk_bf16_f32 v201, v178, v179
Mvav 152,248,220
v_cvt_pk_bf16_f32 v227, v230, v231
v_exp_f32 v184, v184
Mvav 88,248,212
v_permlane32_swap_b32 v224, v226
v_exp_f32 v185, v185
Mvav 56,248,208
v_permlane32_swap_b32 v225, v227
v_exp_f32 v186, v186
s_waitcnt lgkmcnt(1)
Mvav 60,252,208
Ba 232,18,49152
GDMA 30,98,2048
v_exp_f32 v187, v187
Mvav 92,252,212
v_permlane16_swap_b32 v224, v226
v_cvt_pk_bf16_f32 v204, v184, v185
v_cvt_pk_bf16_f32 v205, v186, v187
Mvav 156,252,220
v_permlane16_swap_b32 v225, v227
v_exp_f32 v164, v164
Mvav 124,252,216
v_accvgpr_write_b32 a84, v224
v_accvgpr_write_b32 a85, v225
v_exp_f32 v165, v165
Zvaa 160,224,160
Ba 236,19,49152
GDMA 31,98,3072
v_accvgpr_write_b32 a86, v226
v_exp_f32 v166, v166
Zvaa 168,224,176
v_accvgpr_write_b32 a87, v227
v_accvgpr_read_b32 v224, a80
v_exp_f32 v167, v167
Zvaa 184,224,208
v_accvgpr_read_b32 v225, a81
v_cvt_pk_bf16_f32 v194, v164, v165
v_cvt_pk_bf16_f32 v195, v166, v167
Zvaa 176,224,192
v_accvgpr_read_b32 v226, a82
v_accvgpr_read_b32 v227, a83
v_exp_f32 v172, v172
s_waitcnt lgkmcnt(1)
Mvaa 160,228,164
Ba 240,16,53248
v_xor_b32 v16, 0x10000, v16
v_accvgpr_read_b32 v228, a88
v_exp_f32 v173, v173
Mvaa 168,228,180
v_accvgpr_read_b32 v229, a89
v_accvgpr_read_b32 v230, a90
v_exp_f32 v174, v174
Mvaa 184,228,212
v_accvgpr_read_b32 v231, a91
v_exp_f32 v175, v175
Mvaa 176,228,196
v_cvt_pk_bf16_f32 v224, v224, v225
v_cvt_pk_bf16_f32 v198, v172, v173
v_cvt_pk_bf16_f32 v225, v226, v227
v_cvt_pk_bf16_f32 v199, v174, v175
Mvaa 160,232,168
Ba 244,17,53248
v_xor_b32 v17, 0x10000, v17
v_cvt_pk_bf16_f32 v226, v228, v229
v_exp_f32 v180, v180
Mvaa 168,232,184
v_cvt_pk_bf16_f32 v227, v230, v231
v_exp_f32 v181, v181
Mvaa 184,232,216
v_permlane32_swap_b32 v224, v226
v_exp_f32 v182, v182
Mvaa 176,232,200
v_permlane32_swap_b32 v225, v227
v_exp_f32 v183, v183
s_waitcnt lgkmcnt(1)
Mvaa 160,236,172
Ba 248,18,53248
v_xor_b32 v18, 0x10000, v18
v_cvt_pk_bf16_f32 v202, v180, v181
v_cvt_pk_bf16_f32 v203, v182, v183
Mvaa 168,236,188
v_permlane16_swap_b32 v224, v226
v_exp_f32 v188, v188
Mvaa 184,236,220
v_permlane16_swap_b32 v225, v227
v_exp_f32 v189, v189
Mvaa 176,236,204
v_accvgpr_write_b32 a80, v224
v_accvgpr_write_b32 a81, v225
v_exp_f32 v190, v190
Zvaa 164,240,160
Ba 252,19,53248
v_xor_b32 v19, 0x10000, v19
v_accvgpr_write_b32 a82, v226
v_exp_f32 v191, v191
Zvaa 172,240,176
v_accvgpr_write_b32 a83, v227
v_cvt_pk_bf16_f32 v206, v188, v189
v_accvgpr_read_b32 v224, a100
v_cvt_pk_bf16_f32 v207, v190, v191
Zvaa 188,240,208
v_accvgpr_read_b32 v225, a101
v_accvgpr_read_b32 v226, a102
Zvaa 180,240,192
v_accvgpr_read_b32 v227, a103
s_waitcnt lgkmcnt(1)
Mvaa 164,244,164
v_accvgpr_read_b32 v228, a108
v_accvgpr_read_b32 v229, a109
Mvaa 172,244,180
v_accvgpr_read_b32 v230, a110
v_accvgpr_read_b32 v231, a111
Mvaa 188,244,212
v_cvt_pk_bf16_f32 v224, v224, v225
v_cvt_pk_bf16_f32 v225, v226, v227
Mvaa 180,244,196
v_cvt_pk_bf16_f32 v226, v228, v229
v_cvt_pk_bf16_f32 v227, v230, v231
Mvaa 164,248,168
Ta 224,20,40960
Ta 226,20,45056
Mvaa 172,248,184
v_permlane32_swap_b32 v224, v226
Mvaa 188,248,216
v_permlane32_swap_b32 v225, v227
Mvaa 180,248,200
s_waitcnt lgkmcnt(0)
Mvaa 164,252,172
Ta 228,21,40960
Ta 230,21,45056
Mvaa 172,252,188
v_permlane16_swap_b32 v224, v226
Mvaa 188,252,220
v_permlane16_swap_b32 v225, v227
Mvaa 180,252,204
v_accvgpr_write_b32 a100, v224
v_accvgpr_write_b32 a101, v225
Maav 128,144,192
Ta 232,22,40960
v_accvgpr_write_b32 a102, v226
Maav 132,144,196
Ta 234,22,45056
v_accvgpr_write_b32 a103, v227
v_accvgpr_read_b32 v224, a96
Maav 136,144,200
v_accvgpr_read_b32 v225, a97
v_accvgpr_read_b32 v226, a98
Maav 140,144,204
v_accvgpr_read_b32 v227, a99
v_accvgpr_read_b32 v228, a104
Mvav 96,224,200
Ta 236,23,40960
Ta 238,23,45056
Mvav 128,224,204
v_exp_f32 v160, v160
v_accvgpr_read_b32 v229, a105
v_accvgpr_read_b32 v230, a106
Mvav 64,224,196
v_accvgpr_read_b32 v231, a107
v_cvt_pk_bf16_f32 v224, v224, v225
Mvav 32,224,192
v_cvt_pk_bf16_f32 v225, v226, v227
s_waitcnt lgkmcnt(2)
Mvav 36,228,192
Ta 240,24,40960
v_cvt_pk_bf16_f32 v226, v228, v229
Mvav 68,228,196
Ta 242,24,45056
v_cvt_pk_bf16_f32 v227, v230, v231
Mvav 132,228,204
v_permlane32_swap_b32 v224, v226
Mvav 100,228,200
v_permlane32_swap_b32 v225, v227
Mvav 104,232,200
Ta 244,25,40960
Ta 246,25,45056
Mvav 136,232,204
v_permlane16_swap_b32 v224, v226
Mvav 72,232,196
v_permlane16_swap_b32 v225, v227
Mvav 40,232,192
v_accvgpr_write_b32 a96, v224
v_accvgpr_write_b32 a97, v225
v_exp_f32 v161, v161
s_waitcnt lgkmcnt(2)
Mvav 44,236,192
Ta 248,26,40960
v_accvgpr_write_b32 a98, v226
v_exp_f32 v162, v162
Mvav 76,236,196
Ta 250,26,45056
v_accvgpr_write_b32 a99, v227
v_accvgpr_read_b32 v224, a116
v_exp_f32 v163, v163
Mvav 140,236,204
v_accvgpr_read_b32 v225, a117
v_cvt_pk_bf16_f32 v208, v160, v161
v_cvt_pk_bf16_f32 v209, v162, v163
Mvav 108,236,200
v_accvgpr_read_b32 v226, a118
v_accvgpr_read_b32 v227, a119
v_exp_f32 v168, v168
Mvav 112,240,200
Ta 252,27,40960
v_accvgpr_read_b32 v228, a124
v_exp_f32 v169, v169
Mvav 144,240,204
Ta 254,27,45056
v_accvgpr_read_b32 v229, a125
v_accvgpr_read_b32 v230, a126
v_exp_f32 v170, v170
Mvav 80,240,196
v_accvgpr_read_b32 v231, a127
v_exp_f32 v171, v171
Mvav 48,240,192
v_cvt_pk_bf16_f32 v224, v224, v225
v_cvt_pk_bf16_f32 v212, v168, v169
v_cvt_pk_bf16_f32 v225, v226, v227
v_cvt_pk_bf16_f32 v213, v170, v171
s_waitcnt lgkmcnt(2)
s_waitcnt vmcnt(19)
s_barrier
Mvav 52,244,192
Ba 224,16,0
s_add_u32 m0, s35, 0x4000
v_cvt_pk_bf16_f32 v226, v228, v229
v_exp_f32 v176, v176
Mvav 84,244,196
s_add_u32 s44, s38, 0x8a000
v_cvt_pk_bf16_f32 v227, v230, v231
v_exp_f32 v177, v177
Mvav 148,244,204
s_add_u32 s98, s16, s44
s_addc_u32 s99, s17, 0
v_permlane32_swap_b32 v224, v226
v_exp_f32 v178, v178
Mvav 116,244,200
GDMA 28,98,0
v_permlane32_swap_b32 v225, v227
v_exp_f32 v179, v179
Mvav 120,248,200
Ba 228,17,0
GDMA 29,98,1024
v_cvt_pk_bf16_f32 v216, v176, v177
v_cvt_pk_bf16_f32 v217, v178, v179
Mvav 152,248,204
v_permlane16_swap_b32 v224, v226
v_exp_f32 v184, v184
Mvav 88,248,196
v_permlane16_swap_b32 v225, v227
v_exp_f32 v185, v185
Mvav 56,248,192
v_accvgpr_write_b32 a116, v224
v_accvgpr_write_b32 a117, v225
v_exp_f32 v186, v186
s_waitcnt lgkmcnt(1)
Mvav 60,252,192
Ba 232,18,0
GDMA 30,98,2048
v_accvgpr_write_b32 a118, v226
v_exp_f32 v187, v187
Mvav 92,252,196
v_accvgpr_write_b32 a119, v227
v_cvt_pk_bf16_f32 v220, v184, v185
v_accvgpr_read_b32 v224, a112
v_cvt_pk_bf16_f32 v221, v186, v187
Mvav 156,252,204
v_accvgpr_read_b32 v225, a113
v_exp_f32 v164, v164
Mvav 124,252,200
v_accvgpr_read_b32 v226, a114
v_accvgpr_read_b32 v227, a115
v_exp_f32 v165, v165
Zvaa 160,224,0
Ba 236,19,0
GDMA 31,98,3072
v_accvgpr_read_b32 v228, a120
v_exp_f32 v166, v166
Zvaa 168,224,4
v_accvgpr_read_b32 v229, a121
v_accvgpr_read_b32 v230, a122
v_exp_f32 v167, v167
Zvaa 184,224,68
v_accvgpr_read_b32 v231, a123
v_cvt_pk_bf16_f32 v210, v164, v165
v_cvt_pk_bf16_f32 v211, v166, v167
Zvaa 176,224,64
v_cvt_pk_bf16_f32 v224, v224, v225
v_cvt_pk_bf16_f32 v225, v226, v227
v_exp_f32 v172, v172
s_waitcnt lgkmcnt(1)
Mvaa 160,228,16
Ba 240,16,4096
v_cvt_pk_bf16_f32 v226, v228, v229
v_cvt_pk_bf16_f32 v227, v230, v231
v_exp_f32 v173, v173
Mvaa 168,228,20
v_exp_f32 v174, v174
Mvaa 184,228,84
v_permlane32_swap_b32 v224, v226
v_exp_f32 v175, v175
Mvaa 176,228,80
v_cvt_pk_bf16_f32 v214, v172, v173
v_permlane32_swap_b32 v225, v227
v_cvt_pk_bf16_f32 v215, v174, v175
Mvaa 160,232,32
Ba 244,17,4096
v_exp_f32 v180, v180
Mvaa 168,232,36
v_permlane16_swap_b32 v224, v226
v_exp_f32 v181, v181
Mvaa 184,232,100
v_permlane16_swap_b32 v225, v227
v_exp_f32 v182, v182
Mvaa 176,232,96
v_accvgpr_write_b32 a112, v224
v_accvgpr_write_b32 a113, v225
v_exp_f32 v183, v183
s_waitcnt lgkmcnt(1)
Mvaa 160,236,48
Ba 248,18,4096
v_accvgpr_write_b32 a114, v226
v_cvt_pk_bf16_f32 v218, v180, v181
v_accvgpr_write_b32 a115, v227
v_cvt_pk_bf16_f32 v219, v182, v183
Mvaa 168,236,52
v_exp_f32 v188, v188
Mvaa 184,236,116
v_exp_f32 v189, v189
Mvaa 176,236,112
v_exp_f32 v190, v190
Zvaa 164,240,0
Ba 252,19,4096
v_exp_f32 v191, v191
Zvaa 172,240,4
v_cvt_pk_bf16_f32 v222, v188, v189
v_cvt_pk_bf16_f32 v223, v190, v191
Zvaa 188,240,68
v_exp_f32 v160, v160
Zvaa 180,240,64
s_waitcnt lgkmcnt(1)
Mvaa 164,244,16
v_exp_f32 v161, v161
Mvaa 172,244,20
v_exp_f32 v162, v162
Mvaa 188,244,84
v_exp_f32 v163, v163
Mvaa 180,244,80
v_cvt_pk_bf16_f32 v192, v160, v161
v_cvt_pk_bf16_f32 v193, v162, v163
Mvaa 164,248,32
Ta 224,20,57344
Ta 226,20,61440
Mvaa 172,248,36
v_exp_f32 v168, v168
Mvaa 188,248,100
v_xor_b32 v20, 0x10000, v20
Mvaa 180,248,96
s_waitcnt lgkmcnt(0)
Mvaa 164,252,48
Ta 228,21,57344
Ta 230,21,61440
Mvaa 172,252,52
v_exp_f32 v169, v169
Mvaa 188,252,116
v_xor_b32 v21, 0x10000, v21
Mvaa 180,252,112
v_exp_f32 v170, v170
Maav 128,144,208
Ta 232,22,57344
Ta 234,22,61440
Maav 132,144,212
v_exp_f32 v171, v171
Maav 136,144,216
v_xor_b32 v22, 0x10000, v22
v_cvt_pk_bf16_f32 v196, v168, v169
Maav 140,144,220
v_cvt_pk_bf16_f32 v197, v170, v171
Mvav 96,224,216
Ta 236,23,57344
Ta 238,23,61440
Mvav 128,224,220
v_exp_f32 v176, v176
Mvav 64,224,212
v_xor_b32 v23, 0x10000, v23
Mvav 32,224,208
s_waitcnt lgkmcnt(2)
Mvav 36,228,208
Ta 240,24,57344
Ta 242,24,61440
Mvav 68,228,212
v_exp_f32 v177, v177
Mvav 132,228,220
v_xor_b32 v24, 0x10000, v24
v_accvgpr_read_b32 v232, a128
Mvav 100,228,216
v_accvgpr_read_b32 v233, a132
v_accvgpr_read_b32 v234, a136
Mvav 104,232,216
Ta 244,25,57344
Ta 246,25,61440
Mvav 136,232,220
v_exp_f32 v178, v178
Mvav 72,232,212
v_xor_b32 v25, 0x10000, v25
v_accvgpr_read_b32 v235, a140
Mvav 40,232,208
v_lshrrev_b32 v236, 23, v232
s_waitcnt lgkmcnt(2)
Mvav 44,236,208
Ta 248,26,57344
Ta 250,26,61440
Mvav 76,236,212
v_exp_f32 v179, v179
Mvav 140,236,220
v_xor_b32 v26, 0x10000, v26
v_subrev_u32 v236, 0x43, v236
Mvav 108,236,216
v_cvt_pk_bf16_f32 v200, v176, v177
v_cvt_pk_bf16_f32 v201, v178, v179
Mvav 112,240,216
Ta 252,27,57344
Ta 254,27,61440
Mvav 144,240,220
v_exp_f32 v184, v184
Mvav 80,240,212
v_xor_b32 v27, 0x10000, v27
v_lshrrev_b32 v237, 23, v233
Mvav 48,240,208
s_waitcnt lgkmcnt(2)
s_waitcnt vmcnt(18)
s_barrier
Mvav 52,244,208
Ba 224,16,16384
s_add_u32 m0, s35, 0x8000
Mvav 84,244,212
s_add_u32 s44, s38, 0x8c000
v_subrev_u32 v237, 0x43, v237
Mvav 148,244,220
s_add_u32 s98, s16, s44
s_addc_u32 s99, s17, 0
Mvav 116,244,216
GDMA 28,98,0
v_lshrrev_b32 v238, 23, v234
Mvav 120,248,216
Ba 228,17,16384
GDMA 29,98,1024
Mvav 152,248,220
v_exp_f32 v185, v185
Mvav 88,248,212
v_subrev_u32 v238, 0x43, v238
v_lshrrev_b32 v239, 23, v235
Mvav 56,248,208
v_exp_f32 v186, v186
s_waitcnt lgkmcnt(1)
Mvav 60,252,208
Ba 232,18,16384
GDMA 30,98,2048
v_subrev_u32 v239, 0x43, v239
v_exp_f32 v187, v187
Mvav 92,252,212
v_max_u32 v236, v236, v237
v_cvt_pk_bf16_f32 v204, v184, v185
v_max_u32 v238, v238, v239
v_cvt_pk_bf16_f32 v205, v186, v187
Mvav 156,252,220
v_max_u32 v236, v236, v238
v_exp_f32 v164, v164
v_cmp_lt_u32 vcc, 120, v236
Mvav 124,252,216
v_exp_f32 v165, v165
s_nop 7
s_nop 0
s_cbranch_vccnz L_slow0
L_back0:
Zvaa 160,224,0
Ba 236,19,16384
GDMA 31,98,3072
v_accvgpr_read_b32 v232, a128
v_accvgpr_read_b32 v233, a132
v_accvgpr_read_b32 v234, a136
v_accvgpr_read_b32 v235, a140
v_rcp_f32 v236, v232
v_rcp_f32 v237, v233
v_rcp_f32 v238, v234
v_rcp_f32 v239, v235
v_mul_f32 v32, v32, v236
v_mul_f32 v33, v33, v236
v_mul_f32 v34, v34, v236
v_mul_f32 v35, v35, v236
v_mul_f32 v36, v36, v236
v_mul_f32 v37, v37, v236
v_mul_f32 v38, v38, v236
v_mul_f32 v39, v39, v236
v_cvt_pk_bf16_f32 v32, v32, v33
v_cvt_pk_bf16_f32 v33, v34, v35
v_cvt_pk_bf16_f32 v34, v36, v37
v_cvt_pk_bf16_f32 v35, v38, v39
v_accvgpr_write_b32 a160, v32
v_accvgpr_write_b32 a161, v33
v_accvgpr_write_b32 a162, v34
v_accvgpr_write_b32 a163, v35
v_mul_f32 v64, v64, v237
v_mul_f32 v65, v65, v237
v_mul_f32 v66, v66, v237
v_mul_f32 v67, v67, v237
v_mul_f32 v68, v68, v237
v_mul_f32 v69, v69, v237
v_mul_f32 v70, v70, v237
v_mul_f32 v71, v71, v237
v_cvt_pk_bf16_f32 v64, v64, v65
v_cvt_pk_bf16_f32 v65, v66, v67
v_cvt_pk_bf16_f32 v66, v68, v69
v_cvt_pk_bf16_f32 v67, v70, v71
v_accvgpr_write_b32 a176, v64
v_accvgpr_write_b32 a177, v65
v_accvgpr_write_b32 a178, v66
v_accvgpr_write_b32 a179, v67
v_mul_f32 v96, v96, v238
v_mul_f32 v97, v97, v238
v_mul_f32 v98, v98, v238
v_mul_f32 v99, v99, v238
v_mul_f32 v100, v100, v238
v_mul_f32 v101, v101, v238
v_mul_f32 v102, v102, v238
v_mul_f32 v103, v103, v238
v_cvt_pk_bf16_f32 v96, v96, v97
v_cvt_pk_bf16_f32 v97, v98, v99
v_cvt_pk_bf16_f32 v98, v100, v101
v_cvt_pk_bf16_f32 v99, v102, v103
v_accvgpr_write_b32 a192, v96
v_accvgpr_write_b32 a193, v97
v_accvgpr_write_b32 a194, v98
v_accvgpr_write_b32 a195, v99
v_mul_f32 v128, v128, v239
v_mul_f32 v129, v129, v239
v_mul_f32 v130, v130, v239
v_mul_f32 v131, v131, v239
v_mul_f32 v132, v132, v239
v_mul_f32 v133, v133, v239
v_mul_f32 v134, v134, v239
v_mul_f32 v135, v135, v239
v_cvt_pk_bf16_f32 v128, v128, v129
v_cvt_pk_bf16_f32 v129, v130, v131
v_cvt_pk_bf16_f32 v130, v132, v133
v_cvt_pk_bf16_f32 v131, v134, v135
v_accvgpr_write_b32 a208, v128
v_accvgpr_write_b32 a209, v129
v_accvgpr_write_b32 a210, v130
v_accvgpr_write_b32 a211, v131
v_mul_f32 v40, v40, v236
v_mul_f32 v41, v41, v236
v_mul_f32 v42, v42, v236
v_mul_f32 v43, v43, v236
v_mul_f32 v44, v44, v236
v_mul_f32 v45, v45, v236
v_mul_f32 v46, v46, v236
v_mul_f32 v47, v47, v236
v_cvt_pk_bf16_f32 v40, v40, v41
v_cvt_pk_bf16_f32 v41, v42, v43
v_cvt_pk_bf16_f32 v42, v44, v45
v_cvt_pk_bf16_f32 v43, v46, v47
v_accvgpr_write_b32 a164, v40
v_accvgpr_write_b32 a165, v41
v_accvgpr_write_b32 a166, v42
v_accvgpr_write_b32 a167, v43
v_mul_f32 v72, v72, v237
v_mul_f32 v73, v73, v237
v_mul_f32 v74, v74, v237
v_mul_f32 v75, v75, v237
v_mul_f32 v76, v76, v237
v_mul_f32 v77, v77, v237
v_mul_f32 v78, v78, v237
v_mul_f32 v79, v79, v237
v_cvt_pk_bf16_f32 v72, v72, v73
v_cvt_pk_bf16_f32 v73, v74, v75
v_cvt_pk_bf16_f32 v74, v76, v77
v_cvt_pk_bf16_f32 v75, v78, v79
v_accvgpr_write_b32 a180, v72
v_accvgpr_write_b32 a181, v73
v_accvgpr_write_b32 a182, v74
v_accvgpr_write_b32 a183, v75
v_mul_f32 v104, v104, v238
v_mul_f32 v105, v105, v238
v_mul_f32 v106, v106, v238
v_mul_f32 v107, v107, v238
v_mul_f32 v108, v108, v238
v_mul_f32 v109, v109, v238
v_mul_f32 v110, v110, v238
v_mul_f32 v111, v111, v238
v_cvt_pk_bf16_f32 v104, v104, v105
v_cvt_pk_bf16_f32 v105, v106, v107
v_cvt_pk_bf16_f32 v106, v108, v109
v_cvt_pk_bf16_f32 v107, v110, v111
v_accvgpr_write_b32 a196, v104
v_accvgpr_write_b32 a197, v105
v_accvgpr_write_b32 a198, v106
v_accvgpr_write_b32 a199, v107
v_mul_f32 v136, v136, v239
v_mul_f32 v137, v137, v239
v_mul_f32 v138, v138, v239
v_mul_f32 v139, v139, v239
v_mul_f32 v140, v140, v239
v_mul_f32 v141, v141, v239
v_mul_f32 v142, v142, v239
v_mul_f32 v143, v143, v239
v_cvt_pk_bf16_f32 v136, v136, v137
v_cvt_pk_bf16_f32 v137, v138, v139
v_cvt_pk_bf16_f32 v138, v140, v141
v_cvt_pk_bf16_f32 v139, v142, v143
v_accvgpr_write_b32 a212, v136
v_accvgpr_write_b32 a213, v137
v_accvgpr_write_b32 a214, v138
v_accvgpr_write_b32 a215, v139
v_mul_f32 v48, v48, v236
v_mul_f32 v49, v49, v236
v_mul_f32 v50, v50, v236
v_mul_f32 v51, v51, v236
v_mul_f32 v52, v52, v236
v_mul_f32 v53, v53, v236
v_mul_f32 v54, v54, v236
v_exp_f32 v166, v166
v_mul_f32 v55, v55, v236
Zvaa 168,224,4
v_cvt_pk_bf16_f32 v48, v48, v49
v_exp_f32 v167, v167
v_cvt_pk_bf16_f32 v49, v50, v51
Zvaa 184,224,68
v_cvt_pk_bf16_f32 v194, v164, v165
v_cvt_pk_bf16_f32 v50, v52, v53
v_cvt_pk_bf16_f32 v195, v166, v167
v_cvt_pk_bf16_f32 v51, v54, v55
Zvaa 176,224,64
v_accvgpr_write_b32 a168, v48
v_exp_f32 v172, v172
v_accvgpr_write_b32 a169, v49
s_waitcnt lgkmcnt(1)
Mvaa 160,228,16
Ba 240,16,20480
v_accvgpr_write_b32 a170, v50
v_exp_f32 v173, v173
v_accvgpr_write_b32 a171, v51
Mvaa 168,228,20
v_mul_f32 v80, v80, v237
v_exp_f32 v174, v174
v_mul_f32 v81, v81, v237
Mvaa 184,228,84
v_mul_f32 v82, v82, v237
v_exp_f32 v175, v175
v_mul_f32 v83, v83, v237
Mvaa 176,228,80
v_cvt_pk_bf16_f32 v198, v172, v173
v_mul_f32 v84, v84, v237
v_cvt_pk_bf16_f32 v199, v174, v175
v_mul_f32 v85, v85, v237
Mvaa 160,232,32
Ba 244,17,20480
v_mul_f32 v86, v86, v237
v_exp_f32 v180, v180
v_mul_f32 v87, v87, v237
Mvaa 168,232,36
v_cvt_pk_bf16_f32 v80, v80, v81
v_exp_f32 v181, v181
v_cvt_pk_bf16_f32 v81, v82, v83
Mvaa 184,232,100
v_cvt_pk_bf16_f32 v82, v84, v85
v_exp_f32 v182, v182
v_cvt_pk_bf16_f32 v83, v86, v87
Mvaa 176,232,96
v_accvgpr_write_b32 a184, v80
v_exp_f32 v183, v183
v_accvgpr_write_b32 a185, v81
s_waitcnt lgkmcnt(1)
Mvaa 160,236,48
Ba 248,18,20480
v_cvt_pk_bf16_f32 v202, v180, v181
v_accvgpr_write_b32 a186, v82
v_cvt_pk_bf16_f32 v203, v182, v183
v_accvgpr_write_b32 a187, v83
Mvaa 168,236,52
v_mul_f32 v112, v112, v238
v_exp_f32 v188, v188
v_mul_f32 v113, v113, v238
Mvaa 184,236,116
v_mul_f32 v114, v114, v238
v_exp_f32 v189, v189
v_mul_f32 v115, v115, v238
Mvaa 176,236,112
v_mul_f32 v116, v116, v238
v_exp_f32 v190, v190
v_mul_f32 v117, v117, v238
Zvaa 164,240,0
Ba 252,19,20480
v_mul_f32 v118, v118, v238
v_exp_f32 v191, v191
v_mul_f32 v119, v119, v238
Zvaa 172,240,4
v_cvt_pk_bf16_f32 v206, v188, v189
v_cvt_pk_bf16_f32 v112, v112, v113
v_cvt_pk_bf16_f32 v207, v190, v191
v_cvt_pk_bf16_f32 v113, v114, v115
Zvaa 188,240,68
v_cvt_pk_bf16_f32 v114, v116, v117
v_cvt_pk_bf16_f32 v115, v118, v119
Zvaa 180,240,64
v_accvgpr_write_b32 a200, v112
v_accvgpr_write_b32 a201, v113
s_waitcnt lgkmcnt(1)
Mvaa 164,244,16
v_accvgpr_write_b32 a202, v114
v_accvgpr_write_b32 a203, v115
Mvaa 172,244,20
v_mul_f32 v144, v144, v239
v_mul_f32 v145, v145, v239
Mvaa 188,244,84
v_mul_f32 v146, v146, v239
v_mul_f32 v147, v147, v239
Mvaa 180,244,80
v_mul_f32 v148, v148, v239
v_mul_f32 v149, v149, v239
Mvaa 164,248,32
Ta 224,20,8192
v_mul_f32 v150, v150, v239
v_mul_f32 v151, v151, v239
Mvaa 172,248,36
Ta 226,20,12288
v_cvt_pk_bf16_f32 v144, v144, v145
v_cvt_pk_bf16_f32 v145, v146, v147
Mvaa 188,248,100
v_cvt_pk_bf16_f32 v146, v148, v149
v_cvt_pk_bf16_f32 v147, v150, v151
Mvaa 180,248,96
v_accvgpr_write_b32 a216, v144
v_accvgpr_write_b32 a217, v145
s_waitcnt lgkmcnt(0)
Mvaa 164,252,48
Ta 228,21,8192
v_accvgpr_write_b32 a218, v146
v_accvgpr_write_b32 a219, v147
Mvaa 172,252,52
Ta 230,21,12288
v_mul_f32 v56, v56, v236
v_mul_f32 v57, v57, v236
Mvaa 188,252,116
v_mul_f32 v58, v58, v236
v_mul_f32 v59, v59, v236
Mvaa 180,252,112
v_mul_f32 v60, v60, v236
v_mul_f32 v61, v61, v236
Zaav 128,144,192
Ta 232,22,8192
v_mul_f32 v62, v62, v236
v_mul_f32 v63, v63, v236
Zaav 132,144,196
Ta 234,22,12288
v_cvt_pk_bf16_f32 v56, v56, v57
v_cvt_pk_bf16_f32 v57, v58, v59
Zaav 136,144,200
v_cvt_pk_bf16_f32 v58, v60, v61
v_cvt_pk_bf16_f32 v59, v62, v63
Zaav 140,144,204
v_accvgpr_write_b32 a172, v56
v_accvgpr_write_b32 a173, v57
Zvav 96,224,200
Ta 236,23,8192
v_accvgpr_write_b32 a174, v58
v_accvgpr_write_b32 a175, v59
Zvav 128,224,204
Ta 238,23,12288
v_mul_f32 v88, v88, v237
v_mul_f32 v89, v89, v237
Zvav 64,224,196
v_mul_f32 v90, v90, v237
v_mul_f32 v91, v91, v237
Zvav 32,224,192
v_mul_f32 v92, v92, v237
v_mul_f32 v93, v93, v237
s_waitcnt lgkmcnt(2)
Zvav 36,228,192
Ta 240,24,8192
v_mul_f32 v94, v94, v237
v_mul_f32 v95, v95, v237
Zvav 68,228,196
Ta 242,24,12288
v_cvt_pk_bf16_f32 v88, v88, v89
v_cvt_pk_bf16_f32 v89, v90, v91
Zvav 132,228,204
v_cvt_pk_bf16_f32 v90, v92, v93
v_cvt_pk_bf16_f32 v91, v94, v95
Zvav 100,228,200
v_accvgpr_write_b32 a188, v88
v_accvgpr_write_b32 a189, v89
Zvav 104,232,200
Ta 244,25,8192
v_accvgpr_write_b32 a190, v90
v_accvgpr_write_b32 a191, v91
Zvav 136,232,204
Ta 246,25,12288
v_mul_f32 v120, v120, v238
v_mul_f32 v121, v121, v238
Zvav 72,232,196
v_mul_f32 v122, v122, v238
v_exp_f32 v160, v160
v_mul_f32 v123, v123, v238
Zvav 40,232,192
v_mul_f32 v124, v124, v238
v_exp_f32 v161, v161
v_mul_f32 v125, v125, v238
s_waitcnt lgkmcnt(2)
Zvav 44,236,192
Ta 248,26,8192
v_mul_f32 v126, v126, v238
v_exp_f32 v162, v162
v_mul_f32 v127, v127, v238
Zvav 76,236,196
Ta 250,26,12288
v_cvt_pk_bf16_f32 v120, v120, v121
v_exp_f32 v163, v163
v_cvt_pk_bf16_f32 v121, v122, v123
Zvav 140,236,204
v_cvt_pk_bf16_f32 v208, v160, v161
v_cvt_pk_bf16_f32 v122, v124, v125
v_cvt_pk_bf16_f32 v209, v162, v163
v_cvt_pk_bf16_f32 v123, v126, v127
Zvav 108,236,200
v_accvgpr_write_b32 a204, v120
v_exp_f32 v168, v168
v_accvgpr_write_b32 a205, v121
Zvav 112,240,200
Ta 252,27,8192
v_accvgpr_write_b32 a206, v122
v_exp_f32 v169, v169
v_accvgpr_write_b32 a207, v123
Zvav 144,240,204
Ta 254,27,12288
v_mul_f32 v152, v152, v239
v_exp_f32 v170, v170
v_mul_f32 v153, v153, v239
Zvav 80,240,196
v_mul_f32 v154, v154, v239
v_exp_f32 v171, v171
v_mul_f32 v155, v155, v239
Zvav 48,240,192
v_cvt_pk_bf16_f32 v212, v168, v169
v_mul_f32 v156, v156, v239
v_cvt_pk_bf16_f32 v213, v170, v171
v_mul_f32 v157, v157, v239
s_waitcnt lgkmcnt(2)
s_waitcnt vmcnt(17)
s_barrier
Zvav 52,244,192
Ba 224,16,32768
s_add_u32 m0, s35, 0xc000
v_mul_f32 v158, v158, v239
v_exp_f32 v176, v176
v_mul_f32 v159, v159, v239
Zvav 84,244,196
s_add_u32 s44, s38, 0x8e000
v_cvt_pk_bf16_f32 v152, v152, v153
v_exp_f32 v177, v177
v_cvt_pk_bf16_f32 v153, v154, v155
Zvav 148,244,204
s_add_u32 s98, s16, s44
s_addc_u32 s99, s17, 0
v_cvt_pk_bf16_f32 v154, v156, v157
v_exp_f32 v178, v178
v_cvt_pk_bf16_f32 v155, v158, v159
Zvav 116,244,200
GDMA 28,98,0
v_accvgpr_write_b32 a220, v152
v_exp_f32 v179, v179
v_accvgpr_write_b32 a221, v153
Zvav 120,248,200
Ba 228,17,32768
GDMA 29,98,1024
v_cvt_pk_bf16_f32 v216, v176, v177
v_accvgpr_write_b32 a222, v154
v_cvt_pk_bf16_f32 v217, v178, v179
v_accvgpr_write_b32 a223, v155
Zvav 152,248,204
v_exp_f32 v184, v184
Zvav 88,248,196
v_exp_f32 v185, v185
Zvav 56,248,192
v_exp_f32 v186, v186
s_waitcnt lgkmcnt(1)
Zvav 60,252,192
Ba 232,18,32768
GDMA 30,98,2048
v_exp_f32 v187, v187
Zvav 92,252,196
v_cvt_pk_bf16_f32 v220, v184, v185
v_cvt_pk_bf16_f32 v221, v186, v187
Zvav 156,252,204
v_exp_f32 v164, v164
Zvav 124,252,200
v_exp_f32 v165, v165
Zvaa 160,224,0
Ba 236,19,32768
GDMA 31,98,3072
v_exp_f32 v166, v166
Zvaa 168,224,4
v_exp_f32 v167, v167
Zvaa 184,224,68
v_cvt_pk_bf16_f32 v210, v164, v165
v_cvt_pk_bf16_f32 v211, v166, v167
Zvaa 176,224,64
v_exp_f32 v172, v172
s_waitcnt lgkmcnt(1)
Mvaa 160,228,16
Ba 240,16,36864
v_exp_f32 v173, v173
Mvaa 168,228,20
v_exp_f32 v174, v174
Mvaa 184,228,84
v_exp_f32 v175, v175
Mvaa 176,228,80
v_cvt_pk_bf16_f32 v214, v172, v173
v_cvt_pk_bf16_f32 v215, v174, v175
Mvaa 160,232,32
Ba 244,17,36864
v_exp_f32 v180, v180
Mvaa 168,232,36
v_exp_f32 v181, v181
Mvaa 184,232,100
v_exp_f32 v182, v182
Mvaa 176,232,96
v_exp_f32 v183, v183
s_waitcnt lgkmcnt(1)
Mvaa 160,236,48
Ba 248,18,36864
v_cvt_pk_bf16_f32 v218, v180, v181
v_cvt_pk_bf16_f32 v219, v182, v183
Mvaa 168,236,52
v_exp_f32 v188, v188
Mvaa 184,236,116
v_exp_f32 v189, v189
Mvaa 176,236,112
v_exp_f32 v190, v190
Zvaa 164,240,0
Ba 252,19,36864
v_exp_f32 v191, v191
Zvaa 172,240,4
v_cvt_pk_bf16_f32 v222, v188, v189
v_cvt_pk_bf16_f32 v223, v190, v191
Zvaa 188,240,68
v_exp_f32 v160, v160
Zvaa 180,240,64
s_waitcnt lgkmcnt(1)
Mvaa 164,244,16
v_exp_f32 v161, v161
Mvaa 172,244,20
v_exp_f32 v162, v162
Mvaa 188,244,84
v_exp_f32 v163, v163
Mvaa 180,244,80
v_cvt_pk_bf16_f32 v192, v160, v161
v_cvt_pk_bf16_f32 v193, v162, v163
Mvaa 164,248,32
Ta 224,20,24576
Ta 226,20,28672
Mvaa 172,248,36
v_exp_f32 v168, v168
Mvaa 188,248,100
v_exp_f32 v169, v169
Mvaa 180,248,96
s_waitcnt lgkmcnt(0)
Mvaa 164,252,48
Ta 228,21,24576
Ta 230,21,28672
Mvaa 172,252,52
v_exp_f32 v170, v170
Mvaa 188,252,116
v_exp_f32 v171, v171
Mvaa 180,252,112
v_cvt_pk_bf16_f32 v196, v168, v169
v_cvt_pk_bf16_f32 v197, v170, v171
Maav 128,144,208
Ta 232,22,24576
Ta 234,22,28672
Maav 132,144,212
v_exp_f32 v176, v176
Maav 136,144,216
v_exp_f32 v177, v177
Maav 140,144,220
v_exp_f32 v178, v178
Mvav 96,224,216
Ta 236,23,24576
Ta 238,23,28672
Mvav 128,224,220
v_exp_f32 v179, v179
Mvav 64,224,212
v_cvt_pk_bf16_f32 v200, v176, v177
v_cvt_pk_bf16_f32 v201, v178, v179
Mvav 32,224,208
s_waitcnt lgkmcnt(2)
Mvav 36,228,208
Ta 240,24,24576
Ta 242,24,28672
Mvav 68,228,212
v_exp_f32 v184, v184
Mvav 132,228,220
v_exp_f32 v185, v185
Mvav 100,228,216
v_exp_f32 v186, v186
Mvav 104,232,216
Ta 244,25,24576
Ta 246,25,28672
Mvav 136,232,220
v_exp_f32 v187, v187
Mvav 72,232,212
v_cvt_pk_bf16_f32 v204, v184, v185
v_cvt_pk_bf16_f32 v205, v186, v187
Mvav 40,232,208
s_waitcnt lgkmcnt(2)
Mvav 44,236,208
Ta 248,26,24576
Ta 250,26,28672
Mvav 76,236,212
v_exp_f32 v164, v164
Mvav 140,236,220
v_exp_f32 v165, v165
Mvav 108,236,216
v_exp_f32 v166, v166
Mvav 112,240,216
Ta 252,27,24576
Ta 254,27,28672
Mvav 144,240,220
v_exp_f32 v167, v167
Mvav 80,240,212
v_cvt_pk_bf16_f32 v194, v164, v165
v_cvt_pk_bf16_f32 v195, v166, v167
Mvav 48,240,208
s_waitcnt lgkmcnt(2)
s_waitcnt vmcnt(16)
s_barrier
Mvav 52,244,208
Ba 224,16,49152
s_add_u32 m0, s35, 0x10000
Mvav 84,244,212
s_add_u32 s44, s38, 0x90000
Mvav 148,244,220
s_add_u32 s98, s16, s44
s_addc_u32 s99, s17, 0
Mvav 116,244,216
GDMA 28,98,0
Mvav 120,248,216
Ba 228,17,49152
GDMA 29,98,1024
Mvav 152,248,220
v_exp_f32 v172, v172
Mvav 88,248,212
v_exp_f32 v173, v173
Mvav 56,248,208
s_waitcnt lgkmcnt(1)
Mvav 60,252,208
Ba 232,18,49152
GDMA 30,98,2048
Mvav 92,252,212
v_exp_f32 v174, v174
Mvav 156,252,220
v_exp_f32 v175, v175
Mvav 124,252,216
v_cvt_pk_bf16_f32 v198, v172, v173
v_cvt_pk_bf16_f32 v199, v174, v175
Zvaa 160,224,0
Ba 236,19,49152
GDMA 31,98,3072
Zvaa 168,224,4
v_exp_f32 v180, v180
Zvaa 184,224,68
v_exp_f32 v181, v181
Zvaa 176,224,64
s_waitcnt lgkmcnt(1)
Mvaa 160,228,16
Ba 240,16,53248
v_xor_b32 v16, 0x10000, v16
Mvaa 168,228,20
v_exp_f32 v182, v182
Mvaa 184,228,84
v_exp_f32 v183, v183
Mvaa 176,228,80
v_cvt_pk_bf16_f32 v202, v180, v181
v_cvt_pk_bf16_f32 v203, v182, v183
Mvaa 160,232,32
Ba 244,17,53248
v_xor_b32 v17, 0x10000, v17
Mvaa 168,232,36
v_exp_f32 v188, v188
Mvaa 184,232,100
v_exp_f32 v189, v189
Mvaa 176,232,96
s_waitcnt lgkmcnt(1)
Mvaa 160,236,48
Ba 248,18,53248
v_xor_b32 v18, 0x10000, v18
Mvaa 168,236,52
v_exp_f32 v190, v190
Mvaa 184,236,116
v_exp_f32 v191, v191
Mvaa 176,236,112
v_cvt_pk_bf16_f32 v206, v188, v189
v_cvt_pk_bf16_f32 v207, v190, v191
Zvaa 164,240,0
Ba 252,19,53248
v_xor_b32 v19, 0x10000, v19
Zvaa 172,240,4
v_exp_f32 v160, v160
Zvaa 188,240,68
v_exp_f32 v161, v161
Zvaa 180,240,64
s_waitcnt lgkmcnt(1)
Mvaa 164,244,16
v_exp_f32 v162, v162
Mvaa 172,244,20
v_exp_f32 v163, v163
Mvaa 188,244,84
v_cvt_pk_bf16_f32 v208, v160, v161
v_cvt_pk_bf16_f32 v209, v162, v163
Mvaa 180,244,80
v_exp_f32 v168, v168
Mvaa 164,248,32
Ta 224,20,40960
Ta 226,20,45056
Mvaa 172,248,36
v_exp_f32 v169, v169
Mvaa 188,248,100
v_exp_f32 v170, v170
Mvaa 180,248,96
s_waitcnt lgkmcnt(0)
Mvaa 164,252,48
Ta 228,21,40960
Ta 230,21,45056
Mvaa 172,252,52
v_exp_f32 v171, v171
Mvaa 188,252,116
v_cvt_pk_bf16_f32 v212, v168, v169
v_cvt_pk_bf16_f32 v213, v170, v171
Mvaa 180,252,112
v_exp_f32 v176, v176
Maav 128,144,192
Ta 232,22,40960
Ta 234,22,45056
Maav 132,144,196
v_exp_f32 v177, v177
Maav 136,144,200
v_exp_f32 v178, v178
Maav 140,144,204
v_exp_f32 v179, v179
Mvav 96,224,200
Ta 236,23,40960
v_cvt_pk_bf16_f32 v216, v176, v177
Mvav 128,224,204
Ta 238,23,45056
v_cvt_pk_bf16_f32 v217, v178, v179
Mvav 64,224,196
v_exp_f32 v184, v184
Mvav 32,224,192
s_waitcnt lgkmcnt(2)
Mvav 36,228,192
Ta 240,24,40960
Ta 242,24,45056
Mvav 68,228,196
v_exp_f32 v185, v185
Mvav 132,228,204
v_exp_f32 v186, v186
Mvav 100,228,200
v_exp_f32 v187, v187
Mvav 104,232,200
Ta 244,25,40960
v_cvt_pk_bf16_f32 v220, v184, v185
Mvav 136,232,204
Ta 246,25,45056
v_cvt_pk_bf16_f32 v221, v186, v187
Mvav 72,232,196
v_exp_f32 v164, v164
Mvav 40,232,192
s_waitcnt lgkmcnt(2)
Mvav 44,236,192
Ta 248,26,40960
Ta 250,26,45056
Mvav 76,236,196
v_exp_f32 v165, v165
Mvav 140,236,204
v_exp_f32 v166, v166
Mvav 108,236,200
v_exp_f32 v167, v167
Mvav 112,240,200
Ta 252,27,40960
v_cvt_pk_bf16_f32 v210, v164, v165
Mvav 144,240,204
Ta 254,27,45056
v_cvt_pk_bf16_f32 v211, v166, v167
Mvav 80,240,196
v_exp_f32 v172, v172
Mvav 48,240,192
s_waitcnt lgkmcnt(2)
s_waitcnt vmcnt(16)
s_barrier
Mvav 52,244,192
Ba 224,16,0
s_add_u32 m0, s35, 0x14000
Mvav 84,244,196
s_add_u32 s44, s38, 0x92000
Mvav 148,244,204
s_add_u32 s98, s16, s44
s_addc_u32 s99, s17, 0
Mvav 116,244,200
GDMA 28,98,0
Mvav 120,248,200
Ba 228,17,0
GDMA 29,98,1024
Mvav 152,248,204
v_exp_f32 v173, v173
Mvav 88,248,196
v_exp_f32 v174, v174
Mvav 56,248,192
s_waitcnt lgkmcnt(1)
Mvav 60,252,192
Ba 232,18,0
GDMA 30,98,2048
Mvav 92,252,196
v_exp_f32 v175, v175
Mvav 156,252,204
v_cvt_pk_bf16_f32 v214, v172, v173
v_cvt_pk_bf16_f32 v215, v174, v175
Mvav 124,252,200
v_exp_f32 v180, v180
Zvaa 160,224,0
Ba 236,19,0
GDMA 31,98,3072
Zvaa 168,224,4
v_exp_f32 v181, v181
Zvaa 184,224,68
v_exp_f32 v182, v182
Zvaa 176,224,64
s_lshl_b32 s81, s87, 2
s_waitcnt lgkmcnt(1)
Mvaa 160,228,16
Ba 240,16,4096
s_add_u32 s81, s81, s3
Mvaa 168,228,20
v_exp_f32 v183, v183
Mvaa 184,228,84
v_cvt_pk_bf16_f32 v218, v180, v181
v_cvt_pk_bf16_f32 v219, v182, v183
Mvaa 176,228,80
v_exp_f32 v188, v188
Mvaa 160,232,32
Ba 244,17,4096
s_mul_i32 s81, s81, 0x2400
Mvaa 168,232,36
v_exp_f32 v189, v189
Mvaa 184,232,100
v_exp_f32 v190, v190
Mvaa 176,232,96
s_mul_i32 s80, s32, 0x90000
s_waitcnt lgkmcnt(1)
Mvaa 160,236,48
Ba 248,18,4096
s_add_u32 s81, s81, s80
Mvaa 168,236,52
v_exp_f32 v191, v191
Mvaa 184,236,116
v_cvt_pk_bf16_f32 v222, v188, v189
v_cvt_pk_bf16_f32 v223, v190, v191
Mvaa 176,236,112
v_mul_u32_u24 v240, 0x48, v1
v_add_u32 v240, s81, v240
Zvaa 164,240,0
Ba 252,19,4096
buffer_load_dword a150, v240, s[12:15], 0 offen offset:0
Zvaa 172,240,4
v_exp_f32 v160, v160
Zvaa 188,240,68
v_exp_f32 v161, v161
Zvaa 180,240,64
v_add_u32 v240, 0x1200, v240
s_waitcnt lgkmcnt(1)
Mvaa 164,244,16
buffer_load_dword a151, v240, s[12:15], 0 offen offset:0
Mvaa 172,244,20
v_exp_f32 v162, v162
Mvaa 188,244,84
v_exp_f32 v163, v163
Mvaa 180,244,80
v_cvt_pk_bf16_f32 v192, v160, v161
v_cvt_pk_bf16_f32 v193, v162, v163
Mvaa 164,248,32
Ta 224,20,57344
Ta 226,20,61440
Mvaa 172,248,36
v_exp_f32 v168, v168
Mvaa 188,248,100
v_xor_b32 v20, 0x10000, v20
Mvaa 180,248,96
s_waitcnt lgkmcnt(0)
Mvaa 164,252,48
Ta 228,21,57344
Ta 230,21,61440
Mvaa 172,252,52
v_exp_f32 v169, v169
Mvaa 188,252,116
v_xor_b32 v21, 0x10000, v21
Mvaa 180,252,112
v_exp_f32 v170, v170
Maav 128,144,208
Ta 232,22,57344
Ta 234,22,61440
Maav 132,144,212
v_exp_f32 v171, v171
Maav 136,144,216
v_xor_b32 v22, 0x10000, v22
v_cvt_pk_bf16_f32 v196, v168, v169
Maav 140,144,220
v_cvt_pk_bf16_f32 v197, v170, v171
Mvav 96,224,216
Ta 236,23,57344
Ta 238,23,61440
Mvav 128,224,220
v_exp_f32 v176, v176
Mvav 64,224,212
v_xor_b32 v23, 0x10000, v23
Mvav 32,224,208
s_waitcnt lgkmcnt(2)
Mvav 36,228,208
Ta 240,24,57344
Ta 242,24,61440
Mvav 68,228,212
v_exp_f32 v177, v177
Mvav 132,228,220
v_xor_b32 v24, 0x10000, v24
Mvav 100,228,216
v_exp_f32 v178, v178
Mvav 104,232,216
Ta 244,25,57344
Ta 246,25,61440
Mvav 136,232,220
v_exp_f32 v179, v179
Mvav 72,232,212
v_xor_b32 v25, 0x10000, v25
v_cvt_pk_bf16_f32 v200, v176, v177
Mvav 40,232,208
v_cvt_pk_bf16_f32 v201, v178, v179
s_waitcnt lgkmcnt(2)
Mvav 44,236,208
Ta 248,26,57344
Ta 250,26,61440
Mvav 76,236,212
v_exp_f32 v184, v184
Mvav 140,236,220
v_xor_b32 v26, 0x10000, v26
Mvav 108,236,216
v_exp_f32 v185, v185
Mvav 112,240,216
Ta 252,27,57344
Ta 254,27,61440
Mvav 144,240,220
v_exp_f32 v186, v186
Mvav 80,240,212
v_xor_b32 v27, 0x10000, v27
Mvav 48,240,208
s_waitcnt lgkmcnt(2)
s_waitcnt vmcnt(18)
s_barrier
Mvav 52,244,208
Ba 224,16,16384
s_add_u32 m0, s35, 0x18000
Mvav 84,244,212
s_add_u32 s44, s38, 0x94000
s_lshl_b32 s45, s33, 2
Mvav 148,244,220
s_add_u32 s98, s16, s44
s_addc_u32 s99, s17, 0
Mvav 116,244,216
GDMA 28,98,0
v_mov_b32 v244, 0x7ffffff0
Mvav 120,248,216
Ba 228,17,16384
GDMA 29,98,1024
Mvav 152,248,220
v_exp_f32 v187, v187
Mvav 88,248,212
v_cvt_pk_bf16_f32 v204, v184, v185
v_cvt_pk_bf16_f32 v205, v186, v187
Mvav 56,248,208
v_mov_b32 v245, s45
s_waitcnt lgkmcnt(1)
Mvav 60,252,208
Ba 232,18,16384
GDMA 30,98,2048
Mvav 92,252,212
v_exp_f32 v164, v164
Mvav 156,252,220
v_exp_f32 v165, v165
Mvav 124,252,216
v_exp_f32 v166, v166
Zvaa 160,224,0
Ba 236,19,16384
GDMA 31,98,3072
Zvaa 168,224,4
v_exp_f32 v167, v167
Zvaa 184,224,68
v_cvt_pk_bf16_f32 v194, v164, v165
v_cvt_pk_bf16_f32 v195, v166, v167
Zvaa 176,224,64
v_exp_f32 v172, v172
s_waitcnt lgkmcnt(1)
Mvaa 160,228,16
Ba 240,16,20480
v_exp_f32 v173, v173
Mvaa 168,228,20
v_exp_f32 v174, v174
Mvaa 184,228,84
v_exp_f32 v175, v175
Mvaa 176,228,80
v_cvt_pk_bf16_f32 v198, v172, v173
v_cvt_pk_bf16_f32 v199, v174, v175
Mvaa 160,232,32
Ba 244,17,20480
v_exp_f32 v180, v180
Mvaa 168,232,36
v_exp_f32 v181, v181
Mvaa 184,232,100
v_exp_f32 v182, v182
Mvaa 176,232,96
v_exp_f32 v183, v183
s_waitcnt lgkmcnt(1)
Mvaa 160,236,48
Ba 248,18,20480
v_cvt_pk_bf16_f32 v202, v180, v181
v_cvt_pk_bf16_f32 v203, v182, v183
Mvaa 168,236,52
v_exp_f32 v188, v188
Mvaa 184,236,116
v_exp_f32 v189, v189
Mvaa 176,236,112
v_exp_f32 v190, v190
Zvaa 164,240,0
Ba 252,19,20480
v_cndmask_b32 v244, v244, v245, s[92:93]
v_exp_f32 v191, v191
Zvaa 172,240,4
v_mov_b32 v245, 1
buffer_atomic_add v245, v244, s[68:71], 0 offen
v_cvt_pk_bf16_f32 v206, v188, v189
v_cvt_pk_bf16_f32 v207, v190, v191
Zvaa 188,240,68
v_exp_f32 v160, v160
Zvaa 180,240,64
s_waitcnt lgkmcnt(1)
Mvaa 164,244,16
v_exp_f32 v161, v161
Mvaa 172,244,20
v_exp_f32 v162, v162
Mvaa 188,244,84
v_exp_f32 v163, v163
Mvaa 180,244,80
v_cvt_pk_bf16_f32 v208, v160, v161
v_cvt_pk_bf16_f32 v209, v162, v163
Mvaa 164,248,32
Ta 224,20,8192
Ta 226,20,12288
Mvaa 172,248,36
v_exp_f32 v168, v168
Mvaa 188,248,100
v_exp_f32 v169, v169
Mvaa 180,248,96
s_waitcnt lgkmcnt(0)
Mvaa 164,252,48
Ta 228,21,8192
Ta 230,21,12288
Mvaa 172,252,52
v_exp_f32 v170, v170
Mvaa 188,252,116
v_exp_f32 v171, v171
Mvaa 180,252,112
v_cvt_pk_bf16_f32 v212, v168, v169
v_cvt_pk_bf16_f32 v213, v170, v171
Maav 128,144,192
Ta 232,22,8192
Ta 234,22,12288
Maav 132,144,196
v_exp_f32 v176, v176
Maav 136,144,200
v_exp_f32 v177, v177
Maav 140,144,204
v_exp_f32 v178, v178
Mvav 96,224,200
Ta 236,23,8192
Ta 238,23,12288
Mvav 128,224,204
v_exp_f32 v179, v179
Mvav 64,224,196
v_cvt_pk_bf16_f32 v216, v176, v177
v_cvt_pk_bf16_f32 v217, v178, v179
Mvav 32,224,192
s_waitcnt lgkmcnt(2)
Mvav 36,228,192
Ta 240,24,8192
Ta 242,24,12288
Mvav 68,228,196
v_exp_f32 v184, v184
Mvav 132,228,204
v_exp_f32 v185, v185
Mvav 100,228,200
v_exp_f32 v186, v186
Mvav 104,232,200
Ta 244,25,8192
Ta 246,25,12288
Mvav 136,232,204
v_exp_f32 v187, v187
Mvav 72,232,196
v_cvt_pk_bf16_f32 v220, v184, v185
v_cvt_pk_bf16_f32 v221, v186, v187
Mvav 40,232,192
s_waitcnt lgkmcnt(2)
Mvav 44,236,192
Ta 248,26,8192
Ta 250,26,12288
Mvav 76,236,196
v_exp_f32 v164, v164
Mvav 140,236,204
v_exp_f32 v165, v165
Mvav 108,236,200
v_exp_f32 v166, v166
Mvav 112,240,200
Ta 252,27,8192
Ta 254,27,12288
Mvav 144,240,204
v_exp_f32 v167, v167
Mvav 80,240,196
v_cvt_pk_bf16_f32 v210, v164, v165
v_cvt_pk_bf16_f32 v211, v166, v167
Mvav 48,240,192
s_waitcnt lgkmcnt(2)
s_waitcnt vmcnt(19)
s_barrier
Mvav 52,244,192
Ba 224,16,32768
s_add_u32 m0, s35, 0x1c000
Mvav 84,244,196
s_add_u32 s44, s38, 0x96000
Mvav 148,244,204
s_add_u32 s98, s16, s44
s_addc_u32 s99, s17, 0
Mvav 116,244,200
GDMA 28,98,0
Mvav 120,248,200
Ba 228,17,32768
GDMA 29,98,1024
Mvav 152,248,204
v_exp_f32 v172, v172
Mvav 88,248,196
v_exp_f32 v173, v173
Mvav 56,248,192
s_waitcnt lgkmcnt(1)
Mvav 60,252,192
Ba 232,18,32768
GDMA 30,98,2048
Mvav 92,252,196
v_exp_f32 v174, v174
Mvav 156,252,204
v_exp_f32 v175, v175
Mvav 124,252,200
v_cvt_pk_bf16_f32 v214, v172, v173
v_cvt_pk_bf16_f32 v215, v174, v175
Zvaa 160,224,0
Ba 236,19,32768
GDMA 31,98,3072
Zvaa 168,224,4
v_exp_f32 v180, v180
Zvaa 184,224,68
v_exp_f32 v181, v181
Zvaa 176,224,64
s_waitcnt lgkmcnt(1)
Mvaa 160,228,16
Ba 240,16,36864
Mvaa 168,228,20
v_exp_f32 v182, v182
Mvaa 184,228,84
v_exp_f32 v183, v183
Mvaa 176,228,80
v_cvt_pk_bf16_f32 v218, v180, v181
v_cvt_pk_bf16_f32 v219, v182, v183
Mvaa 160,232,32
Ba 244,17,36864
Mvaa 168,232,36
v_exp_f32 v188, v188
Mvaa 184,232,100
v_exp_f32 v189, v189
Mvaa 176,232,96
s_waitcnt lgkmcnt(1)
Mvaa 160,236,48
Ba 248,18,36864
Mvaa 168,236,52
v_exp_f32 v190, v190
Mvaa 184,236,116
v_exp_f32 v191, v191
Mvaa 176,236,112
v_cvt_pk_bf16_f32 v222, v188, v189
v_cvt_pk_bf16_f32 v223, v190, v191
Zvaa 164,240,0
Ba 252,19,36864
Zvaa 172,240,4
v_exp_f32 v160, v160
Zvaa 188,240,68
v_exp_f32 v161, v161
Zvaa 180,240,64
s_waitcnt lgkmcnt(1)
Mvaa 164,244,16
v_exp_f32 v162, v162
Mvaa 172,244,20
v_exp_f32 v163, v163
Mvaa 188,244,84
v_cvt_pk_bf16_f32 v192, v160, v161
v_cvt_pk_bf16_f32 v193, v162, v163
Mvaa 180,244,80
v_exp_f32 v168, v168
Mvaa 164,248,32
Ta 224,20,24576
Ta 226,20,28672
Mvaa 172,248,36
v_exp_f32 v169, v169
Mvaa 188,248,100
v_exp_f32 v170, v170
Mvaa 180,248,96
s_waitcnt lgkmcnt(0)
Mvaa 164,252,48
Ta 228,21,24576
Ta 230,21,28672
Mvaa 172,252,52
v_exp_f32 v171, v171
Mvaa 188,252,116
v_cvt_pk_bf16_f32 v196, v168, v169
v_cvt_pk_bf16_f32 v197, v170, v171
Mvaa 180,252,112
v_exp_f32 v176, v176
Maav 128,144,208
Ta 232,22,24576
Ta 234,22,28672
Maav 132,144,212
v_exp_f32 v177, v177
Maav 136,144,216
v_exp_f32 v178, v178
Maav 140,144,220
v_exp_f32 v179, v179
Mvav 96,224,216
Ta 236,23,24576
v_cvt_pk_bf16_f32 v200, v176, v177
Mvav 128,224,220
Ta 238,23,28672
v_cvt_pk_bf16_f32 v201, v178, v179
Mvav 64,224,212
v_exp_f32 v184, v184
Mvav 32,224,208
s_waitcnt lgkmcnt(2)
Mvav 36,228,208
Ta 240,24,24576
Ta 242,24,28672
Mvav 68,228,212
v_exp_f32 v185, v185
Mvav 132,228,220
v_exp_f32 v186, v186
Mvav 100,228,216
v_exp_f32 v187, v187
Mvav 104,232,216
Ta 244,25,24576
v_cvt_pk_bf16_f32 v204, v184, v185
Mvav 136,232,220
Ta 246,25,28672
v_cvt_pk_bf16_f32 v205, v186, v187
Mvav 72,232,212
v_exp_f32 v164, v164
Mvav 40,232,208
s_waitcnt lgkmcnt(2)
Mvav 44,236,208
Ta 248,26,24576
Ta 250,26,28672
Mvav 76,236,212
v_exp_f32 v165, v165
Mvav 140,236,220
v_exp_f32 v166, v166
Mvav 108,236,216
v_exp_f32 v167, v167
Mvav 112,240,216
Ta 252,27,24576
v_cvt_pk_bf16_f32 v194, v164, v165
Mvav 144,240,220
Ta 254,27,28672
v_cvt_pk_bf16_f32 v195, v166, v167
Mvav 80,240,212
v_exp_f32 v172, v172
Mvav 48,240,208
s_waitcnt lgkmcnt(2)
s_waitcnt vmcnt(19)
s_barrier
Mvav 52,244,208
Ba 224,16,49152
s_mov_b32 m0, s35
Mvav 84,244,212
s_add_u32 s44, s38, 0x98000
Mvav 148,244,220
s_add_u32 s98, s16, s44
s_addc_u32 s99, s17, 0
Mvav 116,244,216
GDMA 28,98,0
Mvav 120,248,216
Ba 228,17,49152
GDMA 29,98,1024
Mvav 152,248,220
v_exp_f32 v173, v173
Mvav 88,248,212
v_exp_f32 v174, v174
Mvav 56,248,208
s_waitcnt lgkmcnt(1)
Mvav 60,252,208
Ba 232,18,49152
GDMA 30,98,2048
Mvav 92,252,212
v_exp_f32 v175, v175
Mvav 156,252,220
v_cvt_pk_bf16_f32 v198, v172, v173
v_cvt_pk_bf16_f32 v199, v174, v175
Mvav 124,252,216
v_exp_f32 v180, v180
Zvaa 160,224,0
Ba 236,19,49152
GDMA 31,98,3072
Zvaa 168,224,4
v_exp_f32 v181, v181
Zvaa 184,224,68
v_exp_f32 v182, v182
Zvaa 176,224,64
s_waitcnt lgkmcnt(1)
Mvaa 160,228,16
Ba 240,16,53248
v_xor_b32 v16, 0x10000, v16
Mvaa 168,228,20
v_exp_f32 v183, v183
Mvaa 184,228,84
v_cvt_pk_bf16_f32 v202, v180, v181
v_cvt_pk_bf16_f32 v203, v182, v183
Mvaa 176,228,80
v_exp_f32 v188, v188
Mvaa 160,232,32
Ba 244,17,53248
v_xor_b32 v17, 0x10000, v17
Mvaa 168,232,36
v_exp_f32 v189, v189
Mvaa 184,232,100
v_exp_f32 v190, v190
Mvaa 176,232,96
s_waitcnt lgkmcnt(1)
Mvaa 160,236,48
Ba 248,18,53248
v_xor_b32 v18, 0x10000, v18
Mvaa 168,236,52
v_exp_f32 v191, v191
Mvaa 184,236,116
v_cvt_pk_bf16_f32 v206, v188, v189
v_cvt_pk_bf16_f32 v207, v190, v191
Mvaa 176,236,112
Zvaa 164,240,0
Ba 252,19,53248
v_xor_b32 v19, 0x10000, v19
Zvaa 172,240,4
v_exp_f32 v160, v160
Zvaa 188,240,68
v_exp_f32 v161, v161
Zvaa 180,240,64
s_waitcnt lgkmcnt(1)
Mvaa 164,244,16
v_exp_f32 v162, v162
Mvaa 172,244,20
v_exp_f32 v163, v163
Mvaa 188,244,84
v_cvt_pk_bf16_f32 v208, v160, v161
v_cvt_pk_bf16_f32 v209, v162, v163
Mvaa 180,244,80
v_exp_f32 v168, v168
Mvaa 164,248,32
Ta 224,20,40960
Ta 226,20,45056
Mvaa 172,248,36
v_exp_f32 v169, v169
Mvaa 188,248,100
v_exp_f32 v170, v170
Mvaa 180,248,96
s_waitcnt lgkmcnt(0)
Mvaa 164,252,48
Ta 228,21,40960
Ta 230,21,45056
Mvaa 172,252,52
v_exp_f32 v171, v171
Mvaa 188,252,116
v_cvt_pk_bf16_f32 v212, v168, v169
v_cvt_pk_bf16_f32 v213, v170, v171
Mvaa 180,252,112
v_exp_f32 v176, v176
Maav 128,144,192
Ta 232,22,40960
Ta 234,22,45056
Maav 132,144,196
v_exp_f32 v177, v177
Maav 136,144,200
v_exp_f32 v178, v178
Maav 140,144,204
v_exp_f32 v179, v179
Mvav 96,224,200
Ta 236,23,40960
v_cvt_pk_bf16_f32 v216, v176, v177
Mvav 128,224,204
Ta 238,23,45056
v_cvt_pk_bf16_f32 v217, v178, v179
Mvav 64,224,196
v_exp_f32 v184, v184
Mvav 32,224,192
s_waitcnt lgkmcnt(2)
Mvav 36,228,192
Ta 240,24,40960
Ta 242,24,45056
Mvav 68,228,196
v_exp_f32 v185, v185
Mvav 132,228,204
v_exp_f32 v186, v186
Mvav 100,228,200
v_exp_f32 v187, v187
Mvav 104,232,200
Ta 244,25,40960
v_cvt_pk_bf16_f32 v220, v184, v185
Mvav 136,232,204
Ta 246,25,45056
v_cvt_pk_bf16_f32 v221, v186, v187
Mvav 72,232,196
v_exp_f32 v164, v164
Mvav 40,232,192
s_waitcnt lgkmcnt(2)
Mvav 44,236,192
Ta 248,26,40960
Ta 250,26,45056
Mvav 76,236,196
v_exp_f32 v165, v165
Mvav 140,236,204
v_exp_f32 v166, v166
Mvav 108,236,200
v_exp_f32 v167, v167
Mvav 112,240,200
Ta 252,27,40960
v_cvt_pk_bf16_f32 v210, v164, v165
Mvav 144,240,204
Ta 254,27,45056
v_cvt_pk_bf16_f32 v211, v166, v167
Mvav 80,240,196
v_exp_f32 v172, v172
Mvav 48,240,192
s_waitcnt lgkmcnt(2)
s_waitcnt vmcnt(19)
s_barrier
Mvav 52,244,192
Ba 224,16,0
s_add_u32 m0, s35, 0x4000
Mvav 84,244,196
s_add_u32 s44, s38, 0x9a000
Mvav 148,244,204
s_add_u32 s98, s16, s44
s_addc_u32 s99, s17, 0
Mvav 116,244,200
GDMA 28,98,0
Mvav 120,248,200
Ba 228,17,0
GDMA 29,98,1024
Mvav 152,248,204
v_exp_f32 v173, v173
Mvav 88,248,196
v_exp_f32 v174, v174
Mvav 56,248,192
s_waitcnt lgkmcnt(1)
Mvav 60,252,192
Ba 232,18,0
GDMA 30,98,2048
Mvav 92,252,196
v_exp_f32 v175, v175
Mvav 156,252,204
v_cvt_pk_bf16_f32 v214, v172, v173
v_cvt_pk_bf16_f32 v215, v174, v175
Mvav 124,252,200
v_exp_f32 v180, v180
Zvaa 160,224,0
Ba 236,19,0
GDMA 31,98,3072
Zvaa 168,224,4
v_exp_f32 v181, v181
Zvaa 184,224,68
v_exp_f32 v182, v182
Zvaa 176,224,64
s_mul_i32 s81, s33, 0x240000
s_waitcnt lgkmcnt(1)
Mvaa 160,228,16
Ba 240,16,4096
s_mov_b32 s56, s81
Mvaa 168,228,20
v_exp_f32 v183, v183
Mvaa 184,228,84
v_cvt_pk_bf16_f32 v218, v180, v181
v_cvt_pk_bf16_f32 v219, v182, v183
Mvaa 176,228,80
v_exp_f32 v188, v188
Mvaa 160,232,32
Ba 244,17,4096
s_add_u32 s57, s81, 0x24000
Mvaa 168,232,36
v_exp_f32 v189, v189
Mvaa 184,232,100
v_exp_f32 v190, v190
Mvaa 176,232,96
s_add_u32 s58, s81, 0x48000
s_waitcnt lgkmcnt(1)
Mvaa 160,236,48
Ba 248,18,4096
s_add_u32 s59, s81, 0x6c000
Mvaa 168,236,52
v_exp_f32 v191, v191
Mvaa 184,236,116
v_cvt_pk_bf16_f32 v222, v188, v189
v_cvt_pk_bf16_f32 v223, v190, v191
Mvaa 176,236,112
s_add_u32 s64, s81, 0x90000
s_add_u32 s65, s81, 0xb4000
Zvaa 164,240,0
Ba 252,19,4096
s_add_u32 s66, s81, 0xd8000
Zvaa 172,240,4
v_exp_f32 v160, v160
Zvaa 188,240,68
v_exp_f32 v161, v161
Zvaa 180,240,64
s_add_u32 s67, s81, 0xfc000
s_waitcnt lgkmcnt(1)
Mvaa 164,244,16
v_exp_f32 v162, v162
Mvaa 172,244,20
v_exp_f32 v163, v163
Mvaa 188,244,84
v_cvt_pk_bf16_f32 v192, v160, v161
v_cvt_pk_bf16_f32 v193, v162, v163
Mvaa 180,244,80
v_exp_f32 v168, v168
Mvaa 164,248,32
Ta 224,20,57344
Ta 226,20,61440
Mvaa 172,248,36
v_exp_f32 v169, v169
Mvaa 188,248,100
v_xor_b32 v20, 0x10000, v20
s_add_u32 s72, s81, 0x120000
Mvaa 180,248,96
s_add_u32 s73, s81, 0x144000
s_waitcnt lgkmcnt(0)
Mvaa 164,252,48
Ta 228,21,57344
Ta 230,21,61440
Mvaa 172,252,52
v_exp_f32 v170, v170
Mvaa 188,252,116
v_xor_b32 v21, 0x10000, v21
s_add_u32 s74, s81, 0x168000
Mvaa 180,252,112
v_exp_f32 v171, v171
Maav 128,144,208
Ta 232,22,57344
v_cvt_pk_bf16_f32 v196, v168, v169
Maav 132,144,212
Ta 234,22,61440
v_xor_b32 v22, 0x10000, v22
Maav 136,144,216
v_cvt_pk_bf16_f32 v197, v170, v171
s_add_u32 s75, s81, 0x18c000
Maav 140,144,220
v_exp_f32 v176, v176
Mvav 96,224,216
Ta 236,23,57344
Ta 238,23,61440
Mvav 128,224,220
v_exp_f32 v177, v177
Mvav 64,224,212
v_xor_b32 v23, 0x10000, v23
s_add_u32 s88, s81, 0x1b0000
Mvav 32,224,208
s_add_u32 s89, s81, 0x1d4000
s_waitcnt lgkmcnt(2)
Mvav 36,228,208
Ta 240,24,57344
Ta 242,24,61440
Mvav 68,228,212
v_exp_f32 v178, v178
Mvav 132,228,220
v_xor_b32 v24, 0x10000, v24
s_add_u32 s90, s81, 0x1f8000
Mvav 100,228,216
v_exp_f32 v179, v179
Mvav 104,232,216
Ta 244,25,57344
v_cvt_pk_bf16_f32 v200, v176, v177
Mvav 136,232,220
Ta 246,25,61440
v_xor_b32 v25, 0x10000, v25
Mvav 72,232,212
v_cvt_pk_bf16_f32 v201, v178, v179
s_add_u32 s91, s81, 0x21c000
Mvav 40,232,208
v_lshrrev_b32 v246, 4, v1
s_waitcnt lgkmcnt(2)
Mvav 44,236,208
Ta 248,26,57344
Ta 250,26,61440
Mvav 76,236,212
v_exp_f32 v184, v184
Mvav 140,236,220
v_xor_b32 v26, 0x10000, v26
v_lshlrev_b32 v246, 8, v246
Mvav 108,236,216
v_exp_f32 v185, v185
Mvav 112,240,216
Ta 252,27,57344
Ta 254,27,61440
Mvav 144,240,220
v_exp_f32 v186, v186
Mvav 80,240,212
v_xor_b32 v27, 0x10000, v27
v_bfe_u32 v247, v1, 3, 1
Mvav 48,240,208
s_waitcnt lgkmcnt(2)
s_waitcnt vmcnt(19)
s_barrier
Mvav 52,244,208
Ba 224,16,16384
s_add_u32 m0, s35, 0x8000
Mvav 84,244,212
s_add_u32 s44, s38, 0x9c000
v_lshl_or_b32 v246, v247, 11, v246
Mvav 148,244,220
s_add_u32 s98, s16, s44
s_addc_u32 s99, s17, 0
Mvav 116,244,216
GDMA 28,98,0
v_and_b32 v247, 7, v1
Mvav 120,248,216
Ba 228,17,16384
GDMA 29,98,1024
Mvav 152,248,220
v_exp_f32 v187, v187
Mvav 88,248,212
v_cvt_pk_bf16_f32 v204, v184, v185
v_cvt_pk_bf16_f32 v205, v186, v187
Mvav 56,248,208
v_lshl_or_b32 v246, v247, 4, v246
s_waitcnt lgkmcnt(1)
Mvav 60,252,208
Ba 232,18,16384
GDMA 30,98,2048
Mvav 92,252,212
v_exp_f32 v164, v164
Mvav 156,252,220
v_exp_f32 v165, v165
Mvav 124,252,216
v_exp_f32 v166, v166
Zvaa 160,224,0
Ba 236,19,16384
GDMA 31,98,3072
Zvaa 168,224,4
v_exp_f32 v167, v167
Zvaa 184,224,68
v_cvt_pk_bf16_f32 v194, v164, v165
v_cvt_pk_bf16_f32 v195, v166, v167
Zvaa 176,224,64
v_exp_f32 v172, v172
s_waitcnt lgkmcnt(1)
Mvaa 160,228,16
Ba 240,16,20480
v_exp_f32 v173, v173
Mvaa 168,228,20
v_exp_f32 v174, v174
Mvaa 184,228,84
v_exp_f32 v175, v175
Mvaa 176,228,80
v_cvt_pk_bf16_f32 v198, v172, v173
v_cvt_pk_bf16_f32 v199, v174, v175
Mvaa 160,232,32
Ba 244,17,20480
v_exp_f32 v180, v180
Mvaa 168,232,36
v_exp_f32 v181, v181
Mvaa 184,232,100
v_exp_f32 v182, v182
Mvaa 176,232,96
v_exp_f32 v183, v183
s_waitcnt lgkmcnt(1)
Mvaa 160,236,48
Ba 248,18,20480
v_cvt_pk_bf16_f32 v202, v180, v181
v_cvt_pk_bf16_f32 v203, v182, v183
Mvaa 168,236,52
v_exp_f32 v188, v188
Mvaa 184,236,116
v_exp_f32 v189, v189
Mvaa 176,236,112
v_exp_f32 v190, v190
Zvaa 164,240,0
Ba 252,19,20480
v_exp_f32 v191, v191
Zvaa 172,240,4
v_cvt_pk_bf16_f32 v206, v188, v189
v_cvt_pk_bf16_f32 v207, v190, v191
Zvaa 188,240,68
v_exp_f32 v160, v160
Zvaa 180,240,64
s_mov_b32 s79, s42
s_waitcnt lgkmcnt(1)
Mvaa 164,244,16
v_exp_f32 v161, v161
Mvaa 172,244,20
v_exp_f32 v162, v162
Mvaa 188,244,84
v_exp_f32 v163, v163
Mvaa 180,244,80
v_cvt_pk_bf16_f32 v208, v160, v161
v_cvt_pk_bf16_f32 v209, v162, v163
Mvaa 164,248,32
Ta 224,20,8192
Ta 226,20,12288
Mvaa 172,248,36
v_exp_f32 v168, v168
Mvaa 188,248,100
v_exp_f32 v169, v169
Mvaa 180,248,96
s_lshr_b32 s81, s79, 2
s_waitcnt lgkmcnt(0)
Mvaa 164,252,48
Ta 228,21,8192
Ta 230,21,12288
Mvaa 172,252,52
v_exp_f32 v170, v170
Mvaa 188,252,116
v_exp_f32 v171, v171
Mvaa 180,252,112
v_cvt_pk_bf16_f32 v212, v168, v169
v_cvt_pk_bf16_f32 v213, v170, v171
Maav 128,144,192
Ta 232,22,8192
Ta 234,22,12288
Maav 132,144,196
v_exp_f32 v176, v176
Maav 136,144,200
v_exp_f32 v177, v177
Maav 140,144,204
v_exp_f32 v178, v178
Mvav 96,224,200
Ta 236,23,8192
Ta 238,23,12288
Mvav 128,224,204
v_exp_f32 v179, v179
Mvav 64,224,196
v_cvt_pk_bf16_f32 v216, v176, v177
v_cvt_pk_bf16_f32 v217, v178, v179
Mvav 32,224,192
s_mul_i32 s81, s81, 0x9000
s_waitcnt lgkmcnt(2)
Mvav 36,228,192
Ta 240,24,8192
Ta 242,24,12288
Mvav 68,228,196
v_exp_f32 v184, v184
Mvav 132,228,204
v_exp_f32 v185, v185
Mvav 100,228,200
v_exp_f32 v186, v186
Mvav 104,232,200
Ta 244,25,8192
Ta 246,25,12288
Mvav 136,232,204
v_exp_f32 v187, v187
Mvav 72,232,196
v_cvt_pk_bf16_f32 v220, v184, v185
v_cvt_pk_bf16_f32 v221, v186, v187
Mvav 40,232,192
s_lshr_b32 s80, s79, 1
s_waitcnt lgkmcnt(2)
Mvav 44,236,192
Ta 248,26,8192
Ta 250,26,12288
Mvav 76,236,196
v_exp_f32 v164, v164
Mvav 140,236,204
s_and_b32 s80, s80, 1
s_lshl_b32 s80, s80, 10
Mvav 108,236,200
v_exp_f32 v165, v165
Mvav 112,240,200
Ta 252,27,8192
Ta 254,27,12288
Mvav 144,240,204
v_exp_f32 v166, v166
Mvav 80,240,196
s_add_u32 s81, s81, s80
s_and_b32 s80, s79, 1
Mvav 48,240,192
s_waitcnt lgkmcnt(2)
s_waitcnt vmcnt(17)
s_barrier
Mvav 52,244,192
Ba 224,16,32768
s_add_u32 m0, s35, 0xc000
Mvav 84,244,196
s_add_u32 s44, s38, 0x9e000
s_lshl_b32 s80, s80, 7
Mvav 148,244,204
s_add_u32 s98, s16, s44
s_addc_u32 s99, s17, 0
Mvav 116,244,200
GDMA 28,98,0
s_add_u32 s81, s81, s80
Mvav 120,248,200
Ba 228,17,32768
GDMA 29,98,1024
Mvav 152,248,204
v_exp_f32 v167, v167
Mvav 88,248,196
v_cvt_pk_bf16_f32 v210, v164, v165
v_cvt_pk_bf16_f32 v211, v166, v167
Mvav 56,248,192
s_lshl_b32 s80, s3, 12
s_waitcnt lgkmcnt(1)
Mvav 60,252,192
Ba 232,18,32768
GDMA 30,98,2048
Mvav 92,252,196
v_exp_f32 v172, v172
Mvav 156,252,204
s_add_u32 s81, s81, s80
v_add_u32 v248, s81, v246
Mvav 124,252,200
v_exp_f32 v173, v173
Zvaa 160,224,0
Ba 236,19,32768
GDMA 31,98,3072
Zvaa 168,224,4
s_lshl_b32 s81, s33, 7
s_lshl_b32 s80, s42, 3
Zvaa 184,224,68
v_exp_f32 v174, v174
Zvaa 176,224,64
s_add_u32 s81, s81, s80
s_waitcnt lgkmcnt(1)
Mvaa 160,228,16
Ba 240,16,36864
v_and_b32 v246, 7, v1
Mvaa 168,228,20
v_exp_f32 v175, v175
Mvaa 184,228,84
v_cvt_pk_bf16_f32 v214, v172, v173
v_cvt_pk_bf16_f32 v215, v174, v175
Mvaa 176,228,80
v_add_u32 v246, s81, v246
v_mul_u32_u24 v246, 0x480, v246
Mvaa 160,232,32
Ba 244,17,36864
v_exp_f32 v180, v180
Mvaa 168,232,36
s_lshl_b32 s81, s3, 7
v_exp_f32 v181, v181
Mvaa 184,232,100
v_add_u32 v246, s81, v246
v_exp_f32 v182, v182
Mvaa 176,232,96
v_bfe_u32 v247, v1, 3, 1
v_lshl_add_u32 v246, v247, 6, v246
v_exp_f32 v183, v183
s_waitcnt lgkmcnt(1)
Mvaa 160,236,48
Ba 248,18,36864
v_lshrrev_b32 v247, 4, v1
v_cvt_pk_bf16_f32 v218, v180, v181
v_cvt_pk_bf16_f32 v219, v182, v183
Mvaa 168,236,52
v_lshl_add_u32 v249, v247, 4, v246
s_lshl_b32 s81, s33, 7
v_exp_f32 v188, v188
Mvaa 184,236,116
s_add_u32 s81, s81, 0xc800000
v_exp_f32 v189, v189
Mvaa 176,236,112
v_and_b32 v246, 15, v1
v_lshlrev_b32 v246, 2, v246
v_exp_f32 v190, v190
Zvaa 164,240,0
Ba 252,19,36864
v_add_u32 v250, s81, v246
v_exp_f32 v191, v191
Zvaa 172,240,4
s_lshl_b32 s80, s42, 2
v_cvt_pk_bf16_f32 v222, v188, v189
s_add_u32 s80, s80, s81
v_cvt_pk_bf16_f32 v223, v190, v191
Zvaa 188,240,68
v_mov_b32 v246, 0x7ffffff0
v_mov_b32 v247, s80
Zvaa 180,240,64
v_cndmask_b32 v252, v246, v247, s[92:93]
s_waitcnt lgkmcnt(1)
Mvaa 164,244,16
s_lshl_b32 s81, s33, 2
v_mov_b32 v253, s81
Mvaa 172,244,20
v_mov_b32 v255, v250
Mvaa 188,244,84
v_exp_f32 v160, v160
Mvaa 180,244,80
s_cmp_eq_u32 s3, 0
s_cselect_b32 s81, 0, 0x3ffffff8
s_cselect_b32 s100, 1, 0
Mvaa 164,248,32
Ta 224,20,24576
v_add_u32 v250, s81, v250
v_add_u32 v253, s81, v253
Mvaa 172,248,36
Ta 226,20,28672
buffer_load_dword v251, v253, s[68:71], 0 offen offset:0 sc1
Mvaa 188,248,100
v_exp_f32 v161, v161
Mvaa 180,248,96
s_waitcnt lgkmcnt(0)
Mvaa 164,252,48
Ta 228,21,24576
Ta 230,21,28672
Mvaa 172,252,52
v_exp_f32 v162, v162
Mvaa 188,252,116
v_exp_f32 v163, v163
Mvaa 180,252,112
v_cvt_pk_bf16_f32 v192, v160, v161
v_cvt_pk_bf16_f32 v193, v162, v163
Maav 128,144,208
Ta 232,22,24576
Ta 234,22,28672
Maav 132,144,212
v_exp_f32 v168, v168
Maav 136,144,216
v_exp_f32 v169, v169
Maav 140,144,220
v_exp_f32 v170, v170
Mvav 96,224,216
Ta 236,23,24576
Ta 238,23,28672
Mvav 128,224,220
v_exp_f32 v171, v171
Mvav 64,224,212
v_cvt_pk_bf16_f32 v196, v168, v169
v_cvt_pk_bf16_f32 v197, v170, v171
Mvav 32,224,208
s_waitcnt lgkmcnt(2)
Mvav 36,228,208
Ta 240,24,24576
Ta 242,24,28672
Mvav 68,228,212
v_exp_f32 v176, v176
Mvav 132,228,220
v_exp_f32 v177, v177
Mvav 100,228,216
v_exp_f32 v178, v178
Mvav 104,232,216
Ta 244,25,24576
Ta 246,25,28672
Mvav 136,232,220
v_exp_f32 v179, v179
Mvav 72,232,212
v_cvt_pk_bf16_f32 v200, v176, v177
v_cvt_pk_bf16_f32 v201, v178, v179
Mvav 40,232,208
s_waitcnt lgkmcnt(2)
Mvav 44,236,208
Ta 248,26,24576
Ta 250,26,28672
Mvav 76,236,212
v_exp_f32 v184, v184
Mvav 140,236,220
v_exp_f32 v185, v185
Mvav 108,236,216
v_exp_f32 v186, v186
Mvav 112,240,216
Ta 252,27,24576
Ta 254,27,28672
Mvav 144,240,220
v_exp_f32 v187, v187
Mvav 80,240,212
v_cvt_pk_bf16_f32 v204, v184, v185
v_cvt_pk_bf16_f32 v205, v186, v187
Mvav 48,240,208
s_waitcnt lgkmcnt(2)
s_waitcnt vmcnt(17)
s_barrier
Mvav 52,244,208
Ba 224,16,49152
s_add_u32 m0, s35, 0x10000
Mvav 84,244,212
s_mov_b32 s44, s39
Mvav 148,244,220
s_add_u32 s98, s12, s44
s_addc_u32 s99, s13, 0
Mvav 116,244,216
GDMA 12,98,0
Mvav 120,248,216
Ba 228,17,49152
GDMA 13,98,1024
Mvav 152,248,220
v_exp_f32 v164, v164
Mvav 88,248,212
v_exp_f32 v165, v165
Mvav 56,248,208
s_waitcnt lgkmcnt(1)
Mvav 60,252,208
Ba 232,18,49152
GDMA 14,98,2048
Mvav 92,252,212
v_exp_f32 v166, v166
Mvav 156,252,220
v_exp_f32 v167, v167
Mvav 124,252,216
v_cvt_pk_bf16_f32 v194, v164, v165
v_cvt_pk_bf16_f32 v195, v166, v167
Zvaa 160,224,0
Ba 236,19,49152
GDMA 15,98,3072
Zvaa 168,224,4
v_exp_f32 v172, v172
Zvaa 184,224,68
v_exp_f32 v173, v173
Zvaa 176,224,64
s_waitcnt lgkmcnt(1)
Mvaa 160,228,16
Ba 240,16,53248
v_xor_b32 v16, 0x10000, v16
Mvaa 168,228,20
v_exp_f32 v174, v174
Mvaa 184,228,84
v_exp_f32 v175, v175
Mvaa 176,228,80
v_cvt_pk_bf16_f32 v198, v172, v173
v_cvt_pk_bf16_f32 v199, v174, v175
Mvaa 160,232,32
Ba 244,17,53248
v_xor_b32 v17, 0x10000, v17
v_exp_f32 v180, v180
Mvaa 168,232,36
v_exp_f32 v181, v181
Mvaa 184,232,100
v_exp_f32 v182, v182
Mvaa 176,232,96
v_exp_f32 v183, v183
s_waitcnt lgkmcnt(1)
Mvaa 160,236,48
Ba 248,18,53248
v_xor_b32 v18, 0x10000, v18
v_cvt_pk_bf16_f32 v202, v180, v181
v_cvt_pk_bf16_f32 v203, v182, v183
Mvaa 168,236,52
v_exp_f32 v188, v188
Mvaa 184,236,116
v_exp_f32 v189, v189
Mvaa 176,236,112
v_exp_f32 v190, v190
Zvaa 164,240,0
Ba 252,19,53248
v_xor_b32 v19, 0x10000, v19
v_exp_f32 v191, v191
Zvaa 172,240,4
v_cvt_pk_bf16_f32 v206, v188, v189
v_cvt_pk_bf16_f32 v207, v190, v191
Zvaa 188,240,68
v_exp_f32 v160, v160
Zvaa 180,240,64
s_waitcnt lgkmcnt(1)
Mvaa 164,244,16
v_exp_f32 v161, v161
Mvaa 172,244,20
v_exp_f32 v162, v162
Mvaa 188,244,84
v_exp_f32 v163, v163
Mvaa 180,244,80
v_cvt_pk_bf16_f32 v208, v160, v161
v_cvt_pk_bf16_f32 v209, v162, v163
Mvaa 164,248,32
Ta 224,20,40960
Ta 226,20,45056
Mvaa 172,248,36
v_exp_f32 v168, v168
Mvaa 188,248,100
v_exp_f32 v169, v169
Mvaa 180,248,96
s_waitcnt lgkmcnt(0)
Mvaa 164,252,48
Ta 228,21,40960
Ta 230,21,45056
Mvaa 172,252,52
v_exp_f32 v170, v170
Mvaa 188,252,116
v_exp_f32 v171, v171
Mvaa 180,252,112
v_cvt_pk_bf16_f32 v212, v168, v169
v_cvt_pk_bf16_f32 v213, v170, v171
Maav 128,144,192
Ta 232,22,40960
Ta 234,22,45056
Maav 132,144,196
v_exp_f32 v176, v176
Maav 136,144,200
v_exp_f32 v177, v177
Maav 140,144,204
v_exp_f32 v178, v178
Mvav 96,224,200
Ta 236,23,40960
Ta 238,23,45056
Mvav 128,224,204
v_exp_f32 v179, v179
Mvav 64,224,196
v_cvt_pk_bf16_f32 v216, v176, v177
v_cvt_pk_bf16_f32 v217, v178, v179
Mvav 32,224,192
s_waitcnt lgkmcnt(2)
Mvav 36,228,192
Ta 240,24,40960
Ta 242,24,45056
Mvav 68,228,196
v_exp_f32 v184, v184
Mvav 132,228,204
v_exp_f32 v185, v185
Mvav 100,228,200
v_exp_f32 v186, v186
Mvav 104,232,200
Ta 244,25,40960
Ta 246,25,45056
Mvav 136,232,204
v_exp_f32 v187, v187
Mvav 72,232,196
v_cvt_pk_bf16_f32 v220, v184, v185
v_cvt_pk_bf16_f32 v221, v186, v187
Mvav 40,232,192
s_waitcnt lgkmcnt(2)
Mvav 44,236,192
Ta 248,26,40960
Ta 250,26,45056
Mvav 76,236,196
v_exp_f32 v164, v164
Mvav 140,236,204
v_exp_f32 v165, v165
Mvav 108,236,200
v_exp_f32 v166, v166
Mvav 112,240,200
Ta 252,27,40960
Ta 254,27,45056
Mvav 144,240,204
v_exp_f32 v167, v167
Mvav 80,240,196
v_cvt_pk_bf16_f32 v210, v164, v165
v_cvt_pk_bf16_f32 v211, v166, v167
Mvav 48,240,192
s_waitcnt lgkmcnt(2)
s_waitcnt vmcnt(17)
s_barrier
Mvav 52,244,192
Ba 224,16,0
s_add_u32 m0, s35, 0x14000
Mvav 84,244,196
s_add_u32 s44, s39, 0x80
Mvav 148,244,204
s_add_u32 s98, s12, s44
s_addc_u32 s99, s13, 0
Mvav 116,244,200
GDMA 12,98,0
Mvav 120,248,200
Ba 228,17,0
GDMA 13,98,1024
Mvav 152,248,204
v_exp_f32 v172, v172
Mvav 88,248,196
v_exp_f32 v173, v173
Mvav 56,248,192
s_waitcnt lgkmcnt(1)
Mvav 60,252,192
Ba 232,18,0
GDMA 14,98,2048
Mvav 92,252,196
v_exp_f32 v174, v174
Mvav 156,252,204
v_exp_f32 v175, v175
Mvav 124,252,200
v_cvt_pk_bf16_f32 v214, v172, v173
v_cvt_pk_bf16_f32 v215, v174, v175
Zvaa 160,224,0
Ba 236,19,0
GDMA 15,98,3072
Zvaa 168,224,4
v_exp_f32 v180, v180
Zvaa 184,224,68
v_exp_f32 v181, v181
Zvaa 176,224,64
s_waitcnt lgkmcnt(1)
Mvaa 160,228,16
Ba 240,16,4096
Mvaa 168,228,20
v_exp_f32 v182, v182
Mvaa 184,228,84
v_exp_f32 v183, v183
Mvaa 176,228,80
v_cvt_pk_bf16_f32 v218, v180, v181
v_cvt_pk_bf16_f32 v219, v182, v183
Mvaa 160,232,32
Ba 244,17,4096
Mvaa 168,232,36
v_exp_f32 v188, v188
Mvaa 184,232,100
v_exp_f32 v189, v189
Mvaa 176,232,96
s_waitcnt lgkmcnt(1)
Mvaa 160,236,48
Ba 248,18,4096
Mvaa 168,236,52
v_exp_f32 v190, v190
Mvaa 184,236,116
v_exp_f32 v191, v191
Mvaa 176,236,112
v_cvt_pk_bf16_f32 v222, v188, v189
v_cvt_pk_bf16_f32 v223, v190, v191
Zvaa 164,240,0
Ba 252,19,4096
Zvaa 172,240,4
v_exp_f32 v160, v160
Zvaa 188,240,68
v_exp_f32 v161, v161
Zvaa 180,240,64
s_waitcnt lgkmcnt(1)
Mvaa 164,244,16
v_exp_f32 v162, v162
Mvaa 172,244,20
v_exp_f32 v163, v163
Mvaa 188,244,84
v_cvt_pk_bf16_f32 v192, v160, v161
v_cvt_pk_bf16_f32 v193, v162, v163
Mvaa 180,244,80
v_exp_f32 v168, v168
Mvaa 164,248,32
Ta 224,20,57344
Ta 226,20,61440
Mvaa 172,248,36
v_exp_f32 v169, v169
Mvaa 188,248,100
v_xor_b32 v20, 0x10000, v20
Mvaa 180,248,96
s_waitcnt lgkmcnt(0)
Mvaa 164,252,48
Ta 228,21,57344
s_mul_i32 s101, s100, 16
s_waitcnt vmcnt(8)
v_cmp_gt_u32 vcc, s101, v251
s_nop 4
s_cbranch_vccnz L_spin_att_cnt
L_spin_att_cnt_b:
Mvaa 172,252,52
Ta 230,21,61440
v_xor_b32 v21, 0x10000, v21
Mvaa 188,252,116
v_exp_f32 v170, v170
Mvaa 180,252,112
v_exp_f32 v171, v171
Maav 128,144,208
Ta 232,22,57344
v_cvt_pk_bf16_f32 v196, v168, v169
Maav 132,144,212
Ta 234,22,61440
v_xor_b32 v22, 0x10000, v22
Maav 136,144,216
v_cvt_pk_bf16_f32 v197, v170, v171
Maav 140,144,220
v_exp_f32 v176, v176
Mvav 96,224,216
Ta 236,23,57344
Ta 238,23,61440
Mvav 128,224,220
v_exp_f32 v177, v177
Mvav 64,224,212
v_xor_b32 v23, 0x10000, v23
Mvav 32,224,208
s_waitcnt lgkmcnt(2)
Mvav 36,228,208
Ta 240,24,57344
Ta 242,24,61440
Mvav 68,228,212
v_exp_f32 v178, v178
Mvav 132,228,220
v_xor_b32 v24, 0x10000, v24
Mvav 100,228,216
v_exp_f32 v179, v179
Mvav 104,232,216
Ta 244,25,57344
v_cvt_pk_bf16_f32 v200, v176, v177
Mvav 136,232,220
Ta 246,25,61440
v_xor_b32 v25, 0x10000, v25
Mvav 72,232,212
v_cvt_pk_bf16_f32 v201, v178, v179
Mvav 40,232,208
s_waitcnt lgkmcnt(2)
Mvav 44,236,208
Ta 248,26,57344
Ta 250,26,61440
Mvav 76,236,212
v_exp_f32 v184, v184
Mvav 140,236,220
v_xor_b32 v26, 0x10000, v26
Mvav 108,236,216
v_exp_f32 v185, v185
Mvav 112,240,216
Ta 252,27,57344
Ta 254,27,61440
Mvav 144,240,220
v_exp_f32 v186, v186
Mvav 80,240,212
v_xor_b32 v27, 0x10000, v27
Mvav 48,240,208
s_waitcnt lgkmcnt(2)
s_barrier
Mvav 52,244,208
Ba 224,16,16384
s_add_u32 m0, s35, 0x18000
Mvav 84,244,212
s_add_u32 s44, s39, 0x24000
Mvav 148,244,220
s_add_u32 s98, s12, s44
s_addc_u32 s99, s13, 0
Mvav 116,244,216
GDMA 12,98,0
Mvav 120,248,216
Ba 228,17,16384
GDMA 13,98,1024
Mvav 152,248,220
v_exp_f32 v187, v187
Mvav 88,248,212
v_cvt_pk_bf16_f32 v204, v184, v185
v_cvt_pk_bf16_f32 v205, v186, v187
Mvav 56,248,208
s_waitcnt lgkmcnt(1)
Mvav 60,252,208
Ba 232,18,16384
GDMA 14,98,2048
Mvav 92,252,212
v_exp_f32 v164, v164
Mvav 156,252,220
v_exp_f32 v165, v165
Mvav 124,252,216
v_exp_f32 v166, v166
Zvaa 160,224,0
Ba 236,19,16384
GDMA 15,98,3072
Zvaa 168,224,4
v_exp_f32 v167, v167
Zvaa 184,224,68
v_cvt_pk_bf16_f32 v194, v164, v165
v_cvt_pk_bf16_f32 v195, v166, v167
Zvaa 176,224,64
v_exp_f32 v172, v172
s_waitcnt lgkmcnt(1)
Mvaa 160,228,16
Ba 240,16,20480
v_exp_f32 v173, v173
Mvaa 168,228,20
v_exp_f32 v174, v174
Mvaa 184,228,84
v_exp_f32 v175, v175
Mvaa 176,228,80
v_cvt_pk_bf16_f32 v198, v172, v173
v_cvt_pk_bf16_f32 v199, v174, v175
Mvaa 160,232,32
Ba 244,17,20480
v_exp_f32 v180, v180
Mvaa 168,232,36
v_exp_f32 v181, v181
Mvaa 184,232,100
v_exp_f32 v182, v182
Mvaa 176,232,96
v_exp_f32 v183, v183
s_waitcnt lgkmcnt(1)
Mvaa 160,236,48
Ba 248,18,20480
v_cvt_pk_bf16_f32 v202, v180, v181
v_cvt_pk_bf16_f32 v203, v182, v183
Mvaa 168,236,52
v_exp_f32 v188, v188
Mvaa 184,236,116
v_exp_f32 v189, v189
Mvaa 176,236,112
v_exp_f32 v190, v190
Zvaa 164,240,0
Ba 252,19,20480
v_exp_f32 v191, v191
Zvaa 172,240,4
v_cvt_pk_bf16_f32 v206, v188, v189
v_cvt_pk_bf16_f32 v207, v190, v191
Zvaa 188,240,68
v_exp_f32 v160, v160
Zvaa 180,240,64
s_waitcnt lgkmcnt(1)
Mvaa 164,244,16
v_exp_f32 v161, v161
Mvaa 172,244,20
v_exp_f32 v162, v162
Mvaa 188,244,84
v_exp_f32 v163, v163
Mvaa 180,244,80
v_cvt_pk_bf16_f32 v208, v160, v161
v_cvt_pk_bf16_f32 v209, v162, v163
Mvaa 164,248,32
Ta 224,20,8192
Ta 226,20,12288
Mvaa 172,248,36
v_exp_f32 v168, v168
Mvaa 188,248,100
v_exp_f32 v169, v169
Mvaa 180,248,96
s_waitcnt lgkmcnt(0)
Mvaa 164,252,48
Ta 228,21,8192
Ta 230,21,12288
Mvaa 172,252,52
v_exp_f32 v170, v170
Mvaa 188,252,116
v_exp_f32 v171, v171
Mvaa 180,252,112
v_cvt_pk_bf16_f32 v212, v168, v169
v_cvt_pk_bf16_f32 v213, v170, v171
Maav 128,144,192
Ta 232,22,8192
Ta 234,22,12288
Maav 132,144,196
v_exp_f32 v176, v176
Maav 136,144,200
v_exp_f32 v177, v177
Maav 140,144,204
v_exp_f32 v178, v178
Mvav 96,224,200
Ta 236,23,8192
Ta 238,23,12288
Mvav 128,224,204
v_exp_f32 v179, v179
Mvav 64,224,196
v_cvt_pk_bf16_f32 v216, v176, v177
v_cvt_pk_bf16_f32 v217, v178, v179
Mvav 32,224,192
s_waitcnt lgkmcnt(2)
Mvav 36,228,192
Ta 240,24,8192
Ta 242,24,12288
Mvav 68,228,196
v_exp_f32 v184, v184
Mvav 132,228,204
v_exp_f32 v185, v185
Mvav 100,228,200
v_exp_f32 v186, v186
Mvav 104,232,200
Ta 244,25,8192
Ta 246,25,12288
Mvav 136,232,204
v_exp_f32 v187, v187
Mvav 72,232,196
v_cvt_pk_bf16_f32 v220, v184, v185
v_cvt_pk_bf16_f32 v221, v186, v187
Mvav 40,232,192
s_waitcnt lgkmcnt(2)
Mvav 44,236,192
Ta 248,26,8192
Ta 250,26,12288
Mvav 76,236,196
v_exp_f32 v164, v164
Mvav 140,236,204
v_exp_f32 v165, v165
Mvav 108,236,200
v_exp_f32 v166, v166
Mvav 112,240,200
Ta 252,27,8192
Ta 254,27,12288
Mvav 144,240,204
v_exp_f32 v167, v167
Mvav 80,240,196
v_cvt_pk_bf16_f32 v210, v164, v165
v_cvt_pk_bf16_f32 v211, v166, v167
Mvav 48,240,192
s_waitcnt lgkmcnt(2)
s_barrier
Mvav 52,244,192
Ba 224,16,32768
s_add_u32 m0, s35, 0x1c000
Mvav 84,244,196
s_add_u32 s44, s39, 0x24080
Mvav 148,244,204
s_add_u32 s98, s12, s44
s_addc_u32 s99, s13, 0
Mvav 116,244,200
GDMA 12,98,0
Mvav 120,248,200
Ba 228,17,32768
GDMA 13,98,1024
Mvav 152,248,204
v_exp_f32 v172, v172
Mvav 88,248,196
v_exp_f32 v173, v173
Mvav 56,248,192
s_waitcnt lgkmcnt(1)
Mvav 60,252,192
Ba 232,18,32768
GDMA 14,98,2048
Mvav 92,252,196
v_exp_f32 v174, v174
Mvav 156,252,204
v_exp_f32 v175, v175
Mvav 124,252,200
v_cvt_pk_bf16_f32 v214, v172, v173
v_cvt_pk_bf16_f32 v215, v174, v175
Zvaa 160,224,0
Ba 236,19,32768
GDMA 15,98,3072
Zvaa 168,224,4
v_exp_f32 v180, v180
Zvaa 184,224,68
v_exp_f32 v181, v181
Zvaa 176,224,64
s_waitcnt lgkmcnt(1)
Mvaa 160,228,16
Ba 240,16,36864
Mvaa 168,228,20
v_exp_f32 v182, v182
Mvaa 184,228,84
v_exp_f32 v183, v183
Mvaa 176,228,80
v_cvt_pk_bf16_f32 v218, v180, v181
v_cvt_pk_bf16_f32 v219, v182, v183
Mvaa 160,232,32
Ba 244,17,36864
Mvaa 168,232,36
v_exp_f32 v188, v188
Mvaa 184,232,100
v_exp_f32 v189, v189
Mvaa 176,232,96
s_waitcnt lgkmcnt(1)
Mvaa 160,236,48
Ba 248,18,36864
Mvaa 168,236,52
v_exp_f32 v190, v190
Mvaa 184,236,116
v_exp_f32 v191, v191
Mvaa 176,236,112
v_cvt_pk_bf16_f32 v222, v188, v189
v_cvt_pk_bf16_f32 v223, v190, v191
Zvaa 164,240,0
Ba 252,19,36864
Zvaa 172,240,4
v_exp_f32 v160, v160
Zvaa 188,240,68
v_exp_f32 v161, v161
Zvaa 180,240,64
s_waitcnt lgkmcnt(1)
Mvaa 164,244,16
v_exp_f32 v162, v162
Mvaa 172,244,20
v_exp_f32 v163, v163
Mvaa 188,244,84
v_cvt_pk_bf16_f32 v192, v160, v161
v_cvt_pk_bf16_f32 v193, v162, v163
Mvaa 180,244,80
v_exp_f32 v168, v168
Mvaa 164,248,32
Ta 224,20,24576
Ta 226,20,28672
Mvaa 172,248,36
v_exp_f32 v169, v169
Mvaa 188,248,100
v_exp_f32 v170, v170
Mvaa 180,248,96
s_waitcnt lgkmcnt(0)
Mvaa 164,252,48
Ta 228,21,24576
Ta 230,21,28672
Mvaa 172,252,52
v_exp_f32 v171, v171
Mvaa 188,252,116
v_cvt_pk_bf16_f32 v196, v168, v169
v_cvt_pk_bf16_f32 v197, v170, v171
Mvaa 180,252,112
v_exp_f32 v176, v176
Maav 128,144,208
Ta 232,22,24576
Ta 234,22,28672
Maav 132,144,212
v_exp_f32 v177, v177
Maav 136,144,216
v_exp_f32 v178, v178
Maav 140,144,220
v_exp_f32 v179, v179
Mvav 96,224,216
Ta 236,23,24576
v_cvt_pk_bf16_f32 v200, v176, v177
Mvav 128,224,220
Ta 238,23,28672
v_cvt_pk_bf16_f32 v201, v178, v179
Mvav 64,224,212
v_exp_f32 v184, v184
Mvav 32,224,208
s_waitcnt lgkmcnt(2)
Mvav 36,228,208
Ta 240,24,24576
Ta 242,24,28672
Mvav 68,228,212
v_exp_f32 v185, v185
Mvav 132,228,220
v_exp_f32 v186, v186
Mvav 100,228,216
v_exp_f32 v187, v187
Mvav 104,232,216
Ta 244,25,24576
v_cvt_pk_bf16_f32 v204, v184, v185
Mvav 136,232,220
Ta 246,25,28672
v_cvt_pk_bf16_f32 v205, v186, v187
Mvav 72,232,212
v_exp_f32 v164, v164
Mvav 40,232,208
s_waitcnt lgkmcnt(2)
Mvav 44,236,208
Ta 248,26,24576
Ta 250,26,28672
Mvav 76,236,212
v_exp_f32 v165, v165
Mvav 140,236,220
v_exp_f32 v166, v166
Mvav 108,236,216
v_exp_f32 v167, v167
Mvav 112,240,216
Ta 252,27,24576
v_cvt_pk_bf16_f32 v194, v164, v165
Mvav 144,240,220
Ta 254,27,28672
v_cvt_pk_bf16_f32 v195, v166, v167
Mvav 80,240,212
v_exp_f32 v172, v172
Mvav 48,240,208
s_waitcnt lgkmcnt(2)
s_barrier
Mvav 52,244,208
Ba 224,16,49152
s_mov_b32 m0, s35
Mvav 84,244,212
s_add_u32 s44, s39, 0x48000
Mvav 148,244,220
s_add_u32 s98, s12, s44
s_addc_u32 s99, s13, 0
Mvav 116,244,216
GDMA 12,98,0
Mvav 120,248,216
Ba 228,17,49152
GDMA 13,98,1024
Mvav 152,248,220
v_exp_f32 v173, v173
Mvav 88,248,212
v_exp_f32 v174, v174
Mvav 56,248,208
s_waitcnt lgkmcnt(1)
Mvav 60,252,208
Ba 232,18,49152
GDMA 14,98,2048
Mvav 92,252,212
v_exp_f32 v175, v175
Mvav 156,252,220
v_cvt_pk_bf16_f32 v198, v172, v173
v_cvt_pk_bf16_f32 v199, v174, v175
Mvav 124,252,216
v_exp_f32 v180, v180
Zvaa 160,224,0
Ba 236,19,49152
GDMA 15,98,3072
Zvaa 168,224,4
v_exp_f32 v181, v181
Zvaa 184,224,68
v_exp_f32 v182, v182
Zvaa 176,224,64
s_waitcnt lgkmcnt(1)
Mvaa 160,228,16
Ba 240,16,53248
Mvaa 168,228,20
v_exp_f32 v183, v183
Mvaa 184,228,84
v_cvt_pk_bf16_f32 v202, v180, v181
v_cvt_pk_bf16_f32 v203, v182, v183
Mvaa 176,228,80
v_exp_f32 v188, v188
Mvaa 160,232,32
Ba 244,17,53248
Mvaa 168,232,36
v_exp_f32 v189, v189
Mvaa 184,232,100
v_exp_f32 v190, v190
Mvaa 176,232,96
s_waitcnt lgkmcnt(1)
Mvaa 160,236,48
Ba 248,18,53248
Mvaa 168,236,52
v_exp_f32 v191, v191
Mvaa 184,236,116
v_cvt_pk_bf16_f32 v206, v188, v189
v_cvt_pk_bf16_f32 v207, v190, v191
Mvaa 176,236,112
Zvaa 164,240,0
Ba 252,19,53248
Zvaa 172,240,4
v_exp_f32 v160, v160
Zvaa 188,240,68
v_exp_f32 v161, v161
Zvaa 180,240,64
s_waitcnt lgkmcnt(1)
Mvaa 164,244,16
v_exp_f32 v162, v162
Mvaa 172,244,20
v_exp_f32 v163, v163
Mvaa 188,244,84
v_cvt_pk_bf16_f32 v208, v160, v161
v_cvt_pk_bf16_f32 v209, v162, v163
Mvaa 180,244,80
v_exp_f32 v168, v168
Mvaa 164,248,32
Ta 224,20,40960
Ta 226,20,45056
Mvaa 172,248,36
v_exp_f32 v169, v169
Mvaa 188,248,100
v_exp_f32 v170, v170
Mvaa 180,248,96
s_waitcnt lgkmcnt(0)
Mvaa 164,252,48
Ta 228,21,40960
Ta 230,21,45056
Mvaa 172,252,52
v_exp_f32 v171, v171
Mvaa 188,252,116
v_cvt_pk_bf16_f32 v212, v168, v169
v_cvt_pk_bf16_f32 v213, v170, v171
Mvaa 180,252,112
v_exp_f32 v176, v176
Maav 128,144,192
Ta 232,22,40960
Ta 234,22,45056
Maav 132,144,196
v_exp_f32 v177, v177
Maav 136,144,200
v_exp_f32 v178, v178
Maav 140,144,204
v_exp_f32 v179, v179
Mvav 96,224,200
Ta 236,23,40960
v_cvt_pk_bf16_f32 v216, v176, v177
Mvav 128,224,204
Ta 238,23,45056
v_cvt_pk_bf16_f32 v217, v178, v179
Mvav 64,224,196
v_exp_f32 v184, v184
Mvav 32,224,192
s_waitcnt lgkmcnt(2)
Mvav 36,228,192
Ta 240,24,40960
Ta 242,24,45056
Mvav 68,228,196
v_exp_f32 v185, v185
Mvav 132,228,204
v_exp_f32 v186, v186
Mvav 100,228,200
v_exp_f32 v187, v187
Mvav 104,232,200
Ta 244,25,40960
v_cvt_pk_bf16_f32 v220, v184, v185
Mvav 136,232,204
Ta 246,25,45056
v_cvt_pk_bf16_f32 v221, v186, v187
Mvav 72,232,196
v_exp_f32 v164, v164
Mvav 40,232,192
s_waitcnt lgkmcnt(2)
Mvav 44,236,192
Ta 248,26,40960
Ta 250,26,45056
Mvav 76,236,196
v_exp_f32 v165, v165
Mvav 140,236,204
v_exp_f32 v166, v166
Mvav 108,236,200
v_exp_f32 v167, v167
Mvav 112,240,200
Ta 252,27,40960
v_cvt_pk_bf16_f32 v210, v164, v165
Mvav 144,240,204
Ta 254,27,45056
v_cvt_pk_bf16_f32 v211, v166, v167
Mvav 80,240,196
v_exp_f32 v172, v172
Mvav 48,240,192
s_waitcnt lgkmcnt(2)
Mvav 52,244,192
v_exp_f32 v173, v173
Mvav 84,244,196
v_exp_f32 v174, v174
Mvav 148,244,204
v_exp_f32 v175, v175
Mvav 116,244,200
v_cvt_pk_bf16_f32 v214, v172, v173
v_cvt_pk_bf16_f32 v215, v174, v175
Mvav 120,248,200
Ta 224,20,57344
Ta 226,20,61440
v_exp_f32 v180, v180
Mvav 152,248,204
v_exp_f32 v181, v181
Mvav 88,248,196
v_exp_f32 v182, v182
Mvav 56,248,192
v_exp_f32 v183, v183
s_waitcnt lgkmcnt(0)
Mvav 60,252,192
Ta 228,21,57344
v_cvt_pk_bf16_f32 v218, v180, v181
v_cvt_pk_bf16_f32 v219, v182, v183
Mvav 92,252,196
Ta 230,21,61440
v_exp_f32 v188, v188
Mvav 156,252,204
v_exp_f32 v189, v189
Mvav 124,252,200
v_exp_f32 v190, v190
Maav 128,144,208
Ta 232,22,57344
Ta 234,22,61440
v_exp_f32 v191, v191
Maav 132,144,212
v_cvt_pk_bf16_f32 v222, v188, v189
v_cvt_pk_bf16_f32 v223, v190, v191
Maav 136,144,216
s_nop 0
Maav 140,144,220
Mvav 96,224,216
Ta 236,23,57344
Mvav 128,224,220
Ta 238,23,61440
Mvav 64,224,212
Mvav 32,224,208
s_waitcnt lgkmcnt(2)
Mvav 36,228,208
Ta 240,24,57344
Mvav 68,228,212
Ta 242,24,61440
v_accvgpr_read_b32 v232, a128
Mvav 132,228,220
v_accvgpr_read_b32 v233, a132
v_accvgpr_read_b32 v234, a136
Mvav 100,228,216
v_accvgpr_read_b32 v235, a140
v_lshrrev_b32 v236, 23, v232
Mvav 104,232,216
Ta 244,25,57344
v_subrev_u32 v236, 0x43, v236
Mvav 136,232,220
Ta 246,25,61440
v_lshrrev_b32 v237, 23, v233
Mvav 72,232,212
v_subrev_u32 v237, 0x43, v237
v_lshrrev_b32 v238, 23, v234
Mvav 40,232,208
v_subrev_u32 v238, 0x43, v238
s_waitcnt lgkmcnt(2)
Mvav 44,236,208
Ta 248,26,57344
v_lshrrev_b32 v239, 23, v235
Mvav 76,236,212
Ta 250,26,61440
v_subrev_u32 v239, 0x43, v239
Mvav 140,236,220
v_max_u32 v236, v236, v237
v_max_u32 v238, v238, v239
Mvav 108,236,216
v_max_u32 v236, v236, v238
v_cmp_lt_u32 vcc, 120, v236
Mvav 112,240,216
Ta 252,27,57344
Mvav 144,240,220
Ta 254,27,61440
Mvav 80,240,212
Mvav 48,240,208
s_waitcnt lgkmcnt(2)
s_waitcnt vmcnt(16)
s_barrier
Mvav 52,244,208
Ta 224,2,0
s_add_u32 m0, s35, 0x4000
Mvav 84,244,212
Ta 226,2,2048
s_add_u32 s44, s39, 0x48080
Mvav 148,244,220
Ta 228,3,0
s_add_u32 s98, s12, s44
s_addc_u32 s99, s13, 0
Mvav 116,244,216
Ta 230,3,2048
GDMA 12,98,0
Mvav 120,248,216
Ta 232,4,0
GDMA 13,98,1024
Mvav 152,248,220
Ta 234,4,2048
Mvav 88,248,212
Ta 236,5,0
Mvav 56,248,208
Ta 238,5,2048
s_waitcnt lgkmcnt(6)
Mvav 60,252,208
Ta 240,2,4096
GDMA 14,98,2048
Mvav 92,252,212
Ta 242,2,6144
Mvav 156,252,220
Ta 244,3,4096
Mvav 124,252,216
Ta 246,3,6144
s_nop 7
s_nop 0
s_cbranch_vccnz L_slow1
L_back1:
Zaaa 0,224,160
Ta 248,4,4096
GDMA 15,98,3072
Zaaa 4,224,176
Ta 250,4,6144
s_waitcnt lgkmcnt(4)
Zaaa 12,228,176
Ta 252,5,4096
s_add_u32 m0, s35, 0x8000
Zaaa 8,228,160
Ta 254,5,6144
s_add_u32 s44, s39, 0x6c000
Zaaa 16,232,160
Ta 224,2,8192
s_add_u32 s98, s12, s44
s_addc_u32 s99, s13, 0
Zaaa 20,232,176
Ta 226,2,10240
GDMA 12,98,0
Zaaa 28,236,176
Ta 228,3,8192
GDMA 13,98,1024
Zaaa 24,236,160
Ta 230,3,10240
GDMA 14,98,2048
Maaa 0,240,164
Ta 232,4,8192
GDMA 15,98,3072
Maaa 4,240,180
Ta 234,4,10240
s_waitcnt lgkmcnt(4)
Maaa 12,244,180
Ta 236,5,8192
v_accvgpr_read_b32 v232, a128
Maaa 8,244,164
Ta 238,5,10240
v_accvgpr_read_b32 v233, a132
Maaa 16,248,164
Ta 240,2,12288
v_accvgpr_read_b32 v234, a136
Maaa 20,248,180
Ta 242,2,14336
v_accvgpr_read_b32 v235, a140
Maaa 28,252,180
Ta 244,3,12288
Ta 246,3,14336
Maaa 24,252,164
v_rcp_f32 v236, v232
Maaa 0,224,168
Ta 248,4,12288
v_lshlrev_b32 v28, 4, v1
Maaa 4,224,184
Ta 250,4,14336
s_waitcnt lgkmcnt(4)
Maaa 12,228,184
Ta 252,5,12288
Maaa 8,228,168
Ta 254,5,14336
s_waitcnt vmcnt(20)
s_barrier
Maaa 16,232,168
Ta 224,2,16384
Ta 226,2,18432
Maaa 20,232,184
v_rcp_f32 v237, v233
Maaa 28,236,184
Ta 228,3,16384
Ta 230,3,18432
Maaa 24,236,168
v_rcp_f32 v238, v234
Maaa 0,240,172
Ta 232,4,16384
s_add_u32 m0, s35, 0xc000
Maaa 4,240,188
Ta 234,4,18432
s_waitcnt lgkmcnt(4)
Maaa 12,244,188
Ta 236,5,16384
Ta 238,5,18432
Maaa 8,244,172
v_rcp_f32 v239, v235
Maaa 16,248,172
Ta 240,2,20480
s_add_u32 s44, s39, 0x6c080
Maaa 20,248,188
Ta 242,2,22528
s_add_u32 s98, s12, s44
s_addc_u32 s99, s13, 0
Maaa 28,252,188
Ta 244,3,20480
GDMA 12,98,0
Maaa 24,252,172
Ta 246,3,22528
GDMA 13,98,1024
Zaaa 32,224,160
Ta 248,4,20480
GDMA 14,98,2048
Zaaa 36,224,176
Ta 250,4,22528
s_waitcnt lgkmcnt(4)
Zaaa 44,228,176
Ta 252,5,20480
GDMA 15,98,3072
Zaaa 40,228,160
Ta 254,5,22528
v_mul_f32 v32, v32, v236
Zaaa 48,232,160
Ta 224,2,24576
v_mul_f32 v33, v33, v236
Zaaa 52,232,176
Ta 226,2,26624
v_mul_f32 v34, v34, v236
Zaaa 60,236,176
Ta 228,3,24576
v_mul_f32 v35, v35, v236
Zaaa 56,236,160
Ta 230,3,26624
v_mul_f32 v36, v36, v236
Maaa 32,240,164
Ta 232,4,24576
v_mul_f32 v37, v37, v236
Maaa 36,240,180
Ta 234,4,26624
s_waitcnt lgkmcnt(4)
Maaa 44,244,180
Ta 236,5,24576
v_mul_f32 v38, v38, v236
Maaa 40,244,164
Ta 238,5,26624
v_mul_f32 v39, v39, v236
Maaa 48,248,164
Ta 240,2,28672
v_cvt_pk_bf16_f32 v160, v32, v33
Maaa 52,248,180
Ta 242,2,30720
v_cvt_pk_bf16_f32 v161, v34, v35
Maaa 60,252,180
Ta 244,3,28672
v_cvt_pk_bf16_f32 v162, v36, v37
Maaa 56,252,164
Ta 246,3,30720
v_cvt_pk_bf16_f32 v163, v38, v39
Maaa 32,224,168
Ta 248,4,28672
v_mul_f32 v64, v64, v237
Maaa 36,224,184
Ta 250,4,30720
s_waitcnt lgkmcnt(4)
Maaa 44,228,184
Ta 252,5,28672
v_mul_f32 v65, v65, v237
Maaa 40,228,168
Ta 254,5,30720
s_waitcnt vmcnt(20)
s_barrier
Maaa 48,232,168
Ta 224,2,32768
s_add_u32 m0, s35, 0x10000
Maaa 52,232,184
Ta 226,2,34816
s_add_u32 s44, s39, 0x100
Maaa 60,236,184
Ta 228,3,32768
s_add_u32 s98, s12, s44
s_addc_u32 s99, s13, 0
Maaa 56,236,168
Ta 230,3,34816
GDMA 12,98,0
Maaa 32,240,172
Ta 232,4,32768
GDMA 13,98,1024
Maaa 36,240,188
Ta 234,4,34816
s_waitcnt lgkmcnt(4)
Maaa 44,244,188
Ta 236,5,32768
v_mul_f32 v66, v66, v237
Maaa 40,244,172
Ta 238,5,34816
v_mul_f32 v67, v67, v237
Maaa 48,248,172
Ta 240,2,36864
GDMA 14,98,2048
Maaa 52,248,188
Ta 242,2,38912
v_mul_f32 v68, v68, v237
Maaa 60,252,188
Ta 244,3,36864
v_mul_f32 v69, v69, v237
Maaa 56,252,172
Ta 246,3,38912
v_mul_f32 v70, v70, v237
Maaa 0,224,192
Ta 248,4,36864
GDMA 15,98,3072
Maaa 4,224,208
Ta 250,4,38912
s_waitcnt lgkmcnt(4)
Maaa 12,228,208
Ta 252,5,36864
v_mul_f32 v71, v71, v237
Maaa 8,228,192
Ta 254,5,38912
v_cvt_pk_bf16_f32 v176, v64, v65
Maaa 16,232,192
Ta 224,2,40960
v_cvt_pk_bf16_f32 v177, v66, v67
Maaa 20,232,208
Ta 226,2,43008
v_cvt_pk_bf16_f32 v178, v68, v69
Maaa 28,236,208
Ta 228,3,40960
v_cvt_pk_bf16_f32 v179, v70, v71
Maaa 24,236,192
Ta 230,3,43008
v_mul_f32 v96, v96, v238
Maaa 0,240,196
Ta 232,4,40960
v_mul_f32 v97, v97, v238
Maaa 4,240,212
Ta 234,4,43008
s_waitcnt lgkmcnt(4)
Maaa 12,244,212
Ta 236,5,40960
v_mul_f32 v98, v98, v238
Maaa 8,244,196
Ta 238,5,43008
v_mul_f32 v99, v99, v238
Maaa 16,248,196
Ta 240,2,45056
v_mul_f32 v100, v100, v238
Maaa 20,248,212
Ta 242,2,47104
v_mul_f32 v101, v101, v238
Maaa 28,252,212
Ta 244,3,45056
v_mul_f32 v102, v102, v238
Maaa 24,252,196
Ta 246,3,47104
v_mul_f32 v103, v103, v238
Maaa 0,224,200
Ta 248,4,45056
v_cvt_pk_bf16_f32 v192, v96, v97
Maaa 4,224,216
Ta 250,4,47104
s_waitcnt lgkmcnt(4)
Maaa 12,228,216
Ta 252,5,45056
v_cvt_pk_bf16_f32 v193, v98, v99
Maaa 8,228,200
Ta 254,5,47104
s_waitcnt vmcnt(20)
s_barrier
Maaa 16,232,200
Ta 224,2,49152
s_add_u32 m0, s35, 0x14000
v_cvt_pk_bf16_f32 v194, v100, v101
v_cvt_pk_bf16_f32 v195, v102, v103
Maaa 20,232,216
Ta 226,2,51200
s_add_u32 s44, s39, 0x24100
v_mul_f32 v128, v128, v239
v_mul_f32 v129, v129, v239
Maaa 28,236,216
Ta 228,3,49152
s_add_u32 s98, s12, s44
s_addc_u32 s99, s13, 0
v_mul_f32 v130, v130, v239
v_mul_f32 v131, v131, v239
Maaa 24,236,200
Ta 230,3,51200
GDMA 12,98,0
v_mul_f32 v132, v132, v239
v_mul_f32 v133, v133, v239
Maaa 0,240,204
Ta 232,4,49152
GDMA 13,98,1024
v_mul_f32 v134, v134, v239
v_mul_f32 v135, v135, v239
Maaa 4,240,220
Ta 234,4,51200
v_cvt_pk_bf16_f32 v208, v128, v129
v_cvt_pk_bf16_f32 v209, v130, v131
s_waitcnt lgkmcnt(4)
Maaa 12,244,220
Ta 236,5,49152
v_cvt_pk_bf16_f32 v210, v132, v133
v_cvt_pk_bf16_f32 v211, v134, v135
Maaa 8,244,204
Ta 238,5,51200
v_mul_f32 v40, v40, v236
v_mul_f32 v41, v41, v236
Maaa 16,248,204
Ta 240,2,53248
GDMA 14,98,2048
v_mul_f32 v42, v42, v236
v_mul_f32 v43, v43, v236
Maaa 20,248,220
Ta 242,2,55296
v_mul_f32 v44, v44, v236
v_mul_f32 v45, v45, v236
Maaa 28,252,220
Ta 244,3,53248
v_mul_f32 v46, v46, v236
v_mul_f32 v47, v47, v236
Maaa 24,252,204
Ta 246,3,55296
v_cvt_pk_bf16_f32 v164, v40, v41
v_cvt_pk_bf16_f32 v165, v42, v43
Maaa 32,224,192
Ta 248,4,53248
GDMA 15,98,3072
v_cvt_pk_bf16_f32 v166, v44, v45
v_cvt_pk_bf16_f32 v167, v46, v47
Maaa 36,224,208
Ta 250,4,55296
v_mul_f32 v72, v72, v237
v_mul_f32 v73, v73, v237
s_waitcnt lgkmcnt(4)
Maaa 44,228,208
Ta 252,5,53248
v_mul_f32 v74, v74, v237
v_mul_f32 v75, v75, v237
Maaa 40,228,192
Ta 254,5,55296
v_mul_f32 v76, v76, v237
v_mul_f32 v77, v77, v237
Maaa 48,232,192
Ta 224,2,57344
v_mul_f32 v78, v78, v237
v_mul_f32 v79, v79, v237
Maaa 52,232,208
Ta 226,2,59392
v_cvt_pk_bf16_f32 v180, v72, v73
v_cvt_pk_bf16_f32 v181, v74, v75
Maaa 60,236,208
Ta 228,3,57344
v_cvt_pk_bf16_f32 v182, v76, v77
v_cvt_pk_bf16_f32 v183, v78, v79
Maaa 56,236,192
Ta 230,3,59392
v_mul_f32 v104, v104, v238
v_mul_f32 v105, v105, v238
Maaa 32,240,196
Ta 232,4,57344
v_mul_f32 v106, v106, v238
v_mul_f32 v107, v107, v238
Maaa 36,240,212
Ta 234,4,59392
v_mul_f32 v108, v108, v238
v_mul_f32 v109, v109, v238
s_waitcnt lgkmcnt(4)
Maaa 44,244,212
Ta 236,5,57344
v_mul_f32 v110, v110, v238
v_mul_f32 v111, v111, v238
Maaa 40,244,196
Ta 238,5,59392
v_cvt_pk_bf16_f32 v196, v104, v105
v_cvt_pk_bf16_f32 v197, v106, v107
Maaa 48,248,196
Ta 240,2,61440
v_cvt_pk_bf16_f32 v198, v108, v109
v_cvt_pk_bf16_f32 v199, v110, v111
Maaa 52,248,212
Ta 242,2,63488
v_xor_b32 v2, 0x10000, v2
v_mul_f32 v136, v136, v239
v_mul_f32 v137, v137, v239
Maaa 60,252,212
Ta 244,3,61440
v_mul_f32 v138, v138, v239
v_mul_f32 v139, v139, v239
Maaa 56,252,196
Ta 246,3,63488
v_xor_b32 v3, 0x10000, v3
v_mul_f32 v140, v140, v239
v_mul_f32 v141, v141, v239
Maaa 32,224,200
Ta 248,4,61440
v_mul_f32 v142, v142, v239
v_mul_f32 v143, v143, v239
Maaa 36,224,216
Ta 250,4,63488
v_cvt_pk_bf16_f32 v212, v136, v137
v_cvt_pk_bf16_f32 v213, v138, v139
s_waitcnt lgkmcnt(4)
Maaa 44,228,216
Ta 252,5,61440
v_xor_b32 v4, 0x10000, v4
v_cvt_pk_bf16_f32 v214, v140, v141
v_cvt_pk_bf16_f32 v215, v142, v143
Maaa 40,228,200
Ta 254,5,63488
v_mul_f32 v48, v48, v236
v_mul_f32 v49, v49, v236
s_waitcnt vmcnt(20)
s_barrier
Maaa 48,232,200
Ta 224,2,0
v_xor_b32 v5, 0x10000, v5
v_mul_f32 v50, v50, v236
v_mul_f32 v51, v51, v236
Maaa 52,232,216
Ta 226,2,2048
s_add_u32 m0, s35, 0x18000
v_mul_f32 v52, v52, v236
v_mul_f32 v53, v53, v236
Maaa 60,236,216
Ta 228,3,0
s_add_u32 s44, s39, 0x48100
v_mul_f32 v54, v54, v236
v_mul_f32 v55, v55, v236
Maaa 56,236,200
Ta 230,3,2048
s_add_u32 s98, s12, s44
s_addc_u32 s99, s13, 0
v_cvt_pk_bf16_f32 v168, v48, v49
v_cvt_pk_bf16_f32 v169, v50, v51
Maaa 32,240,204
Ta 232,4,0
GDMA 12,98,0
v_cvt_pk_bf16_f32 v170, v52, v53
v_cvt_pk_bf16_f32 v171, v54, v55
Maaa 36,240,220
Ta 234,4,2048
v_mul_f32 v80, v80, v237
v_mul_f32 v81, v81, v237
s_waitcnt lgkmcnt(4)
Maaa 44,244,220
Ta 236,5,0
GDMA 13,98,1024
v_mul_f32 v82, v82, v237
v_mul_f32 v83, v83, v237
Maaa 40,244,204
Ta 238,5,2048
v_mul_f32 v84, v84, v237
v_mul_f32 v85, v85, v237
Maaa 48,248,204
Ta 240,2,4096
GDMA 14,98,2048
v_mul_f32 v86, v86, v237
v_mul_f32 v87, v87, v237
Maaa 52,248,220
Ta 242,2,6144
v_cvt_pk_bf16_f32 v184, v80, v81
v_cvt_pk_bf16_f32 v185, v82, v83
Maaa 60,252,220
Ta 244,3,4096
v_cvt_pk_bf16_f32 v186, v84, v85
v_cvt_pk_bf16_f32 v187, v86, v87
Maaa 56,252,204
Ta 246,3,6144
v_mul_f32 v112, v112, v238
v_mul_f32 v113, v113, v238
Maav 0,224,160
Ta 248,4,4096
GDMA 15,98,3072
v_mul_f32 v114, v114, v238
v_mul_f32 v115, v115, v238
Maav 4,224,176
Ta 250,4,6144
v_mul_f32 v116, v116, v238
v_mul_f32 v117, v117, v238
s_waitcnt lgkmcnt(4)
Maav 12,228,176
Ta 252,5,4096
v_mul_f32 v118, v118, v238
v_mul_f32 v119, v119, v238
Maav 8,228,160
Ta 254,5,6144
v_cvt_pk_bf16_f32 v200, v112, v113
v_cvt_pk_bf16_f32 v201, v114, v115
Maav 16,232,160
Ta 224,2,8192
v_cvt_pk_bf16_f32 v202, v116, v117
v_cvt_pk_bf16_f32 v203, v118, v119
Maav 20,232,176
Ta 226,2,10240
v_mul_f32 v144, v144, v239
v_mul_f32 v145, v145, v239
Maav 28,236,176
Ta 228,3,8192
v_mul_f32 v146, v146, v239
v_mul_f32 v147, v147, v239
Maav 24,236,160
Ta 230,3,10240
v_mul_f32 v148, v148, v239
v_mul_f32 v149, v149, v239
Maav 0,240,164
Ta 232,4,8192
v_mul_f32 v150, v150, v239
v_mul_f32 v151, v151, v239
Maav 4,240,180
Ta 234,4,10240
v_cvt_pk_bf16_f32 v216, v144, v145
v_cvt_pk_bf16_f32 v217, v146, v147
s_waitcnt lgkmcnt(4)
Maav 12,244,180
Ta 236,5,8192
v_cvt_pk_bf16_f32 v218, v148, v149
v_cvt_pk_bf16_f32 v219, v150, v151
Maav 8,244,164
Ta 238,5,10240
v_mul_f32 v56, v56, v236
v_mul_f32 v57, v57, v236
Maav 16,248,164
Ta 240,2,12288
v_mul_f32 v58, v58, v236
v_mul_f32 v59, v59, v236
Maav 20,248,180
Ta 242,2,14336
v_mul_f32 v60, v60, v236
v_mul_f32 v61, v61, v236
Maav 28,252,180
Ta 244,3,12288
v_mul_f32 v62, v62, v236
v_mul_f32 v63, v63, v236
Maav 24,252,164
Ta 246,3,14336
v_cvt_pk_bf16_f32 v172, v56, v57
v_cvt_pk_bf16_f32 v173, v58, v59
Maav 0,224,168
Ta 248,4,12288
v_cvt_pk_bf16_f32 v174, v60, v61
v_cvt_pk_bf16_f32 v175, v62, v63
Maav 4,224,184
Ta 250,4,14336
v_mul_f32 v88, v88, v237
v_mul_f32 v89, v89, v237
s_waitcnt lgkmcnt(4)
Maav 12,228,184
Ta 252,5,12288
v_mul_f32 v90, v90, v237
v_mul_f32 v91, v91, v237
Maav 8,228,168
Ta 254,5,14336
v_mul_f32 v92, v92, v237
v_mul_f32 v93, v93, v237
s_waitcnt vmcnt(20)
s_barrier
Maav 16,232,168
Ta 224,2,16384
s_add_u32 m0, s35, 0x1c000
v_mul_f32 v94, v94, v237
v_mul_f32 v95, v95, v237
Maav 20,232,184
Ta 226,2,18432
s_add_u32 s44, s39, 0x6c100
v_cvt_pk_bf16_f32 v188, v88, v89
v_cvt_pk_bf16_f32 v189, v90, v91
Maav 28,236,184
Ta 228,3,16384
s_add_u32 s98, s12, s44
s_addc_u32 s99, s13, 0
v_cvt_pk_bf16_f32 v190, v92, v93
v_cvt_pk_bf16_f32 v191, v94, v95
Maav 24,236,168
Ta 230,3,18432
GDMA 12,98,0
Maav 0,240,172
Ta 232,4,16384
GDMA 13,98,1024
Maav 4,240,188
Ta 234,4,18432
s_waitcnt lgkmcnt(4)
Maav 12,244,188
Ta 236,5,16384
v_mul_f32 v120, v120, v238
Maav 8,244,172
Ta 238,5,18432
v_mul_f32 v121, v121, v238
Maav 16,248,172
Ta 240,2,20480
GDMA 14,98,2048
Maav 20,248,188
Ta 242,2,22528
v_mul_f32 v122, v122, v238
Maav 28,252,188
Ta 244,3,20480
v_mul_f32 v123, v123, v238
Maav 24,252,172
Ta 246,3,22528
v_mul_f32 v124, v124, v238
Maav 32,224,160
Ta 248,4,20480
GDMA 15,98,3072
Maav 36,224,176
Ta 250,4,22528
s_waitcnt lgkmcnt(4)
Maav 44,228,176
Ta 252,5,20480
v_mul_f32 v125, v125, v238
Maav 40,228,160
Ta 254,5,22528
v_mul_f32 v126, v126, v238
Maav 48,232,160
Ta 224,2,24576
v_mul_f32 v127, v127, v238
Maav 52,232,176
Ta 226,2,26624
v_cvt_pk_bf16_f32 v204, v120, v121
Maav 60,236,176
Ta 228,3,24576
v_cvt_pk_bf16_f32 v205, v122, v123
Maav 56,236,160
Ta 230,3,26624
v_cvt_pk_bf16_f32 v206, v124, v125
Maav 32,240,164
Ta 232,4,24576
v_cvt_pk_bf16_f32 v207, v126, v127
Maav 36,240,180
Ta 234,4,26624
s_waitcnt lgkmcnt(4)
Maav 44,244,180
Ta 236,5,24576
v_mul_f32 v152, v152, v239
Maav 40,244,164
Ta 238,5,26624
v_mul_f32 v153, v153, v239
Maav 48,248,164
Ta 240,2,28672
v_mul_f32 v154, v154, v239
Maav 52,248,180
Ta 242,2,30720
v_mul_f32 v155, v155, v239
Maav 60,252,180
Ta 244,3,28672
v_mul_f32 v156, v156, v239
Maav 56,252,164
Ta 246,3,30720
v_mul_f32 v157, v157, v239
Maav 32,224,168
Ta 248,4,28672
v_mul_f32 v158, v158, v239
Maav 36,224,184
Ta 250,4,30720
s_waitcnt lgkmcnt(4)
Maav 44,228,184
Ta 252,5,28672
v_mul_f32 v159, v159, v239
Maav 40,228,168
Ta 254,5,30720
s_waitcnt vmcnt(20)
s_barrier
Maav 48,232,168
Ta 224,2,32768
s_mov_b32 m0, s35
Maav 52,232,184
Ta 226,2,34816
s_add_u32 s44, s39, 0x180
Maav 60,236,184
Ta 228,3,32768
s_add_u32 s98, s12, s44
s_addc_u32 s99, s13, 0
Maav 56,236,168
Ta 230,3,34816
GDMA 12,98,0
Maav 32,240,172
Ta 232,4,32768
GDMA 13,98,1024
Maav 36,240,188
Ta 234,4,34816
s_waitcnt lgkmcnt(4)
Maav 44,244,188
Ta 236,5,32768
v_cvt_pk_bf16_f32 v220, v152, v153
Maav 40,244,172
Ta 238,5,34816
v_cvt_pk_bf16_f32 v221, v154, v155
Maav 48,248,172
Ta 240,2,36864
GDMA 14,98,2048
Maav 52,248,188
Ta 242,2,38912
v_cvt_pk_bf16_f32 v222, v156, v157
Maav 60,252,188
Ta 244,3,36864
v_cvt_pk_bf16_f32 v223, v158, v159
Maav 56,252,172
Ta 246,3,38912
Maav 0,224,192
Ta 248,4,36864
GDMA 15,98,3072
Maav 4,224,208
Ta 250,4,38912
s_waitcnt lgkmcnt(4)
Maav 12,228,208
Ta 252,5,36864
Maav 8,228,192
Ta 254,5,38912
Maav 16,232,192
Ta 224,2,40960
Maav 20,232,208
Ta 226,2,43008
Maav 28,236,208
Ta 228,3,40960
Maav 24,236,192
Ta 230,3,43008
Maav 0,240,196
Ta 232,4,40960
Maav 4,240,212
Ta 234,4,43008
s_waitcnt lgkmcnt(4)
Maav 12,244,212
Ta 236,5,40960
Maav 8,244,196
Ta 238,5,43008
Maav 16,248,196
Ta 240,2,45056
Maav 20,248,212
Ta 242,2,47104
Maav 28,252,212
Ta 244,3,45056
Maav 24,252,196
Ta 246,3,47104
Maav 0,224,200
Ta 248,4,45056
Maav 4,224,216
Ta 250,4,47104
s_waitcnt lgkmcnt(4)
Maav 12,228,216
Ta 252,5,45056
Maav 8,228,200
Ta 254,5,47104
s_waitcnt vmcnt(20)
s_barrier
Maav 16,232,200
Ta 224,2,49152
s_add_u32 m0, s35, 0x4000
Maav 20,232,216
Ta 226,2,51200
s_add_u32 s44, s39, 0x24180
Maav 28,236,216
Ta 228,3,49152
s_add_u32 s98, s12, s44
s_addc_u32 s99, s13, 0
Maav 24,236,200
Ta 230,3,51200
GDMA 12,98,0
Maav 0,240,204
Ta 232,4,49152
GDMA 13,98,1024
Maav 4,240,220
Ta 234,4,51200
s_waitcnt lgkmcnt(4)
Maav 12,244,220
Ta 236,5,49152
Maav 8,244,204
Ta 238,5,51200
Maav 16,248,204
Ta 240,2,53248
GDMA 14,98,2048
Maav 20,248,220
Ta 242,2,55296
Maav 28,252,220
Ta 244,3,53248
Maav 24,252,204
Ta 246,3,55296
Maav 32,224,192
Ta 248,4,53248
GDMA 15,98,3072
Maav 36,224,208
Ta 250,4,55296
s_waitcnt lgkmcnt(4)
Maav 44,228,208
Ta 252,5,53248
v_accvgpr_read_b32 v224, a0
Maav 40,228,192
Ta 254,5,55296
v_accvgpr_read_b32 v225, a1
Maav 48,232,192
Ta 224,2,57344
v_accvgpr_read_b32 v226, a2
Maav 52,232,208
Ta 226,2,59392
v_accvgpr_read_b32 v227, a3
Maav 60,236,208
Ta 228,3,57344
v_accvgpr_read_b32 v228, a8
Maav 56,236,192
Ta 230,3,59392
v_accvgpr_read_b32 v229, a9
Maav 32,240,196
Ta 232,4,57344
v_accvgpr_read_b32 v230, a10
Maav 36,240,212
Ta 234,4,59392
s_waitcnt lgkmcnt(4)
Maav 44,244,212
Ta 236,5,57344
v_accvgpr_read_b32 v231, a11
Maav 40,244,196
Ta 238,5,59392
v_cvt_pk_bf16_f32 v224, v224, v225
Maav 48,248,196
Ta 240,2,61440
v_cvt_pk_bf16_f32 v225, v226, v227
Maav 52,248,212
Ta 242,2,63488
v_xor_b32 v2, 0x10000, v2
Maav 60,252,212
Ta 244,3,61440
v_cvt_pk_bf16_f32 v226, v228, v229
Maav 56,252,196
Ta 246,3,63488
v_xor_b32 v3, 0x10000, v3
Maav 32,224,200
Ta 248,4,61440
v_cvt_pk_bf16_f32 v227, v230, v231
Maav 36,224,216
Ta 250,4,63488
s_waitcnt lgkmcnt(4)
Maav 44,228,216
Ta 252,5,61440
v_xor_b32 v4, 0x10000, v4
Maav 40,228,200
Ta 254,5,63488
s_waitcnt vmcnt(20)
s_barrier
Maav 48,232,200
Ta 224,2,0
v_xor_b32 v5, 0x10000, v5
Maav 52,232,216
Ta 226,2,2048
s_add_u32 m0, s35, 0x8000
Maav 60,236,216
Ta 228,3,0
s_add_u32 s44, s39, 0x48180
Maav 56,236,200
Ta 230,3,2048
s_add_u32 s98, s12, s44
s_addc_u32 s99, s13, 0
Maav 32,240,204
Ta 232,4,0
GDMA 12,98,0
Maav 36,240,220
Ta 234,4,2048
s_waitcnt lgkmcnt(4)
Maav 44,244,220
Ta 236,5,0
GDMA 13,98,1024
Maav 40,244,204
Ta 238,5,2048
s_mov_b32 s48, s47
Maav 48,248,204
Ta 240,2,4096
GDMA 14,98,2048
Maav 52,248,220
Ta 242,2,6144
buffer_store_dwordx4 v[224:227], v28, s[28:31], s48 offen offset:0 sc1
Maav 60,252,220
Ta 244,3,4096
v_accvgpr_read_b32 v232, a4
Maav 56,252,204
Ta 246,3,6144
v_accvgpr_read_b32 v233, a5
Zvaa 32,224,160
Ta 248,4,4096
GDMA 15,98,3072
Zvaa 36,224,176
Ta 250,4,6144
s_waitcnt lgkmcnt(4)
Zvaa 44,228,176
Ta 252,5,4096
v_accvgpr_read_b32 v234, a6
Zvaa 40,228,160
Ta 254,5,6144
v_accvgpr_read_b32 v235, a7
Zvaa 48,232,160
Ta 224,2,8192
v_accvgpr_read_b32 v236, a12
Zvaa 52,232,176
Ta 226,2,10240
v_accvgpr_read_b32 v237, a13
Zvaa 60,236,176
Ta 228,3,8192
v_accvgpr_read_b32 v238, a14
Zvaa 56,236,160
Ta 230,3,10240
v_accvgpr_read_b32 v239, a15
Mvaa 32,240,164
Ta 232,4,8192
v_cvt_pk_bf16_f32 v232, v232, v233
Mvaa 36,240,180
Ta 234,4,10240
s_waitcnt lgkmcnt(4)
Mvaa 44,244,180
Ta 236,5,8192
v_cvt_pk_bf16_f32 v233, v234, v235
Mvaa 40,244,164
Ta 238,5,10240
v_cvt_pk_bf16_f32 v234, v236, v237
Mvaa 48,248,164
Ta 240,2,12288
v_cvt_pk_bf16_f32 v235, v238, v239
Mvaa 52,248,180
Ta 242,2,14336
buffer_store_dwordx4 v[232:235], v28, s[28:31], s48 offen offset:1024 sc1
Mvaa 60,252,180
Ta 244,3,12288
v_accvgpr_read_b32 v240, a16
Mvaa 56,252,164
Ta 246,3,14336
v_accvgpr_read_b32 v241, a17
Mvaa 32,224,168
Ta 248,4,12288
v_accvgpr_read_b32 v242, a18
Mvaa 36,224,184
Ta 250,4,14336
s_waitcnt lgkmcnt(4)
Mvaa 44,228,184
Ta 252,5,12288
v_accvgpr_read_b32 v243, a19
Mvaa 40,228,168
Ta 254,5,14336
s_waitcnt vmcnt(22)
s_barrier
Mvaa 48,232,168
Ta 224,2,16384
s_add_u32 m0, s35, 0xc000
Mvaa 52,232,184
Ta 226,2,18432
s_add_u32 s44, s39, 0x6c180
Mvaa 60,236,184
Ta 228,3,16384
s_add_u32 s98, s12, s44
s_addc_u32 s99, s13, 0
Mvaa 56,236,168
Ta 230,3,18432
GDMA 12,98,0
Mvaa 32,240,172
Ta 232,4,16384
GDMA 13,98,1024
Mvaa 36,240,188
Ta 234,4,18432
s_waitcnt lgkmcnt(4)
Mvaa 44,244,188
Ta 236,5,16384
v_accvgpr_read_b32 v244, a24
Mvaa 40,244,172
Ta 238,5,18432
v_accvgpr_read_b32 v245, a25
Mvaa 48,248,172
Ta 240,2,20480
GDMA 14,98,2048
v_accvgpr_read_b32 v246, a26
v_accvgpr_read_b32 v247, a27
Mvaa 52,248,188
Ta 242,2,22528
v_cvt_pk_bf16_f32 v240, v240, v241
v_cvt_pk_bf16_f32 v241, v242, v243
Mvaa 60,252,188
Ta 244,3,20480
v_cvt_pk_bf16_f32 v242, v244, v245
v_cvt_pk_bf16_f32 v243, v246, v247
Mvaa 56,252,172
Ta 246,3,22528
buffer_store_dwordx4 v[240:243], v28, s[28:31], s48 offen offset:2048 sc1
v_accvgpr_read_b32 v224, a20
Mvaa 32,224,192
Ta 248,4,20480
GDMA 15,98,3072
v_accvgpr_read_b32 v225, a21
v_accvgpr_read_b32 v226, a22
Mvaa 36,224,208
Ta 250,4,22528
v_accvgpr_read_b32 v227, a23
v_accvgpr_read_b32 v228, a28
s_waitcnt lgkmcnt(4)
Mvaa 44,228,208
Ta 252,5,20480
v_accvgpr_read_b32 v229, a29
v_accvgpr_read_b32 v230, a30
Mvaa 40,228,192
Ta 254,5,22528
v_accvgpr_read_b32 v231, a31
v_cvt_pk_bf16_f32 v224, v224, v225
Mvaa 48,232,192
Ta 224,2,24576
v_cvt_pk_bf16_f32 v225, v226, v227
v_cvt_pk_bf16_f32 v226, v228, v229
Mvaa 52,232,208
Ta 226,2,26624
v_cvt_pk_bf16_f32 v227, v230, v231
buffer_store_dwordx4 v[224:227], v28, s[28:31], s48 offen offset:3072 sc1
Mvaa 60,236,208
Ta 228,3,24576
v_accvgpr_read_b32 v232, a32
Mvaa 56,236,192
Ta 230,3,26624
v_accvgpr_read_b32 v233, a33
Mvaa 32,240,196
Ta 232,4,24576
v_accvgpr_read_b32 v234, a34
Mvaa 36,240,212
Ta 234,4,26624
s_waitcnt lgkmcnt(4)
Mvaa 44,244,212
Ta 236,5,24576
v_accvgpr_read_b32 v235, a35
Mvaa 40,244,196
Ta 238,5,26624
v_accvgpr_read_b32 v236, a40
Mvaa 48,248,196
Ta 240,2,28672
v_accvgpr_read_b32 v237, a41
Mvaa 52,248,212
Ta 242,2,30720
v_accvgpr_read_b32 v238, a42
Mvaa 60,252,212
Ta 244,3,28672
v_accvgpr_read_b32 v239, a43
Mvaa 56,252,196
Ta 246,3,30720
v_cvt_pk_bf16_f32 v232, v232, v233
Mvaa 32,224,200
Ta 248,4,28672
v_cvt_pk_bf16_f32 v233, v234, v235
v_cvt_pk_bf16_f32 v234, v236, v237
Mvaa 36,224,216
Ta 250,4,30720
v_cvt_pk_bf16_f32 v235, v238, v239
s_add_u32 s48, s47, 0x1000
s_waitcnt lgkmcnt(4)
Mvaa 44,228,216
Ta 252,5,28672
buffer_store_dwordx4 v[232:235], v28, s[28:31], s48 offen offset:0 sc1
v_accvgpr_read_b32 v240, a36
Mvaa 40,228,200
Ta 254,5,30720
v_accvgpr_read_b32 v241, a37
v_accvgpr_read_b32 v242, a38
s_waitcnt vmcnt(25)
s_barrier
Mvaa 48,232,200
Ta 224,2,32768
s_add_u32 m0, s35, 0x10000
v_accvgpr_read_b32 v243, a39
v_accvgpr_read_b32 v244, a44
Mvaa 52,232,216
Ta 226,2,34816
s_add_u32 s44, s39, 0x200
v_accvgpr_read_b32 v245, a45
v_accvgpr_read_b32 v246, a46
Mvaa 60,236,216
Ta 228,3,32768
s_add_u32 s98, s12, s44
s_addc_u32 s99, s13, 0
v_accvgpr_read_b32 v247, a47
v_cvt_pk_bf16_f32 v240, v240, v241
Mvaa 56,236,200
Ta 230,3,34816
GDMA 12,98,0
v_cvt_pk_bf16_f32 v241, v242, v243
v_cvt_pk_bf16_f32 v242, v244, v245
Mvaa 32,240,204
Ta 232,4,32768
GDMA 13,98,1024
v_cvt_pk_bf16_f32 v243, v246, v247
buffer_store_dwordx4 v[240:243], v28, s[28:31], s48 offen offset:1024 sc1
Mvaa 36,240,220
Ta 234,4,34816
v_accvgpr_read_b32 v224, a48
v_accvgpr_read_b32 v225, a49
s_waitcnt lgkmcnt(4)
Mvaa 44,244,220
Ta 236,5,32768
v_accvgpr_read_b32 v226, a50
v_accvgpr_read_b32 v227, a51
Mvaa 40,244,204
Ta 238,5,34816
v_accvgpr_read_b32 v228, a56
v_accvgpr_read_b32 v229, a57
Mvaa 48,248,204
Ta 240,2,36864
GDMA 14,98,2048
v_accvgpr_read_b32 v230, a58
v_accvgpr_read_b32 v231, a59
Mvaa 52,248,220
Ta 242,2,38912
v_cvt_pk_bf16_f32 v224, v224, v225
v_cvt_pk_bf16_f32 v225, v226, v227
Mvaa 60,252,220
Ta 244,3,36864
v_cvt_pk_bf16_f32 v226, v228, v229
v_cvt_pk_bf16_f32 v227, v230, v231
Mvaa 56,252,204
Ta 246,3,38912
buffer_store_dwordx4 v[224:227], v28, s[28:31], s48 offen offset:2048 sc1
v_accvgpr_read_b32 v232, a52
Mvav 32,224,160
Ta 248,4,36864
GDMA 15,98,3072
v_accvgpr_read_b32 v233, a53
v_accvgpr_read_b32 v234, a54
Mvav 36,224,176
Ta 250,4,38912
v_accvgpr_read_b32 v235, a55
v_accvgpr_read_b32 v236, a60
s_waitcnt lgkmcnt(4)
Mvav 44,228,176
Ta 252,5,36864
v_accvgpr_read_b32 v237, a61
v_accvgpr_read_b32 v238, a62
Mvav 40,228,160
Ta 254,5,38912
v_accvgpr_read_b32 v239, a63
v_cvt_pk_bf16_f32 v232, v232, v233
Mvav 48,232,160
Ta 224,2,40960
v_cvt_pk_bf16_f32 v233, v234, v235
v_cvt_pk_bf16_f32 v234, v236, v237
Mvav 52,232,176
Ta 226,2,43008
v_cvt_pk_bf16_f32 v235, v238, v239
buffer_store_dwordx4 v[232:235], v28, s[28:31], s48 offen offset:3072 sc1
Mvav 60,236,176
Ta 228,3,40960
Mvav 56,236,160
Ta 230,3,43008
Mvav 32,240,164
Ta 232,4,40960
Mvav 36,240,180
Ta 234,4,43008
s_waitcnt lgkmcnt(4)
Mvav 44,244,180
Ta 236,5,40960
Mvav 40,244,164
Ta 238,5,43008
Mvav 48,248,164
Ta 240,2,45056
Mvav 52,248,180
Ta 242,2,47104
Mvav 60,252,180
Ta 244,3,45056
Mvav 56,252,164
Ta 246,3,47104
Mvav 32,224,168
Ta 248,4,45056
Mvav 36,224,184
Ta 250,4,47104
s_waitcnt lgkmcnt(4)
Mvav 44,228,184
Ta 252,5,45056
Mvav 40,228,168
Ta 254,5,47104
s_waitcnt vmcnt(28)
s_barrier
Mvav 48,232,168
Ta 224,2,49152
s_add_u32 m0, s35, 0x14000
Mvav 52,232,184
Ta 226,2,51200
s_add_u32 s44, s39, 0x24200
Mvav 60,236,184
Ta 228,3,49152
s_add_u32 s98, s12, s44
s_addc_u32 s99, s13, 0
Mvav 56,236,168
Ta 230,3,51200
GDMA 12,98,0
Mvav 32,240,172
Ta 232,4,49152
GDMA 13,98,1024
Mvav 36,240,188
Ta 234,4,51200
s_waitcnt lgkmcnt(4)
Mvav 44,244,188
Ta 236,5,49152
Mvav 40,244,172
Ta 238,5,51200
Mvav 48,248,172
Ta 240,2,53248
GDMA 14,98,2048
Mvav 52,248,188
Ta 242,2,55296
Mvav 60,252,188
Ta 244,3,53248
Mvav 56,252,172
Ta 246,3,55296
Mvav 32,224,192
Ta 248,4,53248
GDMA 15,98,3072
Mvav 36,224,208
Ta 250,4,55296
s_waitcnt lgkmcnt(4)
Mvav 44,228,208
Ta 252,5,53248
Mvav 40,228,192
Ta 254,5,55296
Mvav 48,232,192
Ta 224,2,57344
Mvav 52,232,208
Ta 226,2,59392
Mvav 60,236,208
Ta 228,3,57344
Mvav 56,236,192
Ta 230,3,59392
Mvav 32,240,196
Ta 232,4,57344
Mvav 36,240,212
Ta 234,4,59392
s_waitcnt lgkmcnt(4)
Mvav 44,244,212
Ta 236,5,57344
Mvav 40,244,196
Ta 238,5,59392
Mvav 48,248,196
Ta 240,2,61440
Mvav 52,248,212
Ta 242,2,63488
v_xor_b32 v2, 0x10000, v2
Mvav 60,252,212
Ta 244,3,61440
Mvav 56,252,196
Ta 246,3,63488
v_xor_b32 v3, 0x10000, v3
Mvav 32,224,200
Ta 248,4,61440
Mvav 36,224,216
Ta 250,4,63488
s_waitcnt lgkmcnt(4)
Mvav 44,228,216
Ta 252,5,61440
v_xor_b32 v4, 0x10000, v4
Mvav 40,228,200
Ta 254,5,63488
s_waitcnt vmcnt(28)
s_barrier
Mvav 48,232,200
Ta 224,2,0
v_xor_b32 v5, 0x10000, v5
Mvav 52,232,216
Ta 226,2,2048
s_add_u32 m0, s35, 0x18000
Mvav 60,236,216
Ta 228,3,0
s_add_u32 s44, s39, 0x48200
Mvav 56,236,200
Ta 230,3,2048
s_add_u32 s98, s12, s44
s_addc_u32 s99, s13, 0
Mvav 32,240,204
Ta 232,4,0
GDMA 12,98,0
Mvav 36,240,220
Ta 234,4,2048
s_waitcnt lgkmcnt(4)
Mvav 44,244,220
Ta 236,5,0
GDMA 13,98,1024
Mvav 40,244,204
Ta 238,5,2048
Mvav 48,248,204
Ta 240,2,4096
GDMA 14,98,2048
Mvav 52,248,220
Ta 242,2,6144
Mvav 60,252,220
Ta 244,3,4096
Mvav 56,252,204
Ta 246,3,6144
Zvaa 64,224,160
Ta 248,4,4096
GDMA 15,98,3072
Zvaa 68,224,176
Ta 250,4,6144
s_waitcnt lgkmcnt(4)
Zvaa 76,228,176
Ta 252,5,4096
v_cvt_pk_bf16_f32 v240, v32, v33
Zvaa 72,228,160
Ta 254,5,6144
v_cvt_pk_bf16_f32 v241, v34, v35
Zvaa 80,232,160
Ta 224,2,8192
v_cvt_pk_bf16_f32 v242, v40, v41
Zvaa 84,232,176
Ta 226,2,10240
v_cvt_pk_bf16_f32 v243, v42, v43
Zvaa 92,236,176
Ta 228,3,8192
s_add_u32 s48, s47, 0x2000
Zvaa 88,236,160
Ta 230,3,10240
buffer_store_dwordx4 v[240:243], v28, s[28:31], s48 offen offset:0 sc1
Mvaa 64,240,164
Ta 232,4,8192
v_cvt_pk_bf16_f32 v224, v36, v37
Mvaa 68,240,180
Ta 234,4,10240
s_waitcnt lgkmcnt(4)
Mvaa 76,244,180
Ta 236,5,8192
v_cvt_pk_bf16_f32 v225, v38, v39
Mvaa 72,244,164
Ta 238,5,10240
v_cvt_pk_bf16_f32 v226, v44, v45
Mvaa 80,248,164
Ta 240,2,12288
v_cvt_pk_bf16_f32 v227, v46, v47
Mvaa 84,248,180
Ta 242,2,14336
buffer_store_dwordx4 v[224:227], v28, s[28:31], s48 offen offset:1024 sc1
Mvaa 92,252,180
Ta 244,3,12288
v_cvt_pk_bf16_f32 v232, v48, v49
Mvaa 88,252,164
Ta 246,3,14336
v_cvt_pk_bf16_f32 v233, v50, v51
Mvaa 64,224,168
Ta 248,4,12288
v_cvt_pk_bf16_f32 v234, v56, v57
Mvaa 68,224,184
Ta 250,4,14336
s_waitcnt lgkmcnt(4)
Mvaa 76,228,184
Ta 252,5,12288
v_cvt_pk_bf16_f32 v235, v58, v59
Mvaa 72,228,168
Ta 254,5,14336
s_waitcnt vmcnt(30)
s_barrier
Mvaa 80,232,168
Ta 224,2,16384
s_add_u32 m0, s35, 0x1c000
Mvaa 84,232,184
Ta 226,2,18432
s_add_u32 s44, s39, 0x6c200
Mvaa 92,236,184
Ta 228,3,16384
s_add_u32 s98, s12, s44
s_addc_u32 s99, s13, 0
Mvaa 88,236,168
Ta 230,3,18432
GDMA 12,98,0
Mvaa 64,240,172
Ta 232,4,16384
GDMA 13,98,1024
Mvaa 68,240,188
Ta 234,4,18432
s_waitcnt lgkmcnt(4)
Mvaa 76,244,188
Ta 236,5,16384
buffer_store_dwordx4 v[232:235], v28, s[28:31], s48 offen offset:2048 sc1
Mvaa 72,244,172
Ta 238,5,18432
v_cvt_pk_bf16_f32 v240, v52, v53
Mvaa 80,248,172
Ta 240,2,20480
GDMA 14,98,2048
Mvaa 84,248,188
Ta 242,2,22528
v_cvt_pk_bf16_f32 v241, v54, v55
Mvaa 92,252,188
Ta 244,3,20480
v_cvt_pk_bf16_f32 v242, v60, v61
Mvaa 88,252,172
Ta 246,3,22528
v_cvt_pk_bf16_f32 v243, v62, v63
Mvaa 64,224,192
Ta 248,4,20480
GDMA 15,98,3072
Mvaa 68,224,208
Ta 250,4,22528
s_waitcnt lgkmcnt(4)
Mvaa 76,228,208
Ta 252,5,20480
buffer_store_dwordx4 v[240:243], v28, s[28:31], s48 offen offset:3072 sc1
Mvaa 72,228,192
Ta 254,5,22528
Mvaa 80,232,192
Ta 224,2,24576
Mvaa 84,232,208
Ta 226,2,26624
Mvaa 92,236,208
Ta 228,3,24576
Mvaa 88,236,192
Ta 230,3,26624
Mvaa 64,240,196
Ta 232,4,24576
Mvaa 68,240,212
Ta 234,4,26624
s_waitcnt lgkmcnt(4)
Mvaa 76,244,212
Ta 236,5,24576
Mvaa 72,244,196
Ta 238,5,26624
Mvaa 80,248,196
Ta 240,2,28672
Mvaa 84,248,212
Ta 242,2,30720
Mvaa 92,252,212
Ta 244,3,28672
Mvaa 88,252,196
Ta 246,3,30720
Mvaa 64,224,200
Ta 248,4,28672
Mvaa 68,224,216
Ta 250,4,30720
s_waitcnt lgkmcnt(4)
Mvaa 76,228,216
Ta 252,5,28672
Mvaa 72,228,200
Ta 254,5,30720
s_waitcnt vmcnt(31)
s_barrier
Mvaa 80,232,200
Ta 224,2,32768
s_mov_b32 m0, s35
Mvaa 84,232,216
Ta 226,2,34816
s_add_u32 s44, s39, 0x280
Mvaa 92,236,216
Ta 228,3,32768
s_add_u32 s98, s12, s44
s_addc_u32 s99, s13, 0
Mvaa 88,236,200
Ta 230,3,34816
GDMA 12,98,0
Mvaa 64,240,204
Ta 232,4,32768
GDMA 13,98,1024
Mvaa 68,240,220
Ta 234,4,34816
s_waitcnt lgkmcnt(4)
Mvaa 76,244,220
Ta 236,5,32768
Mvaa 72,244,204
Ta 238,5,34816
Mvaa 80,248,204
Ta 240,2,36864
GDMA 14,98,2048
Mvaa 84,248,220
Ta 242,2,38912
Mvaa 92,252,220
Ta 244,3,36864
Mvaa 88,252,204
Ta 246,3,38912
Mvav 64,224,160
Ta 248,4,36864
GDMA 15,98,3072
Mvav 68,224,176
Ta 250,4,38912
s_waitcnt lgkmcnt(4)
Mvav 76,228,176
Ta 252,5,36864
Mvav 72,228,160
Ta 254,5,38912
Mvav 80,232,160
Ta 224,2,40960
Mvav 84,232,176
Ta 226,2,43008
Mvav 92,236,176
Ta 228,3,40960
Mvav 88,236,160
Ta 230,3,43008
Mvav 64,240,164
Ta 232,4,40960
Mvav 68,240,180
Ta 234,4,43008
s_waitcnt lgkmcnt(4)
Mvav 76,244,180
Ta 236,5,40960
Mvav 72,244,164
Ta 238,5,43008
Mvav 80,248,164
Ta 240,2,45056
Mvav 84,248,180
Ta 242,2,47104
Mvav 92,252,180
Ta 244,3,45056
Mvav 88,252,164
Ta 246,3,47104
Mvav 64,224,168
Ta 248,4,45056
Mvav 68,224,184
Ta 250,4,47104
s_waitcnt lgkmcnt(4)
Mvav 76,228,184
Ta 252,5,45056
Mvav 72,228,168
Ta 254,5,47104
s_waitcnt vmcnt(29)
s_barrier
Mvav 80,232,168
Ta 224,2,49152
s_add_u32 m0, s35, 0x4000
Mvav 84,232,184
Ta 226,2,51200
s_add_u32 s44, s39, 0x24280
Mvav 92,236,184
Ta 228,3,49152
s_add_u32 s98, s12, s44
s_addc_u32 s99, s13, 0
Mvav 88,236,168
Ta 230,3,51200
GDMA 12,98,0
Mvav 64,240,172
Ta 232,4,49152
GDMA 13,98,1024
Mvav 68,240,188
Ta 234,4,51200
s_waitcnt lgkmcnt(4)
Mvav 76,244,188
Ta 236,5,49152
Mvav 72,244,172
Ta 238,5,51200
Mvav 80,248,172
Ta 240,2,53248
GDMA 14,98,2048
Mvav 84,248,188
Ta 242,2,55296
Mvav 92,252,188
Ta 244,3,53248
Mvav 88,252,172
Ta 246,3,55296
Mvav 64,224,192
Ta 248,4,53248
GDMA 15,98,3072
Mvav 68,224,208
Ta 250,4,55296
s_waitcnt lgkmcnt(4)
Mvav 76,228,208
Ta 252,5,53248
Mvav 72,228,192
Ta 254,5,55296
Mvav 80,232,192
Ta 224,2,57344
Mvav 84,232,208
Ta 226,2,59392
Mvav 92,236,208
Ta 228,3,57344
Mvav 88,236,192
Ta 230,3,59392
Mvav 64,240,196
Ta 232,4,57344
Mvav 68,240,212
Ta 234,4,59392
s_waitcnt lgkmcnt(4)
Mvav 76,244,212
Ta 236,5,57344
Mvav 72,244,196
Ta 238,5,59392
Mvav 80,248,196
Ta 240,2,61440
Mvav 84,248,212
Ta 242,2,63488
v_xor_b32 v2, 0x10000, v2
Mvav 92,252,212
Ta 244,3,61440
Mvav 88,252,196
Ta 246,3,63488
v_xor_b32 v3, 0x10000, v3
Mvav 64,224,200
Ta 248,4,61440
Mvav 68,224,216
Ta 250,4,63488
s_waitcnt lgkmcnt(4)
Mvav 76,228,216
Ta 252,5,61440
v_xor_b32 v4, 0x10000, v4
Mvav 72,228,200
Ta 254,5,63488
s_waitcnt vmcnt(25)
s_barrier
Mvav 80,232,200
Ta 224,2,0
v_xor_b32 v5, 0x10000, v5
Mvav 84,232,216
Ta 226,2,2048
s_add_u32 m0, s35, 0x8000
Mvav 92,236,216
Ta 228,3,0
s_add_u32 s44, s39, 0x48280
Mvav 88,236,200
Ta 230,3,2048
s_add_u32 s98, s12, s44
s_addc_u32 s99, s13, 0
Mvav 64,240,204
Ta 232,4,0
GDMA 12,98,0
Mvav 68,240,220
Ta 234,4,2048
s_waitcnt lgkmcnt(4)
Mvav 76,244,220
Ta 236,5,0
GDMA 13,98,1024
Mvav 72,244,204
Ta 238,5,2048
Mvav 80,248,204
Ta 240,2,4096
GDMA 14,98,2048
Mvav 84,248,220
Ta 242,2,6144
Mvav 92,252,220
Ta 244,3,4096
Mvav 88,252,204
Ta 246,3,6144
Zvaa 96,224,160
Ta 248,4,4096
GDMA 15,98,3072
Zvaa 100,224,176
Ta 250,4,6144
s_waitcnt lgkmcnt(4)
Zvaa 108,228,176
Ta 252,5,4096
v_cvt_pk_bf16_f32 v224, v64, v65
Zvaa 104,228,160
Ta 254,5,6144
v_cvt_pk_bf16_f32 v225, v66, v67
Zvaa 112,232,160
Ta 224,2,8192
v_cvt_pk_bf16_f32 v226, v72, v73
Zvaa 116,232,176
Ta 226,2,10240
v_cvt_pk_bf16_f32 v227, v74, v75
Zvaa 124,236,176
Ta 228,3,8192
s_add_u32 s48, s47, 0x3000
Zvaa 120,236,160
Ta 230,3,10240
buffer_store_dwordx4 v[224:227], v28, s[28:31], s48 offen offset:0 sc1
Mvaa 96,240,164
Ta 232,4,8192
v_cvt_pk_bf16_f32 v232, v68, v69
Mvaa 100,240,180
Ta 234,4,10240
s_waitcnt lgkmcnt(4)
Mvaa 108,244,180
Ta 236,5,8192
v_cvt_pk_bf16_f32 v233, v70, v71
Mvaa 104,244,164
Ta 238,5,10240
v_cvt_pk_bf16_f32 v234, v76, v77
Mvaa 112,248,164
Ta 240,2,12288
v_cvt_pk_bf16_f32 v235, v78, v79
Mvaa 116,248,180
Ta 242,2,14336
buffer_store_dwordx4 v[232:235], v28, s[28:31], s48 offen offset:1024 sc1
Mvaa 124,252,180
Ta 244,3,12288
v_cvt_pk_bf16_f32 v240, v80, v81
Mvaa 120,252,164
Ta 246,3,14336
v_cvt_pk_bf16_f32 v241, v82, v83
Mvaa 96,224,168
Ta 248,4,12288
v_cvt_pk_bf16_f32 v242, v88, v89
Mvaa 100,224,184
Ta 250,4,14336
s_waitcnt lgkmcnt(4)
Mvaa 108,228,184
Ta 252,5,12288
v_cvt_pk_bf16_f32 v243, v90, v91
Mvaa 104,228,168
Ta 254,5,14336
s_waitcnt vmcnt(26)
s_barrier
Mvaa 112,232,168
Ta 224,2,16384
s_add_u32 m0, s35, 0xc000
Mvaa 116,232,184
Ta 226,2,18432
s_add_u32 s44, s39, 0x6c280
Mvaa 124,236,184
Ta 228,3,16384
s_add_u32 s98, s12, s44
s_addc_u32 s99, s13, 0
Mvaa 120,236,168
Ta 230,3,18432
GDMA 12,98,0
Mvaa 96,240,172
Ta 232,4,16384
GDMA 13,98,1024
Mvaa 100,240,188
Ta 234,4,18432
s_waitcnt lgkmcnt(4)
Mvaa 108,244,188
Ta 236,5,16384
buffer_store_dwordx4 v[240:243], v28, s[28:31], s48 offen offset:2048 sc1
Mvaa 104,244,172
Ta 238,5,18432
v_cvt_pk_bf16_f32 v224, v84, v85
Mvaa 112,248,172
Ta 240,2,20480
GDMA 14,98,2048
Mvaa 116,248,188
Ta 242,2,22528
v_cvt_pk_bf16_f32 v225, v86, v87
Mvaa 124,252,188
Ta 244,3,20480
v_cvt_pk_bf16_f32 v226, v92, v93
Mvaa 120,252,172
Ta 246,3,22528
v_cvt_pk_bf16_f32 v227, v94, v95
Mvaa 96,224,192
Ta 248,4,20480
GDMA 15,98,3072
Mvaa 100,224,208
Ta 250,4,22528
s_waitcnt lgkmcnt(4)
Mvaa 108,228,208
Ta 252,5,20480
buffer_store_dwordx4 v[224:227], v28, s[28:31], s48 offen offset:3072 sc1
Mvaa 104,228,192
Ta 254,5,22528
Mvaa 112,232,192
Ta 224,2,24576
Mvaa 116,232,208
Ta 226,2,26624
Mvaa 124,236,208
Ta 228,3,24576
Mvaa 120,236,192
Ta 230,3,26624
Mvaa 96,240,196
Ta 232,4,24576
Mvaa 100,240,212
Ta 234,4,26624
s_waitcnt lgkmcnt(4)
Mvaa 108,244,212
Ta 236,5,24576
Mvaa 104,244,196
Ta 238,5,26624
Mvaa 112,248,196
Ta 240,2,28672
Mvaa 116,248,212
Ta 242,2,30720
Mvaa 124,252,212
Ta 244,3,28672
Mvaa 120,252,196
Ta 246,3,30720
Mvaa 96,224,200
Ta 248,4,28672
Mvaa 100,224,216
Ta 250,4,30720
s_waitcnt lgkmcnt(4)
Mvaa 108,228,216
Ta 252,5,28672
Mvaa 104,228,200
Ta 254,5,30720
s_waitcnt vmcnt(28)
s_barrier
Mvaa 112,232,200
Ta 224,2,32768
s_add_u32 m0, s35, 0x10000
Mvaa 116,232,216
Ta 226,2,34816
s_add_u32 s44, s39, 0x300
Mvaa 124,236,216
Ta 228,3,32768
s_add_u32 s98, s12, s44
s_addc_u32 s99, s13, 0
Mvaa 120,236,200
Ta 230,3,34816
GDMA 12,98,0
Mvaa 96,240,204
Ta 232,4,32768
GDMA 13,98,1024
Mvaa 100,240,220
Ta 234,4,34816
s_waitcnt lgkmcnt(4)
Mvaa 108,244,220
Ta 236,5,32768
Mvaa 104,244,204
Ta 238,5,34816
Mvaa 112,248,204
Ta 240,2,36864
GDMA 14,98,2048
Mvaa 116,248,220
Ta 242,2,38912
Mvaa 124,252,220
Ta 244,3,36864
Mvaa 120,252,204
Ta 246,3,38912
Mvav 96,224,160
Ta 248,4,36864
GDMA 15,98,3072
Mvav 100,224,176
Ta 250,4,38912
s_waitcnt lgkmcnt(4)
Mvav 108,228,176
Ta 252,5,36864
Mvav 104,228,160
Ta 254,5,38912
Mvav 112,232,160
Ta 224,2,40960
Mvav 116,232,176
Ta 226,2,43008
Mvav 124,236,176
Ta 228,3,40960
Mvav 120,236,160
Ta 230,3,43008
Mvav 96,240,164
Ta 232,4,40960
Mvav 100,240,180
Ta 234,4,43008
s_waitcnt lgkmcnt(4)
Mvav 108,244,180
Ta 236,5,40960
Mvav 104,244,164
Ta 238,5,43008
Mvav 112,248,164
Ta 240,2,45056
Mvav 116,248,180
Ta 242,2,47104
Mvav 124,252,180
Ta 244,3,45056
Mvav 120,252,164
Ta 246,3,47104
Mvav 96,224,168
Ta 248,4,45056
Mvav 100,224,184
Ta 250,4,47104
s_waitcnt lgkmcnt(4)
Mvav 108,228,184
Ta 252,5,45056
Mvav 104,228,168
Ta 254,5,47104
s_waitcnt vmcnt(25)
s_barrier
Mvav 112,232,168
Ta 224,2,49152
s_add_u32 m0, s35, 0x14000
Mvav 116,232,184
Ta 226,2,51200
s_add_u32 s44, s39, 0x24300
Mvav 124,236,184
Ta 228,3,49152
s_add_u32 s98, s12, s44
s_addc_u32 s99, s13, 0
Mvav 120,236,168
Ta 230,3,51200
GDMA 12,98,0
Mvav 96,240,172
Ta 232,4,49152
GDMA 13,98,1024
Mvav 100,240,188
Ta 234,4,51200
s_waitcnt lgkmcnt(4)
Mvav 108,244,188
Ta 236,5,49152
Mvav 104,244,172
Ta 238,5,51200
Mvav 112,248,172
Ta 240,2,53248
GDMA 14,98,2048
Mvav 116,248,188
Ta 242,2,55296
Mvav 124,252,188
Ta 244,3,53248
Mvav 120,252,172
Ta 246,3,55296
Mvav 96,224,192
Ta 248,4,53248
GDMA 15,98,3072
Mvav 100,224,208
Ta 250,4,55296
s_waitcnt lgkmcnt(4)
Mvav 108,228,208
Ta 252,5,53248
Mvav 104,228,192
Ta 254,5,55296
Mvav 112,232,192
Ta 224,2,57344
Mvav 116,232,208
Ta 226,2,59392
Mvav 124,236,208
Ta 228,3,57344
Mvav 120,236,192
Ta 230,3,59392
Mvav 96,240,196
Ta 232,4,57344
Mvav 100,240,212
Ta 234,4,59392
s_waitcnt lgkmcnt(4)
Mvav 108,244,212
Ta 236,5,57344
Mvav 104,244,196
Ta 238,5,59392
Mvav 112,248,196
Ta 240,2,61440
Mvav 116,248,212
Ta 242,2,63488
v_xor_b32 v2, 0x10000, v2
Mvav 124,252,212
Ta 244,3,61440
Mvav 120,252,196
Ta 246,3,63488
v_xor_b32 v3, 0x10000, v3
Mvav 96,224,200
Ta 248,4,61440
Mvav 100,224,216
Ta 250,4,63488
s_waitcnt lgkmcnt(4)
Mvav 108,228,216
Ta 252,5,61440
v_xor_b32 v4, 0x10000, v4
Mvav 104,228,200
Ta 254,5,63488
s_waitcnt vmcnt(24)
s_barrier
Mvav 112,232,200
Ta 224,2,0
v_xor_b32 v5, 0x10000, v5
Mvav 116,232,216
Ta 226,2,2048
s_add_u32 m0, s35, 0x18000
Mvav 124,236,216
Ta 228,3,0
s_add_u32 s44, s39, 0x48300
Mvav 120,236,200
Ta 230,3,2048
s_add_u32 s98, s12, s44
s_addc_u32 s99, s13, 0
Mvav 96,240,204
Ta 232,4,0
GDMA 12,98,0
Mvav 100,240,220
Ta 234,4,2048
s_waitcnt lgkmcnt(4)
Mvav 108,244,220
Ta 236,5,0
GDMA 13,98,1024
Mvav 104,244,204
Ta 238,5,2048
Mvav 112,248,204
Ta 240,2,4096
GDMA 14,98,2048
Mvav 116,248,220
Ta 242,2,6144
Mvav 124,252,220
Ta 244,3,4096
Mvav 120,252,204
Ta 246,3,6144
Zvaa 32,224,160
Ta 248,4,4096
GDMA 15,98,3072
Zvaa 36,224,176
Ta 250,4,6144
s_waitcnt lgkmcnt(4)
Zvaa 44,228,176
Ta 252,5,4096
v_cvt_pk_bf16_f32 v232, v96, v97
Zvaa 40,228,160
Ta 254,5,6144
v_cvt_pk_bf16_f32 v233, v98, v99
Zvaa 48,232,160
Ta 224,2,8192
v_cvt_pk_bf16_f32 v234, v104, v105
Zvaa 52,232,176
Ta 226,2,10240
v_cvt_pk_bf16_f32 v235, v106, v107
Zvaa 60,236,176
Ta 228,3,8192
s_add_u32 s48, s47, 0x4000
Zvaa 56,236,160
Ta 230,3,10240
buffer_store_dwordx4 v[232:235], v28, s[28:31], s48 offen offset:0 sc1
Mvaa 32,240,164
Ta 232,4,8192
v_cvt_pk_bf16_f32 v240, v100, v101
Mvaa 36,240,180
Ta 234,4,10240
s_waitcnt lgkmcnt(4)
Mvaa 44,244,180
Ta 236,5,8192
v_cvt_pk_bf16_f32 v241, v102, v103
Mvaa 40,244,164
Ta 238,5,10240
v_cvt_pk_bf16_f32 v242, v108, v109
Mvaa 48,248,164
Ta 240,2,12288
v_cvt_pk_bf16_f32 v243, v110, v111
Mvaa 52,248,180
Ta 242,2,14336
buffer_store_dwordx4 v[240:243], v28, s[28:31], s48 offen offset:1024 sc1
Mvaa 60,252,180
Ta 244,3,12288
v_cvt_pk_bf16_f32 v224, v112, v113
Mvaa 56,252,164
Ta 246,3,14336
v_cvt_pk_bf16_f32 v225, v114, v115
Mvaa 32,224,168
Ta 248,4,12288
v_cvt_pk_bf16_f32 v226, v120, v121
Mvaa 36,224,184
Ta 250,4,14336
s_waitcnt lgkmcnt(4)
Mvaa 44,228,184
Ta 252,5,12288
v_cvt_pk_bf16_f32 v227, v122, v123
Mvaa 40,228,168
Ta 254,5,14336
s_waitcnt vmcnt(26)
s_barrier
Mvaa 48,232,168
Ta 224,2,16384
s_add_u32 m0, s35, 0x1c000
Mvaa 52,232,184
Ta 226,2,18432
s_add_u32 s44, s39, 0x6c300
Mvaa 60,236,184
Ta 228,3,16384
s_add_u32 s98, s12, s44
s_addc_u32 s99, s13, 0
Mvaa 56,236,168
Ta 230,3,18432
GDMA 12,98,0
Mvaa 32,240,172
Ta 232,4,16384
GDMA 13,98,1024
Mvaa 36,240,188
Ta 234,4,18432
s_waitcnt lgkmcnt(4)
Mvaa 44,244,188
Ta 236,5,16384
buffer_store_dwordx4 v[224:227], v28, s[28:31], s48 offen offset:2048 sc1
Mvaa 40,244,172
Ta 238,5,18432
v_cvt_pk_bf16_f32 v232, v116, v117
Mvaa 48,248,172
Ta 240,2,20480
GDMA 14,98,2048
Mvaa 52,248,188
Ta 242,2,22528
v_cvt_pk_bf16_f32 v233, v118, v119
Mvaa 60,252,188
Ta 244,3,20480
v_cvt_pk_bf16_f32 v234, v124, v125
Mvaa 56,252,172
Ta 246,3,22528
v_cvt_pk_bf16_f32 v235, v126, v127
Mvaa 32,224,192
Ta 248,4,20480
GDMA 15,98,3072
Mvaa 36,224,208
Ta 250,4,22528
s_waitcnt lgkmcnt(4)
Mvaa 44,228,208
Ta 252,5,20480
buffer_store_dwordx4 v[232:235], v28, s[28:31], s48 offen offset:3072 sc1
Mvaa 40,228,192
Ta 254,5,22528
Mvaa 48,232,192
Ta 224,2,24576
Mvaa 52,232,208
Ta 226,2,26624
Mvaa 60,236,208
Ta 228,3,24576
Mvaa 56,236,192
Ta 230,3,26624
Mvaa 32,240,196
Ta 232,4,24576
Mvaa 36,240,212
Ta 234,4,26624
s_waitcnt lgkmcnt(4)
Mvaa 44,244,212
Ta 236,5,24576
Mvaa 40,244,196
Ta 238,5,26624
Mvaa 48,248,196
Ta 240,2,28672
Mvaa 52,248,212
Ta 242,2,30720
Mvaa 60,252,212
Ta 244,3,28672
Mvaa 56,252,196
Ta 246,3,30720
Mvaa 32,224,200
Ta 248,4,28672
Mvaa 36,224,216
Ta 250,4,30720
s_waitcnt lgkmcnt(4)
Mvaa 44,228,216
Ta 252,5,28672
Mvaa 40,228,200
Ta 254,5,30720
s_waitcnt vmcnt(28)
s_barrier
Mvaa 48,232,200
Ta 224,2,32768
s_mov_b32 m0, s35
Mvaa 52,232,216
Ta 226,2,34816
s_add_u32 s44, s39, 0x380
Mvaa 60,236,216
Ta 228,3,32768
s_add_u32 s98, s12, s44
s_addc_u32 s99, s13, 0
Mvaa 56,236,200
Ta 230,3,34816
GDMA 12,98,0
Mvaa 32,240,204
Ta 232,4,32768
GDMA 13,98,1024
Mvaa 36,240,220
Ta 234,4,34816
s_waitcnt lgkmcnt(4)
Mvaa 44,244,220
Ta 236,5,32768
Mvaa 40,244,204
Ta 238,5,34816
Mvaa 48,248,204
Ta 240,2,36864
GDMA 14,98,2048
Mvaa 52,248,220
Ta 242,2,38912
Mvaa 60,252,220
Ta 244,3,36864
Mvaa 56,252,204
Ta 246,3,38912
Mvav 32,224,160
Ta 248,4,36864
GDMA 15,98,3072
Mvav 36,224,176
Ta 250,4,38912
s_waitcnt lgkmcnt(4)
Mvav 44,228,176
Ta 252,5,36864
Mvav 40,228,160
Ta 254,5,38912
Mvav 48,232,160
Ta 224,2,40960
Mvav 52,232,176
Ta 226,2,43008
Mvav 60,236,176
Ta 228,3,40960
Mvav 56,236,160
Ta 230,3,43008
Mvav 32,240,164
Ta 232,4,40960
Mvav 36,240,180
Ta 234,4,43008
s_waitcnt lgkmcnt(4)
Mvav 44,244,180
Ta 236,5,40960
Mvav 40,244,164
Ta 238,5,43008
Mvav 48,248,164
Ta 240,2,45056
Mvav 52,248,180
Ta 242,2,47104
Mvav 60,252,180
Ta 244,3,45056
Mvav 56,252,164
Ta 246,3,47104
Mvav 32,224,168
Ta 248,4,45056
Mvav 36,224,184
Ta 250,4,47104
s_waitcnt lgkmcnt(4)
Mvav 44,228,184
Ta 252,5,45056
Mvav 40,228,168
Ta 254,5,47104
s_waitcnt vmcnt(24)
s_barrier
Mvav 48,232,168
Ta 224,2,49152
s_add_u32 m0, s35, 0x4000
Mvav 52,232,184
Ta 226,2,51200
s_add_u32 s44, s39, 0x24380
Mvav 60,236,184
Ta 228,3,49152
s_add_u32 s98, s12, s44
s_addc_u32 s99, s13, 0
Mvav 56,236,168
Ta 230,3,51200
GDMA 12,98,0
Mvav 32,240,172
Ta 232,4,49152
GDMA 13,98,1024
Mvav 36,240,188
Ta 234,4,51200
s_waitcnt lgkmcnt(4)
Mvav 44,244,188
Ta 236,5,49152
v_mov_b32 v254, 4
Mvav 40,244,172
Ta 238,5,51200
buffer_store_dword v254, v252, s[28:31], 0 offen offset:0 sc1
Mvav 48,248,172
Ta 240,2,53248
GDMA 14,98,2048
Mvav 52,248,188
Ta 242,2,55296
Mvav 60,252,188
Ta 244,3,53248
Mvav 56,252,172
Ta 246,3,55296
Mvav 32,224,192
Ta 248,4,53248
GDMA 15,98,3072
Mvav 36,224,208
Ta 250,4,55296
s_waitcnt lgkmcnt(4)
Mvav 44,228,208
Ta 252,5,53248
Mvav 40,228,192
Ta 254,5,55296
Mvav 48,232,192
Ta 224,2,57344
Mvav 52,232,208
Ta 226,2,59392
Mvav 60,236,208
Ta 228,3,57344
Mvav 56,236,192
Ta 230,3,59392
Mvav 32,240,196
Ta 232,4,57344
Mvav 36,240,212
Ta 234,4,59392
s_waitcnt lgkmcnt(4)
Mvav 44,244,212
Ta 236,5,57344
Mvav 40,244,196
Ta 238,5,59392
Mvav 48,248,196
Ta 240,2,61440
Mvav 52,248,212
Ta 242,2,63488
v_xor_b32 v2, 0x10000, v2
Mvav 60,252,212
Ta 244,3,61440
Mvav 56,252,196
Ta 246,3,63488
v_xor_b32 v3, 0x10000, v3
Mvav 32,224,200
Ta 248,4,61440
Mvav 36,224,216
Ta 250,4,63488
s_waitcnt lgkmcnt(4)
Mvav 44,228,216
Ta 252,5,61440
v_xor_b32 v4, 0x10000, v4
Mvav 40,228,200
Ta 254,5,63488
s_waitcnt vmcnt(25)
s_barrier
Mvav 48,232,200
Ta 224,2,0
v_xor_b32 v5, 0x10000, v5
Mvav 52,232,216
Ta 226,2,2048
s_add_u32 m0, s35, 0x8000
Mvav 60,236,216
Ta 228,3,0
s_add_u32 s44, s39, 0x48380
Mvav 56,236,200
Ta 230,3,2048
s_add_u32 s98, s12, s44
s_addc_u32 s99, s13, 0
Mvav 32,240,204
Ta 232,4,0
GDMA 12,98,0
Mvav 36,240,220
Ta 234,4,2048
s_waitcnt lgkmcnt(4)
Mvav 44,244,220
Ta 236,5,0
GDMA 13,98,1024
Mvav 40,244,204
Ta 238,5,2048
Mvav 48,248,204
Ta 240,2,4096
GDMA 14,98,2048
Mvav 52,248,220
Ta 242,2,6144
Mvav 60,252,220
Ta 244,3,4096
Mvav 56,252,204
Ta 246,3,6144
Zvaa 64,224,160
Ta 248,4,4096
GDMA 15,98,3072
Zvaa 68,224,176
Ta 250,4,6144
s_waitcnt lgkmcnt(4)
Zvaa 76,228,176
Ta 252,5,4096
v_cvt_pk_bf16_f32 v240, v32, v33
Zvaa 72,228,160
Ta 254,5,6144
v_cvt_pk_bf16_f32 v241, v34, v35
Zvaa 80,232,160
Ta 224,2,8192
v_cvt_pk_bf16_f32 v242, v40, v41
Zvaa 84,232,176
Ta 226,2,10240
v_cvt_pk_bf16_f32 v243, v42, v43
Zvaa 92,236,176
Ta 228,3,8192
s_add_u32 s48, s47, 0x5000
Zvaa 88,236,160
Ta 230,3,10240
buffer_store_dwordx4 v[240:243], v28, s[28:31], s48 offen offset:0 sc1
Mvaa 64,240,164
Ta 232,4,8192
v_cvt_pk_bf16_f32 v224, v36, v37
Mvaa 68,240,180
Ta 234,4,10240
s_waitcnt lgkmcnt(4)
Mvaa 76,244,180
Ta 236,5,8192
v_cvt_pk_bf16_f32 v225, v38, v39
Mvaa 72,244,164
Ta 238,5,10240
v_cvt_pk_bf16_f32 v226, v44, v45
Mvaa 80,248,164
Ta 240,2,12288
v_cvt_pk_bf16_f32 v227, v46, v47
Mvaa 84,248,180
Ta 242,2,14336
buffer_store_dwordx4 v[224:227], v28, s[28:31], s48 offen offset:1024 sc1
Mvaa 92,252,180
Ta 244,3,12288
v_cvt_pk_bf16_f32 v232, v48, v49
Mvaa 88,252,164
Ta 246,3,14336
v_cvt_pk_bf16_f32 v233, v50, v51
Mvaa 64,224,168
Ta 248,4,12288
v_cvt_pk_bf16_f32 v234, v56, v57
Mvaa 68,224,184
Ta 250,4,14336
s_waitcnt lgkmcnt(4)
Mvaa 76,228,184
Ta 252,5,12288
v_cvt_pk_bf16_f32 v235, v58, v59
Mvaa 72,228,168
Ta 254,5,14336
s_waitcnt vmcnt(27)
s_barrier
Mvaa 80,232,168
Ta 224,2,16384
s_add_u32 m0, s35, 0xc000
Mvaa 84,232,184
Ta 226,2,18432
s_add_u32 s44, s39, 0x6c380
Mvaa 92,236,184
Ta 228,3,16384
s_add_u32 s98, s12, s44
s_addc_u32 s99, s13, 0
Mvaa 88,236,168
Ta 230,3,18432
GDMA 12,98,0
Mvaa 64,240,172
Ta 232,4,16384
GDMA 13,98,1024
Mvaa 68,240,188
Ta 234,4,18432
s_waitcnt lgkmcnt(4)
Mvaa 76,244,188
Ta 236,5,16384
buffer_store_dwordx4 v[232:235], v28, s[28:31], s48 offen offset:2048 sc1
Mvaa 72,244,172
Ta 238,5,18432
v_cvt_pk_bf16_f32 v240, v52, v53
Mvaa 80,248,172
Ta 240,2,20480
GDMA 14,98,2048
Mvaa 84,248,188
Ta 242,2,22528
v_cvt_pk_bf16_f32 v241, v54, v55
Mvaa 92,252,188
Ta 244,3,20480
v_cvt_pk_bf16_f32 v242, v60, v61
Mvaa 88,252,172
Ta 246,3,22528
v_cvt_pk_bf16_f32 v243, v62, v63
Mvaa 64,224,192
Ta 248,4,20480
GDMA 15,98,3072
Mvaa 68,224,208
Ta 250,4,22528
s_waitcnt lgkmcnt(4)
Mvaa 76,228,208
Ta 252,5,20480
buffer_store_dwordx4 v[240:243], v28, s[28:31], s48 offen offset:3072 sc1
Mvaa 72,228,192
Ta 254,5,22528
Mvaa 80,232,192
Ta 224,2,24576
Mvaa 84,232,208
Ta 226,2,26624
Mvaa 92,236,208
Ta 228,3,24576
Mvaa 88,236,192
Ta 230,3,26624
Mvaa 64,240,196
Ta 232,4,24576
Mvaa 68,240,212
Ta 234,4,26624
s_waitcnt lgkmcnt(4)
Mvaa 76,244,212
Ta 236,5,24576
Mvaa 72,244,196
Ta 238,5,26624
Mvaa 80,248,196
Ta 240,2,28672
Mvaa 84,248,212
Ta 242,2,30720
Mvaa 92,252,212
Ta 244,3,28672
Mvaa 88,252,196
Ta 246,3,30720
Mvaa 64,224,200
Ta 248,4,28672
Mvaa 68,224,216
Ta 250,4,30720
s_waitcnt lgkmcnt(4)
Mvaa 76,228,216
Ta 252,5,28672
Mvaa 72,228,200
Ta 254,5,30720
s_waitcnt vmcnt(29)
s_barrier
Mvaa 80,232,200
Ta 224,2,32768
s_add_u32 m0, s35, 0x10000
Mvaa 84,232,216
Ta 226,2,34816
s_add_u32 s44, s39, 0x400
Mvaa 92,236,216
Ta 228,3,32768
s_add_u32 s98, s12, s44
s_addc_u32 s99, s13, 0
Mvaa 88,236,200
Ta 230,3,34816
GDMA 12,98,0
Mvaa 64,240,204
Ta 232,4,32768
GDMA 13,98,1024
Mvaa 68,240,220
Ta 234,4,34816
s_waitcnt lgkmcnt(4)
Mvaa 76,244,220
Ta 236,5,32768
Mvaa 72,244,204
Ta 238,5,34816
Mvaa 80,248,204
Ta 240,2,36864
GDMA 14,98,2048
Mvaa 84,248,220
Ta 242,2,38912
Mvaa 92,252,220
Ta 244,3,36864
Mvaa 88,252,204
Ta 246,3,38912
buffer_load_dword v251, v250, s[28:31], 0 offen offset:0 sc1
Mvav 64,224,160
Ta 248,4,36864
GDMA 15,98,3072
Mvav 68,224,176
Ta 250,4,38912
s_waitcnt lgkmcnt(4)
Mvav 76,228,176
Ta 252,5,36864
Mvav 72,228,160
Ta 254,5,38912
Mvav 80,232,160
Ta 224,2,40960
Mvav 84,232,176
Ta 226,2,43008
Mvav 92,236,176
Ta 228,3,40960
Mvav 88,236,160
Ta 230,3,43008
Mvav 64,240,164
Ta 232,4,40960
Mvav 68,240,180
Ta 234,4,43008
s_waitcnt lgkmcnt(4)
Mvav 76,244,180
Ta 236,5,40960
Mvav 72,244,164
Ta 238,5,43008
Mvav 80,248,164
Ta 240,2,45056
Mvav 84,248,180
Ta 242,2,47104
Mvav 92,252,180
Ta 244,3,45056
Mvav 88,252,164
Ta 246,3,47104
Mvav 64,224,168
Ta 248,4,45056
Mvav 68,224,184
Ta 250,4,47104
s_waitcnt lgkmcnt(4)
Mvav 76,228,184
Ta 252,5,45056
Mvav 72,228,168
Ta 254,5,47104
s_waitcnt vmcnt(27)
s_barrier
Mvav 80,232,168
Ta 224,2,49152
s_add_u32 m0, s35, 0x14000
Mvav 84,232,184
Ta 226,2,51200
s_add_u32 s44, s39, 0x24400
Mvav 92,236,184
Ta 228,3,49152
s_add_u32 s98, s12, s44
s_addc_u32 s99, s13, 0
Mvav 88,236,168
Ta 230,3,51200
GDMA 12,98,0
Mvav 64,240,172
Ta 232,4,49152
GDMA 13,98,1024
Mvav 68,240,188
Ta 234,4,51200
s_waitcnt lgkmcnt(4)
Mvav 76,244,188
Ta 236,5,49152
Mvav 72,244,172
Ta 238,5,51200
Mvav 80,248,172
Ta 240,2,53248
GDMA 14,98,2048
Mvav 84,248,188
Ta 242,2,55296
Mvav 92,252,188
Ta 244,3,53248
Mvav 88,252,172
Ta 246,3,55296
Mvav 64,224,192
Ta 248,4,53248
GDMA 15,98,3072
Mvav 68,224,208
Ta 250,4,55296
s_waitcnt lgkmcnt(4)
Mvav 76,228,208
Ta 252,5,53248
Mvav 72,228,192
Ta 254,5,55296
Mvav 80,232,192
Ta 224,2,57344
Mvav 84,232,208
Ta 226,2,59392
Mvav 92,236,208
Ta 228,3,57344
Mvav 88,236,192
Ta 230,3,59392
Mvav 64,240,196
Ta 232,4,57344
Mvav 68,240,212
Ta 234,4,59392
s_waitcnt lgkmcnt(4)
Mvav 76,244,212
Ta 236,5,57344
Mvav 72,244,196
Ta 238,5,59392
Mvav 80,248,196
Ta 240,2,61440
Mvav 84,248,212
Ta 242,2,63488
v_xor_b32 v2, 0x10000, v2
Mvav 92,252,212
Ta 244,3,61440
Mvav 88,252,196
Ta 246,3,63488
v_xor_b32 v3, 0x10000, v3
Mvav 64,224,200
Ta 248,4,61440
Mvav 68,224,216
Ta 250,4,63488
s_waitcnt lgkmcnt(4)
Mvav 76,228,216
Ta 252,5,61440
v_xor_b32 v4, 0x10000, v4
Mvav 72,228,200
Ta 254,5,63488
s_waitcnt vmcnt(26)
s_barrier
Mvav 80,232,200
Ta 224,2,0
v_xor_b32 v5, 0x10000, v5
Mvav 84,232,216
Ta 226,2,2048
s_add_u32 m0, s35, 0x18000
Mvav 92,236,216
Ta 228,3,0
s_add_u32 s44, s39, 0x48400
Mvav 88,236,200
Ta 230,3,2048
s_add_u32 s98, s12, s44
s_addc_u32 s99, s13, 0
Mvav 64,240,204
Ta 232,4,0
GDMA 12,98,0
Mvav 68,240,220
Ta 234,4,2048
s_waitcnt lgkmcnt(4)
Mvav 76,244,220
Ta 236,5,0
GDMA 13,98,1024
Mvav 72,244,204
Ta 238,5,2048
Mvav 80,248,204
Ta 240,2,4096
GDMA 14,98,2048
Mvav 84,248,220
Ta 242,2,6144
Mvav 92,252,220
Ta 244,3,4096
Mvav 88,252,204
Ta 246,3,6144
Zvaa 96,224,160
Ta 248,4,4096
GDMA 15,98,3072
Zvaa 100,224,176
Ta 250,4,6144
s_waitcnt lgkmcnt(4)
Zvaa 108,228,176
Ta 252,5,4096
v_cvt_pk_bf16_f32 v224, v64, v65
Zvaa 104,228,160
Ta 254,5,6144
v_cvt_pk_bf16_f32 v225, v66, v67
Zvaa 112,232,160
Ta 224,2,8192
v_cvt_pk_bf16_f32 v226, v72, v73
Zvaa 116,232,176
Ta 226,2,10240
v_cvt_pk_bf16_f32 v227, v74, v75
Zvaa 124,236,176
Ta 228,3,8192
s_add_u32 s48, s47, 0x6000
Zvaa 120,236,160
Ta 230,3,10240
buffer_store_dwordx4 v[224:227], v28, s[28:31], s48 offen offset:0 sc1
Mvaa 96,240,164
Ta 232,4,8192
v_cvt_pk_bf16_f32 v232, v68, v69
Mvaa 100,240,180
Ta 234,4,10240
s_waitcnt lgkmcnt(4)
Mvaa 108,244,180
Ta 236,5,8192
v_cvt_pk_bf16_f32 v233, v70, v71
Mvaa 104,244,164
Ta 238,5,10240
v_cvt_pk_bf16_f32 v234, v76, v77
Mvaa 112,248,164
Ta 240,2,12288
v_cvt_pk_bf16_f32 v235, v78, v79
Mvaa 116,248,180
Ta 242,2,14336
buffer_store_dwordx4 v[232:235], v28, s[28:31], s48 offen offset:1024 sc1
Mvaa 124,252,180
Ta 244,3,12288
v_cvt_pk_bf16_f32 v240, v80, v81
Mvaa 120,252,164
Ta 246,3,14336
v_cvt_pk_bf16_f32 v241, v82, v83
Mvaa 96,224,168
Ta 248,4,12288
v_cvt_pk_bf16_f32 v242, v88, v89
Mvaa 100,224,184
Ta 250,4,14336
s_waitcnt lgkmcnt(4)
Mvaa 108,228,184
Ta 252,5,12288
v_cvt_pk_bf16_f32 v243, v90, v91
Mvaa 104,228,168
Ta 254,5,14336
s_waitcnt vmcnt(27)
s_barrier
Mvaa 112,232,168
Ta 224,2,16384
s_add_u32 m0, s35, 0x1c000
Mvaa 116,232,184
Ta 226,2,18432
s_add_u32 s44, s39, 0x6c400
Mvaa 124,236,184
Ta 228,3,16384
s_add_u32 s98, s12, s44
s_addc_u32 s99, s13, 0
Mvaa 120,236,168
Ta 230,3,18432
GDMA 12,98,0
Mvaa 96,240,172
Ta 232,4,16384
GDMA 13,98,1024
Mvaa 100,240,188
Ta 234,4,18432
s_waitcnt lgkmcnt(4)
Mvaa 108,244,188
Ta 236,5,16384
buffer_store_dwordx4 v[240:243], v28, s[28:31], s48 offen offset:2048 sc1
Mvaa 104,244,172
Ta 238,5,18432
v_cvt_pk_bf16_f32 v224, v84, v85
Mvaa 112,248,172
Ta 240,2,20480
GDMA 14,98,2048
Mvaa 116,248,188
Ta 242,2,22528
v_cvt_pk_bf16_f32 v225, v86, v87
Mvaa 124,252,188
Ta 244,3,20480
v_cvt_pk_bf16_f32 v226, v92, v93
Mvaa 120,252,172
Ta 246,3,22528
v_cvt_pk_bf16_f32 v227, v94, v95
Mvaa 96,224,192
Ta 248,4,20480
GDMA 15,98,3072
Mvaa 100,224,208
Ta 250,4,22528
s_waitcnt lgkmcnt(4)
Mvaa 108,228,208
Ta 252,5,20480
buffer_store_dwordx4 v[224:227], v28, s[28:31], s48 offen offset:3072 sc1
Mvaa 104,228,192
Ta 254,5,22528
Mvaa 112,232,192
Ta 224,2,24576
Mvaa 116,232,208
Ta 226,2,26624
Mvaa 124,236,208
Ta 228,3,24576
Mvaa 120,236,192
Ta 230,3,26624
Mvaa 96,240,196
Ta 232,4,24576
Mvaa 100,240,212
Ta 234,4,26624
s_waitcnt lgkmcnt(4)
Mvaa 108,244,212
Ta 236,5,24576
Mvaa 104,244,196
Ta 238,5,26624
Mvaa 112,248,196
Ta 240,2,28672
Mvaa 116,248,212
Ta 242,2,30720
Mvaa 124,252,212
Ta 244,3,28672
Mvaa 120,252,196
Ta 246,3,30720
Mvaa 96,224,200
Ta 248,4,28672
Mvaa 100,224,216
Ta 250,4,30720
s_waitcnt lgkmcnt(4)
Mvaa 108,228,216
Ta 252,5,28672
Mvaa 104,228,200
Ta 254,5,30720
s_waitcnt vmcnt(29)
s_barrier
Mvaa 112,232,200
Ta 224,2,32768
Mvaa 116,232,216
Ta 226,2,34816
Mvaa 124,236,216
Ta 228,3,32768
Mvaa 120,236,200
Ta 230,3,34816
Mvaa 96,240,204
Ta 232,4,32768
Mvaa 100,240,220
Ta 234,4,34816
s_waitcnt lgkmcnt(4)
Mvaa 108,244,220
Ta 236,5,32768
Mvaa 104,244,204
Ta 238,5,34816
Mvaa 112,248,204
Ta 240,2,36864
Mvaa 116,248,220
Ta 242,2,38912
Mvaa 124,252,220
Ta 244,3,36864
Mvaa 120,252,204
Ta 246,3,38912
Mvav 96,224,160
Ta 248,4,36864
Mvav 100,224,176
Ta 250,4,38912
s_waitcnt lgkmcnt(4)
Mvav 108,228,176
Ta 252,5,36864
Mvav 104,228,160
Ta 254,5,38912
Mvav 112,232,160
Ta 224,2,40960
Mvav 116,232,176
Ta 226,2,43008
Mvav 124,236,176
Ta 228,3,40960
Mvav 120,236,160
Ta 230,3,43008
Mvav 96,240,164
Ta 232,4,40960
Mvav 100,240,180
Ta 234,4,43008
s_waitcnt lgkmcnt(4)
Mvav 108,244,180
Ta 236,5,40960
Mvav 104,244,164
Ta 238,5,43008
Mvav 112,248,164
Ta 240,2,45056
Mvav 116,248,180
Ta 242,2,47104
Mvav 124,252,180
Ta 244,3,45056
Mvav 120,252,164
Ta 246,3,47104
Mvav 96,224,168
Ta 248,4,45056
Mvav 100,224,184
Ta 250,4,47104
s_waitcnt lgkmcnt(4)
Mvav 108,228,184
Ta 252,5,45056
Mvav 104,228,168
Ta 254,5,47104
s_waitcnt vmcnt(22)
s_barrier
Mvav 112,232,168
Ta 224,2,49152
Mvav 116,232,184
Ta 226,2,51200
Mvav 124,236,184
Ta 228,3,49152
Mvav 120,236,168
Ta 230,3,51200
Mvav 96,240,172
Ta 232,4,49152
Mvav 100,240,188
Ta 234,4,51200
s_waitcnt lgkmcnt(4)
Mvav 108,244,188
Ta 236,5,49152
Mvav 104,244,172
Ta 238,5,51200
Mvav 112,248,172
Ta 240,2,53248
Mvav 116,248,188
Ta 242,2,55296
Mvav 124,252,188
Ta 244,3,53248
Mvav 120,252,172
Ta 246,3,55296
s_mul_i32 s101, s100, 4
s_waitcnt vmcnt(17)
v_cmp_gt_u32 vcc, s101, v251
s_nop 4
s_cbranch_vccnz L_spin_att_r0
L_spin_att_r0_b:
Mvav 96,224,192
Ta 248,4,53248
Mvav 100,224,208
Ta 250,4,55296
s_waitcnt lgkmcnt(4)
Mvav 108,228,208
Ta 252,5,53248
Mvav 104,228,192
Ta 254,5,55296
Mvav 112,232,192
Ta 224,2,57344
Mvav 116,232,208
Ta 226,2,59392
Mvav 124,236,208
Ta 228,3,57344
Mvav 120,236,192
Ta 230,3,59392
Mvav 96,240,196
Ta 232,4,57344
Mvav 100,240,212
Ta 234,4,59392
s_waitcnt lgkmcnt(4)
Mvav 108,244,212
Ta 236,5,57344
Mvav 104,244,196
Ta 238,5,59392
Mvav 112,248,196
Ta 240,2,61440
Mvav 116,248,212
Ta 242,2,63488
v_xor_b32 v2, 0x10000, v2
Mvav 124,252,212
Ta 244,3,61440
Mvav 120,252,196
Ta 246,3,63488
v_xor_b32 v3, 0x10000, v3
Mvav 96,224,200
Ta 248,4,61440
Mvav 100,224,216
Ta 250,4,63488
s_waitcnt lgkmcnt(4)
Mvav 108,228,216
Ta 252,5,61440
v_xor_b32 v4, 0x10000, v4
Mvav 104,228,200
Ta 254,5,63488
s_waitcnt vmcnt(16)
s_barrier
Mvav 112,232,200
Ta 224,2,0
v_xor_b32 v5, 0x10000, v5
Mvav 116,232,216
Ta 226,2,2048
buffer_load_dwordx4 a[64:67], v248, s[28:31], s56 offen offset:0 sc1
Mvav 124,236,216
Ta 228,3,0
Mvav 120,236,200
Ta 230,3,2048
Mvav 96,240,204
Ta 232,4,0
Mvav 100,240,220
Ta 234,4,2048
s_waitcnt lgkmcnt(4)
Mvav 108,244,220
Ta 236,5,0
buffer_load_dwordx4 a[68:71], v248, s[28:31], s57 offen offset:0 sc1
Mvav 104,244,204
Ta 238,5,2048
Mvav 112,248,204
Ta 240,2,4096
Mvav 116,248,220
Ta 242,2,6144
Mvav 124,252,220
Ta 244,3,4096
Mvav 120,252,204
Ta 246,3,6144
Zvaa 32,224,160
Ta 248,4,4096
buffer_load_dwordx4 a[72:75], v248, s[28:31], s58 offen offset:0 sc1
Zvaa 36,224,176
Ta 250,4,6144
s_waitcnt lgkmcnt(4)
Zvaa 44,228,176
Ta 252,5,4096
v_cvt_pk_bf16_f32 v232, v96, v97
Zvaa 40,228,160
Ta 254,5,6144
v_cvt_pk_bf16_f32 v233, v98, v99
Zvaa 48,232,160
Ta 224,2,8192
v_cvt_pk_bf16_f32 v234, v104, v105
Zvaa 52,232,176
Ta 226,2,10240
v_cvt_pk_bf16_f32 v235, v106, v107
Zvaa 60,236,176
Ta 228,3,8192
buffer_load_dwordx4 a[76:79], v248, s[28:31], s59 offen offset:0 sc1
Zvaa 56,236,160
Ta 230,3,10240
s_add_u32 s48, s47, 0x7000
Mvaa 32,240,164
Ta 232,4,8192
buffer_store_dwordx4 v[232:235], v28, s[28:31], s48 offen offset:0 sc1
Mvaa 36,240,180
Ta 234,4,10240
s_waitcnt lgkmcnt(4)
Mvaa 44,244,180
Ta 236,5,8192
v_cvt_pk_bf16_f32 v240, v100, v101
Mvaa 40,244,164
Ta 238,5,10240
v_cvt_pk_bf16_f32 v241, v102, v103
Mvaa 48,248,164
Ta 240,2,12288
buffer_load_dwordx4 a[80:83], v248, s[28:31], s64 offen offset:0 sc1
Mvaa 52,248,180
Ta 242,2,14336
v_cvt_pk_bf16_f32 v242, v108, v109
Mvaa 60,252,180
Ta 244,3,12288
v_cvt_pk_bf16_f32 v243, v110, v111
Mvaa 56,252,164
Ta 246,3,14336
buffer_store_dwordx4 v[240:243], v28, s[28:31], s48 offen offset:1024 sc1
Mvaa 32,224,168
Ta 248,4,12288
v_cvt_pk_bf16_f32 v224, v112, v113
Mvaa 36,224,184
Ta 250,4,14336
s_waitcnt lgkmcnt(4)
Mvaa 44,228,184
Ta 252,5,12288
buffer_load_dwordx4 a[84:87], v248, s[28:31], s65 offen offset:0 sc1
Mvaa 40,228,168
Ta 254,5,14336
s_waitcnt vmcnt(20)
s_barrier
Mvaa 48,232,168
Ta 224,2,16384
v_cvt_pk_bf16_f32 v225, v114, v115
Mvaa 52,232,184
Ta 226,2,18432
v_cvt_pk_bf16_f32 v226, v120, v121
Mvaa 60,236,184
Ta 228,3,16384
v_cvt_pk_bf16_f32 v227, v122, v123
Mvaa 56,236,168
Ta 230,3,18432
buffer_store_dwordx4 v[224:227], v28, s[28:31], s48 offen offset:2048 sc1
Mvaa 32,240,172
Ta 232,4,16384
buffer_load_dwordx4 a[88:91], v248, s[28:31], s66 offen offset:0 sc1
Mvaa 36,240,188
Ta 234,4,18432
s_waitcnt lgkmcnt(4)
Mvaa 44,244,188
Ta 236,5,16384
v_cvt_pk_bf16_f32 v232, v116, v117
Mvaa 40,244,172
Ta 238,5,18432
v_cvt_pk_bf16_f32 v233, v118, v119
Mvaa 48,248,172
Ta 240,2,20480
v_cvt_pk_bf16_f32 v234, v124, v125
Mvaa 52,248,188
Ta 242,2,22528
v_cvt_pk_bf16_f32 v235, v126, v127
Mvaa 60,252,188
Ta 244,3,20480
buffer_store_dwordx4 v[232:235], v28, s[28:31], s48 offen offset:3072 sc1
Mvaa 56,252,172
Ta 246,3,22528
buffer_load_dwordx4 a[92:95], v248, s[28:31], s67 offen offset:0 sc1
Mvaa 32,224,192
Ta 248,4,20480
Mvaa 36,224,208
Ta 250,4,22528
s_waitcnt lgkmcnt(4)
Mvaa 44,228,208
Ta 252,5,20480
Mvaa 40,228,192
Ta 254,5,22528
Mvaa 48,232,192
Ta 224,2,24576
buffer_load_dwordx4 a[96:99], v248, s[28:31], s72 offen offset:0 sc1
Mvaa 52,232,208
Ta 226,2,26624
Mvaa 60,236,208
Ta 228,3,24576
buffer_load_dword v251, v255, s[28:31], 0 offen offset:0 sc1
Mvaa 56,236,192
Ta 230,3,26624
Mvaa 32,240,196
Ta 232,4,24576
Mvaa 36,240,212
Ta 234,4,26624
s_waitcnt lgkmcnt(4)
Mvaa 44,244,212
Ta 236,5,24576
buffer_load_dwordx4 a[100:103], v248, s[28:31], s73 offen offset:0 sc1
Mvaa 40,244,196
Ta 238,5,26624
Mvaa 48,248,196
Ta 240,2,28672
Mvaa 52,248,212
Ta 242,2,30720
Mvaa 60,252,212
Ta 244,3,28672
Mvaa 56,252,196
Ta 246,3,30720
Mvaa 32,224,200
Ta 248,4,28672
buffer_load_dwordx4 a[104:107], v248, s[28:31], s74 offen offset:0 sc1
Mvaa 36,224,216
Ta 250,4,30720
s_waitcnt lgkmcnt(4)
Mvaa 44,228,216
Ta 252,5,28672
Mvaa 40,228,200
Ta 254,5,30720
s_waitcnt vmcnt(16)
s_barrier
Mvaa 48,232,200
Ta 224,2,32768
v_mov_b32 v254, 7
Mvaa 52,232,216
Ta 226,2,34816
buffer_store_dword v254, v252, s[28:31], 0 offen offset:0 sc1
Mvaa 60,236,216
Ta 228,3,32768
buffer_load_dwordx4 a[108:111], v248, s[28:31], s75 offen offset:0 sc1
Mvaa 56,236,200
Ta 230,3,34816
Mvaa 32,240,204
Ta 232,4,32768
Mvaa 36,240,220
Ta 234,4,34816
s_waitcnt lgkmcnt(4)
Mvaa 44,244,220
Ta 236,5,32768
Mvaa 40,244,204
Ta 238,5,34816
Mvaa 48,248,204
Ta 240,2,36864
buffer_load_dwordx4 a[112:115], v248, s[28:31], s88 offen offset:0 sc1
Mvaa 52,248,220
Ta 242,2,38912
Mvaa 60,252,220
Ta 244,3,36864
Mvaa 56,252,204
Ta 246,3,38912
Mvav 32,224,160
Ta 248,4,36864
Mvav 36,224,176
Ta 250,4,38912
s_waitcnt lgkmcnt(4)
Mvav 44,228,176
Ta 252,5,36864
buffer_load_dwordx4 a[116:119], v248, s[28:31], s89 offen offset:0 sc1
Mvav 40,228,160
Ta 254,5,38912
Mvav 48,232,160
Ta 224,2,40960
Mvav 52,232,176
Ta 226,2,43008
Mvav 60,236,176
Ta 228,3,40960
Mvav 56,236,160
Ta 230,3,43008
Mvav 32,240,164
Ta 232,4,40960
buffer_load_dwordx4 a[120:123], v248, s[28:31], s90 offen offset:0 sc1
Mvav 36,240,180
Ta 234,4,43008
s_waitcnt lgkmcnt(4)
Mvav 44,244,180
Ta 236,5,40960
Mvav 40,244,164
Ta 238,5,43008
Mvav 48,248,164
Ta 240,2,45056
Mvav 52,248,180
Ta 242,2,47104
Mvav 60,252,180
Ta 244,3,45056
buffer_load_dwordx4 a[124:127], v248, s[28:31], s91 offen offset:0 sc1
Mvav 56,252,164
Ta 246,3,47104
Mvav 32,224,168
Ta 248,4,45056
Mvav 36,224,184
Ta 250,4,47104
s_waitcnt lgkmcnt(4)
Mvav 44,228,184
Ta 252,5,45056
Mvav 40,228,168
Ta 254,5,47104
s_barrier
Mvav 48,232,168
Ta 224,2,49152
buffer_load_dwordx4 a[128:131], v249, s[4:7], 0 offen offset:0
Mvav 52,232,184
Ta 226,2,51200
Mvav 60,236,184
Ta 228,3,49152
Mvav 56,236,168
Ta 230,3,51200
Mvav 32,240,172
Ta 232,4,49152
Mvav 36,240,188
Ta 234,4,51200
s_waitcnt lgkmcnt(4)
Mvav 44,244,188
Ta 236,5,49152
v_add_u32 v248, 0x4000, v248
Mvav 40,244,172
Ta 238,5,51200
Mvav 48,248,172
Ta 240,2,53248
Mvav 52,248,188
Ta 242,2,55296
Mvav 60,252,188
Ta 244,3,53248
Mvav 56,252,172
Ta 246,3,55296
Mvav 32,224,192
Ta 248,4,53248
Mvav 36,224,208
Ta 250,4,55296
s_waitcnt lgkmcnt(4)
Mvav 44,228,208
Ta 252,5,53248
Mvav 40,228,192
Ta 254,5,55296
Mvav 48,232,192
Ta 224,2,57344
Mvav 52,232,208
Ta 226,2,59392
Mvav 60,236,208
Ta 228,3,57344
Mvav 56,236,192
Ta 230,3,59392
Mvav 32,240,196
Ta 232,4,57344
Mvav 36,240,212
Ta 234,4,59392
s_waitcnt lgkmcnt(4)
Mvav 44,244,212
Ta 236,5,57344
Mvav 40,244,196
Ta 238,5,59392
Mvav 48,248,196
Ta 240,2,61440
Mvav 52,248,212
Ta 242,2,63488
Mvav 60,252,212
Ta 244,3,61440
Mvav 56,252,196
Ta 246,3,63488
Mvav 32,224,200
Ta 248,4,61440
Mvav 36,224,216
Ta 250,4,63488
s_waitcnt lgkmcnt(4)
Mvav 44,228,216
Ta 252,5,61440
Mvav 40,228,200
Ta 254,5,63488
Mvav 48,232,200
Mvav 52,232,216
Mvav 60,236,216
Mvav 56,236,200
Mvav 32,240,204
Mvav 36,240,220
s_waitcnt lgkmcnt(0)
Mvav 44,244,220
Mvav 40,244,204
Mvav 48,248,204
Mvav 52,248,220
Mvav 60,252,220
Mvav 56,252,204
v_cvt_pk_bf16_f32 v240, v32, v33
v_cvt_pk_bf16_f32 v241, v34, v35
s_nop 1
v_cvt_pk_bf16_f32 v242, v40, v41
v_cvt_pk_bf16_f32 v243, v42, v43
s_add_u32 s48, s47, 0x8000
buffer_store_dwordx4 v[240:243], v28, s[28:31], s48 offen offset:0 sc1
v_cvt_pk_bf16_f32 v224, v36, v37
v_cvt_pk_bf16_f32 v225, v38, v39
v_cvt_pk_bf16_f32 v226, v44, v45
v_cvt_pk_bf16_f32 v227, v46, v47
buffer_store_dwordx4 v[224:227], v28, s[28:31], s48 offen offset:1024 sc1
v_cvt_pk_bf16_f32 v232, v48, v49
v_cvt_pk_bf16_f32 v233, v50, v51
v_cvt_pk_bf16_f32 v234, v56, v57
v_cvt_pk_bf16_f32 v235, v58, v59
buffer_store_dwordx4 v[232:235], v28, s[28:31], s48 offen offset:2048 sc1
v_cvt_pk_bf16_f32 v240, v52, v53
v_cvt_pk_bf16_f32 v241, v54, v55
v_cvt_pk_bf16_f32 v242, v60, v61
v_cvt_pk_bf16_f32 v243, v62, v63
buffer_store_dwordx4 v[240:243], v28, s[28:31], s48 offen offset:3072 sc1
s_mov_b32 s94, 0x3f80
s_mov_b32 s95, 0x3f800000
s_cmp_eq_u32 s3, 3
s_cbranch_scc1 L_tailB_att
s_mov_b32 s101, 7
s_waitcnt vmcnt(13)
v_cmp_gt_u32 vcc, s101, v251
s_nop 4
s_cbranch_vccnz L_spin_att_a
L_spin_att_a_b:
buffer_load_dwordx4 v[32:35], v248, s[28:31], s56 offen offset:0 sc1
buffer_load_dwordx4 v[36:39], v248, s[28:31], s57 offen offset:0 sc1
buffer_load_dwordx4 v[40:43], v248, s[28:31], s58 offen offset:0 sc1
buffer_load_dwordx4 v[44:47], v248, s[28:31], s59 offen offset:0 sc1
buffer_load_dwordx4 v[48:51], v248, s[28:31], s64 offen offset:0 sc1
buffer_load_dwordx4 v[52:55], v248, s[28:31], s65 offen offset:0 sc1
buffer_load_dwordx4 v[56:59], v248, s[28:31], s66 offen offset:0 sc1
buffer_load_dwordx4 v[60:63], v248, s[28:31], s67 offen offset:0 sc1
buffer_load_dwordx4 v[64:67], v248, s[28:31], s72 offen offset:0 sc1
buffer_load_dwordx4 v[68:71], v248, s[28:31], s73 offen offset:0 sc1
buffer_load_dwordx4 v[72:75], v248, s[28:31], s74 offen offset:0 sc1
buffer_load_dwordx4 v[76:79], v248, s[28:31], s75 offen offset:0 sc1
buffer_load_dwordx4 v[80:83], v248, s[28:31], s88 offen offset:0 sc1
buffer_load_dwordx4 v[84:87], v248, s[28:31], s89 offen offset:0 sc1
buffer_load_dwordx4 v[88:91], v248, s[28:31], s90 offen offset:0 sc1
buffer_load_dwordx4 v[92:95], v248, s[28:31], s91 offen offset:0 sc1
buffer_load_dwordx4 v[96:99], v249, s[4:7], 0 offen offset:512
v_add_u32 v248, 0x4000, v248
s_waitcnt vmcnt(21)
v_accvgpr_read_b32 v184, a64
v_dot2_f32_bf16 v168, v184, s94, 0
v_dot2_f32_bf16 v169, v184, s95, 0
v_accvgpr_read_b32 v185, a65
v_dot2_f32_bf16 v170, v185, s94, 0
v_dot2_f32_bf16 v171, v185, s95, 0
v_accvgpr_read_b32 v186, a66
v_dot2_f32_bf16 v172, v186, s94, 0
v_dot2_f32_bf16 v173, v186, s95, 0
v_accvgpr_read_b32 v187, a67
v_dot2_f32_bf16 v174, v187, s94, 0
v_dot2_f32_bf16 v175, v187, s95, 0
v_accvgpr_read_b32 v184, a68
v_dot2_f32_bf16 v168, v184, s94, v168
v_dot2_f32_bf16 v169, v184, s95, v169
v_accvgpr_read_b32 v185, a69
v_dot2_f32_bf16 v170, v185, s94, v170
v_dot2_f32_bf16 v171, v185, s95, v171
v_accvgpr_read_b32 v186, a70
v_dot2_f32_bf16 v172, v186, s94, v172
v_dot2_f32_bf16 v173, v186, s95, v173
v_accvgpr_read_b32 v187, a71
v_dot2_f32_bf16 v174, v187, s94, v174
v_dot2_f32_bf16 v175, v187, s95, v175
v_accvgpr_read_b32 v184, a72
v_dot2_f32_bf16 v168, v184, s94, v168
v_dot2_f32_bf16 v169, v184, s95, v169
v_accvgpr_read_b32 v185, a73
v_dot2_f32_bf16 v170, v185, s94, v170
v_dot2_f32_bf16 v171, v185, s95, v171
v_accvgpr_read_b32 v186, a74
v_dot2_f32_bf16 v172, v186, s94, v172
v_dot2_f32_bf16 v173, v186, s95, v173
v_accvgpr_read_b32 v187, a75
v_dot2_f32_bf16 v174, v187, s94, v174
v_dot2_f32_bf16 v175, v187, s95, v175
v_accvgpr_read_b32 v184, a76
v_dot2_f32_bf16 v168, v184, s94, v168
v_dot2_f32_bf16 v169, v184, s95, v169
v_accvgpr_read_b32 v185, a77
v_dot2_f32_bf16 v170, v185, s94, v170
v_dot2_f32_bf16 v171, v185, s95, v171
v_accvgpr_read_b32 v186, a78
v_dot2_f32_bf16 v172, v186, s94, v172
v_dot2_f32_bf16 v173, v186, s95, v173
v_accvgpr_read_b32 v187, a79
v_dot2_f32_bf16 v174, v187, s94, v174
v_dot2_f32_bf16 v175, v187, s95, v175
v_accvgpr_read_b32 v184, a80
v_dot2_f32_bf16 v168, v184, s94, v168
v_dot2_f32_bf16 v169, v184, s95, v169
v_accvgpr_read_b32 v185, a81
v_dot2_f32_bf16 v170, v185, s94, v170
v_dot2_f32_bf16 v171, v185, s95, v171
v_accvgpr_read_b32 v186, a82
v_dot2_f32_bf16 v172, v186, s94, v172
v_dot2_f32_bf16 v173, v186, s95, v173
v_accvgpr_read_b32 v187, a83
v_dot2_f32_bf16 v174, v187, s94, v174
v_dot2_f32_bf16 v175, v187, s95, v175
v_accvgpr_read_b32 v184, a84
v_dot2_f32_bf16 v168, v184, s94, v168
v_dot2_f32_bf16 v169, v184, s95, v169
v_accvgpr_read_b32 v185, a85
v_dot2_f32_bf16 v170, v185, s94, v170
v_dot2_f32_bf16 v171, v185, s95, v171
v_accvgpr_read_b32 v186, a86
v_dot2_f32_bf16 v172, v186, s94, v172
v_dot2_f32_bf16 v173, v186, s95, v173
v_accvgpr_read_b32 v187, a87
v_dot2_f32_bf16 v174, v187, s94, v174
v_dot2_f32_bf16 v175, v187, s95, v175
v_accvgpr_read_b32 v184, a88
v_dot2_f32_bf16 v168, v184, s94, v168
v_dot2_f32_bf16 v169, v184, s95, v169
v_accvgpr_read_b32 v185, a89
v_dot2_f32_bf16 v170, v185, s94, v170
v_dot2_f32_bf16 v171, v185, s95, v171
v_accvgpr_read_b32 v186, a90
v_dot2_f32_bf16 v172, v186, s94, v172
v_dot2_f32_bf16 v173, v186, s95, v173
v_accvgpr_read_b32 v187, a91
v_dot2_f32_bf16 v174, v187, s94, v174
v_dot2_f32_bf16 v175, v187, s95, v175
v_accvgpr_read_b32 v184, a92
v_dot2_f32_bf16 v168, v184, s94, v168
v_dot2_f32_bf16 v169, v184, s95, v169
v_accvgpr_read_b32 v185, a93
v_dot2_f32_bf16 v170, v185, s94, v170
v_dot2_f32_bf16 v171, v185, s95, v171
v_accvgpr_read_b32 v186, a94
v_dot2_f32_bf16 v172, v186, s94, v172
v_dot2_f32_bf16 v173, v186, s95, v173
v_accvgpr_read_b32 v187, a95
v_dot2_f32_bf16 v174, v187, s94, v174
v_dot2_f32_bf16 v175, v187, s95, v175
v_accvgpr_read_b32 v184, a96
v_dot2_f32_bf16 v176, v184, s94, 0
v_dot2_f32_bf16 v177, v184, s95, 0
v_accvgpr_read_b32 v185, a97
v_dot2_f32_bf16 v178, v185, s94, 0
v_dot2_f32_bf16 v179, v185, s95, 0
v_accvgpr_read_b32 v186, a98
v_dot2_f32_bf16 v180, v186, s94, 0
v_dot2_f32_bf16 v181, v186, s95, 0
v_accvgpr_read_b32 v187, a99
v_dot2_f32_bf16 v182, v187, s94, 0
v_dot2_f32_bf16 v183, v187, s95, 0
v_accvgpr_read_b32 v184, a100
v_dot2_f32_bf16 v176, v184, s94, v176
v_dot2_f32_bf16 v177, v184, s95, v177
v_accvgpr_read_b32 v185, a101
v_dot2_f32_bf16 v178, v185, s94, v178
v_dot2_f32_bf16 v179, v185, s95, v179
v_accvgpr_read_b32 v186, a102
v_dot2_f32_bf16 v180, v186, s94, v180
v_dot2_f32_bf16 v181, v186, s95, v181
v_accvgpr_read_b32 v187, a103
v_dot2_f32_bf16 v182, v187, s94, v182
v_dot2_f32_bf16 v183, v187, s95, v183
v_accvgpr_read_b32 v184, a104
v_dot2_f32_bf16 v176, v184, s94, v176
v_dot2_f32_bf16 v177, v184, s95, v177
v_accvgpr_read_b32 v185, a105
v_dot2_f32_bf16 v178, v185, s94, v178
v_dot2_f32_bf16 v179, v185, s95, v179
v_accvgpr_read_b32 v186, a106
v_dot2_f32_bf16 v180, v186, s94, v180
v_dot2_f32_bf16 v181, v186, s95, v181
v_accvgpr_read_b32 v187, a107
v_dot2_f32_bf16 v182, v187, s94, v182
v_dot2_f32_bf16 v183, v187, s95, v183
v_accvgpr_read_b32 v184, a108
v_dot2_f32_bf16 v176, v184, s94, v176
v_dot2_f32_bf16 v177, v184, s95, v177
v_accvgpr_read_b32 v185, a109
v_dot2_f32_bf16 v178, v185, s94, v178
v_dot2_f32_bf16 v179, v185, s95, v179
v_accvgpr_read_b32 v186, a110
v_dot2_f32_bf16 v180, v186, s94, v180
v_dot2_f32_bf16 v181, v186, s95, v181
v_accvgpr_read_b32 v187, a111
v_dot2_f32_bf16 v182, v187, s94, v182
v_dot2_f32_bf16 v183, v187, s95, v183
v_accvgpr_read_b32 v184, a112
v_dot2_f32_bf16 v176, v184, s94, v176
v_dot2_f32_bf16 v177, v184, s95, v177
v_accvgpr_read_b32 v185, a113
v_dot2_f32_bf16 v178, v185, s94, v178
v_dot2_f32_bf16 v179, v185, s95, v179
v_accvgpr_read_b32 v186, a114
v_dot2_f32_bf16 v180, v186, s94, v180
v_dot2_f32_bf16 v181, v186, s95, v181
v_accvgpr_read_b32 v187, a115
v_dot2_f32_bf16 v182, v187, s94, v182
v_dot2_f32_bf16 v183, v187, s95, v183
v_accvgpr_read_b32 v184, a116
v_dot2_f32_bf16 v176, v184, s94, v176
v_dot2_f32_bf16 v177, v184, s95, v177
v_accvgpr_read_b32 v185, a117
v_dot2_f32_bf16 v178, v185, s94, v178
v_dot2_f32_bf16 v179, v185, s95, v179
v_accvgpr_read_b32 v186, a118
v_dot2_f32_bf16 v180, v186, s94, v180
v_dot2_f32_bf16 v181, v186, s95, v181
v_accvgpr_read_b32 v187, a119
v_dot2_f32_bf16 v182, v187, s94, v182
v_dot2_f32_bf16 v183, v187, s95, v183
v_accvgpr_read_b32 v184, a120
v_dot2_f32_bf16 v176, v184, s94, v176
v_dot2_f32_bf16 v177, v184, s95, v177
v_accvgpr_read_b32 v185, a121
v_dot2_f32_bf16 v178, v185, s94, v178
v_dot2_f32_bf16 v179, v185, s95, v179
v_accvgpr_read_b32 v186, a122
v_dot2_f32_bf16 v180, v186, s94, v180
v_dot2_f32_bf16 v181, v186, s95, v181
v_accvgpr_read_b32 v187, a123
v_dot2_f32_bf16 v182, v187, s94, v182
v_dot2_f32_bf16 v183, v187, s95, v183
v_accvgpr_read_b32 v184, a124
v_dot2_f32_bf16 v176, v184, s94, v176
v_dot2_f32_bf16 v177, v184, s95, v177
v_accvgpr_read_b32 v185, a125
v_dot2_f32_bf16 v178, v185, s94, v178
v_dot2_f32_bf16 v179, v185, s95, v179
v_accvgpr_read_b32 v186, a126
v_dot2_f32_bf16 v180, v186, s94, v180
v_dot2_f32_bf16 v181, v186, s95, v181
v_accvgpr_read_b32 v187, a127
v_dot2_f32_bf16 v182, v187, s94, v182
v_dot2_f32_bf16 v183, v187, s95, v183
v_mul_f32 v184, 0xc0d22e3c, v176
v_mul_f32 v185, 0xc0d22e3c, v177
v_mul_f32 v186, 0xc0d22e3c, v178
v_mul_f32 v187, 0xc0d22e3c, v179
v_mul_f32 v188, 0xc0d22e3c, v180
v_mul_f32 v189, 0xc0d22e3c, v181
v_mul_f32 v190, 0xc0d22e3c, v182
v_mul_f32 v191, 0xc0d22e3c, v183
v_exp_f32 v184, v184
v_exp_f32 v185, v185
v_exp_f32 v186, v186
v_exp_f32 v187, v187
v_exp_f32 v188, v188
v_exp_f32 v189, v189
v_exp_f32 v190, v190
v_exp_f32 v191, v191
v_mul_f32 v168, v168, v176
v_mul_f32 v169, v169, v177
v_mul_f32 v170, v170, v178
v_mul_f32 v171, v171, v179
v_mul_f32 v172, v172, v180
v_mul_f32 v173, v173, v181
v_mul_f32 v174, v174, v182
v_mul_f32 v175, v175, v183
v_add_f32 v184, 1.0, v184
v_add_f32 v185, 1.0, v185
v_add_f32 v186, 1.0, v186
v_add_f32 v187, 1.0, v187
v_add_f32 v188, 1.0, v188
v_add_f32 v189, 1.0, v189
v_add_f32 v190, 1.0, v190
v_add_f32 v191, 1.0, v191
v_rcp_f32 v184, v184
v_rcp_f32 v185, v185
v_rcp_f32 v186, v186
v_rcp_f32 v187, v187
v_rcp_f32 v188, v188
v_rcp_f32 v189, v189
v_rcp_f32 v190, v190
v_rcp_f32 v191, v191
v_mul_f32 v168, 0x4091afa4, v168
v_mul_f32 v169, 0x4091afa4, v169
v_mul_f32 v170, 0x4091afa4, v170
v_mul_f32 v171, 0x4091afa4, v171
v_mul_f32 v172, 0x4091afa4, v172
v_mul_f32 v173, 0x4091afa4, v173
v_mul_f32 v174, 0x4091afa4, v174
v_mul_f32 v175, 0x4091afa4, v175
v_mul_f32 v168, v168, v184
v_mul_f32 v169, v169, v185
v_mul_f32 v170, v170, v186
v_mul_f32 v171, v171, v187
v_mul_f32 v172, v172, v188
v_mul_f32 v173, v173, v189
v_mul_f32 v174, v174, v190
v_mul_f32 v175, v175, v191
v_permlane32_swap_b32 v168, v172
v_permlane32_swap_b32 v169, v173
v_permlane32_swap_b32 v170, v174
v_permlane32_swap_b32 v171, v175
v_permlane16_swap_b32 v168, v172
v_permlane16_swap_b32 v169, v173
v_permlane16_swap_b32 v170, v174
v_permlane16_swap_b32 v171, v175
v_accvgpr_read_b32 v176, a128
v_accvgpr_read_b32 v177, a129
v_accvgpr_read_b32 v178, a130
v_accvgpr_read_b32 v179, a131
v_lshlrev_b32 v184, 16, v176
v_and_b32 v185, s46, v176
v_lshlrev_b32 v186, 16, v177
v_and_b32 v187, s46, v177
v_lshlrev_b32 v188, 16, v178
v_and_b32 v189, s46, v178
v_lshlrev_b32 v190, 16, v179
v_and_b32 v191, s46, v179
v_add_f32 v184, v184, v168
v_add_f32 v185, v185, v169
v_add_f32 v186, v186, v170
v_add_f32 v187, v187, v171
v_add_f32 v188, v188, v172
v_add_f32 v189, v189, v173
v_add_f32 v190, v190, v174
v_add_f32 v191, v191, v175
v_cvt_pk_bf16_f32 v180, v184, v185
v_cvt_pk_bf16_f32 v181, v186, v187
v_cvt_pk_bf16_f32 v182, v188, v189
v_cvt_pk_bf16_f32 v183, v190, v191
buffer_store_dwordx4 v[180:183], v249, s[60:63], 0 offen offset:0
s_waitcnt vmcnt(1)
v_dot2_f32_bf16 v168, v32, s94, 0
v_dot2_f32_bf16 v169, v32, s95, 0
v_dot2_f32_bf16 v170, v33, s94, 0
v_dot2_f32_bf16 v171, v33, s95, 0
v_dot2_f32_bf16 v172, v34, s94, 0
v_dot2_f32_bf16 v173, v34, s95, 0
v_dot2_f32_bf16 v174, v35, s94, 0
v_dot2_f32_bf16 v175, v35, s95, 0
v_dot2_f32_bf16 v168, v36, s94, v168
v_dot2_f32_bf16 v169, v36, s95, v169
v_dot2_f32_bf16 v170, v37, s94, v170
v_dot2_f32_bf16 v171, v37, s95, v171
v_dot2_f32_bf16 v172, v38, s94, v172
v_dot2_f32_bf16 v173, v38, s95, v173
v_dot2_f32_bf16 v174, v39, s94, v174
v_dot2_f32_bf16 v175, v39, s95, v175
v_dot2_f32_bf16 v168, v40, s94, v168
v_dot2_f32_bf16 v169, v40, s95, v169
v_dot2_f32_bf16 v170, v41, s94, v170
v_dot2_f32_bf16 v171, v41, s95, v171
v_dot2_f32_bf16 v172, v42, s94, v172
v_dot2_f32_bf16 v173, v42, s95, v173
v_dot2_f32_bf16 v174, v43, s94, v174
v_dot2_f32_bf16 v175, v43, s95, v175
v_dot2_f32_bf16 v168, v44, s94, v168
v_dot2_f32_bf16 v169, v44, s95, v169
v_dot2_f32_bf16 v170, v45, s94, v170
v_dot2_f32_bf16 v171, v45, s95, v171
v_dot2_f32_bf16 v172, v46, s94, v172
v_dot2_f32_bf16 v173, v46, s95, v173
v_dot2_f32_bf16 v174, v47, s94, v174
v_dot2_f32_bf16 v175, v47, s95, v175
v_dot2_f32_bf16 v168, v48, s94, v168
v_dot2_f32_bf16 v169, v48, s95, v169
v_dot2_f32_bf16 v170, v49, s94, v170
v_dot2_f32_bf16 v171, v49, s95, v171
v_dot2_f32_bf16 v172, v50, s94, v172
v_dot2_f32_bf16 v173, v50, s95, v173
v_dot2_f32_bf16 v174, v51, s94, v174
v_dot2_f32_bf16 v175, v51, s95, v175
v_dot2_f32_bf16 v168, v52, s94, v168
v_dot2_f32_bf16 v169, v52, s95, v169
v_dot2_f32_bf16 v170, v53, s94, v170
v_dot2_f32_bf16 v171, v53, s95, v171
v_dot2_f32_bf16 v172, v54, s94, v172
v_dot2_f32_bf16 v173, v54, s95, v173
v_dot2_f32_bf16 v174, v55, s94, v174
v_dot2_f32_bf16 v175, v55, s95, v175
v_dot2_f32_bf16 v168, v56, s94, v168
v_dot2_f32_bf16 v169, v56, s95, v169
v_dot2_f32_bf16 v170, v57, s94, v170
v_dot2_f32_bf16 v171, v57, s95, v171
v_dot2_f32_bf16 v172, v58, s94, v172
v_dot2_f32_bf16 v173, v58, s95, v173
v_dot2_f32_bf16 v174, v59, s94, v174
v_dot2_f32_bf16 v175, v59, s95, v175
v_dot2_f32_bf16 v168, v60, s94, v168
v_dot2_f32_bf16 v169, v60, s95, v169
v_dot2_f32_bf16 v170, v61, s94, v170
v_dot2_f32_bf16 v171, v61, s95, v171
v_dot2_f32_bf16 v172, v62, s94, v172
v_dot2_f32_bf16 v173, v62, s95, v173
v_dot2_f32_bf16 v174, v63, s94, v174
v_dot2_f32_bf16 v175, v63, s95, v175
v_dot2_f32_bf16 v176, v64, s94, 0
v_dot2_f32_bf16 v177, v64, s95, 0
v_dot2_f32_bf16 v178, v65, s94, 0
v_dot2_f32_bf16 v179, v65, s95, 0
v_dot2_f32_bf16 v180, v66, s94, 0
v_dot2_f32_bf16 v181, v66, s95, 0
v_dot2_f32_bf16 v182, v67, s94, 0
v_dot2_f32_bf16 v183, v67, s95, 0
v_dot2_f32_bf16 v176, v68, s94, v176
v_dot2_f32_bf16 v177, v68, s95, v177
v_dot2_f32_bf16 v178, v69, s94, v178
v_dot2_f32_bf16 v179, v69, s95, v179
v_dot2_f32_bf16 v180, v70, s94, v180
v_dot2_f32_bf16 v181, v70, s95, v181
v_dot2_f32_bf16 v182, v71, s94, v182
v_dot2_f32_bf16 v183, v71, s95, v183
v_dot2_f32_bf16 v176, v72, s94, v176
v_dot2_f32_bf16 v177, v72, s95, v177
v_dot2_f32_bf16 v178, v73, s94, v178
v_dot2_f32_bf16 v179, v73, s95, v179
v_dot2_f32_bf16 v180, v74, s94, v180
v_dot2_f32_bf16 v181, v74, s95, v181
v_dot2_f32_bf16 v182, v75, s94, v182
v_dot2_f32_bf16 v183, v75, s95, v183
v_dot2_f32_bf16 v176, v76, s94, v176
v_dot2_f32_bf16 v177, v76, s95, v177
v_dot2_f32_bf16 v178, v77, s94, v178
v_dot2_f32_bf16 v179, v77, s95, v179
v_dot2_f32_bf16 v180, v78, s94, v180
v_dot2_f32_bf16 v181, v78, s95, v181
v_dot2_f32_bf16 v182, v79, s94, v182
v_dot2_f32_bf16 v183, v79, s95, v183
v_dot2_f32_bf16 v176, v80, s94, v176
v_dot2_f32_bf16 v177, v80, s95, v177
v_dot2_f32_bf16 v178, v81, s94, v178
v_dot2_f32_bf16 v179, v81, s95, v179
v_dot2_f32_bf16 v180, v82, s94, v180
v_dot2_f32_bf16 v181, v82, s95, v181
v_dot2_f32_bf16 v182, v83, s94, v182
v_dot2_f32_bf16 v183, v83, s95, v183
v_dot2_f32_bf16 v176, v84, s94, v176
v_dot2_f32_bf16 v177, v84, s95, v177
v_dot2_f32_bf16 v178, v85, s94, v178
v_dot2_f32_bf16 v179, v85, s95, v179
v_dot2_f32_bf16 v180, v86, s94, v180
v_dot2_f32_bf16 v181, v86, s95, v181
v_dot2_f32_bf16 v182, v87, s94, v182
v_dot2_f32_bf16 v183, v87, s95, v183
v_dot2_f32_bf16 v176, v88, s94, v176
v_dot2_f32_bf16 v177, v88, s95, v177
v_dot2_f32_bf16 v178, v89, s94, v178
v_dot2_f32_bf16 v179, v89, s95, v179
v_dot2_f32_bf16 v180, v90, s94, v180
v_dot2_f32_bf16 v181, v90, s95, v181
v_dot2_f32_bf16 v182, v91, s94, v182
v_dot2_f32_bf16 v183, v91, s95, v183
v_dot2_f32_bf16 v176, v92, s94, v176
v_dot2_f32_bf16 v177, v92, s95, v177
v_dot2_f32_bf16 v178, v93, s94, v178
v_dot2_f32_bf16 v179, v93, s95, v179
v_dot2_f32_bf16 v180, v94, s94, v180
v_dot2_f32_bf16 v181, v94, s95, v181
v_dot2_f32_bf16 v182, v95, s94, v182
v_dot2_f32_bf16 v183, v95, s95, v183
v_mul_f32 v184, 0xc0d22e3c, v176
v_mul_f32 v185, 0xc0d22e3c, v177
v_mul_f32 v186, 0xc0d22e3c, v178
v_mul_f32 v187, 0xc0d22e3c, v179
v_mul_f32 v188, 0xc0d22e3c, v180
v_mul_f32 v189, 0xc0d22e3c, v181
v_mul_f32 v190, 0xc0d22e3c, v182
v_mul_f32 v191, 0xc0d22e3c, v183
v_exp_f32 v184, v184
v_exp_f32 v185, v185
v_exp_f32 v186, v186
v_exp_f32 v187, v187
v_exp_f32 v188, v188
v_exp_f32 v189, v189
v_exp_f32 v190, v190
v_exp_f32 v191, v191
v_mul_f32 v168, v168, v176
v_mul_f32 v169, v169, v177
v_mul_f32 v170, v170, v178
v_mul_f32 v171, v171, v179
v_mul_f32 v172, v172, v180
v_mul_f32 v173, v173, v181
v_mul_f32 v174, v174, v182
v_mul_f32 v175, v175, v183
v_add_f32 v184, 1.0, v184
v_add_f32 v185, 1.0, v185
v_add_f32 v186, 1.0, v186
v_add_f32 v187, 1.0, v187
v_add_f32 v188, 1.0, v188
v_add_f32 v189, 1.0, v189
v_add_f32 v190, 1.0, v190
v_add_f32 v191, 1.0, v191
v_rcp_f32 v184, v184
v_rcp_f32 v185, v185
v_rcp_f32 v186, v186
v_rcp_f32 v187, v187
v_rcp_f32 v188, v188
v_rcp_f32 v189, v189
v_rcp_f32 v190, v190
v_rcp_f32 v191, v191
v_mul_f32 v168, 0x4091afa4, v168
v_mul_f32 v169, 0x4091afa4, v169
v_mul_f32 v170, 0x4091afa4, v170
v_mul_f32 v171, 0x4091afa4, v171
v_mul_f32 v172, 0x4091afa4, v172
v_mul_f32 v173, 0x4091afa4, v173
v_mul_f32 v174, 0x4091afa4, v174
v_mul_f32 v175, 0x4091afa4, v175
v_mul_f32 v168, v168, v184
v_mul_f32 v169, v169, v185
v_mul_f32 v170, v170, v186
v_mul_f32 v171, v171, v187
v_mul_f32 v172, v172, v188
v_mul_f32 v173, v173, v189
v_mul_f32 v174, v174, v190
v_mul_f32 v175, v175, v191
v_permlane32_swap_b32 v168, v172
v_permlane32_swap_b32 v169, v173
v_permlane32_swap_b32 v170, v174
v_permlane32_swap_b32 v171, v175
v_permlane16_swap_b32 v168, v172
v_permlane16_swap_b32 v169, v173
v_permlane16_swap_b32 v170, v174
v_permlane16_swap_b32 v171, v175
v_lshlrev_b32 v184, 16, v96
v_and_b32 v185, s46, v96
v_lshlrev_b32 v186, 16, v97
v_and_b32 v187, s46, v97
v_lshlrev_b32 v188, 16, v98
v_and_b32 v189, s46, v98
v_lshlrev_b32 v190, 16, v99
v_and_b32 v191, s46, v99
v_add_f32 v184, v184, v168
v_add_f32 v185, v185, v169
v_add_f32 v186, v186, v170
v_add_f32 v187, v187, v171
v_add_f32 v188, v188, v172
v_add_f32 v189, v189, v173
v_add_f32 v190, v190, v174
v_add_f32 v191, v191, v175
v_cvt_pk_bf16_f32 v180, v184, v185
v_cvt_pk_bf16_f32 v181, v186, v187
v_cvt_pk_bf16_f32 v182, v188, v189
v_cvt_pk_bf16_f32 v183, v190, v191
buffer_store_dwordx4 v[180:183], v249, s[60:63], 0 offen offset:512
L_fin_att:
s_endpgm
L_att_end:
L_spin_att_cnt:
s_mov_b32 s85, 0x4e20
L_spin_att_cnt_l:
buffer_load_dword v251, v253, s[68:71], 0 offen offset:0 sc1
s_waitcnt vmcnt(0)
v_cmp_gt_u32 vcc, s101, v251
s_nop 4
s_cbranch_vccz L_spin_att_cnt_b
s_sleep 1
s_sub_u32 s85, s85, 1
s_cmp_lg_u32 s85, 0
s_cbranch_scc1 L_spin_att_cnt_l
s_branch L_spin_att_cnt_b
L_spin_att_r0:
s_mov_b32 s85, 0x4e20
L_spin_att_r0_l:
buffer_load_dword v251, v250, s[28:31], 0 offen offset:0 sc1
s_waitcnt vmcnt(0)
v_cmp_gt_u32 vcc, s101, v251
s_nop 4
s_cbranch_vccz L_spin_att_r0_b
s_sleep 1
s_sub_u32 s85, s85, 1
s_cmp_lg_u32 s85, 0
s_cbranch_scc1 L_spin_att_r0_l
s_branch L_spin_att_r0_b
L_spin_att_a:
s_mov_b32 s85, 0x4e20
L_spin_att_a_l:
buffer_load_dword v251, v255, s[28:31], 0 offen offset:0 sc1
s_waitcnt vmcnt(0)
v_cmp_gt_u32 vcc, s101, v251
s_nop 4
s_cbranch_vccz L_spin_att_a_b
s_sleep 1
s_sub_u32 s85, s85, 1
s_cmp_lg_u32 s85, 0
s_cbranch_scc1 L_spin_att_a_l
s_branch L_spin_att_a_b
L_tailB_att:
v_add_u32 v254, 0x1000, v248
buffer_load_dwordx4 v[32:35], v248, s[28:31], s56 offen offset:0 sc1
buffer_load_dwordx4 v[36:39], v248, s[28:31], s57 offen offset:0 sc1
buffer_load_dwordx4 v[40:43], v248, s[28:31], s58 offen offset:0 sc1
buffer_load_dwordx4 v[44:47], v248, s[28:31], s59 offen offset:0 sc1
buffer_load_dwordx4 v[48:51], v248, s[28:31], s64 offen offset:0 sc1
buffer_load_dwordx4 v[52:55], v248, s[28:31], s65 offen offset:0 sc1
buffer_load_dwordx4 v[56:59], v248, s[28:31], s66 offen offset:0 sc1
buffer_load_dwordx4 v[60:63], v248, s[28:31], s67 offen offset:0 sc1
buffer_load_dwordx4 v[64:67], v248, s[28:31], s72 offen offset:0 sc1
buffer_load_dwordx4 v[68:71], v248, s[28:31], s73 offen offset:0 sc1
buffer_load_dwordx4 v[72:75], v248, s[28:31], s74 offen offset:0 sc1
buffer_load_dwordx4 v[76:79], v248, s[28:31], s75 offen offset:0 sc1
buffer_load_dwordx4 v[80:83], v248, s[28:31], s88 offen offset:0 sc1
buffer_load_dwordx4 v[84:87], v248, s[28:31], s89 offen offset:0 sc1
buffer_load_dwordx4 v[88:91], v248, s[28:31], s90 offen offset:0 sc1
buffer_load_dwordx4 v[92:95], v248, s[28:31], s91 offen offset:0 sc1
buffer_load_dwordx4 v[96:99], v249, s[4:7], 0 offen offset:512
buffer_load_dwordx4 v[100:103], v254, s[28:31], s56 offen offset:0 sc1
buffer_load_dwordx4 v[104:107], v254, s[28:31], s57 offen offset:0 sc1
buffer_load_dwordx4 v[108:111], v254, s[28:31], s58 offen offset:0 sc1
buffer_load_dwordx4 v[112:115], v254, s[28:31], s59 offen offset:0 sc1
buffer_load_dwordx4 v[116:119], v254, s[28:31], s64 offen offset:0 sc1
buffer_load_dwordx4 v[120:123], v254, s[28:31], s65 offen offset:0 sc1
buffer_load_dwordx4 v[124:127], v254, s[28:31], s66 offen offset:0 sc1
buffer_load_dwordx4 v[128:131], v254, s[28:31], s67 offen offset:0 sc1
buffer_load_dwordx4 v[132:135], v254, s[28:31], s72 offen offset:0 sc1
buffer_load_dwordx4 v[136:139], v254, s[28:31], s73 offen offset:0 sc1
buffer_load_dwordx4 v[140:143], v254, s[28:31], s74 offen offset:0 sc1
buffer_load_dwordx4 v[144:147], v254, s[28:31], s75 offen offset:0 sc1
buffer_load_dwordx4 v[148:151], v254, s[28:31], s88 offen offset:0 sc1
buffer_load_dwordx4 v[152:155], v254, s[28:31], s89 offen offset:0 sc1
buffer_load_dwordx4 v[156:159], v254, s[28:31], s90 offen offset:0 sc1
buffer_load_dwordx4 v[160:163], v254, s[28:31], s91 offen offset:0 sc1
buffer_load_dwordx4 v[164:167], v249, s[4:7], 0 offen offset:640
s_waitcnt vmcnt(34)
v_accvgpr_read_b32 v184, a64
v_dot2_f32_bf16 v168, v184, s94, 0
v_dot2_f32_bf16 v169, v184, s95, 0
v_accvgpr_read_b32 v185, a65
v_dot2_f32_bf16 v170, v185, s94, 0
v_dot2_f32_bf16 v171, v185, s95, 0
v_accvgpr_read_b32 v186, a66
v_dot2_f32_bf16 v172, v186, s94, 0
v_dot2_f32_bf16 v173, v186, s95, 0
v_accvgpr_read_b32 v187, a67
v_dot2_f32_bf16 v174, v187, s94, 0
v_dot2_f32_bf16 v175, v187, s95, 0
v_accvgpr_read_b32 v184, a68
v_dot2_f32_bf16 v168, v184, s94, v168
v_dot2_f32_bf16 v169, v184, s95, v169
v_accvgpr_read_b32 v185, a69
v_dot2_f32_bf16 v170, v185, s94, v170
v_dot2_f32_bf16 v171, v185, s95, v171
v_accvgpr_read_b32 v186, a70
v_dot2_f32_bf16 v172, v186, s94, v172
v_dot2_f32_bf16 v173, v186, s95, v173
v_accvgpr_read_b32 v187, a71
v_dot2_f32_bf16 v174, v187, s94, v174
v_dot2_f32_bf16 v175, v187, s95, v175
v_accvgpr_read_b32 v184, a72
v_dot2_f32_bf16 v168, v184, s94, v168
v_dot2_f32_bf16 v169, v184, s95, v169
v_accvgpr_read_b32 v185, a73
v_dot2_f32_bf16 v170, v185, s94, v170
v_dot2_f32_bf16 v171, v185, s95, v171
v_accvgpr_read_b32 v186, a74
v_dot2_f32_bf16 v172, v186, s94, v172
v_dot2_f32_bf16 v173, v186, s95, v173
v_accvgpr_read_b32 v187, a75
v_dot2_f32_bf16 v174, v187, s94, v174
v_dot2_f32_bf16 v175, v187, s95, v175
v_accvgpr_read_b32 v184, a76
v_dot2_f32_bf16 v168, v184, s94, v168
v_dot2_f32_bf16 v169, v184, s95, v169
v_accvgpr_read_b32 v185, a77
v_dot2_f32_bf16 v170, v185, s94, v170
v_dot2_f32_bf16 v171, v185, s95, v171
v_accvgpr_read_b32 v186, a78
v_dot2_f32_bf16 v172, v186, s94, v172
v_dot2_f32_bf16 v173, v186, s95, v173
v_accvgpr_read_b32 v187, a79
v_dot2_f32_bf16 v174, v187, s94, v174
v_dot2_f32_bf16 v175, v187, s95, v175
v_accvgpr_read_b32 v184, a80
v_dot2_f32_bf16 v168, v184, s94, v168
v_dot2_f32_bf16 v169, v184, s95, v169
v_accvgpr_read_b32 v185, a81
v_dot2_f32_bf16 v170, v185, s94, v170
v_dot2_f32_bf16 v171, v185, s95, v171
v_accvgpr_read_b32 v186, a82
v_dot2_f32_bf16 v172, v186, s94, v172
v_dot2_f32_bf16 v173, v186, s95, v173
v_accvgpr_read_b32 v187, a83
v_dot2_f32_bf16 v174, v187, s94, v174
v_dot2_f32_bf16 v175, v187, s95, v175
v_accvgpr_read_b32 v184, a84
v_dot2_f32_bf16 v168, v184, s94, v168
v_dot2_f32_bf16 v169, v184, s95, v169
v_accvgpr_read_b32 v185, a85
v_dot2_f32_bf16 v170, v185, s94, v170
v_dot2_f32_bf16 v171, v185, s95, v171
v_accvgpr_read_b32 v186, a86
v_dot2_f32_bf16 v172, v186, s94, v172
v_dot2_f32_bf16 v173, v186, s95, v173
v_accvgpr_read_b32 v187, a87
v_dot2_f32_bf16 v174, v187, s94, v174
v_dot2_f32_bf16 v175, v187, s95, v175
v_accvgpr_read_b32 v184, a88
v_dot2_f32_bf16 v168, v184, s94, v168
v_dot2_f32_bf16 v169, v184, s95, v169
v_accvgpr_read_b32 v185, a89
v_dot2_f32_bf16 v170, v185, s94, v170
v_dot2_f32_bf16 v171, v185, s95, v171
v_accvgpr_read_b32 v186, a90
v_dot2_f32_bf16 v172, v186, s94, v172
v_dot2_f32_bf16 v173, v186, s95, v173
v_accvgpr_read_b32 v187, a91
v_dot2_f32_bf16 v174, v187, s94, v174
v_dot2_f32_bf16 v175, v187, s95, v175
v_accvgpr_read_b32 v184, a92
v_dot2_f32_bf16 v168, v184, s94, v168
v_dot2_f32_bf16 v169, v184, s95, v169
v_accvgpr_read_b32 v185, a93
v_dot2_f32_bf16 v170, v185, s94, v170
v_dot2_f32_bf16 v171, v185, s95, v171
v_accvgpr_read_b32 v186, a94
v_dot2_f32_bf16 v172, v186, s94, v172
v_dot2_f32_bf16 v173, v186, s95, v173
v_accvgpr_read_b32 v187, a95
v_dot2_f32_bf16 v174, v187, s94, v174
v_dot2_f32_bf16 v175, v187, s95, v175
v_accvgpr_read_b32 v184, a96
v_dot2_f32_bf16 v176, v184, s94, 0
v_dot2_f32_bf16 v177, v184, s95, 0
v_accvgpr_read_b32 v185, a97
v_dot2_f32_bf16 v178, v185, s94, 0
v_dot2_f32_bf16 v179, v185, s95, 0
v_accvgpr_read_b32 v186, a98
v_dot2_f32_bf16 v180, v186, s94, 0
v_dot2_f32_bf16 v181, v186, s95, 0
v_accvgpr_read_b32 v187, a99
v_dot2_f32_bf16 v182, v187, s94, 0
v_dot2_f32_bf16 v183, v187, s95, 0
v_accvgpr_read_b32 v184, a100
v_dot2_f32_bf16 v176, v184, s94, v176
v_dot2_f32_bf16 v177, v184, s95, v177
v_accvgpr_read_b32 v185, a101
v_dot2_f32_bf16 v178, v185, s94, v178
v_dot2_f32_bf16 v179, v185, s95, v179
v_accvgpr_read_b32 v186, a102
v_dot2_f32_bf16 v180, v186, s94, v180
v_dot2_f32_bf16 v181, v186, s95, v181
v_accvgpr_read_b32 v187, a103
v_dot2_f32_bf16 v182, v187, s94, v182
v_dot2_f32_bf16 v183, v187, s95, v183
v_accvgpr_read_b32 v184, a104
v_dot2_f32_bf16 v176, v184, s94, v176
v_dot2_f32_bf16 v177, v184, s95, v177
v_accvgpr_read_b32 v185, a105
v_dot2_f32_bf16 v178, v185, s94, v178
v_dot2_f32_bf16 v179, v185, s95, v179
v_accvgpr_read_b32 v186, a106
v_dot2_f32_bf16 v180, v186, s94, v180
v_dot2_f32_bf16 v181, v186, s95, v181
v_accvgpr_read_b32 v187, a107
v_dot2_f32_bf16 v182, v187, s94, v182
v_dot2_f32_bf16 v183, v187, s95, v183
v_accvgpr_read_b32 v184, a108
v_dot2_f32_bf16 v176, v184, s94, v176
v_dot2_f32_bf16 v177, v184, s95, v177
v_accvgpr_read_b32 v185, a109
v_dot2_f32_bf16 v178, v185, s94, v178
v_dot2_f32_bf16 v179, v185, s95, v179
v_accvgpr_read_b32 v186, a110
v_dot2_f32_bf16 v180, v186, s94, v180
v_dot2_f32_bf16 v181, v186, s95, v181
v_accvgpr_read_b32 v187, a111
v_dot2_f32_bf16 v182, v187, s94, v182
v_dot2_f32_bf16 v183, v187, s95, v183
v_accvgpr_read_b32 v184, a112
v_dot2_f32_bf16 v176, v184, s94, v176
v_dot2_f32_bf16 v177, v184, s95, v177
v_accvgpr_read_b32 v185, a113
v_dot2_f32_bf16 v178, v185, s94, v178
v_dot2_f32_bf16 v179, v185, s95, v179
v_accvgpr_read_b32 v186, a114
v_dot2_f32_bf16 v180, v186, s94, v180
v_dot2_f32_bf16 v181, v186, s95, v181
v_accvgpr_read_b32 v187, a115
v_dot2_f32_bf16 v182, v187, s94, v182
v_dot2_f32_bf16 v183, v187, s95, v183
v_accvgpr_read_b32 v184, a116
v_dot2_f32_bf16 v176, v184, s94, v176
v_dot2_f32_bf16 v177, v184, s95, v177
v_accvgpr_read_b32 v185, a117
v_dot2_f32_bf16 v178, v185, s94, v178
v_dot2_f32_bf16 v179, v185, s95, v179
v_accvgpr_read_b32 v186, a118
v_dot2_f32_bf16 v180, v186, s94, v180
v_dot2_f32_bf16 v181, v186, s95, v181
v_accvgpr_read_b32 v187, a119
v_dot2_f32_bf16 v182, v187, s94, v182
v_dot2_f32_bf16 v183, v187, s95, v183
v_accvgpr_read_b32 v184, a120
v_dot2_f32_bf16 v176, v184, s94, v176
v_dot2_f32_bf16 v177, v184, s95, v177
v_accvgpr_read_b32 v185, a121
v_dot2_f32_bf16 v178, v185, s94, v178
v_dot2_f32_bf16 v179, v185, s95, v179
v_accvgpr_read_b32 v186, a122
v_dot2_f32_bf16 v180, v186, s94, v180
v_dot2_f32_bf16 v181, v186, s95, v181
v_accvgpr_read_b32 v187, a123
v_dot2_f32_bf16 v182, v187, s94, v182
v_dot2_f32_bf16 v183, v187, s95, v183
v_accvgpr_read_b32 v184, a124
v_dot2_f32_bf16 v176, v184, s94, v176
v_dot2_f32_bf16 v177, v184, s95, v177
v_accvgpr_read_b32 v185, a125
v_dot2_f32_bf16 v178, v185, s94, v178
v_dot2_f32_bf16 v179, v185, s95, v179
v_accvgpr_read_b32 v186, a126
v_dot2_f32_bf16 v180, v186, s94, v180
v_dot2_f32_bf16 v181, v186, s95, v181
v_accvgpr_read_b32 v187, a127
v_dot2_f32_bf16 v182, v187, s94, v182
v_dot2_f32_bf16 v183, v187, s95, v183
v_mul_f32 v184, 0xc0d22e3c, v176
v_mul_f32 v185, 0xc0d22e3c, v177
v_mul_f32 v186, 0xc0d22e3c, v178
v_mul_f32 v187, 0xc0d22e3c, v179
v_mul_f32 v188, 0xc0d22e3c, v180
v_mul_f32 v189, 0xc0d22e3c, v181
v_mul_f32 v190, 0xc0d22e3c, v182
v_mul_f32 v191, 0xc0d22e3c, v183
v_exp_f32 v184, v184
v_exp_f32 v185, v185
v_exp_f32 v186, v186
v_exp_f32 v187, v187
v_exp_f32 v188, v188
v_exp_f32 v189, v189
v_exp_f32 v190, v190
v_exp_f32 v191, v191
v_mul_f32 v168, v168, v176
v_mul_f32 v169, v169, v177
v_mul_f32 v170, v170, v178
v_mul_f32 v171, v171, v179
v_mul_f32 v172, v172, v180
v_mul_f32 v173, v173, v181
v_mul_f32 v174, v174, v182
v_mul_f32 v175, v175, v183
v_add_f32 v184, 1.0, v184
v_add_f32 v185, 1.0, v185
v_add_f32 v186, 1.0, v186
v_add_f32 v187, 1.0, v187
v_add_f32 v188, 1.0, v188
v_add_f32 v189, 1.0, v189
v_add_f32 v190, 1.0, v190
v_add_f32 v191, 1.0, v191
v_rcp_f32 v184, v184
v_rcp_f32 v185, v185
v_rcp_f32 v186, v186
v_rcp_f32 v187, v187
v_rcp_f32 v188, v188
v_rcp_f32 v189, v189
v_rcp_f32 v190, v190
v_rcp_f32 v191, v191
v_mul_f32 v168, 0x4091afa4, v168
v_mul_f32 v169, 0x4091afa4, v169
v_mul_f32 v170, 0x4091afa4, v170
v_mul_f32 v171, 0x4091afa4, v171
v_mul_f32 v172, 0x4091afa4, v172
v_mul_f32 v173, 0x4091afa4, v173
v_mul_f32 v174, 0x4091afa4, v174
v_mul_f32 v175, 0x4091afa4, v175
v_mul_f32 v168, v168, v184
v_mul_f32 v169, v169, v185
v_mul_f32 v170, v170, v186
v_mul_f32 v171, v171, v187
v_mul_f32 v172, v172, v188
v_mul_f32 v173, v173, v189
v_mul_f32 v174, v174, v190
v_mul_f32 v175, v175, v191
v_permlane32_swap_b32 v168, v172
v_permlane32_swap_b32 v169, v173
v_permlane32_swap_b32 v170, v174
v_permlane32_swap_b32 v171, v175
v_permlane16_swap_b32 v168, v172
v_permlane16_swap_b32 v169, v173
v_permlane16_swap_b32 v170, v174
v_permlane16_swap_b32 v171, v175
v_accvgpr_read_b32 v176, a128
v_accvgpr_read_b32 v177, a129
v_accvgpr_read_b32 v178, a130
v_accvgpr_read_b32 v179, a131
v_lshlrev_b32 v184, 16, v176
v_and_b32 v185, s46, v176
v_lshlrev_b32 v186, 16, v177
v_and_b32 v187, s46, v177
v_lshlrev_b32 v188, 16, v178
v_and_b32 v189, s46, v178
v_lshlrev_b32 v190, 16, v179
v_and_b32 v191, s46, v179
v_add_f32 v184, v184, v168
v_add_f32 v185, v185, v169
v_add_f32 v186, v186, v170
v_add_f32 v187, v187, v171
v_add_f32 v188, v188, v172
v_add_f32 v189, v189, v173
v_add_f32 v190, v190, v174
v_add_f32 v191, v191, v175
v_cvt_pk_bf16_f32 v180, v184, v185
v_cvt_pk_bf16_f32 v181, v186, v187
v_cvt_pk_bf16_f32 v182, v188, v189
v_cvt_pk_bf16_f32 v183, v190, v191
buffer_store_dwordx4 v[180:183], v249, s[60:63], 0 offen offset:0
s_waitcnt vmcnt(18)
v_max3_u32 v184, v32, v33, v34
v_max3_u32 v184, v184, v35, v36
v_max3_u32 v184, v184, v37, v38
v_max3_u32 v184, v184, v39, v40
v_max3_u32 v184, v184, v41, v42
v_max3_u32 v184, v184, v43, v44
v_max3_u32 v184, v184, v45, v46
v_max3_u32 v184, v184, v47, v48
v_max3_u32 v184, v184, v49, v50
v_max3_u32 v184, v184, v51, v52
v_max3_u32 v184, v184, v53, v54
v_max3_u32 v184, v184, v55, v56
v_max3_u32 v184, v184, v57, v58
v_max3_u32 v184, v184, v59, v60
v_max3_u32 v184, v184, v61, v62
v_max3_u32 v184, v184, v63, v64
v_max3_u32 v184, v184, v65, v66
v_max3_u32 v184, v184, v67, v68
v_max3_u32 v184, v184, v69, v70
v_max3_u32 v184, v184, v71, v72
v_max3_u32 v184, v184, v73, v74
v_max3_u32 v184, v184, v75, v76
v_max3_u32 v184, v184, v77, v78
v_max3_u32 v184, v184, v79, v80
v_max3_u32 v184, v184, v81, v82
v_max3_u32 v184, v184, v83, v84
v_max3_u32 v184, v184, v85, v86
v_max3_u32 v184, v184, v87, v88
v_max3_u32 v184, v184, v89, v90
v_max3_u32 v184, v184, v91, v92
v_max3_u32 v184, v184, v93, v94
v_max_u32 v184, v184, v95
v_cmp_eq_u32 vcc, -1, v184
s_nop 4
s_cbranch_vccz L_ver_att_7_ok2
buffer_load_dwordx4 v[32:35], v248, s[28:31], s56 offen offset:0 sc1
buffer_load_dwordx4 v[36:39], v248, s[28:31], s57 offen offset:0 sc1
buffer_load_dwordx4 v[40:43], v248, s[28:31], s58 offen offset:0 sc1
buffer_load_dwordx4 v[44:47], v248, s[28:31], s59 offen offset:0 sc1
buffer_load_dwordx4 v[48:51], v248, s[28:31], s64 offen offset:0 sc1
buffer_load_dwordx4 v[52:55], v248, s[28:31], s65 offen offset:0 sc1
buffer_load_dwordx4 v[56:59], v248, s[28:31], s66 offen offset:0 sc1
buffer_load_dwordx4 v[60:63], v248, s[28:31], s67 offen offset:0 sc1
buffer_load_dwordx4 v[64:67], v248, s[28:31], s72 offen offset:0 sc1
buffer_load_dwordx4 v[68:71], v248, s[28:31], s73 offen offset:0 sc1
buffer_load_dwordx4 v[72:75], v248, s[28:31], s74 offen offset:0 sc1
buffer_load_dwordx4 v[76:79], v248, s[28:31], s75 offen offset:0 sc1
buffer_load_dwordx4 v[80:83], v248, s[28:31], s88 offen offset:0 sc1
buffer_load_dwordx4 v[84:87], v248, s[28:31], s89 offen offset:0 sc1
buffer_load_dwordx4 v[88:91], v248, s[28:31], s90 offen offset:0 sc1
buffer_load_dwordx4 v[92:95], v248, s[28:31], s91 offen offset:0 sc1
s_mov_b32 s85, 0x1388
L_ver_att_7:
s_waitcnt vmcnt(0)
v_max3_u32 v184, v32, v33, v34
v_max3_u32 v184, v184, v35, v36
v_max3_u32 v184, v184, v37, v38
v_max3_u32 v184, v184, v39, v40
v_max3_u32 v184, v184, v41, v42
v_max3_u32 v184, v184, v43, v44
v_max3_u32 v184, v184, v45, v46
v_max3_u32 v184, v184, v47, v48
v_max3_u32 v184, v184, v49, v50
v_max3_u32 v184, v184, v51, v52
v_max3_u32 v184, v184, v53, v54
v_max3_u32 v184, v184, v55, v56
v_max3_u32 v184, v184, v57, v58
v_max3_u32 v184, v184, v59, v60
v_max3_u32 v184, v184, v61, v62
v_max3_u32 v184, v184, v63, v64
v_max3_u32 v184, v184, v65, v66
v_max3_u32 v184, v184, v67, v68
v_max3_u32 v184, v184, v69, v70
v_max3_u32 v184, v184, v71, v72
v_max3_u32 v184, v184, v73, v74
v_max3_u32 v184, v184, v75, v76
v_max3_u32 v184, v184, v77, v78
v_max3_u32 v184, v184, v79, v80
v_max3_u32 v184, v184, v81, v82
v_max3_u32 v184, v184, v83, v84
v_max3_u32 v184, v184, v85, v86
v_max3_u32 v184, v184, v87, v88
v_max3_u32 v184, v184, v89, v90
v_max3_u32 v184, v184, v91, v92
v_max3_u32 v184, v184, v93, v94
v_max_u32 v184, v184, v95
v_cmp_eq_u32 vcc, -1, v184
s_nop 4
s_cbranch_vccz L_ver_att_7_ok
s_sub_u32 s85, s85, 1
s_cmp_eq_u32 s85, 0
s_cbranch_scc1 L_ver_att_7_ok
s_sleep 2
buffer_load_dwordx4 v[32:35], v248, s[28:31], s56 offen offset:0 sc1
buffer_load_dwordx4 v[36:39], v248, s[28:31], s57 offen offset:0 sc1
buffer_load_dwordx4 v[40:43], v248, s[28:31], s58 offen offset:0 sc1
buffer_load_dwordx4 v[44:47], v248, s[28:31], s59 offen offset:0 sc1
buffer_load_dwordx4 v[48:51], v248, s[28:31], s64 offen offset:0 sc1
buffer_load_dwordx4 v[52:55], v248, s[28:31], s65 offen offset:0 sc1
buffer_load_dwordx4 v[56:59], v248, s[28:31], s66 offen offset:0 sc1
buffer_load_dwordx4 v[60:63], v248, s[28:31], s67 offen offset:0 sc1
buffer_load_dwordx4 v[64:67], v248, s[28:31], s72 offen offset:0 sc1
buffer_load_dwordx4 v[68:71], v248, s[28:31], s73 offen offset:0 sc1
buffer_load_dwordx4 v[72:75], v248, s[28:31], s74 offen offset:0 sc1
buffer_load_dwordx4 v[76:79], v248, s[28:31], s75 offen offset:0 sc1
buffer_load_dwordx4 v[80:83], v248, s[28:31], s88 offen offset:0 sc1
buffer_load_dwordx4 v[84:87], v248, s[28:31], s89 offen offset:0 sc1
buffer_load_dwordx4 v[88:91], v248, s[28:31], s90 offen offset:0 sc1
buffer_load_dwordx4 v[92:95], v248, s[28:31], s91 offen offset:0 sc1
s_branch L_ver_att_7
L_ver_att_7_ok:
L_ver_att_7_ok2:
s_waitcnt vmcnt(1)
v_max3_u32 v184, v100, v101, v102
v_max3_u32 v184, v184, v103, v104
v_max3_u32 v184, v184, v105, v106
v_max3_u32 v184, v184, v107, v108
v_max3_u32 v184, v184, v109, v110
v_max3_u32 v184, v184, v111, v112
v_max3_u32 v184, v184, v113, v114
v_max3_u32 v184, v184, v115, v116
v_max3_u32 v184, v184, v117, v118
v_max3_u32 v184, v184, v119, v120
v_max3_u32 v184, v184, v121, v122
v_max3_u32 v184, v184, v123, v124
v_max3_u32 v184, v184, v125, v126
v_max3_u32 v184, v184, v127, v128
v_max3_u32 v184, v184, v129, v130
v_max3_u32 v184, v184, v131, v132
v_max3_u32 v184, v184, v133, v134
v_max3_u32 v184, v184, v135, v136
v_max3_u32 v184, v184, v137, v138
v_max3_u32 v184, v184, v139, v140
v_max3_u32 v184, v184, v141, v142
v_max3_u32 v184, v184, v143, v144
v_max3_u32 v184, v184, v145, v146
v_max3_u32 v184, v184, v147, v148
v_max3_u32 v184, v184, v149, v150
v_max3_u32 v184, v184, v151, v152
v_max3_u32 v184, v184, v153, v154
v_max3_u32 v184, v184, v155, v156
v_max3_u32 v184, v184, v157, v158
v_max3_u32 v184, v184, v159, v160
v_max3_u32 v184, v184, v161, v162
v_max_u32 v184, v184, v163
v_cmp_eq_u32 vcc, -1, v184
s_nop 4
s_cbranch_vccz L_ver_att_8_first
buffer_load_dwordx4 v[100:103], v254, s[28:31], s56 offen offset:0 sc1
buffer_load_dwordx4 v[104:107], v254, s[28:31], s57 offen offset:0 sc1
buffer_load_dwordx4 v[108:111], v254, s[28:31], s58 offen offset:0 sc1
buffer_load_dwordx4 v[112:115], v254, s[28:31], s59 offen offset:0 sc1
buffer_load_dwordx4 v[116:119], v254, s[28:31], s64 offen offset:0 sc1
buffer_load_dwordx4 v[120:123], v254, s[28:31], s65 offen offset:0 sc1
buffer_load_dwordx4 v[124:127], v254, s[28:31], s66 offen offset:0 sc1
buffer_load_dwordx4 v[128:131], v254, s[28:31], s67 offen offset:0 sc1
buffer_load_dwordx4 v[132:135], v254, s[28:31], s72 offen offset:0 sc1
buffer_load_dwordx4 v[136:139], v254, s[28:31], s73 offen offset:0 sc1
buffer_load_dwordx4 v[140:143], v254, s[28:31], s74 offen offset:0 sc1
buffer_load_dwordx4 v[144:147], v254, s[28:31], s75 offen offset:0 sc1
buffer_load_dwordx4 v[148:151], v254, s[28:31], s88 offen offset:0 sc1
buffer_load_dwordx4 v[152:155], v254, s[28:31], s89 offen offset:0 sc1
buffer_load_dwordx4 v[156:159], v254, s[28:31], s90 offen offset:0 sc1
buffer_load_dwordx4 v[160:163], v254, s[28:31], s91 offen offset:0 sc1
L_ver_att_8_first:
v_dot2_f32_bf16 v168, v32, s94, 0
v_dot2_f32_bf16 v169, v32, s95, 0
v_dot2_f32_bf16 v170, v33, s94, 0
v_dot2_f32_bf16 v171, v33, s95, 0
v_dot2_f32_bf16 v172, v34, s94, 0
v_dot2_f32_bf16 v173, v34, s95, 0
v_dot2_f32_bf16 v174, v35, s94, 0
v_dot2_f32_bf16 v175, v35, s95, 0
v_dot2_f32_bf16 v168, v36, s94, v168
v_dot2_f32_bf16 v169, v36, s95, v169
v_dot2_f32_bf16 v170, v37, s94, v170
v_dot2_f32_bf16 v171, v37, s95, v171
v_dot2_f32_bf16 v172, v38, s94, v172
v_dot2_f32_bf16 v173, v38, s95, v173
v_dot2_f32_bf16 v174, v39, s94, v174
v_dot2_f32_bf16 v175, v39, s95, v175
v_dot2_f32_bf16 v168, v40, s94, v168
v_dot2_f32_bf16 v169, v40, s95, v169
v_dot2_f32_bf16 v170, v41, s94, v170
v_dot2_f32_bf16 v171, v41, s95, v171
v_dot2_f32_bf16 v172, v42, s94, v172
v_dot2_f32_bf16 v173, v42, s95, v173
v_dot2_f32_bf16 v174, v43, s94, v174
v_dot2_f32_bf16 v175, v43, s95, v175
v_dot2_f32_bf16 v168, v44, s94, v168
v_dot2_f32_bf16 v169, v44, s95, v169
v_dot2_f32_bf16 v170, v45, s94, v170
v_dot2_f32_bf16 v171, v45, s95, v171
v_dot2_f32_bf16 v172, v46, s94, v172
v_dot2_f32_bf16 v173, v46, s95, v173
v_dot2_f32_bf16 v174, v47, s94, v174
v_dot2_f32_bf16 v175, v47, s95, v175
v_dot2_f32_bf16 v168, v48, s94, v168
v_dot2_f32_bf16 v169, v48, s95, v169
v_dot2_f32_bf16 v170, v49, s94, v170
v_dot2_f32_bf16 v171, v49, s95, v171
v_dot2_f32_bf16 v172, v50, s94, v172
v_dot2_f32_bf16 v173, v50, s95, v173
v_dot2_f32_bf16 v174, v51, s94, v174
v_dot2_f32_bf16 v175, v51, s95, v175
v_dot2_f32_bf16 v168, v52, s94, v168
v_dot2_f32_bf16 v169, v52, s95, v169
v_dot2_f32_bf16 v170, v53, s94, v170
v_dot2_f32_bf16 v171, v53, s95, v171
v_dot2_f32_bf16 v172, v54, s94, v172
v_dot2_f32_bf16 v173, v54, s95, v173
v_dot2_f32_bf16 v174, v55, s94, v174
v_dot2_f32_bf16 v175, v55, s95, v175
v_dot2_f32_bf16 v168, v56, s94, v168
v_dot2_f32_bf16 v169, v56, s95, v169
v_dot2_f32_bf16 v170, v57, s94, v170
v_dot2_f32_bf16 v171, v57, s95, v171
v_dot2_f32_bf16 v172, v58, s94, v172
v_dot2_f32_bf16 v173, v58, s95, v173
v_dot2_f32_bf16 v174, v59, s94, v174
v_dot2_f32_bf16 v175, v59, s95, v175
v_dot2_f32_bf16 v168, v60, s94, v168
v_dot2_f32_bf16 v169, v60, s95, v169
v_dot2_f32_bf16 v170, v61, s94, v170
v_dot2_f32_bf16 v171, v61, s95, v171
v_dot2_f32_bf16 v172, v62, s94, v172
v_dot2_f32_bf16 v173, v62, s95, v173
v_dot2_f32_bf16 v174, v63, s94, v174
v_dot2_f32_bf16 v175, v63, s95, v175
v_dot2_f32_bf16 v176, v64, s94, 0
v_dot2_f32_bf16 v177, v64, s95, 0
v_dot2_f32_bf16 v178, v65, s94, 0
v_dot2_f32_bf16 v179, v65, s95, 0
v_dot2_f32_bf16 v180, v66, s94, 0
v_dot2_f32_bf16 v181, v66, s95, 0
v_dot2_f32_bf16 v182, v67, s94, 0
v_dot2_f32_bf16 v183, v67, s95, 0
v_dot2_f32_bf16 v176, v68, s94, v176
v_dot2_f32_bf16 v177, v68, s95, v177
v_dot2_f32_bf16 v178, v69, s94, v178
v_dot2_f32_bf16 v179, v69, s95, v179
v_dot2_f32_bf16 v180, v70, s94, v180
v_dot2_f32_bf16 v181, v70, s95, v181
v_dot2_f32_bf16 v182, v71, s94, v182
v_dot2_f32_bf16 v183, v71, s95, v183
v_dot2_f32_bf16 v176, v72, s94, v176
v_dot2_f32_bf16 v177, v72, s95, v177
v_dot2_f32_bf16 v178, v73, s94, v178
v_dot2_f32_bf16 v179, v73, s95, v179
v_dot2_f32_bf16 v180, v74, s94, v180
v_dot2_f32_bf16 v181, v74, s95, v181
v_dot2_f32_bf16 v182, v75, s94, v182
v_dot2_f32_bf16 v183, v75, s95, v183
v_dot2_f32_bf16 v176, v76, s94, v176
v_dot2_f32_bf16 v177, v76, s95, v177
v_dot2_f32_bf16 v178, v77, s94, v178
v_dot2_f32_bf16 v179, v77, s95, v179
v_dot2_f32_bf16 v180, v78, s94, v180
v_dot2_f32_bf16 v181, v78, s95, v181
v_dot2_f32_bf16 v182, v79, s94, v182
v_dot2_f32_bf16 v183, v79, s95, v183
v_dot2_f32_bf16 v176, v80, s94, v176
v_dot2_f32_bf16 v177, v80, s95, v177
v_dot2_f32_bf16 v178, v81, s94, v178
v_dot2_f32_bf16 v179, v81, s95, v179
v_dot2_f32_bf16 v180, v82, s94, v180
v_dot2_f32_bf16 v181, v82, s95, v181
v_dot2_f32_bf16 v182, v83, s94, v182
v_dot2_f32_bf16 v183, v83, s95, v183
v_dot2_f32_bf16 v176, v84, s94, v176
v_dot2_f32_bf16 v177, v84, s95, v177
v_dot2_f32_bf16 v178, v85, s94, v178
v_dot2_f32_bf16 v179, v85, s95, v179
v_dot2_f32_bf16 v180, v86, s94, v180
v_dot2_f32_bf16 v181, v86, s95, v181
v_dot2_f32_bf16 v182, v87, s94, v182
v_dot2_f32_bf16 v183, v87, s95, v183
v_dot2_f32_bf16 v176, v88, s94, v176
v_dot2_f32_bf16 v177, v88, s95, v177
v_dot2_f32_bf16 v178, v89, s94, v178
v_dot2_f32_bf16 v179, v89, s95, v179
v_dot2_f32_bf16 v180, v90, s94, v180
v_dot2_f32_bf16 v181, v90, s95, v181
v_dot2_f32_bf16 v182, v91, s94, v182
v_dot2_f32_bf16 v183, v91, s95, v183
v_dot2_f32_bf16 v176, v92, s94, v176
v_dot2_f32_bf16 v177, v92, s95, v177
v_dot2_f32_bf16 v178, v93, s94, v178
v_dot2_f32_bf16 v179, v93, s95, v179
v_dot2_f32_bf16 v180, v94, s94, v180
v_dot2_f32_bf16 v181, v94, s95, v181
v_dot2_f32_bf16 v182, v95, s94, v182
v_dot2_f32_bf16 v183, v95, s95, v183
v_mul_f32 v184, 0xc0d22e3c, v176
v_mul_f32 v185, 0xc0d22e3c, v177
v_mul_f32 v186, 0xc0d22e3c, v178
v_mul_f32 v187, 0xc0d22e3c, v179
v_mul_f32 v188, 0xc0d22e3c, v180
v_mul_f32 v189, 0xc0d22e3c, v181
v_mul_f32 v190, 0xc0d22e3c, v182
v_mul_f32 v191, 0xc0d22e3c, v183
v_exp_f32 v184, v184
v_exp_f32 v185, v185
v_exp_f32 v186, v186
v_exp_f32 v187, v187
v_exp_f32 v188, v188
v_exp_f32 v189, v189
v_exp_f32 v190, v190
v_exp_f32 v191, v191
v_mul_f32 v168, v168, v176
v_mul_f32 v169, v169, v177
v_mul_f32 v170, v170, v178
v_mul_f32 v171, v171, v179
v_mul_f32 v172, v172, v180
v_mul_f32 v173, v173, v181
v_mul_f32 v174, v174, v182
v_mul_f32 v175, v175, v183
v_add_f32 v184, 1.0, v184
v_add_f32 v185, 1.0, v185
v_add_f32 v186, 1.0, v186
v_add_f32 v187, 1.0, v187
v_add_f32 v188, 1.0, v188
v_add_f32 v189, 1.0, v189
v_add_f32 v190, 1.0, v190
v_add_f32 v191, 1.0, v191
v_rcp_f32 v184, v184
v_rcp_f32 v185, v185
v_rcp_f32 v186, v186
v_rcp_f32 v187, v187
v_rcp_f32 v188, v188
v_rcp_f32 v189, v189
v_rcp_f32 v190, v190
v_rcp_f32 v191, v191
v_mul_f32 v168, 0x4091afa4, v168
v_mul_f32 v169, 0x4091afa4, v169
v_mul_f32 v170, 0x4091afa4, v170
v_mul_f32 v171, 0x4091afa4, v171
v_mul_f32 v172, 0x4091afa4, v172
v_mul_f32 v173, 0x4091afa4, v173
v_mul_f32 v174, 0x4091afa4, v174
v_mul_f32 v175, 0x4091afa4, v175
v_mul_f32 v168, v168, v184
v_mul_f32 v169, v169, v185
v_mul_f32 v170, v170, v186
v_mul_f32 v171, v171, v187
v_mul_f32 v172, v172, v188
v_mul_f32 v173, v173, v189
v_mul_f32 v174, v174, v190
v_mul_f32 v175, v175, v191
v_permlane32_swap_b32 v168, v172
v_permlane32_swap_b32 v169, v173
v_permlane32_swap_b32 v170, v174
v_permlane32_swap_b32 v171, v175
v_permlane16_swap_b32 v168, v172
v_permlane16_swap_b32 v169, v173
v_permlane16_swap_b32 v170, v174
v_permlane16_swap_b32 v171, v175
v_lshlrev_b32 v184, 16, v96
v_and_b32 v185, s46, v96
v_lshlrev_b32 v186, 16, v97
v_and_b32 v187, s46, v97
v_lshlrev_b32 v188, 16, v98
v_and_b32 v189, s46, v98
v_lshlrev_b32 v190, 16, v99
v_and_b32 v191, s46, v99
v_add_f32 v184, v184, v168
v_add_f32 v185, v185, v169
v_add_f32 v186, v186, v170
v_add_f32 v187, v187, v171
v_add_f32 v188, v188, v172
v_add_f32 v189, v189, v173
v_add_f32 v190, v190, v174
v_add_f32 v191, v191, v175
v_cvt_pk_bf16_f32 v180, v184, v185
v_cvt_pk_bf16_f32 v181, v186, v187
v_cvt_pk_bf16_f32 v182, v188, v189
v_cvt_pk_bf16_f32 v183, v190, v191
buffer_store_dwordx4 v[180:183], v249, s[60:63], 0 offen offset:512
s_mov_b32 s85, 0x1388
L_ver_att_8:
s_waitcnt vmcnt(0)
v_max3_u32 v184, v100, v101, v102
v_max3_u32 v184, v184, v103, v104
v_max3_u32 v184, v184, v105, v106
v_max3_u32 v184, v184, v107, v108
v_max3_u32 v184, v184, v109, v110
v_max3_u32 v184, v184, v111, v112
v_max3_u32 v184, v184, v113, v114
v_max3_u32 v184, v184, v115, v116
v_max3_u32 v184, v184, v117, v118
v_max3_u32 v184, v184, v119, v120
v_max3_u32 v184, v184, v121, v122
v_max3_u32 v184, v184, v123, v124
v_max3_u32 v184, v184, v125, v126
v_max3_u32 v184, v184, v127, v128
v_max3_u32 v184, v184, v129, v130
v_max3_u32 v184, v184, v131, v132
v_max3_u32 v184, v184, v133, v134
v_max3_u32 v184, v184, v135, v136
v_max3_u32 v184, v184, v137, v138
v_max3_u32 v184, v184, v139, v140
v_max3_u32 v184, v184, v141, v142
v_max3_u32 v184, v184, v143, v144
v_max3_u32 v184, v184, v145, v146
v_max3_u32 v184, v184, v147, v148
v_max3_u32 v184, v184, v149, v150
v_max3_u32 v184, v184, v151, v152
v_max3_u32 v184, v184, v153, v154
v_max3_u32 v184, v184, v155, v156
v_max3_u32 v184, v184, v157, v158
v_max3_u32 v184, v184, v159, v160
v_max3_u32 v184, v184, v161, v162
v_max_u32 v184, v184, v163
v_cmp_eq_u32 vcc, -1, v184
s_nop 4
s_cbranch_vccz L_ver_att_8_ok
s_sub_u32 s85, s85, 1
s_cmp_eq_u32 s85, 0
s_cbranch_scc1 L_ver_att_8_ok
s_sleep 2
buffer_load_dwordx4 v[100:103], v254, s[28:31], s56 offen offset:0 sc1
buffer_load_dwordx4 v[104:107], v254, s[28:31], s57 offen offset:0 sc1
buffer_load_dwordx4 v[108:111], v254, s[28:31], s58 offen offset:0 sc1
buffer_load_dwordx4 v[112:115], v254, s[28:31], s59 offen offset:0 sc1
buffer_load_dwordx4 v[116:119], v254, s[28:31], s64 offen offset:0 sc1
buffer_load_dwordx4 v[120:123], v254, s[28:31], s65 offen offset:0 sc1
buffer_load_dwordx4 v[124:127], v254, s[28:31], s66 offen offset:0 sc1
buffer_load_dwordx4 v[128:131], v254, s[28:31], s67 offen offset:0 sc1
buffer_load_dwordx4 v[132:135], v254, s[28:31], s72 offen offset:0 sc1
buffer_load_dwordx4 v[136:139], v254, s[28:31], s73 offen offset:0 sc1
buffer_load_dwordx4 v[140:143], v254, s[28:31], s74 offen offset:0 sc1
buffer_load_dwordx4 v[144:147], v254, s[28:31], s75 offen offset:0 sc1
buffer_load_dwordx4 v[148:151], v254, s[28:31], s88 offen offset:0 sc1
buffer_load_dwordx4 v[152:155], v254, s[28:31], s89 offen offset:0 sc1
buffer_load_dwordx4 v[156:159], v254, s[28:31], s90 offen offset:0 sc1
buffer_load_dwordx4 v[160:163], v254, s[28:31], s91 offen offset:0 sc1
s_branch L_ver_att_8
L_ver_att_8_ok:
s_waitcnt vmcnt(0)
v_dot2_f32_bf16 v168, v100, s94, 0
v_dot2_f32_bf16 v169, v100, s95, 0
v_dot2_f32_bf16 v170, v101, s94, 0
v_dot2_f32_bf16 v171, v101, s95, 0
v_dot2_f32_bf16 v172, v102, s94, 0
v_dot2_f32_bf16 v173, v102, s95, 0
v_dot2_f32_bf16 v174, v103, s94, 0
v_dot2_f32_bf16 v175, v103, s95, 0
v_dot2_f32_bf16 v168, v104, s94, v168
v_dot2_f32_bf16 v169, v104, s95, v169
v_dot2_f32_bf16 v170, v105, s94, v170
v_dot2_f32_bf16 v171, v105, s95, v171
v_dot2_f32_bf16 v172, v106, s94, v172
v_dot2_f32_bf16 v173, v106, s95, v173
v_dot2_f32_bf16 v174, v107, s94, v174
v_dot2_f32_bf16 v175, v107, s95, v175
v_dot2_f32_bf16 v168, v108, s94, v168
v_dot2_f32_bf16 v169, v108, s95, v169
v_dot2_f32_bf16 v170, v109, s94, v170
v_dot2_f32_bf16 v171, v109, s95, v171
v_dot2_f32_bf16 v172, v110, s94, v172
v_dot2_f32_bf16 v173, v110, s95, v173
v_dot2_f32_bf16 v174, v111, s94, v174
v_dot2_f32_bf16 v175, v111, s95, v175
v_dot2_f32_bf16 v168, v112, s94, v168
v_dot2_f32_bf16 v169, v112, s95, v169
v_dot2_f32_bf16 v170, v113, s94, v170
v_dot2_f32_bf16 v171, v113, s95, v171
v_dot2_f32_bf16 v172, v114, s94, v172
v_dot2_f32_bf16 v173, v114, s95, v173
v_dot2_f32_bf16 v174, v115, s94, v174
v_dot2_f32_bf16 v175, v115, s95, v175
v_dot2_f32_bf16 v168, v116, s94, v168
v_dot2_f32_bf16 v169, v116, s95, v169
v_dot2_f32_bf16 v170, v117, s94, v170
v_dot2_f32_bf16 v171, v117, s95, v171
v_dot2_f32_bf16 v172, v118, s94, v172
v_dot2_f32_bf16 v173, v118, s95, v173
v_dot2_f32_bf16 v174, v119, s94, v174
v_dot2_f32_bf16 v175, v119, s95, v175
v_dot2_f32_bf16 v168, v120, s94, v168
v_dot2_f32_bf16 v169, v120, s95, v169
v_dot2_f32_bf16 v170, v121, s94, v170
v_dot2_f32_bf16 v171, v121, s95, v171
v_dot2_f32_bf16 v172, v122, s94, v172
v_dot2_f32_bf16 v173, v122, s95, v173
v_dot2_f32_bf16 v174, v123, s94, v174
v_dot2_f32_bf16 v175, v123, s95, v175
v_dot2_f32_bf16 v168, v124, s94, v168
v_dot2_f32_bf16 v169, v124, s95, v169
v_dot2_f32_bf16 v170, v125, s94, v170
v_dot2_f32_bf16 v171, v125, s95, v171
v_dot2_f32_bf16 v172, v126, s94, v172
v_dot2_f32_bf16 v173, v126, s95, v173
v_dot2_f32_bf16 v174, v127, s94, v174
v_dot2_f32_bf16 v175, v127, s95, v175
v_dot2_f32_bf16 v168, v128, s94, v168
v_dot2_f32_bf16 v169, v128, s95, v169
v_dot2_f32_bf16 v170, v129, s94, v170
v_dot2_f32_bf16 v171, v129, s95, v171
v_dot2_f32_bf16 v172, v130, s94, v172
v_dot2_f32_bf16 v173, v130, s95, v173
v_dot2_f32_bf16 v174, v131, s94, v174
v_dot2_f32_bf16 v175, v131, s95, v175
v_dot2_f32_bf16 v176, v132, s94, 0
v_dot2_f32_bf16 v177, v132, s95, 0
v_dot2_f32_bf16 v178, v133, s94, 0
v_dot2_f32_bf16 v179, v133, s95, 0
v_dot2_f32_bf16 v180, v134, s94, 0
v_dot2_f32_bf16 v181, v134, s95, 0
v_dot2_f32_bf16 v182, v135, s94, 0
v_dot2_f32_bf16 v183, v135, s95, 0
v_dot2_f32_bf16 v176, v136, s94, v176
v_dot2_f32_bf16 v177, v136, s95, v177
v_dot2_f32_bf16 v178, v137, s94, v178
v_dot2_f32_bf16 v179, v137, s95, v179
v_dot2_f32_bf16 v180, v138, s94, v180
v_dot2_f32_bf16 v181, v138, s95, v181
v_dot2_f32_bf16 v182, v139, s94, v182
v_dot2_f32_bf16 v183, v139, s95, v183
v_dot2_f32_bf16 v176, v140, s94, v176
v_dot2_f32_bf16 v177, v140, s95, v177
v_dot2_f32_bf16 v178, v141, s94, v178
v_dot2_f32_bf16 v179, v141, s95, v179
v_dot2_f32_bf16 v180, v142, s94, v180
v_dot2_f32_bf16 v181, v142, s95, v181
v_dot2_f32_bf16 v182, v143, s94, v182
v_dot2_f32_bf16 v183, v143, s95, v183
v_dot2_f32_bf16 v176, v144, s94, v176
v_dot2_f32_bf16 v177, v144, s95, v177
v_dot2_f32_bf16 v178, v145, s94, v178
v_dot2_f32_bf16 v179, v145, s95, v179
v_dot2_f32_bf16 v180, v146, s94, v180
v_dot2_f32_bf16 v181, v146, s95, v181
v_dot2_f32_bf16 v182, v147, s94, v182
v_dot2_f32_bf16 v183, v147, s95, v183
v_dot2_f32_bf16 v176, v148, s94, v176
v_dot2_f32_bf16 v177, v148, s95, v177
v_dot2_f32_bf16 v178, v149, s94, v178
v_dot2_f32_bf16 v179, v149, s95, v179
v_dot2_f32_bf16 v180, v150, s94, v180
v_dot2_f32_bf16 v181, v150, s95, v181
v_dot2_f32_bf16 v182, v151, s94, v182
v_dot2_f32_bf16 v183, v151, s95, v183
v_dot2_f32_bf16 v176, v152, s94, v176
v_dot2_f32_bf16 v177, v152, s95, v177
v_dot2_f32_bf16 v178, v153, s94, v178
v_dot2_f32_bf16 v179, v153, s95, v179
v_dot2_f32_bf16 v180, v154, s94, v180
v_dot2_f32_bf16 v181, v154, s95, v181
v_dot2_f32_bf16 v182, v155, s94, v182
v_dot2_f32_bf16 v183, v155, s95, v183
v_dot2_f32_bf16 v176, v156, s94, v176
v_dot2_f32_bf16 v177, v156, s95, v177
v_dot2_f32_bf16 v178, v157, s94, v178
v_dot2_f32_bf16 v179, v157, s95, v179
v_dot2_f32_bf16 v180, v158, s94, v180
v_dot2_f32_bf16 v181, v158, s95, v181
v_dot2_f32_bf16 v182, v159, s94, v182
v_dot2_f32_bf16 v183, v159, s95, v183
v_dot2_f32_bf16 v176, v160, s94, v176
v_dot2_f32_bf16 v177, v160, s95, v177
v_dot2_f32_bf16 v178, v161, s94, v178
v_dot2_f32_bf16 v179, v161, s95, v179
v_dot2_f32_bf16 v180, v162, s94, v180
v_dot2_f32_bf16 v181, v162, s95, v181
v_dot2_f32_bf16 v182, v163, s94, v182
v_dot2_f32_bf16 v183, v163, s95, v183
v_mul_f32 v184, 0xc0d22e3c, v176
v_mul_f32 v185, 0xc0d22e3c, v177
v_mul_f32 v186, 0xc0d22e3c, v178
v_mul_f32 v187, 0xc0d22e3c, v179
v_mul_f32 v188, 0xc0d22e3c, v180
v_mul_f32 v189, 0xc0d22e3c, v181
v_mul_f32 v190, 0xc0d22e3c, v182
v_mul_f32 v191, 0xc0d22e3c, v183
v_exp_f32 v184, v184
v_exp_f32 v185, v185
v_exp_f32 v186, v186
v_exp_f32 v187, v187
v_exp_f32 v188, v188
v_exp_f32 v189, v189
v_exp_f32 v190, v190
v_exp_f32 v191, v191
v_mul_f32 v168, v168, v176
v_mul_f32 v169, v169, v177
v_mul_f32 v170, v170, v178
v_mul_f32 v171, v171, v179
v_mul_f32 v172, v172, v180
v_mul_f32 v173, v173, v181
v_mul_f32 v174, v174, v182
v_mul_f32 v175, v175, v183
v_add_f32 v184, 1.0, v184
v_add_f32 v185, 1.0, v185
v_add_f32 v186, 1.0, v186
v_add_f32 v187, 1.0, v187
v_add_f32 v188, 1.0, v188
v_add_f32 v189, 1.0, v189
v_add_f32 v190, 1.0, v190
v_add_f32 v191, 1.0, v191
v_rcp_f32 v184, v184
v_rcp_f32 v185, v185
v_rcp_f32 v186, v186
v_rcp_f32 v187, v187
v_rcp_f32 v188, v188
v_rcp_f32 v189, v189
v_rcp_f32 v190, v190
v_rcp_f32 v191, v191
v_mul_f32 v168, 0x4091afa4, v168
v_mul_f32 v169, 0x4091afa4, v169
v_mul_f32 v170, 0x4091afa4, v170
v_mul_f32 v171, 0x4091afa4, v171
v_mul_f32 v172, 0x4091afa4, v172
v_mul_f32 v173, 0x4091afa4, v173
v_mul_f32 v174, 0x4091afa4, v174
v_mul_f32 v175, 0x4091afa4, v175
v_mul_f32 v168, v168, v184
v_mul_f32 v169, v169, v185
v_mul_f32 v170, v170, v186
v_mul_f32 v171, v171, v187
v_mul_f32 v172, v172, v188
v_mul_f32 v173, v173, v189
v_mul_f32 v174, v174, v190
v_mul_f32 v175, v175, v191
v_permlane32_swap_b32 v168, v172
v_permlane32_swap_b32 v169, v173
v_permlane32_swap_b32 v170, v174
v_permlane32_swap_b32 v171, v175
v_permlane16_swap_b32 v168, v172
v_permlane16_swap_b32 v169, v173
v_permlane16_swap_b32 v170, v174
v_permlane16_swap_b32 v171, v175
v_lshlrev_b32 v184, 16, v164
v_and_b32 v185, s46, v164
v_lshlrev_b32 v186, 16, v165
v_and_b32 v187, s46, v165
v_lshlrev_b32 v188, 16, v166
v_and_b32 v189, s46, v166
v_lshlrev_b32 v190, 16, v167
v_and_b32 v191, s46, v167
v_add_f32 v184, v184, v168
v_add_f32 v185, v185, v169
v_add_f32 v186, v186, v170
v_add_f32 v187, v187, v171
v_add_f32 v188, v188, v172
v_add_f32 v189, v189, v173
v_add_f32 v190, v190, v174
v_add_f32 v191, v191, v175
v_cvt_pk_bf16_f32 v180, v184, v185
v_cvt_pk_bf16_f32 v181, v186, v187
v_cvt_pk_bf16_f32 v182, v188, v189
v_cvt_pk_bf16_f32 v183, v190, v191
buffer_store_dwordx4 v[180:183], v249, s[60:63], 0 offen offset:640
s_branch L_fin_att
L_slow0:
s_waitcnt vmcnt(0) lgkmcnt(0)
v_and_b32 v255, 15, v1
v_lshrrev_b32 v254, 4, v1
v_lshlrev_b32 v253, 4, v254
v_lshl_or_b32 v253, v255, 8, v253
v_lshlrev_b32 v254, 10, v254
v_lshl_or_b32 v254, v255, 1, v254
v_mov_b32 v252, 0xff800000
s_mov_b32 s79, s84
s_mov_b32 s83, 32
L_sm_0_0:
buffer_load_dwordx4 v[224:227], v253, s[20:23], s79 offen offset:0
buffer_load_dwordx4 v[228:231], v253, s[20:23], s79 offen offset:64
buffer_load_dwordx4 v[232:235], v253, s[20:23], s79 offen offset:128
buffer_load_dwordx4 v[236:239], v253, s[20:23], s79 offen offset:192
s_waitcnt vmcnt(0)
Zvva 240,224,160
Mvva 240,228,164
Mvva 240,232,168
Mvva 240,236,172
s_nop 15
v_max3_f32 v252, v252, v240, v241
v_max3_f32 v252, v252, v242, v243
s_add_u32 s79, s79, 0x1000
s_sub_u32 s83, s83, 1
s_cmp_lg_u32 s83, 0
s_cbranch_scc1 L_sm_0_0
v_mov_b32 v255, v252
s_nop 1
v_permlane32_swap_b32 v252, v255
s_nop 1
v_max_f32 v252, v252, v255
v_mov_b32 v255, v252
s_nop 1
v_permlane16_swap_b32 v252, v255
s_nop 1
v_max_f32 v252, v252, v255
v_mov_b32 v32, 0
v_mov_b32 v33, 0
v_mov_b32 v34, 0
v_mov_b32 v35, 0
v_mov_b32 v36, 0
v_mov_b32 v37, 0
v_mov_b32 v38, 0
v_mov_b32 v39, 0
v_mov_b32 v40, 0
v_mov_b32 v41, 0
v_mov_b32 v42, 0
v_mov_b32 v43, 0
v_mov_b32 v44, 0
v_mov_b32 v45, 0
v_mov_b32 v46, 0
v_mov_b32 v47, 0
v_mov_b32 v48, 0
v_mov_b32 v49, 0
v_mov_b32 v50, 0
v_mov_b32 v51, 0
v_mov_b32 v52, 0
v_mov_b32 v53, 0
v_mov_b32 v54, 0
v_mov_b32 v55, 0
v_mov_b32 v56, 0
v_mov_b32 v57, 0
v_mov_b32 v58, 0
v_mov_b32 v59, 0
v_mov_b32 v60, 0
v_mov_b32 v61, 0
v_mov_b32 v62, 0
v_mov_b32 v63, 0
v_accvgpr_write_b32 a128, 0
v_accvgpr_write_b32 a129, 0
v_accvgpr_write_b32 a130, 0
v_accvgpr_write_b32 a131, 0
s_mov_b32 s79, s84
s_mov_b32 s83, 16
L_sp_0_0:
s_add_u32 s80, s79, 0x1000
buffer_load_dwordx4 v[224:227], v253, s[20:23], s79 offen offset:0
buffer_load_dwordx4 v[228:231], v253, s[20:23], s79 offen offset:64
buffer_load_dwordx4 v[232:235], v253, s[20:23], s79 offen offset:128
buffer_load_dwordx4 v[236:239], v253, s[20:23], s79 offen offset:192
s_waitcnt vmcnt(0)
Zvva 240,224,160
Mvva 240,228,164
Mvva 240,232,168
Mvva 240,236,172
s_nop 15
buffer_load_dwordx4 v[224:227], v253, s[20:23], s80 offen offset:0
buffer_load_dwordx4 v[228:231], v253, s[20:23], s80 offen offset:64
buffer_load_dwordx4 v[232:235], v253, s[20:23], s80 offen offset:128
buffer_load_dwordx4 v[236:239], v253, s[20:23], s80 offen offset:192
s_waitcnt vmcnt(0)
Zvva 244,224,160
Mvva 244,228,164
Mvva 244,232,168
Mvva 244,236,172
s_nop 15
v_sub_f32 v240, v240, v252
v_exp_f32 v240, v240
v_sub_f32 v241, v241, v252
v_exp_f32 v241, v241
v_sub_f32 v242, v242, v252
v_exp_f32 v242, v242
v_sub_f32 v243, v243, v252
v_exp_f32 v243, v243
v_sub_f32 v244, v244, v252
v_exp_f32 v244, v244
v_sub_f32 v245, v245, v252
v_exp_f32 v245, v245
v_sub_f32 v246, v246, v252
v_exp_f32 v246, v246
v_sub_f32 v247, v247, v252
v_exp_f32 v247, v247
s_nop 1
v_cvt_pk_bf16_f32 v248, v240, v241
v_cvt_pk_bf16_f32 v249, v242, v243
v_cvt_pk_bf16_f32 v250, v244, v245
v_cvt_pk_bf16_f32 v251, v246, v247
s_nop 1
Maav 128,144,248
buffer_load_ushort v224, v254, s[24:27], s79 offen offset:0
buffer_load_ushort v225, v254, s[24:27], s79 offen offset:256
buffer_load_ushort v226, v254, s[24:27], s79 offen offset:512
buffer_load_ushort v227, v254, s[24:27], s79 offen offset:768
buffer_load_ushort v228, v254, s[24:27], s80 offen offset:0
buffer_load_ushort v229, v254, s[24:27], s80 offen offset:256
buffer_load_ushort v230, v254, s[24:27], s80 offen offset:512
buffer_load_ushort v231, v254, s[24:27], s80 offen offset:768
s_waitcnt vmcnt(0)
v_lshl_or_b32 v232, v225, 16, v224
v_lshl_or_b32 v233, v227, 16, v226
v_lshl_or_b32 v234, v229, 16, v228
v_lshl_or_b32 v235, v231, 16, v230
s_nop 1
Mvvv 32,232,248
s_nop 7
buffer_load_ushort v224, v254, s[24:27], s79 offen offset:32
buffer_load_ushort v225, v254, s[24:27], s79 offen offset:288
buffer_load_ushort v226, v254, s[24:27], s79 offen offset:544
buffer_load_ushort v227, v254, s[24:27], s79 offen offset:800
buffer_load_ushort v228, v254, s[24:27], s80 offen offset:32
buffer_load_ushort v229, v254, s[24:27], s80 offen offset:288
buffer_load_ushort v230, v254, s[24:27], s80 offen offset:544
buffer_load_ushort v231, v254, s[24:27], s80 offen offset:800
s_waitcnt vmcnt(0)
v_lshl_or_b32 v232, v225, 16, v224
v_lshl_or_b32 v233, v227, 16, v226
v_lshl_or_b32 v234, v229, 16, v228
v_lshl_or_b32 v235, v231, 16, v230
s_nop 1
Mvvv 36,232,248
s_nop 7
buffer_load_ushort v224, v254, s[24:27], s79 offen offset:64
buffer_load_ushort v225, v254, s[24:27], s79 offen offset:320
buffer_load_ushort v226, v254, s[24:27], s79 offen offset:576
buffer_load_ushort v227, v254, s[24:27], s79 offen offset:832
buffer_load_ushort v228, v254, s[24:27], s80 offen offset:64
buffer_load_ushort v229, v254, s[24:27], s80 offen offset:320
buffer_load_ushort v230, v254, s[24:27], s80 offen offset:576
buffer_load_ushort v231, v254, s[24:27], s80 offen offset:832
s_waitcnt vmcnt(0)
v_lshl_or_b32 v232, v225, 16, v224
v_lshl_or_b32 v233, v227, 16, v226
v_lshl_or_b32 v234, v229, 16, v228
v_lshl_or_b32 v235, v231, 16, v230
s_nop 1
Mvvv 40,232,248
s_nop 7
buffer_load_ushort v224, v254, s[24:27], s79 offen offset:96
buffer_load_ushort v225, v254, s[24:27], s79 offen offset:352
buffer_load_ushort v226, v254, s[24:27], s79 offen offset:608
buffer_load_ushort v227, v254, s[24:27], s79 offen offset:864
buffer_load_ushort v228, v254, s[24:27], s80 offen offset:96
buffer_load_ushort v229, v254, s[24:27], s80 offen offset:352
buffer_load_ushort v230, v254, s[24:27], s80 offen offset:608
buffer_load_ushort v231, v254, s[24:27], s80 offen offset:864
s_waitcnt vmcnt(0)
v_lshl_or_b32 v232, v225, 16, v224
v_lshl_or_b32 v233, v227, 16, v226
v_lshl_or_b32 v234, v229, 16, v228
v_lshl_or_b32 v235, v231, 16, v230
s_nop 1
Mvvv 44,232,248
s_nop 7
buffer_load_ushort v224, v254, s[24:27], s79 offen offset:128
buffer_load_ushort v225, v254, s[24:27], s79 offen offset:384
buffer_load_ushort v226, v254, s[24:27], s79 offen offset:640
buffer_load_ushort v227, v254, s[24:27], s79 offen offset:896
buffer_load_ushort v228, v254, s[24:27], s80 offen offset:128
buffer_load_ushort v229, v254, s[24:27], s80 offen offset:384
buffer_load_ushort v230, v254, s[24:27], s80 offen offset:640
buffer_load_ushort v231, v254, s[24:27], s80 offen offset:896
s_waitcnt vmcnt(0)
v_lshl_or_b32 v232, v225, 16, v224
v_lshl_or_b32 v233, v227, 16, v226
v_lshl_or_b32 v234, v229, 16, v228
v_lshl_or_b32 v235, v231, 16, v230
s_nop 1
Mvvv 48,232,248
s_nop 7
buffer_load_ushort v224, v254, s[24:27], s79 offen offset:160
buffer_load_ushort v225, v254, s[24:27], s79 offen offset:416
buffer_load_ushort v226, v254, s[24:27], s79 offen offset:672
buffer_load_ushort v227, v254, s[24:27], s79 offen offset:928
buffer_load_ushort v228, v254, s[24:27], s80 offen offset:160
buffer_load_ushort v229, v254, s[24:27], s80 offen offset:416
buffer_load_ushort v230, v254, s[24:27], s80 offen offset:672
buffer_load_ushort v231, v254, s[24:27], s80 offen offset:928
s_waitcnt vmcnt(0)
v_lshl_or_b32 v232, v225, 16, v224
v_lshl_or_b32 v233, v227, 16, v226
v_lshl_or_b32 v234, v229, 16, v228
v_lshl_or_b32 v235, v231, 16, v230
s_nop 1
Mvvv 52,232,248
s_nop 7
buffer_load_ushort v224, v254, s[24:27], s79 offen offset:192
buffer_load_ushort v225, v254, s[24:27], s79 offen offset:448
buffer_load_ushort v226, v254, s[24:27], s79 offen offset:704
buffer_load_ushort v227, v254, s[24:27], s79 offen offset:960
buffer_load_ushort v228, v254, s[24:27], s80 offen offset:192
buffer_load_ushort v229, v254, s[24:27], s80 offen offset:448
buffer_load_ushort v230, v254, s[24:27], s80 offen offset:704
buffer_load_ushort v231, v254, s[24:27], s80 offen offset:960
s_waitcnt vmcnt(0)
v_lshl_or_b32 v232, v225, 16, v224
v_lshl_or_b32 v233, v227, 16, v226
v_lshl_or_b32 v234, v229, 16, v228
v_lshl_or_b32 v235, v231, 16, v230
s_nop 1
Mvvv 56,232,248
s_nop 7
buffer_load_ushort v224, v254, s[24:27], s79 offen offset:224
buffer_load_ushort v225, v254, s[24:27], s79 offen offset:480
buffer_load_ushort v226, v254, s[24:27], s79 offen offset:736
buffer_load_ushort v227, v254, s[24:27], s79 offen offset:992
buffer_load_ushort v228, v254, s[24:27], s80 offen offset:224
buffer_load_ushort v229, v254, s[24:27], s80 offen offset:480
buffer_load_ushort v230, v254, s[24:27], s80 offen offset:736
buffer_load_ushort v231, v254, s[24:27], s80 offen offset:992
s_waitcnt vmcnt(0)
v_lshl_or_b32 v232, v225, 16, v224
v_lshl_or_b32 v233, v227, 16, v226
v_lshl_or_b32 v234, v229, 16, v228
v_lshl_or_b32 v235, v231, 16, v230
s_nop 1
Mvvv 60,232,248
s_nop 7
s_nop 15
s_add_u32 s79, s79, 0x2000
s_sub_u32 s83, s83, 1
s_cmp_lg_u32 s83, 0
s_cbranch_scc1 L_sp_0_0
v_mov_b32 v252, 0xff800000
s_mov_b32 s79, s84
s_mov_b32 s83, 32
L_sm_0_1:
buffer_load_dwordx4 v[224:227], v253, s[20:23], s79 offen offset:0
buffer_load_dwordx4 v[228:231], v253, s[20:23], s79 offen offset:64
buffer_load_dwordx4 v[232:235], v253, s[20:23], s79 offen offset:128
buffer_load_dwordx4 v[236:239], v253, s[20:23], s79 offen offset:192
s_waitcnt vmcnt(0)
Zvva 240,224,176
Mvva 240,228,180
Mvva 240,232,184
Mvva 240,236,188
s_nop 15
v_max3_f32 v252, v252, v240, v241
v_max3_f32 v252, v252, v242, v243
s_add_u32 s79, s79, 0x1000
s_sub_u32 s83, s83, 1
s_cmp_lg_u32 s83, 0
s_cbranch_scc1 L_sm_0_1
v_mov_b32 v255, v252
s_nop 1
v_permlane32_swap_b32 v252, v255
s_nop 1
v_max_f32 v252, v252, v255
v_mov_b32 v255, v252
s_nop 1
v_permlane16_swap_b32 v252, v255
s_nop 1
v_max_f32 v252, v252, v255
v_mov_b32 v64, 0
v_mov_b32 v65, 0
v_mov_b32 v66, 0
v_mov_b32 v67, 0
v_mov_b32 v68, 0
v_mov_b32 v69, 0
v_mov_b32 v70, 0
v_mov_b32 v71, 0
v_mov_b32 v72, 0
v_mov_b32 v73, 0
v_mov_b32 v74, 0
v_mov_b32 v75, 0
v_mov_b32 v76, 0
v_mov_b32 v77, 0
v_mov_b32 v78, 0
v_mov_b32 v79, 0
v_mov_b32 v80, 0
v_mov_b32 v81, 0
v_mov_b32 v82, 0
v_mov_b32 v83, 0
v_mov_b32 v84, 0
v_mov_b32 v85, 0
v_mov_b32 v86, 0
v_mov_b32 v87, 0
v_mov_b32 v88, 0
v_mov_b32 v89, 0
v_mov_b32 v90, 0
v_mov_b32 v91, 0
v_mov_b32 v92, 0
v_mov_b32 v93, 0
v_mov_b32 v94, 0
v_mov_b32 v95, 0
v_accvgpr_write_b32 a132, 0
v_accvgpr_write_b32 a133, 0
v_accvgpr_write_b32 a134, 0
v_accvgpr_write_b32 a135, 0
s_mov_b32 s79, s84
s_mov_b32 s83, 16
L_sp_0_1:
s_add_u32 s80, s79, 0x1000
buffer_load_dwordx4 v[224:227], v253, s[20:23], s79 offen offset:0
buffer_load_dwordx4 v[228:231], v253, s[20:23], s79 offen offset:64
buffer_load_dwordx4 v[232:235], v253, s[20:23], s79 offen offset:128
buffer_load_dwordx4 v[236:239], v253, s[20:23], s79 offen offset:192
s_waitcnt vmcnt(0)
Zvva 240,224,176
Mvva 240,228,180
Mvva 240,232,184
Mvva 240,236,188
s_nop 15
buffer_load_dwordx4 v[224:227], v253, s[20:23], s80 offen offset:0
buffer_load_dwordx4 v[228:231], v253, s[20:23], s80 offen offset:64
buffer_load_dwordx4 v[232:235], v253, s[20:23], s80 offen offset:128
buffer_load_dwordx4 v[236:239], v253, s[20:23], s80 offen offset:192
s_waitcnt vmcnt(0)
Zvva 244,224,176
Mvva 244,228,180
Mvva 244,232,184
Mvva 244,236,188
s_nop 15
v_sub_f32 v240, v240, v252
v_exp_f32 v240, v240
v_sub_f32 v241, v241, v252
v_exp_f32 v241, v241
v_sub_f32 v242, v242, v252
v_exp_f32 v242, v242
v_sub_f32 v243, v243, v252
v_exp_f32 v243, v243
v_sub_f32 v244, v244, v252
v_exp_f32 v244, v244
v_sub_f32 v245, v245, v252
v_exp_f32 v245, v245
v_sub_f32 v246, v246, v252
v_exp_f32 v246, v246
v_sub_f32 v247, v247, v252
v_exp_f32 v247, v247
s_nop 1
v_cvt_pk_bf16_f32 v248, v240, v241
v_cvt_pk_bf16_f32 v249, v242, v243
v_cvt_pk_bf16_f32 v250, v244, v245
v_cvt_pk_bf16_f32 v251, v246, v247
s_nop 1
Maav 132,144,248
buffer_load_ushort v224, v254, s[24:27], s79 offen offset:0
buffer_load_ushort v225, v254, s[24:27], s79 offen offset:256
buffer_load_ushort v226, v254, s[24:27], s79 offen offset:512
buffer_load_ushort v227, v254, s[24:27], s79 offen offset:768
buffer_load_ushort v228, v254, s[24:27], s80 offen offset:0
buffer_load_ushort v229, v254, s[24:27], s80 offen offset:256
buffer_load_ushort v230, v254, s[24:27], s80 offen offset:512
buffer_load_ushort v231, v254, s[24:27], s80 offen offset:768
s_waitcnt vmcnt(0)
v_lshl_or_b32 v232, v225, 16, v224
v_lshl_or_b32 v233, v227, 16, v226
v_lshl_or_b32 v234, v229, 16, v228
v_lshl_or_b32 v235, v231, 16, v230
s_nop 1
Mvvv 64,232,248
s_nop 7
buffer_load_ushort v224, v254, s[24:27], s79 offen offset:32
buffer_load_ushort v225, v254, s[24:27], s79 offen offset:288
buffer_load_ushort v226, v254, s[24:27], s79 offen offset:544
buffer_load_ushort v227, v254, s[24:27], s79 offen offset:800
buffer_load_ushort v228, v254, s[24:27], s80 offen offset:32
buffer_load_ushort v229, v254, s[24:27], s80 offen offset:288
buffer_load_ushort v230, v254, s[24:27], s80 offen offset:544
buffer_load_ushort v231, v254, s[24:27], s80 offen offset:800
s_waitcnt vmcnt(0)
v_lshl_or_b32 v232, v225, 16, v224
v_lshl_or_b32 v233, v227, 16, v226
v_lshl_or_b32 v234, v229, 16, v228
v_lshl_or_b32 v235, v231, 16, v230
s_nop 1
Mvvv 68,232,248
s_nop 7
buffer_load_ushort v224, v254, s[24:27], s79 offen offset:64
buffer_load_ushort v225, v254, s[24:27], s79 offen offset:320
buffer_load_ushort v226, v254, s[24:27], s79 offen offset:576
buffer_load_ushort v227, v254, s[24:27], s79 offen offset:832
buffer_load_ushort v228, v254, s[24:27], s80 offen offset:64
buffer_load_ushort v229, v254, s[24:27], s80 offen offset:320
buffer_load_ushort v230, v254, s[24:27], s80 offen offset:576
buffer_load_ushort v231, v254, s[24:27], s80 offen offset:832
s_waitcnt vmcnt(0)
v_lshl_or_b32 v232, v225, 16, v224
v_lshl_or_b32 v233, v227, 16, v226
v_lshl_or_b32 v234, v229, 16, v228
v_lshl_or_b32 v235, v231, 16, v230
s_nop 1
Mvvv 72,232,248
s_nop 7
buffer_load_ushort v224, v254, s[24:27], s79 offen offset:96
buffer_load_ushort v225, v254, s[24:27], s79 offen offset:352
buffer_load_ushort v226, v254, s[24:27], s79 offen offset:608
buffer_load_ushort v227, v254, s[24:27], s79 offen offset:864
buffer_load_ushort v228, v254, s[24:27], s80 offen offset:96
buffer_load_ushort v229, v254, s[24:27], s80 offen offset:352
buffer_load_ushort v230, v254, s[24:27], s80 offen offset:608
buffer_load_ushort v231, v254, s[24:27], s80 offen offset:864
s_waitcnt vmcnt(0)
v_lshl_or_b32 v232, v225, 16, v224
v_lshl_or_b32 v233, v227, 16, v226
v_lshl_or_b32 v234, v229, 16, v228
v_lshl_or_b32 v235, v231, 16, v230
s_nop 1
Mvvv 76,232,248
s_nop 7
buffer_load_ushort v224, v254, s[24:27], s79 offen offset:128
buffer_load_ushort v225, v254, s[24:27], s79 offen offset:384
buffer_load_ushort v226, v254, s[24:27], s79 offen offset:640
buffer_load_ushort v227, v254, s[24:27], s79 offen offset:896
buffer_load_ushort v228, v254, s[24:27], s80 offen offset:128
buffer_load_ushort v229, v254, s[24:27], s80 offen offset:384
buffer_load_ushort v230, v254, s[24:27], s80 offen offset:640
buffer_load_ushort v231, v254, s[24:27], s80 offen offset:896
s_waitcnt vmcnt(0)
v_lshl_or_b32 v232, v225, 16, v224
v_lshl_or_b32 v233, v227, 16, v226
v_lshl_or_b32 v234, v229, 16, v228
v_lshl_or_b32 v235, v231, 16, v230
s_nop 1
Mvvv 80,232,248
s_nop 7
buffer_load_ushort v224, v254, s[24:27], s79 offen offset:160
buffer_load_ushort v225, v254, s[24:27], s79 offen offset:416
buffer_load_ushort v226, v254, s[24:27], s79 offen offset:672
buffer_load_ushort v227, v254, s[24:27], s79 offen offset:928
buffer_load_ushort v228, v254, s[24:27], s80 offen offset:160
buffer_load_ushort v229, v254, s[24:27], s80 offen offset:416
buffer_load_ushort v230, v254, s[24:27], s80 offen offset:672
buffer_load_ushort v231, v254, s[24:27], s80 offen offset:928
s_waitcnt vmcnt(0)
v_lshl_or_b32 v232, v225, 16, v224
v_lshl_or_b32 v233, v227, 16, v226
v_lshl_or_b32 v234, v229, 16, v228
v_lshl_or_b32 v235, v231, 16, v230
s_nop 1
Mvvv 84,232,248
s_nop 7
buffer_load_ushort v224, v254, s[24:27], s79 offen offset:192
buffer_load_ushort v225, v254, s[24:27], s79 offen offset:448
buffer_load_ushort v226, v254, s[24:27], s79 offen offset:704
buffer_load_ushort v227, v254, s[24:27], s79 offen offset:960
buffer_load_ushort v228, v254, s[24:27], s80 offen offset:192
buffer_load_ushort v229, v254, s[24:27], s80 offen offset:448
buffer_load_ushort v230, v254, s[24:27], s80 offen offset:704
buffer_load_ushort v231, v254, s[24:27], s80 offen offset:960
s_waitcnt vmcnt(0)
v_lshl_or_b32 v232, v225, 16, v224
v_lshl_or_b32 v233, v227, 16, v226
v_lshl_or_b32 v234, v229, 16, v228
v_lshl_or_b32 v235, v231, 16, v230
s_nop 1
Mvvv 88,232,248
s_nop 7
buffer_load_ushort v224, v254, s[24:27], s79 offen offset:224
buffer_load_ushort v225, v254, s[24:27], s79 offen offset:480
buffer_load_ushort v226, v254, s[24:27], s79 offen offset:736
buffer_load_ushort v227, v254, s[24:27], s79 offen offset:992
buffer_load_ushort v228, v254, s[24:27], s80 offen offset:224
buffer_load_ushort v229, v254, s[24:27], s80 offen offset:480
buffer_load_ushort v230, v254, s[24:27], s80 offen offset:736
buffer_load_ushort v231, v254, s[24:27], s80 offen offset:992
s_waitcnt vmcnt(0)
v_lshl_or_b32 v232, v225, 16, v224
v_lshl_or_b32 v233, v227, 16, v226
v_lshl_or_b32 v234, v229, 16, v228
v_lshl_or_b32 v235, v231, 16, v230
s_nop 1
Mvvv 92,232,248
s_nop 7
s_nop 15
s_add_u32 s79, s79, 0x2000
s_sub_u32 s83, s83, 1
s_cmp_lg_u32 s83, 0
s_cbranch_scc1 L_sp_0_1
v_mov_b32 v252, 0xff800000
s_mov_b32 s79, s84
s_mov_b32 s83, 32
L_sm_0_2:
buffer_load_dwordx4 v[224:227], v253, s[20:23], s79 offen offset:0
buffer_load_dwordx4 v[228:231], v253, s[20:23], s79 offen offset:64
buffer_load_dwordx4 v[232:235], v253, s[20:23], s79 offen offset:128
buffer_load_dwordx4 v[236:239], v253, s[20:23], s79 offen offset:192
s_waitcnt vmcnt(0)
Zvva 240,224,192
Mvva 240,228,196
Mvva 240,232,200
Mvva 240,236,204
s_nop 15
v_max3_f32 v252, v252, v240, v241
v_max3_f32 v252, v252, v242, v243
s_add_u32 s79, s79, 0x1000
s_sub_u32 s83, s83, 1
s_cmp_lg_u32 s83, 0
s_cbranch_scc1 L_sm_0_2
v_mov_b32 v255, v252
s_nop 1
v_permlane32_swap_b32 v252, v255
s_nop 1
v_max_f32 v252, v252, v255
v_mov_b32 v255, v252
s_nop 1
v_permlane16_swap_b32 v252, v255
s_nop 1
v_max_f32 v252, v252, v255
v_mov_b32 v96, 0
v_mov_b32 v97, 0
v_mov_b32 v98, 0
v_mov_b32 v99, 0
v_mov_b32 v100, 0
v_mov_b32 v101, 0
v_mov_b32 v102, 0
v_mov_b32 v103, 0
v_mov_b32 v104, 0
v_mov_b32 v105, 0
v_mov_b32 v106, 0
v_mov_b32 v107, 0
v_mov_b32 v108, 0
v_mov_b32 v109, 0
v_mov_b32 v110, 0
v_mov_b32 v111, 0
v_mov_b32 v112, 0
v_mov_b32 v113, 0
v_mov_b32 v114, 0
v_mov_b32 v115, 0
v_mov_b32 v116, 0
v_mov_b32 v117, 0
v_mov_b32 v118, 0
v_mov_b32 v119, 0
v_mov_b32 v120, 0
v_mov_b32 v121, 0
v_mov_b32 v122, 0
v_mov_b32 v123, 0
v_mov_b32 v124, 0
v_mov_b32 v125, 0
v_mov_b32 v126, 0
v_mov_b32 v127, 0
v_accvgpr_write_b32 a136, 0
v_accvgpr_write_b32 a137, 0
v_accvgpr_write_b32 a138, 0
v_accvgpr_write_b32 a139, 0
s_mov_b32 s79, s84
s_mov_b32 s83, 16
L_sp_0_2:
s_add_u32 s80, s79, 0x1000
buffer_load_dwordx4 v[224:227], v253, s[20:23], s79 offen offset:0
buffer_load_dwordx4 v[228:231], v253, s[20:23], s79 offen offset:64
buffer_load_dwordx4 v[232:235], v253, s[20:23], s79 offen offset:128
buffer_load_dwordx4 v[236:239], v253, s[20:23], s79 offen offset:192
s_waitcnt vmcnt(0)
Zvva 240,224,192
Mvva 240,228,196
Mvva 240,232,200
Mvva 240,236,204
s_nop 15
buffer_load_dwordx4 v[224:227], v253, s[20:23], s80 offen offset:0
buffer_load_dwordx4 v[228:231], v253, s[20:23], s80 offen offset:64
buffer_load_dwordx4 v[232:235], v253, s[20:23], s80 offen offset:128
buffer_load_dwordx4 v[236:239], v253, s[20:23], s80 offen offset:192
s_waitcnt vmcnt(0)
Zvva 244,224,192
Mvva 244,228,196
Mvva 244,232,200
Mvva 244,236,204
s_nop 15
v_sub_f32 v240, v240, v252
v_exp_f32 v240, v240
v_sub_f32 v241, v241, v252
v_exp_f32 v241, v241
v_sub_f32 v242, v242, v252
v_exp_f32 v242, v242
v_sub_f32 v243, v243, v252
v_exp_f32 v243, v243
v_sub_f32 v244, v244, v252
v_exp_f32 v244, v244
v_sub_f32 v245, v245, v252
v_exp_f32 v245, v245
v_sub_f32 v246, v246, v252
v_exp_f32 v246, v246
v_sub_f32 v247, v247, v252
v_exp_f32 v247, v247
s_nop 1
v_cvt_pk_bf16_f32 v248, v240, v241
v_cvt_pk_bf16_f32 v249, v242, v243
v_cvt_pk_bf16_f32 v250, v244, v245
v_cvt_pk_bf16_f32 v251, v246, v247
s_nop 1
Maav 136,144,248
buffer_load_ushort v224, v254, s[24:27], s79 offen offset:0
buffer_load_ushort v225, v254, s[24:27], s79 offen offset:256
buffer_load_ushort v226, v254, s[24:27], s79 offen offset:512
buffer_load_ushort v227, v254, s[24:27], s79 offen offset:768
buffer_load_ushort v228, v254, s[24:27], s80 offen offset:0
buffer_load_ushort v229, v254, s[24:27], s80 offen offset:256
buffer_load_ushort v230, v254, s[24:27], s80 offen offset:512
buffer_load_ushort v231, v254, s[24:27], s80 offen offset:768
s_waitcnt vmcnt(0)
v_lshl_or_b32 v232, v225, 16, v224
v_lshl_or_b32 v233, v227, 16, v226
v_lshl_or_b32 v234, v229, 16, v228
v_lshl_or_b32 v235, v231, 16, v230
s_nop 1
Mvvv 96,232,248
s_nop 7
buffer_load_ushort v224, v254, s[24:27], s79 offen offset:32
buffer_load_ushort v225, v254, s[24:27], s79 offen offset:288
buffer_load_ushort v226, v254, s[24:27], s79 offen offset:544
buffer_load_ushort v227, v254, s[24:27], s79 offen offset:800
buffer_load_ushort v228, v254, s[24:27], s80 offen offset:32
buffer_load_ushort v229, v254, s[24:27], s80 offen offset:288
buffer_load_ushort v230, v254, s[24:27], s80 offen offset:544
buffer_load_ushort v231, v254, s[24:27], s80 offen offset:800
s_waitcnt vmcnt(0)
v_lshl_or_b32 v232, v225, 16, v224
v_lshl_or_b32 v233, v227, 16, v226
v_lshl_or_b32 v234, v229, 16, v228
v_lshl_or_b32 v235, v231, 16, v230
s_nop 1
Mvvv 100,232,248
s_nop 7
buffer_load_ushort v224, v254, s[24:27], s79 offen offset:64
buffer_load_ushort v225, v254, s[24:27], s79 offen offset:320
buffer_load_ushort v226, v254, s[24:27], s79 offen offset:576
buffer_load_ushort v227, v254, s[24:27], s79 offen offset:832
buffer_load_ushort v228, v254, s[24:27], s80 offen offset:64
buffer_load_ushort v229, v254, s[24:27], s80 offen offset:320
buffer_load_ushort v230, v254, s[24:27], s80 offen offset:576
buffer_load_ushort v231, v254, s[24:27], s80 offen offset:832
s_waitcnt vmcnt(0)
v_lshl_or_b32 v232, v225, 16, v224
v_lshl_or_b32 v233, v227, 16, v226
v_lshl_or_b32 v234, v229, 16, v228
v_lshl_or_b32 v235, v231, 16, v230
s_nop 1
Mvvv 104,232,248
s_nop 7
buffer_load_ushort v224, v254, s[24:27], s79 offen offset:96
buffer_load_ushort v225, v254, s[24:27], s79 offen offset:352
buffer_load_ushort v226, v254, s[24:27], s79 offen offset:608
buffer_load_ushort v227, v254, s[24:27], s79 offen offset:864
buffer_load_ushort v228, v254, s[24:27], s80 offen offset:96
buffer_load_ushort v229, v254, s[24:27], s80 offen offset:352
buffer_load_ushort v230, v254, s[24:27], s80 offen offset:608
buffer_load_ushort v231, v254, s[24:27], s80 offen offset:864
s_waitcnt vmcnt(0)
v_lshl_or_b32 v232, v225, 16, v224
v_lshl_or_b32 v233, v227, 16, v226
v_lshl_or_b32 v234, v229, 16, v228
v_lshl_or_b32 v235, v231, 16, v230
s_nop 1
Mvvv 108,232,248
s_nop 7
buffer_load_ushort v224, v254, s[24:27], s79 offen offset:128
buffer_load_ushort v225, v254, s[24:27], s79 offen offset:384
buffer_load_ushort v226, v254, s[24:27], s79 offen offset:640
buffer_load_ushort v227, v254, s[24:27], s79 offen offset:896
buffer_load_ushort v228, v254, s[24:27], s80 offen offset:128
buffer_load_ushort v229, v254, s[24:27], s80 offen offset:384
buffer_load_ushort v230, v254, s[24:27], s80 offen offset:640
buffer_load_ushort v231, v254, s[24:27], s80 offen offset:896
s_waitcnt vmcnt(0)
v_lshl_or_b32 v232, v225, 16, v224
v_lshl_or_b32 v233, v227, 16, v226
v_lshl_or_b32 v234, v229, 16, v228
v_lshl_or_b32 v235, v231, 16, v230
s_nop 1
Mvvv 112,232,248
s_nop 7
buffer_load_ushort v224, v254, s[24:27], s79 offen offset:160
buffer_load_ushort v225, v254, s[24:27], s79 offen offset:416
buffer_load_ushort v226, v254, s[24:27], s79 offen offset:672
buffer_load_ushort v227, v254, s[24:27], s79 offen offset:928
buffer_load_ushort v228, v254, s[24:27], s80 offen offset:160
buffer_load_ushort v229, v254, s[24:27], s80 offen offset:416
buffer_load_ushort v230, v254, s[24:27], s80 offen offset:672
buffer_load_ushort v231, v254, s[24:27], s80 offen offset:928
s_waitcnt vmcnt(0)
v_lshl_or_b32 v232, v225, 16, v224
v_lshl_or_b32 v233, v227, 16, v226
v_lshl_or_b32 v234, v229, 16, v228
v_lshl_or_b32 v235, v231, 16, v230
s_nop 1
Mvvv 116,232,248
s_nop 7
buffer_load_ushort v224, v254, s[24:27], s79 offen offset:192
buffer_load_ushort v225, v254, s[24:27], s79 offen offset:448
buffer_load_ushort v226, v254, s[24:27], s79 offen offset:704
buffer_load_ushort v227, v254, s[24:27], s79 offen offset:960
buffer_load_ushort v228, v254, s[24:27], s80 offen offset:192
buffer_load_ushort v229, v254, s[24:27], s80 offen offset:448
buffer_load_ushort v230, v254, s[24:27], s80 offen offset:704
buffer_load_ushort v231, v254, s[24:27], s80 offen offset:960
s_waitcnt vmcnt(0)
v_lshl_or_b32 v232, v225, 16, v224
v_lshl_or_b32 v233, v227, 16, v226
v_lshl_or_b32 v234, v229, 16, v228
v_lshl_or_b32 v235, v231, 16, v230
s_nop 1
Mvvv 120,232,248
s_nop 7
buffer_load_ushort v224, v254, s[24:27], s79 offen offset:224
buffer_load_ushort v225, v254, s[24:27], s79 offen offset:480
buffer_load_ushort v226, v254, s[24:27], s79 offen offset:736
buffer_load_ushort v227, v254, s[24:27], s79 offen offset:992
buffer_load_ushort v228, v254, s[24:27], s80 offen offset:224
buffer_load_ushort v229, v254, s[24:27], s80 offen offset:480
buffer_load_ushort v230, v254, s[24:27], s80 offen offset:736
buffer_load_ushort v231, v254, s[24:27], s80 offen offset:992
s_waitcnt vmcnt(0)
v_lshl_or_b32 v232, v225, 16, v224
v_lshl_or_b32 v233, v227, 16, v226
v_lshl_or_b32 v234, v229, 16, v228
v_lshl_or_b32 v235, v231, 16, v230
s_nop 1
Mvvv 124,232,248
s_nop 7
s_nop 15
s_add_u32 s79, s79, 0x2000
s_sub_u32 s83, s83, 1
s_cmp_lg_u32 s83, 0
s_cbranch_scc1 L_sp_0_2
v_mov_b32 v252, 0xff800000
s_mov_b32 s79, s84
s_mov_b32 s83, 32
L_sm_0_3:
buffer_load_dwordx4 v[224:227], v253, s[20:23], s79 offen offset:0
buffer_load_dwordx4 v[228:231], v253, s[20:23], s79 offen offset:64
buffer_load_dwordx4 v[232:235], v253, s[20:23], s79 offen offset:128
buffer_load_dwordx4 v[236:239], v253, s[20:23], s79 offen offset:192
s_waitcnt vmcnt(0)
Zvva 240,224,208
Mvva 240,228,212
Mvva 240,232,216
Mvva 240,236,220
s_nop 15
v_max3_f32 v252, v252, v240, v241
v_max3_f32 v252, v252, v242, v243
s_add_u32 s79, s79, 0x1000
s_sub_u32 s83, s83, 1
s_cmp_lg_u32 s83, 0
s_cbranch_scc1 L_sm_0_3
v_mov_b32 v255, v252
s_nop 1
v_permlane32_swap_b32 v252, v255
s_nop 1
v_max_f32 v252, v252, v255
v_mov_b32 v255, v252
s_nop 1
v_permlane16_swap_b32 v252, v255
s_nop 1
v_max_f32 v252, v252, v255
v_mov_b32 v128, 0
v_mov_b32 v129, 0
v_mov_b32 v130, 0
v_mov_b32 v131, 0
v_mov_b32 v132, 0
v_mov_b32 v133, 0
v_mov_b32 v134, 0
v_mov_b32 v135, 0
v_mov_b32 v136, 0
v_mov_b32 v137, 0
v_mov_b32 v138, 0
v_mov_b32 v139, 0
v_mov_b32 v140, 0
v_mov_b32 v141, 0
v_mov_b32 v142, 0
v_mov_b32 v143, 0
v_mov_b32 v144, 0
v_mov_b32 v145, 0
v_mov_b32 v146, 0
v_mov_b32 v147, 0
v_mov_b32 v148, 0
v_mov_b32 v149, 0
v_mov_b32 v150, 0
v_mov_b32 v151, 0
v_mov_b32 v152, 0
v_mov_b32 v153, 0
v_mov_b32 v154, 0
v_mov_b32 v155, 0
v_mov_b32 v156, 0
v_mov_b32 v157, 0
v_mov_b32 v158, 0
v_mov_b32 v159, 0
v_accvgpr_write_b32 a140, 0
v_accvgpr_write_b32 a141, 0
v_accvgpr_write_b32 a142, 0
v_accvgpr_write_b32 a143, 0
s_mov_b32 s79, s84
s_mov_b32 s83, 16
L_sp_0_3:
s_add_u32 s80, s79, 0x1000
buffer_load_dwordx4 v[224:227], v253, s[20:23], s79 offen offset:0
buffer_load_dwordx4 v[228:231], v253, s[20:23], s79 offen offset:64
buffer_load_dwordx4 v[232:235], v253, s[20:23], s79 offen offset:128
buffer_load_dwordx4 v[236:239], v253, s[20:23], s79 offen offset:192
s_waitcnt vmcnt(0)
Zvva 240,224,208
Mvva 240,228,212
Mvva 240,232,216
Mvva 240,236,220
s_nop 15
buffer_load_dwordx4 v[224:227], v253, s[20:23], s80 offen offset:0
buffer_load_dwordx4 v[228:231], v253, s[20:23], s80 offen offset:64
buffer_load_dwordx4 v[232:235], v253, s[20:23], s80 offen offset:128
buffer_load_dwordx4 v[236:239], v253, s[20:23], s80 offen offset:192
s_waitcnt vmcnt(0)
Zvva 244,224,208
Mvva 244,228,212
Mvva 244,232,216
Mvva 244,236,220
s_nop 15
v_sub_f32 v240, v240, v252
v_exp_f32 v240, v240
v_sub_f32 v241, v241, v252
v_exp_f32 v241, v241
v_sub_f32 v242, v242, v252
v_exp_f32 v242, v242
v_sub_f32 v243, v243, v252
v_exp_f32 v243, v243
v_sub_f32 v244, v244, v252
v_exp_f32 v244, v244
v_sub_f32 v245, v245, v252
v_exp_f32 v245, v245
v_sub_f32 v246, v246, v252
v_exp_f32 v246, v246
v_sub_f32 v247, v247, v252
v_exp_f32 v247, v247
s_nop 1
v_cvt_pk_bf16_f32 v248, v240, v241
v_cvt_pk_bf16_f32 v249, v242, v243
v_cvt_pk_bf16_f32 v250, v244, v245
v_cvt_pk_bf16_f32 v251, v246, v247
s_nop 1
Maav 140,144,248
buffer_load_ushort v224, v254, s[24:27], s79 offen offset:0
buffer_load_ushort v225, v254, s[24:27], s79 offen offset:256
buffer_load_ushort v226, v254, s[24:27], s79 offen offset:512
buffer_load_ushort v227, v254, s[24:27], s79 offen offset:768
buffer_load_ushort v228, v254, s[24:27], s80 offen offset:0
buffer_load_ushort v229, v254, s[24:27], s80 offen offset:256
buffer_load_ushort v230, v254, s[24:27], s80 offen offset:512
buffer_load_ushort v231, v254, s[24:27], s80 offen offset:768
s_waitcnt vmcnt(0)
v_lshl_or_b32 v232, v225, 16, v224
v_lshl_or_b32 v233, v227, 16, v226
v_lshl_or_b32 v234, v229, 16, v228
v_lshl_or_b32 v235, v231, 16, v230
s_nop 1
Mvvv 128,232,248
s_nop 7
buffer_load_ushort v224, v254, s[24:27], s79 offen offset:32
buffer_load_ushort v225, v254, s[24:27], s79 offen offset:288
buffer_load_ushort v226, v254, s[24:27], s79 offen offset:544
buffer_load_ushort v227, v254, s[24:27], s79 offen offset:800
buffer_load_ushort v228, v254, s[24:27], s80 offen offset:32
buffer_load_ushort v229, v254, s[24:27], s80 offen offset:288
buffer_load_ushort v230, v254, s[24:27], s80 offen offset:544
buffer_load_ushort v231, v254, s[24:27], s80 offen offset:800
s_waitcnt vmcnt(0)
v_lshl_or_b32 v232, v225, 16, v224
v_lshl_or_b32 v233, v227, 16, v226
v_lshl_or_b32 v234, v229, 16, v228
v_lshl_or_b32 v235, v231, 16, v230
s_nop 1
Mvvv 132,232,248
s_nop 7
buffer_load_ushort v224, v254, s[24:27], s79 offen offset:64
buffer_load_ushort v225, v254, s[24:27], s79 offen offset:320
buffer_load_ushort v226, v254, s[24:27], s79 offen offset:576
buffer_load_ushort v227, v254, s[24:27], s79 offen offset:832
buffer_load_ushort v228, v254, s[24:27], s80 offen offset:64
buffer_load_ushort v229, v254, s[24:27], s80 offen offset:320
buffer_load_ushort v230, v254, s[24:27], s80 offen offset:576
buffer_load_ushort v231, v254, s[24:27], s80 offen offset:832
s_waitcnt vmcnt(0)
v_lshl_or_b32 v232, v225, 16, v224
v_lshl_or_b32 v233, v227, 16, v226
v_lshl_or_b32 v234, v229, 16, v228
v_lshl_or_b32 v235, v231, 16, v230
s_nop 1
Mvvv 136,232,248
s_nop 7
buffer_load_ushort v224, v254, s[24:27], s79 offen offset:96
buffer_load_ushort v225, v254, s[24:27], s79 offen offset:352
buffer_load_ushort v226, v254, s[24:27], s79 offen offset:608
buffer_load_ushort v227, v254, s[24:27], s79 offen offset:864
buffer_load_ushort v228, v254, s[24:27], s80 offen offset:96
buffer_load_ushort v229, v254, s[24:27], s80 offen offset:352
buffer_load_ushort v230, v254, s[24:27], s80 offen offset:608
buffer_load_ushort v231, v254, s[24:27], s80 offen offset:864
s_waitcnt vmcnt(0)
v_lshl_or_b32 v232, v225, 16, v224
v_lshl_or_b32 v233, v227, 16, v226
v_lshl_or_b32 v234, v229, 16, v228
v_lshl_or_b32 v235, v231, 16, v230
s_nop 1
Mvvv 140,232,248
s_nop 7
buffer_load_ushort v224, v254, s[24:27], s79 offen offset:128
buffer_load_ushort v225, v254, s[24:27], s79 offen offset:384
buffer_load_ushort v226, v254, s[24:27], s79 offen offset:640
buffer_load_ushort v227, v254, s[24:27], s79 offen offset:896
buffer_load_ushort v228, v254, s[24:27], s80 offen offset:128
buffer_load_ushort v229, v254, s[24:27], s80 offen offset:384
buffer_load_ushort v230, v254, s[24:27], s80 offen offset:640
buffer_load_ushort v231, v254, s[24:27], s80 offen offset:896
s_waitcnt vmcnt(0)
v_lshl_or_b32 v232, v225, 16, v224
v_lshl_or_b32 v233, v227, 16, v226
v_lshl_or_b32 v234, v229, 16, v228
v_lshl_or_b32 v235, v231, 16, v230
s_nop 1
Mvvv 144,232,248
s_nop 7
buffer_load_ushort v224, v254, s[24:27], s79 offen offset:160
buffer_load_ushort v225, v254, s[24:27], s79 offen offset:416
buffer_load_ushort v226, v254, s[24:27], s79 offen offset:672
buffer_load_ushort v227, v254, s[24:27], s79 offen offset:928
buffer_load_ushort v228, v254, s[24:27], s80 offen offset:160
buffer_load_ushort v229, v254, s[24:27], s80 offen offset:416
buffer_load_ushort v230, v254, s[24:27], s80 offen offset:672
buffer_load_ushort v231, v254, s[24:27], s80 offen offset:928
s_waitcnt vmcnt(0)
v_lshl_or_b32 v232, v225, 16, v224
v_lshl_or_b32 v233, v227, 16, v226
v_lshl_or_b32 v234, v229, 16, v228
v_lshl_or_b32 v235, v231, 16, v230
s_nop 1
Mvvv 148,232,248
s_nop 7
buffer_load_ushort v224, v254, s[24:27], s79 offen offset:192
buffer_load_ushort v225, v254, s[24:27], s79 offen offset:448
buffer_load_ushort v226, v254, s[24:27], s79 offen offset:704
buffer_load_ushort v227, v254, s[24:27], s79 offen offset:960
buffer_load_ushort v228, v254, s[24:27], s80 offen offset:192
buffer_load_ushort v229, v254, s[24:27], s80 offen offset:448
buffer_load_ushort v230, v254, s[24:27], s80 offen offset:704
buffer_load_ushort v231, v254, s[24:27], s80 offen offset:960
s_waitcnt vmcnt(0)
v_lshl_or_b32 v232, v225, 16, v224
v_lshl_or_b32 v233, v227, 16, v226
v_lshl_or_b32 v234, v229, 16, v228
v_lshl_or_b32 v235, v231, 16, v230
s_nop 1
Mvvv 152,232,248
s_nop 7
buffer_load_ushort v224, v254, s[24:27], s79 offen offset:224
buffer_load_ushort v225, v254, s[24:27], s79 offen offset:480
buffer_load_ushort v226, v254, s[24:27], s79 offen offset:736
buffer_load_ushort v227, v254, s[24:27], s79 offen offset:992
buffer_load_ushort v228, v254, s[24:27], s80 offen offset:224
buffer_load_ushort v229, v254, s[24:27], s80 offen offset:480
buffer_load_ushort v230, v254, s[24:27], s80 offen offset:736
buffer_load_ushort v231, v254, s[24:27], s80 offen offset:992
s_waitcnt vmcnt(0)
v_lshl_or_b32 v232, v225, 16, v224
v_lshl_or_b32 v233, v227, 16, v226
v_lshl_or_b32 v234, v229, 16, v228
v_lshl_or_b32 v235, v231, 16, v230
s_nop 1
Mvvv 156,232,248
s_nop 7
s_nop 15
s_add_u32 s79, s79, 0x2000
s_sub_u32 s83, s83, 1
s_cmp_lg_u32 s83, 0
s_cbranch_scc1 L_sp_0_3
s_nop 15
s_branch L_back0
L_slow1:
s_waitcnt vmcnt(0) lgkmcnt(0)
v_and_b32 v191, 15, v1
v_lshrrev_b32 v190, 4, v1
v_lshlrev_b32 v189, 4, v190
v_lshl_or_b32 v189, v191, 8, v189
v_lshlrev_b32 v190, 10, v190
v_lshl_or_b32 v190, v191, 1, v190
v_mov_b32 v188, 0xff800000
s_add_u32 s79, s84, 0x80000
s_mov_b32 s83, 32
L_sm_1_0:
buffer_load_dwordx4 v[160:163], v189, s[20:23], s79 offen offset:0
buffer_load_dwordx4 v[164:167], v189, s[20:23], s79 offen offset:64
buffer_load_dwordx4 v[168:171], v189, s[20:23], s79 offen offset:128
buffer_load_dwordx4 v[172:175], v189, s[20:23], s79 offen offset:192
s_waitcnt vmcnt(0)
Zvva 176,160,0
Mvva 176,164,16
Mvva 176,168,32
Mvva 176,172,48
s_nop 15
v_max3_f32 v188, v188, v176, v177
v_max3_f32 v188, v188, v178, v179
s_add_u32 s79, s79, 0x1000
s_sub_u32 s83, s83, 1
s_cmp_lg_u32 s83, 0
s_cbranch_scc1 L_sm_1_0
v_mov_b32 v191, v188
s_nop 1
v_permlane32_swap_b32 v188, v191
s_nop 1
v_max_f32 v188, v188, v191
v_mov_b32 v191, v188
s_nop 1
v_permlane16_swap_b32 v188, v191
s_nop 1
v_max_f32 v188, v188, v191
v_mov_b32 v32, 0
v_mov_b32 v33, 0
v_mov_b32 v34, 0
v_mov_b32 v35, 0
v_mov_b32 v36, 0
v_mov_b32 v37, 0
v_mov_b32 v38, 0
v_mov_b32 v39, 0
v_mov_b32 v40, 0
v_mov_b32 v41, 0
v_mov_b32 v42, 0
v_mov_b32 v43, 0
v_mov_b32 v44, 0
v_mov_b32 v45, 0
v_mov_b32 v46, 0
v_mov_b32 v47, 0
v_mov_b32 v48, 0
v_mov_b32 v49, 0
v_mov_b32 v50, 0
v_mov_b32 v51, 0
v_mov_b32 v52, 0
v_mov_b32 v53, 0
v_mov_b32 v54, 0
v_mov_b32 v55, 0
v_mov_b32 v56, 0
v_mov_b32 v57, 0
v_mov_b32 v58, 0
v_mov_b32 v59, 0
v_mov_b32 v60, 0
v_mov_b32 v61, 0
v_mov_b32 v62, 0
v_mov_b32 v63, 0
v_accvgpr_write_b32 a128, 0
v_accvgpr_write_b32 a129, 0
v_accvgpr_write_b32 a130, 0
v_accvgpr_write_b32 a131, 0
s_add_u32 s79, s84, 0x80000
s_mov_b32 s83, 16
L_sp_1_0:
s_add_u32 s80, s79, 0x1000
buffer_load_dwordx4 v[160:163], v189, s[20:23], s79 offen offset:0
buffer_load_dwordx4 v[164:167], v189, s[20:23], s79 offen offset:64
buffer_load_dwordx4 v[168:171], v189, s[20:23], s79 offen offset:128
buffer_load_dwordx4 v[172:175], v189, s[20:23], s79 offen offset:192
s_waitcnt vmcnt(0)
Zvva 176,160,0
Mvva 176,164,16
Mvva 176,168,32
Mvva 176,172,48
s_nop 15
buffer_load_dwordx4 v[160:163], v189, s[20:23], s80 offen offset:0
buffer_load_dwordx4 v[164:167], v189, s[20:23], s80 offen offset:64
buffer_load_dwordx4 v[168:171], v189, s[20:23], s80 offen offset:128
buffer_load_dwordx4 v[172:175], v189, s[20:23], s80 offen offset:192
s_waitcnt vmcnt(0)
Zvva 180,160,0
Mvva 180,164,16
Mvva 180,168,32
Mvva 180,172,48
s_nop 15
v_sub_f32 v176, v176, v188
v_exp_f32 v176, v176
v_sub_f32 v177, v177, v188
v_exp_f32 v177, v177
v_sub_f32 v178, v178, v188
v_exp_f32 v178, v178
v_sub_f32 v179, v179, v188
v_exp_f32 v179, v179
v_sub_f32 v180, v180, v188
v_exp_f32 v180, v180
v_sub_f32 v181, v181, v188
v_exp_f32 v181, v181
v_sub_f32 v182, v182, v188
v_exp_f32 v182, v182
v_sub_f32 v183, v183, v188
v_exp_f32 v183, v183
s_nop 1
v_cvt_pk_bf16_f32 v184, v176, v177
v_cvt_pk_bf16_f32 v185, v178, v179
v_cvt_pk_bf16_f32 v186, v180, v181
v_cvt_pk_bf16_f32 v187, v182, v183
s_nop 1
Maav 128,144,184
buffer_load_ushort v160, v190, s[24:27], s79 offen offset:0
buffer_load_ushort v161, v190, s[24:27], s79 offen offset:256
buffer_load_ushort v162, v190, s[24:27], s79 offen offset:512
buffer_load_ushort v163, v190, s[24:27], s79 offen offset:768
buffer_load_ushort v164, v190, s[24:27], s80 offen offset:0
buffer_load_ushort v165, v190, s[24:27], s80 offen offset:256
buffer_load_ushort v166, v190, s[24:27], s80 offen offset:512
buffer_load_ushort v167, v190, s[24:27], s80 offen offset:768
s_waitcnt vmcnt(0)
v_lshl_or_b32 v168, v161, 16, v160
v_lshl_or_b32 v169, v163, 16, v162
v_lshl_or_b32 v170, v165, 16, v164
v_lshl_or_b32 v171, v167, 16, v166
s_nop 1
Mvvv 32,168,184
s_nop 7
buffer_load_ushort v160, v190, s[24:27], s79 offen offset:32
buffer_load_ushort v161, v190, s[24:27], s79 offen offset:288
buffer_load_ushort v162, v190, s[24:27], s79 offen offset:544
buffer_load_ushort v163, v190, s[24:27], s79 offen offset:800
buffer_load_ushort v164, v190, s[24:27], s80 offen offset:32
buffer_load_ushort v165, v190, s[24:27], s80 offen offset:288
buffer_load_ushort v166, v190, s[24:27], s80 offen offset:544
buffer_load_ushort v167, v190, s[24:27], s80 offen offset:800
s_waitcnt vmcnt(0)
v_lshl_or_b32 v168, v161, 16, v160
v_lshl_or_b32 v169, v163, 16, v162
v_lshl_or_b32 v170, v165, 16, v164
v_lshl_or_b32 v171, v167, 16, v166
s_nop 1
Mvvv 36,168,184
s_nop 7
buffer_load_ushort v160, v190, s[24:27], s79 offen offset:64
buffer_load_ushort v161, v190, s[24:27], s79 offen offset:320
buffer_load_ushort v162, v190, s[24:27], s79 offen offset:576
buffer_load_ushort v163, v190, s[24:27], s79 offen offset:832
buffer_load_ushort v164, v190, s[24:27], s80 offen offset:64
buffer_load_ushort v165, v190, s[24:27], s80 offen offset:320
buffer_load_ushort v166, v190, s[24:27], s80 offen offset:576
buffer_load_ushort v167, v190, s[24:27], s80 offen offset:832
s_waitcnt vmcnt(0)
v_lshl_or_b32 v168, v161, 16, v160
v_lshl_or_b32 v169, v163, 16, v162
v_lshl_or_b32 v170, v165, 16, v164
v_lshl_or_b32 v171, v167, 16, v166
s_nop 1
Mvvv 40,168,184
s_nop 7
buffer_load_ushort v160, v190, s[24:27], s79 offen offset:96
buffer_load_ushort v161, v190, s[24:27], s79 offen offset:352
buffer_load_ushort v162, v190, s[24:27], s79 offen offset:608
buffer_load_ushort v163, v190, s[24:27], s79 offen offset:864
buffer_load_ushort v164, v190, s[24:27], s80 offen offset:96
buffer_load_ushort v165, v190, s[24:27], s80 offen offset:352
buffer_load_ushort v166, v190, s[24:27], s80 offen offset:608
buffer_load_ushort v167, v190, s[24:27], s80 offen offset:864
s_waitcnt vmcnt(0)
v_lshl_or_b32 v168, v161, 16, v160
v_lshl_or_b32 v169, v163, 16, v162
v_lshl_or_b32 v170, v165, 16, v164
v_lshl_or_b32 v171, v167, 16, v166
s_nop 1
Mvvv 44,168,184
s_nop 7
buffer_load_ushort v160, v190, s[24:27], s79 offen offset:128
buffer_load_ushort v161, v190, s[24:27], s79 offen offset:384
buffer_load_ushort v162, v190, s[24:27], s79 offen offset:640
buffer_load_ushort v163, v190, s[24:27], s79 offen offset:896
buffer_load_ushort v164, v190, s[24:27], s80 offen offset:128
buffer_load_ushort v165, v190, s[24:27], s80 offen offset:384
buffer_load_ushort v166, v190, s[24:27], s80 offen offset:640
buffer_load_ushort v167, v190, s[24:27], s80 offen offset:896
s_waitcnt vmcnt(0)
v_lshl_or_b32 v168, v161, 16, v160
v_lshl_or_b32 v169, v163, 16, v162
v_lshl_or_b32 v170, v165, 16, v164
v_lshl_or_b32 v171, v167, 16, v166
s_nop 1
Mvvv 48,168,184
s_nop 7
buffer_load_ushort v160, v190, s[24:27], s79 offen offset:160
buffer_load_ushort v161, v190, s[24:27], s79 offen offset:416
buffer_load_ushort v162, v190, s[24:27], s79 offen offset:672
buffer_load_ushort v163, v190, s[24:27], s79 offen offset:928
buffer_load_ushort v164, v190, s[24:27], s80 offen offset:160
buffer_load_ushort v165, v190, s[24:27], s80 offen offset:416
buffer_load_ushort v166, v190, s[24:27], s80 offen offset:672
buffer_load_ushort v167, v190, s[24:27], s80 offen offset:928
s_waitcnt vmcnt(0)
v_lshl_or_b32 v168, v161, 16, v160
v_lshl_or_b32 v169, v163, 16, v162
v_lshl_or_b32 v170, v165, 16, v164
v_lshl_or_b32 v171, v167, 16, v166
s_nop 1
Mvvv 52,168,184
s_nop 7
buffer_load_ushort v160, v190, s[24:27], s79 offen offset:192
buffer_load_ushort v161, v190, s[24:27], s79 offen offset:448
buffer_load_ushort v162, v190, s[24:27], s79 offen offset:704
buffer_load_ushort v163, v190, s[24:27], s79 offen offset:960
buffer_load_ushort v164, v190, s[24:27], s80 offen offset:192
buffer_load_ushort v165, v190, s[24:27], s80 offen offset:448
buffer_load_ushort v166, v190, s[24:27], s80 offen offset:704
buffer_load_ushort v167, v190, s[24:27], s80 offen offset:960
s_waitcnt vmcnt(0)
v_lshl_or_b32 v168, v161, 16, v160
v_lshl_or_b32 v169, v163, 16, v162
v_lshl_or_b32 v170, v165, 16, v164
v_lshl_or_b32 v171, v167, 16, v166
s_nop 1
Mvvv 56,168,184
s_nop 7
buffer_load_ushort v160, v190, s[24:27], s79 offen offset:224
buffer_load_ushort v161, v190, s[24:27], s79 offen offset:480
buffer_load_ushort v162, v190, s[24:27], s79 offen offset:736
buffer_load_ushort v163, v190, s[24:27], s79 offen offset:992
buffer_load_ushort v164, v190, s[24:27], s80 offen offset:224
buffer_load_ushort v165, v190, s[24:27], s80 offen offset:480
buffer_load_ushort v166, v190, s[24:27], s80 offen offset:736
buffer_load_ushort v167, v190, s[24:27], s80 offen offset:992
s_waitcnt vmcnt(0)
v_lshl_or_b32 v168, v161, 16, v160
v_lshl_or_b32 v169, v163, 16, v162
v_lshl_or_b32 v170, v165, 16, v164
v_lshl_or_b32 v171, v167, 16, v166
s_nop 1
Mvvv 60,168,184
s_nop 7
s_nop 15
s_add_u32 s79, s79, 0x2000
s_sub_u32 s83, s83, 1
s_cmp_lg_u32 s83, 0
s_cbranch_scc1 L_sp_1_0
v_mov_b32 v188, 0xff800000
s_add_u32 s79, s84, 0x80000
s_mov_b32 s83, 32
L_sm_1_1:
buffer_load_dwordx4 v[160:163], v189, s[20:23], s79 offen offset:0
buffer_load_dwordx4 v[164:167], v189, s[20:23], s79 offen offset:64
buffer_load_dwordx4 v[168:171], v189, s[20:23], s79 offen offset:128
buffer_load_dwordx4 v[172:175], v189, s[20:23], s79 offen offset:192
s_waitcnt vmcnt(0)
Zvva 176,160,4
Mvva 176,164,20
Mvva 176,168,36
Mvva 176,172,52
s_nop 15
v_max3_f32 v188, v188, v176, v177
v_max3_f32 v188, v188, v178, v179
s_add_u32 s79, s79, 0x1000
s_sub_u32 s83, s83, 1
s_cmp_lg_u32 s83, 0
s_cbranch_scc1 L_sm_1_1
v_mov_b32 v191, v188
s_nop 1
v_permlane32_swap_b32 v188, v191
s_nop 1
v_max_f32 v188, v188, v191
v_mov_b32 v191, v188
s_nop 1
v_permlane16_swap_b32 v188, v191
s_nop 1
v_max_f32 v188, v188, v191
v_mov_b32 v64, 0
v_mov_b32 v65, 0
v_mov_b32 v66, 0
v_mov_b32 v67, 0
v_mov_b32 v68, 0
v_mov_b32 v69, 0
v_mov_b32 v70, 0
v_mov_b32 v71, 0
v_mov_b32 v72, 0
v_mov_b32 v73, 0
v_mov_b32 v74, 0
v_mov_b32 v75, 0
v_mov_b32 v76, 0
v_mov_b32 v77, 0
v_mov_b32 v78, 0
v_mov_b32 v79, 0
v_mov_b32 v80, 0
v_mov_b32 v81, 0
v_mov_b32 v82, 0
v_mov_b32 v83, 0
v_mov_b32 v84, 0
v_mov_b32 v85, 0
v_mov_b32 v86, 0
v_mov_b32 v87, 0
v_mov_b32 v88, 0
v_mov_b32 v89, 0
v_mov_b32 v90, 0
v_mov_b32 v91, 0
v_mov_b32 v92, 0
v_mov_b32 v93, 0
v_mov_b32 v94, 0
v_mov_b32 v95, 0
v_accvgpr_write_b32 a132, 0
v_accvgpr_write_b32 a133, 0
v_accvgpr_write_b32 a134, 0
v_accvgpr_write_b32 a135, 0
s_add_u32 s79, s84, 0x80000
s_mov_b32 s83, 16
L_sp_1_1:
s_add_u32 s80, s79, 0x1000
buffer_load_dwordx4 v[160:163], v189, s[20:23], s79 offen offset:0
buffer_load_dwordx4 v[164:167], v189, s[20:23], s79 offen offset:64
buffer_load_dwordx4 v[168:171], v189, s[20:23], s79 offen offset:128
buffer_load_dwordx4 v[172:175], v189, s[20:23], s79 offen offset:192
s_waitcnt vmcnt(0)
Zvva 176,160,4
Mvva 176,164,20
Mvva 176,168,36
Mvva 176,172,52
s_nop 15
buffer_load_dwordx4 v[160:163], v189, s[20:23], s80 offen offset:0
buffer_load_dwordx4 v[164:167], v189, s[20:23], s80 offen offset:64
buffer_load_dwordx4 v[168:171], v189, s[20:23], s80 offen offset:128
buffer_load_dwordx4 v[172:175], v189, s[20:23], s80 offen offset:192
s_waitcnt vmcnt(0)
Zvva 180,160,4
Mvva 180,164,20
Mvva 180,168,36
Mvva 180,172,52
s_nop 15
v_sub_f32 v176, v176, v188
v_exp_f32 v176, v176
v_sub_f32 v177, v177, v188
v_exp_f32 v177, v177
v_sub_f32 v178, v178, v188
v_exp_f32 v178, v178
v_sub_f32 v179, v179, v188
v_exp_f32 v179, v179
v_sub_f32 v180, v180, v188
v_exp_f32 v180, v180
v_sub_f32 v181, v181, v188
v_exp_f32 v181, v181
v_sub_f32 v182, v182, v188
v_exp_f32 v182, v182
v_sub_f32 v183, v183, v188
v_exp_f32 v183, v183
s_nop 1
v_cvt_pk_bf16_f32 v184, v176, v177
v_cvt_pk_bf16_f32 v185, v178, v179
v_cvt_pk_bf16_f32 v186, v180, v181
v_cvt_pk_bf16_f32 v187, v182, v183
s_nop 1
Maav 132,144,184
buffer_load_ushort v160, v190, s[24:27], s79 offen offset:0
buffer_load_ushort v161, v190, s[24:27], s79 offen offset:256
buffer_load_ushort v162, v190, s[24:27], s79 offen offset:512
buffer_load_ushort v163, v190, s[24:27], s79 offen offset:768
buffer_load_ushort v164, v190, s[24:27], s80 offen offset:0
buffer_load_ushort v165, v190, s[24:27], s80 offen offset:256
buffer_load_ushort v166, v190, s[24:27], s80 offen offset:512
buffer_load_ushort v167, v190, s[24:27], s80 offen offset:768
s_waitcnt vmcnt(0)
v_lshl_or_b32 v168, v161, 16, v160
v_lshl_or_b32 v169, v163, 16, v162
v_lshl_or_b32 v170, v165, 16, v164
v_lshl_or_b32 v171, v167, 16, v166
s_nop 1
Mvvv 64,168,184
s_nop 7
buffer_load_ushort v160, v190, s[24:27], s79 offen offset:32
buffer_load_ushort v161, v190, s[24:27], s79 offen offset:288
buffer_load_ushort v162, v190, s[24:27], s79 offen offset:544
buffer_load_ushort v163, v190, s[24:27], s79 offen offset:800
buffer_load_ushort v164, v190, s[24:27], s80 offen offset:32
buffer_load_ushort v165, v190, s[24:27], s80 offen offset:288
buffer_load_ushort v166, v190, s[24:27], s80 offen offset:544
buffer_load_ushort v167, v190, s[24:27], s80 offen offset:800
s_waitcnt vmcnt(0)
v_lshl_or_b32 v168, v161, 16, v160
v_lshl_or_b32 v169, v163, 16, v162
v_lshl_or_b32 v170, v165, 16, v164
v_lshl_or_b32 v171, v167, 16, v166
s_nop 1
Mvvv 68,168,184
s_nop 7
buffer_load_ushort v160, v190, s[24:27], s79 offen offset:64
buffer_load_ushort v161, v190, s[24:27], s79 offen offset:320
buffer_load_ushort v162, v190, s[24:27], s79 offen offset:576
buffer_load_ushort v163, v190, s[24:27], s79 offen offset:832
buffer_load_ushort v164, v190, s[24:27], s80 offen offset:64
buffer_load_ushort v165, v190, s[24:27], s80 offen offset:320
buffer_load_ushort v166, v190, s[24:27], s80 offen offset:576
buffer_load_ushort v167, v190, s[24:27], s80 offen offset:832
s_waitcnt vmcnt(0)
v_lshl_or_b32 v168, v161, 16, v160
v_lshl_or_b32 v169, v163, 16, v162
v_lshl_or_b32 v170, v165, 16, v164
v_lshl_or_b32 v171, v167, 16, v166
s_nop 1
Mvvv 72,168,184
s_nop 7
buffer_load_ushort v160, v190, s[24:27], s79 offen offset:96
buffer_load_ushort v161, v190, s[24:27], s79 offen offset:352
buffer_load_ushort v162, v190, s[24:27], s79 offen offset:608
buffer_load_ushort v163, v190, s[24:27], s79 offen offset:864
buffer_load_ushort v164, v190, s[24:27], s80 offen offset:96
buffer_load_ushort v165, v190, s[24:27], s80 offen offset:352
buffer_load_ushort v166, v190, s[24:27], s80 offen offset:608
buffer_load_ushort v167, v190, s[24:27], s80 offen offset:864
s_waitcnt vmcnt(0)
v_lshl_or_b32 v168, v161, 16, v160
v_lshl_or_b32 v169, v163, 16, v162
v_lshl_or_b32 v170, v165, 16, v164
v_lshl_or_b32 v171, v167, 16, v166
s_nop 1
Mvvv 76,168,184
s_nop 7
buffer_load_ushort v160, v190, s[24:27], s79 offen offset:128
buffer_load_ushort v161, v190, s[24:27], s79 offen offset:384
buffer_load_ushort v162, v190, s[24:27], s79 offen offset:640
buffer_load_ushort v163, v190, s[24:27], s79 offen offset:896
buffer_load_ushort v164, v190, s[24:27], s80 offen offset:128
buffer_load_ushort v165, v190, s[24:27], s80 offen offset:384
buffer_load_ushort v166, v190, s[24:27], s80 offen offset:640
buffer_load_ushort v167, v190, s[24:27], s80 offen offset:896
s_waitcnt vmcnt(0)
v_lshl_or_b32 v168, v161, 16, v160
v_lshl_or_b32 v169, v163, 16, v162
v_lshl_or_b32 v170, v165, 16, v164
v_lshl_or_b32 v171, v167, 16, v166
s_nop 1
Mvvv 80,168,184
s_nop 7
buffer_load_ushort v160, v190, s[24:27], s79 offen offset:160
buffer_load_ushort v161, v190, s[24:27], s79 offen offset:416
buffer_load_ushort v162, v190, s[24:27], s79 offen offset:672
buffer_load_ushort v163, v190, s[24:27], s79 offen offset:928
buffer_load_ushort v164, v190, s[24:27], s80 offen offset:160
buffer_load_ushort v165, v190, s[24:27], s80 offen offset:416
buffer_load_ushort v166, v190, s[24:27], s80 offen offset:672
buffer_load_ushort v167, v190, s[24:27], s80 offen offset:928
s_waitcnt vmcnt(0)
v_lshl_or_b32 v168, v161, 16, v160
v_lshl_or_b32 v169, v163, 16, v162
v_lshl_or_b32 v170, v165, 16, v164
v_lshl_or_b32 v171, v167, 16, v166
s_nop 1
Mvvv 84,168,184
s_nop 7
buffer_load_ushort v160, v190, s[24:27], s79 offen offset:192
buffer_load_ushort v161, v190, s[24:27], s79 offen offset:448
buffer_load_ushort v162, v190, s[24:27], s79 offen offset:704
buffer_load_ushort v163, v190, s[24:27], s79 offen offset:960
buffer_load_ushort v164, v190, s[24:27], s80 offen offset:192
buffer_load_ushort v165, v190, s[24:27], s80 offen offset:448
buffer_load_ushort v166, v190, s[24:27], s80 offen offset:704
buffer_load_ushort v167, v190, s[24:27], s80 offen offset:960
s_waitcnt vmcnt(0)
v_lshl_or_b32 v168, v161, 16, v160
v_lshl_or_b32 v169, v163, 16, v162
v_lshl_or_b32 v170, v165, 16, v164
v_lshl_or_b32 v171, v167, 16, v166
s_nop 1
Mvvv 88,168,184
s_nop 7
buffer_load_ushort v160, v190, s[24:27], s79 offen offset:224
buffer_load_ushort v161, v190, s[24:27], s79 offen offset:480
buffer_load_ushort v162, v190, s[24:27], s79 offen offset:736
buffer_load_ushort v163, v190, s[24:27], s79 offen offset:992
buffer_load_ushort v164, v190, s[24:27], s80 offen offset:224
buffer_load_ushort v165, v190, s[24:27], s80 offen offset:480
buffer_load_ushort v166, v190, s[24:27], s80 offen offset:736
buffer_load_ushort v167, v190, s[24:27], s80 offen offset:992
s_waitcnt vmcnt(0)
v_lshl_or_b32 v168, v161, 16, v160
v_lshl_or_b32 v169, v163, 16, v162
v_lshl_or_b32 v170, v165, 16, v164
v_lshl_or_b32 v171, v167, 16, v166
s_nop 1
Mvvv 92,168,184
s_nop 7
s_nop 15
s_add_u32 s79, s79, 0x2000
s_sub_u32 s83, s83, 1
s_cmp_lg_u32 s83, 0
s_cbranch_scc1 L_sp_1_1
v_mov_b32 v188, 0xff800000
s_add_u32 s79, s84, 0x80000
s_mov_b32 s83, 32
L_sm_1_2:
buffer_load_dwordx4 v[160:163], v189, s[20:23], s79 offen offset:0
buffer_load_dwordx4 v[164:167], v189, s[20:23], s79 offen offset:64
buffer_load_dwordx4 v[168:171], v189, s[20:23], s79 offen offset:128
buffer_load_dwordx4 v[172:175], v189, s[20:23], s79 offen offset:192
s_waitcnt vmcnt(0)
Zvva 176,160,64
Mvva 176,164,80
Mvva 176,168,96
Mvva 176,172,112
s_nop 15
v_max3_f32 v188, v188, v176, v177
v_max3_f32 v188, v188, v178, v179
s_add_u32 s79, s79, 0x1000
s_sub_u32 s83, s83, 1
s_cmp_lg_u32 s83, 0
s_cbranch_scc1 L_sm_1_2
v_mov_b32 v191, v188
s_nop 1
v_permlane32_swap_b32 v188, v191
s_nop 1
v_max_f32 v188, v188, v191
v_mov_b32 v191, v188
s_nop 1
v_permlane16_swap_b32 v188, v191
s_nop 1
v_max_f32 v188, v188, v191
v_mov_b32 v96, 0
v_mov_b32 v97, 0
v_mov_b32 v98, 0
v_mov_b32 v99, 0
v_mov_b32 v100, 0
v_mov_b32 v101, 0
v_mov_b32 v102, 0
v_mov_b32 v103, 0
v_mov_b32 v104, 0
v_mov_b32 v105, 0
v_mov_b32 v106, 0
v_mov_b32 v107, 0
v_mov_b32 v108, 0
v_mov_b32 v109, 0
v_mov_b32 v110, 0
v_mov_b32 v111, 0
v_mov_b32 v112, 0
v_mov_b32 v113, 0
v_mov_b32 v114, 0
v_mov_b32 v115, 0
v_mov_b32 v116, 0
v_mov_b32 v117, 0
v_mov_b32 v118, 0
v_mov_b32 v119, 0
v_mov_b32 v120, 0
v_mov_b32 v121, 0
v_mov_b32 v122, 0
v_mov_b32 v123, 0
v_mov_b32 v124, 0
v_mov_b32 v125, 0
v_mov_b32 v126, 0
v_mov_b32 v127, 0
v_accvgpr_write_b32 a136, 0
v_accvgpr_write_b32 a137, 0
v_accvgpr_write_b32 a138, 0
v_accvgpr_write_b32 a139, 0
s_add_u32 s79, s84, 0x80000
s_mov_b32 s83, 16
L_sp_1_2:
s_add_u32 s80, s79, 0x1000
buffer_load_dwordx4 v[160:163], v189, s[20:23], s79 offen offset:0
buffer_load_dwordx4 v[164:167], v189, s[20:23], s79 offen offset:64
buffer_load_dwordx4 v[168:171], v189, s[20:23], s79 offen offset:128
buffer_load_dwordx4 v[172:175], v189, s[20:23], s79 offen offset:192
s_waitcnt vmcnt(0)
Zvva 176,160,64
Mvva 176,164,80
Mvva 176,168,96
Mvva 176,172,112
s_nop 15
buffer_load_dwordx4 v[160:163], v189, s[20:23], s80 offen offset:0
buffer_load_dwordx4 v[164:167], v189, s[20:23], s80 offen offset:64
buffer_load_dwordx4 v[168:171], v189, s[20:23], s80 offen offset:128
buffer_load_dwordx4 v[172:175], v189, s[20:23], s80 offen offset:192
s_waitcnt vmcnt(0)
Zvva 180,160,64
Mvva 180,164,80
Mvva 180,168,96
Mvva 180,172,112
s_nop 15
v_sub_f32 v176, v176, v188
v_exp_f32 v176, v176
v_sub_f32 v177, v177, v188
v_exp_f32 v177, v177
v_sub_f32 v178, v178, v188
v_exp_f32 v178, v178
v_sub_f32 v179, v179, v188
v_exp_f32 v179, v179
v_sub_f32 v180, v180, v188
v_exp_f32 v180, v180
v_sub_f32 v181, v181, v188
v_exp_f32 v181, v181
v_sub_f32 v182, v182, v188
v_exp_f32 v182, v182
v_sub_f32 v183, v183, v188
v_exp_f32 v183, v183
s_nop 1
v_cvt_pk_bf16_f32 v184, v176, v177
v_cvt_pk_bf16_f32 v185, v178, v179
v_cvt_pk_bf16_f32 v186, v180, v181
v_cvt_pk_bf16_f32 v187, v182, v183
s_nop 1
Maav 136,144,184
buffer_load_ushort v160, v190, s[24:27], s79 offen offset:0
buffer_load_ushort v161, v190, s[24:27], s79 offen offset:256
buffer_load_ushort v162, v190, s[24:27], s79 offen offset:512
buffer_load_ushort v163, v190, s[24:27], s79 offen offset:768
buffer_load_ushort v164, v190, s[24:27], s80 offen offset:0
buffer_load_ushort v165, v190, s[24:27], s80 offen offset:256
buffer_load_ushort v166, v190, s[24:27], s80 offen offset:512
buffer_load_ushort v167, v190, s[24:27], s80 offen offset:768
s_waitcnt vmcnt(0)
v_lshl_or_b32 v168, v161, 16, v160
v_lshl_or_b32 v169, v163, 16, v162
v_lshl_or_b32 v170, v165, 16, v164
v_lshl_or_b32 v171, v167, 16, v166
s_nop 1
Mvvv 96,168,184
s_nop 7
buffer_load_ushort v160, v190, s[24:27], s79 offen offset:32
buffer_load_ushort v161, v190, s[24:27], s79 offen offset:288
buffer_load_ushort v162, v190, s[24:27], s79 offen offset:544
buffer_load_ushort v163, v190, s[24:27], s79 offen offset:800
buffer_load_ushort v164, v190, s[24:27], s80 offen offset:32
buffer_load_ushort v165, v190, s[24:27], s80 offen offset:288
buffer_load_ushort v166, v190, s[24:27], s80 offen offset:544
buffer_load_ushort v167, v190, s[24:27], s80 offen offset:800
s_waitcnt vmcnt(0)
v_lshl_or_b32 v168, v161, 16, v160
v_lshl_or_b32 v169, v163, 16, v162
v_lshl_or_b32 v170, v165, 16, v164
v_lshl_or_b32 v171, v167, 16, v166
s_nop 1
Mvvv 100,168,184
s_nop 7
buffer_load_ushort v160, v190, s[24:27], s79 offen offset:64
buffer_load_ushort v161, v190, s[24:27], s79 offen offset:320
buffer_load_ushort v162, v190, s[24:27], s79 offen offset:576
buffer_load_ushort v163, v190, s[24:27], s79 offen offset:832
buffer_load_ushort v164, v190, s[24:27], s80 offen offset:64
buffer_load_ushort v165, v190, s[24:27], s80 offen offset:320
buffer_load_ushort v166, v190, s[24:27], s80 offen offset:576
buffer_load_ushort v167, v190, s[24:27], s80 offen offset:832
s_waitcnt vmcnt(0)
v_lshl_or_b32 v168, v161, 16, v160
v_lshl_or_b32 v169, v163, 16, v162
v_lshl_or_b32 v170, v165, 16, v164
v_lshl_or_b32 v171, v167, 16, v166
s_nop 1
Mvvv 104,168,184
s_nop 7
buffer_load_ushort v160, v190, s[24:27], s79 offen offset:96
buffer_load_ushort v161, v190, s[24:27], s79 offen offset:352
buffer_load_ushort v162, v190, s[24:27], s79 offen offset:608
buffer_load_ushort v163, v190, s[24:27], s79 offen offset:864
buffer_load_ushort v164, v190, s[24:27], s80 offen offset:96
buffer_load_ushort v165, v190, s[24:27], s80 offen offset:352
buffer_load_ushort v166, v190, s[24:27], s80 offen offset:608
buffer_load_ushort v167, v190, s[24:27], s80 offen offset:864
s_waitcnt vmcnt(0)
v_lshl_or_b32 v168, v161, 16, v160
v_lshl_or_b32 v169, v163, 16, v162
v_lshl_or_b32 v170, v165, 16, v164
v_lshl_or_b32 v171, v167, 16, v166
s_nop 1
Mvvv 108,168,184
s_nop 7
buffer_load_ushort v160, v190, s[24:27], s79 offen offset:128
buffer_load_ushort v161, v190, s[24:27], s79 offen offset:384
buffer_load_ushort v162, v190, s[24:27], s79 offen offset:640
buffer_load_ushort v163, v190, s[24:27], s79 offen offset:896
buffer_load_ushort v164, v190, s[24:27], s80 offen offset:128
buffer_load_ushort v165, v190, s[24:27], s80 offen offset:384
buffer_load_ushort v166, v190, s[24:27], s80 offen offset:640
buffer_load_ushort v167, v190, s[24:27], s80 offen offset:896
s_waitcnt vmcnt(0)
v_lshl_or_b32 v168, v161, 16, v160
v_lshl_or_b32 v169, v163, 16, v162
v_lshl_or_b32 v170, v165, 16, v164
v_lshl_or_b32 v171, v167, 16, v166
s_nop 1
Mvvv 112,168,184
s_nop 7
buffer_load_ushort v160, v190, s[24:27], s79 offen offset:160
buffer_load_ushort v161, v190, s[24:27], s79 offen offset:416
buffer_load_ushort v162, v190, s[24:27], s79 offen offset:672
buffer_load_ushort v163, v190, s[24:27], s79 offen offset:928
buffer_load_ushort v164, v190, s[24:27], s80 offen offset:160
buffer_load_ushort v165, v190, s[24:27], s80 offen offset:416
buffer_load_ushort v166, v190, s[24:27], s80 offen offset:672
buffer_load_ushort v167, v190, s[24:27], s80 offen offset:928
s_waitcnt vmcnt(0)
v_lshl_or_b32 v168, v161, 16, v160
v_lshl_or_b32 v169, v163, 16, v162
v_lshl_or_b32 v170, v165, 16, v164
v_lshl_or_b32 v171, v167, 16, v166
s_nop 1
Mvvv 116,168,184
s_nop 7
buffer_load_ushort v160, v190, s[24:27], s79 offen offset:192
buffer_load_ushort v161, v190, s[24:27], s79 offen offset:448
buffer_load_ushort v162, v190, s[24:27], s79 offen offset:704
buffer_load_ushort v163, v190, s[24:27], s79 offen offset:960
buffer_load_ushort v164, v190, s[24:27], s80 offen offset:192
buffer_load_ushort v165, v190, s[24:27], s80 offen offset:448
buffer_load_ushort v166, v190, s[24:27], s80 offen offset:704
buffer_load_ushort v167, v190, s[24:27], s80 offen offset:960
s_waitcnt vmcnt(0)
v_lshl_or_b32 v168, v161, 16, v160
v_lshl_or_b32 v169, v163, 16, v162
v_lshl_or_b32 v170, v165, 16, v164
v_lshl_or_b32 v171, v167, 16, v166
s_nop 1
Mvvv 120,168,184
s_nop 7
buffer_load_ushort v160, v190, s[24:27], s79 offen offset:224
buffer_load_ushort v161, v190, s[24:27], s79 offen offset:480
buffer_load_ushort v162, v190, s[24:27], s79 offen offset:736
buffer_load_ushort v163, v190, s[24:27], s79 offen offset:992
buffer_load_ushort v164, v190, s[24:27], s80 offen offset:224
buffer_load_ushort v165, v190, s[24:27], s80 offen offset:480
buffer_load_ushort v166, v190, s[24:27], s80 offen offset:736
buffer_load_ushort v167, v190, s[24:27], s80 offen offset:992
s_waitcnt vmcnt(0)
v_lshl_or_b32 v168, v161, 16, v160
v_lshl_or_b32 v169, v163, 16, v162
v_lshl_or_b32 v170, v165, 16, v164
v_lshl_or_b32 v171, v167, 16, v166
s_nop 1
Mvvv 124,168,184
s_nop 7
s_nop 15
s_add_u32 s79, s79, 0x2000
s_sub_u32 s83, s83, 1
s_cmp_lg_u32 s83, 0
s_cbranch_scc1 L_sp_1_2
v_mov_b32 v188, 0xff800000
s_add_u32 s79, s84, 0x80000
s_mov_b32 s83, 32
L_sm_1_3:
buffer_load_dwordx4 v[160:163], v189, s[20:23], s79 offen offset:0
buffer_load_dwordx4 v[164:167], v189, s[20:23], s79 offen offset:64
buffer_load_dwordx4 v[168:171], v189, s[20:23], s79 offen offset:128
buffer_load_dwordx4 v[172:175], v189, s[20:23], s79 offen offset:192
s_waitcnt vmcnt(0)
Zvva 176,160,68
Mvva 176,164,84
Mvva 176,168,100
Mvva 176,172,116
s_nop 15
v_max3_f32 v188, v188, v176, v177
v_max3_f32 v188, v188, v178, v179
s_add_u32 s79, s79, 0x1000
s_sub_u32 s83, s83, 1
s_cmp_lg_u32 s83, 0
s_cbranch_scc1 L_sm_1_3
v_mov_b32 v191, v188
s_nop 1
v_permlane32_swap_b32 v188, v191
s_nop 1
v_max_f32 v188, v188, v191
v_mov_b32 v191, v188
s_nop 1
v_permlane16_swap_b32 v188, v191
s_nop 1
v_max_f32 v188, v188, v191
v_mov_b32 v128, 0
v_mov_b32 v129, 0
v_mov_b32 v130, 0
v_mov_b32 v131, 0
v_mov_b32 v132, 0
v_mov_b32 v133, 0
v_mov_b32 v134, 0
v_mov_b32 v135, 0
v_mov_b32 v136, 0
v_mov_b32 v137, 0
v_mov_b32 v138, 0
v_mov_b32 v139, 0
v_mov_b32 v140, 0
v_mov_b32 v141, 0
v_mov_b32 v142, 0
v_mov_b32 v143, 0
v_mov_b32 v144, 0
v_mov_b32 v145, 0
v_mov_b32 v146, 0
v_mov_b32 v147, 0
v_mov_b32 v148, 0
v_mov_b32 v149, 0
v_mov_b32 v150, 0
v_mov_b32 v151, 0
v_mov_b32 v152, 0
v_mov_b32 v153, 0
v_mov_b32 v154, 0
v_mov_b32 v155, 0
v_mov_b32 v156, 0
v_mov_b32 v157, 0
v_mov_b32 v158, 0
v_mov_b32 v159, 0
v_accvgpr_write_b32 a140, 0
v_accvgpr_write_b32 a141, 0
v_accvgpr_write_b32 a142, 0
v_accvgpr_write_b32 a143, 0
s_add_u32 s79, s84, 0x80000
s_mov_b32 s83, 16
L_sp_1_3:
s_add_u32 s80, s79, 0x1000
buffer_load_dwordx4 v[160:163], v189, s[20:23], s79 offen offset:0
buffer_load_dwordx4 v[164:167], v189, s[20:23], s79 offen offset:64
buffer_load_dwordx4 v[168:171], v189, s[20:23], s79 offen offset:128
buffer_load_dwordx4 v[172:175], v189, s[20:23], s79 offen offset:192
s_waitcnt vmcnt(0)
Zvva 176,160,68
Mvva 176,164,84
Mvva 176,168,100
Mvva 176,172,116
s_nop 15
buffer_load_dwordx4 v[160:163], v189, s[20:23], s80 offen offset:0
buffer_load_dwordx4 v[164:167], v189, s[20:23], s80 offen offset:64
buffer_load_dwordx4 v[168:171], v189, s[20:23], s80 offen offset:128
buffer_load_dwordx4 v[172:175], v189, s[20:23], s80 offen offset:192
s_waitcnt vmcnt(0)
Zvva 180,160,68
Mvva 180,164,84
Mvva 180,168,100
Mvva 180,172,116
s_nop 15
v_sub_f32 v176, v176, v188
v_exp_f32 v176, v176
v_sub_f32 v177, v177, v188
v_exp_f32 v177, v177
v_sub_f32 v178, v178, v188
v_exp_f32 v178, v178
v_sub_f32 v179, v179, v188
v_exp_f32 v179, v179
v_sub_f32 v180, v180, v188
v_exp_f32 v180, v180
v_sub_f32 v181, v181, v188
v_exp_f32 v181, v181
v_sub_f32 v182, v182, v188
v_exp_f32 v182, v182
v_sub_f32 v183, v183, v188
v_exp_f32 v183, v183
s_nop 1
v_cvt_pk_bf16_f32 v184, v176, v177
v_cvt_pk_bf16_f32 v185, v178, v179
v_cvt_pk_bf16_f32 v186, v180, v181
v_cvt_pk_bf16_f32 v187, v182, v183
s_nop 1
Maav 140,144,184
buffer_load_ushort v160, v190, s[24:27], s79 offen offset:0
buffer_load_ushort v161, v190, s[24:27], s79 offen offset:256
buffer_load_ushort v162, v190, s[24:27], s79 offen offset:512
buffer_load_ushort v163, v190, s[24:27], s79 offen offset:768
buffer_load_ushort v164, v190, s[24:27], s80 offen offset:0
buffer_load_ushort v165, v190, s[24:27], s80 offen offset:256
buffer_load_ushort v166, v190, s[24:27], s80 offen offset:512
buffer_load_ushort v167, v190, s[24:27], s80 offen offset:768
s_waitcnt vmcnt(0)
v_lshl_or_b32 v168, v161, 16, v160
v_lshl_or_b32 v169, v163, 16, v162
v_lshl_or_b32 v170, v165, 16, v164
v_lshl_or_b32 v171, v167, 16, v166
s_nop 1
Mvvv 128,168,184
s_nop 7
buffer_load_ushort v160, v190, s[24:27], s79 offen offset:32
buffer_load_ushort v161, v190, s[24:27], s79 offen offset:288
buffer_load_ushort v162, v190, s[24:27], s79 offen offset:544
buffer_load_ushort v163, v190, s[24:27], s79 offen offset:800
buffer_load_ushort v164, v190, s[24:27], s80 offen offset:32
buffer_load_ushort v165, v190, s[24:27], s80 offen offset:288
buffer_load_ushort v166, v190, s[24:27], s80 offen offset:544
buffer_load_ushort v167, v190, s[24:27], s80 offen offset:800
s_waitcnt vmcnt(0)
v_lshl_or_b32 v168, v161, 16, v160
v_lshl_or_b32 v169, v163, 16, v162
v_lshl_or_b32 v170, v165, 16, v164
v_lshl_or_b32 v171, v167, 16, v166
s_nop 1
Mvvv 132,168,184
s_nop 7
buffer_load_ushort v160, v190, s[24:27], s79 offen offset:64
buffer_load_ushort v161, v190, s[24:27], s79 offen offset:320
buffer_load_ushort v162, v190, s[24:27], s79 offen offset:576
buffer_load_ushort v163, v190, s[24:27], s79 offen offset:832
buffer_load_ushort v164, v190, s[24:27], s80 offen offset:64
buffer_load_ushort v165, v190, s[24:27], s80 offen offset:320
buffer_load_ushort v166, v190, s[24:27], s80 offen offset:576
buffer_load_ushort v167, v190, s[24:27], s80 offen offset:832
s_waitcnt vmcnt(0)
v_lshl_or_b32 v168, v161, 16, v160
v_lshl_or_b32 v169, v163, 16, v162
v_lshl_or_b32 v170, v165, 16, v164
v_lshl_or_b32 v171, v167, 16, v166
s_nop 1
Mvvv 136,168,184
s_nop 7
buffer_load_ushort v160, v190, s[24:27], s79 offen offset:96
buffer_load_ushort v161, v190, s[24:27], s79 offen offset:352
buffer_load_ushort v162, v190, s[24:27], s79 offen offset:608
buffer_load_ushort v163, v190, s[24:27], s79 offen offset:864
buffer_load_ushort v164, v190, s[24:27], s80 offen offset:96
buffer_load_ushort v165, v190, s[24:27], s80 offen offset:352
buffer_load_ushort v166, v190, s[24:27], s80 offen offset:608
buffer_load_ushort v167, v190, s[24:27], s80 offen offset:864
s_waitcnt vmcnt(0)
v_lshl_or_b32 v168, v161, 16, v160
v_lshl_or_b32 v169, v163, 16, v162
v_lshl_or_b32 v170, v165, 16, v164
v_lshl_or_b32 v171, v167, 16, v166
s_nop 1
Mvvv 140,168,184
s_nop 7
buffer_load_ushort v160, v190, s[24:27], s79 offen offset:128
buffer_load_ushort v161, v190, s[24:27], s79 offen offset:384
buffer_load_ushort v162, v190, s[24:27], s79 offen offset:640
buffer_load_ushort v163, v190, s[24:27], s79 offen offset:896
buffer_load_ushort v164, v190, s[24:27], s80 offen offset:128
buffer_load_ushort v165, v190, s[24:27], s80 offen offset:384
buffer_load_ushort v166, v190, s[24:27], s80 offen offset:640
buffer_load_ushort v167, v190, s[24:27], s80 offen offset:896
s_waitcnt vmcnt(0)
v_lshl_or_b32 v168, v161, 16, v160
v_lshl_or_b32 v169, v163, 16, v162
v_lshl_or_b32 v170, v165, 16, v164
v_lshl_or_b32 v171, v167, 16, v166
s_nop 1
Mvvv 144,168,184
s_nop 7
buffer_load_ushort v160, v190, s[24:27], s79 offen offset:160
buffer_load_ushort v161, v190, s[24:27], s79 offen offset:416
buffer_load_ushort v162, v190, s[24:27], s79 offen offset:672
buffer_load_ushort v163, v190, s[24:27], s79 offen offset:928
buffer_load_ushort v164, v190, s[24:27], s80 offen offset:160
buffer_load_ushort v165, v190, s[24:27], s80 offen offset:416
buffer_load_ushort v166, v190, s[24:27], s80 offen offset:672
buffer_load_ushort v167, v190, s[24:27], s80 offen offset:928
s_waitcnt vmcnt(0)
v_lshl_or_b32 v168, v161, 16, v160
v_lshl_or_b32 v169, v163, 16, v162
v_lshl_or_b32 v170, v165, 16, v164
v_lshl_or_b32 v171, v167, 16, v166
s_nop 1
Mvvv 148,168,184
s_nop 7
buffer_load_ushort v160, v190, s[24:27], s79 offen offset:192
buffer_load_ushort v161, v190, s[24:27], s79 offen offset:448
buffer_load_ushort v162, v190, s[24:27], s79 offen offset:704
buffer_load_ushort v163, v190, s[24:27], s79 offen offset:960
buffer_load_ushort v164, v190, s[24:27], s80 offen offset:192
buffer_load_ushort v165, v190, s[24:27], s80 offen offset:448
buffer_load_ushort v166, v190, s[24:27], s80 offen offset:704
buffer_load_ushort v167, v190, s[24:27], s80 offen offset:960
s_waitcnt vmcnt(0)
v_lshl_or_b32 v168, v161, 16, v160
v_lshl_or_b32 v169, v163, 16, v162
v_lshl_or_b32 v170, v165, 16, v164
v_lshl_or_b32 v171, v167, 16, v166
s_nop 1
Mvvv 152,168,184
s_nop 7
buffer_load_ushort v160, v190, s[24:27], s79 offen offset:224
buffer_load_ushort v161, v190, s[24:27], s79 offen offset:480
buffer_load_ushort v162, v190, s[24:27], s79 offen offset:736
buffer_load_ushort v163, v190, s[24:27], s79 offen offset:992
buffer_load_ushort v164, v190, s[24:27], s80 offen offset:224
buffer_load_ushort v165, v190, s[24:27], s80 offen offset:480
buffer_load_ushort v166, v190, s[24:27], s80 offen offset:736
buffer_load_ushort v167, v190, s[24:27], s80 offen offset:992
s_waitcnt vmcnt(0)
v_lshl_or_b32 v168, v161, 16, v160
v_lshl_or_b32 v169, v163, 16, v162
v_lshl_or_b32 v170, v165, 16, v164
v_lshl_or_b32 v171, v167, 16, v166
s_nop 1
Mvvv 156,168,184
s_nop 7
s_nop 15
s_add_u32 s79, s79, 0x2000
s_sub_u32 s83, s83, 1
s_cmp_lg_u32 s83, 0
s_cbranch_scc1 L_sp_1_3
s_nop 15
s_branch L_back1
.p2align 6
L_ffn:
s_and_b32 s79, s3, 1
s_cmp_eq_u32 s79, 0
s_cselect_b32 s8, s68, s70
s_cselect_b32 s9, s69, s71
s_mov_b32 s10, 0x510000
s_mov_b32 s11, 0x20000
s_mov_b32 s12, s72
s_mov_b32 s13, s73
s_mov_b32 s14, 0x510000
s_mov_b32 s15, 0x20000
s_lshr_b32 s80, s3, 1
s_mul_i32 s36, s80, 0x48000
s_mul_i32 s45, s32, 0x480
s_add_u32 s36, s36, s45
s_mul_i32 s45, s32, 0xa2000
s_mul_i32 s39, s3, 0x9000
s_add_u32 s39, s39, s45
s_mul_i32 s41, s79, 0x9000
s_add_u32 s41, s41, s45
s_lshl_b32 s80, s80, 7
s_add_u32 s40, s41, s80
s_mov_b32 s49, 0xc09d30fc
v_lshrrev_b32 v244, 3, v1
v_bfe_u32 v245, v1, 1, 2
v_bfe_u32 v13, v1, 4, 1
v_xor_b32 v245, v245, v13
v_lshlrev_b32 v245, 5, v245
v_and_b32 v13, 1, v1
v_lshl_or_b32 v245, v13, 4, v245
v_mul_u32_u24 v244, 0x2400, v244
v_add_u32 v12, v244, v245
v_xor_b32 v13, 64, v12
v_add_u32 v13, 0x11c00, v13
v_add_u32 v14, 0x23800, v12
v_xor_b32 v15, 64, v12
v_add_u32 v15, 0x35400, v15
v_lshrrev_b32 v244, 4, v1
v_lshlrev_b32 v244, 10, v244
v_bfe_u32 v245, v1, 2, 2
v_lshl_or_b32 v244, v245, 7, v244
v_bfe_u32 v245, v1, 3, 2
v_lshl_or_b32 v244, v245, 5, v244
v_and_b32 v245, 3, v1
v_lshl_or_b32 v2, v245, 3, v244
v_xor_b32 v3, 32, v2
v_xor_b32 v4, 64, v2
v_xor_b32 v5, 0x60, v2
s_lshl_b32 s42, s34, 3
s_add_u32 s42, s42, s32
s_lshl_b32 s45, s33, 7
s_lshl_b32 s79, s42, 2
s_add_u32 s45, s45, s79
s_add_u32 s45, s45, 0xc800000
v_mov_b32 v246, 0x7ffffff0
v_mov_b32 v247, s45
v_cndmask_b32 v246, v246, v247, s[92:93]
v_mov_b32 v247, 0
buffer_store_dword v247, v246, s[28:31], 0 offen offset:0 sc1
s_mov_b32 s60, s88
s_mov_b32 s61, s89
s_mov_b32 s62, 0x240000
s_mov_b32 s63, 0x20000
s_mov_b32 s68, s90
s_mov_b32 s69, s91
s_mov_b32 s70, 0x100
s_mov_b32 s71, 0x20000
s_mov_b32 m0, s35
s_mov_b32 s44, s36
s_add_u32 s98, s8, s44
s_addc_u32 s99, s9, 0
GDMA 12,98,0
GDMA 13,98,1024
GDMA 14,98,2048
GDMA 15,98,3072
s_getpc_b64 s[54:55]
L_pc_L_ffn:
s_lshl_b32 s45, s86, 2
s_add_u32 s45, s45, s3
s_lshl_b32 s45, s45, 11
v_lshlrev_b32 v7, 5, v1
v_add_u32 v7, s45, v7
v_min_u32 v7, L_ffn_end-L_pc_L_ffn-4, v7
global_load_dword v255, v7, s[54:55]
v_mov_b32 v240, 0x3f803f80
v_mov_b32 v241, 0x3f803f80
v_mov_b32 v242, 0x3f803f80
v_mov_b32 v243, 0x3f803f80
s_nop 1
s_waitcnt vmcnt(41)
Zvvv 224,240,16
Zvvv 228,16,16
s_waitcnt vmcnt(40)
Zvvv 232,240,20
Zvvv 236,20,20
s_waitcnt vmcnt(39)
Mvvv 224,240,24
Mvvv 228,24,24
s_waitcnt vmcnt(38)
Mvvv 232,240,28
Mvvv 236,28,28
s_waitcnt vmcnt(37)
Mvvv 224,240,32
Mvvv 228,32,32
s_waitcnt vmcnt(36)
Mvvv 232,240,36
Mvvv 236,36,36
s_waitcnt vmcnt(35)
Mvvv 224,240,40
Mvvv 228,40,40
s_waitcnt vmcnt(34)
Mvvv 232,240,44
Mvvv 236,44,44
s_waitcnt vmcnt(33)
Mvvv 224,240,48
Mvvv 228,48,48
s_waitcnt vmcnt(32)
Mvvv 232,240,52
Mvvv 236,52,52
s_waitcnt vmcnt(31)
Mvvv 224,240,56
Mvvv 228,56,56
s_waitcnt vmcnt(30)
Mvvv 232,240,60
Mvvv 236,60,60
s_waitcnt vmcnt(29)
Mvvv 224,240,64
Mvvv 228,64,64
s_waitcnt vmcnt(28)
Mvvv 232,240,68
Mvvv 236,68,68
s_waitcnt vmcnt(27)
Mvvv 224,240,72
Mvvv 228,72,72
s_waitcnt vmcnt(26)
Mvvv 232,240,76
Mvvv 236,76,76
s_waitcnt vmcnt(25)
Mvvv 224,240,80
Mvvv 228,80,80
s_waitcnt vmcnt(24)
Mvvv 232,240,84
Mvvv 236,84,84
s_waitcnt vmcnt(23)
Mvvv 224,240,88
Mvvv 228,88,88
s_waitcnt vmcnt(22)
Mvvv 232,240,92
Mvvv 236,92,92
s_waitcnt vmcnt(21)
Mvvv 224,240,96
Mvvv 228,96,96
s_waitcnt vmcnt(20)
Mvvv 232,240,100
Mvvv 236,100,100
s_waitcnt vmcnt(19)
Mvvv 224,240,104
Mvvv 228,104,104
s_waitcnt vmcnt(18)
Mvvv 232,240,108
Mvvv 236,108,108
s_waitcnt vmcnt(17)
Mvvv 224,240,112
Mvvv 228,112,112
s_waitcnt vmcnt(16)
Mvvv 232,240,116
Mvvv 236,116,116
s_waitcnt vmcnt(15)
Mvvv 224,240,120
Mvvv 228,120,120
s_waitcnt vmcnt(14)
Mvvv 232,240,124
Mvvv 236,124,124
s_add_u32 m0, s35, 0x4000
s_add_u32 s44, s36, 0x90000
s_add_u32 s98, s8, s44
s_addc_u32 s99, s9, 0
GDMA 12,98,0
GDMA 13,98,1024
GDMA 14,98,2048
GDMA 15,98,3072
s_add_u32 m0, s35, 0x8000
s_add_u32 s44, s36, 0x120000
s_add_u32 s98, s8, s44
s_addc_u32 s99, s9, 0
GDMA 12,98,0
GDMA 13,98,1024
GDMA 14,98,2048
GDMA 15,98,3072
s_waitcnt vmcnt(21)
Mvvv 224,240,128
Mvvv 228,128,128
s_waitcnt vmcnt(20)
Mvvv 232,240,132
Mvvv 236,132,132
s_waitcnt vmcnt(19)
Mvvv 224,240,136
Mvvv 228,136,136
s_waitcnt vmcnt(18)
Mvvv 232,240,140
Mvvv 236,140,140
s_waitcnt vmcnt(17)
Mvvv 224,240,144
Mvvv 228,144,144
s_waitcnt vmcnt(16)
Mvvv 232,240,148
Mvvv 236,148,148
s_waitcnt vmcnt(15)
Mvvv 224,240,152
Mvvv 228,152,152
s_waitcnt vmcnt(14)
Mvvv 232,240,156
Mvvv 236,156,156
v_and_b32 v244, 15, v1
v_lshrrev_b32 v245, 2, v244
v_lshl_add_u32 v244, v245, 4, v244
v_lshlrev_b32 v244, 2, v244
s_nop 0
v_cndmask_b32 v246, v228, v229, s[50:51]
v_cndmask_b32 v247, v230, v231, s[50:51]
v_cndmask_b32 v246, v246, v247, s[52:53]
ds_bpermute_b32 v248, v244, v246
v_cndmask_b32 v246, v236, v237, s[50:51]
v_cndmask_b32 v247, v238, v239, s[50:51]
v_cndmask_b32 v246, v246, v247, s[52:53]
ds_bpermute_b32 v249, v244, v246
v_mul_f32 v250, 0x3ae38e39, v224
s_waitcnt lgkmcnt(1)
v_mul_f32 v248, 0x3ae38e39, v248
v_fma_f32 v248, -v250, v250, v248
v_max_f32 v248, 0, v248
v_add_f32 v248, 0x3727c5ac, v248
v_rsq_f32 v248, v248
s_nop 0
v_mul_f32 v8, 0x3eeff558, v248
v_mul_f32 v10, -v250, v8
v_mul_f32 v251, 0x3ae38e39, v232
s_waitcnt lgkmcnt(0)
v_mul_f32 v249, 0x3ae38e39, v249
v_fma_f32 v249, -v251, v251, v249
v_max_f32 v249, 0, v249
v_add_f32 v249, 0x3727c5ac, v249
v_rsq_f32 v249, v249
s_nop 0
v_mul_f32 v9, 0x3eeff558, v249
v_mul_f32 v11, -v251, v9
s_waitcnt vmcnt(9)
s_barrier
Ta 208,2,0
Ta 210,2,512
Ta 212,3,0
Ta 214,3,512
Ta 216,4,0
Ta 218,4,512
Ta 220,5,0
Ta 222,5,512
Ta 224,2,4096
Ta 226,2,4608
Ta 228,3,4096
Ta 230,3,4608
v_lshlrev_b32 v6, 16, v16
v_and_b32 v7, s46, v16
v_pk_fma_f32 v[6:7], v[6:7], v[8:9], v[10:11] op_sel:[0,0,0] op_sel_hi:[1,0,0]
v_cvt_pk_bf16_f32 v16, v6, v7
v_lshlrev_b32 v246, 16, v17
v_and_b32 v247, s46, v17
v_pk_fma_f32 v[246:247], v[246:247], v[8:9], v[10:11] op_sel:[0,0,0] op_sel_hi:[1,0,0]
v_cvt_pk_bf16_f32 v17, v246, v247
v_lshlrev_b32 v6, 16, v18
v_and_b32 v7, s46, v18
v_pk_fma_f32 v[6:7], v[6:7], v[8:9], v[10:11] op_sel:[0,0,0] op_sel_hi:[1,0,0]
v_cvt_pk_bf16_f32 v18, v6, v7
v_lshlrev_b32 v246, 16, v19
v_and_b32 v247, s46, v19
v_pk_fma_f32 v[246:247], v[246:247], v[8:9], v[10:11] op_sel:[0,0,0] op_sel_hi:[1,0,0]
v_cvt_pk_bf16_f32 v19, v246, v247
v_lshlrev_b32 v6, 16, v20
v_and_b32 v7, s46, v20
v_pk_fma_f32 v[6:7], v[6:7], v[8:9], v[10:11] op_sel:[0,1,1] op_sel_hi:[1,1,1]
v_cvt_pk_bf16_f32 v20, v6, v7
v_lshlrev_b32 v246, 16, v21
v_and_b32 v247, s46, v21
v_pk_fma_f32 v[246:247], v[246:247], v[8:9], v[10:11] op_sel:[0,1,1] op_sel_hi:[1,1,1]
v_cvt_pk_bf16_f32 v21, v246, v247
v_lshlrev_b32 v6, 16, v22
v_and_b32 v7, s46, v22
v_pk_fma_f32 v[6:7], v[6:7], v[8:9], v[10:11] op_sel:[0,1,1] op_sel_hi:[1,1,1]
v_cvt_pk_bf16_f32 v22, v6, v7
v_lshlrev_b32 v246, 16, v23
v_and_b32 v247, s46, v23
v_pk_fma_f32 v[246:247], v[246:247], v[8:9], v[10:11] op_sel:[0,1,1] op_sel_hi:[1,1,1]
v_cvt_pk_bf16_f32 v23, v246, v247
v_lshlrev_b32 v6, 16, v24
v_and_b32 v7, s46, v24
v_pk_fma_f32 v[6:7], v[6:7], v[8:9], v[10:11] op_sel:[0,0,0] op_sel_hi:[1,0,0]
v_cvt_pk_bf16_f32 v24, v6, v7
v_lshlrev_b32 v246, 16, v25
v_and_b32 v247, s46, v25
v_pk_fma_f32 v[246:247], v[246:247], v[8:9], v[10:11] op_sel:[0,0,0] op_sel_hi:[1,0,0]
v_cvt_pk_bf16_f32 v25, v246, v247
v_lshlrev_b32 v6, 16, v26
v_and_b32 v7, s46, v26
v_pk_fma_f32 v[6:7], v[6:7], v[8:9], v[10:11] op_sel:[0,0,0] op_sel_hi:[1,0,0]
v_cvt_pk_bf16_f32 v26, v6, v7
v_lshlrev_b32 v246, 16, v27
v_and_b32 v247, s46, v27
v_pk_fma_f32 v[246:247], v[246:247], v[8:9], v[10:11] op_sel:[0,0,0] op_sel_hi:[1,0,0]
v_cvt_pk_bf16_f32 v27, v246, v247
v_lshlrev_b32 v6, 16, v28
v_and_b32 v7, s46, v28
v_pk_fma_f32 v[6:7], v[6:7], v[8:9], v[10:11] op_sel:[0,1,1] op_sel_hi:[1,1,1]
v_cvt_pk_bf16_f32 v28, v6, v7
v_lshlrev_b32 v246, 16, v29
v_and_b32 v247, s46, v29
v_pk_fma_f32 v[246:247], v[246:247], v[8:9], v[10:11] op_sel:[0,1,1] op_sel_hi:[1,1,1]
v_cvt_pk_bf16_f32 v29, v246, v247
v_lshlrev_b32 v6, 16, v30
v_and_b32 v7, s46, v30
v_pk_fma_f32 v[6:7], v[6:7], v[8:9], v[10:11] op_sel:[0,1,1] op_sel_hi:[1,1,1]
v_cvt_pk_bf16_f32 v30, v6, v7
v_lshlrev_b32 v246, 16, v31
v_and_b32 v247, s46, v31
v_pk_fma_f32 v[246:247], v[246:247], v[8:9], v[10:11] op_sel:[0,1,1] op_sel_hi:[1,1,1]
v_cvt_pk_bf16_f32 v31, v246, v247
v_lshlrev_b32 v6, 16, v32
v_and_b32 v7, s46, v32
v_fma_f32 v6, v6, v8, v10
v_fma_f32 v7, v7, v8, v10
v_cvt_pk_bf16_f32 v32, v6, v7
v_lshlrev_b32 v246, 16, v33
v_and_b32 v247, s46, v33
v_fma_f32 v246, v246, v8, v10
v_fma_f32 v247, v247, v8, v10
v_cvt_pk_bf16_f32 v33, v246, v247
v_lshlrev_b32 v6, 16, v34
v_and_b32 v7, s46, v34
v_fma_f32 v6, v6, v8, v10
v_fma_f32 v7, v7, v8, v10
v_cvt_pk_bf16_f32 v34, v6, v7
v_lshlrev_b32 v246, 16, v35
v_and_b32 v247, s46, v35
v_fma_f32 v246, v246, v8, v10
v_fma_f32 v247, v247, v8, v10
v_cvt_pk_bf16_f32 v35, v246, v247
v_lshlrev_b32 v6, 16, v36
v_and_b32 v7, s46, v36
v_fma_f32 v6, v6, v9, v11
v_fma_f32 v7, v7, v9, v11
v_cvt_pk_bf16_f32 v36, v6, v7
v_lshlrev_b32 v246, 16, v37
v_and_b32 v247, s46, v37
v_fma_f32 v246, v246, v9, v11
v_fma_f32 v247, v247, v9, v11
v_cvt_pk_bf16_f32 v37, v246, v247
v_lshlrev_b32 v6, 16, v38
v_and_b32 v7, s46, v38
v_fma_f32 v6, v6, v9, v11
v_fma_f32 v7, v7, v9, v11
v_cvt_pk_bf16_f32 v38, v6, v7
v_lshlrev_b32 v246, 16, v39
v_and_b32 v247, s46, v39
v_fma_f32 v246, v246, v9, v11
v_fma_f32 v247, v247, v9, v11
v_cvt_pk_bf16_f32 v39, v246, v247
v_lshlrev_b32 v6, 16, v40
v_and_b32 v7, s46, v40
v_fma_f32 v6, v6, v8, v10
v_fma_f32 v7, v7, v8, v10
v_cvt_pk_bf16_f32 v40, v6, v7
v_lshlrev_b32 v246, 16, v41
v_and_b32 v247, s46, v41
v_fma_f32 v246, v246, v8, v10
v_fma_f32 v247, v247, v8, v10
v_cvt_pk_bf16_f32 v41, v246, v247
v_lshlrev_b32 v6, 16, v42
v_and_b32 v7, s46, v42
v_fma_f32 v6, v6, v8, v10
v_fma_f32 v7, v7, v8, v10
v_cvt_pk_bf16_f32 v42, v6, v7
v_lshlrev_b32 v246, 16, v43
v_and_b32 v247, s46, v43
v_fma_f32 v246, v246, v8, v10
v_fma_f32 v247, v247, v8, v10
v_cvt_pk_bf16_f32 v43, v246, v247
v_lshlrev_b32 v6, 16, v44
v_and_b32 v7, s46, v44
v_fma_f32 v6, v6, v9, v11
v_fma_f32 v7, v7, v9, v11
v_cvt_pk_bf16_f32 v44, v6, v7
v_lshlrev_b32 v246, 16, v45
v_and_b32 v247, s46, v45
v_fma_f32 v246, v246, v9, v11
v_fma_f32 v247, v247, v9, v11
v_cvt_pk_bf16_f32 v45, v246, v247
v_lshlrev_b32 v6, 16, v46
v_and_b32 v7, s46, v46
v_fma_f32 v6, v6, v9, v11
v_fma_f32 v7, v7, v9, v11
v_cvt_pk_bf16_f32 v46, v6, v7
v_lshlrev_b32 v246, 16, v47
v_and_b32 v247, s46, v47
v_fma_f32 v246, v246, v9, v11
v_fma_f32 v247, v247, v9, v11
v_cvt_pk_bf16_f32 v47, v246, v247
v_lshlrev_b32 v6, 16, v48
v_and_b32 v7, s46, v48
v_fma_f32 v6, v6, v8, v10
v_fma_f32 v7, v7, v8, v10
v_cvt_pk_bf16_f32 v48, v6, v7
v_lshlrev_b32 v246, 16, v49
v_and_b32 v247, s46, v49
v_fma_f32 v246, v246, v8, v10
v_fma_f32 v247, v247, v8, v10
v_cvt_pk_bf16_f32 v49, v246, v247
v_lshlrev_b32 v6, 16, v50
v_and_b32 v7, s46, v50
v_fma_f32 v6, v6, v8, v10
v_fma_f32 v7, v7, v8, v10
v_cvt_pk_bf16_f32 v50, v6, v7
v_lshlrev_b32 v246, 16, v51
v_and_b32 v247, s46, v51
v_fma_f32 v246, v246, v8, v10
v_fma_f32 v247, v247, v8, v10
v_cvt_pk_bf16_f32 v51, v246, v247
v_lshlrev_b32 v6, 16, v52
v_and_b32 v7, s46, v52
v_fma_f32 v6, v6, v9, v11
v_fma_f32 v7, v7, v9, v11
v_cvt_pk_bf16_f32 v52, v6, v7
v_lshlrev_b32 v246, 16, v53
v_and_b32 v247, s46, v53
v_fma_f32 v246, v246, v9, v11
v_fma_f32 v247, v247, v9, v11
v_cvt_pk_bf16_f32 v53, v246, v247
v_lshlrev_b32 v6, 16, v54
v_and_b32 v7, s46, v54
v_fma_f32 v6, v6, v9, v11
v_fma_f32 v7, v7, v9, v11
v_cvt_pk_bf16_f32 v54, v6, v7
v_lshlrev_b32 v246, 16, v55
v_and_b32 v247, s46, v55
v_fma_f32 v246, v246, v9, v11
v_fma_f32 v247, v247, v9, v11
v_cvt_pk_bf16_f32 v55, v246, v247
v_lshlrev_b32 v6, 16, v56
v_and_b32 v7, s46, v56
v_fma_f32 v6, v6, v8, v10
v_fma_f32 v7, v7, v8, v10
v_cvt_pk_bf16_f32 v56, v6, v7
v_lshlrev_b32 v246, 16, v57
v_and_b32 v247, s46, v57
v_fma_f32 v246, v246, v8, v10
v_fma_f32 v247, v247, v8, v10
v_cvt_pk_bf16_f32 v57, v246, v247
v_lshlrev_b32 v6, 16, v58
v_and_b32 v7, s46, v58
v_fma_f32 v6, v6, v8, v10
v_fma_f32 v7, v7, v8, v10
v_cvt_pk_bf16_f32 v58, v6, v7
v_lshlrev_b32 v246, 16, v59
v_and_b32 v247, s46, v59
v_fma_f32 v246, v246, v8, v10
v_fma_f32 v247, v247, v8, v10
v_cvt_pk_bf16_f32 v59, v246, v247
v_lshlrev_b32 v6, 16, v60
v_and_b32 v7, s46, v60
v_fma_f32 v6, v6, v9, v11
v_fma_f32 v7, v7, v9, v11
v_cvt_pk_bf16_f32 v60, v6, v7
v_lshlrev_b32 v246, 16, v61
v_and_b32 v247, s46, v61
v_fma_f32 v246, v246, v9, v11
v_fma_f32 v247, v247, v9, v11
v_cvt_pk_bf16_f32 v61, v246, v247
v_lshlrev_b32 v6, 16, v62
v_and_b32 v7, s46, v62
v_fma_f32 v6, v6, v9, v11
v_fma_f32 v7, v7, v9, v11
v_cvt_pk_bf16_f32 v62, v6, v7
v_lshlrev_b32 v246, 16, v63
v_and_b32 v247, s46, v63
v_fma_f32 v246, v246, v9, v11
v_fma_f32 v247, v247, v9, v11
v_cvt_pk_bf16_f32 v63, v246, v247
v_lshlrev_b32 v6, 16, v64
v_and_b32 v7, s46, v64
s_waitcnt lgkmcnt(10)
Zvav 160,208,16
Ta 232,4,4096
s_add_u32 m0, s35, 0xc000
v_fma_f32 v6, v6, v8, v10
v_fma_f32 v7, v7, v8, v10
Zvav 164,208,20
Ta 234,4,4608
s_add_u32 s44, s36, 0x1b0000
v_cvt_pk_bf16_f32 v64, v6, v7
v_lshlrev_b32 v246, 16, v65
s_waitcnt lgkmcnt(4)
Zvav 172,212,20
Ta 236,5,4096
s_add_u32 s98, s8, s44
s_addc_u32 s99, s9, 0
v_and_b32 v247, s46, v65
v_fma_f32 v246, v246, v8, v10
Zvav 168,212,16
Ta 238,5,4608
GDMA 12,98,0
v_fma_f32 v247, v247, v8, v10
v_cvt_pk_bf16_f32 v65, v246, v247
Zvav 176,216,16
Ta 208,2,8192
GDMA 13,98,1024
v_lshlrev_b32 v6, 16, v66
v_and_b32 v7, s46, v66
Zvav 180,216,20
Ta 210,2,8704
v_fma_f32 v6, v6, v8, v10
v_fma_f32 v7, v7, v8, v10
Zvav 188,220,20
Ta 212,3,8192
v_cvt_pk_bf16_f32 v66, v6, v7
v_lshlrev_b32 v246, 16, v67
Zvav 184,220,16
Ta 214,3,8704
v_and_b32 v247, s46, v67
v_fma_f32 v246, v246, v8, v10
Zvav 192,224,16
Ta 216,4,8192
GDMA 14,98,2048
v_fma_f32 v247, v247, v8, v10
v_cvt_pk_bf16_f32 v67, v246, v247
Zvav 196,224,20
Ta 218,4,8704
v_lshlrev_b32 v6, 16, v68
v_and_b32 v7, s46, v68
s_waitcnt lgkmcnt(4)
Zvav 204,228,20
Ta 220,5,8192
v_fma_f32 v6, v6, v9, v11
v_fma_f32 v7, v7, v9, v11
Zvav 200,228,16
Ta 222,5,8704
v_cvt_pk_bf16_f32 v68, v6, v7
v_lshlrev_b32 v246, 16, v69
Zvav 208,232,16
Ta 224,2,12288
GDMA 15,98,3072
v_and_b32 v247, s46, v69
v_fma_f32 v246, v246, v9, v11
Zvav 212,232,20
Ta 226,2,12800
v_fma_f32 v247, v247, v9, v11
v_cvt_pk_bf16_f32 v69, v246, v247
Zvav 220,236,20
Ta 228,3,12288
v_lshlrev_b32 v6, 16, v70
v_and_b32 v7, s46, v70
Zvav 216,236,16
Ta 230,3,12800
v_fma_f32 v6, v6, v9, v11
v_fma_f32 v7, v7, v9, v11
Mvav 160,208,24
Ta 232,4,12288
s_add_u32 m0, s35, 0x10000
v_cvt_pk_bf16_f32 v70, v6, v7
v_lshlrev_b32 v246, 16, v71
Mvav 164,208,28
Ta 234,4,12800
s_add_u32 s44, s36, 0x240000
v_and_b32 v247, s46, v71
v_fma_f32 v246, v246, v9, v11
s_waitcnt lgkmcnt(4)
Mvav 172,212,28
Ta 236,5,12288
s_add_u32 s98, s8, s44
s_addc_u32 s99, s9, 0
v_fma_f32 v247, v247, v9, v11
v_cvt_pk_bf16_f32 v71, v246, v247
Mvav 168,212,24
Ta 238,5,12800
GDMA 12,98,0
v_lshlrev_b32 v6, 16, v72
v_and_b32 v7, s46, v72
s_waitcnt vmcnt(9)
s_barrier
Mvav 176,216,24
Ta 208,2,16384
GDMA 13,98,1024
v_fma_f32 v6, v6, v8, v10
v_fma_f32 v7, v7, v8, v10
Mvav 180,216,28
Ta 210,2,16896
v_cvt_pk_bf16_f32 v72, v6, v7
v_lshlrev_b32 v246, 16, v73
Mvav 188,220,28
Ta 212,3,16384
v_and_b32 v247, s46, v73
v_fma_f32 v246, v246, v8, v10
Mvav 184,220,24
Ta 214,3,16896
v_fma_f32 v247, v247, v8, v10
v_cvt_pk_bf16_f32 v73, v246, v247
Mvav 192,224,24
Ta 216,4,16384
GDMA 14,98,2048
v_lshlrev_b32 v6, 16, v74
v_and_b32 v7, s46, v74
Mvav 196,224,28
Ta 218,4,16896
v_fma_f32 v6, v6, v8, v10
v_fma_f32 v7, v7, v8, v10
s_waitcnt lgkmcnt(4)
Mvav 204,228,28
Ta 220,5,16384
v_cvt_pk_bf16_f32 v74, v6, v7
v_lshlrev_b32 v246, 16, v75
Mvav 200,228,24
Ta 222,5,16896
v_and_b32 v247, s46, v75
v_fma_f32 v246, v246, v8, v10
Mvav 208,232,24
Ta 224,2,20480
GDMA 15,98,3072
v_fma_f32 v247, v247, v8, v10
v_cvt_pk_bf16_f32 v75, v246, v247
Mvav 212,232,28
Ta 226,2,20992
v_lshlrev_b32 v6, 16, v76
v_and_b32 v7, s46, v76
Mvav 220,236,28
Ta 228,3,20480
v_fma_f32 v6, v6, v9, v11
v_fma_f32 v7, v7, v9, v11
Mvav 216,236,24
Ta 230,3,20992
v_cvt_pk_bf16_f32 v76, v6, v7
v_lshlrev_b32 v246, 16, v77
Mvav 160,208,32
Ta 232,4,20480
s_add_u32 m0, s35, 0x14000
v_and_b32 v247, s46, v77
v_fma_f32 v246, v246, v9, v11
Mvav 164,208,36
Ta 234,4,20992
s_add_u32 s44, s36, 0x2d0000
v_fma_f32 v247, v247, v9, v11
v_cvt_pk_bf16_f32 v77, v246, v247
s_waitcnt lgkmcnt(4)
Mvav 172,212,36
Ta 236,5,20480
s_add_u32 s98, s8, s44
s_addc_u32 s99, s9, 0
v_lshlrev_b32 v6, 16, v78
v_and_b32 v7, s46, v78
Mvav 168,212,32
Ta 238,5,20992
GDMA 12,98,0
v_fma_f32 v6, v6, v9, v11
v_fma_f32 v7, v7, v9, v11
Mvav 176,216,32
Ta 208,2,24576
GDMA 13,98,1024
v_cvt_pk_bf16_f32 v78, v6, v7
v_lshlrev_b32 v246, 16, v79
Mvav 180,216,36
Ta 210,2,25088
v_and_b32 v247, s46, v79
v_fma_f32 v246, v246, v9, v11
Mvav 188,220,36
Ta 212,3,24576
v_fma_f32 v247, v247, v9, v11
v_cvt_pk_bf16_f32 v79, v246, v247
Mvav 184,220,32
Ta 214,3,25088
v_lshlrev_b32 v6, 16, v80
v_and_b32 v7, s46, v80
Mvav 192,224,32
Ta 216,4,24576
GDMA 14,98,2048
v_fma_f32 v6, v6, v8, v10
v_fma_f32 v7, v7, v8, v10
Mvav 196,224,36
Ta 218,4,25088
v_cvt_pk_bf16_f32 v80, v6, v7
v_lshlrev_b32 v246, 16, v81
s_waitcnt lgkmcnt(4)
Mvav 204,228,36
Ta 220,5,24576
v_and_b32 v247, s46, v81
v_fma_f32 v246, v246, v8, v10
Mvav 200,228,32
Ta 222,5,25088
v_fma_f32 v247, v247, v8, v10
v_cvt_pk_bf16_f32 v81, v246, v247
Mvav 208,232,32
Ta 224,2,28672
GDMA 15,98,3072
v_lshlrev_b32 v6, 16, v82
v_and_b32 v7, s46, v82
Mvav 212,232,36
Ta 226,2,29184
v_fma_f32 v6, v6, v8, v10
v_fma_f32 v7, v7, v8, v10
Mvav 220,236,36
Ta 228,3,28672
v_cvt_pk_bf16_f32 v82, v6, v7
v_lshlrev_b32 v246, 16, v83
Mvav 216,236,32
Ta 230,3,29184
v_and_b32 v247, s46, v83
v_fma_f32 v246, v246, v8, v10
Mvav 160,208,40
Ta 232,4,28672
s_add_u32 m0, s35, 0x18000
v_fma_f32 v247, v247, v8, v10
v_cvt_pk_bf16_f32 v83, v246, v247
Mvav 164,208,44
Ta 234,4,29184
s_add_u32 s44, s36, 0x360000
v_lshlrev_b32 v6, 16, v84
v_and_b32 v7, s46, v84
s_waitcnt lgkmcnt(4)
Mvav 172,212,44
Ta 236,5,28672
s_add_u32 s98, s8, s44
s_addc_u32 s99, s9, 0
v_fma_f32 v6, v6, v9, v11
v_fma_f32 v7, v7, v9, v11
Mvav 168,212,40
Ta 238,5,29184
GDMA 12,98,0
v_cvt_pk_bf16_f32 v84, v6, v7
v_lshlrev_b32 v246, 16, v85
s_waitcnt vmcnt(13)
s_barrier
Mvav 176,216,40
Ta 208,2,32768
GDMA 13,98,1024
v_and_b32 v247, s46, v85
v_fma_f32 v246, v246, v9, v11
Mvav 180,216,44
Ta 210,2,33280
v_fma_f32 v247, v247, v9, v11
v_cvt_pk_bf16_f32 v85, v246, v247
Mvav 188,220,44
Ta 212,3,32768
v_lshlrev_b32 v6, 16, v86
v_and_b32 v7, s46, v86
Mvav 184,220,40
Ta 214,3,33280
v_fma_f32 v6, v6, v9, v11
v_fma_f32 v7, v7, v9, v11
Mvav 192,224,40
Ta 216,4,32768
GDMA 14,98,2048
v_cvt_pk_bf16_f32 v86, v6, v7
v_lshlrev_b32 v246, 16, v87
Mvav 196,224,44
Ta 218,4,33280
v_and_b32 v247, s46, v87
v_fma_f32 v246, v246, v9, v11
s_waitcnt lgkmcnt(4)
Mvav 204,228,44
Ta 220,5,32768
v_fma_f32 v247, v247, v9, v11
v_cvt_pk_bf16_f32 v87, v246, v247
Mvav 200,228,40
Ta 222,5,33280
v_lshlrev_b32 v6, 16, v88
v_and_b32 v7, s46, v88
Mvav 208,232,40
Ta 224,2,36864
GDMA 15,98,3072
v_fma_f32 v6, v6, v8, v10
v_fma_f32 v7, v7, v8, v10
Mvav 212,232,44
Ta 226,2,37376
v_cvt_pk_bf16_f32 v88, v6, v7
v_lshlrev_b32 v246, 16, v89
Mvav 220,236,44
Ta 228,3,36864
v_and_b32 v247, s46, v89
v_fma_f32 v246, v246, v8, v10
Mvav 216,236,40
Ta 230,3,37376
v_fma_f32 v247, v247, v8, v10
v_cvt_pk_bf16_f32 v89, v246, v247
Mvav 160,208,48
Ta 232,4,36864
s_add_u32 m0, s35, 0x1c000
v_lshlrev_b32 v6, 16, v90
v_and_b32 v7, s46, v90
Mvav 164,208,52
Ta 234,4,37376
s_add_u32 s44, s36, 0x3f0000
v_fma_f32 v6, v6, v8, v10
v_fma_f32 v7, v7, v8, v10
s_waitcnt lgkmcnt(4)
Mvav 172,212,52
Ta 236,5,36864
s_add_u32 s98, s8, s44
s_addc_u32 s99, s9, 0
v_cvt_pk_bf16_f32 v90, v6, v7
v_lshlrev_b32 v246, 16, v91
Mvav 168,212,48
Ta 238,5,37376
GDMA 12,98,0
v_and_b32 v247, s46, v91
v_fma_f32 v246, v246, v8, v10
Mvav 176,216,48
Ta 208,2,40960
GDMA 13,98,1024
v_fma_f32 v247, v247, v8, v10
v_cvt_pk_bf16_f32 v91, v246, v247
Mvav 180,216,52
Ta 210,2,41472
v_lshlrev_b32 v6, 16, v92
v_and_b32 v7, s46, v92
Mvav 188,220,52
Ta 212,3,40960
v_fma_f32 v6, v6, v9, v11
v_fma_f32 v7, v7, v9, v11
Mvav 184,220,48
Ta 214,3,41472
v_cvt_pk_bf16_f32 v92, v6, v7
v_lshlrev_b32 v246, 16, v93
Mvav 192,224,48
Ta 216,4,40960
GDMA 14,98,2048
v_and_b32 v247, s46, v93
v_fma_f32 v246, v246, v9, v11
Mvav 196,224,52
Ta 218,4,41472
v_fma_f32 v247, v247, v9, v11
v_cvt_pk_bf16_f32 v93, v246, v247
s_waitcnt lgkmcnt(4)
Mvav 204,228,52
Ta 220,5,40960
v_lshlrev_b32 v6, 16, v94
v_and_b32 v7, s46, v94
Mvav 200,228,48
Ta 222,5,41472
v_fma_f32 v6, v6, v9, v11
v_fma_f32 v7, v7, v9, v11
Mvav 208,232,48
Ta 224,2,45056
GDMA 15,98,3072
v_cvt_pk_bf16_f32 v94, v6, v7
v_lshlrev_b32 v246, 16, v95
Mvav 212,232,52
Ta 226,2,45568
s_mov_b32 m0, s35
v_and_b32 v247, s46, v95
v_fma_f32 v246, v246, v9, v11
Mvav 220,236,52
Ta 228,3,45056
s_add_u32 s44, s36, 0x480000
v_fma_f32 v247, v247, v9, v11
v_cvt_pk_bf16_f32 v95, v246, v247
Mvav 216,236,48
Ta 230,3,45568
s_add_u32 s98, s8, s44
s_addc_u32 s99, s9, 0
v_lshlrev_b32 v6, 16, v96
v_and_b32 v7, s46, v96
Mvav 160,208,56
Ta 232,4,45056
GDMA 12,98,0
v_fma_f32 v6, v6, v8, v10
v_fma_f32 v7, v7, v8, v10
Mvav 164,208,60
Ta 234,4,45568
GDMA 13,98,1024
v_cvt_pk_bf16_f32 v6, v6, v7
v_accvgpr_write_b32 a144, v6
s_waitcnt lgkmcnt(4)
Mvav 172,212,60
Ta 236,5,45056
GDMA 14,98,2048
v_lshlrev_b32 v246, 16, v97
v_and_b32 v247, s46, v97
Mvav 168,212,56
Ta 238,5,45568
GDMA 15,98,3072
v_fma_f32 v246, v246, v8, v10
v_fma_f32 v247, v247, v8, v10
s_waitcnt vmcnt(20)
s_barrier
Mvav 176,216,56
Ta 208,2,49152
s_add_u32 m0, s35, 0x4000
v_cvt_pk_bf16_f32 v246, v246, v247
v_accvgpr_write_b32 a145, v246
Mvav 180,216,60
Ta 210,2,49664
s_add_u32 s44, s36, 0x80
v_lshlrev_b32 v6, 16, v98
v_and_b32 v7, s46, v98
Mvav 188,220,60
Ta 212,3,49152
s_add_u32 s98, s8, s44
s_addc_u32 s99, s9, 0
v_fma_f32 v6, v6, v8, v10
v_fma_f32 v7, v7, v8, v10
Mvav 184,220,56
Ta 214,3,49664
GDMA 12,98,0
v_cvt_pk_bf16_f32 v6, v6, v7
v_accvgpr_write_b32 a146, v6
Mvav 192,224,56
Ta 216,4,49152
GDMA 13,98,1024
v_lshlrev_b32 v246, 16, v99
v_and_b32 v247, s46, v99
Mvav 196,224,60
Ta 218,4,49664
v_fma_f32 v246, v246, v8, v10
v_fma_f32 v247, v247, v8, v10
s_waitcnt lgkmcnt(4)
Mvav 204,228,60
Ta 220,5,49152
v_cvt_pk_bf16_f32 v246, v246, v247
v_accvgpr_write_b32 a147, v246
Mvav 200,228,56
Ta 222,5,49664
v_lshlrev_b32 v6, 16, v100
v_and_b32 v7, s46, v100
Mvav 208,232,56
Ta 224,2,53248
GDMA 14,98,2048
v_fma_f32 v6, v6, v9, v11
v_fma_f32 v7, v7, v9, v11
Mvav 212,232,60
Ta 226,2,53760
v_cvt_pk_bf16_f32 v6, v6, v7
v_accvgpr_write_b32 a148, v6
Mvav 220,236,60
Ta 228,3,53248
v_lshlrev_b32 v246, 16, v101
v_and_b32 v247, s46, v101
Mvav 216,236,56
Ta 230,3,53760
v_fma_f32 v246, v246, v9, v11
v_fma_f32 v247, v247, v9, v11
Mvav 160,208,64
Ta 232,4,53248
GDMA 15,98,3072
v_cvt_pk_bf16_f32 v246, v246, v247
v_accvgpr_write_b32 a149, v246
Mvav 164,208,68
Ta 234,4,53760
v_lshlrev_b32 v6, 16, v102
v_and_b32 v7, s46, v102
s_waitcnt lgkmcnt(4)
Mvav 172,212,68
Ta 236,5,53248
v_fma_f32 v6, v6, v9, v11
v_fma_f32 v7, v7, v9, v11
Mvav 168,212,64
Ta 238,5,53760
v_cvt_pk_bf16_f32 v6, v6, v7
v_accvgpr_write_b32 a150, v6
Mvav 176,216,64
Ta 208,2,57344
v_lshlrev_b32 v246, 16, v103
v_and_b32 v247, s46, v103
Mvav 180,216,68
Ta 210,2,57856
v_fma_f32 v246, v246, v9, v11
v_fma_f32 v247, v247, v9, v11
Mvav 188,220,68
Ta 212,3,57344
v_cvt_pk_bf16_f32 v246, v246, v247
v_accvgpr_write_b32 a151, v246
Mvav 184,220,64
Ta 214,3,57856
v_lshlrev_b32 v6, 16, v104
v_and_b32 v7, s46, v104
Mvav 192,224,64
Ta 216,4,57344
v_fma_f32 v6, v6, v8, v10
v_fma_f32 v7, v7, v8, v10
Mvav 196,224,68
Ta 218,4,57856
v_cvt_pk_bf16_f32 v6, v6, v7
v_accvgpr_write_b32 a152, v6
s_waitcnt lgkmcnt(4)
Mvav 204,228,68
Ta 220,5,57344
v_lshlrev_b32 v246, 16, v105
v_and_b32 v247, s46, v105
Mvav 200,228,64
Ta 222,5,57856
v_fma_f32 v246, v246, v8, v10
v_fma_f32 v247, v247, v8, v10
Mvav 208,232,64
Ta 224,2,61440
v_cvt_pk_bf16_f32 v246, v246, v247
v_accvgpr_write_b32 a153, v246
Mvav 212,232,68
Ta 226,2,61952
v_xor_b32 v2, 0x10000, v2
v_lshlrev_b32 v6, 16, v106
v_and_b32 v7, s46, v106
Mvav 220,236,68
Ta 228,3,61440
v_fma_f32 v6, v6, v8, v10
v_fma_f32 v7, v7, v8, v10
Mvav 216,236,64
Ta 230,3,61952
v_xor_b32 v3, 0x10000, v3
v_cvt_pk_bf16_f32 v6, v6, v7
v_accvgpr_write_b32 a154, v6
Mvav 160,208,72
Ta 232,4,61440
v_lshlrev_b32 v246, 16, v107
v_and_b32 v247, s46, v107
Mvav 164,208,76
Ta 234,4,61952
v_xor_b32 v4, 0x10000, v4
v_fma_f32 v246, v246, v8, v10
v_fma_f32 v247, v247, v8, v10
s_waitcnt lgkmcnt(4)
Mvav 172,212,76
Ta 236,5,61440
v_cvt_pk_bf16_f32 v246, v246, v247
v_accvgpr_write_b32 a155, v246
Mvav 168,212,72
Ta 238,5,61952
v_xor_b32 v5, 0x10000, v5
v_lshlrev_b32 v6, 16, v108
v_and_b32 v7, s46, v108
s_waitcnt vmcnt(20)
s_barrier
Mvav 176,216,72
Ta 208,2,0
s_add_u32 m0, s35, 0x8000
v_fma_f32 v6, v6, v9, v11
v_fma_f32 v7, v7, v9, v11
Mvav 180,216,76
Ta 210,2,512
s_add_u32 s44, s36, 0x90080
v_cvt_pk_bf16_f32 v6, v6, v7
v_accvgpr_write_b32 a156, v6
Mvav 188,220,76
Ta 212,3,0
s_add_u32 s98, s8, s44
s_addc_u32 s99, s9, 0
v_lshlrev_b32 v246, 16, v109
v_and_b32 v247, s46, v109
Mvav 184,220,72
Ta 214,3,512
GDMA 12,98,0
v_fma_f32 v246, v246, v9, v11
v_fma_f32 v247, v247, v9, v11
Mvav 192,224,72
Ta 216,4,0
GDMA 13,98,1024
v_cvt_pk_bf16_f32 v246, v246, v247
v_accvgpr_write_b32 a157, v246
Mvav 196,224,76
Ta 218,4,512
v_lshlrev_b32 v6, 16, v110
v_and_b32 v7, s46, v110
s_waitcnt lgkmcnt(4)
Mvav 204,228,76
Ta 220,5,0
v_fma_f32 v6, v6, v9, v11
v_fma_f32 v7, v7, v9, v11
Mvav 200,228,72
Ta 222,5,512
v_cvt_pk_bf16_f32 v6, v6, v7
v_accvgpr_write_b32 a158, v6
Mvav 208,232,72
Ta 224,2,4096
GDMA 14,98,2048
v_lshlrev_b32 v246, 16, v111
v_and_b32 v247, s46, v111
Mvav 212,232,76
Ta 226,2,4608
v_fma_f32 v246, v246, v9, v11
v_fma_f32 v247, v247, v9, v11
Mvav 220,236,76
Ta 228,3,4096
v_cvt_pk_bf16_f32 v246, v246, v247
v_accvgpr_write_b32 a159, v246
Mvav 216,236,72
Ta 230,3,4608
v_lshlrev_b32 v6, 16, v112
v_and_b32 v7, s46, v112
Mvav 160,208,80
Ta 232,4,4096
GDMA 15,98,3072
v_fma_f32 v6, v6, v8, v10
v_fma_f32 v7, v7, v8, v10
Mvav 164,208,84
Ta 234,4,4608
v_cvt_pk_bf16_f32 v6, v6, v7
v_accvgpr_write_b32 a160, v6
s_waitcnt lgkmcnt(4)
Mvav 172,212,84
Ta 236,5,4096
v_lshlrev_b32 v246, 16, v113
v_and_b32 v247, s46, v113
Mvav 168,212,80
Ta 238,5,4608
v_fma_f32 v246, v246, v8, v10
v_fma_f32 v247, v247, v8, v10
Mvav 176,216,80
Ta 208,2,8192
v_cvt_pk_bf16_f32 v246, v246, v247
v_accvgpr_write_b32 a161, v246
Mvav 180,216,84
Ta 210,2,8704
v_lshlrev_b32 v6, 16, v114
v_and_b32 v7, s46, v114
Mvav 188,220,84
Ta 212,3,8192
v_fma_f32 v6, v6, v8, v10
v_fma_f32 v7, v7, v8, v10
Mvav 184,220,80
Ta 214,3,8704
v_cvt_pk_bf16_f32 v6, v6, v7
v_accvgpr_write_b32 a162, v6
Mvav 192,224,80
Ta 216,4,8192
v_lshlrev_b32 v246, 16, v115
v_and_b32 v247, s46, v115
Mvav 196,224,84
Ta 218,4,8704
v_fma_f32 v246, v246, v8, v10
v_fma_f32 v247, v247, v8, v10
s_waitcnt lgkmcnt(4)
Mvav 204,228,84
Ta 220,5,8192
v_cvt_pk_bf16_f32 v246, v246, v247
v_accvgpr_write_b32 a163, v246
Mvav 200,228,80
Ta 222,5,8704
v_lshlrev_b32 v6, 16, v116
v_and_b32 v7, s46, v116
Mvav 208,232,80
Ta 224,2,12288
v_fma_f32 v6, v6, v9, v11
v_fma_f32 v7, v7, v9, v11
Mvav 212,232,84
Ta 226,2,12800
v_cvt_pk_bf16_f32 v6, v6, v7
v_accvgpr_write_b32 a164, v6
Mvav 220,236,84
Ta 228,3,12288
v_lshlrev_b32 v246, 16, v117
v_and_b32 v247, s46, v117
Mvav 216,236,80
Ta 230,3,12800
v_fma_f32 v246, v246, v9, v11
v_fma_f32 v247, v247, v9, v11
Mvav 160,208,88
Ta 232,4,12288
v_cvt_pk_bf16_f32 v246, v246, v247
v_accvgpr_write_b32 a165, v246
Mvav 164,208,92
Ta 234,4,12800
v_lshlrev_b32 v6, 16, v118
v_and_b32 v7, s46, v118
s_waitcnt lgkmcnt(4)
Mvav 172,212,92
Ta 236,5,12288
v_fma_f32 v6, v6, v9, v11
v_fma_f32 v7, v7, v9, v11
Mvav 168,212,88
Ta 238,5,12800
v_cvt_pk_bf16_f32 v6, v6, v7
v_accvgpr_write_b32 a166, v6
s_waitcnt vmcnt(20)
s_barrier
Mvav 176,216,88
Ta 208,2,16384
s_add_u32 m0, s35, 0xc000
v_lshlrev_b32 v246, 16, v119
v_and_b32 v247, s46, v119
Mvav 180,216,92
Ta 210,2,16896
s_add_u32 s44, s36, 0x120080
v_fma_f32 v246, v246, v9, v11
v_fma_f32 v247, v247, v9, v11
Mvav 188,220,92
Ta 212,3,16384
s_add_u32 s98, s8, s44
s_addc_u32 s99, s9, 0
v_cvt_pk_bf16_f32 v246, v246, v247
v_accvgpr_write_b32 a167, v246
Mvav 184,220,88
Ta 214,3,16896
GDMA 12,98,0
v_lshlrev_b32 v6, 16, v120
v_and_b32 v7, s46, v120
Mvav 192,224,88
Ta 216,4,16384
GDMA 13,98,1024
v_fma_f32 v6, v6, v8, v10
v_fma_f32 v7, v7, v8, v10
Mvav 196,224,92
Ta 218,4,16896
v_cvt_pk_bf16_f32 v6, v6, v7
v_accvgpr_write_b32 a168, v6
s_waitcnt lgkmcnt(4)
Mvav 204,228,92
Ta 220,5,16384
v_lshlrev_b32 v246, 16, v121
v_and_b32 v247, s46, v121
Mvav 200,228,88
Ta 222,5,16896
v_fma_f32 v246, v246, v8, v10
v_fma_f32 v247, v247, v8, v10
Mvav 208,232,88
Ta 224,2,20480
GDMA 14,98,2048
v_cvt_pk_bf16_f32 v246, v246, v247
v_accvgpr_write_b32 a169, v246
Mvav 212,232,92
Ta 226,2,20992
v_lshlrev_b32 v6, 16, v122
v_and_b32 v7, s46, v122
Mvav 220,236,92
Ta 228,3,20480
v_fma_f32 v6, v6, v8, v10
v_fma_f32 v7, v7, v8, v10
Mvav 216,236,88
Ta 230,3,20992
v_cvt_pk_bf16_f32 v6, v6, v7
v_accvgpr_write_b32 a170, v6
Mvaa 160,208,144
Ta 232,4,20480
GDMA 15,98,3072
v_lshlrev_b32 v246, 16, v123
v_and_b32 v247, s46, v123
Mvaa 164,208,148
Ta 234,4,20992
v_fma_f32 v246, v246, v8, v10
v_fma_f32 v247, v247, v8, v10
s_waitcnt lgkmcnt(4)
Mvaa 172,212,148
Ta 236,5,20480
v_cvt_pk_bf16_f32 v246, v246, v247
v_accvgpr_write_b32 a171, v246
Mvaa 168,212,144
Ta 238,5,20992
v_lshlrev_b32 v6, 16, v124
v_and_b32 v7, s46, v124
Mvaa 176,216,144
Ta 208,2,24576
v_fma_f32 v6, v6, v9, v11
v_fma_f32 v7, v7, v9, v11
Mvaa 180,216,148
Ta 210,2,25088
v_cvt_pk_bf16_f32 v6, v6, v7
v_accvgpr_write_b32 a172, v6
Mvaa 188,220,148
Ta 212,3,24576
v_lshlrev_b32 v246, 16, v125
v_and_b32 v247, s46, v125
Mvaa 184,220,144
Ta 214,3,25088
v_fma_f32 v246, v246, v9, v11
v_fma_f32 v247, v247, v9, v11
Mvaa 192,224,144
Ta 216,4,24576
v_cvt_pk_bf16_f32 v246, v246, v247
v_accvgpr_write_b32 a173, v246
Mvaa 196,224,148
Ta 218,4,25088
v_lshlrev_b32 v6, 16, v126
v_and_b32 v7, s46, v126
s_waitcnt lgkmcnt(4)
Mvaa 204,228,148
Ta 220,5,24576
v_fma_f32 v6, v6, v9, v11
v_fma_f32 v7, v7, v9, v11
Mvaa 200,228,144
Ta 222,5,25088
v_cvt_pk_bf16_f32 v6, v6, v7
v_accvgpr_write_b32 a174, v6
Mvaa 208,232,144
Ta 224,2,28672
v_lshlrev_b32 v246, 16, v127
v_and_b32 v247, s46, v127
Mvaa 212,232,148
Ta 226,2,29184
v_fma_f32 v246, v246, v9, v11
v_fma_f32 v247, v247, v9, v11
Mvaa 220,236,148
Ta 228,3,28672
v_cvt_pk_bf16_f32 v246, v246, v247
v_accvgpr_write_b32 a175, v246
Mvaa 216,236,144
Ta 230,3,29184
v_lshlrev_b32 v6, 16, v128
v_and_b32 v7, s46, v128
Mvaa 160,208,152
Ta 232,4,28672
v_fma_f32 v6, v6, v8, v10
v_fma_f32 v7, v7, v8, v10
Mvaa 164,208,156
Ta 234,4,29184
v_cvt_pk_bf16_f32 v6, v6, v7
v_accvgpr_write_b32 a176, v6
s_waitcnt lgkmcnt(4)
Mvaa 172,212,156
Ta 236,5,28672
v_lshlrev_b32 v246, 16, v129
v_and_b32 v247, s46, v129
Mvaa 168,212,152
Ta 238,5,29184
v_fma_f32 v246, v246, v8, v10
v_fma_f32 v247, v247, v8, v10
s_waitcnt vmcnt(20)
s_barrier
Mvaa 176,216,152
Ta 208,2,32768
s_add_u32 m0, s35, 0x10000
v_cvt_pk_bf16_f32 v246, v246, v247
v_accvgpr_write_b32 a177, v246
Mvaa 180,216,156
Ta 210,2,33280
s_add_u32 s44, s36, 0x1b0080
v_lshlrev_b32 v6, 16, v130
v_and_b32 v7, s46, v130
Mvaa 188,220,156
Ta 212,3,32768
s_add_u32 s98, s8, s44
s_addc_u32 s99, s9, 0
v_fma_f32 v6, v6, v8, v10
v_fma_f32 v7, v7, v8, v10
Mvaa 184,220,152
Ta 214,3,33280
GDMA 12,98,0
v_cvt_pk_bf16_f32 v6, v6, v7
v_accvgpr_write_b32 a178, v6
Mvaa 192,224,152
Ta 216,4,32768
GDMA 13,98,1024
v_lshlrev_b32 v246, 16, v131
v_and_b32 v247, s46, v131
Mvaa 196,224,156
Ta 218,4,33280
v_fma_f32 v246, v246, v8, v10
v_fma_f32 v247, v247, v8, v10
s_waitcnt lgkmcnt(4)
Mvaa 204,228,156
Ta 220,5,32768
v_cvt_pk_bf16_f32 v246, v246, v247
v_accvgpr_write_b32 a179, v246
Mvaa 200,228,152
Ta 222,5,33280
v_lshlrev_b32 v6, 16, v132
v_and_b32 v7, s46, v132
Mvaa 208,232,152
Ta 224,2,36864
GDMA 14,98,2048
v_fma_f32 v6, v6, v9, v11
v_fma_f32 v7, v7, v9, v11
Mvaa 212,232,156
Ta 226,2,37376
v_cvt_pk_bf16_f32 v6, v6, v7
v_accvgpr_write_b32 a180, v6
Mvaa 220,236,156
Ta 228,3,36864
v_lshlrev_b32 v246, 16, v133
v_and_b32 v247, s46, v133
Mvaa 216,236,152
Ta 230,3,37376
v_fma_f32 v246, v246, v9, v11
v_fma_f32 v247, v247, v9, v11
Mvaa 160,208,160
Ta 232,4,36864
GDMA 15,98,3072
v_cvt_pk_bf16_f32 v246, v246, v247
v_accvgpr_write_b32 a181, v246
Mvaa 164,208,164
Ta 234,4,37376
v_lshlrev_b32 v6, 16, v134
v_and_b32 v7, s46, v134
s_waitcnt lgkmcnt(4)
Mvaa 172,212,164
Ta 236,5,36864
v_fma_f32 v6, v6, v9, v11
v_fma_f32 v7, v7, v9, v11
Mvaa 168,212,160
Ta 238,5,37376
v_cvt_pk_bf16_f32 v6, v6, v7
v_accvgpr_write_b32 a182, v6
Mvaa 176,216,160
Ta 208,2,40960
v_lshlrev_b32 v246, 16, v135
v_and_b32 v247, s46, v135
Mvaa 180,216,164
Ta 210,2,41472
v_fma_f32 v246, v246, v9, v11
v_fma_f32 v247, v247, v9, v11
Mvaa 188,220,164
Ta 212,3,40960
v_cvt_pk_bf16_f32 v246, v246, v247
v_accvgpr_write_b32 a183, v246
Mvaa 184,220,160
Ta 214,3,41472
v_lshlrev_b32 v6, 16, v136
v_and_b32 v7, s46, v136
Mvaa 192,224,160
Ta 216,4,40960
v_fma_f32 v6, v6, v8, v10
v_fma_f32 v7, v7, v8, v10
Mvaa 196,224,164
Ta 218,4,41472
v_cvt_pk_bf16_f32 v6, v6, v7
v_accvgpr_write_b32 a184, v6
s_waitcnt lgkmcnt(4)
Mvaa 204,228,164
Ta 220,5,40960
v_lshlrev_b32 v246, 16, v137
v_and_b32 v247, s46, v137
Mvaa 200,228,160
Ta 222,5,41472
v_fma_f32 v246, v246, v8, v10
v_fma_f32 v247, v247, v8, v10
Mvaa 208,232,160
Ta 224,2,45056
v_cvt_pk_bf16_f32 v246, v246, v247
v_accvgpr_write_b32 a185, v246
Mvaa 212,232,164
Ta 226,2,45568
v_lshlrev_b32 v6, 16, v138
v_and_b32 v7, s46, v138
Mvaa 220,236,164
Ta 228,3,45056
v_fma_f32 v6, v6, v8, v10
v_fma_f32 v7, v7, v8, v10
Mvaa 216,236,160
Ta 230,3,45568
v_cvt_pk_bf16_f32 v6, v6, v7
v_accvgpr_write_b32 a186, v6
Mvaa 160,208,168
Ta 232,4,45056
v_lshlrev_b32 v246, 16, v139
v_and_b32 v247, s46, v139
Mvaa 164,208,172
Ta 234,4,45568
v_fma_f32 v246, v246, v8, v10
v_fma_f32 v247, v247, v8, v10
s_waitcnt lgkmcnt(4)
Mvaa 172,212,172
Ta 236,5,45056
v_cvt_pk_bf16_f32 v246, v246, v247
v_accvgpr_write_b32 a187, v246
Mvaa 168,212,168
Ta 238,5,45568
v_lshlrev_b32 v6, 16, v140
v_and_b32 v7, s46, v140
s_waitcnt vmcnt(20)
s_barrier
Mvaa 176,216,168
Ta 208,2,49152
s_add_u32 m0, s35, 0x14000
v_fma_f32 v6, v6, v9, v11
v_fma_f32 v7, v7, v9, v11
Mvaa 180,216,172
Ta 210,2,49664
s_add_u32 s44, s36, 0x240080
v_cvt_pk_bf16_f32 v6, v6, v7
v_accvgpr_write_b32 a188, v6
Mvaa 188,220,172
Ta 212,3,49152
s_add_u32 s98, s8, s44
s_addc_u32 s99, s9, 0
v_lshlrev_b32 v246, 16, v141
v_and_b32 v247, s46, v141
Mvaa 184,220,168
Ta 214,3,49664
GDMA 12,98,0
v_fma_f32 v246, v246, v9, v11
v_fma_f32 v247, v247, v9, v11
Mvaa 192,224,168
Ta 216,4,49152
GDMA 13,98,1024
v_cvt_pk_bf16_f32 v246, v246, v247
v_accvgpr_write_b32 a189, v246
Mvaa 196,224,172
Ta 218,4,49664
v_lshlrev_b32 v6, 16, v142
v_and_b32 v7, s46, v142
s_waitcnt lgkmcnt(4)
Mvaa 204,228,172
Ta 220,5,49152
v_fma_f32 v6, v6, v9, v11
v_fma_f32 v7, v7, v9, v11
Mvaa 200,228,168
Ta 222,5,49664
v_cvt_pk_bf16_f32 v6, v6, v7
v_accvgpr_write_b32 a190, v6
Mvaa 208,232,168
Ta 224,2,53248
GDMA 14,98,2048
v_lshlrev_b32 v246, 16, v143
v_and_b32 v247, s46, v143
Mvaa 212,232,172
Ta 226,2,53760
v_fma_f32 v246, v246, v9, v11
v_fma_f32 v247, v247, v9, v11
Mvaa 220,236,172
Ta 228,3,53248
v_cvt_pk_bf16_f32 v246, v246, v247
v_accvgpr_write_b32 a191, v246
Mvaa 216,236,168
Ta 230,3,53760
v_lshlrev_b32 v6, 16, v144
v_and_b32 v7, s46, v144
Mvaa 160,208,176
Ta 232,4,53248
GDMA 15,98,3072
v_fma_f32 v6, v6, v8, v10
v_fma_f32 v7, v7, v8, v10
Mvaa 164,208,180
Ta 234,4,53760
v_cvt_pk_bf16_f32 v6, v6, v7
v_accvgpr_write_b32 a192, v6
s_waitcnt lgkmcnt(4)
Mvaa 172,212,180
Ta 236,5,53248
v_lshlrev_b32 v246, 16, v145
v_and_b32 v247, s46, v145
Mvaa 168,212,176
Ta 238,5,53760
v_fma_f32 v246, v246, v8, v10
v_fma_f32 v247, v247, v8, v10
Mvaa 176,216,176
Ta 208,2,57344
v_cvt_pk_bf16_f32 v246, v246, v247
v_accvgpr_write_b32 a193, v246
Mvaa 180,216,180
Ta 210,2,57856
v_lshlrev_b32 v6, 16, v146
v_and_b32 v7, s46, v146
Mvaa 188,220,180
Ta 212,3,57344
v_fma_f32 v6, v6, v8, v10
v_fma_f32 v7, v7, v8, v10
Mvaa 184,220,176
Ta 214,3,57856
v_cvt_pk_bf16_f32 v6, v6, v7
v_accvgpr_write_b32 a194, v6
Mvaa 192,224,176
Ta 216,4,57344
v_lshlrev_b32 v246, 16, v147
v_and_b32 v247, s46, v147
Mvaa 196,224,180
Ta 218,4,57856
v_fma_f32 v246, v246, v8, v10
v_fma_f32 v247, v247, v8, v10
s_waitcnt lgkmcnt(4)
Mvaa 204,228,180
Ta 220,5,57344
v_cvt_pk_bf16_f32 v246, v246, v247
v_accvgpr_write_b32 a195, v246
Mvaa 200,228,176
Ta 222,5,57856
v_lshlrev_b32 v6, 16, v148
v_and_b32 v7, s46, v148
Mvaa 208,232,176
Ta 224,2,61440
v_fma_f32 v6, v6, v9, v11
v_fma_f32 v7, v7, v9, v11
Mvaa 212,232,180
Ta 226,2,61952
v_xor_b32 v2, 0x10000, v2
v_cvt_pk_bf16_f32 v6, v6, v7
v_accvgpr_write_b32 a196, v6
Mvaa 220,236,180
Ta 228,3,61440
v_lshlrev_b32 v246, 16, v149
v_and_b32 v247, s46, v149
Mvaa 216,236,176
Ta 230,3,61952
v_xor_b32 v3, 0x10000, v3
v_fma_f32 v246, v246, v9, v11
v_fma_f32 v247, v247, v9, v11
Mvaa 160,208,184
Ta 232,4,61440
v_cvt_pk_bf16_f32 v246, v246, v247
v_accvgpr_write_b32 a197, v246
Mvaa 164,208,188
Ta 234,4,61952
v_xor_b32 v4, 0x10000, v4
v_lshlrev_b32 v6, 16, v150
v_and_b32 v7, s46, v150
s_waitcnt lgkmcnt(4)
Mvaa 172,212,188
Ta 236,5,61440
v_fma_f32 v6, v6, v9, v11
v_fma_f32 v7, v7, v9, v11
Mvaa 168,212,184
Ta 238,5,61952
v_xor_b32 v5, 0x10000, v5
v_cvt_pk_bf16_f32 v6, v6, v7
v_accvgpr_write_b32 a198, v6
s_waitcnt vmcnt(20)
s_barrier
Mvaa 176,216,184
Ta 208,2,0
s_add_u32 m0, s35, 0x18000
v_lshlrev_b32 v246, 16, v151
v_and_b32 v247, s46, v151
Mvaa 180,216,188
Ta 210,2,512
s_add_u32 s44, s36, 0x2d0080
v_fma_f32 v246, v246, v9, v11
v_fma_f32 v247, v247, v9, v11
Mvaa 188,220,188
Ta 212,3,0
s_add_u32 s98, s8, s44
s_addc_u32 s99, s9, 0
v_cvt_pk_bf16_f32 v246, v246, v247
v_accvgpr_write_b32 a199, v246
Mvaa 184,220,184
Ta 214,3,512
GDMA 12,98,0
v_lshlrev_b32 v6, 16, v152
v_and_b32 v7, s46, v152
Mvaa 192,224,184
Ta 216,4,0
GDMA 13,98,1024
v_fma_f32 v6, v6, v8, v10
v_fma_f32 v7, v7, v8, v10
Mvaa 196,224,188
Ta 218,4,512
v_cvt_pk_bf16_f32 v6, v6, v7
v_accvgpr_write_b32 a200, v6
s_waitcnt lgkmcnt(4)
Mvaa 204,228,188
Ta 220,5,0
v_lshlrev_b32 v246, 16, v153
v_and_b32 v247, s46, v153
Mvaa 200,228,184
Ta 222,5,512
v_fma_f32 v246, v246, v8, v10
v_fma_f32 v247, v247, v8, v10
Mvaa 208,232,184
Ta 224,2,4096
GDMA 14,98,2048
v_cvt_pk_bf16_f32 v246, v246, v247
v_accvgpr_write_b32 a201, v246
Mvaa 212,232,188
Ta 226,2,4608
v_lshlrev_b32 v6, 16, v154
v_and_b32 v7, s46, v154
Mvaa 220,236,188
Ta 228,3,4096
v_fma_f32 v6, v6, v8, v10
v_fma_f32 v7, v7, v8, v10
Mvaa 216,236,184
Ta 230,3,4608
v_cvt_pk_bf16_f32 v6, v6, v7
v_accvgpr_write_b32 a202, v6
Mvaa 160,208,192
Ta 232,4,4096
GDMA 15,98,3072
v_lshlrev_b32 v246, 16, v155
v_and_b32 v247, s46, v155
Mvaa 164,208,196
Ta 234,4,4608
v_fma_f32 v246, v246, v8, v10
v_fma_f32 v247, v247, v8, v10
s_waitcnt lgkmcnt(4)
Mvaa 172,212,196
Ta 236,5,4096
v_cvt_pk_bf16_f32 v246, v246, v247
v_accvgpr_write_b32 a203, v246
Mvaa 168,212,192
Ta 238,5,4608
v_lshlrev_b32 v6, 16, v156
v_and_b32 v7, s46, v156
Mvaa 176,216,192
Ta 208,2,8192
v_fma_f32 v6, v6, v9, v11
v_fma_f32 v7, v7, v9, v11
Mvaa 180,216,196
Ta 210,2,8704
v_cvt_pk_bf16_f32 v6, v6, v7
v_accvgpr_write_b32 a204, v6
Mvaa 188,220,196
Ta 212,3,8192
v_lshlrev_b32 v246, 16, v157
v_and_b32 v247, s46, v157
Mvaa 184,220,192
Ta 214,3,8704
v_fma_f32 v246, v246, v9, v11
v_fma_f32 v247, v247, v9, v11
Mvaa 192,224,192
Ta 216,4,8192
v_cvt_pk_bf16_f32 v246, v246, v247
v_accvgpr_write_b32 a205, v246
Mvaa 196,224,196
Ta 218,4,8704
v_lshlrev_b32 v6, 16, v158
v_and_b32 v7, s46, v158
s_waitcnt lgkmcnt(4)
Mvaa 204,228,196
Ta 220,5,8192
v_fma_f32 v6, v6, v9, v11
v_fma_f32 v7, v7, v9, v11
Mvaa 200,228,192
Ta 222,5,8704
v_cvt_pk_bf16_f32 v6, v6, v7
v_accvgpr_write_b32 a206, v6
Mvaa 208,232,192
Ta 224,2,12288
v_lshlrev_b32 v246, 16, v159
v_and_b32 v247, s46, v159
Mvaa 212,232,196
Ta 226,2,12800
v_fma_f32 v246, v246, v9, v11
v_fma_f32 v247, v247, v9, v11
Mvaa 220,236,196
Ta 228,3,12288
v_cvt_pk_bf16_f32 v246, v246, v247
v_accvgpr_write_b32 a207, v246
Mvaa 216,236,192
Ta 230,3,12800
s_lshl_b32 s81, s87, 1
Mvaa 160,208,200
Ta 232,4,12288
s_lshr_b32 s80, s3, 1
Mvaa 164,208,204
Ta 234,4,12800
s_waitcnt lgkmcnt(4)
Mvaa 172,212,204
Ta 236,5,12288
s_add_u32 s81, s81, s80
Mvaa 168,212,200
Ta 238,5,12800
s_waitcnt vmcnt(20)
s_barrier
Mvaa 176,216,200
Ta 208,2,16384
s_add_u32 m0, s35, 0x1c000
Mvaa 180,216,204
Ta 210,2,16896
s_add_u32 s44, s36, 0x360080
s_mul_i32 s81, s81, 0x28800
Mvaa 188,220,204
Ta 212,3,16384
s_add_u32 s98, s8, s44
s_addc_u32 s99, s9, 0
s_mul_i32 s80, s32, 0x480
s_add_u32 s81, s81, s80
Mvaa 184,220,200
Ta 214,3,16896
GDMA 12,98,0
v_min_u32 v253, 17, v1
Mvaa 192,224,200
Ta 216,4,16384
GDMA 13,98,1024
v_mul_u32_u24 v253, 0x2400, v253
v_add_u32 v253, s81, v253
Mvaa 196,224,204
Ta 218,4,16896
s_waitcnt lgkmcnt(4)
Mvaa 204,228,204
Ta 220,5,16384
Mvaa 200,228,200
Ta 222,5,16896
Mvaa 208,232,200
Ta 224,2,20480
GDMA 14,98,2048
Mvaa 212,232,204
Ta 226,2,20992
v_fma_f32 v224, -v160, v160, s49
Mvaa 220,236,204
Ta 228,3,20480
v_fma_f32 v225, -v161, v161, s49
Mvaa 216,236,200
Ta 230,3,20992
v_fma_f32 v226, -v162, v162, s49
Zvav 96,208,16
Ta 232,4,20480
GDMA 15,98,3072
Zvav 100,208,20
Ta 234,4,20992
s_waitcnt lgkmcnt(4)
Zvav 108,212,20
Ta 236,5,20480
v_fma_f32 v227, -v163, v163, s49
Zvav 104,212,16
Ta 238,5,20992
v_mul_f32 v224, v224, v160
Zvav 112,216,16
Ta 208,2,24576
v_mul_f32 v225, v225, v161
Zvav 116,216,20
Ta 210,2,25088
v_mul_f32 v226, v226, v162
Zvav 124,220,20
Ta 212,3,24576
v_mul_f32 v227, v227, v163
Zvav 120,220,16
Ta 214,3,25088
v_exp_f32 v224, v224
Zvav 128,224,16
Ta 216,4,24576
buffer_load_dword a242, v253, s[8:11], 0 offen offset:384
Zvav 132,224,20
Ta 218,4,25088
s_waitcnt lgkmcnt(4)
Zvav 140,228,20
Ta 220,5,24576
v_exp_f32 v225, v225
Zvav 136,228,16
Ta 222,5,25088
v_exp_f32 v226, v226
Zvav 144,232,16
Ta 224,2,28672
v_exp_f32 v227, v227
Zvav 148,232,20
Ta 226,2,29184
v_mul_f32 v160, v160, v192
Zvav 156,236,20
Ta 228,3,28672
v_mul_f32 v161, v161, v193
Zvav 152,236,16
Ta 230,3,29184
v_add_f32 v224, 1.0, v224
Mvav 96,208,24
Ta 232,4,28672
v_add_f32 v225, 1.0, v225
Mvav 100,208,28
Ta 234,4,29184
s_waitcnt lgkmcnt(4)
Mvav 108,212,28
Ta 236,5,28672
v_add_f32 v226, 1.0, v226
Mvav 104,212,24
Ta 238,5,29184
s_waitcnt vmcnt(21)
s_barrier
Mvav 112,216,24
Ta 208,2,32768
s_mov_b32 m0, s35
Mvav 116,216,28
Ta 210,2,33280
s_add_u32 s44, s36, 0x3f0080
Mvav 124,220,28
Ta 212,3,32768
s_add_u32 s98, s8, s44
s_addc_u32 s99, s9, 0
Mvav 120,220,24
Ta 214,3,33280
GDMA 12,98,0
Mvav 128,224,24
Ta 216,4,32768
GDMA 13,98,1024
v_add_f32 v227, 1.0, v227
Mvav 132,224,28
Ta 218,4,33280
v_rcp_f32 v224, v224
s_waitcnt lgkmcnt(4)
Mvav 140,228,28
Ta 220,5,32768
v_rcp_f32 v225, v225
Mvav 136,228,24
Ta 222,5,33280
v_rcp_f32 v226, v226
Mvav 144,232,24
Ta 224,2,36864
GDMA 14,98,2048
Mvav 148,232,28
Ta 226,2,37376
v_rcp_f32 v227, v227
Mvav 156,236,28
Ta 228,3,36864
v_mul_f32 v162, v162, v194
v_mul_f32 v163, v163, v195
Mvav 152,236,24
Ta 230,3,37376
v_mul_f32 v160, v160, v224
Mvav 96,208,32
Ta 232,4,36864
GDMA 15,98,3072
v_mul_f32 v161, v161, v225
v_mul_f32 v162, v162, v226
Mvav 100,208,36
Ta 234,4,37376
v_mul_f32 v163, v163, v227
s_waitcnt lgkmcnt(4)
Mvav 108,212,36
Ta 236,5,36864
v_cvt_pk_bf16_f32 v224, v160, v161
v_cvt_pk_bf16_f32 v225, v162, v163
Mvav 104,212,32
Ta 238,5,37376
v_accvgpr_write_b32 a0, v224
v_accvgpr_write_b32 a1, v225
Mvav 112,216,32
Ta 208,2,40960
v_fma_f32 v228, -v164, v164, s49
Mvav 116,216,36
Ta 210,2,41472
v_fma_f32 v229, -v165, v165, s49
Mvav 124,220,36
Ta 212,3,40960
v_fma_f32 v230, -v166, v166, s49
Mvav 120,220,32
Ta 214,3,41472
v_fma_f32 v231, -v167, v167, s49
Mvav 128,224,32
Ta 216,4,40960
v_mul_f32 v228, v228, v164
Mvav 132,224,36
Ta 218,4,41472
s_waitcnt lgkmcnt(4)
Mvav 140,228,36
Ta 220,5,40960
v_mul_f32 v229, v229, v165
Mvav 136,228,32
Ta 222,5,41472
v_mul_f32 v230, v230, v166
Mvav 144,232,32
Ta 224,2,45056
v_mul_f32 v231, v231, v167
Mvav 148,232,36
Ta 226,2,45568
v_exp_f32 v228, v228
Mvav 156,236,36
Ta 228,3,45056
v_exp_f32 v229, v229
Mvav 152,236,32
Ta 230,3,45568
v_exp_f32 v230, v230
Mvav 96,208,40
Ta 232,4,45056
v_exp_f32 v231, v231
Mvav 100,208,44
Ta 234,4,45568
s_waitcnt lgkmcnt(4)
Mvav 108,212,44
Ta 236,5,45056
v_mul_f32 v164, v164, v196
Mvav 104,212,40
Ta 238,5,45568
s_waitcnt vmcnt(21)
s_barrier
Mvav 112,216,40
Ta 208,2,49152
s_add_u32 m0, s35, 0x4000
Mvav 116,216,44
Ta 210,2,49664
s_add_u32 s44, s36, 0x480080
Mvav 124,220,44
Ta 212,3,49152
s_add_u32 s98, s8, s44
s_addc_u32 s99, s9, 0
Mvav 120,220,40
Ta 214,3,49664
GDMA 12,98,0
Mvav 128,224,40
Ta 216,4,49152
GDMA 13,98,1024
Mvav 132,224,44
Ta 218,4,49664
s_waitcnt lgkmcnt(4)
Mvav 140,228,44
Ta 220,5,49152
v_mul_f32 v165, v165, v197
v_add_f32 v228, 1.0, v228
Mvav 136,228,40
Ta 222,5,49664
v_add_f32 v229, 1.0, v229
Mvav 144,232,40
Ta 224,2,53248
GDMA 14,98,2048
v_add_f32 v230, 1.0, v230
v_add_f32 v231, 1.0, v231
Mvav 148,232,44
Ta 226,2,53760
v_rcp_f32 v228, v228
Mvav 156,236,44
Ta 228,3,53248
v_rcp_f32 v229, v229
Mvav 152,236,40
Ta 230,3,53760
v_rcp_f32 v230, v230
Mvav 96,208,48
Ta 232,4,53248
GDMA 15,98,3072
Mvav 100,208,52
Ta 234,4,53760
v_rcp_f32 v231, v231
s_waitcnt lgkmcnt(4)
Mvav 108,212,52
Ta 236,5,53248
v_mul_f32 v166, v166, v198
v_mul_f32 v167, v167, v199
Mvav 104,212,48
Ta 238,5,53760
v_mul_f32 v164, v164, v228
Mvav 112,216,48
Ta 208,2,57344
v_mul_f32 v165, v165, v229
v_mul_f32 v166, v166, v230
Mvav 116,216,52
Ta 210,2,57856
v_mul_f32 v167, v167, v231
Mvav 124,220,52
Ta 212,3,57344
v_cvt_pk_bf16_f32 v228, v164, v165
v_cvt_pk_bf16_f32 v229, v166, v167
Mvav 120,220,48
Ta 214,3,57856
v_accvgpr_write_b32 a4, v228
v_accvgpr_write_b32 a5, v229
Mvav 128,224,48
Ta 216,4,57344
v_fma_f32 v224, -v168, v168, s49
Mvav 132,224,52
Ta 218,4,57856
s_waitcnt lgkmcnt(4)
Mvav 140,228,52
Ta 220,5,57344
v_fma_f32 v225, -v169, v169, s49
Mvav 136,228,48
Ta 222,5,57856
v_fma_f32 v226, -v170, v170, s49
Mvav 144,232,48
Ta 224,2,61440
v_fma_f32 v227, -v171, v171, s49
Mvav 148,232,52
Ta 226,2,61952
v_xor_b32 v2, 0x10000, v2
Mvav 156,236,52
Ta 228,3,61440
v_mul_f32 v224, v224, v168
Mvav 152,236,48
Ta 230,3,61952
v_xor_b32 v3, 0x10000, v3
Mvav 96,208,56
Ta 232,4,61440
v_mul_f32 v225, v225, v169
Mvav 100,208,60
Ta 234,4,61952
v_xor_b32 v4, 0x10000, v4
s_waitcnt lgkmcnt(4)
Mvav 108,212,60
Ta 236,5,61440
v_mul_f32 v226, v226, v170
Mvav 104,212,56
Ta 238,5,61952
v_xor_b32 v5, 0x10000, v5
s_waitcnt vmcnt(21)
s_barrier
Mvav 112,216,56
Ta 208,2,0
s_add_u32 m0, s35, 0x8000
Mvav 116,216,60
Ta 210,2,512
s_add_u32 s44, s36, 0x100
Mvav 124,220,60
Ta 212,3,0
s_add_u32 s98, s8, s44
s_addc_u32 s99, s9, 0
Mvav 120,220,56
Ta 214,3,512
GDMA 12,98,0
v_mul_f32 v227, v227, v171
Mvav 128,224,56
Ta 216,4,0
GDMA 13,98,1024
Mvav 132,224,60
Ta 218,4,512
v_exp_f32 v224, v224
s_waitcnt lgkmcnt(4)
Mvav 140,228,60
Ta 220,5,0
v_exp_f32 v225, v225
Mvav 136,228,56
Ta 222,5,512
v_exp_f32 v226, v226
Mvav 144,232,56
Ta 224,2,4096
GDMA 14,98,2048
v_exp_f32 v227, v227
Mvav 148,232,60
Ta 226,2,4608
v_mul_f32 v168, v168, v200
Mvav 156,236,60
Ta 228,3,4096
v_mul_f32 v169, v169, v201
v_add_f32 v224, 1.0, v224
Mvav 152,236,56
Ta 230,3,4608
v_add_f32 v225, 1.0, v225
Mvav 96,208,64
Ta 232,4,4096
GDMA 15,98,3072
v_add_f32 v226, 1.0, v226
v_add_f32 v227, 1.0, v227
Mvav 100,208,68
Ta 234,4,4608
v_rcp_f32 v224, v224
s_waitcnt lgkmcnt(4)
Mvav 108,212,68
Ta 236,5,4096
v_rcp_f32 v225, v225
Mvav 104,212,64
Ta 238,5,4608
v_rcp_f32 v226, v226
Mvav 112,216,64
Ta 208,2,8192
v_rcp_f32 v227, v227
Mvav 116,216,68
Ta 210,2,8704
v_mul_f32 v170, v170, v202
Mvav 124,220,68
Ta 212,3,8192
v_mul_f32 v171, v171, v203
Mvav 120,220,64
Ta 214,3,8704
v_mul_f32 v168, v168, v224
Mvav 128,224,64
Ta 216,4,8192
v_mul_f32 v169, v169, v225
v_mul_f32 v170, v170, v226
Mvav 132,224,68
Ta 218,4,8704
v_mul_f32 v171, v171, v227
s_waitcnt lgkmcnt(4)
Mvav 140,228,68
Ta 220,5,8192
v_cvt_pk_bf16_f32 v224, v168, v169
v_cvt_pk_bf16_f32 v225, v170, v171
Mvav 136,228,64
Ta 222,5,8704
v_accvgpr_write_b32 a2, v224
v_accvgpr_write_b32 a3, v225
Mvav 144,232,64
Ta 224,2,12288
v_fma_f32 v228, -v172, v172, s49
Mvav 148,232,68
Ta 226,2,12800
v_fma_f32 v229, -v173, v173, s49
Mvav 156,236,68
Ta 228,3,12288
v_fma_f32 v230, -v174, v174, s49
Mvav 152,236,64
Ta 230,3,12800
v_fma_f32 v231, -v175, v175, s49
Mvav 96,208,72
Ta 232,4,12288
v_mul_f32 v228, v228, v172
Mvav 100,208,76
Ta 234,4,12800
s_waitcnt lgkmcnt(4)
Mvav 108,212,76
Ta 236,5,12288
v_mul_f32 v229, v229, v173
Mvav 104,212,72
Ta 238,5,12800
s_waitcnt vmcnt(21)
s_barrier
Mvav 112,216,72
Ta 208,2,16384
s_add_u32 m0, s35, 0xc000
Mvav 116,216,76
Ta 210,2,16896
s_add_u32 s44, s36, 0x90100
Mvav 124,220,76
Ta 212,3,16384
s_add_u32 s98, s8, s44
s_addc_u32 s99, s9, 0
Mvav 120,220,72
Ta 214,3,16896
GDMA 12,98,0
Mvav 128,224,72
Ta 216,4,16384
GDMA 13,98,1024
Mvav 132,224,76
Ta 218,4,16896
s_waitcnt lgkmcnt(4)
Mvav 140,228,76
Ta 220,5,16384
v_mul_f32 v230, v230, v174
Mvav 136,228,72
Ta 222,5,16896
v_mul_f32 v231, v231, v175
Mvav 144,232,72
Ta 224,2,20480
GDMA 14,98,2048
Mvav 148,232,76
Ta 226,2,20992
v_exp_f32 v228, v228
Mvav 156,236,76
Ta 228,3,20480
v_exp_f32 v229, v229
Mvav 152,236,72
Ta 230,3,20992
v_exp_f32 v230, v230
Mvav 96,208,80
Ta 232,4,20480
GDMA 15,98,3072
v_exp_f32 v231, v231
Mvav 100,208,84
Ta 234,4,20992
v_mul_f32 v172, v172, v204
s_waitcnt lgkmcnt(4)
Mvav 108,212,84
Ta 236,5,20480
v_mul_f32 v173, v173, v205
v_add_f32 v228, 1.0, v228
Mvav 104,212,80
Ta 238,5,20992
v_add_f32 v229, 1.0, v229
Mvav 112,216,80
Ta 208,2,24576
v_add_f32 v230, 1.0, v230
v_add_f32 v231, 1.0, v231
Mvav 116,216,84
Ta 210,2,25088
v_rcp_f32 v228, v228
Mvav 124,220,84
Ta 212,3,24576
v_rcp_f32 v229, v229
Mvav 120,220,80
Ta 214,3,25088
v_rcp_f32 v230, v230
Mvav 128,224,80
Ta 216,4,24576
v_rcp_f32 v231, v231
Mvav 132,224,84
Ta 218,4,25088
s_waitcnt lgkmcnt(4)
Mvav 140,228,84
Ta 220,5,24576
v_mul_f32 v174, v174, v206
v_mul_f32 v175, v175, v207
Mvav 136,228,80
Ta 222,5,25088
v_mul_f32 v172, v172, v228
Mvav 144,232,80
Ta 224,2,28672
v_mul_f32 v173, v173, v229
v_mul_f32 v174, v174, v230
Mvav 148,232,84
Ta 226,2,29184
v_mul_f32 v175, v175, v231
Mvav 156,236,84
Ta 228,3,28672
v_cvt_pk_bf16_f32 v228, v172, v173
v_cvt_pk_bf16_f32 v229, v174, v175
Mvav 152,236,80
Ta 230,3,29184
v_accvgpr_write_b32 a6, v228
v_accvgpr_write_b32 a7, v229
Mvav 96,208,88
Ta 232,4,28672
v_fma_f32 v224, -v176, v176, s49
Mvav 100,208,92
Ta 234,4,29184
s_waitcnt lgkmcnt(4)
Mvav 108,212,92
Ta 236,5,28672
v_fma_f32 v225, -v177, v177, s49
Mvav 104,212,88
Ta 238,5,29184
s_waitcnt vmcnt(21)
s_barrier
Mvav 112,216,88
Ta 208,2,32768
s_add_u32 m0, s35, 0x10000
Mvav 116,216,92
Ta 210,2,33280
s_add_u32 s44, s36, 0x120100
Mvav 124,220,92
Ta 212,3,32768
s_add_u32 s98, s8, s44
s_addc_u32 s99, s9, 0
Mvav 120,220,88
Ta 214,3,33280
GDMA 12,98,0
Mvav 128,224,88
Ta 216,4,32768
GDMA 13,98,1024
Mvav 132,224,92
Ta 218,4,33280
s_waitcnt lgkmcnt(4)
Mvav 140,228,92
Ta 220,5,32768
v_fma_f32 v226, -v178, v178, s49
Mvav 136,228,88
Ta 222,5,33280
v_fma_f32 v227, -v179, v179, s49
Mvav 144,232,88
Ta 224,2,36864
GDMA 14,98,2048
Mvav 148,232,92
Ta 226,2,37376
v_mul_f32 v224, v224, v176
Mvav 156,236,92
Ta 228,3,36864
v_mul_f32 v225, v225, v177
Mvav 152,236,88
Ta 230,3,37376
v_mul_f32 v226, v226, v178
v_mul_f32 v227, v227, v179
Mvaa 96,208,144
Ta 232,4,36864
GDMA 15,98,3072
Mvaa 100,208,148
Ta 234,4,37376
v_exp_f32 v224, v224
s_waitcnt lgkmcnt(4)
Mvaa 108,212,148
Ta 236,5,36864
v_exp_f32 v225, v225
Mvaa 104,212,144
Ta 238,5,37376
v_exp_f32 v226, v226
Mvaa 112,216,144
Ta 208,2,40960
v_exp_f32 v227, v227
Mvaa 116,216,148
Ta 210,2,41472
v_mul_f32 v176, v176, v208
Mvaa 124,220,148
Ta 212,3,40960
v_mul_f32 v177, v177, v209
v_add_f32 v224, 1.0, v224
Mvaa 120,220,144
Ta 214,3,41472
v_add_f32 v225, 1.0, v225
Mvaa 128,224,144
Ta 216,4,40960
v_add_f32 v226, 1.0, v226
v_add_f32 v227, 1.0, v227
Mvaa 132,224,148
Ta 218,4,41472
v_rcp_f32 v224, v224
s_waitcnt lgkmcnt(4)
Mvaa 140,228,148
Ta 220,5,40960
v_rcp_f32 v225, v225
Mvaa 136,228,144
Ta 222,5,41472
v_rcp_f32 v226, v226
Mvaa 144,232,144
Ta 224,2,45056
v_rcp_f32 v227, v227
Mvaa 148,232,148
Ta 226,2,45568
v_mul_f32 v178, v178, v210
Mvaa 156,236,148
Ta 228,3,45056
v_mul_f32 v179, v179, v211
Mvaa 152,236,144
Ta 230,3,45568
v_mul_f32 v176, v176, v224
Mvaa 96,208,152
Ta 232,4,45056
v_mul_f32 v177, v177, v225
v_mul_f32 v178, v178, v226
Mvaa 100,208,156
Ta 234,4,45568
v_mul_f32 v179, v179, v227
s_waitcnt lgkmcnt(4)
Mvaa 108,212,156
Ta 236,5,45056
v_cvt_pk_bf16_f32 v224, v176, v177
v_cvt_pk_bf16_f32 v225, v178, v179
Mvaa 104,212,152
Ta 238,5,45568
v_accvgpr_write_b32 a8, v224
v_accvgpr_write_b32 a9, v225
s_waitcnt vmcnt(21)
s_barrier
Mvaa 112,216,152
Ta 208,2,49152
s_add_u32 m0, s35, 0x14000
Mvaa 116,216,156
Ta 210,2,49664
s_add_u32 s44, s36, 0x1b0100
Mvaa 124,220,156
Ta 212,3,49152
s_add_u32 s98, s8, s44
s_addc_u32 s99, s9, 0
Mvaa 120,220,152
Ta 214,3,49664
GDMA 12,98,0
Mvaa 128,224,152
Ta 216,4,49152
GDMA 13,98,1024
Mvaa 132,224,156
Ta 218,4,49664
s_waitcnt lgkmcnt(4)
Mvaa 140,228,156
Ta 220,5,49152
v_fma_f32 v228, -v180, v180, s49
Mvaa 136,228,152
Ta 222,5,49664
v_fma_f32 v229, -v181, v181, s49
Mvaa 144,232,152
Ta 224,2,53248
GDMA 14,98,2048
Mvaa 148,232,156
Ta 226,2,53760
v_fma_f32 v230, -v182, v182, s49
Mvaa 156,236,156
Ta 228,3,53248
v_fma_f32 v231, -v183, v183, s49
Mvaa 152,236,152
Ta 230,3,53760
v_mul_f32 v228, v228, v180
Mvaa 96,208,160
Ta 232,4,53248
GDMA 15,98,3072
Mvaa 100,208,164
Ta 234,4,53760
s_waitcnt lgkmcnt(4)
Mvaa 108,212,164
Ta 236,5,53248
v_mul_f32 v229, v229, v181
Mvaa 104,212,160
Ta 238,5,53760
v_mul_f32 v230, v230, v182
v_mul_f32 v231, v231, v183
Mvaa 112,216,160
Ta 208,2,57344
v_exp_f32 v228, v228
Mvaa 116,216,164
Ta 210,2,57856
v_exp_f32 v229, v229
Mvaa 124,220,164
Ta 212,3,57344
v_exp_f32 v230, v230
Mvaa 120,220,160
Ta 214,3,57856
v_exp_f32 v231, v231
Mvaa 128,224,160
Ta 216,4,57344
v_mul_f32 v180, v180, v212
Mvaa 132,224,164
Ta 218,4,57856
s_waitcnt lgkmcnt(4)
Mvaa 140,228,164
Ta 220,5,57344
v_mul_f32 v181, v181, v213
v_add_f32 v228, 1.0, v228
Mvaa 136,228,160
Ta 222,5,57856
v_add_f32 v229, 1.0, v229
Mvaa 144,232,160
Ta 224,2,61440
v_add_f32 v230, 1.0, v230
v_add_f32 v231, 1.0, v231
Mvaa 148,232,164
Ta 226,2,61952
v_xor_b32 v2, 0x10000, v2
v_rcp_f32 v228, v228
Mvaa 156,236,164
Ta 228,3,61440
v_rcp_f32 v229, v229
Mvaa 152,236,160
Ta 230,3,61952
v_xor_b32 v3, 0x10000, v3
Mvaa 96,208,168
Ta 232,4,61440
v_rcp_f32 v230, v230
Mvaa 100,208,172
Ta 234,4,61952
v_xor_b32 v4, 0x10000, v4
v_rcp_f32 v231, v231
s_waitcnt lgkmcnt(4)
Mvaa 108,212,172
Ta 236,5,61440
v_mul_f32 v182, v182, v214
v_mul_f32 v183, v183, v215
Mvaa 104,212,168
Ta 238,5,61952
v_xor_b32 v5, 0x10000, v5
v_mul_f32 v180, v180, v228
s_waitcnt vmcnt(20)
s_barrier
Mvaa 112,216,168
Ta 208,2,0
s_add_u32 m0, s35, 0x18000
v_mul_f32 v181, v181, v229
v_mul_f32 v182, v182, v230
Mvaa 116,216,172
Ta 210,2,512
s_add_u32 s44, s36, 0x240100
v_mul_f32 v183, v183, v231
Mvaa 124,220,172
Ta 212,3,0
s_add_u32 s98, s8, s44
s_addc_u32 s99, s9, 0
v_cvt_pk_bf16_f32 v228, v180, v181
v_cvt_pk_bf16_f32 v229, v182, v183
Mvaa 120,220,168
Ta 214,3,512
GDMA 12,98,0
v_accvgpr_write_b32 a12, v228
v_accvgpr_write_b32 a13, v229
Mvaa 128,224,168
Ta 216,4,0
GDMA 13,98,1024
Mvaa 132,224,172
Ta 218,4,512
s_waitcnt lgkmcnt(4)
Mvaa 140,228,172
Ta 220,5,0
v_fma_f32 v224, -v184, v184, s49
Mvaa 136,228,168
Ta 222,5,512
v_fma_f32 v225, -v185, v185, s49
Mvaa 144,232,168
Ta 224,2,4096
GDMA 14,98,2048
Mvaa 148,232,172
Ta 226,2,4608
v_fma_f32 v226, -v186, v186, s49
Mvaa 156,236,172
Ta 228,3,4096
v_fma_f32 v227, -v187, v187, s49
Mvaa 152,236,168
Ta 230,3,4608
v_mul_f32 v224, v224, v184
Mvaa 96,208,176
Ta 232,4,4096
GDMA 15,98,3072
Mvaa 100,208,180
Ta 234,4,4608
s_waitcnt lgkmcnt(4)
Mvaa 108,212,180
Ta 236,5,4096
v_mul_f32 v225, v225, v185
Mvaa 104,212,176
Ta 238,5,4608
v_mul_f32 v226, v226, v186
Mvaa 112,216,176
Ta 208,2,8192
v_mul_f32 v227, v227, v187
Mvaa 116,216,180
Ta 210,2,8704
v_exp_f32 v224, v224
Mvaa 124,220,180
Ta 212,3,8192
v_exp_f32 v225, v225
Mvaa 120,220,176
Ta 214,3,8704
v_exp_f32 v226, v226
Mvaa 128,224,176
Ta 216,4,8192
v_exp_f32 v227, v227
Mvaa 132,224,180
Ta 218,4,8704
s_waitcnt lgkmcnt(4)
Mvaa 140,228,180
Ta 220,5,8192
v_mul_f32 v184, v184, v216
Mvaa 136,228,176
Ta 222,5,8704
v_mul_f32 v185, v185, v217
Mvaa 144,232,176
Ta 224,2,12288
v_add_f32 v224, 1.0, v224
Mvaa 148,232,180
Ta 226,2,12800
v_add_f32 v225, 1.0, v225
Mvaa 156,236,180
Ta 228,3,12288
v_add_f32 v226, 1.0, v226
Mvaa 152,236,176
Ta 230,3,12800
v_add_f32 v227, 1.0, v227
Mvaa 96,208,184
Ta 232,4,12288
v_rcp_f32 v224, v224
Mvaa 100,208,188
Ta 234,4,12800
s_waitcnt lgkmcnt(4)
Mvaa 108,212,188
Ta 236,5,12288
v_rcp_f32 v225, v225
Mvaa 104,212,184
Ta 238,5,12800
s_waitcnt vmcnt(20)
s_barrier
Mvaa 112,216,184
Ta 208,2,16384
s_add_u32 m0, s35, 0x1c000
v_rcp_f32 v226, v226
Mvaa 116,216,188
Ta 210,2,16896
s_add_u32 s44, s36, 0x2d0100
v_rcp_f32 v227, v227
Mvaa 124,220,188
Ta 212,3,16384
s_add_u32 s98, s8, s44
s_addc_u32 s99, s9, 0
v_mul_f32 v186, v186, v218
v_mul_f32 v187, v187, v219
Mvaa 120,220,184
Ta 214,3,16896
GDMA 12,98,0
v_mul_f32 v184, v184, v224
Mvaa 128,224,184
Ta 216,4,16384
GDMA 13,98,1024
v_mul_f32 v185, v185, v225
v_mul_f32 v186, v186, v226
Mvaa 132,224,188
Ta 218,4,16896
v_mul_f32 v187, v187, v227
s_waitcnt lgkmcnt(4)
Mvaa 140,228,188
Ta 220,5,16384
v_cvt_pk_bf16_f32 v224, v184, v185
v_cvt_pk_bf16_f32 v225, v186, v187
Mvaa 136,228,184
Ta 222,5,16896
v_accvgpr_write_b32 a10, v224
v_accvgpr_write_b32 a11, v225
Mvaa 144,232,184
Ta 224,2,20480
GDMA 14,98,2048
Mvaa 148,232,188
Ta 226,2,20992
v_fma_f32 v228, -v188, v188, s49
Mvaa 156,236,188
Ta 228,3,20480
v_fma_f32 v229, -v189, v189, s49
Mvaa 152,236,184
Ta 230,3,20992
v_fma_f32 v230, -v190, v190, s49
Mvaa 96,208,192
Ta 232,4,20480
GDMA 15,98,3072
Mvaa 100,208,196
Ta 234,4,20992
s_waitcnt lgkmcnt(4)
Mvaa 108,212,196
Ta 236,5,20480
v_fma_f32 v231, -v191, v191, s49
Mvaa 104,212,192
Ta 238,5,20992
v_mul_f32 v228, v228, v188
Mvaa 112,216,192
Ta 208,2,24576
v_mul_f32 v229, v229, v189
Mvaa 116,216,196
Ta 210,2,25088
v_mul_f32 v230, v230, v190
Mvaa 124,220,196
Ta 212,3,24576
v_mul_f32 v231, v231, v191
Mvaa 120,220,192
Ta 214,3,25088
v_exp_f32 v228, v228
Mvaa 128,224,192
Ta 216,4,24576
v_exp_f32 v229, v229
Mvaa 132,224,196
Ta 218,4,25088
s_waitcnt lgkmcnt(4)
Mvaa 140,228,196
Ta 220,5,24576
v_exp_f32 v230, v230
Mvaa 136,228,192
Ta 222,5,25088
v_exp_f32 v231, v231
Mvaa 144,232,192
Ta 224,2,28672
v_mul_f32 v188, v188, v220
Mvaa 148,232,196
Ta 226,2,29184
v_mul_f32 v189, v189, v221
Mvaa 156,236,196
Ta 228,3,28672
v_add_f32 v228, 1.0, v228
Mvaa 152,236,192
Ta 230,3,29184
v_add_f32 v229, 1.0, v229
Mvaa 96,208,200
Ta 232,4,28672
v_add_f32 v230, 1.0, v230
Mvaa 100,208,204
Ta 234,4,29184
s_waitcnt lgkmcnt(4)
Mvaa 108,212,204
Ta 236,5,28672
v_add_f32 v231, 1.0, v231
Mvaa 104,212,200
Ta 238,5,29184
s_waitcnt vmcnt(20)
s_barrier
Mvaa 112,216,200
Ta 208,2,32768
s_mov_b32 m0, s35
Mvaa 116,216,204
Ta 210,2,33280
s_add_u32 s44, s36, 0x360100
v_rcp_f32 v228, v228
Mvaa 124,220,204
Ta 212,3,32768
s_add_u32 s98, s8, s44
s_addc_u32 s99, s9, 0
Mvaa 120,220,200
Ta 214,3,33280
GDMA 12,98,0
v_rcp_f32 v229, v229
Mvaa 128,224,200
Ta 216,4,32768
GDMA 13,98,1024
v_rcp_f32 v230, v230
Mvaa 132,224,204
Ta 218,4,33280
v_rcp_f32 v231, v231
s_waitcnt lgkmcnt(4)
Mvaa 140,228,204
Ta 220,5,32768
v_mul_f32 v190, v190, v222
v_mul_f32 v191, v191, v223
Mvaa 136,228,200
Ta 222,5,33280
v_mul_f32 v188, v188, v228
Mvaa 144,232,200
Ta 224,2,36864
GDMA 14,98,2048
v_mul_f32 v189, v189, v229
v_mul_f32 v190, v190, v230
Mvaa 148,232,204
Ta 226,2,37376
v_mul_f32 v191, v191, v231
Mvaa 156,236,204
Ta 228,3,36864
v_cvt_pk_bf16_f32 v228, v188, v189
v_cvt_pk_bf16_f32 v229, v190, v191
Mvaa 152,236,200
Ta 230,3,37376
v_accvgpr_write_b32 a14, v228
v_accvgpr_write_b32 a15, v229
Zvav 160,208,16
Ta 232,4,36864
GDMA 15,98,3072
Zvav 164,208,20
Ta 234,4,37376
s_waitcnt lgkmcnt(4)
Zvav 172,212,20
Ta 236,5,36864
v_fma_f32 v224, -v96, v96, s49
Zvav 168,212,16
Ta 238,5,37376
v_fma_f32 v225, -v97, v97, s49
Zvav 176,216,16
Ta 208,2,40960
v_fma_f32 v226, -v98, v98, s49
Zvav 180,216,20
Ta 210,2,41472
v_fma_f32 v227, -v99, v99, s49
Zvav 188,220,20
Ta 212,3,40960
v_mul_f32 v224, v224, v96
Zvav 184,220,16
Ta 214,3,41472
v_mul_f32 v225, v225, v97
Zvav 192,224,16
Ta 216,4,40960
buffer_load_dword a241, v253, s[8:11], 0 offen offset:512
Zvav 196,224,20
Ta 218,4,41472
s_waitcnt lgkmcnt(4)
Zvav 204,228,20
Ta 220,5,40960
v_mul_f32 v226, v226, v98
Zvav 200,228,16
Ta 222,5,41472
v_mul_f32 v227, v227, v99
Zvav 208,232,16
Ta 224,2,45056
v_exp_f32 v224, v224
Zvav 212,232,20
Ta 226,2,45568
v_exp_f32 v225, v225
Zvav 220,236,20
Ta 228,3,45056
v_exp_f32 v226, v226
Zvav 216,236,16
Ta 230,3,45568
v_exp_f32 v227, v227
Mvav 160,208,24
Ta 232,4,45056
v_mul_f32 v96, v96, v128
Mvav 164,208,28
Ta 234,4,45568
s_waitcnt lgkmcnt(4)
Mvav 172,212,28
Ta 236,5,45056
v_mul_f32 v97, v97, v129
Mvav 168,212,24
Ta 238,5,45568
s_waitcnt vmcnt(21)
s_barrier
Mvav 176,216,24
Ta 208,2,49152
s_add_u32 m0, s35, 0x4000
Mvav 180,216,28
Ta 210,2,49664
s_add_u32 s44, s36, 0x3f0100
Mvav 188,220,28
Ta 212,3,49152
s_add_u32 s98, s8, s44
s_addc_u32 s99, s9, 0
v_add_f32 v224, 1.0, v224
Mvav 184,220,24
Ta 214,3,49664
GDMA 12,98,0
v_add_f32 v225, 1.0, v225
Mvav 192,224,24
Ta 216,4,49152
GDMA 13,98,1024
v_add_f32 v226, 1.0, v226
v_add_f32 v227, 1.0, v227
Mvav 196,224,28
Ta 218,4,49664
v_rcp_f32 v224, v224
s_waitcnt lgkmcnt(4)
Mvav 204,228,28
Ta 220,5,49152
v_rcp_f32 v225, v225
Mvav 200,228,24
Ta 222,5,49664
v_rcp_f32 v226, v226
Mvav 208,232,24
Ta 224,2,53248
GDMA 14,98,2048
Mvav 212,232,28
Ta 226,2,53760
v_rcp_f32 v227, v227
Mvav 220,236,28
Ta 228,3,53248
v_mul_f32 v98, v98, v130
v_mul_f32 v99, v99, v131
Mvav 216,236,24
Ta 230,3,53760
v_mul_f32 v96, v96, v224
Mvav 160,208,32
Ta 232,4,53248
GDMA 15,98,3072
v_mul_f32 v97, v97, v225
v_mul_f32 v98, v98, v226
Mvav 164,208,36
Ta 234,4,53760
v_mul_f32 v99, v99, v227
s_waitcnt lgkmcnt(4)
Mvav 172,212,36
Ta 236,5,53248
v_cvt_pk_bf16_f32 v224, v96, v97
v_cvt_pk_bf16_f32 v225, v98, v99
Mvav 168,212,32
Ta 238,5,53760
v_accvgpr_write_b32 a16, v224
v_accvgpr_write_b32 a17, v225
Mvav 176,216,32
Ta 208,2,57344
v_fma_f32 v228, -v100, v100, s49
Mvav 180,216,36
Ta 210,2,57856
v_fma_f32 v229, -v101, v101, s49
Mvav 188,220,36
Ta 212,3,57344
v_fma_f32 v230, -v102, v102, s49
Mvav 184,220,32
Ta 214,3,57856
v_fma_f32 v231, -v103, v103, s49
Mvav 192,224,32
Ta 216,4,57344
v_mul_f32 v228, v228, v100
Mvav 196,224,36
Ta 218,4,57856
s_waitcnt lgkmcnt(4)
Mvav 204,228,36
Ta 220,5,57344
v_mul_f32 v229, v229, v101
Mvav 200,228,32
Ta 222,5,57856
v_mul_f32 v230, v230, v102
Mvav 208,232,32
Ta 224,2,61440
v_mul_f32 v231, v231, v103
Mvav 212,232,36
Ta 226,2,61952
v_xor_b32 v2, 0x10000, v2
Mvav 220,236,36
Ta 228,3,61440
v_exp_f32 v228, v228
Mvav 216,236,32
Ta 230,3,61952
v_xor_b32 v3, 0x10000, v3
Mvav 160,208,40
Ta 232,4,61440
v_exp_f32 v229, v229
Mvav 164,208,44
Ta 234,4,61952
v_xor_b32 v4, 0x10000, v4
s_waitcnt lgkmcnt(4)
Mvav 172,212,44
Ta 236,5,61440
v_exp_f32 v230, v230
Mvav 168,212,40
Ta 238,5,61952
v_xor_b32 v5, 0x10000, v5
s_waitcnt vmcnt(21)
s_barrier
Mvav 176,216,40
Ta 208,2,0
s_add_u32 m0, s35, 0x8000
Mvav 180,216,44
Ta 210,2,512
s_add_u32 s44, s36, 0x480100
Mvav 188,220,44
Ta 212,3,0
s_add_u32 s98, s8, s44
s_addc_u32 s99, s9, 0
Mvav 184,220,40
Ta 214,3,512
GDMA 12,98,0
Mvav 192,224,40
Ta 216,4,0
GDMA 13,98,1024
v_exp_f32 v231, v231
Mvav 196,224,44
Ta 218,4,512
v_mul_f32 v100, v100, v132
s_waitcnt lgkmcnt(4)
Mvav 204,228,44
Ta 220,5,0
v_mul_f32 v101, v101, v133
v_add_f32 v228, 1.0, v228
Mvav 200,228,40
Ta 222,5,512
v_add_f32 v229, 1.0, v229
Mvav 208,232,40
Ta 224,2,4096
GDMA 14,98,2048
v_add_f32 v230, 1.0, v230
v_add_f32 v231, 1.0, v231
Mvav 212,232,44
Ta 226,2,4608
v_rcp_f32 v228, v228
Mvav 220,236,44
Ta 228,3,4096
v_rcp_f32 v229, v229
Mvav 216,236,40
Ta 230,3,4608
v_rcp_f32 v230, v230
Mvav 160,208,48
Ta 232,4,4096
GDMA 15,98,3072
Mvav 164,208,52
Ta 234,4,4608
v_rcp_f32 v231, v231
s_waitcnt lgkmcnt(4)
Mvav 172,212,52
Ta 236,5,4096
v_mul_f32 v102, v102, v134
v_mul_f32 v103, v103, v135
Mvav 168,212,48
Ta 238,5,4608
v_mul_f32 v100, v100, v228
Mvav 176,216,48
Ta 208,2,8192
v_mul_f32 v101, v101, v229
v_mul_f32 v102, v102, v230
Mvav 180,216,52
Ta 210,2,8704
v_mul_f32 v103, v103, v231
Mvav 188,220,52
Ta 212,3,8192
v_cvt_pk_bf16_f32 v228, v100, v101
v_cvt_pk_bf16_f32 v229, v102, v103
Mvav 184,220,48
Ta 214,3,8704
v_accvgpr_write_b32 a20, v228
v_accvgpr_write_b32 a21, v229
Mvav 192,224,48
Ta 216,4,8192
v_fma_f32 v224, -v104, v104, s49
Mvav 196,224,52
Ta 218,4,8704
s_waitcnt lgkmcnt(4)
Mvav 204,228,52
Ta 220,5,8192
v_fma_f32 v225, -v105, v105, s49
Mvav 200,228,48
Ta 222,5,8704
v_fma_f32 v226, -v106, v106, s49
Mvav 208,232,48
Ta 224,2,12288
v_fma_f32 v227, -v107, v107, s49
Mvav 212,232,52
Ta 226,2,12800
v_mul_f32 v224, v224, v104
Mvav 220,236,52
Ta 228,3,12288
v_mul_f32 v225, v225, v105
Mvav 216,236,48
Ta 230,3,12800
v_mul_f32 v226, v226, v106
Mvav 160,208,56
Ta 232,4,12288
v_mul_f32 v227, v227, v107
Mvav 164,208,60
Ta 234,4,12800
s_waitcnt lgkmcnt(4)
Mvav 172,212,60
Ta 236,5,12288
v_exp_f32 v224, v224
Mvav 168,212,56
Ta 238,5,12800
s_waitcnt vmcnt(21)
s_barrier
Mvav 176,216,56
Ta 208,2,16384
s_add_u32 m0, s35, 0xc000
Mvav 180,216,60
Ta 210,2,16896
s_add_u32 s44, s36, 0x180
Mvav 188,220,60
Ta 212,3,16384
s_add_u32 s98, s8, s44
s_addc_u32 s99, s9, 0
Mvav 184,220,56
Ta 214,3,16896
GDMA 12,98,0
Mvav 192,224,56
Ta 216,4,16384
GDMA 13,98,1024
Mvav 196,224,60
Ta 218,4,16896
s_waitcnt lgkmcnt(4)
Mvav 204,228,60
Ta 220,5,16384
v_exp_f32 v225, v225
Mvav 200,228,56
Ta 222,5,16896
v_exp_f32 v226, v226
Mvav 208,232,56
Ta 224,2,20480
GDMA 14,98,2048
v_exp_f32 v227, v227
Mvav 212,232,60
Ta 226,2,20992
v_mul_f32 v104, v104, v136
Mvav 220,236,60
Ta 228,3,20480
v_mul_f32 v105, v105, v137
v_add_f32 v224, 1.0, v224
Mvav 216,236,56
Ta 230,3,20992
v_add_f32 v225, 1.0, v225
Mvav 160,208,64
Ta 232,4,20480
GDMA 15,98,3072
v_add_f32 v226, 1.0, v226
v_add_f32 v227, 1.0, v227
Mvav 164,208,68
Ta 234,4,20992
v_rcp_f32 v224, v224
s_waitcnt lgkmcnt(4)
Mvav 172,212,68
Ta 236,5,20480
v_rcp_f32 v225, v225
Mvav 168,212,64
Ta 238,5,20992
v_rcp_f32 v226, v226
Mvav 176,216,64
Ta 208,2,24576
v_rcp_f32 v227, v227
Mvav 180,216,68
Ta 210,2,25088
v_mul_f32 v106, v106, v138
Mvav 188,220,68
Ta 212,3,24576
v_mul_f32 v107, v107, v139
Mvav 184,220,64
Ta 214,3,25088
v_mul_f32 v104, v104, v224
Mvav 192,224,64
Ta 216,4,24576
v_mul_f32 v105, v105, v225
v_mul_f32 v106, v106, v226
Mvav 196,224,68
Ta 218,4,25088
v_mul_f32 v107, v107, v227
s_waitcnt lgkmcnt(4)
Mvav 204,228,68
Ta 220,5,24576
v_cvt_pk_bf16_f32 v224, v104, v105
v_cvt_pk_bf16_f32 v225, v106, v107
Mvav 200,228,64
Ta 222,5,25088
v_accvgpr_write_b32 a18, v224
v_accvgpr_write_b32 a19, v225
Mvav 208,232,64
Ta 224,2,28672
v_fma_f32 v228, -v108, v108, s49
Mvav 212,232,68
Ta 226,2,29184
v_fma_f32 v229, -v109, v109, s49
Mvav 220,236,68
Ta 228,3,28672
v_fma_f32 v230, -v110, v110, s49
Mvav 216,236,64
Ta 230,3,29184
v_fma_f32 v231, -v111, v111, s49
Mvav 160,208,72
Ta 232,4,28672
v_mul_f32 v228, v228, v108
Mvav 164,208,76
Ta 234,4,29184
s_waitcnt lgkmcnt(4)
Mvav 172,212,76
Ta 236,5,28672
v_mul_f32 v229, v229, v109
Mvav 168,212,72
Ta 238,5,29184
s_waitcnt vmcnt(21)
s_barrier
Mvav 176,216,72
Ta 208,2,32768
s_add_u32 m0, s35, 0x10000
Mvav 180,216,76
Ta 210,2,33280
s_add_u32 s44, s36, 0x90180
Mvav 188,220,76
Ta 212,3,32768
s_add_u32 s98, s8, s44
s_addc_u32 s99, s9, 0
Mvav 184,220,72
Ta 214,3,33280
GDMA 12,98,0
Mvav 192,224,72
Ta 216,4,32768
GDMA 13,98,1024
Mvav 196,224,76
Ta 218,4,33280
s_waitcnt lgkmcnt(4)
Mvav 204,228,76
Ta 220,5,32768
v_mul_f32 v230, v230, v110
Mvav 200,228,72
Ta 222,5,33280
v_mul_f32 v231, v231, v111
Mvav 208,232,72
Ta 224,2,36864
GDMA 14,98,2048
Mvav 212,232,76
Ta 226,2,37376
v_exp_f32 v228, v228
Mvav 220,236,76
Ta 228,3,36864
v_exp_f32 v229, v229
Mvav 216,236,72
Ta 230,3,37376
v_exp_f32 v230, v230
Mvav 160,208,80
Ta 232,4,36864
GDMA 15,98,3072
v_exp_f32 v231, v231
Mvav 164,208,84
Ta 234,4,37376
v_mul_f32 v108, v108, v140
s_waitcnt lgkmcnt(4)
Mvav 172,212,84
Ta 236,5,36864
v_mul_f32 v109, v109, v141
v_add_f32 v228, 1.0, v228
Mvav 168,212,80
Ta 238,5,37376
v_add_f32 v229, 1.0, v229
Mvav 176,216,80
Ta 208,2,40960
v_add_f32 v230, 1.0, v230
v_add_f32 v231, 1.0, v231
Mvav 180,216,84
Ta 210,2,41472
v_rcp_f32 v228, v228
Mvav 188,220,84
Ta 212,3,40960
v_rcp_f32 v229, v229
Mvav 184,220,80
Ta 214,3,41472
v_rcp_f32 v230, v230
Mvav 192,224,80
Ta 216,4,40960
v_rcp_f32 v231, v231
Mvav 196,224,84
Ta 218,4,41472
s_waitcnt lgkmcnt(4)
Mvav 204,228,84
Ta 220,5,40960
v_mul_f32 v110, v110, v142
v_mul_f32 v111, v111, v143
Mvav 200,228,80
Ta 222,5,41472
v_mul_f32 v108, v108, v228
Mvav 208,232,80
Ta 224,2,45056
v_mul_f32 v109, v109, v229
v_mul_f32 v110, v110, v230
Mvav 212,232,84
Ta 226,2,45568
v_mul_f32 v111, v111, v231
Mvav 220,236,84
Ta 228,3,45056
v_cvt_pk_bf16_f32 v228, v108, v109
v_cvt_pk_bf16_f32 v229, v110, v111
Mvav 216,236,80
Ta 230,3,45568
v_accvgpr_write_b32 a22, v228
v_accvgpr_write_b32 a23, v229
Mvav 160,208,88
Ta 232,4,45056
v_fma_f32 v224, -v112, v112, s49
Mvav 164,208,92
Ta 234,4,45568
s_waitcnt lgkmcnt(4)
Mvav 172,212,92
Ta 236,5,45056
v_fma_f32 v225, -v113, v113, s49
Mvav 168,212,88
Ta 238,5,45568
s_waitcnt vmcnt(21)
s_barrier
Mvav 176,216,88
Ta 208,2,49152
s_add_u32 m0, s35, 0x14000
Mvav 180,216,92
Ta 210,2,49664
s_add_u32 s44, s36, 0x120180
Mvav 188,220,92
Ta 212,3,49152
s_add_u32 s98, s8, s44
s_addc_u32 s99, s9, 0
Mvav 184,220,88
Ta 214,3,49664
GDMA 12,98,0
Mvav 192,224,88
Ta 216,4,49152
GDMA 13,98,1024
Mvav 196,224,92
Ta 218,4,49664
s_waitcnt lgkmcnt(4)
Mvav 204,228,92
Ta 220,5,49152
v_fma_f32 v226, -v114, v114, s49
Mvav 200,228,88
Ta 222,5,49664
v_fma_f32 v227, -v115, v115, s49
Mvav 208,232,88
Ta 224,2,53248
GDMA 14,98,2048
Mvav 212,232,92
Ta 226,2,53760
v_mul_f32 v224, v224, v112
Mvav 220,236,92
Ta 228,3,53248
v_mul_f32 v225, v225, v113
Mvav 216,236,88
Ta 230,3,53760
v_mul_f32 v226, v226, v114
v_mul_f32 v227, v227, v115
Mvaa 160,208,144
Ta 232,4,53248
GDMA 15,98,3072
Mvaa 164,208,148
Ta 234,4,53760
v_exp_f32 v224, v224
s_waitcnt lgkmcnt(4)
Mvaa 172,212,148
Ta 236,5,53248
v_exp_f32 v225, v225
Mvaa 168,212,144
Ta 238,5,53760
v_exp_f32 v226, v226
Mvaa 176,216,144
Ta 208,2,57344
v_exp_f32 v227, v227
Mvaa 180,216,148
Ta 210,2,57856
v_mul_f32 v112, v112, v144
Mvaa 188,220,148
Ta 212,3,57344
v_mul_f32 v113, v113, v145
v_add_f32 v224, 1.0, v224
Mvaa 184,220,144
Ta 214,3,57856
v_add_f32 v225, 1.0, v225
Mvaa 192,224,144
Ta 216,4,57344
v_add_f32 v226, 1.0, v226
v_add_f32 v227, 1.0, v227
Mvaa 196,224,148
Ta 218,4,57856
v_rcp_f32 v224, v224
s_waitcnt lgkmcnt(4)
Mvaa 204,228,148
Ta 220,5,57344
v_rcp_f32 v225, v225
Mvaa 200,228,144
Ta 222,5,57856
v_rcp_f32 v226, v226
Mvaa 208,232,144
Ta 224,2,61440
v_rcp_f32 v227, v227
Mvaa 212,232,148
Ta 226,2,61952
v_xor_b32 v2, 0x10000, v2
Mvaa 220,236,148
Ta 228,3,61440
v_mul_f32 v114, v114, v146
v_mul_f32 v115, v115, v147
Mvaa 216,236,144
Ta 230,3,61952
v_xor_b32 v3, 0x10000, v3
v_mul_f32 v112, v112, v224
Mvaa 160,208,152
Ta 232,4,61440
v_mul_f32 v113, v113, v225
v_mul_f32 v114, v114, v226
Mvaa 164,208,156
Ta 234,4,61952
v_xor_b32 v4, 0x10000, v4
v_mul_f32 v115, v115, v227
s_waitcnt lgkmcnt(4)
Mvaa 172,212,156
Ta 236,5,61440
v_cvt_pk_bf16_f32 v224, v112, v113
v_cvt_pk_bf16_f32 v225, v114, v115
Mvaa 168,212,152
Ta 238,5,61952
v_xor_b32 v5, 0x10000, v5
v_accvgpr_write_b32 a24, v224
v_accvgpr_write_b32 a25, v225
s_waitcnt vmcnt(21)
s_barrier
Mvaa 176,216,152
Ta 208,2,0
s_add_u32 m0, s35, 0x18000
Mvaa 180,216,156
Ta 210,2,512
s_add_u32 s44, s36, 0x1b0180
Mvaa 188,220,156
Ta 212,3,0
s_add_u32 s98, s8, s44
s_addc_u32 s99, s9, 0
Mvaa 184,220,152
Ta 214,3,512
GDMA 12,98,0
Mvaa 192,224,152
Ta 216,4,0
GDMA 13,98,1024
Mvaa 196,224,156
Ta 218,4,512
s_waitcnt lgkmcnt(4)
Mvaa 204,228,156
Ta 220,5,0
v_fma_f32 v228, -v116, v116, s49
Mvaa 200,228,152
Ta 222,5,512
v_fma_f32 v229, -v117, v117, s49
Mvaa 208,232,152
Ta 224,2,4096
GDMA 14,98,2048
Mvaa 212,232,156
Ta 226,2,4608
v_fma_f32 v230, -v118, v118, s49
Mvaa 220,236,156
Ta 228,3,4096
v_fma_f32 v231, -v119, v119, s49
Mvaa 216,236,152
Ta 230,3,4608
v_mul_f32 v228, v228, v116
Mvaa 160,208,160
Ta 232,4,4096
GDMA 15,98,3072
Mvaa 164,208,164
Ta 234,4,4608
s_waitcnt lgkmcnt(4)
Mvaa 172,212,164
Ta 236,5,4096
v_mul_f32 v229, v229, v117
Mvaa 168,212,160
Ta 238,5,4608
v_mul_f32 v230, v230, v118
v_mul_f32 v231, v231, v119
Mvaa 176,216,160
Ta 208,2,8192
v_exp_f32 v228, v228
Mvaa 180,216,164
Ta 210,2,8704
v_exp_f32 v229, v229
Mvaa 188,220,164
Ta 212,3,8192
v_exp_f32 v230, v230
Mvaa 184,220,160
Ta 214,3,8704
v_exp_f32 v231, v231
Mvaa 192,224,160
Ta 216,4,8192
v_mul_f32 v116, v116, v148
Mvaa 196,224,164
Ta 218,4,8704
s_waitcnt lgkmcnt(4)
Mvaa 204,228,164
Ta 220,5,8192
v_mul_f32 v117, v117, v149
v_add_f32 v228, 1.0, v228
Mvaa 200,228,160
Ta 222,5,8704
v_add_f32 v229, 1.0, v229
Mvaa 208,232,160
Ta 224,2,12288
v_add_f32 v230, 1.0, v230
v_add_f32 v231, 1.0, v231
Mvaa 212,232,164
Ta 226,2,12800
v_rcp_f32 v228, v228
Mvaa 220,236,164
Ta 228,3,12288
v_rcp_f32 v229, v229
Mvaa 216,236,160
Ta 230,3,12800
v_rcp_f32 v230, v230
Mvaa 160,208,168
Ta 232,4,12288
v_rcp_f32 v231, v231
Mvaa 164,208,172
Ta 234,4,12800
s_waitcnt lgkmcnt(4)
Mvaa 172,212,172
Ta 236,5,12288
v_mul_f32 v118, v118, v150
v_mul_f32 v119, v119, v151
Mvaa 168,212,168
Ta 238,5,12800
v_mul_f32 v116, v116, v228
s_waitcnt vmcnt(20)
s_barrier
Mvaa 176,216,168
Ta 208,2,16384
s_add_u32 m0, s35, 0x1c000
v_mul_f32 v117, v117, v229
v_mul_f32 v118, v118, v230
Mvaa 180,216,172
Ta 210,2,16896
s_add_u32 s44, s36, 0x240180
v_mul_f32 v119, v119, v231
Mvaa 188,220,172
Ta 212,3,16384
s_add_u32 s98, s8, s44
s_addc_u32 s99, s9, 0
v_cvt_pk_bf16_f32 v228, v116, v117
v_cvt_pk_bf16_f32 v229, v118, v119
Mvaa 184,220,168
Ta 214,3,16896
GDMA 12,98,0
v_accvgpr_write_b32 a28, v228
v_accvgpr_write_b32 a29, v229
Mvaa 192,224,168
Ta 216,4,16384
GDMA 13,98,1024
Mvaa 196,224,172
Ta 218,4,16896
s_waitcnt lgkmcnt(4)
Mvaa 204,228,172
Ta 220,5,16384
v_fma_f32 v224, -v120, v120, s49
Mvaa 200,228,168
Ta 222,5,16896
v_fma_f32 v225, -v121, v121, s49
Mvaa 208,232,168
Ta 224,2,20480
GDMA 14,98,2048
Mvaa 212,232,172
Ta 226,2,20992
v_fma_f32 v226, -v122, v122, s49
Mvaa 220,236,172
Ta 228,3,20480
v_fma_f32 v227, -v123, v123, s49
Mvaa 216,236,168
Ta 230,3,20992
v_mul_f32 v224, v224, v120
Mvaa 160,208,176
Ta 232,4,20480
GDMA 15,98,3072
Mvaa 164,208,180
Ta 234,4,20992
s_waitcnt lgkmcnt(4)
Mvaa 172,212,180
Ta 236,5,20480
v_mul_f32 v225, v225, v121
Mvaa 168,212,176
Ta 238,5,20992
v_mul_f32 v226, v226, v122
Mvaa 176,216,176
Ta 208,2,24576
v_mul_f32 v227, v227, v123
Mvaa 180,216,180
Ta 210,2,25088
v_exp_f32 v224, v224
Mvaa 188,220,180
Ta 212,3,24576
v_exp_f32 v225, v225
Mvaa 184,220,176
Ta 214,3,25088
v_exp_f32 v226, v226
Mvaa 192,224,176
Ta 216,4,24576
v_exp_f32 v227, v227
Mvaa 196,224,180
Ta 218,4,25088
s_waitcnt lgkmcnt(4)
Mvaa 204,228,180
Ta 220,5,24576
v_mul_f32 v120, v120, v152
Mvaa 200,228,176
Ta 222,5,25088
v_mul_f32 v121, v121, v153
Mvaa 208,232,176
Ta 224,2,28672
v_add_f32 v224, 1.0, v224
Mvaa 212,232,180
Ta 226,2,29184
v_add_f32 v225, 1.0, v225
Mvaa 220,236,180
Ta 228,3,28672
v_add_f32 v226, 1.0, v226
Mvaa 216,236,176
Ta 230,3,29184
v_add_f32 v227, 1.0, v227
Mvaa 160,208,184
Ta 232,4,28672
v_rcp_f32 v224, v224
Mvaa 164,208,188
Ta 234,4,29184
s_waitcnt lgkmcnt(4)
Mvaa 172,212,188
Ta 236,5,28672
v_rcp_f32 v225, v225
Mvaa 168,212,184
Ta 238,5,29184
s_waitcnt vmcnt(20)
s_barrier
Mvaa 176,216,184
Ta 208,2,32768
s_mov_b32 m0, s35
v_rcp_f32 v226, v226
Mvaa 180,216,188
Ta 210,2,33280
s_add_u32 s44, s36, 0x2d0180
v_rcp_f32 v227, v227
Mvaa 188,220,188
Ta 212,3,32768
s_add_u32 s98, s8, s44
s_addc_u32 s99, s9, 0
v_mul_f32 v122, v122, v154
v_mul_f32 v123, v123, v155
Mvaa 184,220,184
Ta 214,3,33280
GDMA 12,98,0
v_mul_f32 v120, v120, v224
Mvaa 192,224,184
Ta 216,4,32768
GDMA 13,98,1024
v_mul_f32 v121, v121, v225
v_mul_f32 v122, v122, v226
Mvaa 196,224,188
Ta 218,4,33280
v_mul_f32 v123, v123, v227
s_waitcnt lgkmcnt(4)
Mvaa 204,228,188
Ta 220,5,32768
v_cvt_pk_bf16_f32 v224, v120, v121
v_cvt_pk_bf16_f32 v225, v122, v123
Mvaa 200,228,184
Ta 222,5,33280
v_accvgpr_write_b32 a26, v224
v_accvgpr_write_b32 a27, v225
Mvaa 208,232,184
Ta 224,2,36864
GDMA 14,98,2048
Mvaa 212,232,188
Ta 226,2,37376
v_fma_f32 v228, -v124, v124, s49
Mvaa 220,236,188
Ta 228,3,36864
v_fma_f32 v229, -v125, v125, s49
Mvaa 216,236,184
Ta 230,3,37376
v_fma_f32 v230, -v126, v126, s49
Mvaa 160,208,192
Ta 232,4,36864
GDMA 15,98,3072
Mvaa 164,208,196
Ta 234,4,37376
s_waitcnt lgkmcnt(4)
Mvaa 172,212,196
Ta 236,5,36864
v_fma_f32 v231, -v127, v127, s49
Mvaa 168,212,192
Ta 238,5,37376
v_mul_f32 v228, v228, v124
Mvaa 176,216,192
Ta 208,2,40960
v_mul_f32 v229, v229, v125
Mvaa 180,216,196
Ta 210,2,41472
v_mul_f32 v230, v230, v126
Mvaa 188,220,196
Ta 212,3,40960
v_mul_f32 v231, v231, v127
Mvaa 184,220,192
Ta 214,3,41472
v_exp_f32 v228, v228
Mvaa 192,224,192
Ta 216,4,40960
v_exp_f32 v229, v229
Mvaa 196,224,196
Ta 218,4,41472
s_waitcnt lgkmcnt(4)
Mvaa 204,228,196
Ta 220,5,40960
v_exp_f32 v230, v230
Mvaa 200,228,192
Ta 222,5,41472
v_exp_f32 v231, v231
Mvaa 208,232,192
Ta 224,2,45056
v_mul_f32 v124, v124, v156
Mvaa 212,232,196
Ta 226,2,45568
v_mul_f32 v125, v125, v157
Mvaa 220,236,196
Ta 228,3,45056
v_add_f32 v228, 1.0, v228
Mvaa 216,236,192
Ta 230,3,45568
v_add_f32 v229, 1.0, v229
Mvaa 160,208,200
Ta 232,4,45056
v_add_f32 v230, 1.0, v230
Mvaa 164,208,204
Ta 234,4,45568
s_waitcnt lgkmcnt(4)
Mvaa 172,212,204
Ta 236,5,45056
v_add_f32 v231, 1.0, v231
Mvaa 168,212,200
Ta 238,5,45568
s_waitcnt vmcnt(20)
s_barrier
Mvaa 176,216,200
Ta 208,2,49152
s_add_u32 m0, s35, 0x4000
Mvaa 180,216,204
Ta 210,2,49664
s_add_u32 s44, s36, 0x360180
v_rcp_f32 v228, v228
Mvaa 188,220,204
Ta 212,3,49152
s_add_u32 s98, s8, s44
s_addc_u32 s99, s9, 0
Mvaa 184,220,200
Ta 214,3,49664
GDMA 12,98,0
v_rcp_f32 v229, v229
Mvaa 192,224,200
Ta 216,4,49152
GDMA 13,98,1024
v_rcp_f32 v230, v230
Mvaa 196,224,204
Ta 218,4,49664
v_rcp_f32 v231, v231
s_waitcnt lgkmcnt(4)
Mvaa 204,228,204
Ta 220,5,49152
v_mul_f32 v126, v126, v158
v_mul_f32 v127, v127, v159
Mvaa 200,228,200
Ta 222,5,49664
v_mul_f32 v124, v124, v228
Mvaa 208,232,200
Ta 224,2,53248
GDMA 14,98,2048
v_mul_f32 v125, v125, v229
v_mul_f32 v126, v126, v230
Mvaa 212,232,204
Ta 226,2,53760
v_mul_f32 v127, v127, v231
Mvaa 220,236,204
Ta 228,3,53248
v_cvt_pk_bf16_f32 v228, v124, v125
v_cvt_pk_bf16_f32 v229, v126, v127
Mvaa 216,236,200
Ta 230,3,53760
v_accvgpr_write_b32 a30, v228
v_accvgpr_write_b32 a31, v229
Zvav 96,208,16
Ta 232,4,53248
GDMA 15,98,3072
Zvav 100,208,20
Ta 234,4,53760
s_waitcnt lgkmcnt(4)
Zvav 108,212,20
Ta 236,5,53248
v_fma_f32 v224, -v160, v160, s49
Zvav 104,212,16
Ta 238,5,53760
v_fma_f32 v225, -v161, v161, s49
Zvav 112,216,16
Ta 208,2,57344
v_fma_f32 v226, -v162, v162, s49
Zvav 116,216,20
Ta 210,2,57856
v_fma_f32 v227, -v163, v163, s49
Zvav 124,220,20
Ta 212,3,57344
v_mul_f32 v224, v224, v160
Zvav 120,220,16
Ta 214,3,57856
v_mul_f32 v225, v225, v161
Zvav 128,224,16
Ta 216,4,57344
buffer_load_dword a242, v253, s[8:11], 0 offen offset:640
Zvav 132,224,20
Ta 218,4,57856
s_waitcnt lgkmcnt(4)
Zvav 140,228,20
Ta 220,5,57344
v_mul_f32 v226, v226, v162
Zvav 136,228,16
Ta 222,5,57856
v_mul_f32 v227, v227, v163
Zvav 144,232,16
Ta 224,2,61440
v_exp_f32 v224, v224
Zvav 148,232,20
Ta 226,2,61952
v_xor_b32 v2, 0x10000, v2
Zvav 156,236,20
Ta 228,3,61440
v_exp_f32 v225, v225
Zvav 152,236,16
Ta 230,3,61952
v_xor_b32 v3, 0x10000, v3
Mvav 96,208,24
Ta 232,4,61440
v_exp_f32 v226, v226
Mvav 100,208,28
Ta 234,4,61952
v_xor_b32 v4, 0x10000, v4
s_waitcnt lgkmcnt(4)
Mvav 108,212,28
Ta 236,5,61440
v_exp_f32 v227, v227
Mvav 104,212,24
Ta 238,5,61952
v_xor_b32 v5, 0x10000, v5
s_waitcnt vmcnt(21)
s_barrier
Mvav 112,216,24
Ta 208,2,0
s_add_u32 m0, s35, 0x8000
Mvav 116,216,28
Ta 210,2,512
s_add_u32 s44, s36, 0x3f0180
v_mul_f32 v160, v160, v192
Mvav 124,220,28
Ta 212,3,0
s_add_u32 s98, s8, s44
s_addc_u32 s99, s9, 0
v_mul_f32 v161, v161, v193
v_add_f32 v224, 1.0, v224
Mvav 120,220,24
Ta 214,3,512
GDMA 12,98,0
v_add_f32 v225, 1.0, v225
Mvav 128,224,24
Ta 216,4,0
GDMA 13,98,1024
v_add_f32 v226, 1.0, v226
v_add_f32 v227, 1.0, v227
Mvav 132,224,28
Ta 218,4,512
v_rcp_f32 v224, v224
s_waitcnt lgkmcnt(4)
Mvav 140,228,28
Ta 220,5,0
v_rcp_f32 v225, v225
Mvav 136,228,24
Ta 222,5,512
v_rcp_f32 v226, v226
Mvav 144,232,24
Ta 224,2,4096
GDMA 14,98,2048
Mvav 148,232,28
Ta 226,2,4608
v_rcp_f32 v227, v227
Mvav 156,236,28
Ta 228,3,4096
v_mul_f32 v162, v162, v194
v_mul_f32 v163, v163, v195
Mvav 152,236,24
Ta 230,3,4608
v_mul_f32 v160, v160, v224
Mvav 96,208,32
Ta 232,4,4096
GDMA 15,98,3072
v_mul_f32 v161, v161, v225
v_mul_f32 v162, v162, v226
Mvav 100,208,36
Ta 234,4,4608
v_mul_f32 v163, v163, v227
s_waitcnt lgkmcnt(4)
Mvav 108,212,36
Ta 236,5,4096
v_cvt_pk_bf16_f32 v224, v160, v161
v_cvt_pk_bf16_f32 v225, v162, v163
Mvav 104,212,32
Ta 238,5,4608
v_accvgpr_write_b32 a32, v224
v_accvgpr_write_b32 a33, v225
Mvav 112,216,32
Ta 208,2,8192
v_fma_f32 v228, -v164, v164, s49
Mvav 116,216,36
Ta 210,2,8704
v_fma_f32 v229, -v165, v165, s49
Mvav 124,220,36
Ta 212,3,8192
v_fma_f32 v230, -v166, v166, s49
Mvav 120,220,32
Ta 214,3,8704
v_fma_f32 v231, -v167, v167, s49
Mvav 128,224,32
Ta 216,4,8192
v_mul_f32 v228, v228, v164
Mvav 132,224,36
Ta 218,4,8704
s_waitcnt lgkmcnt(4)
Mvav 140,228,36
Ta 220,5,8192
v_mul_f32 v229, v229, v165
Mvav 136,228,32
Ta 222,5,8704
v_mul_f32 v230, v230, v166
Mvav 144,232,32
Ta 224,2,12288
v_mul_f32 v231, v231, v167
Mvav 148,232,36
Ta 226,2,12800
v_exp_f32 v228, v228
Mvav 156,236,36
Ta 228,3,12288
v_exp_f32 v229, v229
Mvav 152,236,32
Ta 230,3,12800
v_exp_f32 v230, v230
Mvav 96,208,40
Ta 232,4,12288
v_exp_f32 v231, v231
Mvav 100,208,44
Ta 234,4,12800
s_waitcnt lgkmcnt(4)
Mvav 108,212,44
Ta 236,5,12288
v_mul_f32 v164, v164, v196
Mvav 104,212,40
Ta 238,5,12800
s_waitcnt vmcnt(21)
s_barrier
Mvav 112,216,40
Ta 208,2,16384
s_add_u32 m0, s35, 0xc000
Mvav 116,216,44
Ta 210,2,16896
s_add_u32 s44, s36, 0x480180
Mvav 124,220,44
Ta 212,3,16384
s_add_u32 s98, s8, s44
s_addc_u32 s99, s9, 0
Mvav 120,220,40
Ta 214,3,16896
GDMA 12,98,0
Mvav 128,224,40
Ta 216,4,16384
GDMA 13,98,1024
Mvav 132,224,44
Ta 218,4,16896
s_waitcnt lgkmcnt(4)
Mvav 140,228,44
Ta 220,5,16384
v_mul_f32 v165, v165, v197
v_add_f32 v228, 1.0, v228
Mvav 136,228,40
Ta 222,5,16896
v_add_f32 v229, 1.0, v229
Mvav 144,232,40
Ta 224,2,20480
GDMA 14,98,2048
v_add_f32 v230, 1.0, v230
v_add_f32 v231, 1.0, v231
Mvav 148,232,44
Ta 226,2,20992
v_rcp_f32 v228, v228
Mvav 156,236,44
Ta 228,3,20480
v_rcp_f32 v229, v229
Mvav 152,236,40
Ta 230,3,20992
v_rcp_f32 v230, v230
Mvav 96,208,48
Ta 232,4,20480
GDMA 15,98,3072
Mvav 100,208,52
Ta 234,4,20992
v_rcp_f32 v231, v231
s_waitcnt lgkmcnt(4)
Mvav 108,212,52
Ta 236,5,20480
v_mul_f32 v166, v166, v198
v_mul_f32 v167, v167, v199
Mvav 104,212,48
Ta 238,5,20992
v_mul_f32 v164, v164, v228
Mvav 112,216,48
Ta 208,2,24576
v_mul_f32 v165, v165, v229
v_mul_f32 v166, v166, v230
Mvav 116,216,52
Ta 210,2,25088
v_mul_f32 v167, v167, v231
Mvav 124,220,52
Ta 212,3,24576
v_cvt_pk_bf16_f32 v228, v164, v165
v_cvt_pk_bf16_f32 v229, v166, v167
Mvav 120,220,48
Ta 214,3,25088
v_accvgpr_write_b32 a36, v228
v_accvgpr_write_b32 a37, v229
Mvav 128,224,48
Ta 216,4,24576
v_mov_b32 v248, -1
Mvav 132,224,52
Ta 218,4,25088
s_waitcnt lgkmcnt(4)
Mvav 140,228,52
Ta 220,5,24576
v_mov_b32 v249, -1
Mvav 136,228,48
Ta 222,5,25088
v_mov_b32 v250, -1
Mvav 144,232,48
Ta 224,2,28672
v_mov_b32 v251, -1
Mvav 148,232,52
Ta 226,2,29184
v_lshlrev_b32 v252, 4, v1
Mvav 156,236,52
Ta 228,3,28672
s_add_u32 s48, s47, 0x7000
Mvav 152,236,48
Ta 230,3,29184
v_fma_f32 v224, -v168, v168, s49
Mvav 96,208,56
Ta 232,4,28672
v_fma_f32 v225, -v169, v169, s49
Mvav 100,208,60
Ta 234,4,29184
s_waitcnt lgkmcnt(4)
Mvav 108,212,60
Ta 236,5,28672
v_fma_f32 v226, -v170, v170, s49
Mvav 104,212,56
Ta 238,5,29184
s_waitcnt vmcnt(21)
s_barrier
Mvav 112,216,56
Ta 208,2,32768
s_add_u32 m0, s35, 0x10000
Mvav 116,216,60
Ta 210,2,33280
s_add_u32 s44, s36, 0x200
v_fma_f32 v227, -v171, v171, s49
Mvav 124,220,60
Ta 212,3,32768
s_add_u32 s98, s8, s44
s_addc_u32 s99, s9, 0
v_mul_f32 v224, v224, v168
v_mul_f32 v225, v225, v169
Mvav 120,220,56
Ta 214,3,33280
GDMA 12,98,0
v_mul_f32 v226, v226, v170
v_mul_f32 v227, v227, v171
Mvav 128,224,56
Ta 216,4,32768
GDMA 13,98,1024
Mvav 132,224,60
Ta 218,4,33280
v_exp_f32 v224, v224
s_waitcnt lgkmcnt(4)
Mvav 140,228,60
Ta 220,5,32768
v_exp_f32 v225, v225
Mvav 136,228,56
Ta 222,5,33280
v_exp_f32 v226, v226
Mvav 144,232,56
Ta 224,2,36864
GDMA 14,98,2048
v_exp_f32 v227, v227
Mvav 148,232,60
Ta 226,2,37376
v_mul_f32 v168, v168, v200
Mvav 156,236,60
Ta 228,3,36864
v_mul_f32 v169, v169, v201
v_add_f32 v224, 1.0, v224
Mvav 152,236,56
Ta 230,3,37376
v_add_f32 v225, 1.0, v225
Mvav 96,208,64
Ta 232,4,36864
GDMA 15,98,3072
v_add_f32 v226, 1.0, v226
v_add_f32 v227, 1.0, v227
Mvav 100,208,68
Ta 234,4,37376
v_rcp_f32 v224, v224
s_waitcnt lgkmcnt(4)
Mvav 108,212,68
Ta 236,5,36864
v_rcp_f32 v225, v225
Mvav 104,212,64
Ta 238,5,37376
v_rcp_f32 v226, v226
Mvav 112,216,64
Ta 208,2,40960
buffer_store_dwordx4 v[248:251], v252, s[28:31], s48 offen offset:0 sc1
Mvav 116,216,68
Ta 210,2,41472
v_rcp_f32 v227, v227
Mvav 124,220,68
Ta 212,3,40960
v_mul_f32 v170, v170, v202
v_mul_f32 v171, v171, v203
Mvav 120,220,64
Ta 214,3,41472
v_mul_f32 v168, v168, v224
Mvav 128,224,64
Ta 216,4,40960
v_mul_f32 v169, v169, v225
v_mul_f32 v170, v170, v226
Mvav 132,224,68
Ta 218,4,41472
v_mul_f32 v171, v171, v227
s_waitcnt lgkmcnt(4)
Mvav 140,228,68
Ta 220,5,40960
v_cvt_pk_bf16_f32 v224, v168, v169
v_cvt_pk_bf16_f32 v225, v170, v171
Mvav 136,228,64
Ta 222,5,41472
v_accvgpr_write_b32 a34, v224
v_accvgpr_write_b32 a35, v225
Mvav 144,232,64
Ta 224,2,45056
v_fma_f32 v228, -v172, v172, s49
Mvav 148,232,68
Ta 226,2,45568
v_fma_f32 v229, -v173, v173, s49
Mvav 156,236,68
Ta 228,3,45056
v_fma_f32 v230, -v174, v174, s49
Mvav 152,236,64
Ta 230,3,45568
v_fma_f32 v231, -v175, v175, s49
Mvav 96,208,72
Ta 232,4,45056
v_mul_f32 v228, v228, v172
Mvav 100,208,76
Ta 234,4,45568
s_waitcnt lgkmcnt(4)
Mvav 108,212,76
Ta 236,5,45056
v_mul_f32 v229, v229, v173
Mvav 104,212,72
Ta 238,5,45568
s_waitcnt vmcnt(22)
s_barrier
Mvav 112,216,72
Ta 208,2,49152
s_add_u32 m0, s35, 0x14000
Mvav 116,216,76
Ta 210,2,49664
s_add_u32 s44, s36, 0x90200
Mvav 124,220,76
Ta 212,3,49152
s_add_u32 s98, s8, s44
s_addc_u32 s99, s9, 0
Mvav 120,220,72
Ta 214,3,49664
GDMA 12,98,0
Mvav 128,224,72
Ta 216,4,49152
GDMA 13,98,1024
Mvav 132,224,76
Ta 218,4,49664
s_waitcnt lgkmcnt(4)
Mvav 140,228,76
Ta 220,5,49152
v_mul_f32 v230, v230, v174
Mvav 136,228,72
Ta 222,5,49664
v_mul_f32 v231, v231, v175
Mvav 144,232,72
Ta 224,2,53248
GDMA 14,98,2048
Mvav 148,232,76
Ta 226,2,53760
v_exp_f32 v228, v228
Mvav 156,236,76
Ta 228,3,53248
v_exp_f32 v229, v229
Mvav 152,236,72
Ta 230,3,53760
v_exp_f32 v230, v230
Mvav 96,208,80
Ta 232,4,53248
GDMA 15,98,3072
v_exp_f32 v231, v231
Mvav 100,208,84
Ta 234,4,53760
v_mul_f32 v172, v172, v204
s_waitcnt lgkmcnt(4)
Mvav 108,212,84
Ta 236,5,53248
v_mul_f32 v173, v173, v205
v_add_f32 v228, 1.0, v228
Mvav 104,212,80
Ta 238,5,53760
v_add_f32 v229, 1.0, v229
Mvav 112,216,80
Ta 208,2,57344
v_add_f32 v230, 1.0, v230
v_add_f32 v231, 1.0, v231
Mvav 116,216,84
Ta 210,2,57856
v_rcp_f32 v228, v228
Mvav 124,220,84
Ta 212,3,57344
v_rcp_f32 v229, v229
Mvav 120,220,80
Ta 214,3,57856
v_rcp_f32 v230, v230
Mvav 128,224,80
Ta 216,4,57344
v_rcp_f32 v231, v231
Mvav 132,224,84
Ta 218,4,57856
s_waitcnt lgkmcnt(4)
Mvav 140,228,84
Ta 220,5,57344
v_mul_f32 v174, v174, v206
v_mul_f32 v175, v175, v207
Mvav 136,228,80
Ta 222,5,57856
v_mul_f32 v172, v172, v228
Mvav 144,232,80
Ta 224,2,61440
v_mul_f32 v173, v173, v229
v_mul_f32 v174, v174, v230
Mvav 148,232,84
Ta 226,2,61952
v_xor_b32 v2, 0x10000, v2
v_mul_f32 v175, v175, v231
Mvav 156,236,84
Ta 228,3,61440
v_cvt_pk_bf16_f32 v228, v172, v173
v_cvt_pk_bf16_f32 v229, v174, v175
Mvav 152,236,80
Ta 230,3,61952
v_xor_b32 v3, 0x10000, v3
v_accvgpr_write_b32 a38, v228
v_accvgpr_write_b32 a39, v229
Mvav 96,208,88
Ta 232,4,61440
v_fma_f32 v224, -v176, v176, s49
Mvav 100,208,92
Ta 234,4,61952
v_xor_b32 v4, 0x10000, v4
s_waitcnt lgkmcnt(4)
Mvav 108,212,92
Ta 236,5,61440
v_fma_f32 v225, -v177, v177, s49
Mvav 104,212,88
Ta 238,5,61952
v_xor_b32 v5, 0x10000, v5
s_waitcnt vmcnt(22)
s_barrier
Mvav 112,216,88
Ta 208,2,0
s_add_u32 m0, s35, 0x18000
Mvav 116,216,92
Ta 210,2,512
s_add_u32 s44, s36, 0x120200
Mvav 124,220,92
Ta 212,3,0
s_add_u32 s98, s8, s44
s_addc_u32 s99, s9, 0
Mvav 120,220,88
Ta 214,3,512
GDMA 12,98,0
Mvav 128,224,88
Ta 216,4,0
GDMA 13,98,1024
Mvav 132,224,92
Ta 218,4,512
s_waitcnt lgkmcnt(4)
Mvav 140,228,92
Ta 220,5,0
v_fma_f32 v226, -v178, v178, s49
Mvav 136,228,88
Ta 222,5,512
v_fma_f32 v227, -v179, v179, s49
Mvav 144,232,88
Ta 224,2,4096
GDMA 14,98,2048
Mvav 148,232,92
Ta 226,2,4608
v_mul_f32 v224, v224, v176
Mvav 156,236,92
Ta 228,3,4096
v_mul_f32 v225, v225, v177
Mvav 152,236,88
Ta 230,3,4608
v_mul_f32 v226, v226, v178
v_mul_f32 v227, v227, v179
Mvaa 96,208,144
Ta 232,4,4096
GDMA 15,98,3072
Mvaa 100,208,148
Ta 234,4,4608
v_exp_f32 v224, v224
s_waitcnt lgkmcnt(4)
Mvaa 108,212,148
Ta 236,5,4096
v_exp_f32 v225, v225
Mvaa 104,212,144
Ta 238,5,4608
v_exp_f32 v226, v226
Mvaa 112,216,144
Ta 208,2,8192
v_exp_f32 v227, v227
Mvaa 116,216,148
Ta 210,2,8704
v_mul_f32 v176, v176, v208
Mvaa 124,220,148
Ta 212,3,8192
v_mul_f32 v177, v177, v209
v_add_f32 v224, 1.0, v224
Mvaa 120,220,144
Ta 214,3,8704
v_add_f32 v225, 1.0, v225
Mvaa 128,224,144
Ta 216,4,8192
v_add_f32 v226, 1.0, v226
v_add_f32 v227, 1.0, v227
Mvaa 132,224,148
Ta 218,4,8704
v_rcp_f32 v224, v224
s_waitcnt lgkmcnt(4)
Mvaa 140,228,148
Ta 220,5,8192
buffer_store_dwordx4 v[248:251], v252, s[28:31], s48 offen offset:1024 sc1
Mvaa 136,228,144
Ta 222,5,8704
v_rcp_f32 v225, v225
Mvaa 144,232,144
Ta 224,2,12288
v_rcp_f32 v226, v226
Mvaa 148,232,148
Ta 226,2,12800
v_rcp_f32 v227, v227
Mvaa 156,236,148
Ta 228,3,12288
v_mul_f32 v178, v178, v210
v_mul_f32 v179, v179, v211
Mvaa 152,236,144
Ta 230,3,12800
v_mul_f32 v176, v176, v224
Mvaa 96,208,152
Ta 232,4,12288
v_mul_f32 v177, v177, v225
v_mul_f32 v178, v178, v226
Mvaa 100,208,156
Ta 234,4,12800
v_mul_f32 v179, v179, v227
s_waitcnt lgkmcnt(4)
Mvaa 108,212,156
Ta 236,5,12288
v_cvt_pk_bf16_f32 v224, v176, v177
v_cvt_pk_bf16_f32 v225, v178, v179
Mvaa 104,212,152
Ta 238,5,12800
v_accvgpr_write_b32 a40, v224
v_accvgpr_write_b32 a41, v225
s_waitcnt vmcnt(23)
s_barrier
Mvaa 112,216,152
Ta 208,2,16384
s_add_u32 m0, s35, 0x1c000
Mvaa 116,216,156
Ta 210,2,16896
s_add_u32 s44, s36, 0x1b0200
Mvaa 124,220,156
Ta 212,3,16384
s_add_u32 s98, s8, s44
s_addc_u32 s99, s9, 0
Mvaa 120,220,152
Ta 214,3,16896
GDMA 12,98,0
Mvaa 128,224,152
Ta 216,4,16384
GDMA 13,98,1024
Mvaa 132,224,156
Ta 218,4,16896
s_waitcnt lgkmcnt(4)
Mvaa 140,228,156
Ta 220,5,16384
v_fma_f32 v228, -v180, v180, s49
Mvaa 136,228,152
Ta 222,5,16896
v_fma_f32 v229, -v181, v181, s49
Mvaa 144,232,152
Ta 224,2,20480
GDMA 14,98,2048
Mvaa 148,232,156
Ta 226,2,20992
v_fma_f32 v230, -v182, v182, s49
Mvaa 156,236,156
Ta 228,3,20480
v_fma_f32 v231, -v183, v183, s49
Mvaa 152,236,152
Ta 230,3,20992
v_mul_f32 v228, v228, v180
Mvaa 96,208,160
Ta 232,4,20480
GDMA 15,98,3072
Mvaa 100,208,164
Ta 234,4,20992
s_waitcnt lgkmcnt(4)
Mvaa 108,212,164
Ta 236,5,20480
v_mul_f32 v229, v229, v181
Mvaa 104,212,160
Ta 238,5,20992
v_mul_f32 v230, v230, v182
v_mul_f32 v231, v231, v183
Mvaa 112,216,160
Ta 208,2,24576
v_exp_f32 v228, v228
Mvaa 116,216,164
Ta 210,2,25088
v_exp_f32 v229, v229
Mvaa 124,220,164
Ta 212,3,24576
v_exp_f32 v230, v230
Mvaa 120,220,160
Ta 214,3,25088
v_exp_f32 v231, v231
Mvaa 128,224,160
Ta 216,4,24576
v_mul_f32 v180, v180, v212
Mvaa 132,224,164
Ta 218,4,25088
s_waitcnt lgkmcnt(4)
Mvaa 140,228,164
Ta 220,5,24576
v_mul_f32 v181, v181, v213
v_add_f32 v228, 1.0, v228
Mvaa 136,228,160
Ta 222,5,25088
v_add_f32 v229, 1.0, v229
Mvaa 144,232,160
Ta 224,2,28672
v_add_f32 v230, 1.0, v230
v_add_f32 v231, 1.0, v231
Mvaa 148,232,164
Ta 226,2,29184
v_rcp_f32 v228, v228
Mvaa 156,236,164
Ta 228,3,28672
v_rcp_f32 v229, v229
Mvaa 152,236,160
Ta 230,3,29184
v_rcp_f32 v230, v230
Mvaa 96,208,168
Ta 232,4,28672
v_rcp_f32 v231, v231
Mvaa 100,208,172
Ta 234,4,29184
s_waitcnt lgkmcnt(4)
Mvaa 108,212,172
Ta 236,5,28672
v_mul_f32 v182, v182, v214
v_mul_f32 v183, v183, v215
Mvaa 104,212,168
Ta 238,5,29184
v_mul_f32 v180, v180, v228
s_waitcnt vmcnt(22)
s_barrier
Mvaa 112,216,168
Ta 208,2,32768
s_mov_b32 m0, s35
v_mul_f32 v181, v181, v229
v_mul_f32 v182, v182, v230
Mvaa 116,216,172
Ta 210,2,33280
s_add_u32 s44, s36, 0x240200
v_mul_f32 v183, v183, v231
Mvaa 124,220,172
Ta 212,3,32768
s_add_u32 s98, s8, s44
s_addc_u32 s99, s9, 0
v_cvt_pk_bf16_f32 v228, v180, v181
v_cvt_pk_bf16_f32 v229, v182, v183
Mvaa 120,220,168
Ta 214,3,33280
GDMA 12,98,0
v_accvgpr_write_b32 a44, v228
v_accvgpr_write_b32 a45, v229
Mvaa 128,224,168
Ta 216,4,32768
GDMA 13,98,1024
Mvaa 132,224,172
Ta 218,4,33280
s_waitcnt lgkmcnt(4)
Mvaa 140,228,172
Ta 220,5,32768
v_fma_f32 v224, -v184, v184, s49
Mvaa 136,228,168
Ta 222,5,33280
v_fma_f32 v225, -v185, v185, s49
Mvaa 144,232,168
Ta 224,2,36864
GDMA 14,98,2048
Mvaa 148,232,172
Ta 226,2,37376
buffer_store_dwordx4 v[248:251], v252, s[28:31], s48 offen offset:2048 sc1
Mvaa 156,236,172
Ta 228,3,36864
v_fma_f32 v226, -v186, v186, s49
Mvaa 152,236,168
Ta 230,3,37376
v_fma_f32 v227, -v187, v187, s49
Mvaa 96,208,176
Ta 232,4,36864
GDMA 15,98,3072
Mvaa 100,208,180
Ta 234,4,37376
s_waitcnt lgkmcnt(4)
Mvaa 108,212,180
Ta 236,5,36864
v_mul_f32 v224, v224, v184
Mvaa 104,212,176
Ta 238,5,37376
v_mul_f32 v225, v225, v185
Mvaa 112,216,176
Ta 208,2,40960
v_mul_f32 v226, v226, v186
Mvaa 116,216,180
Ta 210,2,41472
v_mul_f32 v227, v227, v187
Mvaa 124,220,180
Ta 212,3,40960
v_exp_f32 v224, v224
Mvaa 120,220,176
Ta 214,3,41472
v_exp_f32 v225, v225
Mvaa 128,224,176
Ta 216,4,40960
v_exp_f32 v226, v226
Mvaa 132,224,180
Ta 218,4,41472
s_waitcnt lgkmcnt(4)
Mvaa 140,228,180
Ta 220,5,40960
v_exp_f32 v227, v227
Mvaa 136,228,176
Ta 222,5,41472
v_mul_f32 v184, v184, v216
Mvaa 144,232,176
Ta 224,2,45056
v_mul_f32 v185, v185, v217
Mvaa 148,232,180
Ta 226,2,45568
v_add_f32 v224, 1.0, v224
Mvaa 156,236,180
Ta 228,3,45056
v_add_f32 v225, 1.0, v225
Mvaa 152,236,176
Ta 230,3,45568
v_add_f32 v226, 1.0, v226
Mvaa 96,208,184
Ta 232,4,45056
v_add_f32 v227, 1.0, v227
Mvaa 100,208,188
Ta 234,4,45568
v_rcp_f32 v224, v224
s_waitcnt lgkmcnt(4)
Mvaa 108,212,188
Ta 236,5,45056
v_rcp_f32 v225, v225
Mvaa 104,212,184
Ta 238,5,45568
s_waitcnt vmcnt(23)
s_barrier
Mvaa 112,216,184
Ta 208,2,49152
s_add_u32 m0, s35, 0x4000
v_rcp_f32 v226, v226
Mvaa 116,216,188
Ta 210,2,49664
s_add_u32 s44, s36, 0x2d0200
v_rcp_f32 v227, v227
Mvaa 124,220,188
Ta 212,3,49152
s_add_u32 s98, s8, s44
s_addc_u32 s99, s9, 0
v_mul_f32 v186, v186, v218
v_mul_f32 v187, v187, v219
Mvaa 120,220,184
Ta 214,3,49664
GDMA 12,98,0
v_mul_f32 v184, v184, v224
Mvaa 128,224,184
Ta 216,4,49152
GDMA 13,98,1024
v_mul_f32 v185, v185, v225
v_mul_f32 v186, v186, v226
Mvaa 132,224,188
Ta 218,4,49664
v_mul_f32 v187, v187, v227
s_waitcnt lgkmcnt(4)
Mvaa 140,228,188
Ta 220,5,49152
v_cvt_pk_bf16_f32 v224, v184, v185
v_cvt_pk_bf16_f32 v225, v186, v187
Mvaa 136,228,184
Ta 222,5,49664
v_accvgpr_write_b32 a42, v224
v_accvgpr_write_b32 a43, v225
Mvaa 144,232,184
Ta 224,2,53248
GDMA 14,98,2048
Mvaa 148,232,188
Ta 226,2,53760
v_fma_f32 v228, -v188, v188, s49
Mvaa 156,236,188
Ta 228,3,53248
v_fma_f32 v229, -v189, v189, s49
Mvaa 152,236,184
Ta 230,3,53760
v_fma_f32 v230, -v190, v190, s49
Mvaa 96,208,192
Ta 232,4,53248
GDMA 15,98,3072
Mvaa 100,208,196
Ta 234,4,53760
s_waitcnt lgkmcnt(4)
Mvaa 108,212,196
Ta 236,5,53248
v_fma_f32 v231, -v191, v191, s49
Mvaa 104,212,192
Ta 238,5,53760
v_mul_f32 v228, v228, v188
Mvaa 112,216,192
Ta 208,2,57344
v_mul_f32 v229, v229, v189
Mvaa 116,216,196
Ta 210,2,57856
v_mul_f32 v230, v230, v190
Mvaa 124,220,196
Ta 212,3,57344
v_mul_f32 v231, v231, v191
Mvaa 120,220,192
Ta 214,3,57856
v_exp_f32 v228, v228
Mvaa 128,224,192
Ta 216,4,57344
v_exp_f32 v229, v229
Mvaa 132,224,196
Ta 218,4,57856
s_waitcnt lgkmcnt(4)
Mvaa 140,228,196
Ta 220,5,57344
v_exp_f32 v230, v230
Mvaa 136,228,192
Ta 222,5,57856
v_exp_f32 v231, v231
Mvaa 144,232,192
Ta 224,2,61440
v_mul_f32 v188, v188, v220
Mvaa 148,232,196
Ta 226,2,61952
v_xor_b32 v2, 0x10000, v2
Mvaa 156,236,196
Ta 228,3,61440
v_mul_f32 v189, v189, v221
Mvaa 152,236,192
Ta 230,3,61952
v_xor_b32 v3, 0x10000, v3
Mvaa 96,208,200
Ta 232,4,61440
v_add_f32 v228, 1.0, v228
Mvaa 100,208,204
Ta 234,4,61952
v_xor_b32 v4, 0x10000, v4
s_waitcnt lgkmcnt(4)
Mvaa 108,212,204
Ta 236,5,61440
v_add_f32 v229, 1.0, v229
Mvaa 104,212,200
Ta 238,5,61952
v_xor_b32 v5, 0x10000, v5
s_waitcnt vmcnt(23)
s_barrier
Mvaa 112,216,200
Ta 208,2,0
s_add_u32 m0, s35, 0x8000
v_add_f32 v230, 1.0, v230
v_add_f32 v231, 1.0, v231
Mvaa 116,216,204
Ta 210,2,512
s_add_u32 s44, s36, 0x360200
v_rcp_f32 v228, v228
Mvaa 124,220,204
Ta 212,3,0
s_add_u32 s98, s8, s44
s_addc_u32 s99, s9, 0
Mvaa 120,220,200
Ta 214,3,512
GDMA 12,98,0
v_rcp_f32 v229, v229
Mvaa 128,224,200
Ta 216,4,0
GDMA 13,98,1024
v_rcp_f32 v230, v230
Mvaa 132,224,204
Ta 218,4,512
v_rcp_f32 v231, v231
s_waitcnt lgkmcnt(4)
Mvaa 140,228,204
Ta 220,5,0
v_mul_f32 v190, v190, v222
v_mul_f32 v191, v191, v223
Mvaa 136,228,200
Ta 222,5,512
v_mul_f32 v188, v188, v228
Mvaa 144,232,200
Ta 224,2,4096
GDMA 14,98,2048
v_mul_f32 v189, v189, v229
v_mul_f32 v190, v190, v230
Mvaa 148,232,204
Ta 226,2,4608
v_mul_f32 v191, v191, v231
Mvaa 156,236,204
Ta 228,3,4096
v_cvt_pk_bf16_f32 v228, v188, v189
v_cvt_pk_bf16_f32 v229, v190, v191
Mvaa 152,236,200
Ta 230,3,4608
v_accvgpr_write_b32 a46, v228
v_accvgpr_write_b32 a47, v229
Zvav 160,208,16
Ta 232,4,4096
GDMA 15,98,3072
Zvav 164,208,20
Ta 234,4,4608
s_waitcnt lgkmcnt(4)
Zvav 172,212,20
Ta 236,5,4096
buffer_store_dwordx4 v[248:251], v252, s[28:31], s48 offen offset:3072 sc1
Zvav 168,212,16
Ta 238,5,4608
v_fma_f32 v224, -v96, v96, s49
Zvav 176,216,16
Ta 208,2,8192
v_fma_f32 v225, -v97, v97, s49
Zvav 180,216,20
Ta 210,2,8704
v_fma_f32 v226, -v98, v98, s49
Zvav 188,220,20
Ta 212,3,8192
v_fma_f32 v227, -v99, v99, s49
Zvav 184,220,16
Ta 214,3,8704
v_mul_f32 v224, v224, v96
Zvav 192,224,16
Ta 216,4,8192
buffer_load_dword a241, v253, s[8:11], 0 offen offset:768
Zvav 196,224,20
Ta 218,4,8704
s_waitcnt lgkmcnt(4)
Zvav 204,228,20
Ta 220,5,8192
v_mul_f32 v225, v225, v97
Zvav 200,228,16
Ta 222,5,8704
v_mul_f32 v226, v226, v98
Zvav 208,232,16
Ta 224,2,12288
v_mul_f32 v227, v227, v99
Zvav 212,232,20
Ta 226,2,12800
v_exp_f32 v224, v224
Zvav 220,236,20
Ta 228,3,12288
v_exp_f32 v225, v225
Zvav 216,236,16
Ta 230,3,12800
v_exp_f32 v226, v226
Mvav 160,208,24
Ta 232,4,12288
v_exp_f32 v227, v227
Mvav 164,208,28
Ta 234,4,12800
s_waitcnt lgkmcnt(4)
Mvav 172,212,28
Ta 236,5,12288
v_mul_f32 v96, v96, v128
Mvav 168,212,24
Ta 238,5,12800
s_waitcnt vmcnt(24)
s_barrier
Mvav 176,216,24
Ta 208,2,16384
s_add_u32 m0, s35, 0xc000
Mvav 180,216,28
Ta 210,2,16896
s_add_u32 s44, s36, 0x3f0200
Mvav 188,220,28
Ta 212,3,16384
s_add_u32 s98, s8, s44
s_addc_u32 s99, s9, 0
v_mul_f32 v97, v97, v129
v_add_f32 v224, 1.0, v224
Mvav 184,220,24
Ta 214,3,16896
GDMA 12,98,0
v_add_f32 v225, 1.0, v225
Mvav 192,224,24
Ta 216,4,16384
GDMA 13,98,1024
v_add_f32 v226, 1.0, v226
v_add_f32 v227, 1.0, v227
Mvav 196,224,28
Ta 218,4,16896
v_rcp_f32 v224, v224
s_waitcnt lgkmcnt(4)
Mvav 204,228,28
Ta 220,5,16384
v_rcp_f32 v225, v225
Mvav 200,228,24
Ta 222,5,16896
v_rcp_f32 v226, v226
Mvav 208,232,24
Ta 224,2,20480
GDMA 14,98,2048
Mvav 212,232,28
Ta 226,2,20992
v_rcp_f32 v227, v227
Mvav 220,236,28
Ta 228,3,20480
v_mul_f32 v98, v98, v130
v_mul_f32 v99, v99, v131
Mvav 216,236,24
Ta 230,3,20992
v_mul_f32 v96, v96, v224
Mvav 160,208,32
Ta 232,4,20480
GDMA 15,98,3072
v_mul_f32 v97, v97, v225
v_mul_f32 v98, v98, v226
s_add_u32 s48, s47, 0x8000
Mvav 164,208,36
Ta 234,4,20992
v_mul_f32 v99, v99, v227
s_waitcnt lgkmcnt(4)
Mvav 172,212,36
Ta 236,5,20480
v_cvt_pk_bf16_f32 v224, v96, v97
v_cvt_pk_bf16_f32 v225, v98, v99
Mvav 168,212,32
Ta 238,5,20992
v_accvgpr_write_b32 a48, v224
v_accvgpr_write_b32 a49, v225
Mvav 176,216,32
Ta 208,2,24576
v_fma_f32 v228, -v100, v100, s49
Mvav 180,216,36
Ta 210,2,25088
v_fma_f32 v229, -v101, v101, s49
Mvav 188,220,36
Ta 212,3,24576
v_fma_f32 v230, -v102, v102, s49
Mvav 184,220,32
Ta 214,3,25088
v_fma_f32 v231, -v103, v103, s49
Mvav 192,224,32
Ta 216,4,24576
v_mul_f32 v228, v228, v100
Mvav 196,224,36
Ta 218,4,25088
s_waitcnt lgkmcnt(4)
Mvav 204,228,36
Ta 220,5,24576
v_mul_f32 v229, v229, v101
Mvav 200,228,32
Ta 222,5,25088
v_mul_f32 v230, v230, v102
Mvav 208,232,32
Ta 224,2,28672
v_mul_f32 v231, v231, v103
Mvav 212,232,36
Ta 226,2,29184
v_exp_f32 v228, v228
Mvav 220,236,36
Ta 228,3,28672
v_exp_f32 v229, v229
Mvav 216,236,32
Ta 230,3,29184
v_exp_f32 v230, v230
Mvav 160,208,40
Ta 232,4,28672
v_exp_f32 v231, v231
Mvav 164,208,44
Ta 234,4,29184
s_waitcnt lgkmcnt(4)
Mvav 172,212,44
Ta 236,5,28672
v_mul_f32 v100, v100, v132
Mvav 168,212,40
Ta 238,5,29184
s_waitcnt vmcnt(24)
s_barrier
Mvav 176,216,40
Ta 208,2,32768
s_add_u32 m0, s35, 0x10000
Mvav 180,216,44
Ta 210,2,33280
s_add_u32 s44, s36, 0x480200
Mvav 188,220,44
Ta 212,3,32768
s_add_u32 s98, s8, s44
s_addc_u32 s99, s9, 0
Mvav 184,220,40
Ta 214,3,33280
GDMA 12,98,0
Mvav 192,224,40
Ta 216,4,32768
GDMA 13,98,1024
Mvav 196,224,44
Ta 218,4,33280
s_waitcnt lgkmcnt(4)
Mvav 204,228,44
Ta 220,5,32768
v_mul_f32 v101, v101, v133
v_add_f32 v228, 1.0, v228
Mvav 200,228,40
Ta 222,5,33280
v_add_f32 v229, 1.0, v229
Mvav 208,232,40
Ta 224,2,36864
GDMA 14,98,2048
v_add_f32 v230, 1.0, v230
v_add_f32 v231, 1.0, v231
Mvav 212,232,44
Ta 226,2,37376
v_rcp_f32 v228, v228
Mvav 220,236,44
Ta 228,3,36864
buffer_store_dwordx4 v[248:251], v252, s[28:31], s48 offen offset:0 sc1
Mvav 216,236,40
Ta 230,3,37376
v_rcp_f32 v229, v229
Mvav 160,208,48
Ta 232,4,36864
GDMA 15,98,3072
v_rcp_f32 v230, v230
Mvav 164,208,52
Ta 234,4,37376
v_rcp_f32 v231, v231
s_waitcnt lgkmcnt(4)
Mvav 172,212,52
Ta 236,5,36864
v_mul_f32 v102, v102, v134
v_mul_f32 v103, v103, v135
Mvav 168,212,48
Ta 238,5,37376
v_mul_f32 v100, v100, v228
Mvav 176,216,48
Ta 208,2,40960
v_mul_f32 v101, v101, v229
v_mul_f32 v102, v102, v230
Mvav 180,216,52
Ta 210,2,41472
v_mul_f32 v103, v103, v231
Mvav 188,220,52
Ta 212,3,40960
v_cvt_pk_bf16_f32 v228, v100, v101
v_cvt_pk_bf16_f32 v229, v102, v103
Mvav 184,220,48
Ta 214,3,41472
v_accvgpr_write_b32 a52, v228
v_accvgpr_write_b32 a53, v229
Mvav 192,224,48
Ta 216,4,40960
v_fma_f32 v224, -v104, v104, s49
Mvav 196,224,52
Ta 218,4,41472
s_waitcnt lgkmcnt(4)
Mvav 204,228,52
Ta 220,5,40960
v_fma_f32 v225, -v105, v105, s49
Mvav 200,228,48
Ta 222,5,41472
v_fma_f32 v226, -v106, v106, s49
Mvav 208,232,48
Ta 224,2,45056
v_fma_f32 v227, -v107, v107, s49
Mvav 212,232,52
Ta 226,2,45568
v_mul_f32 v224, v224, v104
Mvav 220,236,52
Ta 228,3,45056
v_mul_f32 v225, v225, v105
Mvav 216,236,48
Ta 230,3,45568
v_mul_f32 v226, v226, v106
Mvav 160,208,56
Ta 232,4,45056
v_mul_f32 v227, v227, v107
Mvav 164,208,60
Ta 234,4,45568
s_waitcnt lgkmcnt(4)
Mvav 172,212,60
Ta 236,5,45056
v_exp_f32 v224, v224
Mvav 168,212,56
Ta 238,5,45568
s_waitcnt vmcnt(24)
s_barrier
Mvav 176,216,56
Ta 208,2,49152
s_add_u32 m0, s35, 0x14000
Mvav 180,216,60
Ta 210,2,49664
s_add_u32 s44, s36, 0x280
Mvav 188,220,60
Ta 212,3,49152
s_add_u32 s98, s8, s44
s_addc_u32 s99, s9, 0
Mvav 184,220,56
Ta 214,3,49664
GDMA 12,98,0
Mvav 192,224,56
Ta 216,4,49152
GDMA 13,98,1024
Mvav 196,224,60
Ta 218,4,49664
s_waitcnt lgkmcnt(4)
Mvav 204,228,60
Ta 220,5,49152
v_exp_f32 v225, v225
Mvav 200,228,56
Ta 222,5,49664
v_exp_f32 v226, v226
Mvav 208,232,56
Ta 224,2,53248
GDMA 14,98,2048
v_exp_f32 v227, v227
Mvav 212,232,60
Ta 226,2,53760
v_mul_f32 v104, v104, v136
Mvav 220,236,60
Ta 228,3,53248
v_mul_f32 v105, v105, v137
v_add_f32 v224, 1.0, v224
Mvav 216,236,56
Ta 230,3,53760
v_add_f32 v225, 1.0, v225
Mvav 160,208,64
Ta 232,4,53248
GDMA 15,98,3072
v_add_f32 v226, 1.0, v226
v_add_f32 v227, 1.0, v227
Mvav 164,208,68
Ta 234,4,53760
v_rcp_f32 v224, v224
s_waitcnt lgkmcnt(4)
Mvav 172,212,68
Ta 236,5,53248
v_rcp_f32 v225, v225
Mvav 168,212,64
Ta 238,5,53760
v_rcp_f32 v226, v226
Mvav 176,216,64
Ta 208,2,57344
v_rcp_f32 v227, v227
Mvav 180,216,68
Ta 210,2,57856
v_mul_f32 v106, v106, v138
Mvav 188,220,68
Ta 212,3,57344
v_mul_f32 v107, v107, v139
Mvav 184,220,64
Ta 214,3,57856
v_mul_f32 v104, v104, v224
Mvav 192,224,64
Ta 216,4,57344
v_mul_f32 v105, v105, v225
v_mul_f32 v106, v106, v226
Mvav 196,224,68
Ta 218,4,57856
v_mul_f32 v107, v107, v227
s_waitcnt lgkmcnt(4)
Mvav 204,228,68
Ta 220,5,57344
v_cvt_pk_bf16_f32 v224, v104, v105
v_cvt_pk_bf16_f32 v225, v106, v107
Mvav 200,228,64
Ta 222,5,57856
v_accvgpr_write_b32 a50, v224
v_accvgpr_write_b32 a51, v225
Mvav 208,232,64
Ta 224,2,61440
v_fma_f32 v228, -v108, v108, s49
Mvav 212,232,68
Ta 226,2,61952
v_xor_b32 v2, 0x10000, v2
Mvav 220,236,68
Ta 228,3,61440
v_fma_f32 v229, -v109, v109, s49
Mvav 216,236,64
Ta 230,3,61952
v_xor_b32 v3, 0x10000, v3
Mvav 160,208,72
Ta 232,4,61440
buffer_store_dwordx4 v[248:251], v252, s[28:31], s48 offen offset:1024 sc1
Mvav 164,208,76
Ta 234,4,61952
v_xor_b32 v4, 0x10000, v4
s_waitcnt lgkmcnt(4)
Mvav 172,212,76
Ta 236,5,61440
v_fma_f32 v230, -v110, v110, s49
Mvav 168,212,72
Ta 238,5,61952
v_xor_b32 v5, 0x10000, v5
s_waitcnt vmcnt(24)
s_barrier
Mvav 176,216,72
Ta 208,2,0
s_add_u32 m0, s35, 0x18000
Mvav 180,216,76
Ta 210,2,512
s_add_u32 s44, s36, 0x90280
Mvav 188,220,76
Ta 212,3,0
s_add_u32 s98, s8, s44
s_addc_u32 s99, s9, 0
Mvav 184,220,72
Ta 214,3,512
GDMA 12,98,0
Mvav 192,224,72
Ta 216,4,0
GDMA 13,98,1024
Mvav 196,224,76
Ta 218,4,512
v_fma_f32 v231, -v111, v111, s49
s_waitcnt lgkmcnt(4)
Mvav 204,228,76
Ta 220,5,0
v_mul_f32 v228, v228, v108
v_mul_f32 v229, v229, v109
Mvav 200,228,72
Ta 222,5,512
v_mul_f32 v230, v230, v110
v_mul_f32 v231, v231, v111
Mvav 208,232,72
Ta 224,2,4096
GDMA 14,98,2048
Mvav 212,232,76
Ta 226,2,4608
v_exp_f32 v228, v228
Mvav 220,236,76
Ta 228,3,4096
v_exp_f32 v229, v229
Mvav 216,236,72
Ta 230,3,4608
v_exp_f32 v230, v230
Mvav 160,208,80
Ta 232,4,4096
GDMA 15,98,3072
v_exp_f32 v231, v231
Mvav 164,208,84
Ta 234,4,4608
v_mul_f32 v108, v108, v140
s_waitcnt lgkmcnt(4)
Mvav 172,212,84
Ta 236,5,4096
v_mul_f32 v109, v109, v141
v_add_f32 v228, 1.0, v228
Mvav 168,212,80
Ta 238,5,4608
v_add_f32 v229, 1.0, v229
Mvav 176,216,80
Ta 208,2,8192
v_add_f32 v230, 1.0, v230
v_add_f32 v231, 1.0, v231
Mvav 180,216,84
Ta 210,2,8704
v_rcp_f32 v228, v228
Mvav 188,220,84
Ta 212,3,8192
v_rcp_f32 v229, v229
Mvav 184,220,80
Ta 214,3,8704
v_rcp_f32 v230, v230
Mvav 192,224,80
Ta 216,4,8192
v_rcp_f32 v231, v231
Mvav 196,224,84
Ta 218,4,8704
s_waitcnt lgkmcnt(4)
Mvav 204,228,84
Ta 220,5,8192
v_mul_f32 v110, v110, v142
v_mul_f32 v111, v111, v143
Mvav 200,228,80
Ta 222,5,8704
v_mul_f32 v108, v108, v228
Mvav 208,232,80
Ta 224,2,12288
v_mul_f32 v109, v109, v229
v_mul_f32 v110, v110, v230
Mvav 212,232,84
Ta 226,2,12800
v_mul_f32 v111, v111, v231
Mvav 220,236,84
Ta 228,3,12288
v_cvt_pk_bf16_f32 v228, v108, v109
v_cvt_pk_bf16_f32 v229, v110, v111
Mvav 216,236,80
Ta 230,3,12800
v_accvgpr_write_b32 a54, v228
v_accvgpr_write_b32 a55, v229
Mvav 160,208,88
Ta 232,4,12288
v_fma_f32 v224, -v112, v112, s49
Mvav 164,208,92
Ta 234,4,12800
s_waitcnt lgkmcnt(4)
Mvav 172,212,92
Ta 236,5,12288
v_fma_f32 v225, -v113, v113, s49
Mvav 168,212,88
Ta 238,5,12800
s_waitcnt vmcnt(24)
s_barrier
Mvav 176,216,88
Ta 208,2,16384
s_add_u32 m0, s35, 0x1c000
Mvav 180,216,92
Ta 210,2,16896
s_add_u32 s44, s36, 0x120280
Mvav 188,220,92
Ta 212,3,16384
s_add_u32 s98, s8, s44
s_addc_u32 s99, s9, 0
Mvav 184,220,88
Ta 214,3,16896
GDMA 12,98,0
Mvav 192,224,88
Ta 216,4,16384
GDMA 13,98,1024
Mvav 196,224,92
Ta 218,4,16896
s_waitcnt lgkmcnt(4)
Mvav 204,228,92
Ta 220,5,16384
v_fma_f32 v226, -v114, v114, s49
Mvav 200,228,88
Ta 222,5,16896
v_fma_f32 v227, -v115, v115, s49
Mvav 208,232,88
Ta 224,2,20480
GDMA 14,98,2048
Mvav 212,232,92
Ta 226,2,20992
v_mul_f32 v224, v224, v112
Mvav 220,236,92
Ta 228,3,20480
v_mul_f32 v225, v225, v113
Mvav 216,236,88
Ta 230,3,20992
v_mul_f32 v226, v226, v114
v_mul_f32 v227, v227, v115
Mvaa 160,208,144
Ta 232,4,20480
GDMA 15,98,3072
Mvaa 164,208,148
Ta 234,4,20992
v_exp_f32 v224, v224
s_waitcnt lgkmcnt(4)
Mvaa 172,212,148
Ta 236,5,20480
v_exp_f32 v225, v225
Mvaa 168,212,144
Ta 238,5,20992
v_exp_f32 v226, v226
Mvaa 176,216,144
Ta 208,2,24576
v_exp_f32 v227, v227
Mvaa 180,216,148
Ta 210,2,25088
v_mul_f32 v112, v112, v144
Mvaa 188,220,148
Ta 212,3,24576
v_mul_f32 v113, v113, v145
v_add_f32 v224, 1.0, v224
Mvaa 184,220,144
Ta 214,3,25088
v_add_f32 v225, 1.0, v225
Mvaa 192,224,144
Ta 216,4,24576
v_add_f32 v226, 1.0, v226
v_add_f32 v227, 1.0, v227
Mvaa 196,224,148
Ta 218,4,25088
v_rcp_f32 v224, v224
s_waitcnt lgkmcnt(4)
Mvaa 204,228,148
Ta 220,5,24576
v_rcp_f32 v225, v225
Mvaa 200,228,144
Ta 222,5,25088
v_rcp_f32 v226, v226
Mvaa 208,232,144
Ta 224,2,28672
buffer_store_dwordx4 v[248:251], v252, s[28:31], s48 offen offset:2048 sc1
Mvaa 212,232,148
Ta 226,2,29184
v_rcp_f32 v227, v227
Mvaa 220,236,148
Ta 228,3,28672
v_mul_f32 v114, v114, v146
v_mul_f32 v115, v115, v147
Mvaa 216,236,144
Ta 230,3,29184
v_mul_f32 v112, v112, v224
Mvaa 160,208,152
Ta 232,4,28672
v_mul_f32 v113, v113, v225
v_mul_f32 v114, v114, v226
Mvaa 164,208,156
Ta 234,4,29184
v_mul_f32 v115, v115, v227
s_waitcnt lgkmcnt(4)
Mvaa 172,212,156
Ta 236,5,28672
v_cvt_pk_bf16_f32 v224, v112, v113
v_cvt_pk_bf16_f32 v225, v114, v115
Mvaa 168,212,152
Ta 238,5,29184
v_accvgpr_write_b32 a56, v224
v_accvgpr_write_b32 a57, v225
s_waitcnt vmcnt(25)
s_barrier
Mvaa 176,216,152
Ta 208,2,32768
s_mov_b32 m0, s35
Mvaa 180,216,156
Ta 210,2,33280
s_add_u32 s44, s36, 0x1b0280
Mvaa 188,220,156
Ta 212,3,32768
s_add_u32 s98, s8, s44
s_addc_u32 s99, s9, 0
Mvaa 184,220,152
Ta 214,3,33280
GDMA 12,98,0
Mvaa 192,224,152
Ta 216,4,32768
GDMA 13,98,1024
Mvaa 196,224,156
Ta 218,4,33280
s_waitcnt lgkmcnt(4)
Mvaa 204,228,156
Ta 220,5,32768
v_fma_f32 v228, -v116, v116, s49
Mvaa 200,228,152
Ta 222,5,33280
v_fma_f32 v229, -v117, v117, s49
Mvaa 208,232,152
Ta 224,2,36864
GDMA 14,98,2048
Mvaa 212,232,156
Ta 226,2,37376
v_fma_f32 v230, -v118, v118, s49
Mvaa 220,236,156
Ta 228,3,36864
v_fma_f32 v231, -v119, v119, s49
Mvaa 216,236,152
Ta 230,3,37376
v_mul_f32 v228, v228, v116
Mvaa 160,208,160
Ta 232,4,36864
GDMA 15,98,3072
Mvaa 164,208,164
Ta 234,4,37376
s_waitcnt lgkmcnt(4)
Mvaa 172,212,164
Ta 236,5,36864
v_mul_f32 v229, v229, v117
Mvaa 168,212,160
Ta 238,5,37376
v_mul_f32 v230, v230, v118
v_mul_f32 v231, v231, v119
Mvaa 176,216,160
Ta 208,2,40960
v_exp_f32 v228, v228
Mvaa 180,216,164
Ta 210,2,41472
v_exp_f32 v229, v229
Mvaa 188,220,164
Ta 212,3,40960
v_exp_f32 v230, v230
Mvaa 184,220,160
Ta 214,3,41472
v_exp_f32 v231, v231
Mvaa 192,224,160
Ta 216,4,40960
v_mul_f32 v116, v116, v148
Mvaa 196,224,164
Ta 218,4,41472
s_waitcnt lgkmcnt(4)
Mvaa 204,228,164
Ta 220,5,40960
v_mul_f32 v117, v117, v149
v_add_f32 v228, 1.0, v228
Mvaa 200,228,160
Ta 222,5,41472
v_add_f32 v229, 1.0, v229
Mvaa 208,232,160
Ta 224,2,45056
v_add_f32 v230, 1.0, v230
v_add_f32 v231, 1.0, v231
Mvaa 212,232,164
Ta 226,2,45568
v_rcp_f32 v228, v228
Mvaa 220,236,164
Ta 228,3,45056
v_rcp_f32 v229, v229
Mvaa 216,236,160
Ta 230,3,45568
v_rcp_f32 v230, v230
Mvaa 160,208,168
Ta 232,4,45056
v_rcp_f32 v231, v231
Mvaa 164,208,172
Ta 234,4,45568
s_waitcnt lgkmcnt(4)
Mvaa 172,212,172
Ta 236,5,45056
v_mul_f32 v118, v118, v150
v_mul_f32 v119, v119, v151
Mvaa 168,212,168
Ta 238,5,45568
v_mul_f32 v116, v116, v228
s_waitcnt vmcnt(23)
s_barrier
Mvaa 176,216,168
Ta 208,2,49152
s_add_u32 m0, s35, 0x4000
v_mul_f32 v117, v117, v229
v_mul_f32 v118, v118, v230
Mvaa 180,216,172
Ta 210,2,49664
s_add_u32 s44, s36, 0x240280
v_mul_f32 v119, v119, v231
Mvaa 188,220,172
Ta 212,3,49152
s_add_u32 s98, s8, s44
s_addc_u32 s99, s9, 0
v_cvt_pk_bf16_f32 v228, v116, v117
v_cvt_pk_bf16_f32 v229, v118, v119
Mvaa 184,220,168
Ta 214,3,49664
GDMA 12,98,0
v_accvgpr_write_b32 a60, v228
v_accvgpr_write_b32 a61, v229
Mvaa 192,224,168
Ta 216,4,49152
GDMA 13,98,1024
Mvaa 196,224,172
Ta 218,4,49664
s_waitcnt lgkmcnt(4)
Mvaa 204,228,172
Ta 220,5,49152
v_fma_f32 v224, -v120, v120, s49
Mvaa 200,228,168
Ta 222,5,49664
v_fma_f32 v225, -v121, v121, s49
Mvaa 208,232,168
Ta 224,2,53248
GDMA 14,98,2048
Mvaa 212,232,172
Ta 226,2,53760
v_fma_f32 v226, -v122, v122, s49
Mvaa 220,236,172
Ta 228,3,53248
v_fma_f32 v227, -v123, v123, s49
Mvaa 216,236,168
Ta 230,3,53760
v_mul_f32 v224, v224, v120
Mvaa 160,208,176
Ta 232,4,53248
GDMA 15,98,3072
Mvaa 164,208,180
Ta 234,4,53760
s_waitcnt lgkmcnt(4)
Mvaa 172,212,180
Ta 236,5,53248
v_mul_f32 v225, v225, v121
Mvaa 168,212,176
Ta 238,5,53760
v_mul_f32 v226, v226, v122
Mvaa 176,216,176
Ta 208,2,57344
v_mul_f32 v227, v227, v123
Mvaa 180,216,180
Ta 210,2,57856
v_exp_f32 v224, v224
Mvaa 188,220,180
Ta 212,3,57344
v_exp_f32 v225, v225
Mvaa 184,220,176
Ta 214,3,57856
v_exp_f32 v226, v226
Mvaa 192,224,176
Ta 216,4,57344
buffer_store_dwordx4 v[248:251], v252, s[28:31], s48 offen offset:3072 sc1
Mvaa 196,224,180
Ta 218,4,57856
s_waitcnt lgkmcnt(4)
Mvaa 204,228,180
Ta 220,5,57344
v_exp_f32 v227, v227
Mvaa 200,228,176
Ta 222,5,57856
v_mul_f32 v120, v120, v152
Mvaa 208,232,176
Ta 224,2,61440
v_mul_f32 v121, v121, v153
Mvaa 212,232,180
Ta 226,2,61952
v_xor_b32 v2, 0x10000, v2
Mvaa 220,236,180
Ta 228,3,61440
v_add_f32 v224, 1.0, v224
Mvaa 216,236,176
Ta 230,3,61952
v_xor_b32 v3, 0x10000, v3
v_add_f32 v225, 1.0, v225
Mvaa 160,208,184
Ta 232,4,61440
v_add_f32 v226, 1.0, v226
v_add_f32 v227, 1.0, v227
Mvaa 164,208,188
Ta 234,4,61952
v_xor_b32 v4, 0x10000, v4
v_rcp_f32 v224, v224
s_waitcnt lgkmcnt(4)
Mvaa 172,212,188
Ta 236,5,61440
v_rcp_f32 v225, v225
Mvaa 168,212,184
Ta 238,5,61952
v_xor_b32 v5, 0x10000, v5
s_waitcnt vmcnt(23)
s_barrier
Mvaa 176,216,184
Ta 208,2,0
s_add_u32 m0, s35, 0x8000
v_rcp_f32 v226, v226
Mvaa 180,216,188
Ta 210,2,512
s_add_u32 s44, s36, 0x2d0280
v_rcp_f32 v227, v227
Mvaa 188,220,188
Ta 212,3,0
s_add_u32 s98, s8, s44
s_addc_u32 s99, s9, 0
v_mul_f32 v122, v122, v154
v_mul_f32 v123, v123, v155
Mvaa 184,220,184
Ta 214,3,512
GDMA 12,98,0
v_mul_f32 v120, v120, v224
Mvaa 192,224,184
Ta 216,4,0
GDMA 13,98,1024
v_mul_f32 v121, v121, v225
v_mul_f32 v122, v122, v226
Mvaa 196,224,188
Ta 218,4,512
v_mul_f32 v123, v123, v227
s_waitcnt lgkmcnt(4)
Mvaa 204,228,188
Ta 220,5,0
v_cvt_pk_bf16_f32 v224, v120, v121
v_cvt_pk_bf16_f32 v225, v122, v123
Mvaa 200,228,184
Ta 222,5,512
v_accvgpr_write_b32 a58, v224
v_accvgpr_write_b32 a59, v225
Mvaa 208,232,184
Ta 224,2,4096
GDMA 14,98,2048
Mvaa 212,232,188
Ta 226,2,4608
v_fma_f32 v228, -v124, v124, s49
Mvaa 220,236,188
Ta 228,3,4096
v_fma_f32 v229, -v125, v125, s49
Mvaa 216,236,184
Ta 230,3,4608
v_fma_f32 v230, -v126, v126, s49
Mvaa 160,208,192
Ta 232,4,4096
GDMA 15,98,3072
Mvaa 164,208,196
Ta 234,4,4608
s_waitcnt lgkmcnt(4)
Mvaa 172,212,196
Ta 236,5,4096
v_fma_f32 v231, -v127, v127, s49
Mvaa 168,212,192
Ta 238,5,4608
v_mul_f32 v228, v228, v124
Mvaa 176,216,192
Ta 208,2,8192
v_mul_f32 v229, v229, v125
Mvaa 180,216,196
Ta 210,2,8704
v_mul_f32 v230, v230, v126
Mvaa 188,220,196
Ta 212,3,8192
v_mul_f32 v231, v231, v127
Mvaa 184,220,192
Ta 214,3,8704
v_exp_f32 v228, v228
Mvaa 192,224,192
Ta 216,4,8192
v_exp_f32 v229, v229
Mvaa 196,224,196
Ta 218,4,8704
s_waitcnt lgkmcnt(4)
Mvaa 204,228,196
Ta 220,5,8192
v_exp_f32 v230, v230
Mvaa 200,228,192
Ta 222,5,8704
v_exp_f32 v231, v231
Mvaa 208,232,192
Ta 224,2,12288
v_mul_f32 v124, v124, v156
Mvaa 212,232,196
Ta 226,2,12800
v_mul_f32 v125, v125, v157
Mvaa 220,236,196
Ta 228,3,12288
v_add_f32 v228, 1.0, v228
Mvaa 216,236,192
Ta 230,3,12800
v_add_f32 v229, 1.0, v229
Mvaa 160,208,200
Ta 232,4,12288
v_add_f32 v230, 1.0, v230
Mvaa 164,208,204
Ta 234,4,12800
s_waitcnt lgkmcnt(4)
Mvaa 172,212,204
Ta 236,5,12288
v_add_f32 v231, 1.0, v231
Mvaa 168,212,200
Ta 238,5,12800
s_waitcnt vmcnt(23)
s_barrier
Mvaa 176,216,200
Ta 208,2,16384
s_add_u32 m0, s35, 0xc000
Mvaa 180,216,204
Ta 210,2,16896
s_add_u32 s44, s36, 0x360280
v_rcp_f32 v228, v228
Mvaa 188,220,204
Ta 212,3,16384
s_add_u32 s98, s8, s44
s_addc_u32 s99, s9, 0
Mvaa 184,220,200
Ta 214,3,16896
GDMA 12,98,0
v_rcp_f32 v229, v229
Mvaa 192,224,200
Ta 216,4,16384
GDMA 13,98,1024
v_rcp_f32 v230, v230
Mvaa 196,224,204
Ta 218,4,16896
v_rcp_f32 v231, v231
s_waitcnt lgkmcnt(4)
Mvaa 204,228,204
Ta 220,5,16384
v_mul_f32 v126, v126, v158
v_mul_f32 v127, v127, v159
Mvaa 200,228,200
Ta 222,5,16896
v_mul_f32 v124, v124, v228
Mvaa 208,232,200
Ta 224,2,20480
GDMA 14,98,2048
v_mul_f32 v125, v125, v229
v_mul_f32 v126, v126, v230
Mvaa 212,232,204
Ta 226,2,20992
v_mul_f32 v127, v127, v231
Mvaa 220,236,204
Ta 228,3,20480
v_cvt_pk_bf16_f32 v228, v124, v125
v_cvt_pk_bf16_f32 v229, v126, v127
Mvaa 216,236,200
Ta 230,3,20992
v_accvgpr_write_b32 a62, v228
v_accvgpr_write_b32 a63, v229
Zvav 96,208,16
Ta 232,4,20480
GDMA 15,98,3072
Zvav 100,208,20
Ta 234,4,20992
s_waitcnt lgkmcnt(4)
Zvav 108,212,20
Ta 236,5,20480
v_fma_f32 v224, -v160, v160, s49
Zvav 104,212,16
Ta 238,5,20992
v_fma_f32 v225, -v161, v161, s49
Zvav 112,216,16
Ta 208,2,24576
v_fma_f32 v226, -v162, v162, s49
Zvav 116,216,20
Ta 210,2,25088
v_fma_f32 v227, -v163, v163, s49
Zvav 124,220,20
Ta 212,3,24576
v_mul_f32 v224, v224, v160
Zvav 120,220,16
Ta 214,3,25088
v_mul_f32 v225, v225, v161
Zvav 128,224,16
Ta 216,4,24576
buffer_load_dword a242, v253, s[8:11], 0 offen offset:896
Zvav 132,224,20
Ta 218,4,25088
s_waitcnt lgkmcnt(4)
Zvav 140,228,20
Ta 220,5,24576
v_mul_f32 v226, v226, v162
Zvav 136,228,16
Ta 222,5,25088
v_mul_f32 v227, v227, v163
Zvav 144,232,16
Ta 224,2,28672
v_exp_f32 v224, v224
Zvav 148,232,20
Ta 226,2,29184
v_exp_f32 v225, v225
Zvav 156,236,20
Ta 228,3,28672
v_exp_f32 v226, v226
Zvav 152,236,16
Ta 230,3,29184
v_exp_f32 v227, v227
Mvav 96,208,24
Ta 232,4,28672
v_mul_f32 v160, v160, v192
Mvav 100,208,28
Ta 234,4,29184
s_waitcnt lgkmcnt(4)
Mvav 108,212,28
Ta 236,5,28672
v_mul_f32 v161, v161, v193
Mvav 104,212,24
Ta 238,5,29184
s_waitcnt vmcnt(23)
s_barrier
Mvav 112,216,24
Ta 208,2,32768
s_add_u32 m0, s35, 0x10000
Mvav 116,216,28
Ta 210,2,33280
s_add_u32 s44, s36, 0x3f0280
Mvav 124,220,28
Ta 212,3,32768
s_add_u32 s98, s8, s44
s_addc_u32 s99, s9, 0
v_add_f32 v224, 1.0, v224
Mvav 120,220,24
Ta 214,3,33280
GDMA 12,98,0
v_add_f32 v225, 1.0, v225
Mvav 128,224,24
Ta 216,4,32768
GDMA 13,98,1024
v_add_f32 v226, 1.0, v226
v_add_f32 v227, 1.0, v227
Mvav 132,224,28
Ta 218,4,33280
v_rcp_f32 v224, v224
s_waitcnt lgkmcnt(4)
Mvav 140,228,28
Ta 220,5,32768
v_rcp_f32 v225, v225
Mvav 136,228,24
Ta 222,5,33280
v_rcp_f32 v226, v226
Mvav 144,232,24
Ta 224,2,36864
GDMA 14,98,2048
Mvav 148,232,28
Ta 226,2,37376
v_rcp_f32 v227, v227
Mvav 156,236,28
Ta 228,3,36864
v_mul_f32 v162, v162, v194
v_mul_f32 v163, v163, v195
Mvav 152,236,24
Ta 230,3,37376
v_mul_f32 v160, v160, v224
Mvav 96,208,32
Ta 232,4,36864
GDMA 15,98,3072
v_mul_f32 v161, v161, v225
v_mul_f32 v162, v162, v226
Mvav 100,208,36
Ta 234,4,37376
v_mul_f32 v163, v163, v227
s_waitcnt lgkmcnt(4)
Mvav 108,212,36
Ta 236,5,36864
v_cvt_pk_bf16_f32 v224, v160, v161
v_cvt_pk_bf16_f32 v225, v162, v163
Mvav 104,212,32
Ta 238,5,37376
v_accvgpr_write_b32 a64, v224
v_accvgpr_write_b32 a65, v225
Mvav 112,216,32
Ta 208,2,40960
v_fma_f32 v228, -v164, v164, s49
Mvav 116,216,36
Ta 210,2,41472
v_fma_f32 v229, -v165, v165, s49
Mvav 124,220,36
Ta 212,3,40960
v_fma_f32 v230, -v166, v166, s49
Mvav 120,220,32
Ta 214,3,41472
v_fma_f32 v231, -v167, v167, s49
Mvav 128,224,32
Ta 216,4,40960
v_mul_f32 v228, v228, v164
Mvav 132,224,36
Ta 218,4,41472
s_waitcnt lgkmcnt(4)
Mvav 140,228,36
Ta 220,5,40960
v_mul_f32 v229, v229, v165
Mvav 136,228,32
Ta 222,5,41472
v_mul_f32 v230, v230, v166
Mvav 144,232,32
Ta 224,2,45056
v_mul_f32 v231, v231, v167
Mvav 148,232,36
Ta 226,2,45568
v_exp_f32 v228, v228
Mvav 156,236,36
Ta 228,3,45056
v_exp_f32 v229, v229
Mvav 152,236,32
Ta 230,3,45568
v_exp_f32 v230, v230
Mvav 96,208,40
Ta 232,4,45056
v_exp_f32 v231, v231
Mvav 100,208,44
Ta 234,4,45568
s_waitcnt lgkmcnt(4)
Mvav 108,212,44
Ta 236,5,45056
v_mul_f32 v164, v164, v196
Mvav 104,212,40
Ta 238,5,45568
s_waitcnt vmcnt(23)
s_barrier
Mvav 112,216,40
Ta 208,2,49152
s_add_u32 m0, s35, 0x14000
Mvav 116,216,44
Ta 210,2,49664
s_add_u32 s44, s36, 0x480280
Mvav 124,220,44
Ta 212,3,49152
s_add_u32 s98, s8, s44
s_addc_u32 s99, s9, 0
Mvav 120,220,40
Ta 214,3,49664
GDMA 12,98,0
Mvav 128,224,40
Ta 216,4,49152
GDMA 13,98,1024
Mvav 132,224,44
Ta 218,4,49664
s_waitcnt lgkmcnt(4)
Mvav 140,228,44
Ta 220,5,49152
v_mul_f32 v165, v165, v197
v_add_f32 v228, 1.0, v228
Mvav 136,228,40
Ta 222,5,49664
v_add_f32 v229, 1.0, v229
Mvav 144,232,40
Ta 224,2,53248
GDMA 14,98,2048
v_add_f32 v230, 1.0, v230
v_add_f32 v231, 1.0, v231
Mvav 148,232,44
Ta 226,2,53760
v_rcp_f32 v228, v228
Mvav 156,236,44
Ta 228,3,53248
v_rcp_f32 v229, v229
Mvav 152,236,40
Ta 230,3,53760
v_rcp_f32 v230, v230
Mvav 96,208,48
Ta 232,4,53248
GDMA 15,98,3072
Mvav 100,208,52
Ta 234,4,53760
v_rcp_f32 v231, v231
s_waitcnt lgkmcnt(4)
Mvav 108,212,52
Ta 236,5,53248
v_mul_f32 v166, v166, v198
v_mul_f32 v167, v167, v199
Mvav 104,212,48
Ta 238,5,53760
v_mul_f32 v164, v164, v228
Mvav 112,216,48
Ta 208,2,57344
v_mul_f32 v165, v165, v229
v_mul_f32 v166, v166, v230
Mvav 116,216,52
Ta 210,2,57856
v_mul_f32 v167, v167, v231
Mvav 124,220,52
Ta 212,3,57344
v_cvt_pk_bf16_f32 v228, v164, v165
v_cvt_pk_bf16_f32 v229, v166, v167
Mvav 120,220,48
Ta 214,3,57856
v_accvgpr_write_b32 a68, v228
v_accvgpr_write_b32 a69, v229
Mvav 128,224,48
Ta 216,4,57344
v_fma_f32 v224, -v168, v168, s49
Mvav 132,224,52
Ta 218,4,57856
s_waitcnt lgkmcnt(4)
Mvav 140,228,52
Ta 220,5,57344
v_fma_f32 v225, -v169, v169, s49
Mvav 136,228,48
Ta 222,5,57856
v_fma_f32 v226, -v170, v170, s49
Mvav 144,232,48
Ta 224,2,61440
v_fma_f32 v227, -v171, v171, s49
Mvav 148,232,52
Ta 226,2,61952
v_xor_b32 v2, 0x10000, v2
Mvav 156,236,52
Ta 228,3,61440
v_mul_f32 v224, v224, v168
Mvav 152,236,48
Ta 230,3,61952
v_xor_b32 v3, 0x10000, v3
Mvav 96,208,56
Ta 232,4,61440
v_mul_f32 v225, v225, v169
Mvav 100,208,60
Ta 234,4,61952
v_xor_b32 v4, 0x10000, v4
s_waitcnt lgkmcnt(4)
Mvav 108,212,60
Ta 236,5,61440
v_mul_f32 v226, v226, v170
Mvav 104,212,56
Ta 238,5,61952
v_xor_b32 v5, 0x10000, v5
s_waitcnt vmcnt(22)
s_barrier
Mvav 112,216,56
Ta 208,2,0
s_add_u32 m0, s35, 0x18000
Mvav 116,216,60
Ta 210,2,512
s_add_u32 s44, s36, 0x300
Mvav 124,220,60
Ta 212,3,0
s_add_u32 s98, s8, s44
s_addc_u32 s99, s9, 0
Mvav 120,220,56
Ta 214,3,512
GDMA 12,98,0
v_mul_f32 v227, v227, v171
Mvav 128,224,56
Ta 216,4,0
GDMA 13,98,1024
Mvav 132,224,60
Ta 218,4,512
v_exp_f32 v224, v224
s_waitcnt lgkmcnt(4)
Mvav 140,228,60
Ta 220,5,0
v_exp_f32 v225, v225
Mvav 136,228,56
Ta 222,5,512
v_exp_f32 v226, v226
Mvav 144,232,56
Ta 224,2,4096
GDMA 14,98,2048
v_exp_f32 v227, v227
Mvav 148,232,60
Ta 226,2,4608
v_mul_f32 v168, v168, v200
Mvav 156,236,60
Ta 228,3,4096
v_mul_f32 v169, v169, v201
v_add_f32 v224, 1.0, v224
Mvav 152,236,56
Ta 230,3,4608
v_add_f32 v225, 1.0, v225
Mvav 96,208,64
Ta 232,4,4096
GDMA 15,98,3072
v_add_f32 v226, 1.0, v226
v_add_f32 v227, 1.0, v227
Mvav 100,208,68
Ta 234,4,4608
v_rcp_f32 v224, v224
s_waitcnt lgkmcnt(4)
Mvav 108,212,68
Ta 236,5,4096
v_rcp_f32 v225, v225
Mvav 104,212,64
Ta 238,5,4608
v_rcp_f32 v226, v226
Mvav 112,216,64
Ta 208,2,8192
v_rcp_f32 v227, v227
Mvav 116,216,68
Ta 210,2,8704
v_mul_f32 v170, v170, v202
Mvav 124,220,68
Ta 212,3,8192
v_mul_f32 v171, v171, v203
Mvav 120,220,64
Ta 214,3,8704
v_mul_f32 v168, v168, v224
Mvav 128,224,64
Ta 216,4,8192
v_mul_f32 v169, v169, v225
v_mul_f32 v170, v170, v226
Mvav 132,224,68
Ta 218,4,8704
v_mul_f32 v171, v171, v227
s_waitcnt lgkmcnt(4)
Mvav 140,228,68
Ta 220,5,8192
v_cvt_pk_bf16_f32 v224, v168, v169
v_cvt_pk_bf16_f32 v225, v170, v171
Mvav 136,228,64
Ta 222,5,8704
v_accvgpr_write_b32 a66, v224
v_accvgpr_write_b32 a67, v225
Mvav 144,232,64
Ta 224,2,12288
v_fma_f32 v228, -v172, v172, s49
Mvav 148,232,68
Ta 226,2,12800
v_fma_f32 v229, -v173, v173, s49
Mvav 156,236,68
Ta 228,3,12288
v_fma_f32 v230, -v174, v174, s49
Mvav 152,236,64
Ta 230,3,12800
v_fma_f32 v231, -v175, v175, s49
Mvav 96,208,72
Ta 232,4,12288
v_mul_f32 v228, v228, v172
Mvav 100,208,76
Ta 234,4,12800
s_waitcnt lgkmcnt(4)
Mvav 108,212,76
Ta 236,5,12288
v_mul_f32 v229, v229, v173
Mvav 104,212,72
Ta 238,5,12800
s_waitcnt vmcnt(22)
s_barrier
Mvav 112,216,72
Ta 208,2,16384
s_add_u32 m0, s35, 0x1c000
Mvav 116,216,76
Ta 210,2,16896
s_add_u32 s44, s36, 0x90300
Mvav 124,220,76
Ta 212,3,16384
s_add_u32 s98, s8, s44
s_addc_u32 s99, s9, 0
Mvav 120,220,72
Ta 214,3,16896
GDMA 12,98,0
Mvav 128,224,72
Ta 216,4,16384
GDMA 13,98,1024
Mvav 132,224,76
Ta 218,4,16896
s_waitcnt lgkmcnt(4)
Mvav 140,228,76
Ta 220,5,16384
v_mul_f32 v230, v230, v174
Mvav 136,228,72
Ta 222,5,16896
v_mul_f32 v231, v231, v175
Mvav 144,232,72
Ta 224,2,20480
GDMA 14,98,2048
Mvav 148,232,76
Ta 226,2,20992
v_exp_f32 v228, v228
Mvav 156,236,76
Ta 228,3,20480
v_exp_f32 v229, v229
Mvav 152,236,72
Ta 230,3,20992
v_exp_f32 v230, v230
Mvav 96,208,80
Ta 232,4,20480
GDMA 15,98,3072
v_exp_f32 v231, v231
Mvav 100,208,84
Ta 234,4,20992
v_mul_f32 v172, v172, v204
s_waitcnt lgkmcnt(4)
Mvav 108,212,84
Ta 236,5,20480
v_mul_f32 v173, v173, v205
v_add_f32 v228, 1.0, v228
Mvav 104,212,80
Ta 238,5,20992
v_add_f32 v229, 1.0, v229
Mvav 112,216,80
Ta 208,2,24576
v_add_f32 v230, 1.0, v230
v_add_f32 v231, 1.0, v231
Mvav 116,216,84
Ta 210,2,25088
v_rcp_f32 v228, v228
Mvav 124,220,84
Ta 212,3,24576
v_rcp_f32 v229, v229
Mvav 120,220,80
Ta 214,3,25088
v_rcp_f32 v230, v230
Mvav 128,224,80
Ta 216,4,24576
v_rcp_f32 v231, v231
Mvav 132,224,84
Ta 218,4,25088
s_waitcnt lgkmcnt(4)
Mvav 140,228,84
Ta 220,5,24576
v_mul_f32 v174, v174, v206
v_mul_f32 v175, v175, v207
Mvav 136,228,80
Ta 222,5,25088
v_mul_f32 v172, v172, v228
Mvav 144,232,80
Ta 224,2,28672
v_mul_f32 v173, v173, v229
v_mul_f32 v174, v174, v230
Mvav 148,232,84
Ta 226,2,29184
v_mul_f32 v175, v175, v231
Mvav 156,236,84
Ta 228,3,28672
v_cvt_pk_bf16_f32 v228, v172, v173
v_cvt_pk_bf16_f32 v229, v174, v175
Mvav 152,236,80
Ta 230,3,29184
v_accvgpr_write_b32 a70, v228
v_accvgpr_write_b32 a71, v229
Mvav 96,208,88
Ta 232,4,28672
v_fma_f32 v224, -v176, v176, s49
Mvav 100,208,92
Ta 234,4,29184
s_waitcnt lgkmcnt(4)
Mvav 108,212,92
Ta 236,5,28672
v_fma_f32 v225, -v177, v177, s49
Mvav 104,212,88
Ta 238,5,29184
s_waitcnt vmcnt(21)
s_barrier
Mvav 112,216,88
Ta 208,2,32768
s_mov_b32 m0, s35
Mvav 116,216,92
Ta 210,2,33280
s_add_u32 s44, s36, 0x120300
Mvav 124,220,92
Ta 212,3,32768
s_add_u32 s98, s8, s44
s_addc_u32 s99, s9, 0
Mvav 120,220,88
Ta 214,3,33280
GDMA 12,98,0
Mvav 128,224,88
Ta 216,4,32768
GDMA 13,98,1024
Mvav 132,224,92
Ta 218,4,33280
s_waitcnt lgkmcnt(4)
Mvav 140,228,92
Ta 220,5,32768
v_fma_f32 v226, -v178, v178, s49
Mvav 136,228,88
Ta 222,5,33280
v_fma_f32 v227, -v179, v179, s49
Mvav 144,232,88
Ta 224,2,36864
GDMA 14,98,2048
Mvav 148,232,92
Ta 226,2,37376
v_mul_f32 v224, v224, v176
Mvav 156,236,92
Ta 228,3,36864
v_mul_f32 v225, v225, v177
Mvav 152,236,88
Ta 230,3,37376
v_mul_f32 v226, v226, v178
v_mul_f32 v227, v227, v179
Mvaa 96,208,144
Ta 232,4,36864
GDMA 15,98,3072
Mvaa 100,208,148
Ta 234,4,37376
v_exp_f32 v224, v224
s_waitcnt lgkmcnt(4)
Mvaa 108,212,148
Ta 236,5,36864
v_exp_f32 v225, v225
Mvaa 104,212,144
Ta 238,5,37376
v_exp_f32 v226, v226
Mvaa 112,216,144
Ta 208,2,40960
v_exp_f32 v227, v227
Mvaa 116,216,148
Ta 210,2,41472
v_mul_f32 v176, v176, v208
Mvaa 124,220,148
Ta 212,3,40960
v_mul_f32 v177, v177, v209
v_add_f32 v224, 1.0, v224
Mvaa 120,220,144
Ta 214,3,41472
v_add_f32 v225, 1.0, v225
Mvaa 128,224,144
Ta 216,4,40960
v_add_f32 v226, 1.0, v226
v_add_f32 v227, 1.0, v227
Mvaa 132,224,148
Ta 218,4,41472
v_rcp_f32 v224, v224
s_waitcnt lgkmcnt(4)
Mvaa 140,228,148
Ta 220,5,40960
v_rcp_f32 v225, v225
Mvaa 136,228,144
Ta 222,5,41472
v_rcp_f32 v226, v226
Mvaa 144,232,144
Ta 224,2,45056
v_rcp_f32 v227, v227
Mvaa 148,232,148
Ta 226,2,45568
v_mul_f32 v178, v178, v210
Mvaa 156,236,148
Ta 228,3,45056
v_mul_f32 v179, v179, v211
Mvaa 152,236,144
Ta 230,3,45568
v_mul_f32 v176, v176, v224
Mvaa 96,208,152
Ta 232,4,45056
v_mul_f32 v177, v177, v225
v_mul_f32 v178, v178, v226
Mvaa 100,208,156
Ta 234,4,45568
v_mul_f32 v179, v179, v227
s_waitcnt lgkmcnt(4)
Mvaa 108,212,156
Ta 236,5,45056
v_cvt_pk_bf16_f32 v224, v176, v177
v_cvt_pk_bf16_f32 v225, v178, v179
Mvaa 104,212,152
Ta 238,5,45568
v_accvgpr_write_b32 a72, v224
v_accvgpr_write_b32 a73, v225
s_waitcnt vmcnt(21)
s_barrier
Mvaa 112,216,152
Ta 208,2,49152
s_add_u32 m0, s35, 0x4000
Mvaa 116,216,156
Ta 210,2,49664
s_add_u32 s44, s36, 0x1b0300
Mvaa 124,220,156
Ta 212,3,49152
s_add_u32 s98, s8, s44
s_addc_u32 s99, s9, 0
Mvaa 120,220,152
Ta 214,3,49664
GDMA 12,98,0
Mvaa 128,224,152
Ta 216,4,49152
GDMA 13,98,1024
Mvaa 132,224,156
Ta 218,4,49664
s_waitcnt lgkmcnt(4)
Mvaa 140,228,156
Ta 220,5,49152
v_fma_f32 v228, -v180, v180, s49
Mvaa 136,228,152
Ta 222,5,49664
v_fma_f32 v229, -v181, v181, s49
Mvaa 144,232,152
Ta 224,2,53248
GDMA 14,98,2048
Mvaa 148,232,156
Ta 226,2,53760
v_fma_f32 v230, -v182, v182, s49
Mvaa 156,236,156
Ta 228,3,53248
v_fma_f32 v231, -v183, v183, s49
Mvaa 152,236,152
Ta 230,3,53760
v_mul_f32 v228, v228, v180
Mvaa 96,208,160
Ta 232,4,53248
GDMA 15,98,3072
Mvaa 100,208,164
Ta 234,4,53760
s_waitcnt lgkmcnt(4)
Mvaa 108,212,164
Ta 236,5,53248
v_mul_f32 v229, v229, v181
Mvaa 104,212,160
Ta 238,5,53760
v_mul_f32 v230, v230, v182
v_mul_f32 v231, v231, v183
Mvaa 112,216,160
Ta 208,2,57344
v_exp_f32 v228, v228
Mvaa 116,216,164
Ta 210,2,57856
v_exp_f32 v229, v229
Mvaa 124,220,164
Ta 212,3,57344
v_exp_f32 v230, v230
Mvaa 120,220,160
Ta 214,3,57856
v_exp_f32 v231, v231
Mvaa 128,224,160
Ta 216,4,57344
v_mul_f32 v180, v180, v212
Mvaa 132,224,164
Ta 218,4,57856
s_waitcnt lgkmcnt(4)
Mvaa 140,228,164
Ta 220,5,57344
v_mul_f32 v181, v181, v213
v_add_f32 v228, 1.0, v228
Mvaa 136,228,160
Ta 222,5,57856
v_add_f32 v229, 1.0, v229
Mvaa 144,232,160
Ta 224,2,61440
v_add_f32 v230, 1.0, v230
v_add_f32 v231, 1.0, v231
Mvaa 148,232,164
Ta 226,2,61952
v_xor_b32 v2, 0x10000, v2
v_rcp_f32 v228, v228
Mvaa 156,236,164
Ta 228,3,61440
v_rcp_f32 v229, v229
Mvaa 152,236,160
Ta 230,3,61952
v_xor_b32 v3, 0x10000, v3
Mvaa 96,208,168
Ta 232,4,61440
v_rcp_f32 v230, v230
Mvaa 100,208,172
Ta 234,4,61952
v_xor_b32 v4, 0x10000, v4
v_rcp_f32 v231, v231
s_waitcnt lgkmcnt(4)
Mvaa 108,212,172
Ta 236,5,61440
v_mul_f32 v182, v182, v214
v_mul_f32 v183, v183, v215
Mvaa 104,212,168
Ta 238,5,61952
v_xor_b32 v5, 0x10000, v5
v_mul_f32 v180, v180, v228
s_waitcnt vmcnt(20)
s_barrier
Mvaa 112,216,168
Ta 208,2,0
s_add_u32 m0, s35, 0x8000
v_mul_f32 v181, v181, v229
v_mul_f32 v182, v182, v230
Mvaa 116,216,172
Ta 210,2,512
s_add_u32 s44, s36, 0x240300
v_mul_f32 v183, v183, v231
Mvaa 124,220,172
Ta 212,3,0
s_add_u32 s98, s8, s44
s_addc_u32 s99, s9, 0
v_cvt_pk_bf16_f32 v228, v180, v181
v_cvt_pk_bf16_f32 v229, v182, v183
Mvaa 120,220,168
Ta 214,3,512
GDMA 12,98,0
v_accvgpr_write_b32 a76, v228
v_accvgpr_write_b32 a77, v229
Mvaa 128,224,168
Ta 216,4,0
GDMA 13,98,1024
Mvaa 132,224,172
Ta 218,4,512
s_waitcnt lgkmcnt(4)
Mvaa 140,228,172
Ta 220,5,0
v_fma_f32 v224, -v184, v184, s49
Mvaa 136,228,168
Ta 222,5,512
v_fma_f32 v225, -v185, v185, s49
Mvaa 144,232,168
Ta 224,2,4096
GDMA 14,98,2048
Mvaa 148,232,172
Ta 226,2,4608
v_fma_f32 v226, -v186, v186, s49
Mvaa 156,236,172
Ta 228,3,4096
v_fma_f32 v227, -v187, v187, s49
Mvaa 152,236,168
Ta 230,3,4608
v_mul_f32 v224, v224, v184
Mvaa 96,208,176
Ta 232,4,4096
GDMA 15,98,3072
Mvaa 100,208,180
Ta 234,4,4608
s_waitcnt lgkmcnt(4)
Mvaa 108,212,180
Ta 236,5,4096
v_mul_f32 v225, v225, v185
Mvaa 104,212,176
Ta 238,5,4608
v_mul_f32 v226, v226, v186
Mvaa 112,216,176
Ta 208,2,8192
v_mul_f32 v227, v227, v187
Mvaa 116,216,180
Ta 210,2,8704
v_exp_f32 v224, v224
Mvaa 124,220,180
Ta 212,3,8192
v_exp_f32 v225, v225
Mvaa 120,220,176
Ta 214,3,8704
v_exp_f32 v226, v226
Mvaa 128,224,176
Ta 216,4,8192
v_exp_f32 v227, v227
Mvaa 132,224,180
Ta 218,4,8704
s_waitcnt lgkmcnt(4)
Mvaa 140,228,180
Ta 220,5,8192
v_mul_f32 v184, v184, v216
Mvaa 136,228,176
Ta 222,5,8704
v_mul_f32 v185, v185, v217
Mvaa 144,232,176
Ta 224,2,12288
v_add_f32 v224, 1.0, v224
Mvaa 148,232,180
Ta 226,2,12800
v_add_f32 v225, 1.0, v225
Mvaa 156,236,180
Ta 228,3,12288
v_add_f32 v226, 1.0, v226
Mvaa 152,236,176
Ta 230,3,12800
v_add_f32 v227, 1.0, v227
Mvaa 96,208,184
Ta 232,4,12288
v_rcp_f32 v224, v224
Mvaa 100,208,188
Ta 234,4,12800
s_waitcnt lgkmcnt(4)
Mvaa 108,212,188
Ta 236,5,12288
v_rcp_f32 v225, v225
Mvaa 104,212,184
Ta 238,5,12800
s_waitcnt vmcnt(20)
s_barrier
Mvaa 112,216,184
Ta 208,2,16384
s_add_u32 m0, s35, 0xc000
v_rcp_f32 v226, v226
Mvaa 116,216,188
Ta 210,2,16896
s_add_u32 s44, s36, 0x2d0300
v_rcp_f32 v227, v227
Mvaa 124,220,188
Ta 212,3,16384
s_add_u32 s98, s8, s44
s_addc_u32 s99, s9, 0
v_mul_f32 v186, v186, v218
v_mul_f32 v187, v187, v219
Mvaa 120,220,184
Ta 214,3,16896
GDMA 12,98,0
v_mul_f32 v184, v184, v224
Mvaa 128,224,184
Ta 216,4,16384
GDMA 13,98,1024
v_mul_f32 v185, v185, v225
v_mul_f32 v186, v186, v226
Mvaa 132,224,188
Ta 218,4,16896
v_mul_f32 v187, v187, v227
s_waitcnt lgkmcnt(4)
Mvaa 140,228,188
Ta 220,5,16384
v_cvt_pk_bf16_f32 v224, v184, v185
v_cvt_pk_bf16_f32 v225, v186, v187
Mvaa 136,228,184
Ta 222,5,16896
v_accvgpr_write_b32 a74, v224
v_accvgpr_write_b32 a75, v225
Mvaa 144,232,184
Ta 224,2,20480
GDMA 14,98,2048
Mvaa 148,232,188
Ta 226,2,20992
v_fma_f32 v228, -v188, v188, s49
Mvaa 156,236,188
Ta 228,3,20480
v_fma_f32 v229, -v189, v189, s49
Mvaa 152,236,184
Ta 230,3,20992
v_fma_f32 v230, -v190, v190, s49
Mvaa 96,208,192
Ta 232,4,20480
GDMA 15,98,3072
Mvaa 100,208,196
Ta 234,4,20992
s_waitcnt lgkmcnt(4)
Mvaa 108,212,196
Ta 236,5,20480
v_fma_f32 v231, -v191, v191, s49
Mvaa 104,212,192
Ta 238,5,20992
v_mul_f32 v228, v228, v188
Mvaa 112,216,192
Ta 208,2,24576
v_mul_f32 v229, v229, v189
Mvaa 116,216,196
Ta 210,2,25088
v_mul_f32 v230, v230, v190
Mvaa 124,220,196
Ta 212,3,24576
v_mul_f32 v231, v231, v191
Mvaa 120,220,192
Ta 214,3,25088
v_exp_f32 v228, v228
Mvaa 128,224,192
Ta 216,4,24576
v_exp_f32 v229, v229
Mvaa 132,224,196
Ta 218,4,25088
s_waitcnt lgkmcnt(4)
Mvaa 140,228,196
Ta 220,5,24576
v_exp_f32 v230, v230
Mvaa 136,228,192
Ta 222,5,25088
v_exp_f32 v231, v231
Mvaa 144,232,192
Ta 224,2,28672
v_mul_f32 v188, v188, v220
Mvaa 148,232,196
Ta 226,2,29184
v_mul_f32 v189, v189, v221
Mvaa 156,236,196
Ta 228,3,28672
v_add_f32 v228, 1.0, v228
Mvaa 152,236,192
Ta 230,3,29184
v_add_f32 v229, 1.0, v229
Mvaa 96,208,200
Ta 232,4,28672
v_add_f32 v230, 1.0, v230
Mvaa 100,208,204
Ta 234,4,29184
s_waitcnt lgkmcnt(4)
Mvaa 108,212,204
Ta 236,5,28672
v_add_f32 v231, 1.0, v231
Mvaa 104,212,200
Ta 238,5,29184
s_waitcnt vmcnt(20)
s_barrier
Mvaa 112,216,200
Ta 208,2,32768
s_add_u32 m0, s35, 0x10000
Mvaa 116,216,204
Ta 210,2,33280
s_add_u32 s44, s36, 0x360300
v_rcp_f32 v228, v228
Mvaa 124,220,204
Ta 212,3,32768
s_add_u32 s98, s8, s44
s_addc_u32 s99, s9, 0
Mvaa 120,220,200
Ta 214,3,33280
GDMA 12,98,0
v_rcp_f32 v229, v229
Mvaa 128,224,200
Ta 216,4,32768
GDMA 13,98,1024
v_rcp_f32 v230, v230
Mvaa 132,224,204
Ta 218,4,33280
v_rcp_f32 v231, v231
s_waitcnt lgkmcnt(4)
Mvaa 140,228,204
Ta 220,5,32768
v_mul_f32 v190, v190, v222
v_mul_f32 v191, v191, v223
Mvaa 136,228,200
Ta 222,5,33280
v_mul_f32 v188, v188, v228
Mvaa 144,232,200
Ta 224,2,36864
GDMA 14,98,2048
v_mul_f32 v189, v189, v229
v_mul_f32 v190, v190, v230
Mvaa 148,232,204
Ta 226,2,37376
v_mul_f32 v191, v191, v231
Mvaa 156,236,204
Ta 228,3,36864
v_cvt_pk_bf16_f32 v228, v188, v189
v_cvt_pk_bf16_f32 v229, v190, v191
Mvaa 152,236,200
Ta 230,3,37376
v_accvgpr_write_b32 a78, v228
v_accvgpr_write_b32 a79, v229
Zvav 160,208,16
Ta 232,4,36864
GDMA 15,98,3072
Zvav 164,208,20
Ta 234,4,37376
s_waitcnt lgkmcnt(4)
Zvav 172,212,20
Ta 236,5,36864
v_fma_f32 v224, -v96, v96, s49
Zvav 168,212,16
Ta 238,5,37376
v_fma_f32 v225, -v97, v97, s49
Zvav 176,216,16
Ta 208,2,40960
v_fma_f32 v226, -v98, v98, s49
Zvav 180,216,20
Ta 210,2,41472
v_fma_f32 v227, -v99, v99, s49
Zvav 188,220,20
Ta 212,3,40960
v_mul_f32 v224, v224, v96
Zvav 184,220,16
Ta 214,3,41472
v_mul_f32 v225, v225, v97
Zvav 192,224,16
Ta 216,4,40960
buffer_load_dword a241, v253, s[8:11], 0 offen offset:1024
Zvav 196,224,20
Ta 218,4,41472
s_waitcnt lgkmcnt(4)
Zvav 204,228,20
Ta 220,5,40960
v_mul_f32 v226, v226, v98
Zvav 200,228,16
Ta 222,5,41472
v_mul_f32 v227, v227, v99
Zvav 208,232,16
Ta 224,2,45056
v_exp_f32 v224, v224
Zvav 212,232,20
Ta 226,2,45568
v_exp_f32 v225, v225
Zvav 220,236,20
Ta 228,3,45056
v_exp_f32 v226, v226
Zvav 216,236,16
Ta 230,3,45568
v_exp_f32 v227, v227
Mvav 160,208,24
Ta 232,4,45056
v_mul_f32 v96, v96, v128
Mvav 164,208,28
Ta 234,4,45568
s_waitcnt lgkmcnt(4)
Mvav 172,212,28
Ta 236,5,45056
v_mul_f32 v97, v97, v129
Mvav 168,212,24
Ta 238,5,45568
s_waitcnt vmcnt(21)
s_barrier
Mvav 176,216,24
Ta 208,2,49152
s_add_u32 m0, s35, 0x14000
Mvav 180,216,28
Ta 210,2,49664
s_add_u32 s44, s36, 0x3f0300
Mvav 188,220,28
Ta 212,3,49152
s_add_u32 s98, s8, s44
s_addc_u32 s99, s9, 0
v_add_f32 v224, 1.0, v224
Mvav 184,220,24
Ta 214,3,49664
GDMA 12,98,0
v_add_f32 v225, 1.0, v225
Mvav 192,224,24
Ta 216,4,49152
GDMA 13,98,1024
v_add_f32 v226, 1.0, v226
v_add_f32 v227, 1.0, v227
Mvav 196,224,28
Ta 218,4,49664
v_rcp_f32 v224, v224
s_waitcnt lgkmcnt(4)
Mvav 204,228,28
Ta 220,5,49152
v_rcp_f32 v225, v225
Mvav 200,228,24
Ta 222,5,49664
v_rcp_f32 v226, v226
Mvav 208,232,24
Ta 224,2,53248
GDMA 14,98,2048
Mvav 212,232,28
Ta 226,2,53760
v_rcp_f32 v227, v227
Mvav 220,236,28
Ta 228,3,53248
v_mul_f32 v98, v98, v130
v_mul_f32 v99, v99, v131
Mvav 216,236,24
Ta 230,3,53760
v_mul_f32 v96, v96, v224
Mvav 160,208,32
Ta 232,4,53248
GDMA 15,98,3072
v_mul_f32 v97, v97, v225
v_mul_f32 v98, v98, v226
Mvav 164,208,36
Ta 234,4,53760
v_mul_f32 v99, v99, v227
s_waitcnt lgkmcnt(4)
Mvav 172,212,36
Ta 236,5,53248
v_cvt_pk_bf16_f32 v224, v96, v97
v_cvt_pk_bf16_f32 v225, v98, v99
Mvav 168,212,32
Ta 238,5,53760
v_accvgpr_write_b32 a80, v224
v_accvgpr_write_b32 a81, v225
Mvav 176,216,32
Ta 208,2,57344
s_lshl_b32 s45, s33, 2
Mvav 180,216,36
Ta 210,2,57856
v_mov_b32 v246, 0x7ffffff0
Mvav 188,220,36
Ta 212,3,57344
v_fma_f32 v228, -v100, v100, s49
Mvav 184,220,32
Ta 214,3,57856
v_mov_b32 v247, s45
Mvav 192,224,32
Ta 216,4,57344
v_fma_f32 v229, -v101, v101, s49
Mvav 196,224,36
Ta 218,4,57856
s_waitcnt lgkmcnt(4)
Mvav 204,228,36
Ta 220,5,57344
v_cndmask_b32 v246, v246, v247, s[92:93]
Mvav 200,228,32
Ta 222,5,57856
v_fma_f32 v230, -v102, v102, s49
Mvav 208,232,32
Ta 224,2,61440
v_mov_b32 v247, 1
Mvav 212,232,36
Ta 226,2,61952
v_xor_b32 v2, 0x10000, v2
Mvav 220,236,36
Ta 228,3,61440
buffer_atomic_add v247, v246, s[68:71], 0 offen
Mvav 216,236,32
Ta 230,3,61952
v_xor_b32 v3, 0x10000, v3
Mvav 160,208,40
Ta 232,4,61440
v_fma_f32 v231, -v103, v103, s49
Mvav 164,208,44
Ta 234,4,61952
v_xor_b32 v4, 0x10000, v4
s_waitcnt lgkmcnt(4)
Mvav 172,212,44
Ta 236,5,61440
v_mul_f32 v228, v228, v100
v_mul_f32 v229, v229, v101
Mvav 168,212,40
Ta 238,5,61952
v_xor_b32 v5, 0x10000, v5
v_mul_f32 v230, v230, v102
v_mul_f32 v231, v231, v103
s_waitcnt vmcnt(22)
s_barrier
Mvav 176,216,40
Ta 208,2,0
s_add_u32 m0, s35, 0x18000
Mvav 180,216,44
Ta 210,2,512
s_add_u32 s44, s36, 0x480300
v_exp_f32 v228, v228
Mvav 188,220,44
Ta 212,3,0
s_add_u32 s98, s8, s44
s_addc_u32 s99, s9, 0
v_exp_f32 v229, v229
Mvav 184,220,40
Ta 214,3,512
GDMA 12,98,0
v_exp_f32 v230, v230
Mvav 192,224,40
Ta 216,4,0
GDMA 13,98,1024
v_exp_f32 v231, v231
Mvav 196,224,44
Ta 218,4,512
v_mul_f32 v100, v100, v132
s_waitcnt lgkmcnt(4)
Mvav 204,228,44
Ta 220,5,0
v_mul_f32 v101, v101, v133
v_add_f32 v228, 1.0, v228
Mvav 200,228,40
Ta 222,5,512
v_add_f32 v229, 1.0, v229
Mvav 208,232,40
Ta 224,2,4096
GDMA 14,98,2048
v_add_f32 v230, 1.0, v230
v_add_f32 v231, 1.0, v231
Mvav 212,232,44
Ta 226,2,4608
v_rcp_f32 v228, v228
Mvav 220,236,44
Ta 228,3,4096
v_rcp_f32 v229, v229
Mvav 216,236,40
Ta 230,3,4608
v_rcp_f32 v230, v230
Mvav 160,208,48
Ta 232,4,4096
GDMA 15,98,3072
Mvav 164,208,52
Ta 234,4,4608
v_rcp_f32 v231, v231
s_waitcnt lgkmcnt(4)
Mvav 172,212,52
Ta 236,5,4096
v_mul_f32 v102, v102, v134
v_mul_f32 v103, v103, v135
Mvav 168,212,48
Ta 238,5,4608
v_mul_f32 v100, v100, v228
Mvav 176,216,48
Ta 208,2,8192
v_mul_f32 v101, v101, v229
v_mul_f32 v102, v102, v230
Mvav 180,216,52
Ta 210,2,8704
v_mul_f32 v103, v103, v231
Mvav 188,220,52
Ta 212,3,8192
v_cvt_pk_bf16_f32 v228, v100, v101
v_cvt_pk_bf16_f32 v229, v102, v103
Mvav 184,220,48
Ta 214,3,8704
v_accvgpr_write_b32 a84, v228
v_accvgpr_write_b32 a85, v229
Mvav 192,224,48
Ta 216,4,8192
v_fma_f32 v224, -v104, v104, s49
Mvav 196,224,52
Ta 218,4,8704
s_waitcnt lgkmcnt(4)
Mvav 204,228,52
Ta 220,5,8192
v_fma_f32 v225, -v105, v105, s49
Mvav 200,228,48
Ta 222,5,8704
v_fma_f32 v226, -v106, v106, s49
Mvav 208,232,48
Ta 224,2,12288
v_fma_f32 v227, -v107, v107, s49
Mvav 212,232,52
Ta 226,2,12800
v_mul_f32 v224, v224, v104
Mvav 220,236,52
Ta 228,3,12288
v_mul_f32 v225, v225, v105
Mvav 216,236,48
Ta 230,3,12800
v_mul_f32 v226, v226, v106
Mvav 160,208,56
Ta 232,4,12288
v_mul_f32 v227, v227, v107
Mvav 164,208,60
Ta 234,4,12800
s_waitcnt lgkmcnt(4)
Mvav 172,212,60
Ta 236,5,12288
v_exp_f32 v224, v224
Mvav 168,212,56
Ta 238,5,12800
s_waitcnt vmcnt(22)
s_barrier
Mvav 176,216,56
Ta 208,2,16384
s_add_u32 m0, s35, 0x1c000
Mvav 180,216,60
Ta 210,2,16896
s_add_u32 s44, s36, 0x380
Mvav 188,220,60
Ta 212,3,16384
s_add_u32 s98, s8, s44
s_addc_u32 s99, s9, 0
Mvav 184,220,56
Ta 214,3,16896
GDMA 12,98,0
Mvav 192,224,56
Ta 216,4,16384
GDMA 13,98,1024
Mvav 196,224,60
Ta 218,4,16896
s_waitcnt lgkmcnt(4)
Mvav 204,228,60
Ta 220,5,16384
v_exp_f32 v225, v225
Mvav 200,228,56
Ta 222,5,16896
v_exp_f32 v226, v226
Mvav 208,232,56
Ta 224,2,20480
GDMA 14,98,2048
v_exp_f32 v227, v227
Mvav 212,232,60
Ta 226,2,20992
v_mul_f32 v104, v104, v136
Mvav 220,236,60
Ta 228,3,20480
v_mul_f32 v105, v105, v137
v_add_f32 v224, 1.0, v224
Mvav 216,236,56
Ta 230,3,20992
v_add_f32 v225, 1.0, v225
Mvav 160,208,64
Ta 232,4,20480
GDMA 15,98,3072
v_add_f32 v226, 1.0, v226
v_add_f32 v227, 1.0, v227
Mvav 164,208,68
Ta 234,4,20992
v_rcp_f32 v224, v224
s_waitcnt lgkmcnt(4)
Mvav 172,212,68
Ta 236,5,20480
v_rcp_f32 v225, v225
Mvav 168,212,64
Ta 238,5,20992
v_rcp_f32 v226, v226
Mvav 176,216,64
Ta 208,2,24576
v_rcp_f32 v227, v227
Mvav 180,216,68
Ta 210,2,25088
v_mul_f32 v106, v106, v138
Mvav 188,220,68
Ta 212,3,24576
v_mul_f32 v107, v107, v139
Mvav 184,220,64
Ta 214,3,25088
v_mul_f32 v104, v104, v224
Mvav 192,224,64
Ta 216,4,24576
v_mul_f32 v105, v105, v225
v_mul_f32 v106, v106, v226
Mvav 196,224,68
Ta 218,4,25088
v_mul_f32 v107, v107, v227
s_waitcnt lgkmcnt(4)
Mvav 204,228,68
Ta 220,5,24576
v_cvt_pk_bf16_f32 v224, v104, v105
v_cvt_pk_bf16_f32 v225, v106, v107
Mvav 200,228,64
Ta 222,5,25088
v_accvgpr_write_b32 a82, v224
v_accvgpr_write_b32 a83, v225
Mvav 208,232,64
Ta 224,2,28672
v_fma_f32 v228, -v108, v108, s49
Mvav 212,232,68
Ta 226,2,29184
v_fma_f32 v229, -v109, v109, s49
Mvav 220,236,68
Ta 228,3,28672
v_fma_f32 v230, -v110, v110, s49
Mvav 216,236,64
Ta 230,3,29184
v_fma_f32 v231, -v111, v111, s49
Mvav 160,208,72
Ta 232,4,28672
v_mul_f32 v228, v228, v108
Mvav 164,208,76
Ta 234,4,29184
s_waitcnt lgkmcnt(4)
Mvav 172,212,76
Ta 236,5,28672
v_mul_f32 v229, v229, v109
Mvav 168,212,72
Ta 238,5,29184
s_waitcnt vmcnt(22)
s_barrier
Mvav 176,216,72
Ta 208,2,32768
s_mov_b32 m0, s35
Mvav 180,216,76
Ta 210,2,33280
s_add_u32 s44, s36, 0x90380
Mvav 188,220,76
Ta 212,3,32768
s_add_u32 s98, s8, s44
s_addc_u32 s99, s9, 0
Mvav 184,220,72
Ta 214,3,33280
GDMA 12,98,0
Mvav 192,224,72
Ta 216,4,32768
GDMA 13,98,1024
Mvav 196,224,76
Ta 218,4,33280
s_waitcnt lgkmcnt(4)
Mvav 204,228,76
Ta 220,5,32768
v_mul_f32 v230, v230, v110
Mvav 200,228,72
Ta 222,5,33280
v_mul_f32 v231, v231, v111
Mvav 208,232,72
Ta 224,2,36864
GDMA 14,98,2048
Mvav 212,232,76
Ta 226,2,37376
v_exp_f32 v228, v228
Mvav 220,236,76
Ta 228,3,36864
v_exp_f32 v229, v229
Mvav 216,236,72
Ta 230,3,37376
v_exp_f32 v230, v230
Mvav 160,208,80
Ta 232,4,36864
GDMA 15,98,3072
v_exp_f32 v231, v231
Mvav 164,208,84
Ta 234,4,37376
v_mul_f32 v108, v108, v140
s_waitcnt lgkmcnt(4)
Mvav 172,212,84
Ta 236,5,36864
v_mul_f32 v109, v109, v141
v_add_f32 v228, 1.0, v228
Mvav 168,212,80
Ta 238,5,37376
v_add_f32 v229, 1.0, v229
Mvav 176,216,80
Ta 208,2,40960
v_add_f32 v230, 1.0, v230
v_add_f32 v231, 1.0, v231
Mvav 180,216,84
Ta 210,2,41472
v_rcp_f32 v228, v228
Mvav 188,220,84
Ta 212,3,40960
v_rcp_f32 v229, v229
Mvav 184,220,80
Ta 214,3,41472
v_rcp_f32 v230, v230
Mvav 192,224,80
Ta 216,4,40960
v_rcp_f32 v231, v231
Mvav 196,224,84
Ta 218,4,41472
s_waitcnt lgkmcnt(4)
Mvav 204,228,84
Ta 220,5,40960
v_mul_f32 v110, v110, v142
v_mul_f32 v111, v111, v143
Mvav 200,228,80
Ta 222,5,41472
v_mul_f32 v108, v108, v228
Mvav 208,232,80
Ta 224,2,45056
v_mul_f32 v109, v109, v229
v_mul_f32 v110, v110, v230
Mvav 212,232,84
Ta 226,2,45568
v_mul_f32 v111, v111, v231
Mvav 220,236,84
Ta 228,3,45056
v_cvt_pk_bf16_f32 v228, v108, v109
v_cvt_pk_bf16_f32 v229, v110, v111
Mvav 216,236,80
Ta 230,3,45568
v_accvgpr_write_b32 a86, v228
v_accvgpr_write_b32 a87, v229
Mvav 160,208,88
Ta 232,4,45056
v_fma_f32 v224, -v112, v112, s49
Mvav 164,208,92
Ta 234,4,45568
s_waitcnt lgkmcnt(4)
Mvav 172,212,92
Ta 236,5,45056
v_fma_f32 v225, -v113, v113, s49
Mvav 168,212,88
Ta 238,5,45568
s_waitcnt vmcnt(22)
s_barrier
Mvav 176,216,88
Ta 208,2,49152
s_add_u32 m0, s35, 0x4000
Mvav 180,216,92
Ta 210,2,49664
s_add_u32 s44, s36, 0x120380
Mvav 188,220,92
Ta 212,3,49152
s_add_u32 s98, s8, s44
s_addc_u32 s99, s9, 0
Mvav 184,220,88
Ta 214,3,49664
GDMA 12,98,0
Mvav 192,224,88
Ta 216,4,49152
GDMA 13,98,1024
Mvav 196,224,92
Ta 218,4,49664
s_waitcnt lgkmcnt(4)
Mvav 204,228,92
Ta 220,5,49152
v_fma_f32 v226, -v114, v114, s49
Mvav 200,228,88
Ta 222,5,49664
v_fma_f32 v227, -v115, v115, s49
Mvav 208,232,88
Ta 224,2,53248
GDMA 14,98,2048
Mvav 212,232,92
Ta 226,2,53760
v_mul_f32 v224, v224, v112
Mvav 220,236,92
Ta 228,3,53248
v_mul_f32 v225, v225, v113
Mvav 216,236,88
Ta 230,3,53760
v_mul_f32 v226, v226, v114
v_mul_f32 v227, v227, v115
Mvaa 160,208,144
Ta 232,4,53248
GDMA 15,98,3072
Mvaa 164,208,148
Ta 234,4,53760
v_exp_f32 v224, v224
s_waitcnt lgkmcnt(4)
Mvaa 172,212,148
Ta 236,5,53248
v_exp_f32 v225, v225
Mvaa 168,212,144
Ta 238,5,53760
v_exp_f32 v226, v226
Mvaa 176,216,144
Ta 208,2,57344
v_exp_f32 v227, v227
Mvaa 180,216,148
Ta 210,2,57856
v_mul_f32 v112, v112, v144
Mvaa 188,220,148
Ta 212,3,57344
v_mul_f32 v113, v113, v145
v_add_f32 v224, 1.0, v224
Mvaa 184,220,144
Ta 214,3,57856
v_add_f32 v225, 1.0, v225
Mvaa 192,224,144
Ta 216,4,57344
v_add_f32 v226, 1.0, v226
v_add_f32 v227, 1.0, v227
Mvaa 196,224,148
Ta 218,4,57856
v_rcp_f32 v224, v224
s_waitcnt lgkmcnt(4)
Mvaa 204,228,148
Ta 220,5,57344
v_rcp_f32 v225, v225
Mvaa 200,228,144
Ta 222,5,57856
v_rcp_f32 v226, v226
Mvaa 208,232,144
Ta 224,2,61440
v_rcp_f32 v227, v227
Mvaa 212,232,148
Ta 226,2,61952
v_xor_b32 v2, 0x10000, v2
Mvaa 220,236,148
Ta 228,3,61440
v_mul_f32 v114, v114, v146
v_mul_f32 v115, v115, v147
Mvaa 216,236,144
Ta 230,3,61952
v_xor_b32 v3, 0x10000, v3
v_mul_f32 v112, v112, v224
Mvaa 160,208,152
Ta 232,4,61440
v_mul_f32 v113, v113, v225
v_mul_f32 v114, v114, v226
Mvaa 164,208,156
Ta 234,4,61952
v_xor_b32 v4, 0x10000, v4
v_mul_f32 v115, v115, v227
s_waitcnt lgkmcnt(4)
Mvaa 172,212,156
Ta 236,5,61440
v_cvt_pk_bf16_f32 v224, v112, v113
v_cvt_pk_bf16_f32 v225, v114, v115
Mvaa 168,212,152
Ta 238,5,61952
v_xor_b32 v5, 0x10000, v5
v_accvgpr_write_b32 a88, v224
v_accvgpr_write_b32 a89, v225
s_waitcnt vmcnt(22)
s_barrier
Mvaa 176,216,152
Ta 208,2,0
s_add_u32 m0, s35, 0x8000
Mvaa 180,216,156
Ta 210,2,512
s_add_u32 s44, s36, 0x1b0380
Mvaa 188,220,156
Ta 212,3,0
s_add_u32 s98, s8, s44
s_addc_u32 s99, s9, 0
Mvaa 184,220,152
Ta 214,3,512
GDMA 12,98,0
Mvaa 192,224,152
Ta 216,4,0
GDMA 13,98,1024
Mvaa 196,224,156
Ta 218,4,512
s_waitcnt lgkmcnt(4)
Mvaa 204,228,156
Ta 220,5,0
v_fma_f32 v228, -v116, v116, s49
Mvaa 200,228,152
Ta 222,5,512
v_fma_f32 v229, -v117, v117, s49
Mvaa 208,232,152
Ta 224,2,4096
GDMA 14,98,2048
Mvaa 212,232,156
Ta 226,2,4608
v_fma_f32 v230, -v118, v118, s49
Mvaa 220,236,156
Ta 228,3,4096
v_fma_f32 v231, -v119, v119, s49
Mvaa 216,236,152
Ta 230,3,4608
v_mul_f32 v228, v228, v116
Mvaa 160,208,160
Ta 232,4,4096
GDMA 15,98,3072
Mvaa 164,208,164
Ta 234,4,4608
s_waitcnt lgkmcnt(4)
Mvaa 172,212,164
Ta 236,5,4096
v_mul_f32 v229, v229, v117
Mvaa 168,212,160
Ta 238,5,4608
v_mul_f32 v230, v230, v118
v_mul_f32 v231, v231, v119
Mvaa 176,216,160
Ta 208,2,8192
v_exp_f32 v228, v228
Mvaa 180,216,164
Ta 210,2,8704
v_exp_f32 v229, v229
Mvaa 188,220,164
Ta 212,3,8192
v_exp_f32 v230, v230
Mvaa 184,220,160
Ta 214,3,8704
v_exp_f32 v231, v231
Mvaa 192,224,160
Ta 216,4,8192
v_mul_f32 v116, v116, v148
Mvaa 196,224,164
Ta 218,4,8704
s_waitcnt lgkmcnt(4)
Mvaa 204,228,164
Ta 220,5,8192
v_mul_f32 v117, v117, v149
v_add_f32 v228, 1.0, v228
Mvaa 200,228,160
Ta 222,5,8704
v_add_f32 v229, 1.0, v229
Mvaa 208,232,160
Ta 224,2,12288
v_add_f32 v230, 1.0, v230
v_add_f32 v231, 1.0, v231
Mvaa 212,232,164
Ta 226,2,12800
v_rcp_f32 v228, v228
Mvaa 220,236,164
Ta 228,3,12288
v_rcp_f32 v229, v229
Mvaa 216,236,160
Ta 230,3,12800
v_rcp_f32 v230, v230
Mvaa 160,208,168
Ta 232,4,12288
v_rcp_f32 v231, v231
Mvaa 164,208,172
Ta 234,4,12800
s_waitcnt lgkmcnt(4)
Mvaa 172,212,172
Ta 236,5,12288
v_mul_f32 v118, v118, v150
v_mul_f32 v119, v119, v151
Mvaa 168,212,168
Ta 238,5,12800
v_mul_f32 v116, v116, v228
s_waitcnt vmcnt(21)
s_barrier
Mvaa 176,216,168
Ta 208,2,16384
s_add_u32 m0, s35, 0xc000
v_mul_f32 v117, v117, v229
v_mul_f32 v118, v118, v230
Mvaa 180,216,172
Ta 210,2,16896
s_add_u32 s44, s36, 0x240380
v_mul_f32 v119, v119, v231
Mvaa 188,220,172
Ta 212,3,16384
s_add_u32 s98, s8, s44
s_addc_u32 s99, s9, 0
v_cvt_pk_bf16_f32 v228, v116, v117
v_cvt_pk_bf16_f32 v229, v118, v119
Mvaa 184,220,168
Ta 214,3,16896
GDMA 12,98,0
v_accvgpr_write_b32 a92, v228
v_accvgpr_write_b32 a93, v229
Mvaa 192,224,168
Ta 216,4,16384
GDMA 13,98,1024
Mvaa 196,224,172
Ta 218,4,16896
s_waitcnt lgkmcnt(4)
Mvaa 204,228,172
Ta 220,5,16384
v_fma_f32 v224, -v120, v120, s49
Mvaa 200,228,168
Ta 222,5,16896
v_fma_f32 v225, -v121, v121, s49
Mvaa 208,232,168
Ta 224,2,20480
GDMA 14,98,2048
Mvaa 212,232,172
Ta 226,2,20992
v_fma_f32 v226, -v122, v122, s49
Mvaa 220,236,172
Ta 228,3,20480
v_fma_f32 v227, -v123, v123, s49
Mvaa 216,236,168
Ta 230,3,20992
v_mul_f32 v224, v224, v120
Mvaa 160,208,176
Ta 232,4,20480
GDMA 15,98,3072
Mvaa 164,208,180
Ta 234,4,20992
s_waitcnt lgkmcnt(4)
Mvaa 172,212,180
Ta 236,5,20480
v_mul_f32 v225, v225, v121
Mvaa 168,212,176
Ta 238,5,20992
v_mul_f32 v226, v226, v122
Mvaa 176,216,176
Ta 208,2,24576
v_mul_f32 v227, v227, v123
Mvaa 180,216,180
Ta 210,2,25088
v_exp_f32 v224, v224
Mvaa 188,220,180
Ta 212,3,24576
v_exp_f32 v225, v225
Mvaa 184,220,176
Ta 214,3,25088
v_exp_f32 v226, v226
Mvaa 192,224,176
Ta 216,4,24576
v_exp_f32 v227, v227
Mvaa 196,224,180
Ta 218,4,25088
s_waitcnt lgkmcnt(4)
Mvaa 204,228,180
Ta 220,5,24576
v_mul_f32 v120, v120, v152
Mvaa 200,228,176
Ta 222,5,25088
v_mul_f32 v121, v121, v153
Mvaa 208,232,176
Ta 224,2,28672
v_add_f32 v224, 1.0, v224
Mvaa 212,232,180
Ta 226,2,29184
v_add_f32 v225, 1.0, v225
Mvaa 220,236,180
Ta 228,3,28672
v_add_f32 v226, 1.0, v226
Mvaa 216,236,176
Ta 230,3,29184
v_add_f32 v227, 1.0, v227
Mvaa 160,208,184
Ta 232,4,28672
v_rcp_f32 v224, v224
Mvaa 164,208,188
Ta 234,4,29184
s_waitcnt lgkmcnt(4)
Mvaa 172,212,188
Ta 236,5,28672
v_rcp_f32 v225, v225
Mvaa 168,212,184
Ta 238,5,29184
s_waitcnt vmcnt(20)
s_barrier
Mvaa 176,216,184
Ta 208,2,32768
s_add_u32 m0, s35, 0x10000
v_rcp_f32 v226, v226
Mvaa 180,216,188
Ta 210,2,33280
s_add_u32 s44, s36, 0x2d0380
v_rcp_f32 v227, v227
Mvaa 188,220,188
Ta 212,3,32768
s_add_u32 s98, s8, s44
s_addc_u32 s99, s9, 0
v_mul_f32 v122, v122, v154
v_mul_f32 v123, v123, v155
Mvaa 184,220,184
Ta 214,3,33280
GDMA 12,98,0
v_mul_f32 v120, v120, v224
Mvaa 192,224,184
Ta 216,4,32768
GDMA 13,98,1024
v_mul_f32 v121, v121, v225
v_mul_f32 v122, v122, v226
Mvaa 196,224,188
Ta 218,4,33280
v_mul_f32 v123, v123, v227
s_waitcnt lgkmcnt(4)
Mvaa 204,228,188
Ta 220,5,32768
v_cvt_pk_bf16_f32 v224, v120, v121
v_cvt_pk_bf16_f32 v225, v122, v123
Mvaa 200,228,184
Ta 222,5,33280
v_accvgpr_write_b32 a90, v224
v_accvgpr_write_b32 a91, v225
Mvaa 208,232,184
Ta 224,2,36864
GDMA 14,98,2048
Mvaa 212,232,188
Ta 226,2,37376
v_fma_f32 v228, -v124, v124, s49
Mvaa 220,236,188
Ta 228,3,36864
v_fma_f32 v229, -v125, v125, s49
Mvaa 216,236,184
Ta 230,3,37376
v_fma_f32 v230, -v126, v126, s49
Mvaa 160,208,192
Ta 232,4,36864
GDMA 15,98,3072
Mvaa 164,208,196
Ta 234,4,37376
s_waitcnt lgkmcnt(4)
Mvaa 172,212,196
Ta 236,5,36864
v_fma_f32 v231, -v127, v127, s49
Mvaa 168,212,192
Ta 238,5,37376
v_mul_f32 v228, v228, v124
Mvaa 176,216,192
Ta 208,2,40960
v_mul_f32 v229, v229, v125
Mvaa 180,216,196
Ta 210,2,41472
v_mul_f32 v230, v230, v126
Mvaa 188,220,196
Ta 212,3,40960
v_mul_f32 v231, v231, v127
Mvaa 184,220,192
Ta 214,3,41472
v_exp_f32 v228, v228
Mvaa 192,224,192
Ta 216,4,40960
v_exp_f32 v229, v229
Mvaa 196,224,196
Ta 218,4,41472
s_waitcnt lgkmcnt(4)
Mvaa 204,228,196
Ta 220,5,40960
v_exp_f32 v230, v230
Mvaa 200,228,192
Ta 222,5,41472
v_exp_f32 v231, v231
Mvaa 208,232,192
Ta 224,2,45056
v_lshrrev_b32 v244, 3, v1
Mvaa 212,232,196
Ta 226,2,45568
v_mul_f32 v124, v124, v156
Mvaa 220,236,196
Ta 228,3,45056
v_bfe_u32 v245, v1, 1, 2
Mvaa 216,236,192
Ta 230,3,45568
v_mul_f32 v125, v125, v157
Mvaa 160,208,200
Ta 232,4,45056
v_bfe_u32 v241, v1, 4, 2
Mvaa 164,208,204
Ta 234,4,45568
s_waitcnt lgkmcnt(4)
Mvaa 172,212,204
Ta 236,5,45056
v_add_f32 v228, 1.0, v228
Mvaa 168,212,200
Ta 238,5,45568
v_xor_b32 v245, v245, v241
v_add_f32 v229, 1.0, v229
v_lshlrev_b32 v245, 5, v245
s_waitcnt vmcnt(20)
s_barrier
Mvaa 176,216,200
Ta 208,2,49152
s_add_u32 m0, s35, 0x14000
v_add_f32 v230, 1.0, v230
v_and_b32 v241, 1, v1
v_add_f32 v231, 1.0, v231
Mvaa 180,216,204
Ta 210,2,49664
s_add_u32 s44, s36, 0x360380
v_lshl_or_b32 v245, v241, 4, v245
v_mul_u32_u24 v244, 0x480, v244
v_rcp_f32 v228, v228
Mvaa 188,220,204
Ta 212,3,49152
s_add_u32 s98, s8, s44
s_addc_u32 s99, s9, 0
v_add_u32 v240, v244, v245
Mvaa 184,220,200
Ta 214,3,49664
GDMA 12,98,0
v_rcp_f32 v229, v229
v_add_u32 v241, 0x2000, v240
v_add_u32 v242, 0x4000, v240
Mvaa 192,224,200
Ta 216,4,49152
GDMA 13,98,1024
v_rcp_f32 v230, v230
v_add_u32 v243, 0x6000, v240
Mvaa 196,224,204
Ta 218,4,49664
v_lshrrev_b32 v244, 5, v1
v_rcp_f32 v231, v231
v_lshlrev_b32 v244, 10, v244
s_waitcnt lgkmcnt(4)
Mvaa 204,228,204
Ta 220,5,49152
v_mul_f32 v126, v126, v158
v_bfe_u32 v245, v1, 2, 3
v_mul_f32 v127, v127, v159
Mvaa 200,228,200
Ta 222,5,49664
v_lshl_or_b32 v244, v245, 7, v244
v_mul_f32 v124, v124, v228
v_bfe_u32 v245, v1, 3, 2
Mvaa 208,232,200
Ta 224,2,53248
GDMA 14,98,2048
v_mul_f32 v125, v125, v229
v_lshl_or_b32 v244, v245, 5, v244
v_mul_f32 v126, v126, v230
Mvaa 212,232,204
Ta 226,2,53760
v_and_b32 v245, 3, v1
v_mul_f32 v127, v127, v231
v_lshl_or_b32 v236, v245, 3, v244
Mvaa 220,236,204
Ta 228,3,53248
v_cvt_pk_bf16_f32 v228, v124, v125
v_xor_b32 v237, 32, v236
v_cvt_pk_bf16_f32 v229, v126, v127
Mvaa 216,236,200
Ta 230,3,53760
v_xor_b32 v238, 64, v236
v_accvgpr_write_b32 a94, v228
v_xor_b32 v239, 0x60, v236
v_accvgpr_write_b32 a95, v229
Zvav 96,208,16
Ta 232,4,53248
GDMA 15,98,3072
Zvav 100,208,20
Ta 234,4,53760
s_waitcnt lgkmcnt(4)
Zvav 108,212,20
Ta 236,5,53248
v_fma_f32 v224, -v160, v160, s49
Zvav 104,212,16
Ta 238,5,53760
v_fma_f32 v225, -v161, v161, s49
Zvav 112,216,16
Ta 208,2,57344
v_fma_f32 v226, -v162, v162, s49
Zvav 116,216,20
Ta 210,2,57856
v_fma_f32 v227, -v163, v163, s49
Zvav 124,220,20
Ta 212,3,57344
v_mul_f32 v224, v224, v160
Zvav 120,220,16
Ta 214,3,57856
v_mul_f32 v225, v225, v161
Zvav 128,224,16
Ta 216,4,57344
v_mul_f32 v226, v226, v162
Zvav 132,224,20
Ta 218,4,57856
s_waitcnt lgkmcnt(4)
Zvav 140,228,20
Ta 220,5,57344
v_mul_f32 v227, v227, v163
Zvav 136,228,16
Ta 222,5,57856
v_exp_f32 v224, v224
Zvav 144,232,16
Ta 224,2,61440
v_exp_f32 v225, v225
Zvav 148,232,20
Ta 226,2,61952
v_xor_b32 v2, 0x10000, v2
Zvav 156,236,20
Ta 228,3,61440
v_exp_f32 v226, v226
Zvav 152,236,16
Ta 230,3,61952
v_xor_b32 v3, 0x10000, v3
Mvav 96,208,24
Ta 232,4,61440
v_exp_f32 v227, v227
Mvav 100,208,28
Ta 234,4,61952
v_xor_b32 v4, 0x10000, v4
s_waitcnt lgkmcnt(4)
Mvav 108,212,28
Ta 236,5,61440
v_mul_f32 v160, v160, v192
Mvav 104,212,24
Ta 238,5,61952
v_xor_b32 v5, 0x10000, v5
s_waitcnt vmcnt(20)
s_barrier
Mvav 112,216,24
Ta 208,2,0
s_add_u32 m0, s35, 0x18000
Mvav 116,216,28
Ta 210,2,512
s_add_u32 s44, s36, 0x3f0380
Mvav 124,220,28
Ta 212,3,0
s_add_u32 s98, s8, s44
s_addc_u32 s99, s9, 0
v_mul_f32 v161, v161, v193
v_add_f32 v224, 1.0, v224
Mvav 120,220,24
Ta 214,3,512
GDMA 12,98,0
v_add_f32 v225, 1.0, v225
Mvav 128,224,24
Ta 216,4,0
GDMA 13,98,1024
v_add_f32 v226, 1.0, v226
v_add_f32 v227, 1.0, v227
Mvav 132,224,28
Ta 218,4,512
v_rcp_f32 v224, v224
s_waitcnt lgkmcnt(4)
Mvav 140,228,28
Ta 220,5,0
v_rcp_f32 v225, v225
Mvav 136,228,24
Ta 222,5,512
v_rcp_f32 v226, v226
Mvav 144,232,24
Ta 224,2,4096
GDMA 14,98,2048
Mvav 148,232,28
Ta 226,2,4608
v_rcp_f32 v227, v227
Mvav 156,236,28
Ta 228,3,4096
v_mul_f32 v162, v162, v194
v_mul_f32 v163, v163, v195
Mvav 152,236,24
Ta 230,3,4608
v_mul_f32 v160, v160, v224
Mvav 96,208,32
Ta 232,4,4096
GDMA 15,98,3072
v_mul_f32 v161, v161, v225
v_mul_f32 v162, v162, v226
Mvav 100,208,36
Ta 234,4,4608
v_mul_f32 v163, v163, v227
s_waitcnt lgkmcnt(4)
Mvav 108,212,36
Ta 236,5,4096
v_cvt_pk_bf16_f32 v224, v160, v161
v_cvt_pk_bf16_f32 v225, v162, v163
Mvav 104,212,32
Ta 238,5,4608
v_accvgpr_write_b32 a96, v224
v_accvgpr_write_b32 a97, v225
Mvav 112,216,32
Ta 208,2,8192
v_fma_f32 v228, -v164, v164, s49
Mvav 116,216,36
Ta 210,2,8704
v_fma_f32 v229, -v165, v165, s49
Mvav 124,220,36
Ta 212,3,8192
v_fma_f32 v230, -v166, v166, s49
Mvav 120,220,32
Ta 214,3,8704
v_fma_f32 v231, -v167, v167, s49
Mvav 128,224,32
Ta 216,4,8192
v_mul_f32 v228, v228, v164
Mvav 132,224,36
Ta 218,4,8704
s_waitcnt lgkmcnt(4)
Mvav 140,228,36
Ta 220,5,8192
v_mul_f32 v229, v229, v165
Mvav 136,228,32
Ta 222,5,8704
v_mul_f32 v230, v230, v166
Mvav 144,232,32
Ta 224,2,12288
v_mul_f32 v231, v231, v167
Mvav 148,232,36
Ta 226,2,12800
v_exp_f32 v228, v228
Mvav 156,236,36
Ta 228,3,12288
v_exp_f32 v229, v229
Mvav 152,236,32
Ta 230,3,12800
v_exp_f32 v230, v230
Mvav 96,208,40
Ta 232,4,12288
v_exp_f32 v231, v231
Mvav 100,208,44
Ta 234,4,12800
s_waitcnt lgkmcnt(4)
Mvav 108,212,44
Ta 236,5,12288
v_mul_f32 v164, v164, v196
Mvav 104,212,40
Ta 238,5,12800
s_waitcnt vmcnt(20)
s_barrier
Mvav 112,216,40
Ta 208,2,16384
s_add_u32 m0, s35, 0x1c000
Mvav 116,216,44
Ta 210,2,16896
s_add_u32 s44, s36, 0x480380
Mvav 124,220,44
Ta 212,3,16384
s_add_u32 s98, s8, s44
s_addc_u32 s99, s9, 0
Mvav 120,220,40
Ta 214,3,16896
GDMA 12,98,0
Mvav 128,224,40
Ta 216,4,16384
GDMA 13,98,1024
Mvav 132,224,44
Ta 218,4,16896
s_waitcnt lgkmcnt(4)
Mvav 140,228,44
Ta 220,5,16384
v_mul_f32 v165, v165, v197
v_add_f32 v228, 1.0, v228
Mvav 136,228,40
Ta 222,5,16896
v_add_f32 v229, 1.0, v229
Mvav 144,232,40
Ta 224,2,20480
GDMA 14,98,2048
v_add_f32 v230, 1.0, v230
v_add_f32 v231, 1.0, v231
Mvav 148,232,44
Ta 226,2,20992
v_rcp_f32 v228, v228
Mvav 156,236,44
Ta 228,3,20480
v_rcp_f32 v229, v229
Mvav 152,236,40
Ta 230,3,20992
v_rcp_f32 v230, v230
Mvav 96,208,48
Ta 232,4,20480
GDMA 15,98,3072
Mvav 100,208,52
Ta 234,4,20992
v_rcp_f32 v231, v231
s_waitcnt lgkmcnt(4)
Mvav 108,212,52
Ta 236,5,20480
v_mul_f32 v166, v166, v198
v_mul_f32 v167, v167, v199
Mvav 104,212,48
Ta 238,5,20992
v_mul_f32 v164, v164, v228
Mvav 112,216,48
Ta 208,2,24576
v_mul_f32 v165, v165, v229
v_mul_f32 v166, v166, v230
Mvav 116,216,52
Ta 210,2,25088
v_mul_f32 v167, v167, v231
Mvav 124,220,52
Ta 212,3,24576
v_cvt_pk_bf16_f32 v228, v164, v165
v_cvt_pk_bf16_f32 v229, v166, v167
Mvav 120,220,48
Ta 214,3,25088
v_accvgpr_write_b32 a100, v228
v_accvgpr_write_b32 a101, v229
Mvav 128,224,48
Ta 216,4,24576
v_fma_f32 v224, -v168, v168, s49
Mvav 132,224,52
Ta 218,4,25088
s_waitcnt lgkmcnt(4)
Mvav 140,228,52
Ta 220,5,24576
v_fma_f32 v225, -v169, v169, s49
Mvav 136,228,48
Ta 222,5,25088
v_fma_f32 v226, -v170, v170, s49
Mvav 144,232,48
Ta 224,2,28672
v_fma_f32 v227, -v171, v171, s49
Mvav 148,232,52
Ta 226,2,29184
v_mul_f32 v224, v224, v168
Mvav 156,236,52
Ta 228,3,28672
v_mul_f32 v225, v225, v169
Mvav 152,236,48
Ta 230,3,29184
v_mul_f32 v226, v226, v170
Mvav 96,208,56
Ta 232,4,28672
v_mul_f32 v227, v227, v171
Mvav 100,208,60
Ta 234,4,29184
s_waitcnt lgkmcnt(4)
Mvav 108,212,60
Ta 236,5,28672
v_exp_f32 v224, v224
Mvav 104,212,56
Ta 238,5,29184
s_waitcnt vmcnt(20)
s_barrier
Mvav 112,216,56
Ta 208,2,32768
s_mov_b32 m0, s35
Mvav 116,216,60
Ta 210,2,33280
s_add_u32 s44, s36, 0x400
Mvav 124,220,60
Ta 212,3,32768
s_add_u32 s98, s8, s44
s_addc_u32 s99, s9, 0
Mvav 120,220,56
Ta 214,3,33280
GDMA 12,98,0
Mvav 128,224,56
Ta 216,4,32768
GDMA 13,98,1024
Mvav 132,224,60
Ta 218,4,33280
s_waitcnt lgkmcnt(4)
Mvav 140,228,60
Ta 220,5,32768
v_exp_f32 v225, v225
Mvav 136,228,56
Ta 222,5,33280
v_exp_f32 v226, v226
Mvav 144,232,56
Ta 224,2,36864
GDMA 14,98,2048
v_exp_f32 v227, v227
Mvav 148,232,60
Ta 226,2,37376
v_mul_f32 v168, v168, v200
Mvav 156,236,60
Ta 228,3,36864
v_mul_f32 v169, v169, v201
v_add_f32 v224, 1.0, v224
Mvav 152,236,56
Ta 230,3,37376
v_add_f32 v225, 1.0, v225
Mvav 96,208,64
Ta 232,4,36864
GDMA 15,98,3072
v_add_f32 v226, 1.0, v226
v_add_f32 v227, 1.0, v227
Mvav 100,208,68
Ta 234,4,37376
v_rcp_f32 v224, v224
s_waitcnt lgkmcnt(4)
Mvav 108,212,68
Ta 236,5,36864
v_rcp_f32 v225, v225
Mvav 104,212,64
Ta 238,5,37376
v_rcp_f32 v226, v226
Mvav 112,216,64
Ta 208,2,40960
v_rcp_f32 v227, v227
Mvav 116,216,68
Ta 210,2,41472
v_mul_f32 v170, v170, v202
Mvav 124,220,68
Ta 212,3,40960
v_mul_f32 v171, v171, v203
Mvav 120,220,64
Ta 214,3,41472
v_mul_f32 v168, v168, v224
Mvav 128,224,64
Ta 216,4,40960
v_mul_f32 v169, v169, v225
v_mul_f32 v170, v170, v226
Mvav 132,224,68
Ta 218,4,41472
v_mul_f32 v171, v171, v227
s_waitcnt lgkmcnt(4)
Mvav 140,228,68
Ta 220,5,40960
v_cvt_pk_bf16_f32 v224, v168, v169
v_cvt_pk_bf16_f32 v225, v170, v171
Mvav 136,228,64
Ta 222,5,41472
v_accvgpr_write_b32 a98, v224
v_accvgpr_write_b32 a99, v225
Mvav 144,232,64
Ta 224,2,45056
s_lshl_b32 s81, s87, 2
Mvav 148,232,68
Ta 226,2,45568
s_add_u32 s81, s81, s3
Mvav 156,236,68
Ta 228,3,45056
s_mul_i32 s81, s81, 0x2880
Mvav 152,236,64
Ta 230,3,45568
s_mul_i32 s80, s32, 0xa2000
Mvav 96,208,72
Ta 232,4,45056
s_add_u32 s81, s81, s80
Mvav 100,208,76
Ta 234,4,45568
s_waitcnt lgkmcnt(4)
Mvav 108,212,76
Ta 236,5,45056
v_mul_u32_u24 v254, 0x54, v1
Mvav 104,212,72
Ta 238,5,45568
s_waitcnt vmcnt(20)
s_barrier
Mvav 112,216,72
Ta 208,2,49152
s_add_u32 m0, s35, 0x4000
Mvav 116,216,76
Ta 210,2,49664
s_add_u32 s44, s36, 0x90400
Mvav 124,220,76
Ta 212,3,49152
s_add_u32 s98, s8, s44
s_addc_u32 s99, s9, 0
Mvav 120,220,72
Ta 214,3,49664
GDMA 12,98,0
v_add_u32 v254, s81, v254
buffer_load_dword a243, v254, s[12:15], 0 offen offset:0
v_fma_f32 v228, -v172, v172, s49
Mvav 128,224,72
Ta 216,4,49152
GDMA 13,98,1024
v_fma_f32 v229, -v173, v173, s49
v_add_u32 v254, 0x1500, v254
buffer_load_dword a244, v254, s[12:15], 0 offen offset:0
v_fma_f32 v230, -v174, v174, s49
Mvav 132,224,76
Ta 218,4,49664
v_fma_f32 v231, -v175, v175, s49
s_waitcnt lgkmcnt(4)
Mvav 140,228,76
Ta 220,5,49152
v_mul_f32 v228, v228, v172
v_mul_f32 v229, v229, v173
Mvav 136,228,72
Ta 222,5,49664
v_mul_f32 v230, v230, v174
v_mul_f32 v231, v231, v175
Mvav 144,232,72
Ta 224,2,53248
GDMA 14,98,2048
Mvav 148,232,76
Ta 226,2,53760
v_exp_f32 v228, v228
Mvav 156,236,76
Ta 228,3,53248
v_exp_f32 v229, v229
Mvav 152,236,72
Ta 230,3,53760
v_exp_f32 v230, v230
Mvav 96,208,80
Ta 232,4,53248
GDMA 15,98,3072
v_exp_f32 v231, v231
Mvav 100,208,84
Ta 234,4,53760
v_mul_f32 v172, v172, v204
s_waitcnt lgkmcnt(4)
Mvav 108,212,84
Ta 236,5,53248
v_mul_f32 v173, v173, v205
v_add_f32 v228, 1.0, v228
Mvav 104,212,80
Ta 238,5,53760
v_add_f32 v229, 1.0, v229
Mvav 112,216,80
Ta 208,2,57344
v_add_f32 v230, 1.0, v230
v_add_f32 v231, 1.0, v231
Mvav 116,216,84
Ta 210,2,57856
v_rcp_f32 v228, v228
Mvav 124,220,84
Ta 212,3,57344
v_rcp_f32 v229, v229
Mvav 120,220,80
Ta 214,3,57856
v_rcp_f32 v230, v230
Mvav 128,224,80
Ta 216,4,57344
v_rcp_f32 v231, v231
Mvav 132,224,84
Ta 218,4,57856
s_waitcnt lgkmcnt(4)
Mvav 140,228,84
Ta 220,5,57344
v_mul_f32 v174, v174, v206
v_mul_f32 v175, v175, v207
Mvav 136,228,80
Ta 222,5,57856
v_mul_f32 v172, v172, v228
Mvav 144,232,80
Ta 224,2,61440
v_mul_f32 v173, v173, v229
v_mul_f32 v174, v174, v230
Mvav 148,232,84
Ta 226,2,61952
v_xor_b32 v2, 0x10000, v2
v_mul_f32 v175, v175, v231
Mvav 156,236,84
Ta 228,3,61440
v_cvt_pk_bf16_f32 v228, v172, v173
v_cvt_pk_bf16_f32 v229, v174, v175
Mvav 152,236,80
Ta 230,3,61952
v_xor_b32 v3, 0x10000, v3
v_accvgpr_write_b32 a102, v228
v_accvgpr_write_b32 a103, v229
Mvav 96,208,88
Ta 232,4,61440
v_fma_f32 v224, -v176, v176, s49
Mvav 100,208,92
Ta 234,4,61952
v_xor_b32 v4, 0x10000, v4
s_waitcnt lgkmcnt(4)
Mvav 108,212,92
Ta 236,5,61440
v_fma_f32 v225, -v177, v177, s49
Mvav 104,212,88
Ta 238,5,61952
v_xor_b32 v5, 0x10000, v5
s_waitcnt vmcnt(22)
s_barrier
Mvav 112,216,88
Ta 208,2,0
s_add_u32 m0, s35, 0x8000
Mvav 116,216,92
Ta 210,2,512
s_add_u32 s44, s36, 0x120400
Mvav 124,220,92
Ta 212,3,0
s_add_u32 s98, s8, s44
s_addc_u32 s99, s9, 0
Mvav 120,220,88
Ta 214,3,512
GDMA 12,98,0
Mvav 128,224,88
Ta 216,4,0
GDMA 13,98,1024
Mvav 132,224,92
Ta 218,4,512
s_waitcnt lgkmcnt(4)
Mvav 140,228,92
Ta 220,5,0
v_fma_f32 v226, -v178, v178, s49
Mvav 136,228,88
Ta 222,5,512
v_fma_f32 v227, -v179, v179, s49
Mvav 144,232,88
Ta 224,2,4096
GDMA 14,98,2048
Mvav 148,232,92
Ta 226,2,4608
v_mul_f32 v224, v224, v176
Mvav 156,236,92
Ta 228,3,4096
v_mul_f32 v225, v225, v177
Mvav 152,236,88
Ta 230,3,4608
v_mul_f32 v226, v226, v178
v_mul_f32 v227, v227, v179
Mvaa 96,208,144
Ta 232,4,4096
GDMA 15,98,3072
Mvaa 100,208,148
Ta 234,4,4608
v_exp_f32 v224, v224
s_waitcnt lgkmcnt(4)
Mvaa 108,212,148
Ta 236,5,4096
v_exp_f32 v225, v225
Mvaa 104,212,144
Ta 238,5,4608
v_exp_f32 v226, v226
Mvaa 112,216,144
Ta 208,2,8192
v_exp_f32 v227, v227
Mvaa 116,216,148
Ta 210,2,8704
v_mul_f32 v176, v176, v208
Mvaa 124,220,148
Ta 212,3,8192
v_mul_f32 v177, v177, v209
v_add_f32 v224, 1.0, v224
Mvaa 120,220,144
Ta 214,3,8704
v_add_f32 v225, 1.0, v225
Mvaa 128,224,144
Ta 216,4,8192
v_add_f32 v226, 1.0, v226
v_add_f32 v227, 1.0, v227
Mvaa 132,224,148
Ta 218,4,8704
v_rcp_f32 v224, v224
s_waitcnt lgkmcnt(4)
Mvaa 140,228,148
Ta 220,5,8192
v_rcp_f32 v225, v225
Mvaa 136,228,144
Ta 222,5,8704
v_rcp_f32 v226, v226
Mvaa 144,232,144
Ta 224,2,12288
v_rcp_f32 v227, v227
Mvaa 148,232,148
Ta 226,2,12800
v_mul_f32 v178, v178, v210
Mvaa 156,236,148
Ta 228,3,12288
v_mul_f32 v179, v179, v211
Mvaa 152,236,144
Ta 230,3,12800
v_mul_f32 v176, v176, v224
Mvaa 96,208,152
Ta 232,4,12288
v_mul_f32 v177, v177, v225
v_mul_f32 v178, v178, v226
Mvaa 100,208,156
Ta 234,4,12800
v_mul_f32 v179, v179, v227
s_waitcnt lgkmcnt(4)
Mvaa 108,212,156
Ta 236,5,12288
v_cvt_pk_bf16_f32 v224, v176, v177
v_cvt_pk_bf16_f32 v225, v178, v179
Mvaa 104,212,152
Ta 238,5,12800
v_accvgpr_write_b32 a104, v224
v_accvgpr_write_b32 a105, v225
s_waitcnt vmcnt(22)
s_barrier
Mvaa 112,216,152
Ta 208,2,16384
s_add_u32 m0, s35, 0xc000
Mvaa 116,216,156
Ta 210,2,16896
s_add_u32 s44, s36, 0x1b0400
Mvaa 124,220,156
Ta 212,3,16384
s_add_u32 s98, s8, s44
s_addc_u32 s99, s9, 0
Mvaa 120,220,152
Ta 214,3,16896
GDMA 12,98,0
Mvaa 128,224,152
Ta 216,4,16384
GDMA 13,98,1024
Mvaa 132,224,156
Ta 218,4,16896
s_waitcnt lgkmcnt(4)
Mvaa 140,228,156
Ta 220,5,16384
v_fma_f32 v228, -v180, v180, s49
Mvaa 136,228,152
Ta 222,5,16896
v_fma_f32 v229, -v181, v181, s49
Mvaa 144,232,152
Ta 224,2,20480
GDMA 14,98,2048
Mvaa 148,232,156
Ta 226,2,20992
v_fma_f32 v230, -v182, v182, s49
Mvaa 156,236,156
Ta 228,3,20480
v_fma_f32 v231, -v183, v183, s49
Mvaa 152,236,152
Ta 230,3,20992
v_mul_f32 v228, v228, v180
Mvaa 96,208,160
Ta 232,4,20480
GDMA 15,98,3072
Mvaa 100,208,164
Ta 234,4,20992
s_waitcnt lgkmcnt(4)
Mvaa 108,212,164
Ta 236,5,20480
v_mul_f32 v229, v229, v181
Mvaa 104,212,160
Ta 238,5,20992
v_mul_f32 v230, v230, v182
v_mul_f32 v231, v231, v183
Mvaa 112,216,160
Ta 208,2,24576
v_exp_f32 v228, v228
Mvaa 116,216,164
Ta 210,2,25088
v_exp_f32 v229, v229
Mvaa 124,220,164
Ta 212,3,24576
v_exp_f32 v230, v230
Mvaa 120,220,160
Ta 214,3,25088
v_exp_f32 v231, v231
Mvaa 128,224,160
Ta 216,4,24576
v_mul_f32 v180, v180, v212
Mvaa 132,224,164
Ta 218,4,25088
s_waitcnt lgkmcnt(4)
Mvaa 140,228,164
Ta 220,5,24576
v_mul_f32 v181, v181, v213
v_add_f32 v228, 1.0, v228
Mvaa 136,228,160
Ta 222,5,25088
v_add_f32 v229, 1.0, v229
Mvaa 144,232,160
Ta 224,2,28672
v_add_f32 v230, 1.0, v230
v_add_f32 v231, 1.0, v231
Mvaa 148,232,164
Ta 226,2,29184
v_rcp_f32 v228, v228
Mvaa 156,236,164
Ta 228,3,28672
v_rcp_f32 v229, v229
Mvaa 152,236,160
Ta 230,3,29184
v_rcp_f32 v230, v230
Mvaa 96,208,168
Ta 232,4,28672
v_rcp_f32 v231, v231
Mvaa 100,208,172
Ta 234,4,29184
s_waitcnt lgkmcnt(4)
Mvaa 108,212,172
Ta 236,5,28672
v_mul_f32 v182, v182, v214
v_mul_f32 v183, v183, v215
Mvaa 104,212,168
Ta 238,5,29184
v_mul_f32 v180, v180, v228
s_waitcnt vmcnt(22)
s_barrier
Mvaa 112,216,168
Ta 208,2,32768
s_add_u32 m0, s35, 0x10000
v_mul_f32 v181, v181, v229
v_mul_f32 v182, v182, v230
Mvaa 116,216,172
Ta 210,2,33280
s_add_u32 s44, s36, 0x240400
v_mul_f32 v183, v183, v231
Mvaa 124,220,172
Ta 212,3,32768
s_add_u32 s98, s8, s44
s_addc_u32 s99, s9, 0
v_cvt_pk_bf16_f32 v228, v180, v181
v_cvt_pk_bf16_f32 v229, v182, v183
Mvaa 120,220,168
Ta 214,3,33280
GDMA 12,98,0
v_accvgpr_write_b32 a108, v228
v_accvgpr_write_b32 a109, v229
Mvaa 128,224,168
Ta 216,4,32768
GDMA 13,98,1024
Mvaa 132,224,172
Ta 218,4,33280
s_waitcnt lgkmcnt(4)
Mvaa 140,228,172
Ta 220,5,32768
v_fma_f32 v224, -v184, v184, s49
Mvaa 136,228,168
Ta 222,5,33280
v_fma_f32 v225, -v185, v185, s49
Mvaa 144,232,168
Ta 224,2,36864
GDMA 14,98,2048
Mvaa 148,232,172
Ta 226,2,37376
v_fma_f32 v226, -v186, v186, s49
Mvaa 156,236,172
Ta 228,3,36864
v_fma_f32 v227, -v187, v187, s49
Mvaa 152,236,168
Ta 230,3,37376
v_mul_f32 v224, v224, v184
Mvaa 96,208,176
Ta 232,4,36864
GDMA 15,98,3072
Mvaa 100,208,180
Ta 234,4,37376
s_waitcnt lgkmcnt(4)
Mvaa 108,212,180
Ta 236,5,36864
v_mul_f32 v225, v225, v185
Mvaa 104,212,176
Ta 238,5,37376
v_mul_f32 v226, v226, v186
Mvaa 112,216,176
Ta 208,2,40960
v_mul_f32 v227, v227, v187
Mvaa 116,216,180
Ta 210,2,41472
v_exp_f32 v224, v224
Mvaa 124,220,180
Ta 212,3,40960
v_exp_f32 v225, v225
Mvaa 120,220,176
Ta 214,3,41472
v_exp_f32 v226, v226
Mvaa 128,224,176
Ta 216,4,40960
v_exp_f32 v227, v227
Mvaa 132,224,180
Ta 218,4,41472
s_waitcnt lgkmcnt(4)
Mvaa 140,228,180
Ta 220,5,40960
v_mul_f32 v184, v184, v216
Mvaa 136,228,176
Ta 222,5,41472
v_mul_f32 v185, v185, v217
Mvaa 144,232,176
Ta 224,2,45056
v_add_f32 v224, 1.0, v224
Mvaa 148,232,180
Ta 226,2,45568
v_add_f32 v225, 1.0, v225
Mvaa 156,236,180
Ta 228,3,45056
v_add_f32 v226, 1.0, v226
Mvaa 152,236,176
Ta 230,3,45568
v_add_f32 v227, 1.0, v227
Mvaa 96,208,184
Ta 232,4,45056
v_rcp_f32 v224, v224
Mvaa 100,208,188
Ta 234,4,45568
s_waitcnt lgkmcnt(4)
Mvaa 108,212,188
Ta 236,5,45056
v_rcp_f32 v225, v225
Mvaa 104,212,184
Ta 238,5,45568
s_waitcnt vmcnt(22)
s_barrier
Mvaa 112,216,184
Ta 208,2,49152
s_add_u32 m0, s35, 0x14000
v_rcp_f32 v226, v226
Mvaa 116,216,188
Ta 210,2,49664
s_add_u32 s44, s36, 0x2d0400
v_rcp_f32 v227, v227
Mvaa 124,220,188
Ta 212,3,49152
s_add_u32 s98, s8, s44
s_addc_u32 s99, s9, 0
v_mul_f32 v186, v186, v218
v_mul_f32 v187, v187, v219
Mvaa 120,220,184
Ta 214,3,49664
GDMA 12,98,0
v_mul_f32 v184, v184, v224
Mvaa 128,224,184
Ta 216,4,49152
GDMA 13,98,1024
v_mul_f32 v185, v185, v225
v_mul_f32 v186, v186, v226
Mvaa 132,224,188
Ta 218,4,49664
v_mul_f32 v187, v187, v227
s_waitcnt lgkmcnt(4)
Mvaa 140,228,188
Ta 220,5,49152
v_cvt_pk_bf16_f32 v224, v184, v185
v_cvt_pk_bf16_f32 v225, v186, v187
Mvaa 136,228,184
Ta 222,5,49664
v_accvgpr_write_b32 a106, v224
v_accvgpr_write_b32 a107, v225
Mvaa 144,232,184
Ta 224,2,53248
GDMA 14,98,2048
Mvaa 148,232,188
Ta 226,2,53760
v_fma_f32 v228, -v188, v188, s49
Mvaa 156,236,188
Ta 228,3,53248
v_fma_f32 v229, -v189, v189, s49
Mvaa 152,236,184
Ta 230,3,53760
v_fma_f32 v230, -v190, v190, s49
Mvaa 96,208,192
Ta 232,4,53248
GDMA 15,98,3072
Mvaa 100,208,196
Ta 234,4,53760
s_waitcnt lgkmcnt(4)
Mvaa 108,212,196
Ta 236,5,53248
v_fma_f32 v231, -v191, v191, s49
Mvaa 104,212,192
Ta 238,5,53760
v_mul_f32 v228, v228, v188
Mvaa 112,216,192
Ta 208,2,57344
v_mul_f32 v229, v229, v189
Mvaa 116,216,196
Ta 210,2,57856
v_mul_f32 v230, v230, v190
Mvaa 124,220,196
Ta 212,3,57344
v_mul_f32 v231, v231, v191
Mvaa 120,220,192
Ta 214,3,57856
v_exp_f32 v228, v228
Mvaa 128,224,192
Ta 216,4,57344
v_exp_f32 v229, v229
Mvaa 132,224,196
Ta 218,4,57856
s_waitcnt lgkmcnt(4)
Mvaa 140,228,196
Ta 220,5,57344
v_exp_f32 v230, v230
Mvaa 136,228,192
Ta 222,5,57856
v_exp_f32 v231, v231
Mvaa 144,232,192
Ta 224,2,61440
v_mul_f32 v188, v188, v220
Mvaa 148,232,196
Ta 226,2,61952
v_xor_b32 v2, 0x10000, v2
Mvaa 156,236,196
Ta 228,3,61440
v_mul_f32 v189, v189, v221
Mvaa 152,236,192
Ta 230,3,61952
v_xor_b32 v3, 0x10000, v3
Mvaa 96,208,200
Ta 232,4,61440
v_add_f32 v228, 1.0, v228
Mvaa 100,208,204
Ta 234,4,61952
v_xor_b32 v4, 0x10000, v4
s_waitcnt lgkmcnt(4)
Mvaa 108,212,204
Ta 236,5,61440
v_add_f32 v229, 1.0, v229
Mvaa 104,212,200
Ta 238,5,61952
v_xor_b32 v5, 0x10000, v5
s_waitcnt vmcnt(22)
s_barrier
Mvaa 112,216,200
Ta 208,2,0
s_add_u32 m0, s35, 0x18000
v_add_f32 v230, 1.0, v230
v_add_f32 v231, 1.0, v231
Mvaa 116,216,204
Ta 210,2,512
s_add_u32 s44, s36, 0x360400
v_rcp_f32 v228, v228
Mvaa 124,220,204
Ta 212,3,0
s_add_u32 s98, s8, s44
s_addc_u32 s99, s9, 0
Mvaa 120,220,200
Ta 214,3,512
GDMA 12,98,0
v_rcp_f32 v229, v229
Mvaa 128,224,200
Ta 216,4,0
GDMA 13,98,1024
v_rcp_f32 v230, v230
Mvaa 132,224,204
Ta 218,4,512
v_rcp_f32 v231, v231
s_waitcnt lgkmcnt(4)
Mvaa 140,228,204
Ta 220,5,0
v_mul_f32 v190, v190, v222
v_mul_f32 v191, v191, v223
Mvaa 136,228,200
Ta 222,5,512
v_mul_f32 v188, v188, v228
Mvaa 144,232,200
Ta 224,2,4096
GDMA 14,98,2048
v_mul_f32 v189, v189, v229
v_mul_f32 v190, v190, v230
Mvaa 148,232,204
Ta 226,2,4608
v_mul_f32 v191, v191, v231
Mvaa 156,236,204
Ta 228,3,4096
v_cvt_pk_bf16_f32 v228, v188, v189
v_cvt_pk_bf16_f32 v229, v190, v191
Mvaa 152,236,200
Ta 230,3,4608
v_accvgpr_write_b32 a110, v228
v_accvgpr_write_b32 a111, v229
Zvav 160,208,16
Ta 232,4,4096
GDMA 15,98,3072
Zvav 164,208,20
Ta 234,4,4608
s_waitcnt lgkmcnt(4)
Zvav 172,212,20
Ta 236,5,4096
v_fma_f32 v224, -v96, v96, s49
Zvav 168,212,16
Ta 238,5,4608
v_fma_f32 v225, -v97, v97, s49
Zvav 176,216,16
Ta 208,2,8192
v_fma_f32 v226, -v98, v98, s49
Zvav 180,216,20
Ta 210,2,8704
v_fma_f32 v227, -v99, v99, s49
Zvav 188,220,20
Ta 212,3,8192
v_mul_f32 v224, v224, v96
Zvav 184,220,16
Ta 214,3,8704
v_mul_f32 v225, v225, v97
Zvav 192,224,16
Ta 216,4,8192
v_mul_f32 v226, v226, v98
Zvav 196,224,20
Ta 218,4,8704
s_waitcnt lgkmcnt(4)
Zvav 204,228,20
Ta 220,5,8192
v_mul_f32 v227, v227, v99
Zvav 200,228,16
Ta 222,5,8704
v_exp_f32 v224, v224
Zvav 208,232,16
Ta 224,2,12288
v_exp_f32 v225, v225
Zvav 212,232,20
Ta 226,2,12800
v_exp_f32 v226, v226
Zvav 220,236,20
Ta 228,3,12288
v_exp_f32 v227, v227
Zvav 216,236,16
Ta 230,3,12800
v_mul_f32 v96, v96, v128
Mvav 160,208,24
Ta 232,4,12288
v_mul_f32 v97, v97, v129
Mvav 164,208,28
Ta 234,4,12800
s_waitcnt lgkmcnt(4)
Mvav 172,212,28
Ta 236,5,12288
v_add_f32 v224, 1.0, v224
Mvav 168,212,24
Ta 238,5,12800
s_waitcnt vmcnt(20)
s_barrier
Mvav 176,216,24
Ta 208,2,16384
s_add_u32 m0, s35, 0x1c000
Mvav 180,216,28
Ta 210,2,16896
s_add_u32 s44, s36, 0x3f0400
Mvav 188,220,28
Ta 212,3,16384
s_add_u32 s98, s8, s44
s_addc_u32 s99, s9, 0
Mvav 184,220,24
Ta 214,3,16896
GDMA 12,98,0
v_add_f32 v225, 1.0, v225
Mvav 192,224,24
Ta 216,4,16384
GDMA 13,98,1024
v_add_f32 v226, 1.0, v226
v_add_f32 v227, 1.0, v227
Mvav 196,224,28
Ta 218,4,16896
v_rcp_f32 v224, v224
s_waitcnt lgkmcnt(4)
Mvav 204,228,28
Ta 220,5,16384
v_rcp_f32 v225, v225
Mvav 200,228,24
Ta 222,5,16896
v_rcp_f32 v226, v226
Mvav 208,232,24
Ta 224,2,20480
GDMA 14,98,2048
Mvav 212,232,28
Ta 226,2,20992
v_rcp_f32 v227, v227
Mvav 220,236,28
Ta 228,3,20480
v_mul_f32 v98, v98, v130
v_mul_f32 v99, v99, v131
Mvav 216,236,24
Ta 230,3,20992
v_mul_f32 v96, v96, v224
Mvav 160,208,32
Ta 232,4,20480
GDMA 15,98,3072
v_mul_f32 v97, v97, v225
v_mul_f32 v98, v98, v226
Mvav 164,208,36
Ta 234,4,20992
v_mul_f32 v99, v99, v227
s_waitcnt lgkmcnt(4)
Mvav 172,212,36
Ta 236,5,20480
v_cvt_pk_bf16_f32 v224, v96, v97
v_cvt_pk_bf16_f32 v225, v98, v99
Mvav 168,212,32
Ta 238,5,20992
v_accvgpr_write_b32 a112, v224
v_accvgpr_write_b32 a113, v225
Mvav 176,216,32
Ta 208,2,24576
v_fma_f32 v228, -v100, v100, s49
Mvav 180,216,36
Ta 210,2,25088
v_fma_f32 v229, -v101, v101, s49
Mvav 188,220,36
Ta 212,3,24576
v_fma_f32 v230, -v102, v102, s49
Mvav 184,220,32
Ta 214,3,25088
v_fma_f32 v231, -v103, v103, s49
Mvav 192,224,32
Ta 216,4,24576
v_mul_f32 v228, v228, v100
Mvav 196,224,36
Ta 218,4,25088
s_waitcnt lgkmcnt(4)
Mvav 204,228,36
Ta 220,5,24576
v_mul_f32 v229, v229, v101
Mvav 200,228,32
Ta 222,5,25088
v_mul_f32 v230, v230, v102
Mvav 208,232,32
Ta 224,2,28672
v_mul_f32 v231, v231, v103
Mvav 212,232,36
Ta 226,2,29184
v_exp_f32 v228, v228
Mvav 220,236,36
Ta 228,3,28672
v_exp_f32 v229, v229
Mvav 216,236,32
Ta 230,3,29184
v_exp_f32 v230, v230
Mvav 160,208,40
Ta 232,4,28672
v_exp_f32 v231, v231
Mvav 164,208,44
Ta 234,4,29184
s_waitcnt lgkmcnt(4)
Mvav 172,212,44
Ta 236,5,28672
v_mul_f32 v100, v100, v132
Mvav 168,212,40
Ta 238,5,29184
s_waitcnt vmcnt(20)
s_barrier
Mvav 176,216,40
Ta 208,2,32768
s_mov_b32 m0, s35
Mvav 180,216,44
Ta 210,2,33280
s_add_u32 s44, s36, 0x480400
Mvav 188,220,44
Ta 212,3,32768
s_add_u32 s98, s8, s44
s_addc_u32 s99, s9, 0
Mvav 184,220,40
Ta 214,3,33280
GDMA 12,98,0
Mvav 192,224,40
Ta 216,4,32768
GDMA 13,98,1024
Mvav 196,224,44
Ta 218,4,33280
s_waitcnt lgkmcnt(4)
Mvav 204,228,44
Ta 220,5,32768
v_mul_f32 v101, v101, v133
v_add_f32 v228, 1.0, v228
Mvav 200,228,40
Ta 222,5,33280
v_add_f32 v229, 1.0, v229
Mvav 208,232,40
Ta 224,2,36864
GDMA 14,98,2048
v_add_f32 v230, 1.0, v230
v_add_f32 v231, 1.0, v231
Mvav 212,232,44
Ta 226,2,37376
v_rcp_f32 v228, v228
Mvav 220,236,44
Ta 228,3,36864
v_rcp_f32 v229, v229
Mvav 216,236,40
Ta 230,3,37376
v_rcp_f32 v230, v230
Mvav 160,208,48
Ta 232,4,36864
GDMA 15,98,3072
Mvav 164,208,52
Ta 234,4,37376
v_rcp_f32 v231, v231
s_waitcnt lgkmcnt(4)
Mvav 172,212,52
Ta 236,5,36864
v_mul_f32 v102, v102, v134
v_mul_f32 v103, v103, v135
Mvav 168,212,48
Ta 238,5,37376
v_mul_f32 v100, v100, v228
Mvav 176,216,48
Ta 208,2,40960
v_mul_f32 v101, v101, v229
v_mul_f32 v102, v102, v230
Mvav 180,216,52
Ta 210,2,41472
v_mul_f32 v103, v103, v231
Mvav 188,220,52
Ta 212,3,40960
v_cvt_pk_bf16_f32 v228, v100, v101
v_cvt_pk_bf16_f32 v229, v102, v103
Mvav 184,220,48
Ta 214,3,41472
v_accvgpr_write_b32 a116, v228
v_accvgpr_write_b32 a117, v229
Mvav 192,224,48
Ta 216,4,40960
v_fma_f32 v224, -v104, v104, s49
Mvav 196,224,52
Ta 218,4,41472
s_waitcnt lgkmcnt(4)
Mvav 204,228,52
Ta 220,5,40960
v_fma_f32 v225, -v105, v105, s49
Mvav 200,228,48
Ta 222,5,41472
v_fma_f32 v226, -v106, v106, s49
Mvav 208,232,48
Ta 224,2,45056
v_fma_f32 v227, -v107, v107, s49
Mvav 212,232,52
Ta 226,2,45568
v_mul_f32 v224, v224, v104
Mvav 220,236,52
Ta 228,3,45056
v_mul_f32 v225, v225, v105
Mvav 216,236,48
Ta 230,3,45568
v_mul_f32 v226, v226, v106
Mvav 160,208,56
Ta 232,4,45056
v_mul_f32 v227, v227, v107
Mvav 164,208,60
Ta 234,4,45568
s_waitcnt lgkmcnt(4)
Mvav 172,212,60
Ta 236,5,45056
v_exp_f32 v224, v224
Mvav 168,212,56
Ta 238,5,45568
s_waitcnt vmcnt(20)
s_barrier
Mvav 176,216,56
Ta 208,2,49152
s_add_u32 m0, s35, 0x4000
Mvav 180,216,60
Ta 210,2,49664
s_mov_b32 s44, s39
Mvav 188,220,60
Ta 212,3,49152
s_add_u32 s98, s12, s44
s_addc_u32 s99, s13, 0
Mvav 184,220,56
Ta 214,3,49664
GDMA 240,98,0
Mvav 192,224,56
Ta 216,4,49152
GDMA 241,98,1024
Mvav 196,224,60
Ta 218,4,49664
s_waitcnt lgkmcnt(4)
Mvav 204,228,60
Ta 220,5,49152
v_exp_f32 v225, v225
Mvav 200,228,56
Ta 222,5,49664
v_exp_f32 v226, v226
Mvav 208,232,56
Ta 224,2,53248
GDMA 242,98,2048
v_exp_f32 v227, v227
Mvav 212,232,60
Ta 226,2,53760
v_mul_f32 v104, v104, v136
Mvav 220,236,60
Ta 228,3,53248
v_mul_f32 v105, v105, v137
v_add_f32 v224, 1.0, v224
Mvav 216,236,56
Ta 230,3,53760
v_add_f32 v225, 1.0, v225
Mvav 160,208,64
Ta 232,4,53248
GDMA 243,98,3072
v_add_f32 v226, 1.0, v226
v_add_f32 v227, 1.0, v227
Mvav 164,208,68
Ta 234,4,53760
v_rcp_f32 v224, v224
s_waitcnt lgkmcnt(4)
Mvav 172,212,68
Ta 236,5,53248
v_rcp_f32 v225, v225
Mvav 168,212,64
Ta 238,5,53760
v_rcp_f32 v226, v226
Mvav 176,216,64
Ta 208,2,57344
v_rcp_f32 v227, v227
Mvav 180,216,68
Ta 210,2,57856
v_mul_f32 v106, v106, v138
Mvav 188,220,68
Ta 212,3,57344
v_mul_f32 v107, v107, v139
Mvav 184,220,64
Ta 214,3,57856
v_mul_f32 v104, v104, v224
Mvav 192,224,64
Ta 216,4,57344
v_mul_f32 v105, v105, v225
v_mul_f32 v106, v106, v226
Mvav 196,224,68
Ta 218,4,57856
v_mul_f32 v107, v107, v227
s_waitcnt lgkmcnt(4)
Mvav 204,228,68
Ta 220,5,57344
v_cvt_pk_bf16_f32 v224, v104, v105
v_cvt_pk_bf16_f32 v225, v106, v107
Mvav 200,228,64
Ta 222,5,57856
v_accvgpr_write_b32 a114, v224
v_accvgpr_write_b32 a115, v225
Mvav 208,232,64
Ta 224,2,61440
v_fma_f32 v228, -v108, v108, s49
Mvav 212,232,68
Ta 226,2,61952
v_xor_b32 v2, 0x10000, v2
Mvav 220,236,68
Ta 228,3,61440
v_fma_f32 v229, -v109, v109, s49
Mvav 216,236,64
Ta 230,3,61952
v_xor_b32 v3, 0x10000, v3
Mvav 160,208,72
Ta 232,4,61440
v_fma_f32 v230, -v110, v110, s49
Mvav 164,208,76
Ta 234,4,61952
v_xor_b32 v4, 0x10000, v4
s_waitcnt lgkmcnt(4)
Mvav 172,212,76
Ta 236,5,61440
v_fma_f32 v231, -v111, v111, s49
Mvav 168,212,72
Ta 238,5,61952
v_xor_b32 v5, 0x10000, v5
s_waitcnt vmcnt(20)
s_barrier
Mvav 176,216,72
Ta 208,2,0
s_add_u32 m0, s35, 0x8000
Mvav 180,216,76
Ta 210,2,512
s_add_u32 s44, s39, 0x24000
Mvav 188,220,76
Ta 212,3,0
s_add_u32 s98, s12, s44
s_addc_u32 s99, s13, 0
Mvav 184,220,72
Ta 214,3,512
GDMA 240,98,0
Mvav 192,224,72
Ta 216,4,0
GDMA 241,98,1024
Mvav 196,224,76
Ta 218,4,512
s_waitcnt lgkmcnt(4)
Mvav 204,228,76
Ta 220,5,0
v_mul_f32 v228, v228, v108
v_mul_f32 v229, v229, v109
Mvav 200,228,72
Ta 222,5,512
v_mul_f32 v230, v230, v110
v_mul_f32 v231, v231, v111
Mvav 208,232,72
Ta 224,2,4096
GDMA 242,98,2048
Mvav 212,232,76
Ta 226,2,4608
v_exp_f32 v228, v228
Mvav 220,236,76
Ta 228,3,4096
v_exp_f32 v229, v229
Mvav 216,236,72
Ta 230,3,4608
v_exp_f32 v230, v230
Mvav 160,208,80
Ta 232,4,4096
GDMA 243,98,3072
v_exp_f32 v231, v231
Mvav 164,208,84
Ta 234,4,4608
v_mul_f32 v108, v108, v140
s_waitcnt lgkmcnt(4)
Mvav 172,212,84
Ta 236,5,4096
v_mul_f32 v109, v109, v141
v_add_f32 v228, 1.0, v228
Mvav 168,212,80
Ta 238,5,4608
v_add_f32 v229, 1.0, v229
Mvav 176,216,80
Ta 208,2,8192
v_add_f32 v230, 1.0, v230
v_add_f32 v231, 1.0, v231
Mvav 180,216,84
Ta 210,2,8704
v_rcp_f32 v228, v228
Mvav 188,220,84
Ta 212,3,8192
v_rcp_f32 v229, v229
Mvav 184,220,80
Ta 214,3,8704
v_rcp_f32 v230, v230
Mvav 192,224,80
Ta 216,4,8192
v_rcp_f32 v231, v231
Mvav 196,224,84
Ta 218,4,8704
s_waitcnt lgkmcnt(4)
Mvav 204,228,84
Ta 220,5,8192
v_mul_f32 v110, v110, v142
v_mul_f32 v111, v111, v143
Mvav 200,228,80
Ta 222,5,8704
v_mul_f32 v108, v108, v228
Mvav 208,232,80
Ta 224,2,12288
v_mul_f32 v109, v109, v229
v_mul_f32 v110, v110, v230
Mvav 212,232,84
Ta 226,2,12800
v_mul_f32 v111, v111, v231
Mvav 220,236,84
Ta 228,3,12288
v_cvt_pk_bf16_f32 v228, v108, v109
v_cvt_pk_bf16_f32 v229, v110, v111
Mvav 216,236,80
Ta 230,3,12800
v_accvgpr_write_b32 a118, v228
v_accvgpr_write_b32 a119, v229
Mvav 160,208,88
Ta 232,4,12288
v_fma_f32 v224, -v112, v112, s49
Mvav 164,208,92
Ta 234,4,12800
s_waitcnt lgkmcnt(4)
Mvav 172,212,92
Ta 236,5,12288
v_fma_f32 v225, -v113, v113, s49
Mvav 168,212,88
Ta 238,5,12800
s_waitcnt vmcnt(20)
s_barrier
Mvav 176,216,88
Ta 208,2,16384
s_add_u32 m0, s35, 0xc000
Mvav 180,216,92
Ta 210,2,16896
s_add_u32 s44, s39, 0x48000
Mvav 188,220,92
Ta 212,3,16384
s_add_u32 s98, s12, s44
s_addc_u32 s99, s13, 0
Mvav 184,220,88
Ta 214,3,16896
GDMA 240,98,0
Mvav 192,224,88
Ta 216,4,16384
GDMA 241,98,1024
Mvav 196,224,92
Ta 218,4,16896
s_waitcnt lgkmcnt(4)
Mvav 204,228,92
Ta 220,5,16384
v_fma_f32 v226, -v114, v114, s49
Mvav 200,228,88
Ta 222,5,16896
v_fma_f32 v227, -v115, v115, s49
Mvav 208,232,88
Ta 224,2,20480
GDMA 242,98,2048
Mvav 212,232,92
Ta 226,2,20992
v_mul_f32 v224, v224, v112
Mvav 220,236,92
Ta 228,3,20480
v_mul_f32 v225, v225, v113
Mvav 216,236,88
Ta 230,3,20992
v_mul_f32 v226, v226, v114
v_mul_f32 v227, v227, v115
Mvaa 160,208,144
Ta 232,4,20480
GDMA 243,98,3072
Mvaa 164,208,148
Ta 234,4,20992
v_exp_f32 v224, v224
s_waitcnt lgkmcnt(4)
Mvaa 172,212,148
Ta 236,5,20480
v_exp_f32 v225, v225
Mvaa 168,212,144
Ta 238,5,20992
v_exp_f32 v226, v226
Mvaa 176,216,144
Ta 208,2,24576
v_exp_f32 v227, v227
Mvaa 180,216,148
Ta 210,2,25088
v_mul_f32 v112, v112, v144
Mvaa 188,220,148
Ta 212,3,24576
v_mul_f32 v113, v113, v145
v_add_f32 v224, 1.0, v224
Mvaa 184,220,144
Ta 214,3,25088
v_add_f32 v225, 1.0, v225
Mvaa 192,224,144
Ta 216,4,24576
v_add_f32 v226, 1.0, v226
v_add_f32 v227, 1.0, v227
Mvaa 196,224,148
Ta 218,4,25088
v_rcp_f32 v224, v224
s_waitcnt lgkmcnt(4)
Mvaa 204,228,148
Ta 220,5,24576
v_rcp_f32 v225, v225
Mvaa 200,228,144
Ta 222,5,25088
v_rcp_f32 v226, v226
Mvaa 208,232,144
Ta 224,2,28672
v_rcp_f32 v227, v227
Mvaa 212,232,148
Ta 226,2,29184
v_mul_f32 v114, v114, v146
Mvaa 220,236,148
Ta 228,3,28672
v_mul_f32 v115, v115, v147
Mvaa 216,236,144
Ta 230,3,29184
v_mul_f32 v112, v112, v224
Mvaa 160,208,152
Ta 232,4,28672
v_mul_f32 v113, v113, v225
v_mul_f32 v114, v114, v226
Mvaa 164,208,156
Ta 234,4,29184
v_mul_f32 v115, v115, v227
s_waitcnt lgkmcnt(4)
Mvaa 172,212,156
Ta 236,5,28672
v_cvt_pk_bf16_f32 v224, v112, v113
v_cvt_pk_bf16_f32 v225, v114, v115
Mvaa 168,212,152
Ta 238,5,29184
v_accvgpr_write_b32 a120, v224
v_accvgpr_write_b32 a121, v225
s_waitcnt vmcnt(20)
s_barrier
Mvaa 176,216,152
Ta 208,2,32768
s_add_u32 m0, s35, 0x10000
Mvaa 180,216,156
Ta 210,2,33280
s_add_u32 s44, s39, 0x6c000
Mvaa 188,220,156
Ta 212,3,32768
s_add_u32 s98, s12, s44
s_addc_u32 s99, s13, 0
Mvaa 184,220,152
Ta 214,3,33280
GDMA 240,98,0
Mvaa 192,224,152
Ta 216,4,32768
GDMA 241,98,1024
Mvaa 196,224,156
Ta 218,4,33280
s_waitcnt lgkmcnt(4)
Mvaa 204,228,156
Ta 220,5,32768
v_fma_f32 v228, -v116, v116, s49
Mvaa 200,228,152
Ta 222,5,33280
v_fma_f32 v229, -v117, v117, s49
Mvaa 208,232,152
Ta 224,2,36864
GDMA 242,98,2048
Mvaa 212,232,156
Ta 226,2,37376
v_fma_f32 v230, -v118, v118, s49
Mvaa 220,236,156
Ta 228,3,36864
v_fma_f32 v231, -v119, v119, s49
Mvaa 216,236,152
Ta 230,3,37376
v_mul_f32 v228, v228, v116
Mvaa 160,208,160
Ta 232,4,36864
GDMA 243,98,3072
Mvaa 164,208,164
Ta 234,4,37376
s_waitcnt lgkmcnt(4)
Mvaa 172,212,164
Ta 236,5,36864
v_mul_f32 v229, v229, v117
Mvaa 168,212,160
Ta 238,5,37376
v_mul_f32 v230, v230, v118
v_mul_f32 v231, v231, v119
Mvaa 176,216,160
Ta 208,2,40960
v_exp_f32 v228, v228
Mvaa 180,216,164
Ta 210,2,41472
v_exp_f32 v229, v229
Mvaa 188,220,164
Ta 212,3,40960
v_exp_f32 v230, v230
Mvaa 184,220,160
Ta 214,3,41472
v_exp_f32 v231, v231
Mvaa 192,224,160
Ta 216,4,40960
v_mul_f32 v116, v116, v148
Mvaa 196,224,164
Ta 218,4,41472
s_waitcnt lgkmcnt(4)
Mvaa 204,228,164
Ta 220,5,40960
v_mul_f32 v117, v117, v149
v_add_f32 v228, 1.0, v228
Mvaa 200,228,160
Ta 222,5,41472
v_add_f32 v229, 1.0, v229
Mvaa 208,232,160
Ta 224,2,45056
v_add_f32 v230, 1.0, v230
v_add_f32 v231, 1.0, v231
Mvaa 212,232,164
Ta 226,2,45568
v_rcp_f32 v228, v228
Mvaa 220,236,164
Ta 228,3,45056
v_rcp_f32 v229, v229
Mvaa 216,236,160
Ta 230,3,45568
v_rcp_f32 v230, v230
Mvaa 160,208,168
Ta 232,4,45056
v_rcp_f32 v231, v231
Mvaa 164,208,172
Ta 234,4,45568
s_waitcnt lgkmcnt(4)
Mvaa 172,212,172
Ta 236,5,45056
v_mul_f32 v118, v118, v150
v_mul_f32 v119, v119, v151
Mvaa 168,212,168
Ta 238,5,45568
v_mul_f32 v116, v116, v228
s_waitcnt vmcnt(20)
s_barrier
Mvaa 176,216,168
Ta 208,2,49152
s_add_u32 m0, s35, 0x14000
v_mul_f32 v117, v117, v229
v_mul_f32 v118, v118, v230
Mvaa 180,216,172
Ta 210,2,49664
s_add_u32 s44, s39, 0x80
v_mul_f32 v119, v119, v231
Mvaa 188,220,172
Ta 212,3,49152
s_add_u32 s98, s12, s44
s_addc_u32 s99, s13, 0
v_cvt_pk_bf16_f32 v228, v116, v117
v_cvt_pk_bf16_f32 v229, v118, v119
Mvaa 184,220,168
Ta 214,3,49664
GDMA 240,98,0
v_accvgpr_write_b32 a124, v228
v_accvgpr_write_b32 a125, v229
Mvaa 192,224,168
Ta 216,4,49152
GDMA 241,98,1024
Mvaa 196,224,172
Ta 218,4,49664
s_waitcnt lgkmcnt(4)
Mvaa 204,228,172
Ta 220,5,49152
v_fma_f32 v224, -v120, v120, s49
Mvaa 200,228,168
Ta 222,5,49664
v_fma_f32 v225, -v121, v121, s49
Mvaa 208,232,168
Ta 224,2,53248
GDMA 242,98,2048
Mvaa 212,232,172
Ta 226,2,53760
v_fma_f32 v226, -v122, v122, s49
Mvaa 220,236,172
Ta 228,3,53248
v_fma_f32 v227, -v123, v123, s49
Mvaa 216,236,168
Ta 230,3,53760
v_mul_f32 v224, v224, v120
Mvaa 160,208,176
Ta 232,4,53248
GDMA 243,98,3072
Mvaa 164,208,180
Ta 234,4,53760
s_waitcnt lgkmcnt(4)
Mvaa 172,212,180
Ta 236,5,53248
v_mul_f32 v225, v225, v121
Mvaa 168,212,176
Ta 238,5,53760
v_mul_f32 v226, v226, v122
Mvaa 176,216,176
Ta 208,2,57344
v_mul_f32 v227, v227, v123
Mvaa 180,216,180
Ta 210,2,57856
v_exp_f32 v224, v224
Mvaa 188,220,180
Ta 212,3,57344
v_exp_f32 v225, v225
Mvaa 184,220,176
Ta 214,3,57856
v_exp_f32 v226, v226
Mvaa 192,224,176
Ta 216,4,57344
v_exp_f32 v227, v227
Mvaa 196,224,180
Ta 218,4,57856
s_waitcnt lgkmcnt(4)
Mvaa 204,228,180
Ta 220,5,57344
v_mul_f32 v120, v120, v152
Mvaa 200,228,176
Ta 222,5,57856
v_mul_f32 v121, v121, v153
Mvaa 208,232,176
Ta 224,2,61440
v_add_f32 v224, 1.0, v224
Mvaa 212,232,180
Ta 226,2,61952
v_xor_b32 v2, 0x10000, v2
Mvaa 220,236,180
Ta 228,3,61440
v_add_f32 v225, 1.0, v225
Mvaa 216,236,176
Ta 230,3,61952
v_xor_b32 v3, 0x10000, v3
Mvaa 160,208,184
Ta 232,4,61440
v_add_f32 v226, 1.0, v226
v_add_f32 v227, 1.0, v227
Mvaa 164,208,188
Ta 234,4,61952
v_xor_b32 v4, 0x10000, v4
v_rcp_f32 v224, v224
s_waitcnt lgkmcnt(4)
Mvaa 172,212,188
Ta 236,5,61440
v_rcp_f32 v225, v225
Mvaa 168,212,184
Ta 238,5,61952
v_xor_b32 v5, 0x10000, v5
s_waitcnt vmcnt(20)
s_barrier
Mvaa 176,216,184
Ta 208,2,0
s_add_u32 m0, s35, 0x18000
v_rcp_f32 v226, v226
Mvaa 180,216,188
Ta 210,2,512
s_add_u32 s44, s39, 0x24080
v_rcp_f32 v227, v227
Mvaa 188,220,188
Ta 212,3,0
s_add_u32 s98, s12, s44
s_addc_u32 s99, s13, 0
v_mul_f32 v122, v122, v154
v_mul_f32 v123, v123, v155
Mvaa 184,220,184
Ta 214,3,512
GDMA 240,98,0
v_mul_f32 v120, v120, v224
Mvaa 192,224,184
Ta 216,4,0
GDMA 241,98,1024
v_mul_f32 v121, v121, v225
v_mul_f32 v122, v122, v226
Mvaa 196,224,188
Ta 218,4,512
v_mul_f32 v123, v123, v227
s_waitcnt lgkmcnt(4)
Mvaa 204,228,188
Ta 220,5,0
v_cvt_pk_bf16_f32 v224, v120, v121
v_cvt_pk_bf16_f32 v225, v122, v123
Mvaa 200,228,184
Ta 222,5,512
v_accvgpr_write_b32 a122, v224
v_accvgpr_write_b32 a123, v225
Mvaa 208,232,184
Ta 224,2,4096
GDMA 242,98,2048
Mvaa 212,232,188
Ta 226,2,4608
v_fma_f32 v228, -v124, v124, s49
Mvaa 220,236,188
Ta 228,3,4096
v_fma_f32 v229, -v125, v125, s49
Mvaa 216,236,184
Ta 230,3,4608
v_fma_f32 v230, -v126, v126, s49
Mvaa 160,208,192
Ta 232,4,4096
GDMA 243,98,3072
Mvaa 164,208,196
Ta 234,4,4608
s_waitcnt lgkmcnt(4)
Mvaa 172,212,196
Ta 236,5,4096
v_fma_f32 v231, -v127, v127, s49
Mvaa 168,212,192
Ta 238,5,4608
v_mul_f32 v228, v228, v124
Mvaa 176,216,192
Ta 208,2,8192
v_mul_f32 v229, v229, v125
Mvaa 180,216,196
Ta 210,2,8704
v_mul_f32 v230, v230, v126
Mvaa 188,220,196
Ta 212,3,8192
v_mul_f32 v231, v231, v127
Mvaa 184,220,192
Ta 214,3,8704
v_exp_f32 v228, v228
Mvaa 192,224,192
Ta 216,4,8192
v_exp_f32 v229, v229
Mvaa 196,224,196
Ta 218,4,8704
s_waitcnt lgkmcnt(4)
Mvaa 204,228,196
Ta 220,5,8192
v_exp_f32 v230, v230
Mvaa 200,228,192
Ta 222,5,8704
v_exp_f32 v231, v231
Mvaa 208,232,192
Ta 224,2,12288
v_mul_f32 v124, v124, v156
Mvaa 212,232,196
Ta 226,2,12800
v_mul_f32 v125, v125, v157
Mvaa 220,236,196
Ta 228,3,12288
v_add_f32 v228, 1.0, v228
Mvaa 216,236,192
Ta 230,3,12800
v_add_f32 v229, 1.0, v229
Mvaa 160,208,200
Ta 232,4,12288
v_add_f32 v230, 1.0, v230
Mvaa 164,208,204
Ta 234,4,12800
s_waitcnt lgkmcnt(4)
Mvaa 172,212,204
Ta 236,5,12288
v_add_f32 v231, 1.0, v231
Mvaa 168,212,200
Ta 238,5,12800
s_waitcnt vmcnt(20)
s_barrier
Mvaa 176,216,200
Ta 208,236,16384
s_add_u32 m0, s35, 0x1c000
Mvaa 180,216,204
Ta 210,236,18432
s_add_u32 s44, s39, 0x48080
v_rcp_f32 v228, v228
Mvaa 188,220,204
Ta 212,237,16384
s_add_u32 s98, s12, s44
s_addc_u32 s99, s13, 0
Mvaa 184,220,200
Ta 214,237,18432
GDMA 240,98,0
v_rcp_f32 v229, v229
Mvaa 192,224,200
Ta 216,238,16384
GDMA 241,98,1024
v_rcp_f32 v230, v230
Mvaa 196,224,204
Ta 218,238,18432
v_rcp_f32 v231, v231
s_waitcnt lgkmcnt(4)
Mvaa 204,228,204
Ta 220,239,16384
v_mul_f32 v126, v126, v158
v_mul_f32 v127, v127, v159
Mvaa 200,228,200
Ta 222,239,18432
v_mul_f32 v124, v124, v228
Mvaa 208,232,200
Ta 224,236,20480
GDMA 242,98,2048
v_mul_f32 v125, v125, v229
v_mul_f32 v126, v126, v230
Mvaa 212,232,204
Ta 226,236,22528
v_mul_f32 v127, v127, v231
Mvaa 220,236,204
Ta 228,237,20480
v_cvt_pk_bf16_f32 v228, v124, v125
v_cvt_pk_bf16_f32 v229, v126, v127
Mvaa 216,236,200
Ta 230,237,22528
v_accvgpr_write_b32 a126, v228
v_accvgpr_write_b32 a127, v229
Zvaa 16,208,0
Ta 232,238,20480
GDMA 243,98,3072
Zvaa 20,208,4
Ta 234,238,22528
s_waitcnt lgkmcnt(4)
Zvaa 28,212,4
Ta 236,239,20480
v_fma_f32 v224, -v160, v160, s49
Zvaa 24,212,0
Ta 238,239,22528
v_fma_f32 v225, -v161, v161, s49
Zvaa 32,216,0
Ta 208,236,24576
v_fma_f32 v226, -v162, v162, s49
Zvaa 36,216,4
Ta 210,236,26624
v_fma_f32 v227, -v163, v163, s49
Zvaa 44,220,4
Ta 212,237,24576
v_mul_f32 v224, v224, v160
Zvaa 40,220,0
Ta 214,237,26624
v_mul_f32 v225, v225, v161
Mvaa 16,224,8
Ta 216,238,24576
v_mul_f32 v226, v226, v162
v_mul_f32 v227, v227, v163
Mvaa 20,224,12
Ta 218,238,26624
s_waitcnt lgkmcnt(4)
Mvaa 28,228,12
Ta 220,239,24576
v_exp_f32 v224, v224
Mvaa 24,228,8
Ta 222,239,26624
v_exp_f32 v225, v225
Mvaa 32,232,8
Ta 224,236,28672
v_exp_f32 v226, v226
Mvaa 36,232,12
Ta 226,236,30720
v_exp_f32 v227, v227
Mvaa 44,236,12
Ta 228,237,28672
v_mul_f32 v160, v160, v192
Mvaa 40,236,8
Ta 230,237,30720
v_mul_f32 v161, v161, v193
v_add_f32 v224, 1.0, v224
Mvaa 16,208,16
Ta 232,238,28672
v_add_f32 v225, 1.0, v225
Mvaa 20,208,20
Ta 234,238,30720
v_add_f32 v226, 1.0, v226
v_add_f32 v227, 1.0, v227
s_waitcnt lgkmcnt(4)
Mvaa 28,212,20
Ta 236,239,28672
v_rcp_f32 v224, v224
Mvaa 24,212,16
Ta 238,239,30720
s_waitcnt vmcnt(20)
s_barrier
Mvaa 32,216,16
Ta 208,236,32768
s_mov_b32 m0, s35
v_rcp_f32 v225, v225
Mvaa 36,216,20
Ta 210,236,34816
s_add_u32 s44, s39, 0x6c080
v_rcp_f32 v226, v226
Mvaa 44,220,20
Ta 212,237,32768
s_add_u32 s98, s12, s44
s_addc_u32 s99, s13, 0
v_rcp_f32 v227, v227
Mvaa 40,220,16
Ta 214,237,34816
GDMA 240,98,0
v_mul_f32 v162, v162, v194
v_mul_f32 v163, v163, v195
Mvaa 16,224,24
Ta 216,238,32768
GDMA 241,98,1024
v_mul_f32 v160, v160, v224
Mvaa 20,224,28
Ta 218,238,34816
v_mul_f32 v161, v161, v225
v_mul_f32 v162, v162, v226
s_waitcnt lgkmcnt(4)
Mvaa 28,228,28
Ta 220,239,32768
v_mul_f32 v163, v163, v227
Mvaa 24,228,24
Ta 222,239,34816
v_cvt_pk_bf16_f32 v224, v160, v161
v_cvt_pk_bf16_f32 v225, v162, v163
Mvaa 32,232,24
Ta 224,236,36864
GDMA 242,98,2048
v_accvgpr_write_b32 a128, v224
v_accvgpr_write_b32 a129, v225
Mvaa 36,232,28
Ta 226,236,38912
v_fma_f32 v228, -v164, v164, s49
Mvaa 44,236,28
Ta 228,237,36864
v_fma_f32 v229, -v165, v165, s49
Mvaa 40,236,24
Ta 230,237,38912
v_fma_f32 v230, -v166, v166, s49
Mvaa 16,208,32
Ta 232,238,36864
GDMA 243,98,3072
Mvaa 20,208,36
Ta 234,238,38912
s_waitcnt lgkmcnt(4)
Mvaa 28,212,36
Ta 236,239,36864
v_fma_f32 v231, -v167, v167, s49
Mvaa 24,212,32
Ta 238,239,38912
v_mul_f32 v228, v228, v164
v_mul_f32 v229, v229, v165
Mvaa 32,216,32
Ta 208,236,40960
v_mul_f32 v230, v230, v166
v_mul_f32 v231, v231, v167
Mvaa 36,216,36
Ta 210,236,43008
v_exp_f32 v228, v228
Mvaa 44,220,36
Ta 212,237,40960
v_exp_f32 v229, v229
Mvaa 40,220,32
Ta 214,237,43008
v_exp_f32 v230, v230
Mvaa 16,224,40
Ta 216,238,40960
v_exp_f32 v231, v231
Mvaa 20,224,44
Ta 218,238,43008
s_waitcnt lgkmcnt(4)
Mvaa 28,228,44
Ta 220,239,40960
v_mul_f32 v164, v164, v196
Mvaa 24,228,40
Ta 222,239,43008
v_mul_f32 v165, v165, v197
v_add_f32 v228, 1.0, v228
Mvaa 32,232,40
Ta 224,236,45056
v_add_f32 v229, 1.0, v229
Mvaa 36,232,44
Ta 226,236,47104
v_add_f32 v230, 1.0, v230
v_add_f32 v231, 1.0, v231
Mvaa 44,236,44
Ta 228,237,45056
v_rcp_f32 v228, v228
Mvaa 40,236,40
Ta 230,237,47104
v_rcp_f32 v229, v229
Mvaa 16,208,48
Ta 232,238,45056
v_rcp_f32 v230, v230
Mvaa 20,208,52
Ta 234,238,47104
s_waitcnt lgkmcnt(4)
Mvaa 28,212,52
Ta 236,239,45056
v_rcp_f32 v231, v231
Mvaa 24,212,48
Ta 238,239,47104
v_mul_f32 v166, v166, v198
v_mul_f32 v167, v167, v199
s_waitcnt vmcnt(20)
s_barrier
Mvaa 32,216,48
Ta 208,236,49152
s_add_u32 m0, s35, 0x4000
v_mul_f32 v164, v164, v228
Mvaa 36,216,52
Ta 210,236,51200
s_add_u32 s44, s40, 0x90000
v_mul_f32 v165, v165, v229
v_mul_f32 v166, v166, v230
Mvaa 44,220,52
Ta 212,237,49152
s_add_u32 s98, s12, s44
s_addc_u32 s99, s13, 0
v_mul_f32 v167, v167, v231
Mvaa 40,220,48
Ta 214,237,51200
GDMA 240,98,0
v_cvt_pk_bf16_f32 v228, v164, v165
v_cvt_pk_bf16_f32 v229, v166, v167
Mvaa 16,224,56
Ta 216,238,49152
GDMA 241,98,1024
v_accvgpr_write_b32 a132, v228
v_accvgpr_write_b32 a133, v229
Mvaa 20,224,60
Ta 218,238,51200
s_waitcnt lgkmcnt(4)
Mvaa 28,228,60
Ta 220,239,49152
v_fma_f32 v224, -v168, v168, s49
Mvaa 24,228,56
Ta 222,239,51200
v_fma_f32 v225, -v169, v169, s49
Mvaa 32,232,56
Ta 224,236,53248
GDMA 242,98,2048
Mvaa 36,232,60
Ta 226,236,55296
v_fma_f32 v226, -v170, v170, s49
Mvaa 44,236,60
Ta 228,237,53248
v_fma_f32 v227, -v171, v171, s49
Mvaa 40,236,56
Ta 230,237,55296
v_mul_f32 v224, v224, v168
v_mul_f32 v225, v225, v169
Mvaa 16,208,64
Ta 232,238,53248
GDMA 243,98,3072
v_mul_f32 v226, v226, v170
v_mul_f32 v227, v227, v171
Mvaa 20,208,68
Ta 234,238,55296
s_waitcnt lgkmcnt(4)
Mvaa 28,212,68
Ta 236,239,53248
v_exp_f32 v224, v224
Mvaa 24,212,64
Ta 238,239,55296
v_exp_f32 v225, v225
Mvaa 32,216,64
Ta 208,236,57344
v_exp_f32 v226, v226
Mvaa 36,216,68
Ta 210,236,59392
v_exp_f32 v227, v227
Mvaa 44,220,68
Ta 212,237,57344
v_mul_f32 v168, v168, v200
Mvaa 40,220,64
Ta 214,237,59392
v_mul_f32 v169, v169, v201
v_add_f32 v224, 1.0, v224
Mvaa 16,224,72
Ta 216,238,57344
v_add_f32 v225, 1.0, v225
Mvaa 20,224,76
Ta 218,238,59392
v_add_f32 v226, 1.0, v226
v_add_f32 v227, 1.0, v227
s_waitcnt lgkmcnt(4)
Mvaa 28,228,76
Ta 220,239,57344
v_rcp_f32 v224, v224
Mvaa 24,228,72
Ta 222,239,59392
v_rcp_f32 v225, v225
Mvaa 32,232,72
Ta 224,236,61440
v_rcp_f32 v226, v226
Mvaa 36,232,76
Ta 226,236,63488
v_xor_b32 v236, 0x10000, v236
Mvaa 44,236,76
Ta 228,237,61440
v_rcp_f32 v227, v227
Mvaa 40,236,72
Ta 230,237,63488
v_xor_b32 v237, 0x10000, v237
v_mul_f32 v170, v170, v202
v_mul_f32 v171, v171, v203
Mvaa 16,208,80
Ta 232,238,61440
v_mul_f32 v168, v168, v224
Mvaa 20,208,84
Ta 234,238,63488
v_xor_b32 v238, 0x10000, v238
v_mul_f32 v169, v169, v225
v_mul_f32 v170, v170, v226
s_waitcnt lgkmcnt(4)
Mvaa 28,212,84
Ta 236,239,61440
v_mul_f32 v171, v171, v227
Mvaa 24,212,80
Ta 238,239,63488
v_xor_b32 v239, 0x10000, v239
v_cvt_pk_bf16_f32 v224, v168, v169
v_cvt_pk_bf16_f32 v225, v170, v171
s_waitcnt vmcnt(20)
s_barrier
Mvaa 32,216,80
Ta 208,236,0
s_add_u32 m0, s35, 0x8000
v_accvgpr_write_b32 a130, v224
v_accvgpr_write_b32 a131, v225
Mvaa 36,216,84
Ta 210,236,2048
s_add_u32 s44, s40, 0x90100
Mvaa 44,220,84
Ta 212,237,0
s_add_u32 s98, s12, s44
s_addc_u32 s99, s13, 0
Mvaa 40,220,80
Ta 214,237,2048
GDMA 240,98,0
Mvaa 16,224,88
Ta 216,238,0
GDMA 241,98,1024
v_fma_f32 v228, -v172, v172, s49
Mvaa 20,224,92
Ta 218,238,2048
v_fma_f32 v229, -v173, v173, s49
v_fma_f32 v230, -v174, v174, s49
s_waitcnt lgkmcnt(4)
Mvaa 28,228,92
Ta 220,239,0
v_fma_f32 v231, -v175, v175, s49
Mvaa 24,228,88
Ta 222,239,2048
v_mul_f32 v228, v228, v172
v_mul_f32 v229, v229, v173
Mvaa 32,232,88
Ta 224,236,4096
GDMA 242,98,2048
v_mul_f32 v230, v230, v174
v_mul_f32 v231, v231, v175
Mvaa 36,232,92
Ta 226,236,6144
v_exp_f32 v228, v228
Mvaa 44,236,92
Ta 228,237,4096
v_exp_f32 v229, v229
Mvaa 40,236,88
Ta 230,237,6144
v_exp_f32 v230, v230
Mvaa 16,208,96
Ta 232,238,4096
GDMA 243,98,3072
Mvaa 20,208,100
Ta 234,238,6144
v_exp_f32 v231, v231
s_waitcnt lgkmcnt(4)
Mvaa 28,212,100
Ta 236,239,4096
v_mul_f32 v172, v172, v204
Mvaa 24,212,96
Ta 238,239,6144
v_mul_f32 v173, v173, v205
v_add_f32 v228, 1.0, v228
Mvaa 32,216,96
Ta 208,236,8192
v_add_f32 v229, 1.0, v229
v_lshlrev_b32 v252, 4, v1
Mvaa 36,216,100
Ta 210,236,10240
v_add_f32 v230, 1.0, v230
v_add_f32 v231, 1.0, v231
Mvaa 44,220,100
Ta 212,237,8192
v_rcp_f32 v228, v228
Mvaa 40,220,96
Ta 214,237,10240
v_rcp_f32 v229, v229
Mvaa 16,224,104
Ta 216,238,8192
v_rcp_f32 v230, v230
Mvaa 20,224,108
Ta 218,238,10240
s_waitcnt lgkmcnt(4)
Mvaa 28,228,108
Ta 220,239,8192
v_rcp_f32 v231, v231
Mvaa 24,228,104
Ta 222,239,10240
v_mul_f32 v174, v174, v206
v_mul_f32 v175, v175, v207
Mvaa 32,232,104
Ta 224,236,12288
v_mul_f32 v172, v172, v228
Mvaa 36,232,108
Ta 226,236,14336
v_mul_f32 v173, v173, v229
v_mul_f32 v174, v174, v230
Mvaa 44,236,108
Ta 228,237,12288
v_mul_f32 v175, v175, v231
Mvaa 40,236,104
Ta 230,237,14336
v_cvt_pk_bf16_f32 v228, v172, v173
v_cvt_pk_bf16_f32 v229, v174, v175
Mvaa 16,208,112
Ta 232,238,12288
v_accvgpr_write_b32 a134, v228
v_accvgpr_write_b32 a135, v229
Mvaa 20,208,116
Ta 234,238,14336
s_waitcnt lgkmcnt(4)
Mvaa 28,212,116
Ta 236,239,12288
v_fma_f32 v224, -v176, v176, s49
Mvaa 24,212,112
Ta 238,239,14336
s_waitcnt vmcnt(20)
s_barrier
Mvaa 32,216,112
Ta 208,236,16384
s_add_u32 m0, s35, 0xc000
Mvaa 36,216,116
Ta 210,236,18432
s_add_u32 s44, s39, 0x100
v_fma_f32 v225, -v177, v177, s49
v_fma_f32 v226, -v178, v178, s49
Mvaa 44,220,116
Ta 212,237,16384
s_add_u32 s98, s12, s44
s_addc_u32 s99, s13, 0
v_fma_f32 v227, -v179, v179, s49
Mvaa 40,220,112
Ta 214,237,18432
GDMA 240,98,0
v_mul_f32 v224, v224, v176
v_mul_f32 v225, v225, v177
Mvaa 16,224,120
Ta 216,238,16384
GDMA 241,98,1024
v_mul_f32 v226, v226, v178
v_mul_f32 v227, v227, v179
Mvaa 20,224,124
Ta 218,238,18432
s_waitcnt lgkmcnt(4)
Mvaa 28,228,124
Ta 220,239,16384
v_exp_f32 v224, v224
Mvaa 24,228,120
Ta 222,239,18432
v_exp_f32 v225, v225
Mvaa 32,232,120
Ta 224,236,20480
GDMA 242,98,2048
v_exp_f32 v226, v226
Mvaa 36,232,124
Ta 226,236,22528
v_exp_f32 v227, v227
Mvaa 44,236,124
Ta 228,237,20480
v_mul_f32 v176, v176, v208
Mvaa 40,236,120
Ta 230,237,22528
v_mul_f32 v177, v177, v209
v_add_f32 v224, 1.0, v224
Zvaa 48,208,0
Ta 232,238,20480
GDMA 243,98,3072
v_add_f32 v225, 1.0, v225
Zvaa 52,208,4
Ta 234,238,22528
v_add_f32 v226, 1.0, v226
v_add_f32 v227, 1.0, v227
s_waitcnt lgkmcnt(4)
Zvaa 60,212,4
Ta 236,239,20480
v_rcp_f32 v224, v224
Zvaa 56,212,0
Ta 238,239,22528
v_rcp_f32 v225, v225
Zvaa 64,216,0
Ta 208,236,24576
v_rcp_f32 v226, v226
Zvaa 68,216,4
Ta 210,236,26624
v_rcp_f32 v227, v227
Zvaa 76,220,4
Ta 212,237,24576
v_mul_f32 v178, v178, v210
Zvaa 72,220,0
Ta 214,237,26624
v_mul_f32 v179, v179, v211
Mvaa 48,224,8
Ta 216,238,24576
v_mul_f32 v176, v176, v224
Mvaa 52,224,12
Ta 218,238,26624
v_mul_f32 v177, v177, v225
v_mul_f32 v178, v178, v226
s_waitcnt lgkmcnt(4)
Mvaa 60,228,12
Ta 220,239,24576
v_mul_f32 v179, v179, v227
Mvaa 56,228,8
Ta 222,239,26624
v_cvt_pk_bf16_f32 v224, v176, v177
v_cvt_pk_bf16_f32 v225, v178, v179
Mvaa 64,232,8
Ta 224,236,28672
v_accvgpr_write_b32 a136, v224
v_accvgpr_write_b32 a137, v225
Mvaa 68,232,12
Ta 226,236,30720
v_fma_f32 v228, -v180, v180, s49
Mvaa 76,236,12
Ta 228,237,28672
v_fma_f32 v229, -v181, v181, s49
Mvaa 72,236,8
Ta 230,237,30720
v_fma_f32 v230, -v182, v182, s49
Mvaa 48,208,16
Ta 232,238,28672
v_fma_f32 v231, -v183, v183, s49
Mvaa 52,208,20
Ta 234,238,30720
s_waitcnt lgkmcnt(4)
Mvaa 60,212,20
Ta 236,239,28672
v_mul_f32 v228, v228, v180
Mvaa 56,212,16
Ta 238,239,30720
v_mul_f32 v229, v229, v181
s_waitcnt vmcnt(20)
s_barrier
Mvaa 64,216,16
Ta 208,236,32768
s_add_u32 m0, s35, 0x10000
v_mul_f32 v230, v230, v182
v_mul_f32 v231, v231, v183
Mvaa 68,216,20
Ta 210,236,34816
s_add_u32 s44, s39, 0x24100
Mvaa 76,220,20
Ta 212,237,32768
s_add_u32 s98, s12, s44
s_addc_u32 s99, s13, 0
v_exp_f32 v228, v228
Mvaa 72,220,16
Ta 214,237,34816
GDMA 240,98,0
v_exp_f32 v229, v229
Mvaa 48,224,24
Ta 216,238,32768
GDMA 241,98,1024
v_exp_f32 v230, v230
Mvaa 52,224,28
Ta 218,238,34816
v_exp_f32 v231, v231
s_waitcnt lgkmcnt(4)
Mvaa 60,228,28
Ta 220,239,32768
v_mul_f32 v180, v180, v212
Mvaa 56,228,24
Ta 222,239,34816
v_mul_f32 v181, v181, v213
v_add_f32 v228, 1.0, v228
Mvaa 64,232,24
Ta 224,236,36864
GDMA 242,98,2048
v_add_f32 v229, 1.0, v229
Mvaa 68,232,28
Ta 226,236,38912
v_add_f32 v230, 1.0, v230
v_add_f32 v231, 1.0, v231
Mvaa 76,236,28
Ta 228,237,36864
v_rcp_f32 v228, v228
Mvaa 72,236,24
Ta 230,237,38912
v_rcp_f32 v229, v229
Mvaa 48,208,32
Ta 232,238,36864
GDMA 243,98,3072
Mvaa 52,208,36
Ta 234,238,38912
v_rcp_f32 v230, v230
s_waitcnt lgkmcnt(4)
Mvaa 60,212,36
Ta 236,239,36864
v_rcp_f32 v231, v231
Mvaa 56,212,32
Ta 238,239,38912
v_mul_f32 v182, v182, v214
v_mul_f32 v183, v183, v215
Mvaa 64,216,32
Ta 208,236,40960
v_mul_f32 v180, v180, v228
Mvaa 68,216,36
Ta 210,236,43008
v_mul_f32 v181, v181, v229
v_mul_f32 v182, v182, v230
Mvaa 76,220,36
Ta 212,237,40960
v_mul_f32 v183, v183, v231
Mvaa 72,220,32
Ta 214,237,43008
v_cvt_pk_bf16_f32 v228, v180, v181
v_cvt_pk_bf16_f32 v229, v182, v183
Mvaa 48,224,40
Ta 216,238,40960
v_accvgpr_write_b32 a140, v228
v_accvgpr_write_b32 a141, v229
Mvaa 52,224,44
Ta 218,238,43008
s_waitcnt lgkmcnt(4)
Mvaa 60,228,44
Ta 220,239,40960
v_fma_f32 v224, -v184, v184, s49
Mvaa 56,228,40
Ta 222,239,43008
v_fma_f32 v225, -v185, v185, s49
Mvaa 64,232,40
Ta 224,236,45056
v_fma_f32 v226, -v186, v186, s49
Mvaa 68,232,44
Ta 226,236,47104
v_fma_f32 v227, -v187, v187, s49
Mvaa 76,236,44
Ta 228,237,45056
v_mul_f32 v224, v224, v184
Mvaa 72,236,40
Ta 230,237,47104
v_mul_f32 v225, v225, v185
Mvaa 48,208,48
Ta 232,238,45056
v_mul_f32 v226, v226, v186
v_mul_f32 v227, v227, v187
Mvaa 52,208,52
Ta 234,238,47104
s_waitcnt lgkmcnt(4)
Mvaa 60,212,52
Ta 236,239,45056
v_exp_f32 v224, v224
Mvaa 56,212,48
Ta 238,239,47104
v_exp_f32 v225, v225
s_waitcnt vmcnt(20)
s_barrier
Mvaa 64,216,48
Ta 208,236,49152
s_add_u32 m0, s35, 0x14000
v_exp_f32 v226, v226
Mvaa 68,216,52
Ta 210,236,51200
s_add_u32 s44, s39, 0x48100
v_exp_f32 v227, v227
Mvaa 76,220,52
Ta 212,237,49152
s_add_u32 s98, s12, s44
s_addc_u32 s99, s13, 0
v_mul_f32 v184, v184, v216
Mvaa 72,220,48
Ta 214,237,51200
GDMA 240,98,0
v_mul_f32 v185, v185, v217
v_add_f32 v224, 1.0, v224
Mvaa 48,224,56
Ta 216,238,49152
GDMA 241,98,1024
v_add_f32 v225, 1.0, v225
Mvaa 52,224,60
Ta 218,238,51200
v_add_f32 v226, 1.0, v226
v_add_f32 v227, 1.0, v227
s_waitcnt lgkmcnt(4)
Mvaa 60,228,60
Ta 220,239,49152
v_rcp_f32 v224, v224
Mvaa 56,228,56
Ta 222,239,51200
v_rcp_f32 v225, v225
Mvaa 64,232,56
Ta 224,236,53248
GDMA 242,98,2048
Mvaa 68,232,60
Ta 226,236,55296
v_rcp_f32 v226, v226
Mvaa 76,236,60
Ta 228,237,53248
v_rcp_f32 v227, v227
Mvaa 72,236,56
Ta 230,237,55296
v_mul_f32 v186, v186, v218
v_mul_f32 v187, v187, v219
Mvaa 48,208,64
Ta 232,238,53248
GDMA 243,98,3072
v_mul_f32 v184, v184, v224
Mvaa 52,208,68
Ta 234,238,55296
v_mul_f32 v185, v185, v225
v_mul_f32 v186, v186, v226
s_waitcnt lgkmcnt(4)
Mvaa 60,212,68
Ta 236,239,53248
v_mul_f32 v187, v187, v227
Mvaa 56,212,64
Ta 238,239,55296
v_cvt_pk_bf16_f32 v224, v184, v185
v_cvt_pk_bf16_f32 v225, v186, v187
Mvaa 64,216,64
Ta 208,236,57344
v_accvgpr_write_b32 a138, v224
v_accvgpr_write_b32 a139, v225
Mvaa 68,216,68
Ta 210,236,59392
v_fma_f32 v228, -v188, v188, s49
Mvaa 76,220,68
Ta 212,237,57344
v_fma_f32 v229, -v189, v189, s49
Mvaa 72,220,64
Ta 214,237,59392
v_fma_f32 v230, -v190, v190, s49
Mvaa 48,224,72
Ta 216,238,57344
v_fma_f32 v231, -v191, v191, s49
Mvaa 52,224,76
Ta 218,238,59392
s_waitcnt lgkmcnt(4)
Mvaa 60,228,76
Ta 220,239,57344
v_mul_f32 v228, v228, v188
Mvaa 56,228,72
Ta 222,239,59392
v_mul_f32 v229, v229, v189
Mvaa 64,232,72
Ta 224,236,61440
v_mul_f32 v230, v230, v190
v_mul_f32 v231, v231, v191
Mvaa 68,232,76
Ta 226,236,63488
v_xor_b32 v236, 0x10000, v236
Mvaa 76,236,76
Ta 228,237,61440
v_exp_f32 v228, v228
Mvaa 72,236,72
Ta 230,237,63488
v_xor_b32 v237, 0x10000, v237
v_exp_f32 v229, v229
Mvaa 48,208,80
Ta 232,238,61440
v_exp_f32 v230, v230
Mvaa 52,208,84
Ta 234,238,63488
v_xor_b32 v238, 0x10000, v238
v_exp_f32 v231, v231
s_waitcnt lgkmcnt(4)
Mvaa 60,212,84
Ta 236,239,61440
v_mul_f32 v188, v188, v220
Mvaa 56,212,80
Ta 238,239,63488
v_xor_b32 v239, 0x10000, v239
v_mul_f32 v189, v189, v221
v_add_f32 v228, 1.0, v228
s_waitcnt vmcnt(20)
s_barrier
Mvaa 64,216,80
Ta 208,236,0
s_add_u32 m0, s35, 0x18000
v_add_f32 v229, 1.0, v229
Mvaa 68,216,84
Ta 210,236,2048
s_add_u32 s44, s39, 0x6c100
v_add_f32 v230, 1.0, v230
v_add_f32 v231, 1.0, v231
Mvaa 76,220,84
Ta 212,237,0
s_add_u32 s98, s12, s44
s_addc_u32 s99, s13, 0
v_rcp_f32 v228, v228
Mvaa 72,220,80
Ta 214,237,2048
GDMA 240,98,0
Mvaa 48,224,88
Ta 216,238,0
GDMA 241,98,1024
v_rcp_f32 v229, v229
Mvaa 52,224,92
Ta 218,238,2048
v_rcp_f32 v230, v230
s_waitcnt lgkmcnt(4)
Mvaa 60,228,92
Ta 220,239,0
v_rcp_f32 v231, v231
Mvaa 56,228,88
Ta 222,239,2048
v_mul_f32 v190, v190, v222
v_mul_f32 v191, v191, v223
Mvaa 64,232,88
Ta 224,236,4096
GDMA 242,98,2048
v_mul_f32 v188, v188, v228
Mvaa 68,232,92
Ta 226,236,6144
v_mul_f32 v189, v189, v229
v_mul_f32 v190, v190, v230
Mvaa 76,236,92
Ta 228,237,4096
v_mul_f32 v191, v191, v231
Mvaa 72,236,88
Ta 230,237,6144
v_cvt_pk_bf16_f32 v228, v188, v189
v_cvt_pk_bf16_f32 v229, v190, v191
Mvaa 48,208,96
Ta 232,238,4096
GDMA 243,98,3072
v_accvgpr_write_b32 a142, v228
v_accvgpr_write_b32 a143, v229
Mvaa 52,208,100
Ta 234,238,6144
s_waitcnt lgkmcnt(4)
Mvaa 60,212,100
Ta 236,239,4096
Mvaa 56,212,96
Ta 238,239,6144
Mvaa 64,216,96
Ta 208,236,8192
Mvaa 68,216,100
Ta 210,236,10240
Mvaa 76,220,100
Ta 212,237,8192
Mvaa 72,220,96
Ta 214,237,10240
Mvaa 48,224,104
Ta 216,238,8192
Mvaa 52,224,108
Ta 218,238,10240
s_waitcnt lgkmcnt(4)
Mvaa 60,228,108
Ta 220,239,8192
Mvaa 56,228,104
Ta 222,239,10240
Mvaa 64,232,104
Ta 224,236,12288
Mvaa 68,232,108
Ta 226,236,14336
Mvaa 76,236,108
Ta 228,237,12288
Mvaa 72,236,104
Ta 230,237,14336
Mvaa 48,208,112
Ta 232,238,12288
Mvaa 52,208,116
Ta 234,238,14336
s_waitcnt lgkmcnt(4)
Mvaa 60,212,116
Ta 236,239,12288
Mvaa 56,212,112
Ta 238,239,14336
s_waitcnt vmcnt(20)
s_barrier
Mvaa 64,216,112
Ta 208,236,16384
s_add_u32 m0, s35, 0x1c000
Mvaa 68,216,116
Ta 210,236,18432
s_add_u32 s44, s39, 0x180
Mvaa 76,220,116
Ta 212,237,16384
s_add_u32 s98, s12, s44
s_addc_u32 s99, s13, 0
Mvaa 72,220,112
Ta 214,237,18432
GDMA 240,98,0
Mvaa 48,224,120
Ta 216,238,16384
GDMA 241,98,1024
Mvaa 52,224,124
Ta 218,238,18432
s_waitcnt lgkmcnt(4)
Mvaa 60,228,124
Ta 220,239,16384
Mvaa 56,228,120
Ta 222,239,18432
Mvaa 64,232,120
Ta 224,236,20480
GDMA 242,98,2048
Mvaa 68,232,124
Ta 226,236,22528
Mvaa 76,236,124
Ta 228,237,20480
Mvaa 72,236,120
Ta 230,237,22528
Mvaa 16,208,128
Ta 232,238,20480
GDMA 243,98,3072
Mvaa 20,208,132
Ta 234,238,22528
s_waitcnt lgkmcnt(4)
Mvaa 28,212,132
Ta 236,239,20480
Mvaa 24,212,128
Ta 238,239,22528
Mvaa 32,216,128
Ta 208,236,24576
Mvaa 36,216,132
Ta 210,236,26624
Mvaa 44,220,132
Ta 212,237,24576
Mvaa 40,220,128
Ta 214,237,26624
Mvaa 16,224,136
Ta 216,238,24576
Mvaa 20,224,140
Ta 218,238,26624
s_waitcnt lgkmcnt(4)
Mvaa 28,228,140
Ta 220,239,24576
Mvaa 24,228,136
Ta 222,239,26624
Mvaa 32,232,136
Ta 224,236,28672
Mvaa 36,232,140
Ta 226,236,30720
Mvaa 44,236,140
Ta 228,237,28672
Mvaa 40,236,136
Ta 230,237,30720
Mvaa 48,208,128
Ta 232,238,28672
v_cvt_pk_bf16_f32 v144, v16, v17
Mvaa 52,208,132
Ta 234,238,30720
s_waitcnt lgkmcnt(4)
Mvaa 60,212,132
Ta 236,239,28672
v_cvt_pk_bf16_f32 v145, v18, v19
Mvaa 56,212,128
Ta 238,239,30720
s_waitcnt vmcnt(20)
s_barrier
Mvaa 64,216,128
Ta 208,236,32768
s_mov_b32 m0, s35
Mvaa 68,216,132
Ta 210,236,34816
s_add_u32 s44, s39, 0x24180
Mvaa 76,220,132
Ta 212,237,32768
s_add_u32 s98, s12, s44
s_addc_u32 s99, s13, 0
Mvaa 72,220,128
Ta 214,237,34816
GDMA 240,98,0
Mvaa 48,224,136
Ta 216,238,32768
GDMA 241,98,1024
Mvaa 52,224,140
Ta 218,238,34816
s_waitcnt lgkmcnt(4)
Mvaa 60,228,140
Ta 220,239,32768
v_cvt_pk_bf16_f32 v146, v24, v25
Mvaa 56,228,136
Ta 222,239,34816
v_cvt_pk_bf16_f32 v147, v26, v27
Mvaa 64,232,136
Ta 224,236,36864
GDMA 242,98,2048
Mvaa 68,232,140
Ta 226,236,38912
s_mov_b32 s48, s47
Mvaa 76,236,140
Ta 228,237,36864
buffer_store_dwordx4 v[144:147], v252, s[28:31], s48 offen offset:0 sc1
Mvaa 72,236,136
Ta 230,237,38912
v_cvt_pk_bf16_f32 v152, v20, v21
Zvaa 80,208,128
Ta 232,238,36864
GDMA 243,98,3072
Zvaa 84,208,132
Ta 234,238,38912
s_waitcnt lgkmcnt(4)
Zvaa 92,212,132
Ta 236,239,36864
v_cvt_pk_bf16_f32 v153, v22, v23
Zvaa 88,212,128
Ta 238,239,38912
v_cvt_pk_bf16_f32 v154, v28, v29
Zvaa 96,216,128
Ta 208,236,40960
v_cvt_pk_bf16_f32 v155, v30, v31
Zvaa 100,216,132
Ta 210,236,43008
buffer_store_dwordx4 v[152:155], v252, s[28:31], s48 offen offset:1024 sc1
Zvaa 108,220,132
Ta 212,237,40960
v_cvt_pk_bf16_f32 v244, v32, v33
Zvaa 104,220,128
Ta 214,237,43008
v_cvt_pk_bf16_f32 v245, v34, v35
Mvaa 80,224,136
Ta 216,238,40960
v_cvt_pk_bf16_f32 v246, v40, v41
Mvaa 84,224,140
Ta 218,238,43008
s_waitcnt lgkmcnt(4)
Mvaa 92,228,140
Ta 220,239,40960
v_cvt_pk_bf16_f32 v247, v42, v43
Mvaa 88,228,136
Ta 222,239,43008
buffer_store_dwordx4 v[244:247], v252, s[28:31], s48 offen offset:2048 sc1
Mvaa 96,232,136
Ta 224,236,45056
v_cvt_pk_bf16_f32 v144, v36, v37
Mvaa 100,232,140
Ta 226,236,47104
v_cvt_pk_bf16_f32 v145, v38, v39
Mvaa 108,236,140
Ta 228,237,45056
v_cvt_pk_bf16_f32 v146, v44, v45
Mvaa 104,236,136
Ta 230,237,47104
v_cvt_pk_bf16_f32 v147, v46, v47
Zvaa 112,208,128
Ta 232,238,45056
buffer_store_dwordx4 v[144:147], v252, s[28:31], s48 offen offset:3072 sc1
Zvaa 116,208,132
Ta 234,238,47104
s_waitcnt lgkmcnt(4)
Zvaa 124,212,132
Ta 236,239,45056
v_cvt_pk_bf16_f32 v152, v48, v49
Zvaa 120,212,128
Ta 238,239,47104
s_waitcnt vmcnt(24)
s_barrier
Zvaa 128,216,128
Ta 208,236,49152
s_add_u32 m0, s35, 0x4000
Zvaa 132,216,132
Ta 210,236,51200
s_add_u32 s44, s39, 0x48180
Zvaa 140,220,132
Ta 212,237,49152
s_add_u32 s98, s12, s44
s_addc_u32 s99, s13, 0
Zvaa 136,220,128
Ta 214,237,51200
GDMA 240,98,0
Mvaa 112,224,136
Ta 216,238,49152
GDMA 241,98,1024
Mvaa 116,224,140
Ta 218,238,51200
s_waitcnt lgkmcnt(4)
Mvaa 124,228,140
Ta 220,239,49152
v_cvt_pk_bf16_f32 v153, v50, v51
Mvaa 120,228,136
Ta 222,239,51200
v_cvt_pk_bf16_f32 v154, v56, v57
Mvaa 128,232,136
Ta 224,236,53248
GDMA 242,98,2048
Mvaa 132,232,140
Ta 226,236,55296
v_cvt_pk_bf16_f32 v155, v58, v59
Mvaa 140,236,140
Ta 228,237,53248
s_add_u32 s48, s47, 0x1000
Mvaa 136,236,136
Ta 230,237,55296
buffer_store_dwordx4 v[152:155], v252, s[28:31], s48 offen offset:0 sc1
Mvaa 80,208,0
Ta 232,238,53248
GDMA 243,98,3072
Mvaa 84,208,4
Ta 234,238,55296
s_waitcnt lgkmcnt(4)
Mvaa 92,212,4
Ta 236,239,53248
v_cvt_pk_bf16_f32 v244, v52, v53
Mvaa 88,212,0
Ta 238,239,55296
v_cvt_pk_bf16_f32 v245, v54, v55
Mvaa 96,216,0
Ta 208,236,57344
v_cvt_pk_bf16_f32 v246, v60, v61
Mvaa 100,216,4
Ta 210,236,59392
v_cvt_pk_bf16_f32 v247, v62, v63
Mvaa 108,220,4
Ta 212,237,57344
buffer_store_dwordx4 v[244:247], v252, s[28:31], s48 offen offset:1024 sc1
Mvaa 104,220,0
Ta 214,237,59392
v_cvt_pk_bf16_f32 v144, v64, v65
Mvaa 80,224,8
Ta 216,238,57344
v_cvt_pk_bf16_f32 v145, v66, v67
Mvaa 84,224,12
Ta 218,238,59392
s_waitcnt lgkmcnt(4)
Mvaa 92,228,12
Ta 220,239,57344
v_cvt_pk_bf16_f32 v146, v72, v73
Mvaa 88,228,8
Ta 222,239,59392
v_cvt_pk_bf16_f32 v147, v74, v75
Mvaa 96,232,8
Ta 224,236,61440
buffer_store_dwordx4 v[144:147], v252, s[28:31], s48 offen offset:2048 sc1
Mvaa 100,232,12
Ta 226,236,63488
v_xor_b32 v236, 0x10000, v236
Mvaa 108,236,12
Ta 228,237,61440
v_cvt_pk_bf16_f32 v152, v68, v69
Mvaa 104,236,8
Ta 230,237,63488
v_xor_b32 v237, 0x10000, v237
Mvaa 80,208,16
Ta 232,238,61440
v_cvt_pk_bf16_f32 v153, v70, v71
Mvaa 84,208,20
Ta 234,238,63488
v_xor_b32 v238, 0x10000, v238
s_waitcnt lgkmcnt(4)
Mvaa 92,212,20
Ta 236,239,61440
v_cvt_pk_bf16_f32 v154, v76, v77
Mvaa 88,212,16
Ta 238,239,63488
v_xor_b32 v239, 0x10000, v239
s_waitcnt vmcnt(27)
s_barrier
Mvaa 96,216,16
Ta 208,236,0
s_add_u32 m0, s35, 0x8000
Mvaa 100,216,20
Ta 210,236,2048
s_add_u32 s44, s39, 0x6c180
Mvaa 108,220,20
Ta 212,237,0
s_add_u32 s98, s12, s44
s_addc_u32 s99, s13, 0
Mvaa 104,220,16
Ta 214,237,2048
GDMA 240,98,0
Mvaa 80,224,24
Ta 216,238,0
GDMA 241,98,1024
Mvaa 84,224,28
Ta 218,238,2048
s_waitcnt lgkmcnt(4)
Mvaa 92,228,28
Ta 220,239,0
v_cvt_pk_bf16_f32 v155, v78, v79
Mvaa 88,228,24
Ta 222,239,2048
buffer_store_dwordx4 v[152:155], v252, s[28:31], s48 offen offset:3072 sc1
Mvaa 96,232,24
Ta 224,236,4096
GDMA 242,98,2048
Mvaa 100,232,28
Ta 226,236,6144
s_mul_i32 s81, s33, 0x240000
Mvaa 108,236,28
Ta 228,237,4096
s_mov_b32 s56, s81
Mvaa 104,236,24
Ta 230,237,6144
s_add_u32 s57, s81, 0x24000
Mvaa 80,208,32
Ta 232,238,4096
GDMA 243,98,3072
Mvaa 84,208,36
Ta 234,238,6144
s_waitcnt lgkmcnt(4)
Mvaa 92,212,36
Ta 236,239,4096
s_add_u32 s58, s81, 0x48000
Mvaa 88,212,32
Ta 238,239,6144
s_add_u32 s59, s81, 0x6c000
Mvaa 96,216,32
Ta 208,236,8192
s_add_u32 s64, s81, 0x90000
Mvaa 100,216,36
Ta 210,236,10240
s_add_u32 s65, s81, 0xb4000
Mvaa 108,220,36
Ta 212,237,8192
s_add_u32 s66, s81, 0xd8000
Mvaa 104,220,32
Ta 214,237,10240
s_add_u32 s67, s81, 0xfc000
Mvaa 80,224,40
Ta 216,238,8192
s_add_u32 s72, s81, 0x120000
Mvaa 84,224,44
Ta 218,238,10240
s_waitcnt lgkmcnt(4)
Mvaa 92,228,44
Ta 220,239,8192
s_add_u32 s73, s81, 0x144000
Mvaa 88,228,40
Ta 222,239,10240
s_add_u32 s74, s81, 0x168000
Mvaa 96,232,40
Ta 224,236,12288
s_add_u32 s75, s81, 0x18c000
Mvaa 100,232,44
Ta 226,236,14336
s_add_u32 s88, s81, 0x1b0000
Mvaa 108,236,44
Ta 228,237,12288
s_add_u32 s89, s81, 0x1d4000
Mvaa 104,236,40
Ta 230,237,14336
s_add_u32 s90, s81, 0x1f8000
Mvaa 80,208,48
Ta 232,238,12288
s_add_u32 s91, s81, 0x21c000
Mvaa 84,208,52
Ta 234,238,14336
s_waitcnt lgkmcnt(4)
Mvaa 92,212,52
Ta 236,239,12288
v_lshrrev_b32 v190, 4, v1
Mvaa 88,212,48
Ta 238,239,14336
s_waitcnt vmcnt(28)
s_barrier
Mvaa 96,216,48
Ta 208,236,16384
s_add_u32 m0, s35, 0xc000
Mvaa 100,216,52
Ta 210,236,18432
s_add_u32 s44, s40, 0x90200
Mvaa 108,220,52
Ta 212,237,16384
s_add_u32 s98, s12, s44
s_addc_u32 s99, s13, 0
Mvaa 104,220,48
Ta 214,237,18432
GDMA 240,98,0
Mvaa 80,224,56
Ta 216,238,16384
GDMA 241,98,1024
Mvaa 84,224,60
Ta 218,238,18432
s_waitcnt lgkmcnt(4)
Mvaa 92,228,60
Ta 220,239,16384
v_lshlrev_b32 v190, 8, v190
Mvaa 88,228,56
Ta 222,239,18432
v_bfe_u32 v191, v1, 3, 1
Mvaa 96,232,56
Ta 224,236,20480
GDMA 242,98,2048
Mvaa 100,232,60
Ta 226,236,22528
v_lshl_or_b32 v190, v191, 11, v190
Mvaa 108,236,60
Ta 228,237,20480
v_and_b32 v191, 7, v1
Mvaa 104,236,56
Ta 230,237,22528
v_lshl_or_b32 v190, v191, 4, v190
Mvaa 80,208,64
Ta 232,238,20480
GDMA 243,98,3072
Mvaa 84,208,68
Ta 234,238,22528
s_waitcnt lgkmcnt(4)
Mvaa 92,212,68
Ta 236,239,20480
s_mov_b32 s79, s42
Mvaa 88,212,64
Ta 238,239,22528
s_lshr_b32 s81, s79, 2
Mvaa 96,216,64
Ta 208,236,24576
s_mul_i32 s81, s81, 0x9000
Mvaa 100,216,68
Ta 210,236,26624
s_lshr_b32 s80, s79, 1
Mvaa 108,220,68
Ta 212,237,24576
s_and_b32 s80, s80, 1
Mvaa 104,220,64
Ta 214,237,26624
s_lshl_b32 s80, s80, 10
Mvaa 80,224,72
Ta 216,238,24576
s_add_u32 s81, s81, s80
Mvaa 84,224,76
Ta 218,238,26624
s_waitcnt lgkmcnt(4)
Mvaa 92,228,76
Ta 220,239,24576
s_and_b32 s80, s79, 1
Mvaa 88,228,72
Ta 222,239,26624
s_lshl_b32 s80, s80, 7
Mvaa 96,232,72
Ta 224,236,28672
s_add_u32 s81, s81, s80
Mvaa 100,232,76
Ta 226,236,30720
s_lshl_b32 s80, s3, 12
Mvaa 108,236,76
Ta 228,237,28672
s_add_u32 s81, s81, s80
Mvaa 104,236,72
Ta 230,237,30720
v_add_u32 v216, s81, v190
Mvaa 80,208,80
Ta 232,238,28672
s_lshl_b32 s81, s33, 7
Mvaa 84,208,84
Ta 234,238,30720
s_waitcnt lgkmcnt(4)
Mvaa 92,212,84
Ta 236,239,28672
s_lshl_b32 s80, s42, 3
Mvaa 88,212,80
Ta 238,239,30720
s_waitcnt vmcnt(28)
s_barrier
Mvaa 96,216,80
Ta 208,236,32768
s_add_u32 m0, s35, 0x10000
Mvaa 100,216,84
Ta 210,236,34816
s_add_u32 s44, s39, 0x200
Mvaa 108,220,84
Ta 212,237,32768
s_add_u32 s98, s12, s44
s_addc_u32 s99, s13, 0
Mvaa 104,220,80
Ta 214,237,34816
GDMA 240,98,0
Mvaa 80,224,88
Ta 216,238,32768
GDMA 241,98,1024
Mvaa 84,224,92
Ta 218,238,34816
s_waitcnt lgkmcnt(4)
Mvaa 92,228,92
Ta 220,239,32768
s_add_u32 s81, s81, s80
Mvaa 88,228,88
Ta 222,239,34816
v_and_b32 v190, 7, v1
Mvaa 96,232,88
Ta 224,236,36864
GDMA 242,98,2048
Mvaa 100,232,92
Ta 226,236,38912
v_add_u32 v190, s81, v190
Mvaa 108,236,92
Ta 228,237,36864
v_mul_u32_u24 v190, 0x480, v190
Mvaa 104,236,88
Ta 230,237,38912
s_lshl_b32 s81, s3, 7
Mvaa 80,208,96
Ta 232,238,36864
GDMA 243,98,3072
Mvaa 84,208,100
Ta 234,238,38912
s_waitcnt lgkmcnt(4)
Mvaa 92,212,100
Ta 236,239,36864
v_add_u32 v190, s81, v190
Mvaa 88,212,96
Ta 238,239,38912
v_bfe_u32 v191, v1, 3, 1
Mvaa 96,216,96
Ta 208,236,40960
v_lshl_add_u32 v190, v191, 6, v190
Mvaa 100,216,100
Ta 210,236,43008
v_lshrrev_b32 v191, 4, v1
Mvaa 108,220,100
Ta 212,237,40960
v_lshl_add_u32 v217, v191, 4, v190
Mvaa 104,220,96
Ta 214,237,43008
s_lshl_b32 s81, s33, 7
Mvaa 80,224,104
Ta 216,238,40960
s_add_u32 s81, s81, 0xc800000
Mvaa 84,224,108
Ta 218,238,43008
s_waitcnt lgkmcnt(4)
Mvaa 92,228,108
Ta 220,239,40960
v_and_b32 v190, 15, v1
Mvaa 88,228,104
Ta 222,239,43008
v_lshlrev_b32 v190, 2, v190
Mvaa 96,232,104
Ta 224,236,45056
v_add_u32 v218, s81, v190
Mvaa 100,232,108
Ta 226,236,47104
s_lshl_b32 s80, s42, 2
Mvaa 108,236,108
Ta 228,237,45056
s_add_u32 s80, s80, s81
Mvaa 104,236,104
Ta 230,237,47104
v_mov_b32 v190, 0x7ffffff0
Mvaa 80,208,112
Ta 232,238,45056
v_mov_b32 v191, s80
Mvaa 84,208,116
Ta 234,238,47104
s_waitcnt lgkmcnt(4)
Mvaa 92,212,116
Ta 236,239,45056
v_cndmask_b32 v220, v190, v191, s[92:93]
Mvaa 88,212,112
Ta 238,239,47104
s_waitcnt vmcnt(28)
s_barrier
Mvaa 96,216,112
Ta 208,236,49152
s_add_u32 m0, s35, 0x14000
Mvaa 100,216,116
Ta 210,236,51200
s_add_u32 s44, s39, 0x24200
Mvaa 108,220,116
Ta 212,237,49152
s_add_u32 s98, s12, s44
s_addc_u32 s99, s13, 0
Mvaa 104,220,112
Ta 214,237,51200
GDMA 240,98,0
Mvaa 80,224,120
Ta 216,238,49152
GDMA 241,98,1024
Mvaa 84,224,124
Ta 218,238,51200
s_waitcnt lgkmcnt(4)
Mvaa 92,228,124
Ta 220,239,49152
s_lshl_b32 s81, s33, 2
Mvaa 88,228,120
Ta 222,239,51200
v_mov_b32 v221, s81
Mvaa 96,232,120
Ta 224,236,53248
GDMA 242,98,2048
Mvaa 100,232,124
Ta 226,236,55296
v_mov_b32 v223, v218
Mvaa 108,236,124
Ta 228,237,53248
Mvaa 104,236,120
Ta 230,237,55296
Mvaa 112,208,0
Ta 232,238,53248
GDMA 243,98,3072
Mvaa 116,208,4
Ta 234,238,55296
s_waitcnt lgkmcnt(4)
Mvaa 124,212,4
Ta 236,239,53248
v_cvt_pk_bf16_f32 v244, v80, v81
Mvaa 120,212,0
Ta 238,239,55296
v_cvt_pk_bf16_f32 v245, v82, v83
Mvaa 128,216,0
Ta 208,236,57344
v_cvt_pk_bf16_f32 v246, v88, v89
Mvaa 132,216,4
Ta 210,236,59392
v_cvt_pk_bf16_f32 v247, v90, v91
Mvaa 140,220,4
Ta 212,237,57344
s_add_u32 s48, s47, 0x2000
Mvaa 136,220,0
Ta 214,237,59392
buffer_store_dwordx4 v[244:247], v252, s[28:31], s48 offen offset:0 sc1
Mvaa 112,224,8
Ta 216,238,57344
v_cvt_pk_bf16_f32 v144, v84, v85
Mvaa 116,224,12
Ta 218,238,59392
s_waitcnt lgkmcnt(4)
Mvaa 124,228,12
Ta 220,239,57344
v_cvt_pk_bf16_f32 v145, v86, v87
Mvaa 120,228,8
Ta 222,239,59392
s_cmp_eq_u32 s3, 0
s_cselect_b32 s81, 0, 0x3ffffff8
s_cselect_b32 s100, 1, 0
Mvaa 128,232,8
Ta 224,236,61440
v_add_u32 v218, s81, v218
v_add_u32 v221, s81, v221
Mvaa 132,232,12
Ta 226,236,63488
v_xor_b32 v236, 0x10000, v236
Mvaa 140,236,12
Ta 228,237,61440
buffer_load_dword v219, v221, s[68:71], 0 offen offset:0 sc1
Mvaa 136,236,8
Ta 230,237,63488
v_xor_b32 v237, 0x10000, v237
Mvaa 112,208,16
Ta 232,238,61440
v_cvt_pk_bf16_f32 v146, v92, v93
Mvaa 116,208,20
Ta 234,238,63488
v_xor_b32 v238, 0x10000, v238
s_waitcnt lgkmcnt(4)
Mvaa 124,212,20
Ta 236,239,61440
v_cvt_pk_bf16_f32 v147, v94, v95
Mvaa 120,212,16
Ta 238,239,63488
v_xor_b32 v239, 0x10000, v239
s_waitcnt vmcnt(29)
s_barrier
Mvaa 128,216,16
Ta 208,236,0
s_add_u32 m0, s35, 0x18000
Mvaa 132,216,20
Ta 210,236,2048
s_add_u32 s44, s39, 0x48200
Mvaa 140,220,20
Ta 212,237,0
s_add_u32 s98, s12, s44
s_addc_u32 s99, s13, 0
Mvaa 136,220,16
Ta 214,237,2048
GDMA 240,98,0
Mvaa 112,224,24
Ta 216,238,0
GDMA 241,98,1024
Mvaa 116,224,28
Ta 218,238,2048
s_waitcnt lgkmcnt(4)
Mvaa 124,228,28
Ta 220,239,0
buffer_store_dwordx4 v[144:147], v252, s[28:31], s48 offen offset:1024 sc1
Mvaa 120,228,24
Ta 222,239,2048
v_cvt_pk_bf16_f32 v152, v96, v97
Mvaa 128,232,24
Ta 224,236,4096
GDMA 242,98,2048
Mvaa 132,232,28
Ta 226,236,6144
v_cvt_pk_bf16_f32 v153, v98, v99
Mvaa 140,236,28
Ta 228,237,4096
v_cvt_pk_bf16_f32 v154, v104, v105
Mvaa 136,236,24
Ta 230,237,6144
v_cvt_pk_bf16_f32 v155, v106, v107
Mvaa 112,208,32
Ta 232,238,4096
GDMA 243,98,3072
Mvaa 116,208,36
Ta 234,238,6144
s_waitcnt lgkmcnt(4)
Mvaa 124,212,36
Ta 236,239,4096
buffer_store_dwordx4 v[152:155], v252, s[28:31], s48 offen offset:2048 sc1
Mvaa 120,212,32
Ta 238,239,6144
v_cvt_pk_bf16_f32 v244, v100, v101
Mvaa 128,216,32
Ta 208,236,8192
v_cvt_pk_bf16_f32 v245, v102, v103
Mvaa 132,216,36
Ta 210,236,10240
v_cvt_pk_bf16_f32 v246, v108, v109
Mvaa 140,220,36
Ta 212,237,8192
v_cvt_pk_bf16_f32 v247, v110, v111
Mvaa 136,220,32
Ta 214,237,10240
buffer_store_dwordx4 v[244:247], v252, s[28:31], s48 offen offset:3072 sc1
Mvaa 112,224,40
Ta 216,238,8192
Mvaa 116,224,44
Ta 218,238,10240
s_waitcnt lgkmcnt(4)
Mvaa 124,228,44
Ta 220,239,8192
Mvaa 120,228,40
Ta 222,239,10240
Mvaa 128,232,40
Ta 224,236,12288
Mvaa 132,232,44
Ta 226,236,14336
Mvaa 140,236,44
Ta 228,237,12288
Mvaa 136,236,40
Ta 230,237,14336
Mvaa 112,208,48
Ta 232,238,12288
Mvaa 116,208,52
Ta 234,238,14336
s_waitcnt lgkmcnt(4)
Mvaa 124,212,52
Ta 236,239,12288
Mvaa 120,212,48
Ta 238,239,14336
s_waitcnt vmcnt(28)
s_barrier
Mvaa 128,216,48
Ta 208,236,16384
s_add_u32 m0, s35, 0x1c000
Mvaa 132,216,52
Ta 210,236,18432
s_add_u32 s44, s39, 0x6c200
Mvaa 140,220,52
Ta 212,237,16384
s_add_u32 s98, s12, s44
s_addc_u32 s99, s13, 0
Mvaa 136,220,48
Ta 214,237,18432
GDMA 240,98,0
Mvaa 112,224,56
Ta 216,238,16384
GDMA 241,98,1024
Mvaa 116,224,60
Ta 218,238,18432
s_waitcnt lgkmcnt(4)
Mvaa 124,228,60
Ta 220,239,16384
Mvaa 120,228,56
Ta 222,239,18432
Mvaa 128,232,56
Ta 224,236,20480
GDMA 242,98,2048
Mvaa 132,232,60
Ta 226,236,22528
Mvaa 140,236,60
Ta 228,237,20480
Mvaa 136,236,56
Ta 230,237,22528
Mvaa 112,208,64
Ta 232,238,20480
GDMA 243,98,3072
Mvaa 116,208,68
Ta 234,238,22528
s_waitcnt lgkmcnt(4)
Mvaa 124,212,68
Ta 236,239,20480
Mvaa 120,212,64
Ta 238,239,22528
Mvaa 128,216,64
Ta 208,236,24576
Mvaa 132,216,68
Ta 210,236,26624
Mvaa 140,220,68
Ta 212,237,24576
Mvaa 136,220,64
Ta 214,237,26624
Mvaa 112,224,72
Ta 216,238,24576
Mvaa 116,224,76
Ta 218,238,26624
s_waitcnt lgkmcnt(4)
Mvaa 124,228,76
Ta 220,239,24576
Mvaa 120,228,72
Ta 222,239,26624
Mvaa 128,232,72
Ta 224,236,28672
Mvaa 132,232,76
Ta 226,236,30720
Mvaa 140,236,76
Ta 228,237,28672
Mvaa 136,236,72
Ta 230,237,30720
Mvaa 112,208,80
Ta 232,238,28672
Mvaa 116,208,84
Ta 234,238,30720
s_waitcnt lgkmcnt(4)
Mvaa 124,212,84
Ta 236,239,28672
Mvaa 120,212,80
Ta 238,239,30720
s_waitcnt vmcnt(25)
s_barrier
Mvaa 128,216,80
Ta 208,236,32768
s_mov_b32 m0, s35
Mvaa 132,216,84
Ta 210,236,34816
s_add_u32 s44, s39, 0x280
Mvaa 140,220,84
Ta 212,237,32768
s_add_u32 s98, s12, s44
s_addc_u32 s99, s13, 0
Mvaa 136,220,80
Ta 214,237,34816
GDMA 240,98,0
Mvaa 112,224,88
Ta 216,238,32768
GDMA 241,98,1024
Mvaa 116,224,92
Ta 218,238,34816
s_waitcnt lgkmcnt(4)
Mvaa 124,228,92
Ta 220,239,32768
Mvaa 120,228,88
Ta 222,239,34816
Mvaa 128,232,88
Ta 224,236,36864
GDMA 242,98,2048
Mvaa 132,232,92
Ta 226,236,38912
Mvaa 140,236,92
Ta 228,237,36864
Mvaa 136,236,88
Ta 230,237,38912
Mvaa 112,208,96
Ta 232,238,36864
GDMA 243,98,3072
Mvaa 116,208,100
Ta 234,238,38912
s_waitcnt lgkmcnt(4)
Mvaa 124,212,100
Ta 236,239,36864
Mvaa 120,212,96
Ta 238,239,38912
Mvaa 128,216,96
Ta 208,236,40960
Mvaa 132,216,100
Ta 210,236,43008
Mvaa 140,220,100
Ta 212,237,40960
Mvaa 136,220,96
Ta 214,237,43008
Mvaa 112,224,104
Ta 216,238,40960
Mvaa 116,224,108
Ta 218,238,43008
s_waitcnt lgkmcnt(4)
Mvaa 124,228,108
Ta 220,239,40960
Mvaa 120,228,104
Ta 222,239,43008
Mvaa 128,232,104
Ta 224,236,45056
Mvaa 132,232,108
Ta 226,236,47104
Mvaa 140,236,108
Ta 228,237,45056
Mvaa 136,236,104
Ta 230,237,47104
Mvaa 112,208,112
Ta 232,238,45056
Mvaa 116,208,116
Ta 234,238,47104
s_waitcnt lgkmcnt(4)
Mvaa 124,212,116
Ta 236,239,45056
Mvaa 120,212,112
Ta 238,239,47104
s_waitcnt vmcnt(25)
s_barrier
Mvaa 128,216,112
Ta 208,236,49152
s_add_u32 m0, s35, 0x4000
Mvaa 132,216,116
Ta 210,236,51200
s_add_u32 s44, s39, 0x24280
Mvaa 140,220,116
Ta 212,237,49152
s_add_u32 s98, s12, s44
s_addc_u32 s99, s13, 0
Mvaa 136,220,112
Ta 214,237,51200
GDMA 240,98,0
Mvaa 112,224,120
Ta 216,238,49152
GDMA 241,98,1024
Mvaa 116,224,124
Ta 218,238,51200
s_waitcnt lgkmcnt(4)
Mvaa 124,228,124
Ta 220,239,49152
Mvaa 120,228,120
Ta 222,239,51200
Mvaa 128,232,120
Ta 224,236,53248
GDMA 242,98,2048
Mvaa 132,232,124
Ta 226,236,55296
Mvaa 140,236,124
Ta 228,237,53248
Mvaa 136,236,120
Ta 230,237,55296
Zvaa 16,208,128
Ta 232,238,53248
GDMA 243,98,3072
Zvaa 20,208,132
Ta 234,238,55296
s_waitcnt lgkmcnt(4)
Zvaa 28,212,132
Ta 236,239,53248
v_cvt_pk_bf16_f32 v144, v112, v113
Zvaa 24,212,128
Ta 238,239,55296
v_cvt_pk_bf16_f32 v145, v114, v115
Zvaa 32,216,128
Ta 208,236,57344
v_cvt_pk_bf16_f32 v146, v120, v121
Zvaa 36,216,132
Ta 210,236,59392
v_cvt_pk_bf16_f32 v147, v122, v123
Zvaa 44,220,132
Ta 212,237,57344
s_add_u32 s48, s47, 0x3000
Zvaa 40,220,128
Ta 214,237,59392
buffer_store_dwordx4 v[144:147], v252, s[28:31], s48 offen offset:0 sc1
Mvaa 16,224,136
Ta 216,238,57344
v_cvt_pk_bf16_f32 v152, v116, v117
Mvaa 20,224,140
Ta 218,238,59392
s_waitcnt lgkmcnt(4)
Mvaa 28,228,140
Ta 220,239,57344
v_cvt_pk_bf16_f32 v153, v118, v119
Mvaa 24,228,136
Ta 222,239,59392
v_cvt_pk_bf16_f32 v154, v124, v125
Mvaa 32,232,136
Ta 224,236,61440
v_cvt_pk_bf16_f32 v155, v126, v127
Mvaa 36,232,140
Ta 226,236,63488
v_xor_b32 v236, 0x10000, v236
Mvaa 44,236,140
Ta 228,237,61440
buffer_store_dwordx4 v[152:155], v252, s[28:31], s48 offen offset:1024 sc1
Mvaa 40,236,136
Ta 230,237,63488
v_xor_b32 v237, 0x10000, v237
Zvaa 48,208,128
Ta 232,238,61440
v_cvt_pk_bf16_f32 v244, v128, v129
Zvaa 52,208,132
Ta 234,238,63488
v_xor_b32 v238, 0x10000, v238
s_waitcnt lgkmcnt(4)
Zvaa 60,212,132
Ta 236,239,61440
v_cvt_pk_bf16_f32 v245, v130, v131
Zvaa 56,212,128
Ta 238,239,63488
v_xor_b32 v239, 0x10000, v239
s_waitcnt vmcnt(27)
s_barrier
Zvaa 64,216,128
Ta 208,236,0
s_add_u32 m0, s35, 0x8000
Zvaa 68,216,132
Ta 210,236,2048
s_add_u32 s44, s39, 0x48280
Zvaa 76,220,132
Ta 212,237,0
s_add_u32 s98, s12, s44
s_addc_u32 s99, s13, 0
Zvaa 72,220,128
Ta 214,237,2048
GDMA 240,98,0
Mvaa 48,224,136
Ta 216,238,0
GDMA 241,98,1024
s_mul_i32 s101, s100, 16
s_waitcnt vmcnt(23)
v_cmp_gt_u32 vcc, s101, v219
s_nop 4
s_cbranch_vccnz L_spin_ffn_cnt
L_spin_ffn_cnt_b:
Mvaa 52,224,140
Ta 218,238,2048
s_waitcnt lgkmcnt(4)
Mvaa 60,228,140
Ta 220,239,0
v_cvt_pk_bf16_f32 v246, v136, v137
Mvaa 56,228,136
Ta 222,239,2048
v_cvt_pk_bf16_f32 v247, v138, v139
Mvaa 64,232,136
Ta 224,236,4096
GDMA 242,98,2048
Mvaa 68,232,140
Ta 226,236,6144
buffer_store_dwordx4 v[244:247], v252, s[28:31], s48 offen offset:2048 sc1
Mvaa 76,236,140
Ta 228,237,4096
v_cvt_pk_bf16_f32 v144, v132, v133
Mvaa 72,236,136
Ta 230,237,6144
v_cvt_pk_bf16_f32 v145, v134, v135
Mvaa 16,208,0
Ta 232,238,4096
GDMA 243,98,3072
Mvaa 20,208,4
Ta 234,238,6144
s_waitcnt lgkmcnt(4)
Mvaa 28,212,4
Ta 236,239,4096
v_cvt_pk_bf16_f32 v146, v140, v141
Mvaa 24,212,0
Ta 238,239,6144
v_cvt_pk_bf16_f32 v147, v142, v143
Mvaa 32,216,0
Ta 208,236,8192
buffer_store_dwordx4 v[144:147], v252, s[28:31], s48 offen offset:3072 sc1
Mvaa 36,216,4
Ta 210,236,10240
Mvaa 44,220,4
Ta 212,237,8192
Mvaa 40,220,0
Ta 214,237,10240
Mvaa 16,224,8
Ta 216,238,8192
Mvaa 20,224,12
Ta 218,238,10240
s_waitcnt lgkmcnt(4)
Mvaa 28,228,12
Ta 220,239,8192
Mvaa 24,228,8
Ta 222,239,10240
Mvaa 32,232,8
Ta 224,236,12288
Mvaa 36,232,12
Ta 226,236,14336
Mvaa 44,236,12
Ta 228,237,12288
Mvaa 40,236,8
Ta 230,237,14336
Mvaa 16,208,16
Ta 232,238,12288
Mvaa 20,208,20
Ta 234,238,14336
s_waitcnt lgkmcnt(4)
Mvaa 28,212,20
Ta 236,239,12288
Mvaa 24,212,16
Ta 238,239,14336
s_barrier
Mvaa 32,216,16
Ta 208,236,16384
s_add_u32 m0, s35, 0xc000
Mvaa 36,216,20
Ta 210,236,18432
s_add_u32 s44, s39, 0x6c280
Mvaa 44,220,20
Ta 212,237,16384
s_add_u32 s98, s12, s44
s_addc_u32 s99, s13, 0
Mvaa 40,220,16
Ta 214,237,18432
GDMA 240,98,0
Mvaa 16,224,24
Ta 216,238,16384
GDMA 241,98,1024
Mvaa 20,224,28
Ta 218,238,18432
s_waitcnt lgkmcnt(4)
Mvaa 28,228,28
Ta 220,239,16384
Mvaa 24,228,24
Ta 222,239,18432
Mvaa 32,232,24
Ta 224,236,20480
GDMA 242,98,2048
Mvaa 36,232,28
Ta 226,236,22528
Mvaa 44,236,28
Ta 228,237,20480
Mvaa 40,236,24
Ta 230,237,22528
Mvaa 16,208,32
Ta 232,238,20480
GDMA 243,98,3072
Mvaa 20,208,36
Ta 234,238,22528
s_waitcnt lgkmcnt(4)
Mvaa 28,212,36
Ta 236,239,20480
Mvaa 24,212,32
Ta 238,239,22528
Mvaa 32,216,32
Ta 208,236,24576
Mvaa 36,216,36
Ta 210,236,26624
Mvaa 44,220,36
Ta 212,237,24576
Mvaa 40,220,32
Ta 214,237,26624
Mvaa 16,224,40
Ta 216,238,24576
Mvaa 20,224,44
Ta 218,238,26624
s_waitcnt lgkmcnt(4)
Mvaa 28,228,44
Ta 220,239,24576
Mvaa 24,228,40
Ta 222,239,26624
Mvaa 32,232,40
Ta 224,236,28672
Mvaa 36,232,44
Ta 226,236,30720
Mvaa 44,236,44
Ta 228,237,28672
Mvaa 40,236,40
Ta 230,237,30720
Mvaa 16,208,48
Ta 232,238,28672
Mvaa 20,208,52
Ta 234,238,30720
s_waitcnt lgkmcnt(4)
Mvaa 28,212,52
Ta 236,239,28672
Mvaa 24,212,48
Ta 238,239,30720
s_waitcnt vmcnt(26)
s_barrier
Mvaa 32,216,48
Ta 208,236,32768
s_add_u32 m0, s35, 0x10000
Mvaa 36,216,52
Ta 210,236,34816
s_add_u32 s44, s40, 0x90300
Mvaa 44,220,52
Ta 212,237,32768
s_add_u32 s98, s12, s44
s_addc_u32 s99, s13, 0
Mvaa 40,220,48
Ta 214,237,34816
GDMA 240,98,0
Mvaa 16,224,56
Ta 216,238,32768
GDMA 241,98,1024
Mvaa 20,224,60
Ta 218,238,34816
s_waitcnt lgkmcnt(4)
Mvaa 28,228,60
Ta 220,239,32768
Mvaa 24,228,56
Ta 222,239,34816
Mvaa 32,232,56
Ta 224,236,36864
GDMA 242,98,2048
Mvaa 36,232,60
Ta 226,236,38912
Mvaa 44,236,60
Ta 228,237,36864
Mvaa 40,236,56
Ta 230,237,38912
Mvaa 16,208,64
Ta 232,238,36864
GDMA 243,98,3072
Mvaa 20,208,68
Ta 234,238,38912
s_waitcnt lgkmcnt(4)
Mvaa 28,212,68
Ta 236,239,36864
Mvaa 24,212,64
Ta 238,239,38912
Mvaa 32,216,64
Ta 208,236,40960
Mvaa 36,216,68
Ta 210,236,43008
Mvaa 44,220,68
Ta 212,237,40960
Mvaa 40,220,64
Ta 214,237,43008
Mvaa 16,224,72
Ta 216,238,40960
Mvaa 20,224,76
Ta 218,238,43008
s_waitcnt lgkmcnt(4)
Mvaa 28,228,76
Ta 220,239,40960
Mvaa 24,228,72
Ta 222,239,43008
Mvaa 32,232,72
Ta 224,236,45056
Mvaa 36,232,76
Ta 226,236,47104
Mvaa 44,236,76
Ta 228,237,45056
Mvaa 40,236,72
Ta 230,237,47104
Mvaa 16,208,80
Ta 232,238,45056
Mvaa 20,208,84
Ta 234,238,47104
s_waitcnt lgkmcnt(4)
Mvaa 28,212,84
Ta 236,239,45056
Mvaa 24,212,80
Ta 238,239,47104
s_waitcnt vmcnt(24)
s_barrier
Mvaa 32,216,80
Ta 208,236,49152
s_add_u32 m0, s35, 0x14000
Mvaa 36,216,84
Ta 210,236,51200
s_add_u32 s44, s39, 0x300
Mvaa 44,220,84
Ta 212,237,49152
s_add_u32 s98, s12, s44
s_addc_u32 s99, s13, 0
Mvaa 40,220,80
Ta 214,237,51200
GDMA 240,98,0
Mvaa 16,224,88
Ta 216,238,49152
GDMA 241,98,1024
Mvaa 20,224,92
Ta 218,238,51200
s_waitcnt lgkmcnt(4)
Mvaa 28,228,92
Ta 220,239,49152
Mvaa 24,228,88
Ta 222,239,51200
Mvaa 32,232,88
Ta 224,236,53248
GDMA 242,98,2048
Mvaa 36,232,92
Ta 226,236,55296
Mvaa 44,236,92
Ta 228,237,53248
Mvaa 40,236,88
Ta 230,237,55296
Mvaa 16,208,96
Ta 232,238,53248
GDMA 243,98,3072
Mvaa 20,208,100
Ta 234,238,55296
s_waitcnt lgkmcnt(4)
Mvaa 28,212,100
Ta 236,239,53248
Mvaa 24,212,96
Ta 238,239,55296
Mvaa 32,216,96
Ta 208,236,57344
Mvaa 36,216,100
Ta 210,236,59392
Mvaa 44,220,100
Ta 212,237,57344
Mvaa 40,220,96
Ta 214,237,59392
Mvaa 16,224,104
Ta 216,238,57344
Mvaa 20,224,108
Ta 218,238,59392
s_waitcnt lgkmcnt(4)
Mvaa 28,228,108
Ta 220,239,57344
Mvaa 24,228,104
Ta 222,239,59392
Mvaa 32,232,104
Ta 224,236,61440
Mvaa 36,232,108
Ta 226,236,63488
v_xor_b32 v236, 0x10000, v236
Mvaa 44,236,108
Ta 228,237,61440
Mvaa 40,236,104
Ta 230,237,63488
v_xor_b32 v237, 0x10000, v237
Mvaa 16,208,112
Ta 232,238,61440
Mvaa 20,208,116
Ta 234,238,63488
v_xor_b32 v238, 0x10000, v238
s_waitcnt lgkmcnt(4)
Mvaa 28,212,116
Ta 236,239,61440
Mvaa 24,212,112
Ta 238,239,63488
v_xor_b32 v239, 0x10000, v239
s_waitcnt vmcnt(24)
s_barrier
Mvaa 32,216,112
Ta 208,236,0
s_add_u32 m0, s35, 0x18000
Mvaa 36,216,116
Ta 210,236,2048
s_add_u32 s44, s39, 0x24300
Mvaa 44,220,116
Ta 212,237,0
s_add_u32 s98, s12, s44
s_addc_u32 s99, s13, 0
Mvaa 40,220,112
Ta 214,237,2048
GDMA 240,98,0
Mvaa 16,224,120
Ta 216,238,0
GDMA 241,98,1024
Mvaa 20,224,124
Ta 218,238,2048
s_waitcnt lgkmcnt(4)
Mvaa 28,228,124
Ta 220,239,0
Mvaa 24,228,120
Ta 222,239,2048
Mvaa 32,232,120
Ta 224,236,4096
GDMA 242,98,2048
Mvaa 36,232,124
Ta 226,236,6144
Mvaa 44,236,124
Ta 228,237,4096
Mvaa 40,236,120
Ta 230,237,6144
Mvaa 48,208,0
Ta 232,238,4096
GDMA 243,98,3072
Mvaa 52,208,4
Ta 234,238,6144
s_waitcnt lgkmcnt(4)
Mvaa 60,212,4
Ta 236,239,4096
v_cvt_pk_bf16_f32 v152, v16, v17
Mvaa 56,212,0
Ta 238,239,6144
v_cvt_pk_bf16_f32 v153, v18, v19
Mvaa 64,216,0
Ta 208,236,8192
v_cvt_pk_bf16_f32 v154, v24, v25
Mvaa 68,216,4
Ta 210,236,10240
v_cvt_pk_bf16_f32 v155, v26, v27
Mvaa 76,220,4
Ta 212,237,8192
s_add_u32 s48, s47, 0x4000
Mvaa 72,220,0
Ta 214,237,10240
buffer_store_dwordx4 v[152:155], v252, s[28:31], s48 offen offset:0 sc1
Mvaa 48,224,8
Ta 216,238,8192
v_cvt_pk_bf16_f32 v244, v20, v21
Mvaa 52,224,12
Ta 218,238,10240
s_waitcnt lgkmcnt(4)
Mvaa 60,228,12
Ta 220,239,8192
v_cvt_pk_bf16_f32 v245, v22, v23
Mvaa 56,228,8
Ta 222,239,10240
v_cvt_pk_bf16_f32 v246, v28, v29
Mvaa 64,232,8
Ta 224,236,12288
v_cvt_pk_bf16_f32 v247, v30, v31
Mvaa 68,232,12
Ta 226,236,14336
buffer_store_dwordx4 v[244:247], v252, s[28:31], s48 offen offset:1024 sc1
Mvaa 76,236,12
Ta 228,237,12288
v_cvt_pk_bf16_f32 v144, v32, v33
Mvaa 72,236,8
Ta 230,237,14336
v_cvt_pk_bf16_f32 v145, v34, v35
Mvaa 48,208,16
Ta 232,238,12288
v_cvt_pk_bf16_f32 v146, v40, v41
Mvaa 52,208,20
Ta 234,238,14336
s_waitcnt lgkmcnt(4)
Mvaa 60,212,20
Ta 236,239,12288
v_cvt_pk_bf16_f32 v147, v42, v43
Mvaa 56,212,16
Ta 238,239,14336
s_waitcnt vmcnt(26)
s_barrier
Mvaa 64,216,16
Ta 208,236,16384
s_add_u32 m0, s35, 0x1c000
Mvaa 68,216,20
Ta 210,236,18432
s_add_u32 s44, s39, 0x48300
Mvaa 76,220,20
Ta 212,237,16384
s_add_u32 s98, s12, s44
s_addc_u32 s99, s13, 0
Mvaa 72,220,16
Ta 214,237,18432
GDMA 240,98,0
Mvaa 48,224,24
Ta 216,238,16384
GDMA 241,98,1024
Mvaa 52,224,28
Ta 218,238,18432
s_waitcnt lgkmcnt(4)
Mvaa 60,228,28
Ta 220,239,16384
buffer_store_dwordx4 v[144:147], v252, s[28:31], s48 offen offset:2048 sc1
Mvaa 56,228,24
Ta 222,239,18432
v_cvt_pk_bf16_f32 v152, v36, v37
Mvaa 64,232,24
Ta 224,236,20480
GDMA 242,98,2048
Mvaa 68,232,28
Ta 226,236,22528
v_cvt_pk_bf16_f32 v153, v38, v39
Mvaa 76,236,28
Ta 228,237,20480
v_cvt_pk_bf16_f32 v154, v44, v45
Mvaa 72,236,24
Ta 230,237,22528
v_cvt_pk_bf16_f32 v155, v46, v47
Mvaa 48,208,32
Ta 232,238,20480
GDMA 243,98,3072
Mvaa 52,208,36
Ta 234,238,22528
s_waitcnt lgkmcnt(4)
Mvaa 60,212,36
Ta 236,239,20480
buffer_store_dwordx4 v[152:155], v252, s[28:31], s48 offen offset:3072 sc1
Mvaa 56,212,32
Ta 238,239,22528
Mvaa 64,216,32
Ta 208,236,24576
Mvaa 68,216,36
Ta 210,236,26624
Mvaa 76,220,36
Ta 212,237,24576
Mvaa 72,220,32
Ta 214,237,26624
Mvaa 48,224,40
Ta 216,238,24576
Mvaa 52,224,44
Ta 218,238,26624
s_waitcnt lgkmcnt(4)
Mvaa 60,228,44
Ta 220,239,24576
Mvaa 56,228,40
Ta 222,239,26624
Mvaa 64,232,40
Ta 224,236,28672
Mvaa 68,232,44
Ta 226,236,30720
Mvaa 76,236,44
Ta 228,237,28672
Mvaa 72,236,40
Ta 230,237,30720
Mvaa 48,208,48
Ta 232,238,28672
Mvaa 52,208,52
Ta 234,238,30720
s_waitcnt lgkmcnt(4)
Mvaa 60,212,52
Ta 236,239,28672
Mvaa 56,212,48
Ta 238,239,30720
s_waitcnt vmcnt(24)
s_barrier
Mvaa 64,216,48
Ta 208,236,32768
s_mov_b32 m0, s35
Mvaa 68,216,52
Ta 210,236,34816
s_add_u32 s44, s39, 0x6c300
Mvaa 76,220,52
Ta 212,237,32768
s_add_u32 s98, s12, s44
s_addc_u32 s99, s13, 0
Mvaa 72,220,48
Ta 214,237,34816
GDMA 240,98,0
Mvaa 48,224,56
Ta 216,238,32768
GDMA 241,98,1024
Mvaa 52,224,60
Ta 218,238,34816
s_waitcnt lgkmcnt(4)
Mvaa 60,228,60
Ta 220,239,32768
v_mov_b32 v222, 4
Mvaa 56,228,56
Ta 222,239,34816
buffer_store_dword v222, v220, s[28:31], 0 offen offset:0 sc1
Mvaa 64,232,56
Ta 224,236,36864
GDMA 242,98,2048
Mvaa 68,232,60
Ta 226,236,38912
Mvaa 76,236,60
Ta 228,237,36864
Mvaa 72,236,56
Ta 230,237,38912
Mvaa 48,208,64
Ta 232,238,36864
GDMA 243,98,3072
Mvaa 52,208,68
Ta 234,238,38912
s_waitcnt lgkmcnt(4)
Mvaa 60,212,68
Ta 236,239,36864
Mvaa 56,212,64
Ta 238,239,38912
Mvaa 64,216,64
Ta 208,236,40960
Mvaa 68,216,68
Ta 210,236,43008
Mvaa 76,220,68
Ta 212,237,40960
Mvaa 72,220,64
Ta 214,237,43008
Mvaa 48,224,72
Ta 216,238,40960
Mvaa 52,224,76
Ta 218,238,43008
s_waitcnt lgkmcnt(4)
Mvaa 60,228,76
Ta 220,239,40960
Mvaa 56,228,72
Ta 222,239,43008
Mvaa 64,232,72
Ta 224,236,45056
Mvaa 68,232,76
Ta 226,236,47104
Mvaa 76,236,76
Ta 228,237,45056
Mvaa 72,236,72
Ta 230,237,47104
Mvaa 48,208,80
Ta 232,238,45056
Mvaa 52,208,84
Ta 234,238,47104
s_waitcnt lgkmcnt(4)
Mvaa 60,212,84
Ta 236,239,45056
Mvaa 56,212,80
Ta 238,239,47104
s_waitcnt vmcnt(25)
s_barrier
Mvaa 64,216,80
Ta 208,236,49152
s_add_u32 m0, s35, 0x4000
Mvaa 68,216,84
Ta 210,236,51200
s_add_u32 s44, s39, 0x380
Mvaa 76,220,84
Ta 212,237,49152
s_add_u32 s98, s12, s44
s_addc_u32 s99, s13, 0
Mvaa 72,220,80
Ta 214,237,51200
GDMA 240,98,0
Mvaa 48,224,88
Ta 216,238,49152
GDMA 241,98,1024
Mvaa 52,224,92
Ta 218,238,51200
s_waitcnt lgkmcnt(4)
Mvaa 60,228,92
Ta 220,239,49152
Mvaa 56,228,88
Ta 222,239,51200
Mvaa 64,232,88
Ta 224,236,53248
GDMA 242,98,2048
Mvaa 68,232,92
Ta 226,236,55296
Mvaa 76,236,92
Ta 228,237,53248
Mvaa 72,236,88
Ta 230,237,55296
Mvaa 48,208,96
Ta 232,238,53248
GDMA 243,98,3072
Mvaa 52,208,100
Ta 234,238,55296
s_waitcnt lgkmcnt(4)
Mvaa 60,212,100
Ta 236,239,53248
Mvaa 56,212,96
Ta 238,239,55296
Mvaa 64,216,96
Ta 208,236,57344
Mvaa 68,216,100
Ta 210,236,59392
Mvaa 76,220,100
Ta 212,237,57344
Mvaa 72,220,96
Ta 214,237,59392
Mvaa 48,224,104
Ta 216,238,57344
Mvaa 52,224,108
Ta 218,238,59392
s_waitcnt lgkmcnt(4)
Mvaa 60,228,108
Ta 220,239,57344
Mvaa 56,228,104
Ta 222,239,59392
Mvaa 64,232,104
Ta 224,236,61440
Mvaa 68,232,108
Ta 226,236,63488
v_xor_b32 v236, 0x10000, v236
Mvaa 76,236,108
Ta 228,237,61440
Mvaa 72,236,104
Ta 230,237,63488
v_xor_b32 v237, 0x10000, v237
Mvaa 48,208,112
Ta 232,238,61440
Mvaa 52,208,116
Ta 234,238,63488
v_xor_b32 v238, 0x10000, v238
s_waitcnt lgkmcnt(4)
Mvaa 60,212,116
Ta 236,239,61440
Mvaa 56,212,112
Ta 238,239,63488
v_xor_b32 v239, 0x10000, v239
s_waitcnt vmcnt(25)
s_barrier
Mvaa 64,216,112
Ta 208,236,0
s_add_u32 m0, s35, 0x8000
Mvaa 68,216,116
Ta 210,236,2048
s_add_u32 s44, s39, 0x24380
Mvaa 76,220,116
Ta 212,237,0
s_add_u32 s98, s12, s44
s_addc_u32 s99, s13, 0
Mvaa 72,220,112
Ta 214,237,2048
GDMA 240,98,0
Mvaa 48,224,120
Ta 216,238,0
GDMA 241,98,1024
Mvaa 52,224,124
Ta 218,238,2048
s_waitcnt lgkmcnt(4)
Mvaa 60,228,124
Ta 220,239,0
Mvaa 56,228,120
Ta 222,239,2048
Mvaa 64,232,120
Ta 224,236,4096
GDMA 242,98,2048
Mvaa 68,232,124
Ta 226,236,6144
Mvaa 76,236,124
Ta 228,237,4096
Mvaa 72,236,120
Ta 230,237,6144
Zvaa 80,208,128
Ta 232,238,4096
GDMA 243,98,3072
Zvaa 84,208,132
Ta 234,238,6144
s_waitcnt lgkmcnt(4)
Zvaa 92,212,132
Ta 236,239,4096
v_cvt_pk_bf16_f32 v244, v48, v49
Zvaa 88,212,128
Ta 238,239,6144
v_cvt_pk_bf16_f32 v245, v50, v51
Zvaa 96,216,128
Ta 208,236,8192
v_cvt_pk_bf16_f32 v246, v56, v57
Zvaa 100,216,132
Ta 210,236,10240
v_cvt_pk_bf16_f32 v247, v58, v59
Zvaa 108,220,132
Ta 212,237,8192
s_add_u32 s48, s47, 0x5000
Zvaa 104,220,128
Ta 214,237,10240
buffer_store_dwordx4 v[244:247], v252, s[28:31], s48 offen offset:0 sc1
Mvaa 80,224,136
Ta 216,238,8192
v_cvt_pk_bf16_f32 v144, v52, v53
Mvaa 84,224,140
Ta 218,238,10240
s_waitcnt lgkmcnt(4)
Mvaa 92,228,140
Ta 220,239,8192
v_cvt_pk_bf16_f32 v145, v54, v55
Mvaa 88,228,136
Ta 222,239,10240
v_cvt_pk_bf16_f32 v146, v60, v61
Mvaa 96,232,136
Ta 224,236,12288
v_cvt_pk_bf16_f32 v147, v62, v63
Mvaa 100,232,140
Ta 226,236,14336
buffer_store_dwordx4 v[144:147], v252, s[28:31], s48 offen offset:1024 sc1
Mvaa 108,236,140
Ta 228,237,12288
v_cvt_pk_bf16_f32 v152, v64, v65
Mvaa 104,236,136
Ta 230,237,14336
v_cvt_pk_bf16_f32 v153, v66, v67
Zvaa 112,208,128
Ta 232,238,12288
v_cvt_pk_bf16_f32 v154, v72, v73
Zvaa 116,208,132
Ta 234,238,14336
s_waitcnt lgkmcnt(4)
Zvaa 124,212,132
Ta 236,239,12288
v_cvt_pk_bf16_f32 v155, v74, v75
Zvaa 120,212,128
Ta 238,239,14336
s_waitcnt vmcnt(27)
s_barrier
Zvaa 128,216,128
Ta 208,236,16384
s_add_u32 m0, s35, 0xc000
Zvaa 132,216,132
Ta 210,236,18432
s_add_u32 s44, s39, 0x48380
Zvaa 140,220,132
Ta 212,237,16384
s_add_u32 s98, s12, s44
s_addc_u32 s99, s13, 0
Zvaa 136,220,128
Ta 214,237,18432
GDMA 240,98,0
Mvaa 112,224,136
Ta 216,238,16384
GDMA 241,98,1024
Mvaa 116,224,140
Ta 218,238,18432
s_waitcnt lgkmcnt(4)
Mvaa 124,228,140
Ta 220,239,16384
buffer_store_dwordx4 v[152:155], v252, s[28:31], s48 offen offset:2048 sc1
Mvaa 120,228,136
Ta 222,239,18432
v_cvt_pk_bf16_f32 v244, v68, v69
Mvaa 128,232,136
Ta 224,236,20480
GDMA 242,98,2048
Mvaa 132,232,140
Ta 226,236,22528
v_cvt_pk_bf16_f32 v245, v70, v71
Mvaa 140,236,140
Ta 228,237,20480
v_cvt_pk_bf16_f32 v246, v76, v77
Mvaa 136,236,136
Ta 230,237,22528
v_cvt_pk_bf16_f32 v247, v78, v79
Mvaa 80,208,0
Ta 232,238,20480
GDMA 243,98,3072
Mvaa 84,208,4
Ta 234,238,22528
s_waitcnt lgkmcnt(4)
Mvaa 92,212,4
Ta 236,239,20480
buffer_store_dwordx4 v[244:247], v252, s[28:31], s48 offen offset:3072 sc1
Mvaa 88,212,0
Ta 238,239,22528
Mvaa 96,216,0
Ta 208,236,24576
Mvaa 100,216,4
Ta 210,236,26624
Mvaa 108,220,4
Ta 212,237,24576
Mvaa 104,220,0
Ta 214,237,26624
Mvaa 80,224,8
Ta 216,238,24576
Mvaa 84,224,12
Ta 218,238,26624
s_waitcnt lgkmcnt(4)
Mvaa 92,228,12
Ta 220,239,24576
Mvaa 88,228,8
Ta 222,239,26624
Mvaa 96,232,8
Ta 224,236,28672
Mvaa 100,232,12
Ta 226,236,30720
Mvaa 108,236,12
Ta 228,237,28672
Mvaa 104,236,8
Ta 230,237,30720
Mvaa 80,208,16
Ta 232,238,28672
Mvaa 84,208,20
Ta 234,238,30720
s_waitcnt lgkmcnt(4)
Mvaa 92,212,20
Ta 236,239,28672
Mvaa 88,212,16
Ta 238,239,30720
s_waitcnt vmcnt(29)
s_barrier
Mvaa 96,216,16
Ta 208,236,32768
s_add_u32 m0, s35, 0x10000
Mvaa 100,216,20
Ta 210,236,34816
s_add_u32 s44, s39, 0x6c380
Mvaa 108,220,20
Ta 212,237,32768
s_add_u32 s98, s12, s44
s_addc_u32 s99, s13, 0
Mvaa 104,220,16
Ta 214,237,34816
GDMA 240,98,0
Mvaa 80,224,24
Ta 216,238,32768
GDMA 241,98,1024
Mvaa 84,224,28
Ta 218,238,34816
s_waitcnt lgkmcnt(4)
Mvaa 92,228,28
Ta 220,239,32768
Mvaa 88,228,24
Ta 222,239,34816
Mvaa 96,232,24
Ta 224,236,36864
GDMA 242,98,2048
Mvaa 100,232,28
Ta 226,236,38912
Mvaa 108,236,28
Ta 228,237,36864
Mvaa 104,236,24
Ta 230,237,38912
Mvaa 80,208,32
Ta 232,238,36864
GDMA 243,98,3072
Mvaa 84,208,36
Ta 234,238,38912
s_waitcnt lgkmcnt(4)
Mvaa 92,212,36
Ta 236,239,36864
Mvaa 88,212,32
Ta 238,239,38912
Mvaa 96,216,32
Ta 208,236,40960
Mvaa 100,216,36
Ta 210,236,43008
Mvaa 108,220,36
Ta 212,237,40960
Mvaa 104,220,32
Ta 214,237,43008
Mvaa 80,224,40
Ta 216,238,40960
Mvaa 84,224,44
Ta 218,238,43008
s_waitcnt lgkmcnt(4)
Mvaa 92,228,44
Ta 220,239,40960
Mvaa 88,228,40
Ta 222,239,43008
Mvaa 96,232,40
Ta 224,236,45056
Mvaa 100,232,44
Ta 226,236,47104
Mvaa 108,236,44
Ta 228,237,45056
Mvaa 104,236,40
Ta 230,237,47104
Mvaa 80,208,48
Ta 232,238,45056
Mvaa 84,208,52
Ta 234,238,47104
s_waitcnt lgkmcnt(4)
Mvaa 92,212,52
Ta 236,239,45056
Mvaa 88,212,48
Ta 238,239,47104
s_waitcnt vmcnt(26)
s_barrier
Mvaa 96,216,48
Ta 208,236,49152
s_add_u32 m0, s35, 0x14000
Mvaa 100,216,52
Ta 210,236,51200
s_add_u32 s44, s41, 0x90400
Mvaa 108,220,52
Ta 212,237,49152
s_add_u32 s98, s12, s44
s_addc_u32 s99, s13, 0
Mvaa 104,220,48
Ta 214,237,51200
GDMA 240,98,0
Mvaa 80,224,56
Ta 216,238,49152
GDMA 241,98,1024
Mvaa 84,224,60
Ta 218,238,51200
s_waitcnt lgkmcnt(4)
Mvaa 92,228,60
Ta 220,239,49152
Mvaa 88,228,56
Ta 222,239,51200
Mvaa 96,232,56
Ta 224,236,53248
GDMA 242,98,2048
Mvaa 100,232,60
Ta 226,236,55296
Mvaa 108,236,60
Ta 228,237,53248
Mvaa 104,236,56
Ta 230,237,55296
Mvaa 80,208,64
Ta 232,238,53248
GDMA 243,98,3072
Mvaa 84,208,68
Ta 234,238,55296
s_waitcnt lgkmcnt(4)
Mvaa 92,212,68
Ta 236,239,53248
Mvaa 88,212,64
Ta 238,239,55296
Mvaa 96,216,64
Ta 208,236,57344
Mvaa 100,216,68
Ta 210,236,59392
Mvaa 108,220,68
Ta 212,237,57344
Mvaa 104,220,64
Ta 214,237,59392
Mvaa 80,224,72
Ta 216,238,57344
Mvaa 84,224,76
Ta 218,238,59392
s_waitcnt lgkmcnt(4)
Mvaa 92,228,76
Ta 220,239,57344
Mvaa 88,228,72
Ta 222,239,59392
Mvaa 96,232,72
Ta 224,236,61440
Mvaa 100,232,76
Ta 226,236,63488
v_xor_b32 v236, 0x10000, v236
Mvaa 108,236,76
Ta 228,237,61440
Mvaa 104,236,72
Ta 230,237,63488
v_xor_b32 v237, 0x10000, v237
Mvaa 80,208,80
Ta 232,238,61440
Mvaa 84,208,84
Ta 234,238,63488
v_xor_b32 v238, 0x10000, v238
s_waitcnt lgkmcnt(4)
Mvaa 92,212,84
Ta 236,239,61440
Mvaa 88,212,80
Ta 238,239,63488
v_xor_b32 v239, 0x10000, v239
s_waitcnt vmcnt(24)
s_barrier
Mvaa 96,216,80
Ta 208,236,0
s_add_u32 m0, s35, 0x18000
Mvaa 100,216,84
Ta 210,236,2048
s_add_u32 s44, s39, 0x400
Mvaa 108,220,84
Ta 212,237,0
s_add_u32 s98, s12, s44
s_addc_u32 s99, s13, 0
Mvaa 104,220,80
Ta 214,237,2048
GDMA 240,98,0
Mvaa 80,224,88
Ta 216,238,0
GDMA 241,98,1024
Mvaa 84,224,92
Ta 218,238,2048
s_waitcnt lgkmcnt(4)
Mvaa 92,228,92
Ta 220,239,0
Mvaa 88,228,88
Ta 222,239,2048
Mvaa 96,232,88
Ta 224,236,4096
GDMA 242,98,2048
Mvaa 100,232,92
Ta 226,236,6144
Mvaa 108,236,92
Ta 228,237,4096
Mvaa 104,236,88
Ta 230,237,6144
Mvaa 80,208,96
Ta 232,238,4096
GDMA 243,98,3072
Mvaa 84,208,100
Ta 234,238,6144
s_waitcnt lgkmcnt(4)
Mvaa 92,212,100
Ta 236,239,4096
Mvaa 88,212,96
Ta 238,239,6144
Mvaa 96,216,96
Ta 208,236,8192
Mvaa 100,216,100
Ta 210,236,10240
Mvaa 108,220,100
Ta 212,237,8192
Mvaa 104,220,96
Ta 214,237,10240
Mvaa 80,224,104
Ta 216,238,8192
Mvaa 84,224,108
Ta 218,238,10240
s_waitcnt lgkmcnt(4)
Mvaa 92,228,108
Ta 220,239,8192
Mvaa 88,228,104
Ta 222,239,10240
Mvaa 96,232,104
Ta 224,236,12288
Mvaa 100,232,108
Ta 226,236,14336
Mvaa 108,236,108
Ta 228,237,12288
Mvaa 104,236,104
Ta 230,237,14336
Mvaa 80,208,112
Ta 232,238,12288
Mvaa 84,208,116
Ta 234,238,14336
s_waitcnt lgkmcnt(4)
Mvaa 92,212,116
Ta 236,239,12288
Mvaa 88,212,112
Ta 238,239,14336
s_waitcnt vmcnt(24)
s_barrier
Mvaa 96,216,112
Ta 208,236,16384
s_add_u32 m0, s35, 0x1c000
Mvaa 100,216,116
Ta 210,236,18432
s_add_u32 s44, s39, 0x24400
Mvaa 108,220,116
Ta 212,237,16384
s_add_u32 s98, s12, s44
s_addc_u32 s99, s13, 0
Mvaa 104,220,112
Ta 214,237,18432
GDMA 240,98,0
Mvaa 80,224,120
Ta 216,238,16384
GDMA 241,98,1024
Mvaa 84,224,124
Ta 218,238,18432
s_waitcnt lgkmcnt(4)
Mvaa 92,228,124
Ta 220,239,16384
Mvaa 88,228,120
Ta 222,239,18432
Mvaa 96,232,120
Ta 224,236,20480
GDMA 242,98,2048
Mvaa 100,232,124
Ta 226,236,22528
Mvaa 108,236,124
Ta 228,237,20480
Mvaa 104,236,120
Ta 230,237,22528
Mvaa 112,208,0
Ta 232,238,20480
GDMA 243,98,3072
Mvaa 116,208,4
Ta 234,238,22528
s_waitcnt lgkmcnt(4)
Mvaa 124,212,4
Ta 236,239,20480
v_cvt_pk_bf16_f32 v144, v80, v81
Mvaa 120,212,0
Ta 238,239,22528
v_cvt_pk_bf16_f32 v145, v82, v83
Mvaa 128,216,0
Ta 208,236,24576
v_cvt_pk_bf16_f32 v146, v88, v89
Mvaa 132,216,4
Ta 210,236,26624
v_cvt_pk_bf16_f32 v147, v90, v91
Mvaa 140,220,4
Ta 212,237,24576
s_add_u32 s48, s47, 0x6000
Mvaa 136,220,0
Ta 214,237,26624
buffer_store_dwordx4 v[144:147], v252, s[28:31], s48 offen offset:0 sc1
Mvaa 112,224,8
Ta 216,238,24576
v_cvt_pk_bf16_f32 v152, v84, v85
Mvaa 116,224,12
Ta 218,238,26624
s_waitcnt lgkmcnt(4)
Mvaa 124,228,12
Ta 220,239,24576
v_cvt_pk_bf16_f32 v153, v86, v87
Mvaa 120,228,8
Ta 222,239,26624
v_cvt_pk_bf16_f32 v154, v92, v93
Mvaa 128,232,8
Ta 224,236,28672
v_cvt_pk_bf16_f32 v155, v94, v95
Mvaa 132,232,12
Ta 226,236,30720
buffer_store_dwordx4 v[152:155], v252, s[28:31], s48 offen offset:1024 sc1
Mvaa 140,236,12
Ta 228,237,28672
v_cvt_pk_bf16_f32 v244, v96, v97
Mvaa 136,236,8
Ta 230,237,30720
v_cvt_pk_bf16_f32 v245, v98, v99
Mvaa 112,208,16
Ta 232,238,28672
v_cvt_pk_bf16_f32 v246, v104, v105
Mvaa 116,208,20
Ta 234,238,30720
s_waitcnt lgkmcnt(4)
Mvaa 124,212,20
Ta 236,239,28672
v_cvt_pk_bf16_f32 v247, v106, v107
Mvaa 120,212,16
Ta 238,239,30720
s_waitcnt vmcnt(26)
s_barrier
Mvaa 128,216,16
Ta 208,236,32768
s_mov_b32 m0, s35
Mvaa 132,216,20
Ta 210,236,34816
s_add_u32 s44, s39, 0x48400
Mvaa 140,220,20
Ta 212,237,32768
s_add_u32 s98, s12, s44
s_addc_u32 s99, s13, 0
Mvaa 136,220,16
Ta 214,237,34816
GDMA 240,98,0
Mvaa 112,224,24
Ta 216,238,32768
GDMA 241,98,1024
Mvaa 116,224,28
Ta 218,238,34816
s_waitcnt lgkmcnt(4)
Mvaa 124,228,28
Ta 220,239,32768
buffer_store_dwordx4 v[244:247], v252, s[28:31], s48 offen offset:2048 sc1
Mvaa 120,228,24
Ta 222,239,34816
v_cvt_pk_bf16_f32 v144, v100, v101
Mvaa 128,232,24
Ta 224,236,36864
GDMA 242,98,2048
Mvaa 132,232,28
Ta 226,236,38912
v_cvt_pk_bf16_f32 v145, v102, v103
Mvaa 140,236,28
Ta 228,237,36864
v_cvt_pk_bf16_f32 v146, v108, v109
Mvaa 136,236,24
Ta 230,237,38912
v_cvt_pk_bf16_f32 v147, v110, v111
Mvaa 112,208,32
Ta 232,238,36864
GDMA 243,98,3072
Mvaa 116,208,36
Ta 234,238,38912
s_waitcnt lgkmcnt(4)
Mvaa 124,212,36
Ta 236,239,36864
buffer_store_dwordx4 v[144:147], v252, s[28:31], s48 offen offset:3072 sc1
Mvaa 120,212,32
Ta 238,239,38912
Mvaa 128,216,32
Ta 208,236,40960
Mvaa 132,216,36
Ta 210,236,43008
Mvaa 140,220,36
Ta 212,237,40960
Mvaa 136,220,32
Ta 214,237,43008
Mvaa 112,224,40
Ta 216,238,40960
Mvaa 116,224,44
Ta 218,238,43008
s_waitcnt lgkmcnt(4)
Mvaa 124,228,44
Ta 220,239,40960
Mvaa 120,228,40
Ta 222,239,43008
Mvaa 128,232,40
Ta 224,236,45056
Mvaa 132,232,44
Ta 226,236,47104
Mvaa 140,236,44
Ta 228,237,45056
Mvaa 136,236,40
Ta 230,237,47104
Mvaa 112,208,48
Ta 232,238,45056
Mvaa 116,208,52
Ta 234,238,47104
s_waitcnt lgkmcnt(4)
Mvaa 124,212,52
Ta 236,239,45056
Mvaa 120,212,48
Ta 238,239,47104
buffer_load_dword v219, v218, s[28:31], 0 offen offset:0 sc1
s_waitcnt vmcnt(26)
s_barrier
Mvaa 128,216,48
Ta 208,236,49152
s_add_u32 m0, s35, 0x4000
Mvaa 132,216,52
Ta 210,236,51200
s_add_u32 s44, s39, 0x6c400
Mvaa 140,220,52
Ta 212,237,49152
s_add_u32 s98, s12, s44
s_addc_u32 s99, s13, 0
Mvaa 136,220,48
Ta 214,237,51200
GDMA 240,98,0
Mvaa 112,224,56
Ta 216,238,49152
GDMA 241,98,1024
Mvaa 116,224,60
Ta 218,238,51200
s_waitcnt lgkmcnt(4)
Mvaa 124,228,60
Ta 220,239,49152
Mvaa 120,228,56
Ta 222,239,51200
Mvaa 128,232,56
Ta 224,236,53248
GDMA 242,98,2048
Mvaa 132,232,60
Ta 226,236,55296
Mvaa 140,236,60
Ta 228,237,53248
Mvaa 136,236,56
Ta 230,237,55296
Mvaa 112,208,64
Ta 232,238,53248
GDMA 243,98,3072
Mvaa 116,208,68
Ta 234,238,55296
s_waitcnt lgkmcnt(4)
Mvaa 124,212,68
Ta 236,239,53248
Mvaa 120,212,64
Ta 238,239,55296
Mvaa 128,216,64
Ta 208,236,57344
Mvaa 132,216,68
Ta 210,236,59392
Mvaa 140,220,68
Ta 212,237,57344
Mvaa 136,220,64
Ta 214,237,59392
Mvaa 112,224,72
Ta 216,238,57344
Mvaa 116,224,76
Ta 218,238,59392
s_waitcnt lgkmcnt(4)
Mvaa 124,228,76
Ta 220,239,57344
Mvaa 120,228,72
Ta 222,239,59392
Mvaa 128,232,72
Ta 224,236,61440
Mvaa 132,232,76
Ta 226,236,63488
v_xor_b32 v236, 0x10000, v236
Mvaa 140,236,76
Ta 228,237,61440
Mvaa 136,236,72
Ta 230,237,63488
v_xor_b32 v237, 0x10000, v237
Mvaa 112,208,80
Ta 232,238,61440
Mvaa 116,208,84
Ta 234,238,63488
v_xor_b32 v238, 0x10000, v238
s_waitcnt lgkmcnt(4)
Mvaa 124,212,84
Ta 236,239,61440
Mvaa 120,212,80
Ta 238,239,63488
v_xor_b32 v239, 0x10000, v239
s_waitcnt vmcnt(25)
s_barrier
Mvaa 128,216,80
Ta 208,236,0
Mvaa 132,216,84
Ta 210,236,2048
Mvaa 140,220,84
Ta 212,237,0
Mvaa 136,220,80
Ta 214,237,2048
Mvaa 112,224,88
Ta 216,238,0
Mvaa 116,224,92
Ta 218,238,2048
s_waitcnt lgkmcnt(4)
Mvaa 124,228,92
Ta 220,239,0
Mvaa 120,228,88
Ta 222,239,2048
Mvaa 128,232,88
Ta 224,236,4096
Mvaa 132,232,92
Ta 226,236,6144
Mvaa 140,236,92
Ta 228,237,4096
Mvaa 136,236,88
Ta 230,237,6144
Mvaa 112,208,96
Ta 232,238,4096
Mvaa 116,208,100
Ta 234,238,6144
s_waitcnt lgkmcnt(4)
Mvaa 124,212,100
Ta 236,239,4096
Mvaa 120,212,96
Ta 238,239,6144
Mvaa 128,216,96
Ta 208,236,8192
Mvaa 132,216,100
Ta 210,236,10240
Mvaa 140,220,100
Ta 212,237,8192
Mvaa 136,220,96
Ta 214,237,10240
Mvaa 112,224,104
Ta 216,238,8192
Mvaa 116,224,108
Ta 218,238,10240
s_waitcnt lgkmcnt(4)
Mvaa 124,228,108
Ta 220,239,8192
Mvaa 120,228,104
Ta 222,239,10240
Mvaa 128,232,104
Ta 224,236,12288
Mvaa 132,232,108
Ta 226,236,14336
Mvaa 140,236,108
Ta 228,237,12288
Mvaa 136,236,104
Ta 230,237,14336
Mvaa 112,208,112
Ta 232,238,12288
Mvaa 116,208,116
Ta 234,238,14336
s_waitcnt lgkmcnt(4)
Mvaa 124,212,116
Ta 236,239,12288
Mvaa 120,212,112
Ta 238,239,14336
s_waitcnt vmcnt(21)
s_barrier
Mvaa 128,216,112
Ta 208,236,16384
Mvaa 132,216,116
Ta 210,236,18432
Mvaa 140,220,116
Ta 212,237,16384
Mvaa 136,220,112
Ta 214,237,18432
Mvaa 112,224,120
Ta 216,238,16384
Mvaa 116,224,124
Ta 218,238,18432
s_waitcnt lgkmcnt(4)
Mvaa 124,228,124
Ta 220,239,16384
Mvaa 120,228,120
Ta 222,239,18432
Mvaa 128,232,120
Ta 224,236,20480
Mvaa 132,232,124
Ta 226,236,22528
Mvaa 140,236,124
Ta 228,237,20480
Mvaa 136,236,120
Ta 230,237,22528
Zvaa 16,208,128
Ta 232,238,20480
v_cvt_pk_bf16_f32 v152, v112, v113
Zvaa 20,208,132
Ta 234,238,22528
s_waitcnt lgkmcnt(4)
Zvaa 28,212,132
Ta 236,239,20480
v_cvt_pk_bf16_f32 v153, v114, v115
Zvaa 24,212,128
Ta 238,239,22528
s_waitcnt vmcnt(17)
s_barrier
Zvaa 32,216,128
Ta 208,236,32768
v_cvt_pk_bf16_f32 v154, v120, v121
Zvaa 36,216,132
Ta 210,236,34816
v_cvt_pk_bf16_f32 v155, v122, v123
Zvaa 44,220,132
Ta 212,237,32768
s_add_u32 s48, s47, 0x7000
Zvaa 40,220,128
Ta 214,237,34816
buffer_store_dwordx4 v[152:155], v252, s[28:31], s48 offen offset:0 sc1
Mvaa 16,224,136
Ta 216,238,32768
v_cvt_pk_bf16_f32 v244, v116, v117
Mvaa 20,224,140
Ta 218,238,34816
s_waitcnt lgkmcnt(4)
Mvaa 28,228,140
Ta 220,239,32768
v_cvt_pk_bf16_f32 v245, v118, v119
Mvaa 24,228,136
Ta 222,239,34816
v_cvt_pk_bf16_f32 v246, v124, v125
Mvaa 32,232,136
Ta 224,236,36864
v_cvt_pk_bf16_f32 v247, v126, v127
Mvaa 36,232,140
Ta 226,236,38912
buffer_store_dwordx4 v[244:247], v252, s[28:31], s48 offen offset:1024 sc1
Mvaa 44,236,140
Ta 228,237,36864
v_cvt_pk_bf16_f32 v144, v128, v129
Mvaa 40,236,136
Ta 230,237,38912
v_cvt_pk_bf16_f32 v145, v130, v131
Mvaa 16,208,0
Ta 232,238,36864
v_cvt_pk_bf16_f32 v146, v136, v137
Mvaa 20,208,4
Ta 234,238,38912
s_waitcnt lgkmcnt(4)
Mvaa 28,212,4
Ta 236,239,36864
v_cvt_pk_bf16_f32 v147, v138, v139
Mvaa 24,212,0
Ta 238,239,38912
buffer_store_dwordx4 v[144:147], v252, s[28:31], s48 offen offset:2048 sc1
Mvaa 32,216,0
Ta 208,236,40960
v_cvt_pk_bf16_f32 v152, v132, v133
Mvaa 36,216,4
Ta 210,236,43008
v_cvt_pk_bf16_f32 v153, v134, v135
Mvaa 44,220,4
Ta 212,237,40960
v_cvt_pk_bf16_f32 v154, v140, v141
Mvaa 40,220,0
Ta 214,237,43008
v_cvt_pk_bf16_f32 v155, v142, v143
Mvaa 16,224,8
Ta 216,238,40960
buffer_store_dwordx4 v[152:155], v252, s[28:31], s48 offen offset:3072 sc1
Mvaa 20,224,12
Ta 218,238,43008
s_waitcnt lgkmcnt(4)
Mvaa 28,228,12
Ta 220,239,40960
Mvaa 24,228,8
Ta 222,239,43008
Mvaa 32,232,8
Ta 224,236,45056
Mvaa 36,232,12
Ta 226,236,47104
Mvaa 44,236,12
Ta 228,237,45056
Mvaa 40,236,8
Ta 230,237,47104
Mvaa 16,208,16
Ta 232,238,45056
Mvaa 20,208,20
Ta 234,238,47104
s_waitcnt lgkmcnt(4)
Mvaa 28,212,20
Ta 236,239,45056
Mvaa 24,212,16
Ta 238,239,47104
s_waitcnt vmcnt(9)
s_barrier
Mvaa 32,216,16
Ta 208,236,49152
v_mov_b32 v222, 7
Mvaa 36,216,20
Ta 210,236,51200
buffer_store_dword v222, v220, s[28:31], 0 offen offset:0 sc1
Mvaa 44,220,20
Ta 212,237,49152
Mvaa 40,220,16
Ta 214,237,51200
Mvaa 16,224,24
Ta 216,238,49152
Mvaa 20,224,28
Ta 218,238,51200
s_waitcnt lgkmcnt(4)
Mvaa 28,228,28
Ta 220,239,49152
Mvaa 24,228,24
Ta 222,239,51200
Mvaa 32,232,24
Ta 224,236,53248
Mvaa 36,232,28
Ta 226,236,55296
Mvaa 44,236,28
Ta 228,237,53248
Mvaa 40,236,24
Ta 230,237,55296
Mvaa 16,208,32
Ta 232,238,53248
Mvaa 20,208,36
Ta 234,238,55296
s_waitcnt lgkmcnt(4)
Mvaa 28,212,36
Ta 236,239,53248
Mvaa 24,212,32
Ta 238,239,55296
Mvaa 32,216,32
Ta 208,236,57344
Mvaa 36,216,36
Ta 210,236,59392
Mvaa 44,220,36
Ta 212,237,57344
s_waitcnt vmcnt(9)
buffer_load_dword v219, v223, s[28:31], 0 offen offset:0 sc1
Mvaa 40,220,32
Ta 214,237,59392
Mvaa 16,224,40
Ta 216,238,57344
Mvaa 20,224,44
Ta 218,238,59392
s_waitcnt lgkmcnt(4)
Mvaa 28,228,44
Ta 220,239,57344
Mvaa 24,228,40
Ta 222,239,59392
Mvaa 32,232,40
Ta 224,236,61440
Mvaa 36,232,44
Ta 226,236,63488
v_xor_b32 v236, 0x10000, v236
Mvaa 44,236,44
Ta 228,237,61440
Mvaa 40,236,40
Ta 230,237,63488
v_xor_b32 v237, 0x10000, v237
Mvaa 16,208,48
Ta 232,238,61440
Mvaa 20,208,52
Ta 234,238,63488
v_xor_b32 v238, 0x10000, v238
s_waitcnt lgkmcnt(4)
Mvaa 28,212,52
Ta 236,239,61440
Mvaa 24,212,48
Ta 238,239,63488
v_xor_b32 v239, 0x10000, v239
s_barrier
Mvaa 32,216,48
Ta 208,236,0
Mvaa 36,216,52
Ta 210,236,2048
Mvaa 44,220,52
Ta 212,237,0
Mvaa 40,220,48
Ta 214,237,2048
Mvaa 16,224,56
Ta 216,238,0
Mvaa 20,224,60
Ta 218,238,2048
s_waitcnt lgkmcnt(4)
s_mul_i32 s101, s100, 4
s_waitcnt vmcnt(0)
v_cmp_gt_u32 vcc, s101, v219
s_nop 4
s_cbranch_vccnz L_spin_ffn_r0
L_spin_ffn_r0_b:
Mvaa 28,228,60
Ta 220,239,0
Mvaa 24,228,56
Ta 222,239,2048
Mvaa 32,232,56
Ta 224,236,4096
Mvaa 36,232,60
Ta 226,236,6144
Mvaa 44,236,60
Ta 228,237,4096
Mvaa 40,236,56
Ta 230,237,6144
Mvaa 16,208,64
Ta 232,238,4096
Mvaa 20,208,68
Ta 234,238,6144
s_waitcnt lgkmcnt(4)
Mvaa 28,212,68
Ta 236,239,4096
Mvaa 24,212,64
Ta 238,239,6144
Mvaa 32,216,64
Ta 208,236,8192
Mvaa 36,216,68
Ta 210,236,10240
Mvaa 44,220,68
Ta 212,237,8192
Mvaa 40,220,64
Ta 214,237,10240
Mvaa 16,224,72
Ta 216,238,8192
Mvaa 20,224,76
Ta 218,238,10240
s_waitcnt lgkmcnt(4)
Mvaa 28,228,76
Ta 220,239,8192
Mvaa 24,228,72
Ta 222,239,10240
Mvaa 32,232,72
Ta 224,236,12288
Mvaa 36,232,76
Ta 226,236,14336
Mvaa 44,236,76
Ta 228,237,12288
Mvaa 40,236,72
Ta 230,237,14336
Mvaa 16,208,80
Ta 232,238,12288
Mvaa 20,208,84
Ta 234,238,14336
s_waitcnt lgkmcnt(4)
Mvaa 28,212,84
Ta 236,239,12288
Mvaa 24,212,80
Ta 238,239,14336
s_barrier
Mvaa 32,216,80
Ta 208,236,16384
buffer_load_dwordx4 a[144:147], v216, s[28:31], s56 offen offset:0 sc1
Mvaa 36,216,84
Ta 210,236,18432
buffer_load_dwordx4 a[148:151], v216, s[28:31], s57 offen offset:0 sc1
Mvaa 44,220,84
Ta 212,237,16384
buffer_load_dwordx4 a[152:155], v216, s[28:31], s58 offen offset:0 sc1
Mvaa 40,220,80
Ta 214,237,18432
buffer_load_dwordx4 a[156:159], v216, s[28:31], s59 offen offset:0 sc1
Mvaa 16,224,88
Ta 216,238,16384
buffer_load_dwordx4 a[160:163], v216, s[28:31], s64 offen offset:0 sc1
Mvaa 20,224,92
Ta 218,238,18432
s_waitcnt lgkmcnt(4)
Mvaa 28,228,92
Ta 220,239,16384
buffer_load_dwordx4 a[164:167], v216, s[28:31], s65 offen offset:0 sc1
Mvaa 24,228,88
Ta 222,239,18432
buffer_load_dwordx4 a[168:171], v216, s[28:31], s66 offen offset:0 sc1
Mvaa 32,232,88
Ta 224,236,20480
buffer_load_dwordx4 a[172:175], v216, s[28:31], s67 offen offset:0 sc1
Mvaa 36,232,92
Ta 226,236,22528
buffer_load_dwordx4 a[176:179], v216, s[28:31], s72 offen offset:0 sc1
Mvaa 44,236,92
Ta 228,237,20480
buffer_load_dwordx4 a[180:183], v216, s[28:31], s73 offen offset:0 sc1
Mvaa 40,236,88
Ta 230,237,22528
buffer_load_dwordx4 a[184:187], v216, s[28:31], s74 offen offset:0 sc1
Mvaa 16,208,96
Ta 232,238,20480
buffer_load_dwordx4 a[188:191], v216, s[28:31], s75 offen offset:0 sc1
Mvaa 20,208,100
Ta 234,238,22528
s_waitcnt lgkmcnt(4)
Mvaa 28,212,100
Ta 236,239,20480
buffer_load_dwordx4 a[192:195], v216, s[28:31], s88 offen offset:0 sc1
Mvaa 24,212,96
Ta 238,239,22528
buffer_load_dwordx4 a[196:199], v216, s[28:31], s89 offen offset:0 sc1
Mvaa 32,216,96
Ta 208,236,24576
buffer_load_dwordx4 a[200:203], v216, s[28:31], s90 offen offset:0 sc1
Mvaa 36,216,100
Ta 210,236,26624
buffer_load_dwordx4 a[204:207], v216, s[28:31], s91 offen offset:0 sc1
Mvaa 44,220,100
Ta 212,237,24576
buffer_load_dwordx4 a[240:243], v217, s[4:7], 0 offen offset:0
Mvaa 40,220,96
Ta 214,237,26624
v_add_u32 v216, 0x4000, v216
Mvaa 16,224,104
Ta 216,238,24576
Mvaa 20,224,108
Ta 218,238,26624
s_waitcnt lgkmcnt(4)
Mvaa 28,228,108
Ta 220,239,24576
Mvaa 24,228,104
Ta 222,239,26624
Mvaa 32,232,104
Ta 224,236,28672
Mvaa 36,232,108
Ta 226,236,30720
Mvaa 44,236,108
Ta 228,237,28672
Mvaa 40,236,104
Ta 230,237,30720
Mvaa 16,208,112
Ta 232,238,28672
Mvaa 20,208,116
Ta 234,238,30720
s_waitcnt lgkmcnt(4)
Mvaa 28,212,116
Ta 236,239,28672
Mvaa 24,212,112
Ta 238,239,30720
Mvaa 32,216,112
Mvaa 36,216,116
Mvaa 44,220,116
Mvaa 40,220,112
Mvaa 16,224,120
Mvaa 20,224,124
s_waitcnt lgkmcnt(0)
Mvaa 28,228,124
Mvaa 24,228,120
Mvaa 32,232,120
Mvaa 36,232,124
Mvaa 44,236,124
Mvaa 40,236,120
v_cvt_pk_bf16_f32 v244, v16, v17
v_cvt_pk_bf16_f32 v245, v18, v19
s_nop 1
v_cvt_pk_bf16_f32 v246, v24, v25
v_cvt_pk_bf16_f32 v247, v26, v27
s_add_u32 s48, s47, 0x8000
buffer_store_dwordx4 v[244:247], v252, s[28:31], s48 offen offset:0 sc1
v_cvt_pk_bf16_f32 v144, v20, v21
v_cvt_pk_bf16_f32 v145, v22, v23
v_cvt_pk_bf16_f32 v146, v28, v29
v_cvt_pk_bf16_f32 v147, v30, v31
buffer_store_dwordx4 v[144:147], v252, s[28:31], s48 offen offset:1024 sc1
v_cvt_pk_bf16_f32 v152, v32, v33
v_cvt_pk_bf16_f32 v153, v34, v35
v_cvt_pk_bf16_f32 v154, v40, v41
v_cvt_pk_bf16_f32 v155, v42, v43
buffer_store_dwordx4 v[152:155], v252, s[28:31], s48 offen offset:2048 sc1
v_cvt_pk_bf16_f32 v244, v36, v37
v_cvt_pk_bf16_f32 v245, v38, v39
v_cvt_pk_bf16_f32 v246, v44, v45
v_cvt_pk_bf16_f32 v247, v46, v47
buffer_store_dwordx4 v[244:247], v252, s[28:31], s48 offen offset:3072 sc1
s_mov_b32 s94, 0x3f80
s_mov_b32 s95, 0x3f800000
s_cmp_eq_u32 s3, 3
s_cbranch_scc1 L_tailB_ffn
s_mov_b32 s101, 7
v_cmp_gt_u32 vcc, s101, v219
s_nop 4
s_cbranch_vccnz L_spin_ffn_a
L_spin_ffn_a_b:
buffer_load_dwordx4 v[16:19], v216, s[28:31], s56 offen offset:0 sc1
buffer_load_dwordx4 v[20:23], v216, s[28:31], s57 offen offset:0 sc1
buffer_load_dwordx4 v[24:27], v216, s[28:31], s58 offen offset:0 sc1
buffer_load_dwordx4 v[28:31], v216, s[28:31], s59 offen offset:0 sc1
buffer_load_dwordx4 v[32:35], v216, s[28:31], s64 offen offset:0 sc1
buffer_load_dwordx4 v[36:39], v216, s[28:31], s65 offen offset:0 sc1
buffer_load_dwordx4 v[40:43], v216, s[28:31], s66 offen offset:0 sc1
buffer_load_dwordx4 v[44:47], v216, s[28:31], s67 offen offset:0 sc1
buffer_load_dwordx4 v[48:51], v216, s[28:31], s72 offen offset:0 sc1
buffer_load_dwordx4 v[52:55], v216, s[28:31], s73 offen offset:0 sc1
buffer_load_dwordx4 v[56:59], v216, s[28:31], s74 offen offset:0 sc1
buffer_load_dwordx4 v[60:63], v216, s[28:31], s75 offen offset:0 sc1
buffer_load_dwordx4 v[64:67], v216, s[28:31], s88 offen offset:0 sc1
buffer_load_dwordx4 v[68:71], v216, s[28:31], s89 offen offset:0 sc1
buffer_load_dwordx4 v[72:75], v216, s[28:31], s90 offen offset:0 sc1
buffer_load_dwordx4 v[76:79], v216, s[28:31], s91 offen offset:0 sc1
buffer_load_dwordx4 v[80:83], v217, s[4:7], 0 offen offset:512
v_add_u32 v216, 0x4000, v216
s_waitcnt vmcnt(21)
v_accvgpr_read_b32 v208, a144
v_dot2_f32_bf16 v192, v208, s94, 0
v_dot2_f32_bf16 v193, v208, s95, 0
v_accvgpr_read_b32 v209, a145
v_dot2_f32_bf16 v194, v209, s94, 0
v_dot2_f32_bf16 v195, v209, s95, 0
v_accvgpr_read_b32 v210, a146
v_dot2_f32_bf16 v196, v210, s94, 0
v_dot2_f32_bf16 v197, v210, s95, 0
v_accvgpr_read_b32 v211, a147
v_dot2_f32_bf16 v198, v211, s94, 0
v_dot2_f32_bf16 v199, v211, s95, 0
v_accvgpr_read_b32 v208, a148
v_dot2_f32_bf16 v192, v208, s94, v192
v_dot2_f32_bf16 v193, v208, s95, v193
v_accvgpr_read_b32 v209, a149
v_dot2_f32_bf16 v194, v209, s94, v194
v_dot2_f32_bf16 v195, v209, s95, v195
v_accvgpr_read_b32 v210, a150
v_dot2_f32_bf16 v196, v210, s94, v196
v_dot2_f32_bf16 v197, v210, s95, v197
v_accvgpr_read_b32 v211, a151
v_dot2_f32_bf16 v198, v211, s94, v198
v_dot2_f32_bf16 v199, v211, s95, v199
v_accvgpr_read_b32 v208, a152
v_dot2_f32_bf16 v192, v208, s94, v192
v_dot2_f32_bf16 v193, v208, s95, v193
v_accvgpr_read_b32 v209, a153
v_dot2_f32_bf16 v194, v209, s94, v194
v_dot2_f32_bf16 v195, v209, s95, v195
v_accvgpr_read_b32 v210, a154
v_dot2_f32_bf16 v196, v210, s94, v196
v_dot2_f32_bf16 v197, v210, s95, v197
v_accvgpr_read_b32 v211, a155
v_dot2_f32_bf16 v198, v211, s94, v198
v_dot2_f32_bf16 v199, v211, s95, v199
v_accvgpr_read_b32 v208, a156
v_dot2_f32_bf16 v192, v208, s94, v192
v_dot2_f32_bf16 v193, v208, s95, v193
v_accvgpr_read_b32 v209, a157
v_dot2_f32_bf16 v194, v209, s94, v194
v_dot2_f32_bf16 v195, v209, s95, v195
v_accvgpr_read_b32 v210, a158
v_dot2_f32_bf16 v196, v210, s94, v196
v_dot2_f32_bf16 v197, v210, s95, v197
v_accvgpr_read_b32 v211, a159
v_dot2_f32_bf16 v198, v211, s94, v198
v_dot2_f32_bf16 v199, v211, s95, v199
v_accvgpr_read_b32 v208, a160
v_dot2_f32_bf16 v192, v208, s94, v192
v_dot2_f32_bf16 v193, v208, s95, v193
v_accvgpr_read_b32 v209, a161
v_dot2_f32_bf16 v194, v209, s94, v194
v_dot2_f32_bf16 v195, v209, s95, v195
v_accvgpr_read_b32 v210, a162
v_dot2_f32_bf16 v196, v210, s94, v196
v_dot2_f32_bf16 v197, v210, s95, v197
v_accvgpr_read_b32 v211, a163
v_dot2_f32_bf16 v198, v211, s94, v198
v_dot2_f32_bf16 v199, v211, s95, v199
v_accvgpr_read_b32 v208, a164
v_dot2_f32_bf16 v192, v208, s94, v192
v_dot2_f32_bf16 v193, v208, s95, v193
v_accvgpr_read_b32 v209, a165
v_dot2_f32_bf16 v194, v209, s94, v194
v_dot2_f32_bf16 v195, v209, s95, v195
v_accvgpr_read_b32 v210, a166
v_dot2_f32_bf16 v196, v210, s94, v196
v_dot2_f32_bf16 v197, v210, s95, v197
v_accvgpr_read_b32 v211, a167
v_dot2_f32_bf16 v198, v211, s94, v198
v_dot2_f32_bf16 v199, v211, s95, v199
v_accvgpr_read_b32 v208, a168
v_dot2_f32_bf16 v192, v208, s94, v192
v_dot2_f32_bf16 v193, v208, s95, v193
v_accvgpr_read_b32 v209, a169
v_dot2_f32_bf16 v194, v209, s94, v194
v_dot2_f32_bf16 v195, v209, s95, v195
v_accvgpr_read_b32 v210, a170
v_dot2_f32_bf16 v196, v210, s94, v196
v_dot2_f32_bf16 v197, v210, s95, v197
v_accvgpr_read_b32 v211, a171
v_dot2_f32_bf16 v198, v211, s94, v198
v_dot2_f32_bf16 v199, v211, s95, v199
v_accvgpr_read_b32 v208, a172
v_dot2_f32_bf16 v192, v208, s94, v192
v_dot2_f32_bf16 v193, v208, s95, v193
v_accvgpr_read_b32 v209, a173
v_dot2_f32_bf16 v194, v209, s94, v194
v_dot2_f32_bf16 v195, v209, s95, v195
v_accvgpr_read_b32 v210, a174
v_dot2_f32_bf16 v196, v210, s94, v196
v_dot2_f32_bf16 v197, v210, s95, v197
v_accvgpr_read_b32 v211, a175
v_dot2_f32_bf16 v198, v211, s94, v198
v_dot2_f32_bf16 v199, v211, s95, v199
v_accvgpr_read_b32 v208, a176
v_dot2_f32_bf16 v200, v208, s94, 0
v_dot2_f32_bf16 v201, v208, s95, 0
v_accvgpr_read_b32 v209, a177
v_dot2_f32_bf16 v202, v209, s94, 0
v_dot2_f32_bf16 v203, v209, s95, 0
v_accvgpr_read_b32 v210, a178
v_dot2_f32_bf16 v204, v210, s94, 0
v_dot2_f32_bf16 v205, v210, s95, 0
v_accvgpr_read_b32 v211, a179
v_dot2_f32_bf16 v206, v211, s94, 0
v_dot2_f32_bf16 v207, v211, s95, 0
v_accvgpr_read_b32 v208, a180
v_dot2_f32_bf16 v200, v208, s94, v200
v_dot2_f32_bf16 v201, v208, s95, v201
v_accvgpr_read_b32 v209, a181
v_dot2_f32_bf16 v202, v209, s94, v202
v_dot2_f32_bf16 v203, v209, s95, v203
v_accvgpr_read_b32 v210, a182
v_dot2_f32_bf16 v204, v210, s94, v204
v_dot2_f32_bf16 v205, v210, s95, v205
v_accvgpr_read_b32 v211, a183
v_dot2_f32_bf16 v206, v211, s94, v206
v_dot2_f32_bf16 v207, v211, s95, v207
v_accvgpr_read_b32 v208, a184
v_dot2_f32_bf16 v200, v208, s94, v200
v_dot2_f32_bf16 v201, v208, s95, v201
v_accvgpr_read_b32 v209, a185
v_dot2_f32_bf16 v202, v209, s94, v202
v_dot2_f32_bf16 v203, v209, s95, v203
v_accvgpr_read_b32 v210, a186
v_dot2_f32_bf16 v204, v210, s94, v204
v_dot2_f32_bf16 v205, v210, s95, v205
v_accvgpr_read_b32 v211, a187
v_dot2_f32_bf16 v206, v211, s94, v206
v_dot2_f32_bf16 v207, v211, s95, v207
v_accvgpr_read_b32 v208, a188
v_dot2_f32_bf16 v200, v208, s94, v200
v_dot2_f32_bf16 v201, v208, s95, v201
v_accvgpr_read_b32 v209, a189
v_dot2_f32_bf16 v202, v209, s94, v202
v_dot2_f32_bf16 v203, v209, s95, v203
v_accvgpr_read_b32 v210, a190
v_dot2_f32_bf16 v204, v210, s94, v204
v_dot2_f32_bf16 v205, v210, s95, v205
v_accvgpr_read_b32 v211, a191
v_dot2_f32_bf16 v206, v211, s94, v206
v_dot2_f32_bf16 v207, v211, s95, v207
v_accvgpr_read_b32 v208, a192
v_dot2_f32_bf16 v200, v208, s94, v200
v_dot2_f32_bf16 v201, v208, s95, v201
v_accvgpr_read_b32 v209, a193
v_dot2_f32_bf16 v202, v209, s94, v202
v_dot2_f32_bf16 v203, v209, s95, v203
v_accvgpr_read_b32 v210, a194
v_dot2_f32_bf16 v204, v210, s94, v204
v_dot2_f32_bf16 v205, v210, s95, v205
v_accvgpr_read_b32 v211, a195
v_dot2_f32_bf16 v206, v211, s94, v206
v_dot2_f32_bf16 v207, v211, s95, v207
v_accvgpr_read_b32 v208, a196
v_dot2_f32_bf16 v200, v208, s94, v200
v_dot2_f32_bf16 v201, v208, s95, v201
v_accvgpr_read_b32 v209, a197
v_dot2_f32_bf16 v202, v209, s94, v202
v_dot2_f32_bf16 v203, v209, s95, v203
v_accvgpr_read_b32 v210, a198
v_dot2_f32_bf16 v204, v210, s94, v204
v_dot2_f32_bf16 v205, v210, s95, v205
v_accvgpr_read_b32 v211, a199
v_dot2_f32_bf16 v206, v211, s94, v206
v_dot2_f32_bf16 v207, v211, s95, v207
v_accvgpr_read_b32 v208, a200
v_dot2_f32_bf16 v200, v208, s94, v200
v_dot2_f32_bf16 v201, v208, s95, v201
v_accvgpr_read_b32 v209, a201
v_dot2_f32_bf16 v202, v209, s94, v202
v_dot2_f32_bf16 v203, v209, s95, v203
v_accvgpr_read_b32 v210, a202
v_dot2_f32_bf16 v204, v210, s94, v204
v_dot2_f32_bf16 v205, v210, s95, v205
v_accvgpr_read_b32 v211, a203
v_dot2_f32_bf16 v206, v211, s94, v206
v_dot2_f32_bf16 v207, v211, s95, v207
v_accvgpr_read_b32 v208, a204
v_dot2_f32_bf16 v200, v208, s94, v200
v_dot2_f32_bf16 v201, v208, s95, v201
v_accvgpr_read_b32 v209, a205
v_dot2_f32_bf16 v202, v209, s94, v202
v_dot2_f32_bf16 v203, v209, s95, v203
v_accvgpr_read_b32 v210, a206
v_dot2_f32_bf16 v204, v210, s94, v204
v_dot2_f32_bf16 v205, v210, s95, v205
v_accvgpr_read_b32 v211, a207
v_dot2_f32_bf16 v206, v211, s94, v206
v_dot2_f32_bf16 v207, v211, s95, v207
v_mul_f32 v208, 0xc0d22e3c, v200
v_mul_f32 v209, 0xc0d22e3c, v201
v_mul_f32 v210, 0xc0d22e3c, v202
v_mul_f32 v211, 0xc0d22e3c, v203
v_mul_f32 v212, 0xc0d22e3c, v204
v_mul_f32 v213, 0xc0d22e3c, v205
v_mul_f32 v214, 0xc0d22e3c, v206
v_mul_f32 v215, 0xc0d22e3c, v207
v_exp_f32 v208, v208
v_exp_f32 v209, v209
v_exp_f32 v210, v210
v_exp_f32 v211, v211
v_exp_f32 v212, v212
v_exp_f32 v213, v213
v_exp_f32 v214, v214
v_exp_f32 v215, v215
v_mul_f32 v192, v192, v200
v_mul_f32 v193, v193, v201
v_mul_f32 v194, v194, v202
v_mul_f32 v195, v195, v203
v_mul_f32 v196, v196, v204
v_mul_f32 v197, v197, v205
v_mul_f32 v198, v198, v206
v_mul_f32 v199, v199, v207
v_add_f32 v208, 1.0, v208
v_add_f32 v209, 1.0, v209
v_add_f32 v210, 1.0, v210
v_add_f32 v211, 1.0, v211
v_add_f32 v212, 1.0, v212
v_add_f32 v213, 1.0, v213
v_add_f32 v214, 1.0, v214
v_add_f32 v215, 1.0, v215
v_rcp_f32 v208, v208
v_rcp_f32 v209, v209
v_rcp_f32 v210, v210
v_rcp_f32 v211, v211
v_rcp_f32 v212, v212
v_rcp_f32 v213, v213
v_rcp_f32 v214, v214
v_rcp_f32 v215, v215
v_mul_f32 v192, 0x4091afa4, v192
v_mul_f32 v193, 0x4091afa4, v193
v_mul_f32 v194, 0x4091afa4, v194
v_mul_f32 v195, 0x4091afa4, v195
v_mul_f32 v196, 0x4091afa4, v196
v_mul_f32 v197, 0x4091afa4, v197
v_mul_f32 v198, 0x4091afa4, v198
v_mul_f32 v199, 0x4091afa4, v199
v_mul_f32 v192, v192, v208
v_mul_f32 v193, v193, v209
v_mul_f32 v194, v194, v210
v_mul_f32 v195, v195, v211
v_mul_f32 v196, v196, v212
v_mul_f32 v197, v197, v213
v_mul_f32 v198, v198, v214
v_mul_f32 v199, v199, v215
v_permlane32_swap_b32 v192, v196
v_permlane32_swap_b32 v193, v197
v_permlane32_swap_b32 v194, v198
v_permlane32_swap_b32 v195, v199
v_permlane16_swap_b32 v192, v196
v_permlane16_swap_b32 v193, v197
v_permlane16_swap_b32 v194, v198
v_permlane16_swap_b32 v195, v199
v_accvgpr_read_b32 v200, a240
v_accvgpr_read_b32 v201, a241
v_accvgpr_read_b32 v202, a242
v_accvgpr_read_b32 v203, a243
v_lshlrev_b32 v208, 16, v200
v_and_b32 v209, s46, v200
v_lshlrev_b32 v210, 16, v201
v_and_b32 v211, s46, v201
v_lshlrev_b32 v212, 16, v202
v_and_b32 v213, s46, v202
v_lshlrev_b32 v214, 16, v203
v_and_b32 v215, s46, v203
v_add_f32 v208, v208, v192
v_add_f32 v209, v209, v193
v_add_f32 v210, v210, v194
v_add_f32 v211, v211, v195
v_add_f32 v212, v212, v196
v_add_f32 v213, v213, v197
v_add_f32 v214, v214, v198
v_add_f32 v215, v215, v199
v_cvt_pk_bf16_f32 v204, v208, v209
v_cvt_pk_bf16_f32 v205, v210, v211
v_cvt_pk_bf16_f32 v206, v212, v213
v_cvt_pk_bf16_f32 v207, v214, v215
buffer_store_dwordx4 v[204:207], v217, s[60:63], 0 offen offset:0
s_waitcnt vmcnt(1)
v_dot2_f32_bf16 v192, v16, s94, 0
v_dot2_f32_bf16 v193, v16, s95, 0
v_dot2_f32_bf16 v194, v17, s94, 0
v_dot2_f32_bf16 v195, v17, s95, 0
v_dot2_f32_bf16 v196, v18, s94, 0
v_dot2_f32_bf16 v197, v18, s95, 0
v_dot2_f32_bf16 v198, v19, s94, 0
v_dot2_f32_bf16 v199, v19, s95, 0
v_dot2_f32_bf16 v192, v20, s94, v192
v_dot2_f32_bf16 v193, v20, s95, v193
v_dot2_f32_bf16 v194, v21, s94, v194
v_dot2_f32_bf16 v195, v21, s95, v195
v_dot2_f32_bf16 v196, v22, s94, v196
v_dot2_f32_bf16 v197, v22, s95, v197
v_dot2_f32_bf16 v198, v23, s94, v198
v_dot2_f32_bf16 v199, v23, s95, v199
v_dot2_f32_bf16 v192, v24, s94, v192
v_dot2_f32_bf16 v193, v24, s95, v193
v_dot2_f32_bf16 v194, v25, s94, v194
v_dot2_f32_bf16 v195, v25, s95, v195
v_dot2_f32_bf16 v196, v26, s94, v196
v_dot2_f32_bf16 v197, v26, s95, v197
v_dot2_f32_bf16 v198, v27, s94, v198
v_dot2_f32_bf16 v199, v27, s95, v199
v_dot2_f32_bf16 v192, v28, s94, v192
v_dot2_f32_bf16 v193, v28, s95, v193
v_dot2_f32_bf16 v194, v29, s94, v194
v_dot2_f32_bf16 v195, v29, s95, v195
v_dot2_f32_bf16 v196, v30, s94, v196
v_dot2_f32_bf16 v197, v30, s95, v197
v_dot2_f32_bf16 v198, v31, s94, v198
v_dot2_f32_bf16 v199, v31, s95, v199
v_dot2_f32_bf16 v192, v32, s94, v192
v_dot2_f32_bf16 v193, v32, s95, v193
v_dot2_f32_bf16 v194, v33, s94, v194
v_dot2_f32_bf16 v195, v33, s95, v195
v_dot2_f32_bf16 v196, v34, s94, v196
v_dot2_f32_bf16 v197, v34, s95, v197
v_dot2_f32_bf16 v198, v35, s94, v198
v_dot2_f32_bf16 v199, v35, s95, v199
v_dot2_f32_bf16 v192, v36, s94, v192
v_dot2_f32_bf16 v193, v36, s95, v193
v_dot2_f32_bf16 v194, v37, s94, v194
v_dot2_f32_bf16 v195, v37, s95, v195
v_dot2_f32_bf16 v196, v38, s94, v196
v_dot2_f32_bf16 v197, v38, s95, v197
v_dot2_f32_bf16 v198, v39, s94, v198
v_dot2_f32_bf16 v199, v39, s95, v199
v_dot2_f32_bf16 v192, v40, s94, v192
v_dot2_f32_bf16 v193, v40, s95, v193
v_dot2_f32_bf16 v194, v41, s94, v194
v_dot2_f32_bf16 v195, v41, s95, v195
v_dot2_f32_bf16 v196, v42, s94, v196
v_dot2_f32_bf16 v197, v42, s95, v197
v_dot2_f32_bf16 v198, v43, s94, v198
v_dot2_f32_bf16 v199, v43, s95, v199
v_dot2_f32_bf16 v192, v44, s94, v192
v_dot2_f32_bf16 v193, v44, s95, v193
v_dot2_f32_bf16 v194, v45, s94, v194
v_dot2_f32_bf16 v195, v45, s95, v195
v_dot2_f32_bf16 v196, v46, s94, v196
v_dot2_f32_bf16 v197, v46, s95, v197
v_dot2_f32_bf16 v198, v47, s94, v198
v_dot2_f32_bf16 v199, v47, s95, v199
v_dot2_f32_bf16 v200, v48, s94, 0
v_dot2_f32_bf16 v201, v48, s95, 0
v_dot2_f32_bf16 v202, v49, s94, 0
v_dot2_f32_bf16 v203, v49, s95, 0
v_dot2_f32_bf16 v204, v50, s94, 0
v_dot2_f32_bf16 v205, v50, s95, 0
v_dot2_f32_bf16 v206, v51, s94, 0
v_dot2_f32_bf16 v207, v51, s95, 0
v_dot2_f32_bf16 v200, v52, s94, v200
v_dot2_f32_bf16 v201, v52, s95, v201
v_dot2_f32_bf16 v202, v53, s94, v202
v_dot2_f32_bf16 v203, v53, s95, v203
v_dot2_f32_bf16 v204, v54, s94, v204
v_dot2_f32_bf16 v205, v54, s95, v205
v_dot2_f32_bf16 v206, v55, s94, v206
v_dot2_f32_bf16 v207, v55, s95, v207
v_dot2_f32_bf16 v200, v56, s94, v200
v_dot2_f32_bf16 v201, v56, s95, v201
v_dot2_f32_bf16 v202, v57, s94, v202
v_dot2_f32_bf16 v203, v57, s95, v203
v_dot2_f32_bf16 v204, v58, s94, v204
v_dot2_f32_bf16 v205, v58, s95, v205
v_dot2_f32_bf16 v206, v59, s94, v206
v_dot2_f32_bf16 v207, v59, s95, v207
v_dot2_f32_bf16 v200, v60, s94, v200
v_dot2_f32_bf16 v201, v60, s95, v201
v_dot2_f32_bf16 v202, v61, s94, v202
v_dot2_f32_bf16 v203, v61, s95, v203
v_dot2_f32_bf16 v204, v62, s94, v204
v_dot2_f32_bf16 v205, v62, s95, v205
v_dot2_f32_bf16 v206, v63, s94, v206
v_dot2_f32_bf16 v207, v63, s95, v207
v_dot2_f32_bf16 v200, v64, s94, v200
v_dot2_f32_bf16 v201, v64, s95, v201
v_dot2_f32_bf16 v202, v65, s94, v202
v_dot2_f32_bf16 v203, v65, s95, v203
v_dot2_f32_bf16 v204, v66, s94, v204
v_dot2_f32_bf16 v205, v66, s95, v205
v_dot2_f32_bf16 v206, v67, s94, v206
v_dot2_f32_bf16 v207, v67, s95, v207
v_dot2_f32_bf16 v200, v68, s94, v200
v_dot2_f32_bf16 v201, v68, s95, v201
v_dot2_f32_bf16 v202, v69, s94, v202
v_dot2_f32_bf16 v203, v69, s95, v203
v_dot2_f32_bf16 v204, v70, s94, v204
v_dot2_f32_bf16 v205, v70, s95, v205
v_dot2_f32_bf16 v206, v71, s94, v206
v_dot2_f32_bf16 v207, v71, s95, v207
v_dot2_f32_bf16 v200, v72, s94, v200
v_dot2_f32_bf16 v201, v72, s95, v201
v_dot2_f32_bf16 v202, v73, s94, v202
v_dot2_f32_bf16 v203, v73, s95, v203
v_dot2_f32_bf16 v204, v74, s94, v204
v_dot2_f32_bf16 v205, v74, s95, v205
v_dot2_f32_bf16 v206, v75, s94, v206
v_dot2_f32_bf16 v207, v75, s95, v207
v_dot2_f32_bf16 v200, v76, s94, v200
v_dot2_f32_bf16 v201, v76, s95, v201
v_dot2_f32_bf16 v202, v77, s94, v202
v_dot2_f32_bf16 v203, v77, s95, v203
v_dot2_f32_bf16 v204, v78, s94, v204
v_dot2_f32_bf16 v205, v78, s95, v205
v_dot2_f32_bf16 v206, v79, s94, v206
v_dot2_f32_bf16 v207, v79, s95, v207
v_mul_f32 v208, 0xc0d22e3c, v200
v_mul_f32 v209, 0xc0d22e3c, v201
v_mul_f32 v210, 0xc0d22e3c, v202
v_mul_f32 v211, 0xc0d22e3c, v203
v_mul_f32 v212, 0xc0d22e3c, v204
v_mul_f32 v213, 0xc0d22e3c, v205
v_mul_f32 v214, 0xc0d22e3c, v206
v_mul_f32 v215, 0xc0d22e3c, v207
v_exp_f32 v208, v208
v_exp_f32 v209, v209
v_exp_f32 v210, v210
v_exp_f32 v211, v211
v_exp_f32 v212, v212
v_exp_f32 v213, v213
v_exp_f32 v214, v214
v_exp_f32 v215, v215
v_mul_f32 v192, v192, v200
v_mul_f32 v193, v193, v201
v_mul_f32 v194, v194, v202
v_mul_f32 v195, v195, v203
v_mul_f32 v196, v196, v204
v_mul_f32 v197, v197, v205
v_mul_f32 v198, v198, v206
v_mul_f32 v199, v199, v207
v_add_f32 v208, 1.0, v208
v_add_f32 v209, 1.0, v209
v_add_f32 v210, 1.0, v210
v_add_f32 v211, 1.0, v211
v_add_f32 v212, 1.0, v212
v_add_f32 v213, 1.0, v213
v_add_f32 v214, 1.0, v214
v_add_f32 v215, 1.0, v215
v_rcp_f32 v208, v208
v_rcp_f32 v209, v209
v_rcp_f32 v210, v210
v_rcp_f32 v211, v211
v_rcp_f32 v212, v212
v_rcp_f32 v213, v213
v_rcp_f32 v214, v214
v_rcp_f32 v215, v215
v_mul_f32 v192, 0x4091afa4, v192
v_mul_f32 v193, 0x4091afa4, v193
v_mul_f32 v194, 0x4091afa4, v194
v_mul_f32 v195, 0x4091afa4, v195
v_mul_f32 v196, 0x4091afa4, v196
v_mul_f32 v197, 0x4091afa4, v197
v_mul_f32 v198, 0x4091afa4, v198
v_mul_f32 v199, 0x4091afa4, v199
v_mul_f32 v192, v192, v208
v_mul_f32 v193, v193, v209
v_mul_f32 v194, v194, v210
v_mul_f32 v195, v195, v211
v_mul_f32 v196, v196, v212
v_mul_f32 v197, v197, v213
v_mul_f32 v198, v198, v214
v_mul_f32 v199, v199, v215
v_permlane32_swap_b32 v192, v196
v_permlane32_swap_b32 v193, v197
v_permlane32_swap_b32 v194, v198
v_permlane32_swap_b32 v195, v199
v_permlane16_swap_b32 v192, v196
v_permlane16_swap_b32 v193, v197
v_permlane16_swap_b32 v194, v198
v_permlane16_swap_b32 v195, v199
v_lshlrev_b32 v208, 16, v80
v_and_b32 v209, s46, v80
v_lshlrev_b32 v210, 16, v81
v_and_b32 v211, s46, v81
v_lshlrev_b32 v212, 16, v82
v_and_b32 v213, s46, v82
v_lshlrev_b32 v214, 16, v83
v_and_b32 v215, s46, v83
v_add_f32 v208, v208, v192
v_add_f32 v209, v209, v193
v_add_f32 v210, v210, v194
v_add_f32 v211, v211, v195
v_add_f32 v212, v212, v196
v_add_f32 v213, v213, v197
v_add_f32 v214, v214, v198
v_add_f32 v215, v215, v199
v_cvt_pk_bf16_f32 v204, v208, v209
v_cvt_pk_bf16_f32 v205, v210, v211
v_cvt_pk_bf16_f32 v206, v212, v213
v_cvt_pk_bf16_f32 v207, v214, v215
buffer_store_dwordx4 v[204:207], v217, s[60:63], 0 offen offset:512
L_fin_ffn:
s_endpgm
L_ffn_end:
L_spin_ffn_cnt:
s_mov_b32 s85, 0x4e20
L_spin_ffn_cnt_l:
buffer_load_dword v219, v221, s[68:71], 0 offen offset:0 sc1
s_waitcnt vmcnt(0)
v_cmp_gt_u32 vcc, s101, v219
s_nop 4
s_cbranch_vccz L_spin_ffn_cnt_b
s_sleep 1
s_sub_u32 s85, s85, 1
s_cmp_lg_u32 s85, 0
s_cbranch_scc1 L_spin_ffn_cnt_l
s_branch L_spin_ffn_cnt_b
L_spin_ffn_r0:
s_mov_b32 s85, 0x4e20
L_spin_ffn_r0_l:
buffer_load_dword v219, v218, s[28:31], 0 offen offset:0 sc1
s_waitcnt vmcnt(0)
v_cmp_gt_u32 vcc, s101, v219
s_nop 4
s_cbranch_vccz L_spin_ffn_r0_b
s_sleep 1
s_sub_u32 s85, s85, 1
s_cmp_lg_u32 s85, 0
s_cbranch_scc1 L_spin_ffn_r0_l
s_branch L_spin_ffn_r0_b
L_spin_ffn_a:
s_mov_b32 s85, 0x4e20
L_spin_ffn_a_l:
buffer_load_dword v219, v223, s[28:31], 0 offen offset:0 sc1
s_waitcnt vmcnt(0)
v_cmp_gt_u32 vcc, s101, v219
s_nop 4
s_cbranch_vccz L_spin_ffn_a_b
s_sleep 1
s_sub_u32 s85, s85, 1
s_cmp_lg_u32 s85, 0
s_cbranch_scc1 L_spin_ffn_a_l
s_branch L_spin_ffn_a_b
L_tailB_ffn:
v_add_u32 v222, 0x1000, v216
buffer_load_dwordx4 v[16:19], v216, s[28:31], s56 offen offset:0 sc1
buffer_load_dwordx4 v[20:23], v216, s[28:31], s57 offen offset:0 sc1
buffer_load_dwordx4 v[24:27], v216, s[28:31], s58 offen offset:0 sc1
buffer_load_dwordx4 v[28:31], v216, s[28:31], s59 offen offset:0 sc1
buffer_load_dwordx4 v[32:35], v216, s[28:31], s64 offen offset:0 sc1
buffer_load_dwordx4 v[36:39], v216, s[28:31], s65 offen offset:0 sc1
buffer_load_dwordx4 v[40:43], v216, s[28:31], s66 offen offset:0 sc1
buffer_load_dwordx4 v[44:47], v216, s[28:31], s67 offen offset:0 sc1
buffer_load_dwordx4 v[48:51], v216, s[28:31], s72 offen offset:0 sc1
buffer_load_dwordx4 v[52:55], v216, s[28:31], s73 offen offset:0 sc1
buffer_load_dwordx4 v[56:59], v216, s[28:31], s74 offen offset:0 sc1
buffer_load_dwordx4 v[60:63], v216, s[28:31], s75 offen offset:0 sc1
buffer_load_dwordx4 v[64:67], v216, s[28:31], s88 offen offset:0 sc1
buffer_load_dwordx4 v[68:71], v216, s[28:31], s89 offen offset:0 sc1
buffer_load_dwordx4 v[72:75], v216, s[28:31], s90 offen offset:0 sc1
buffer_load_dwordx4 v[76:79], v216, s[28:31], s91 offen offset:0 sc1
buffer_load_dwordx4 v[80:83], v217, s[4:7], 0 offen offset:512
buffer_load_dwordx4 v[84:87], v222, s[28:31], s56 offen offset:0 sc1
buffer_load_dwordx4 v[88:91], v222, s[28:31], s57 offen offset:0 sc1
buffer_load_dwordx4 v[92:95], v222, s[28:31], s58 offen offset:0 sc1
buffer_load_dwordx4 v[96:99], v222, s[28:31], s59 offen offset:0 sc1
buffer_load_dwordx4 v[100:103], v222, s[28:31], s64 offen offset:0 sc1
buffer_load_dwordx4 v[104:107], v222, s[28:31], s65 offen offset:0 sc1
buffer_load_dwordx4 v[108:111], v222, s[28:31], s66 offen offset:0 sc1
buffer_load_dwordx4 v[112:115], v222, s[28:31], s67 offen offset:0 sc1
buffer_load_dwordx4 v[116:119], v222, s[28:31], s72 offen offset:0 sc1
buffer_load_dwordx4 v[120:123], v222, s[28:31], s73 offen offset:0 sc1
buffer_load_dwordx4 v[124:127], v222, s[28:31], s74 offen offset:0 sc1
buffer_load_dwordx4 v[128:131], v222, s[28:31], s75 offen offset:0 sc1
buffer_load_dwordx4 v[132:135], v222, s[28:31], s88 offen offset:0 sc1
buffer_load_dwordx4 v[136:139], v222, s[28:31], s89 offen offset:0 sc1
buffer_load_dwordx4 v[140:143], v222, s[28:31], s90 offen offset:0 sc1
buffer_load_dwordx4 v[144:147], v222, s[28:31], s91 offen offset:0 sc1
buffer_load_dwordx4 v[148:151], v217, s[4:7], 0 offen offset:640
s_waitcnt vmcnt(34)
v_accvgpr_read_b32 v208, a144
v_dot2_f32_bf16 v192, v208, s94, 0
v_dot2_f32_bf16 v193, v208, s95, 0
v_accvgpr_read_b32 v209, a145
v_dot2_f32_bf16 v194, v209, s94, 0
v_dot2_f32_bf16 v195, v209, s95, 0
v_accvgpr_read_b32 v210, a146
v_dot2_f32_bf16 v196, v210, s94, 0
v_dot2_f32_bf16 v197, v210, s95, 0
v_accvgpr_read_b32 v211, a147
v_dot2_f32_bf16 v198, v211, s94, 0
v_dot2_f32_bf16 v199, v211, s95, 0
v_accvgpr_read_b32 v208, a148
v_dot2_f32_bf16 v192, v208, s94, v192
v_dot2_f32_bf16 v193, v208, s95, v193
v_accvgpr_read_b32 v209, a149
v_dot2_f32_bf16 v194, v209, s94, v194
v_dot2_f32_bf16 v195, v209, s95, v195
v_accvgpr_read_b32 v210, a150
v_dot2_f32_bf16 v196, v210, s94, v196
v_dot2_f32_bf16 v197, v210, s95, v197
v_accvgpr_read_b32 v211, a151
v_dot2_f32_bf16 v198, v211, s94, v198
v_dot2_f32_bf16 v199, v211, s95, v199
v_accvgpr_read_b32 v208, a152
v_dot2_f32_bf16 v192, v208, s94, v192
v_dot2_f32_bf16 v193, v208, s95, v193
v_accvgpr_read_b32 v209, a153
v_dot2_f32_bf16 v194, v209, s94, v194
v_dot2_f32_bf16 v195, v209, s95, v195
v_accvgpr_read_b32 v210, a154
v_dot2_f32_bf16 v196, v210, s94, v196
v_dot2_f32_bf16 v197, v210, s95, v197
v_accvgpr_read_b32 v211, a155
v_dot2_f32_bf16 v198, v211, s94, v198
v_dot2_f32_bf16 v199, v211, s95, v199
v_accvgpr_read_b32 v208, a156
v_dot2_f32_bf16 v192, v208, s94, v192
v_dot2_f32_bf16 v193, v208, s95, v193
v_accvgpr_read_b32 v209, a157
v_dot2_f32_bf16 v194, v209, s94, v194
v_dot2_f32_bf16 v195, v209, s95, v195
v_accvgpr_read_b32 v210, a158
v_dot2_f32_bf16 v196, v210, s94, v196
v_dot2_f32_bf16 v197, v210, s95, v197
v_accvgpr_read_b32 v211, a159
v_dot2_f32_bf16 v198, v211, s94, v198
v_dot2_f32_bf16 v199, v211, s95, v199
v_accvgpr_read_b32 v208, a160
v_dot2_f32_bf16 v192, v208, s94, v192
v_dot2_f32_bf16 v193, v208, s95, v193
v_accvgpr_read_b32 v209, a161
v_dot2_f32_bf16 v194, v209, s94, v194
v_dot2_f32_bf16 v195, v209, s95, v195
v_accvgpr_read_b32 v210, a162
v_dot2_f32_bf16 v196, v210, s94, v196
v_dot2_f32_bf16 v197, v210, s95, v197
v_accvgpr_read_b32 v211, a163
v_dot2_f32_bf16 v198, v211, s94, v198
v_dot2_f32_bf16 v199, v211, s95, v199
v_accvgpr_read_b32 v208, a164
v_dot2_f32_bf16 v192, v208, s94, v192
v_dot2_f32_bf16 v193, v208, s95, v193
v_accvgpr_read_b32 v209, a165
v_dot2_f32_bf16 v194, v209, s94, v194
v_dot2_f32_bf16 v195, v209, s95, v195
v_accvgpr_read_b32 v210, a166
v_dot2_f32_bf16 v196, v210, s94, v196
v_dot2_f32_bf16 v197, v210, s95, v197
v_accvgpr_read_b32 v211, a167
v_dot2_f32_bf16 v198, v211, s94, v198
v_dot2_f32_bf16 v199, v211, s95, v199
v_accvgpr_read_b32 v208, a168
v_dot2_f32_bf16 v192, v208, s94, v192
v_dot2_f32_bf16 v193, v208, s95, v193
v_accvgpr_read_b32 v209, a169
v_dot2_f32_bf16 v194, v209, s94, v194
v_dot2_f32_bf16 v195, v209, s95, v195
v_accvgpr_read_b32 v210, a170
v_dot2_f32_bf16 v196, v210, s94, v196
v_dot2_f32_bf16 v197, v210, s95, v197
v_accvgpr_read_b32 v211, a171
v_dot2_f32_bf16 v198, v211, s94, v198
v_dot2_f32_bf16 v199, v211, s95, v199
v_accvgpr_read_b32 v208, a172
v_dot2_f32_bf16 v192, v208, s94, v192
v_dot2_f32_bf16 v193, v208, s95, v193
v_accvgpr_read_b32 v209, a173
v_dot2_f32_bf16 v194, v209, s94, v194
v_dot2_f32_bf16 v195, v209, s95, v195
v_accvgpr_read_b32 v210, a174
v_dot2_f32_bf16 v196, v210, s94, v196
v_dot2_f32_bf16 v197, v210, s95, v197
v_accvgpr_read_b32 v211, a175
v_dot2_f32_bf16 v198, v211, s94, v198
v_dot2_f32_bf16 v199, v211, s95, v199
v_accvgpr_read_b32 v208, a176
v_dot2_f32_bf16 v200, v208, s94, 0
v_dot2_f32_bf16 v201, v208, s95, 0
v_accvgpr_read_b32 v209, a177
v_dot2_f32_bf16 v202, v209, s94, 0
v_dot2_f32_bf16 v203, v209, s95, 0
v_accvgpr_read_b32 v210, a178
v_dot2_f32_bf16 v204, v210, s94, 0
v_dot2_f32_bf16 v205, v210, s95, 0
v_accvgpr_read_b32 v211, a179
v_dot2_f32_bf16 v206, v211, s94, 0
v_dot2_f32_bf16 v207, v211, s95, 0
v_accvgpr_read_b32 v208, a180
v_dot2_f32_bf16 v200, v208, s94, v200
v_dot2_f32_bf16 v201, v208, s95, v201
v_accvgpr_read_b32 v209, a181
v_dot2_f32_bf16 v202, v209, s94, v202
v_dot2_f32_bf16 v203, v209, s95, v203
v_accvgpr_read_b32 v210, a182
v_dot2_f32_bf16 v204, v210, s94, v204
v_dot2_f32_bf16 v205, v210, s95, v205
v_accvgpr_read_b32 v211, a183
v_dot2_f32_bf16 v206, v211, s94, v206
v_dot2_f32_bf16 v207, v211, s95, v207
v_accvgpr_read_b32 v208, a184
v_dot2_f32_bf16 v200, v208, s94, v200
v_dot2_f32_bf16 v201, v208, s95, v201
v_accvgpr_read_b32 v209, a185
v_dot2_f32_bf16 v202, v209, s94, v202
v_dot2_f32_bf16 v203, v209, s95, v203
v_accvgpr_read_b32 v210, a186
v_dot2_f32_bf16 v204, v210, s94, v204
v_dot2_f32_bf16 v205, v210, s95, v205
v_accvgpr_read_b32 v211, a187
v_dot2_f32_bf16 v206, v211, s94, v206
v_dot2_f32_bf16 v207, v211, s95, v207
v_accvgpr_read_b32 v208, a188
v_dot2_f32_bf16 v200, v208, s94, v200
v_dot2_f32_bf16 v201, v208, s95, v201
v_accvgpr_read_b32 v209, a189
v_dot2_f32_bf16 v202, v209, s94, v202
v_dot2_f32_bf16 v203, v209, s95, v203
v_accvgpr_read_b32 v210, a190
v_dot2_f32_bf16 v204, v210, s94, v204
v_dot2_f32_bf16 v205, v210, s95, v205
v_accvgpr_read_b32 v211, a191
v_dot2_f32_bf16 v206, v211, s94, v206
v_dot2_f32_bf16 v207, v211, s95, v207
v_accvgpr_read_b32 v208, a192
v_dot2_f32_bf16 v200, v208, s94, v200
v_dot2_f32_bf16 v201, v208, s95, v201
v_accvgpr_read_b32 v209, a193
v_dot2_f32_bf16 v202, v209, s94, v202
v_dot2_f32_bf16 v203, v209, s95, v203
v_accvgpr_read_b32 v210, a194
v_dot2_f32_bf16 v204, v210, s94, v204
v_dot2_f32_bf16 v205, v210, s95, v205
v_accvgpr_read_b32 v211, a195
v_dot2_f32_bf16 v206, v211, s94, v206
v_dot2_f32_bf16 v207, v211, s95, v207
v_accvgpr_read_b32 v208, a196
v_dot2_f32_bf16 v200, v208, s94, v200
v_dot2_f32_bf16 v201, v208, s95, v201
v_accvgpr_read_b32 v209, a197
v_dot2_f32_bf16 v202, v209, s94, v202
v_dot2_f32_bf16 v203, v209, s95, v203
v_accvgpr_read_b32 v210, a198
v_dot2_f32_bf16 v204, v210, s94, v204
v_dot2_f32_bf16 v205, v210, s95, v205
v_accvgpr_read_b32 v211, a199
v_dot2_f32_bf16 v206, v211, s94, v206
v_dot2_f32_bf16 v207, v211, s95, v207
v_accvgpr_read_b32 v208, a200
v_dot2_f32_bf16 v200, v208, s94, v200
v_dot2_f32_bf16 v201, v208, s95, v201
v_accvgpr_read_b32 v209, a201
v_dot2_f32_bf16 v202, v209, s94, v202
v_dot2_f32_bf16 v203, v209, s95, v203
v_accvgpr_read_b32 v210, a202
v_dot2_f32_bf16 v204, v210, s94, v204
v_dot2_f32_bf16 v205, v210, s95, v205
v_accvgpr_read_b32 v211, a203
v_dot2_f32_bf16 v206, v211, s94, v206
v_dot2_f32_bf16 v207, v211, s95, v207
v_accvgpr_read_b32 v208, a204
v_dot2_f32_bf16 v200, v208, s94, v200
v_dot2_f32_bf16 v201, v208, s95, v201
v_accvgpr_read_b32 v209, a205
v_dot2_f32_bf16 v202, v209, s94, v202
v_dot2_f32_bf16 v203, v209, s95, v203
v_accvgpr_read_b32 v210, a206
v_dot2_f32_bf16 v204, v210, s94, v204
v_dot2_f32_bf16 v205, v210, s95, v205
v_accvgpr_read_b32 v211, a207
v_dot2_f32_bf16 v206, v211, s94, v206
v_dot2_f32_bf16 v207, v211, s95, v207
v_mul_f32 v208, 0xc0d22e3c, v200
v_mul_f32 v209, 0xc0d22e3c, v201
v_mul_f32 v210, 0xc0d22e3c, v202
v_mul_f32 v211, 0xc0d22e3c, v203
v_mul_f32 v212, 0xc0d22e3c, v204
v_mul_f32 v213, 0xc0d22e3c, v205
v_mul_f32 v214, 0xc0d22e3c, v206
v_mul_f32 v215, 0xc0d22e3c, v207
v_exp_f32 v208, v208
v_exp_f32 v209, v209
v_exp_f32 v210, v210
v_exp_f32 v211, v211
v_exp_f32 v212, v212
v_exp_f32 v213, v213
v_exp_f32 v214, v214
v_exp_f32 v215, v215
v_mul_f32 v192, v192, v200
v_mul_f32 v193, v193, v201
v_mul_f32 v194, v194, v202
v_mul_f32 v195, v195, v203
v_mul_f32 v196, v196, v204
v_mul_f32 v197, v197, v205
v_mul_f32 v198, v198, v206
v_mul_f32 v199, v199, v207
v_add_f32 v208, 1.0, v208
v_add_f32 v209, 1.0, v209
v_add_f32 v210, 1.0, v210
v_add_f32 v211, 1.0, v211
v_add_f32 v212, 1.0, v212
v_add_f32 v213, 1.0, v213
v_add_f32 v214, 1.0, v214
v_add_f32 v215, 1.0, v215
v_rcp_f32 v208, v208
v_rcp_f32 v209, v209
v_rcp_f32 v210, v210
v_rcp_f32 v211, v211
v_rcp_f32 v212, v212
v_rcp_f32 v213, v213
v_rcp_f32 v214, v214
v_rcp_f32 v215, v215
v_mul_f32 v192, 0x4091afa4, v192
v_mul_f32 v193, 0x4091afa4, v193
v_mul_f32 v194, 0x4091afa4, v194
v_mul_f32 v195, 0x4091afa4, v195
v_mul_f32 v196, 0x4091afa4, v196
v_mul_f32 v197, 0x4091afa4, v197
v_mul_f32 v198, 0x4091afa4, v198
v_mul_f32 v199, 0x4091afa4, v199
v_mul_f32 v192, v192, v208
v_mul_f32 v193, v193, v209
v_mul_f32 v194, v194, v210
v_mul_f32 v195, v195, v211
v_mul_f32 v196, v196, v212
v_mul_f32 v197, v197, v213
v_mul_f32 v198, v198, v214
v_mul_f32 v199, v199, v215
v_permlane32_swap_b32 v192, v196
v_permlane32_swap_b32 v193, v197
v_permlane32_swap_b32 v194, v198
v_permlane32_swap_b32 v195, v199
v_permlane16_swap_b32 v192, v196
v_permlane16_swap_b32 v193, v197
v_permlane16_swap_b32 v194, v198
v_permlane16_swap_b32 v195, v199
v_accvgpr_read_b32 v200, a240
v_accvgpr_read_b32 v201, a241
v_accvgpr_read_b32 v202, a242
v_accvgpr_read_b32 v203, a243
v_lshlrev_b32 v208, 16, v200
v_and_b32 v209, s46, v200
v_lshlrev_b32 v210, 16, v201
v_and_b32 v211, s46, v201
v_lshlrev_b32 v212, 16, v202
v_and_b32 v213, s46, v202
v_lshlrev_b32 v214, 16, v203
v_and_b32 v215, s46, v203
v_add_f32 v208, v208, v192
v_add_f32 v209, v209, v193
v_add_f32 v210, v210, v194
v_add_f32 v211, v211, v195
v_add_f32 v212, v212, v196
v_add_f32 v213, v213, v197
v_add_f32 v214, v214, v198
v_add_f32 v215, v215, v199
v_cvt_pk_bf16_f32 v204, v208, v209
v_cvt_pk_bf16_f32 v205, v210, v211
v_cvt_pk_bf16_f32 v206, v212, v213
v_cvt_pk_bf16_f32 v207, v214, v215
buffer_store_dwordx4 v[204:207], v217, s[60:63], 0 offen offset:0
s_waitcnt vmcnt(18)
v_max3_u32 v208, v16, v17, v18
v_max3_u32 v208, v208, v19, v20
v_max3_u32 v208, v208, v21, v22
v_max3_u32 v208, v208, v23, v24
v_max3_u32 v208, v208, v25, v26
v_max3_u32 v208, v208, v27, v28
v_max3_u32 v208, v208, v29, v30
v_max3_u32 v208, v208, v31, v32
v_max3_u32 v208, v208, v33, v34
v_max3_u32 v208, v208, v35, v36
v_max3_u32 v208, v208, v37, v38
v_max3_u32 v208, v208, v39, v40
v_max3_u32 v208, v208, v41, v42
v_max3_u32 v208, v208, v43, v44
v_max3_u32 v208, v208, v45, v46
v_max3_u32 v208, v208, v47, v48
v_max3_u32 v208, v208, v49, v50
v_max3_u32 v208, v208, v51, v52
v_max3_u32 v208, v208, v53, v54
v_max3_u32 v208, v208, v55, v56
v_max3_u32 v208, v208, v57, v58
v_max3_u32 v208, v208, v59, v60
v_max3_u32 v208, v208, v61, v62
v_max3_u32 v208, v208, v63, v64
v_max3_u32 v208, v208, v65, v66
v_max3_u32 v208, v208, v67, v68
v_max3_u32 v208, v208, v69, v70
v_max3_u32 v208, v208, v71, v72
v_max3_u32 v208, v208, v73, v74
v_max3_u32 v208, v208, v75, v76
v_max3_u32 v208, v208, v77, v78
v_max_u32 v208, v208, v79
v_cmp_eq_u32 vcc, -1, v208
s_nop 4
s_cbranch_vccz L_ver_ffn_7_ok2
buffer_load_dwordx4 v[16:19], v216, s[28:31], s56 offen offset:0 sc1
buffer_load_dwordx4 v[20:23], v216, s[28:31], s57 offen offset:0 sc1
buffer_load_dwordx4 v[24:27], v216, s[28:31], s58 offen offset:0 sc1
buffer_load_dwordx4 v[28:31], v216, s[28:31], s59 offen offset:0 sc1
buffer_load_dwordx4 v[32:35], v216, s[28:31], s64 offen offset:0 sc1
buffer_load_dwordx4 v[36:39], v216, s[28:31], s65 offen offset:0 sc1
buffer_load_dwordx4 v[40:43], v216, s[28:31], s66 offen offset:0 sc1
buffer_load_dwordx4 v[44:47], v216, s[28:31], s67 offen offset:0 sc1
buffer_load_dwordx4 v[48:51], v216, s[28:31], s72 offen offset:0 sc1
buffer_load_dwordx4 v[52:55], v216, s[28:31], s73 offen offset:0 sc1
buffer_load_dwordx4 v[56:59], v216, s[28:31], s74 offen offset:0 sc1
buffer_load_dwordx4 v[60:63], v216, s[28:31], s75 offen offset:0 sc1
buffer_load_dwordx4 v[64:67], v216, s[28:31], s88 offen offset:0 sc1
buffer_load_dwordx4 v[68:71], v216, s[28:31], s89 offen offset:0 sc1
buffer_load_dwordx4 v[72:75], v216, s[28:31], s90 offen offset:0 sc1
buffer_load_dwordx4 v[76:79], v216, s[28:31], s91 offen offset:0 sc1
s_mov_b32 s85, 0x1388
L_ver_ffn_7:
s_waitcnt vmcnt(0)
v_max3_u32 v208, v16, v17, v18
v_max3_u32 v208, v208, v19, v20
v_max3_u32 v208, v208, v21, v22
v_max3_u32 v208, v208, v23, v24
v_max3_u32 v208, v208, v25, v26
v_max3_u32 v208, v208, v27, v28
v_max3_u32 v208, v208, v29, v30
v_max3_u32 v208, v208, v31, v32
v_max3_u32 v208, v208, v33, v34
v_max3_u32 v208, v208, v35, v36
v_max3_u32 v208, v208, v37, v38
v_max3_u32 v208, v208, v39, v40
v_max3_u32 v208, v208, v41, v42
v_max3_u32 v208, v208, v43, v44
v_max3_u32 v208, v208, v45, v46
v_max3_u32 v208, v208, v47, v48
v_max3_u32 v208, v208, v49, v50
v_max3_u32 v208, v208, v51, v52
v_max3_u32 v208, v208, v53, v54
v_max3_u32 v208, v208, v55, v56
v_max3_u32 v208, v208, v57, v58
v_max3_u32 v208, v208, v59, v60
v_max3_u32 v208, v208, v61, v62
v_max3_u32 v208, v208, v63, v64
v_max3_u32 v208, v208, v65, v66
v_max3_u32 v208, v208, v67, v68
v_max3_u32 v208, v208, v69, v70
v_max3_u32 v208, v208, v71, v72
v_max3_u32 v208, v208, v73, v74
v_max3_u32 v208, v208, v75, v76
v_max3_u32 v208, v208, v77, v78
v_max_u32 v208, v208, v79
v_cmp_eq_u32 vcc, -1, v208
s_nop 4
s_cbranch_vccz L_ver_ffn_7_ok
s_sub_u32 s85, s85, 1
s_cmp_eq_u32 s85, 0
s_cbranch_scc1 L_ver_ffn_7_ok
s_sleep 2
buffer_load_dwordx4 v[16:19], v216, s[28:31], s56 offen offset:0 sc1
buffer_load_dwordx4 v[20:23], v216, s[28:31], s57 offen offset:0 sc1
buffer_load_dwordx4 v[24:27], v216, s[28:31], s58 offen offset:0 sc1
buffer_load_dwordx4 v[28:31], v216, s[28:31], s59 offen offset:0 sc1
buffer_load_dwordx4 v[32:35], v216, s[28:31], s64 offen offset:0 sc1
buffer_load_dwordx4 v[36:39], v216, s[28:31], s65 offen offset:0 sc1
buffer_load_dwordx4 v[40:43], v216, s[28:31], s66 offen offset:0 sc1
buffer_load_dwordx4 v[44:47], v216, s[28:31], s67 offen offset:0 sc1
buffer_load_dwordx4 v[48:51], v216, s[28:31], s72 offen offset:0 sc1
buffer_load_dwordx4 v[52:55], v216, s[28:31], s73 offen offset:0 sc1
buffer_load_dwordx4 v[56:59], v216, s[28:31], s74 offen offset:0 sc1
buffer_load_dwordx4 v[60:63], v216, s[28:31], s75 offen offset:0 sc1
buffer_load_dwordx4 v[64:67], v216, s[28:31], s88 offen offset:0 sc1
buffer_load_dwordx4 v[68:71], v216, s[28:31], s89 offen offset:0 sc1
buffer_load_dwordx4 v[72:75], v216, s[28:31], s90 offen offset:0 sc1
buffer_load_dwordx4 v[76:79], v216, s[28:31], s91 offen offset:0 sc1
s_branch L_ver_ffn_7
L_ver_ffn_7_ok:
L_ver_ffn_7_ok2:
s_waitcnt vmcnt(1)
v_max3_u32 v208, v84, v85, v86
v_max3_u32 v208, v208, v87, v88
v_max3_u32 v208, v208, v89, v90
v_max3_u32 v208, v208, v91, v92
v_max3_u32 v208, v208, v93, v94
v_max3_u32 v208, v208, v95, v96
v_max3_u32 v208, v208, v97, v98
v_max3_u32 v208, v208, v99, v100
v_max3_u32 v208, v208, v101, v102
v_max3_u32 v208, v208, v103, v104
v_max3_u32 v208, v208, v105, v106
v_max3_u32 v208, v208, v107, v108
v_max3_u32 v208, v208, v109, v110
v_max3_u32 v208, v208, v111, v112
v_max3_u32 v208, v208, v113, v114
v_max3_u32 v208, v208, v115, v116
v_max3_u32 v208, v208, v117, v118
v_max3_u32 v208, v208, v119, v120
v_max3_u32 v208, v208, v121, v122
v_max3_u32 v208, v208, v123, v124
v_max3_u32 v208, v208, v125, v126
v_max3_u32 v208, v208, v127, v128
v_max3_u32 v208, v208, v129, v130
v_max3_u32 v208, v208, v131, v132
v_max3_u32 v208, v208, v133, v134
v_max3_u32 v208, v208, v135, v136
v_max3_u32 v208, v208, v137, v138
v_max3_u32 v208, v208, v139, v140
v_max3_u32 v208, v208, v141, v142
v_max3_u32 v208, v208, v143, v144
v_max3_u32 v208, v208, v145, v146
v_max_u32 v208, v208, v147
v_cmp_eq_u32 vcc, -1, v208
s_nop 4
s_cbranch_vccz L_ver_ffn_8_first
buffer_load_dwordx4 v[84:87], v222, s[28:31], s56 offen offset:0 sc1
buffer_load_dwordx4 v[88:91], v222, s[28:31], s57 offen offset:0 sc1
buffer_load_dwordx4 v[92:95], v222, s[28:31], s58 offen offset:0 sc1
buffer_load_dwordx4 v[96:99], v222, s[28:31], s59 offen offset:0 sc1
buffer_load_dwordx4 v[100:103], v222, s[28:31], s64 offen offset:0 sc1
buffer_load_dwordx4 v[104:107], v222, s[28:31], s65 offen offset:0 sc1
buffer_load_dwordx4 v[108:111], v222, s[28:31], s66 offen offset:0 sc1
buffer_load_dwordx4 v[112:115], v222, s[28:31], s67 offen offset:0 sc1
buffer_load_dwordx4 v[116:119], v222, s[28:31], s72 offen offset:0 sc1
buffer_load_dwordx4 v[120:123], v222, s[28:31], s73 offen offset:0 sc1
buffer_load_dwordx4 v[124:127], v222, s[28:31], s74 offen offset:0 sc1
buffer_load_dwordx4 v[128:131], v222, s[28:31], s75 offen offset:0 sc1
buffer_load_dwordx4 v[132:135], v222, s[28:31], s88 offen offset:0 sc1
buffer_load_dwordx4 v[136:139], v222, s[28:31], s89 offen offset:0 sc1
buffer_load_dwordx4 v[140:143], v222, s[28:31], s90 offen offset:0 sc1
buffer_load_dwordx4 v[144:147], v222, s[28:31], s91 offen offset:0 sc1
L_ver_ffn_8_first:
v_dot2_f32_bf16 v192, v16, s94, 0
v_dot2_f32_bf16 v193, v16, s95, 0
v_dot2_f32_bf16 v194, v17, s94, 0
v_dot2_f32_bf16 v195, v17, s95, 0
v_dot2_f32_bf16 v196, v18, s94, 0
v_dot2_f32_bf16 v197, v18, s95, 0
v_dot2_f32_bf16 v198, v19, s94, 0
v_dot2_f32_bf16 v199, v19, s95, 0
v_dot2_f32_bf16 v192, v20, s94, v192
v_dot2_f32_bf16 v193, v20, s95, v193
v_dot2_f32_bf16 v194, v21, s94, v194
v_dot2_f32_bf16 v195, v21, s95, v195
v_dot2_f32_bf16 v196, v22, s94, v196
v_dot2_f32_bf16 v197, v22, s95, v197
v_dot2_f32_bf16 v198, v23, s94, v198
v_dot2_f32_bf16 v199, v23, s95, v199
v_dot2_f32_bf16 v192, v24, s94, v192
v_dot2_f32_bf16 v193, v24, s95, v193
v_dot2_f32_bf16 v194, v25, s94, v194
v_dot2_f32_bf16 v195, v25, s95, v195
v_dot2_f32_bf16 v196, v26, s94, v196
v_dot2_f32_bf16 v197, v26, s95, v197
v_dot2_f32_bf16 v198, v27, s94, v198
v_dot2_f32_bf16 v199, v27, s95, v199
v_dot2_f32_bf16 v192, v28, s94, v192
v_dot2_f32_bf16 v193, v28, s95, v193
v_dot2_f32_bf16 v194, v29, s94, v194
v_dot2_f32_bf16 v195, v29, s95, v195
v_dot2_f32_bf16 v196, v30, s94, v196
v_dot2_f32_bf16 v197, v30, s95, v197
v_dot2_f32_bf16 v198, v31, s94, v198
v_dot2_f32_bf16 v199, v31, s95, v199
v_dot2_f32_bf16 v192, v32, s94, v192
v_dot2_f32_bf16 v193, v32, s95, v193
v_dot2_f32_bf16 v194, v33, s94, v194
v_dot2_f32_bf16 v195, v33, s95, v195
v_dot2_f32_bf16 v196, v34, s94, v196
v_dot2_f32_bf16 v197, v34, s95, v197
v_dot2_f32_bf16 v198, v35, s94, v198
v_dot2_f32_bf16 v199, v35, s95, v199
v_dot2_f32_bf16 v192, v36, s94, v192
v_dot2_f32_bf16 v193, v36, s95, v193
v_dot2_f32_bf16 v194, v37, s94, v194
v_dot2_f32_bf16 v195, v37, s95, v195
v_dot2_f32_bf16 v196, v38, s94, v196
v_dot2_f32_bf16 v197, v38, s95, v197
v_dot2_f32_bf16 v198, v39, s94, v198
v_dot2_f32_bf16 v199, v39, s95, v199
v_dot2_f32_bf16 v192, v40, s94, v192
v_dot2_f32_bf16 v193, v40, s95, v193
v_dot2_f32_bf16 v194, v41, s94, v194
v_dot2_f32_bf16 v195, v41, s95, v195
v_dot2_f32_bf16 v196, v42, s94, v196
v_dot2_f32_bf16 v197, v42, s95, v197
v_dot2_f32_bf16 v198, v43, s94, v198
v_dot2_f32_bf16 v199, v43, s95, v199
v_dot2_f32_bf16 v192, v44, s94, v192
v_dot2_f32_bf16 v193, v44, s95, v193
v_dot2_f32_bf16 v194, v45, s94, v194
v_dot2_f32_bf16 v195, v45, s95, v195
v_dot2_f32_bf16 v196, v46, s94, v196
v_dot2_f32_bf16 v197, v46, s95, v197
v_dot2_f32_bf16 v198, v47, s94, v198
v_dot2_f32_bf16 v199, v47, s95, v199
v_dot2_f32_bf16 v200, v48, s94, 0
v_dot2_f32_bf16 v201, v48, s95, 0
v_dot2_f32_bf16 v202, v49, s94, 0
v_dot2_f32_bf16 v203, v49, s95, 0
v_dot2_f32_bf16 v204, v50, s94, 0
v_dot2_f32_bf16 v205, v50, s95, 0
v_dot2_f32_bf16 v206, v51, s94, 0
v_dot2_f32_bf16 v207, v51, s95, 0
v_dot2_f32_bf16 v200, v52, s94, v200
v_dot2_f32_bf16 v201, v52, s95, v201
v_dot2_f32_bf16 v202, v53, s94, v202
v_dot2_f32_bf16 v203, v53, s95, v203
v_dot2_f32_bf16 v204, v54, s94, v204
v_dot2_f32_bf16 v205, v54, s95, v205
v_dot2_f32_bf16 v206, v55, s94, v206
v_dot2_f32_bf16 v207, v55, s95, v207
v_dot2_f32_bf16 v200, v56, s94, v200
v_dot2_f32_bf16 v201, v56, s95, v201
v_dot2_f32_bf16 v202, v57, s94, v202
v_dot2_f32_bf16 v203, v57, s95, v203
v_dot2_f32_bf16 v204, v58, s94, v204
v_dot2_f32_bf16 v205, v58, s95, v205
v_dot2_f32_bf16 v206, v59, s94, v206
v_dot2_f32_bf16 v207, v59, s95, v207
v_dot2_f32_bf16 v200, v60, s94, v200
v_dot2_f32_bf16 v201, v60, s95, v201
v_dot2_f32_bf16 v202, v61, s94, v202
v_dot2_f32_bf16 v203, v61, s95, v203
v_dot2_f32_bf16 v204, v62, s94, v204
v_dot2_f32_bf16 v205, v62, s95, v205
v_dot2_f32_bf16 v206, v63, s94, v206
v_dot2_f32_bf16 v207, v63, s95, v207
v_dot2_f32_bf16 v200, v64, s94, v200
v_dot2_f32_bf16 v201, v64, s95, v201
v_dot2_f32_bf16 v202, v65, s94, v202
v_dot2_f32_bf16 v203, v65, s95, v203
v_dot2_f32_bf16 v204, v66, s94, v204
v_dot2_f32_bf16 v205, v66, s95, v205
v_dot2_f32_bf16 v206, v67, s94, v206
v_dot2_f32_bf16 v207, v67, s95, v207
v_dot2_f32_bf16 v200, v68, s94, v200
v_dot2_f32_bf16 v201, v68, s95, v201
v_dot2_f32_bf16 v202, v69, s94, v202
v_dot2_f32_bf16 v203, v69, s95, v203
v_dot2_f32_bf16 v204, v70, s94, v204
v_dot2_f32_bf16 v205, v70, s95, v205
v_dot2_f32_bf16 v206, v71, s94, v206
v_dot2_f32_bf16 v207, v71, s95, v207
v_dot2_f32_bf16 v200, v72, s94, v200
v_dot2_f32_bf16 v201, v72, s95, v201
v_dot2_f32_bf16 v202, v73, s94, v202
v_dot2_f32_bf16 v203, v73, s95, v203
v_dot2_f32_bf16 v204, v74, s94, v204
v_dot2_f32_bf16 v205, v74, s95, v205
v_dot2_f32_bf16 v206, v75, s94, v206
v_dot2_f32_bf16 v207, v75, s95, v207
v_dot2_f32_bf16 v200, v76, s94, v200
v_dot2_f32_bf16 v201, v76, s95, v201
v_dot2_f32_bf16 v202, v77, s94, v202
v_dot2_f32_bf16 v203, v77, s95, v203
v_dot2_f32_bf16 v204, v78, s94, v204
v_dot2_f32_bf16 v205, v78, s95, v205
v_dot2_f32_bf16 v206, v79, s94, v206
v_dot2_f32_bf16 v207, v79, s95, v207
v_mul_f32 v208, 0xc0d22e3c, v200
v_mul_f32 v209, 0xc0d22e3c, v201
v_mul_f32 v210, 0xc0d22e3c, v202
v_mul_f32 v211, 0xc0d22e3c, v203
v_mul_f32 v212, 0xc0d22e3c, v204
v_mul_f32 v213, 0xc0d22e3c, v205
v_mul_f32 v214, 0xc0d22e3c, v206
v_mul_f32 v215, 0xc0d22e3c, v207
v_exp_f32 v208, v208
v_exp_f32 v209, v209
v_exp_f32 v210, v210
v_exp_f32 v211, v211
v_exp_f32 v212, v212
v_exp_f32 v213, v213
v_exp_f32 v214, v214
v_exp_f32 v215, v215
v_mul_f32 v192, v192, v200
v_mul_f32 v193, v193, v201
v_mul_f32 v194, v194, v202
v_mul_f32 v195, v195, v203
v_mul_f32 v196, v196, v204
v_mul_f32 v197, v197, v205
v_mul_f32 v198, v198, v206
v_mul_f32 v199, v199, v207
v_add_f32 v208, 1.0, v208
v_add_f32 v209, 1.0, v209
v_add_f32 v210, 1.0, v210
v_add_f32 v211, 1.0, v211
v_add_f32 v212, 1.0, v212
v_add_f32 v213, 1.0, v213
v_add_f32 v214, 1.0, v214
v_add_f32 v215, 1.0, v215
v_rcp_f32 v208, v208
v_rcp_f32 v209, v209
v_rcp_f32 v210, v210
v_rcp_f32 v211, v211
v_rcp_f32 v212, v212
v_rcp_f32 v213, v213
v_rcp_f32 v214, v214
v_rcp_f32 v215, v215
v_mul_f32 v192, 0x4091afa4, v192
v_mul_f32 v193, 0x4091afa4, v193
v_mul_f32 v194, 0x4091afa4, v194
v_mul_f32 v195, 0x4091afa4, v195
v_mul_f32 v196, 0x4091afa4, v196
v_mul_f32 v197, 0x4091afa4, v197
v_mul_f32 v198, 0x4091afa4, v198
v_mul_f32 v199, 0x4091afa4, v199
v_mul_f32 v192, v192, v208
v_mul_f32 v193, v193, v209
v_mul_f32 v194, v194, v210
v_mul_f32 v195, v195, v211
v_mul_f32 v196, v196, v212
v_mul_f32 v197, v197, v213
v_mul_f32 v198, v198, v214
v_mul_f32 v199, v199, v215
v_permlane32_swap_b32 v192, v196
v_permlane32_swap_b32 v193, v197
v_permlane32_swap_b32 v194, v198
v_permlane32_swap_b32 v195, v199
v_permlane16_swap_b32 v192, v196
v_permlane16_swap_b32 v193, v197
v_permlane16_swap_b32 v194, v198
v_permlane16_swap_b32 v195, v199
v_lshlrev_b32 v208, 16, v80
v_and_b32 v209, s46, v80
v_lshlrev_b32 v210, 16, v81
v_and_b32 v211, s46, v81
v_lshlrev_b32 v212, 16, v82
v_and_b32 v213, s46, v82
v_lshlrev_b32 v214, 16, v83
v_and_b32 v215, s46, v83
v_add_f32 v208, v208, v192
v_add_f32 v209, v209, v193
v_add_f32 v210, v210, v194
v_add_f32 v211, v211, v195
v_add_f32 v212, v212, v196
v_add_f32 v213, v213, v197
v_add_f32 v214, v214, v198
v_add_f32 v215, v215, v199
v_cvt_pk_bf16_f32 v204, v208, v209
v_cvt_pk_bf16_f32 v205, v210, v211
v_cvt_pk_bf16_f32 v206, v212, v213
v_cvt_pk_bf16_f32 v207, v214, v215
buffer_store_dwordx4 v[204:207], v217, s[60:63], 0 offen offset:512
s_mov_b32 s85, 0x1388
L_ver_ffn_8:
s_waitcnt vmcnt(0)
v_max3_u32 v208, v84, v85, v86
v_max3_u32 v208, v208, v87, v88
v_max3_u32 v208, v208, v89, v90
v_max3_u32 v208, v208, v91, v92
v_max3_u32 v208, v208, v93, v94
v_max3_u32 v208, v208, v95, v96
v_max3_u32 v208, v208, v97, v98
v_max3_u32 v208, v208, v99, v100
v_max3_u32 v208, v208, v101, v102
v_max3_u32 v208, v208, v103, v104
v_max3_u32 v208, v208, v105, v106
v_max3_u32 v208, v208, v107, v108
v_max3_u32 v208, v208, v109, v110
v_max3_u32 v208, v208, v111, v112
v_max3_u32 v208, v208, v113, v114
v_max3_u32 v208, v208, v115, v116
v_max3_u32 v208, v208, v117, v118
v_max3_u32 v208, v208, v119, v120
v_max3_u32 v208, v208, v121, v122
v_max3_u32 v208, v208, v123, v124
v_max3_u32 v208, v208, v125, v126
v_max3_u32 v208, v208, v127, v128
v_max3_u32 v208, v208, v129, v130
v_max3_u32 v208, v208, v131, v132
v_max3_u32 v208, v208, v133, v134
v_max3_u32 v208, v208, v135, v136
v_max3_u32 v208, v208, v137, v138
v_max3_u32 v208, v208, v139, v140
v_max3_u32 v208, v208, v141, v142
v_max3_u32 v208, v208, v143, v144
v_max3_u32 v208, v208, v145, v146
v_max_u32 v208, v208, v147
v_cmp_eq_u32 vcc, -1, v208
s_nop 4
s_cbranch_vccz L_ver_ffn_8_ok
s_sub_u32 s85, s85, 1
s_cmp_eq_u32 s85, 0
s_cbranch_scc1 L_ver_ffn_8_ok
s_sleep 2
buffer_load_dwordx4 v[84:87], v222, s[28:31], s56 offen offset:0 sc1
buffer_load_dwordx4 v[88:91], v222, s[28:31], s57 offen offset:0 sc1
buffer_load_dwordx4 v[92:95], v222, s[28:31], s58 offen offset:0 sc1
buffer_load_dwordx4 v[96:99], v222, s[28:31], s59 offen offset:0 sc1
buffer_load_dwordx4 v[100:103], v222, s[28:31], s64 offen offset:0 sc1
buffer_load_dwordx4 v[104:107], v222, s[28:31], s65 offen offset:0 sc1
buffer_load_dwordx4 v[108:111], v222, s[28:31], s66 offen offset:0 sc1
buffer_load_dwordx4 v[112:115], v222, s[28:31], s67 offen offset:0 sc1
buffer_load_dwordx4 v[116:119], v222, s[28:31], s72 offen offset:0 sc1
buffer_load_dwordx4 v[120:123], v222, s[28:31], s73 offen offset:0 sc1
buffer_load_dwordx4 v[124:127], v222, s[28:31], s74 offen offset:0 sc1
buffer_load_dwordx4 v[128:131], v222, s[28:31], s75 offen offset:0 sc1
buffer_load_dwordx4 v[132:135], v222, s[28:31], s88 offen offset:0 sc1
buffer_load_dwordx4 v[136:139], v222, s[28:31], s89 offen offset:0 sc1
buffer_load_dwordx4 v[140:143], v222, s[28:31], s90 offen offset:0 sc1
buffer_load_dwordx4 v[144:147], v222, s[28:31], s91 offen offset:0 sc1
s_branch L_ver_ffn_8
L_ver_ffn_8_ok:
s_waitcnt vmcnt(0)
v_dot2_f32_bf16 v192, v84, s94, 0
v_dot2_f32_bf16 v193, v84, s95, 0
v_dot2_f32_bf16 v194, v85, s94, 0
v_dot2_f32_bf16 v195, v85, s95, 0
v_dot2_f32_bf16 v196, v86, s94, 0
v_dot2_f32_bf16 v197, v86, s95, 0
v_dot2_f32_bf16 v198, v87, s94, 0
v_dot2_f32_bf16 v199, v87, s95, 0
v_dot2_f32_bf16 v192, v88, s94, v192
v_dot2_f32_bf16 v193, v88, s95, v193
v_dot2_f32_bf16 v194, v89, s94, v194
v_dot2_f32_bf16 v195, v89, s95, v195
v_dot2_f32_bf16 v196, v90, s94, v196
v_dot2_f32_bf16 v197, v90, s95, v197
v_dot2_f32_bf16 v198, v91, s94, v198
v_dot2_f32_bf16 v199, v91, s95, v199
v_dot2_f32_bf16 v192, v92, s94, v192
v_dot2_f32_bf16 v193, v92, s95, v193
v_dot2_f32_bf16 v194, v93, s94, v194
v_dot2_f32_bf16 v195, v93, s95, v195
v_dot2_f32_bf16 v196, v94, s94, v196
v_dot2_f32_bf16 v197, v94, s95, v197
v_dot2_f32_bf16 v198, v95, s94, v198
v_dot2_f32_bf16 v199, v95, s95, v199
v_dot2_f32_bf16 v192, v96, s94, v192
v_dot2_f32_bf16 v193, v96, s95, v193
v_dot2_f32_bf16 v194, v97, s94, v194
v_dot2_f32_bf16 v195, v97, s95, v195
v_dot2_f32_bf16 v196, v98, s94, v196
v_dot2_f32_bf16 v197, v98, s95, v197
v_dot2_f32_bf16 v198, v99, s94, v198
v_dot2_f32_bf16 v199, v99, s95, v199
v_dot2_f32_bf16 v192, v100, s94, v192
v_dot2_f32_bf16 v193, v100, s95, v193
v_dot2_f32_bf16 v194, v101, s94, v194
v_dot2_f32_bf16 v195, v101, s95, v195
v_dot2_f32_bf16 v196, v102, s94, v196
v_dot2_f32_bf16 v197, v102, s95, v197
v_dot2_f32_bf16 v198, v103, s94, v198
v_dot2_f32_bf16 v199, v103, s95, v199
v_dot2_f32_bf16 v192, v104, s94, v192
v_dot2_f32_bf16 v193, v104, s95, v193
v_dot2_f32_bf16 v194, v105, s94, v194
v_dot2_f32_bf16 v195, v105, s95, v195
v_dot2_f32_bf16 v196, v106, s94, v196
v_dot2_f32_bf16 v197, v106, s95, v197
v_dot2_f32_bf16 v198, v107, s94, v198
v_dot2_f32_bf16 v199, v107, s95, v199
v_dot2_f32_bf16 v192, v108, s94, v192
v_dot2_f32_bf16 v193, v108, s95, v193
v_dot2_f32_bf16 v194, v109, s94, v194
v_dot2_f32_bf16 v195, v109, s95, v195
v_dot2_f32_bf16 v196, v110, s94, v196
v_dot2_f32_bf16 v197, v110, s95, v197
v_dot2_f32_bf16 v198, v111, s94, v198
v_dot2_f32_bf16 v199, v111, s95, v199
v_dot2_f32_bf16 v192, v112, s94, v192
v_dot2_f32_bf16 v193, v112, s95, v193
v_dot2_f32_bf16 v194, v113, s94, v194
v_dot2_f32_bf16 v195, v113, s95, v195
v_dot2_f32_bf16 v196, v114, s94, v196
v_dot2_f32_bf16 v197, v114, s95, v197
v_dot2_f32_bf16 v198, v115, s94, v198
v_dot2_f32_bf16 v199, v115, s95, v199
v_dot2_f32_bf16 v200, v116, s94, 0
v_dot2_f32_bf16 v201, v116, s95, 0
v_dot2_f32_bf16 v202, v117, s94, 0
v_dot2_f32_bf16 v203, v117, s95, 0
v_dot2_f32_bf16 v204, v118, s94, 0
v_dot2_f32_bf16 v205, v118, s95, 0
v_dot2_f32_bf16 v206, v119, s94, 0
v_dot2_f32_bf16 v207, v119, s95, 0
v_dot2_f32_bf16 v200, v120, s94, v200
v_dot2_f32_bf16 v201, v120, s95, v201
v_dot2_f32_bf16 v202, v121, s94, v202
v_dot2_f32_bf16 v203, v121, s95, v203
v_dot2_f32_bf16 v204, v122, s94, v204
v_dot2_f32_bf16 v205, v122, s95, v205
v_dot2_f32_bf16 v206, v123, s94, v206
v_dot2_f32_bf16 v207, v123, s95, v207
v_dot2_f32_bf16 v200, v124, s94, v200
v_dot2_f32_bf16 v201, v124, s95, v201
v_dot2_f32_bf16 v202, v125, s94, v202
v_dot2_f32_bf16 v203, v125, s95, v203
v_dot2_f32_bf16 v204, v126, s94, v204
v_dot2_f32_bf16 v205, v126, s95, v205
v_dot2_f32_bf16 v206, v127, s94, v206
v_dot2_f32_bf16 v207, v127, s95, v207
v_dot2_f32_bf16 v200, v128, s94, v200
v_dot2_f32_bf16 v201, v128, s95, v201
v_dot2_f32_bf16 v202, v129, s94, v202
v_dot2_f32_bf16 v203, v129, s95, v203
v_dot2_f32_bf16 v204, v130, s94, v204
v_dot2_f32_bf16 v205, v130, s95, v205
v_dot2_f32_bf16 v206, v131, s94, v206
v_dot2_f32_bf16 v207, v131, s95, v207
v_dot2_f32_bf16 v200, v132, s94, v200
v_dot2_f32_bf16 v201, v132, s95, v201
v_dot2_f32_bf16 v202, v133, s94, v202
v_dot2_f32_bf16 v203, v133, s95, v203
v_dot2_f32_bf16 v204, v134, s94, v204
v_dot2_f32_bf16 v205, v134, s95, v205
v_dot2_f32_bf16 v206, v135, s94, v206
v_dot2_f32_bf16 v207, v135, s95, v207
v_dot2_f32_bf16 v200, v136, s94, v200
v_dot2_f32_bf16 v201, v136, s95, v201
v_dot2_f32_bf16 v202, v137, s94, v202
v_dot2_f32_bf16 v203, v137, s95, v203
v_dot2_f32_bf16 v204, v138, s94, v204
v_dot2_f32_bf16 v205, v138, s95, v205
v_dot2_f32_bf16 v206, v139, s94, v206
v_dot2_f32_bf16 v207, v139, s95, v207
v_dot2_f32_bf16 v200, v140, s94, v200
v_dot2_f32_bf16 v201, v140, s95, v201
v_dot2_f32_bf16 v202, v141, s94, v202
v_dot2_f32_bf16 v203, v141, s95, v203
v_dot2_f32_bf16 v204, v142, s94, v204
v_dot2_f32_bf16 v205, v142, s95, v205
v_dot2_f32_bf16 v206, v143, s94, v206
v_dot2_f32_bf16 v207, v143, s95, v207
v_dot2_f32_bf16 v200, v144, s94, v200
v_dot2_f32_bf16 v201, v144, s95, v201
v_dot2_f32_bf16 v202, v145, s94, v202
v_dot2_f32_bf16 v203, v145, s95, v203
v_dot2_f32_bf16 v204, v146, s94, v204
v_dot2_f32_bf16 v205, v146, s95, v205
v_dot2_f32_bf16 v206, v147, s94, v206
v_dot2_f32_bf16 v207, v147, s95, v207
v_mul_f32 v208, 0xc0d22e3c, v200
v_mul_f32 v209, 0xc0d22e3c, v201
v_mul_f32 v210, 0xc0d22e3c, v202
v_mul_f32 v211, 0xc0d22e3c, v203
v_mul_f32 v212, 0xc0d22e3c, v204
v_mul_f32 v213, 0xc0d22e3c, v205
v_mul_f32 v214, 0xc0d22e3c, v206
v_mul_f32 v215, 0xc0d22e3c, v207
v_exp_f32 v208, v208
v_exp_f32 v209, v209
v_exp_f32 v210, v210
v_exp_f32 v211, v211
v_exp_f32 v212, v212
v_exp_f32 v213, v213
v_exp_f32 v214, v214
v_exp_f32 v215, v215
v_mul_f32 v192, v192, v200
v_mul_f32 v193, v193, v201
v_mul_f32 v194, v194, v202
v_mul_f32 v195, v195, v203
v_mul_f32 v196, v196, v204
v_mul_f32 v197, v197, v205
v_mul_f32 v198, v198, v206
v_mul_f32 v199, v199, v207
v_add_f32 v208, 1.0, v208
v_add_f32 v209, 1.0, v209
v_add_f32 v210, 1.0, v210
v_add_f32 v211, 1.0, v211
v_add_f32 v212, 1.0, v212
v_add_f32 v213, 1.0, v213
v_add_f32 v214, 1.0, v214
v_add_f32 v215, 1.0, v215
v_rcp_f32 v208, v208
v_rcp_f32 v209, v209
v_rcp_f32 v210, v210
v_rcp_f32 v211, v211
v_rcp_f32 v212, v212
v_rcp_f32 v213, v213
v_rcp_f32 v214, v214
v_rcp_f32 v215, v215
v_mul_f32 v192, 0x4091afa4, v192
v_mul_f32 v193, 0x4091afa4, v193
v_mul_f32 v194, 0x4091afa4, v194
v_mul_f32 v195, 0x4091afa4, v195
v_mul_f32 v196, 0x4091afa4, v196
v_mul_f32 v197, 0x4091afa4, v197
v_mul_f32 v198, 0x4091afa4, v198
v_mul_f32 v199, 0x4091afa4, v199
v_mul_f32 v192, v192, v208
v_mul_f32 v193, v193, v209
v_mul_f32 v194, v194, v210
v_mul_f32 v195, v195, v211
v_mul_f32 v196, v196, v212
v_mul_f32 v197, v197, v213
v_mul_f32 v198, v198, v214
v_mul_f32 v199, v199, v215
v_permlane32_swap_b32 v192, v196
v_permlane32_swap_b32 v193, v197
v_permlane32_swap_b32 v194, v198
v_permlane32_swap_b32 v195, v199
v_permlane16_swap_b32 v192, v196
v_permlane16_swap_b32 v193, v197
v_permlane16_swap_b32 v194, v198
v_permlane16_swap_b32 v195, v199
v_lshlrev_b32 v208, 16, v148
v_and_b32 v209, s46, v148
v_lshlrev_b32 v210, 16, v149
v_and_b32 v211, s46, v149
v_lshlrev_b32 v212, 16, v150
v_and_b32 v213, s46, v150
v_lshlrev_b32 v214, 16, v151
v_and_b32 v215, s46, v151
v_add_f32 v208, v208, v192
v_add_f32 v209, v209, v193
v_add_f32 v210, v210, v194
v_add_f32 v211, v211, v195
v_add_f32 v212, v212, v196
v_add_f32 v213, v213, v197
v_add_f32 v214, v214, v198
v_add_f32 v215, v215, v199
v_cvt_pk_bf16_f32 v204, v208, v209
v_cvt_pk_bf16_f32 v205, v210, v211
v_cvt_pk_bf16_f32 v206, v212, v213
v_cvt_pk_bf16_f32 v207, v214, v215
buffer_store_dwordx4 v[204:207], v217, s[60:63], 0 offen offset:640
s_branch L_fin_ffn
s_endpgm
.section .rodata,"a"
.p2align 6
.amdhsa_kernel recurrent_scan__sliding_block_cached__geglu_ffn__prompt_kernel
  .amdhsa_next_free_vgpr 512
  .amdhsa_next_free_sgpr 102
  .amdhsa_accum_offset 256
  .amdhsa_group_segment_fixed_size 0
  .amdhsa_kernarg_size 96
  .amdhsa_user_sgpr_count 2
  .amdhsa_user_sgpr_kernarg_segment_ptr 1
  .amdhsa_system_sgpr_workgroup_id_x 1
  .amdhsa_float_denorm_mode_32 3
.end_amdhsa_kernel
.text
```
